```python
import torch

def _softmax(x, axis=-1):
    return torch.softmax(x, dim=axis)
def _gelu(x):
    return torch.nn.functional.gelu(x, approximate="tanh")
def _silu(x):
    return torch.nn.functional.silu(x)
def _sigmoid(x):
    return torch.sigmoid(x)
def _layernorm(x, axis=-1, eps=1e-5):
    m = x.mean(dim=axis, keepdim=True)
    v = x.var(dim=axis, keepdim=True, unbiased=False)
    return (x - m) / torch.sqrt(v + eps)
def _scatter_add(tgt, idx, src, axis=0):
    return tgt.clone().index_add_(axis, idx, src)
def _segment_sum(src, seg, n):
    out = torch.zeros((n,) + src.shape[1:], dtype=src.dtype)
    return out.index_add_(0, seg, src)
def _pad(x, pw):
    flat = tuple(v for pair in reversed(pw) for v in pair)
    return torch.nn.functional.pad(x, flat)

kernel_name = 'recurrent_scan__mha_block__swiglu_ffn__prompt'

def setup_inputs():

    _w = (lambda a: (lambda t: t.to(torch.bfloat16) if t.is_floating_point() else t)(torch.as_tensor(a)))
    def _A_setup():
        B, S, D, H = 1, 2048, 1024, 32
        return {
            "x": _w((lambda *s: torch.randn(*s, dtype=torch.bfloat16) * 0.05)(B, S, D)),
            "wqkv": _w((lambda *s: torch.randn(*s, dtype=torch.bfloat16) * 0.05)(D, 3 * D)),
            "wo": _w((lambda *s: torch.randn(*s, dtype=torch.bfloat16) * 0.05)(D, D)),
        }
    _A_in = _A_setup()

    def _B_setup():
        B, S, D, F = 1, 2048, 1024, 3584
        return {
            "x": _w((lambda *s: torch.randn(*s, dtype=torch.bfloat16) * 0.05)(B, S, D)),
            "w_gate": _w((lambda *s: torch.randn(*s, dtype=torch.bfloat16) * 0.05)(D, F)),
            "w_up": _w((lambda *s: torch.randn(*s, dtype=torch.bfloat16) * 0.05)(D, F)),
            "w_down": _w((lambda *s: torch.randn(*s, dtype=torch.bfloat16) * 0.05)(F, D)),
        }
    _B_in = _B_setup()

    return {
        "A_x": _A_in["x"],
        "A_wqkv": _A_in["wqkv"],
        "A_wo": _A_in["wo"],
        "B_x": _B_in["x"],
        "B_w_gate": _B_in["w_gate"],
        "B_w_up": _B_in["w_up"],
        "B_w_down": _B_in["w_down"],
    }

def reference(A_x, A_wqkv, A_wo, B_x, B_w_gate, B_w_up, B_w_down):
    def _A_ref(x, wqkv, wo):
        B, S, D = x.shape
        H = 32
        Dh = D // H
        qkv = (lambda x, *d: x.permute(*d))((x @ wqkv).reshape(B, S, 3, H, Dh), 2, 0, 3, 1, 4)
        q, k, v = qkv[0], qkv[1], qkv[2]
        scores = torch.einsum("bhqd,bhkd->bhqk", q, k) * (Dh ** -0.5)
        p = _softmax(scores, axis=-1)
        o = torch.einsum("bhqk,bhkd->bhqd", p, v)
        return (lambda x, *d: x.permute(*d))(o, 0, 2, 1, 3).reshape(B, S, D) @ wo

    def _B_ref(x, w_gate, w_up, w_down):
        g = _silu(x @ w_gate)
        u = x @ w_up
        return (g * u) @ w_down

    x = A_x
    xn = _layernorm(x, axis=-1)
    s = _A_ref(xn, A_wqkv, A_wo)
    g = _silu(_B_ref(xn, B_w_gate, B_w_up, B_w_down))
    return x + s * g
```

```asm
; @launch kernel=gemm1_kernel grid=(256,1,1) block=(256,1,1) lds=163840
; @launch kernel=attfin_kernel grid=(512,1,1) block=(256,1,1) lds=65536
.amdgcn_target "amdgcn-amd-amdhsa--gfx950"
.text
.globl gemm1_kernel
.p2align 8
.type gemm1_kernel,@function
gemm1_kernel:
 s_cmp_ge_u32 s2, 256
 s_cbranch_scc1 L_g1_end
 s_load_dwordx2 s[14:15], s[0:1], 0
 s_load_dwordx2 s[6:7], s[0:1], 8
 s_load_dwordx4 s[8:11], s[0:1], 32
 s_load_dwordx2 s[12:13], s[0:1], 72
 s_load_dwordx2 s[16:17], s[0:1], 64
 s_load_dwordx2 s[4:5], s[0:1], 48
 s_load_dwordx2 s[88:89], s[0:1], 16
 v_lshrrev_b32 v15, 6, v0
 v_and_b32 v1, 63, v0
 s_and_b32 s97, s2, 31
 s_xor_b32 s97, s97, 1
 s_lshr_b32 s98, s2, 5
 v_readfirstlane_b32 s95, v15
L_g1_here:
 s_lshr_b32 s3, s2, 3
 s_mul_i32 s3, s3, 640
 v_min_u32 v60, 4, v1
 v_lshlrev_b32 v60, 7, v60
 v_add_u32 v60, s3, v60
 v_min_u32 v60, L_g1_H - L_g1_here - 4, v60
 s_getpc_b64 s[80:81]
 s_add_u32 s80, s80, L_g1_here - .
 s_addc_u32 s81, s81, -1
 v_mov_b32 v61, s81
 v_add_co_u32 v60, vcc, s80, v60
 s_nop 1
 v_addc_co_u32 v61, vcc, 0, v61, vcc
 global_load_dword v62, v[60:61], off
 s_lshl_b32 s101, s98, 5
 s_add_u32 s101, s101, s97
 v_and_b32 v65, 7, v0
 v_bfe_u32 v66, v0, 3, 2
 v_bfe_u32 v67, v0, 5, 1
 v_lshlrev_b32 v69, 11, v65
 v_lshl_add_u32 v69, v66, 4, v69
 v_lshl_add_u32 v69, v67, 6, v69
 v_lshl_add_u32 v69, v15, 9, v69
 s_lshl_b32 s3, s101, 14
 s_waitcnt lgkmcnt(0)
 s_mov_b32 s80, s14
 s_mov_b32 s81, s15
 s_mov_b32 s82, 0x400000
 s_mov_b32 s83, 0x20000
 s_mov_b32 s84, s12
 s_mov_b32 s85, s13
 s_mov_b32 s86, 0x10000000
 s_mov_b32 s87, 0x20000
 v_mov_b32 v27, 0
 s_or_b32 s100, s101, s95
 s_cbranch_scc1 L_g1_noold
 s_mov_b32 s100, 42008576
 buffer_load_dword v26, v27, s[84:87], s100 offen sc1
L_g1_noold:
 buffer_load_dwordx4 v[80:83], v69, s[80:83], s3 offen offset:0
 buffer_load_dwordx4 v[84:87], v69, s[80:83], s3 offen offset:128
 buffer_load_dwordx4 v[88:91], v69, s[80:83], s3 offen offset:256
 buffer_load_dwordx4 v[92:95], v69, s[80:83], s3 offen offset:384
 s_lshl_b32 s3, s95, 2
 s_lshr_b32 s100, s95, 1
 s_lshl_b32 s100, s100, 1
 s_sub_u32 s3, s3, s100
 s_add_u32 s3, s3, 3
 s_and_b32 s3, s3, 7
 s_lshl_b32 s3, s3, 7
 s_cmp_ge_u32 s95, 1
 s_cselect_b32 s3, 0x100000, s3
 v_lshlrev_b32 v28, 10, v1
 v_add_u32 v28, s3, v28
 s_mov_b32 s80, s8
 s_mov_b32 s81, s9
 s_mov_b32 s82, 0x0
 s_mov_b32 s83, 0x20000
 s_mul_i32 s3, s2, 7168
 s_add_u32 s82, s3, 7168
 buffer_load_dword v29, v28, s[80:83], s3 offen
 s_mov_b32 s80, s10
 s_mov_b32 s81, s11
 s_mov_b32 s82, 0x0
 s_mov_b32 s83, 0x20000
 s_mul_i32 s3, s2, 7168
 s_add_u32 s82, s3, 7168
 buffer_load_dword v29, v28, s[80:83], s3 offen
 s_mov_b32 s80, s6
 s_mov_b32 s81, s7
 s_mov_b32 s82, 0x0
 s_mov_b32 s83, 0x20000
 s_mul_i32 s3, s2, 6144
 s_add_u32 s82, s3, 6144
 buffer_load_dword v29, v28, s[80:83], s3 offen
 s_mov_b32 s12, s88
 s_mov_b32 s13, s89
 s_movk_i32 s18, 256
 s_mov_b32 s19, 0x20000
 v_lshrrev_b32 v16, 2, v1
 v_lshl_add_u32 v16, v15, 4, v16
 v_lshrrev_b32 v17, 5, v1
 v_lshlrev_b32 v17, 1, v17
 v_and_b32 v18, 3, v1
 v_xor_b32 v17, v17, v18
 v_lshlrev_b32 v17, 4, v17
 v_lshrrev_b32 v19, 4, v1
 v_bfe_u32 v20, v1, 2, 2
 v_lshl_add_u32 v20, v19, 3, v20
 v_lshlrev_b32 v20, 6, v20
 v_lshl_add_u32 v20, v18, 3, v20
 v_and_b32 v21, 1, v19
 v_lshl_add_u32 v4, v21, 5, v20
 v_xor_b32 v5, 32, v4
 s_lshl_b32 s3, s98, 4
 s_lshl_b32 s14, s95, 2
 s_add_u32 s3, s3, s14
 s_lshl_b32 s14, s3, 15
 v_lshl_add_u32 v8, v1, 4, s14
 v_add_u32 v9, 32768, v8
 v_add_u32 v10, 65536, v8
 v_add_u32 v11, 98304, v8
 s_mul_i32 s14, s3, 114688
 s_add_u32 s14, s14, 20971520
 v_lshl_add_u32 v12, v1, 4, s14
 s_lshl_b32 s14, s3, 11
 s_add_u32 s14, s14, 4194304
 v_lshrrev_b32 v22, 1, v19
 v_lshlrev_b32 v22, 10, v22
 v_lshl_add_u32 v22, v21, 9, v22
 v_add_u32 v22, s14, v22
 v_and_b32 v23, 15, v1
 v_lshl_add_u32 v14, v23, 4, v22
 v_and_b32 v24, 7, v1
 v_bfe_u32 v25, v1, 3, 1
 v_lshl_add_u32 v22, v24, 4, v22
 v_lshl_add_u32 v13, v25, 8, v22
 s_lshl_b32 s94, s95, 10
 s_mov_b32 s93, 0
 s_mov_b32 s92, 0
 s_mov_b32 s88, 0
 s_mov_b32 s89, 0
 s_cmp_ge_u32 s97, 23
 s_cbranch_scc1 L_g1_setq
 s_cmp_eq_u32 s97, 22
 s_cbranch_scc1 L_g1_setm
 s_mul_i32 s100, s97, 256
 s_add_u32 s99, s100, 0
 s_add_u32 s40, s8, s99
 s_addc_u32 s41, s9, 0
 s_sub_u32 s42, 7340032, s99
 s_mov_b32 s43, 0x20000
 s_add_u32 s99, s100, 0
 s_add_u32 s44, s10, s99
 s_addc_u32 s45, s11, 0
 s_sub_u32 s46, 7340032, s99
 s_mov_b32 s47, 0x20000
 s_add_u32 s99, s100, 64
 s_add_u32 s48, s8, s99
 s_addc_u32 s49, s9, 0
 s_sub_u32 s50, 7340032, s99
 s_mov_b32 s51, 0x20000
 s_add_u32 s99, s100, 64
 s_add_u32 s52, s10, s99
 s_addc_u32 s53, s11, 0
 s_sub_u32 s54, 7340032, s99
 s_mov_b32 s55, 0x20000
 s_add_u32 s99, s100, 128
 s_add_u32 s56, s8, s99
 s_addc_u32 s57, s9, 0
 s_sub_u32 s58, 7340032, s99
 s_mov_b32 s59, 0x20000
 s_add_u32 s99, s100, 128
 s_add_u32 s60, s10, s99
 s_addc_u32 s61, s11, 0
 s_sub_u32 s62, 7340032, s99
 s_mov_b32 s63, 0x20000
 s_add_u32 s99, s100, 192
 s_add_u32 s64, s8, s99
 s_addc_u32 s65, s9, 0
 s_sub_u32 s66, 7340032, s99
 s_mov_b32 s67, 0x20000
 s_add_u32 s99, s100, 192
 s_add_u32 s68, s10, s99
 s_addc_u32 s69, s11, 0
 s_sub_u32 s70, 7340032, s99
 s_mov_b32 s71, 0x20000
 s_lshl_b32 s100, s97, 6
 s_add_u32 s99, s100, 5760
 s_add_u32 s72, s8, s99
 s_addc_u32 s73, s9, 0
 s_sub_u32 s74, 7340032, s99
 s_mov_b32 s75, 0x20000
 s_add_u32 s99, s100, 5760
 s_add_u32 s76, s10, s99
 s_addc_u32 s77, s11, 0
 s_sub_u32 s78, 7340032, s99
 s_mov_b32 s79, 0x20000
 s_movk_i32 s14, 7168
 s_movk_i32 s15, 7168
 v_mul_lo_u32 v2, v16, s14
 v_mul_lo_u32 v3, v16, s15
 v_add_u32 v2, v2, v17
 v_add_u32 v3, v3, v17
 s_mov_b32 s90, 458752
 s_mov_b32 s91, 458752
 s_branch L_g1_go
L_g1_setm:
 s_movk_i32 s100, 5632
 s_add_u32 s99, s100, 0
 s_add_u32 s40, s8, s99
 s_addc_u32 s41, s9, 0
 s_sub_u32 s42, 7340032, s99
 s_mov_b32 s43, 0x20000
 s_add_u32 s99, s100, 0
 s_add_u32 s44, s10, s99
 s_addc_u32 s45, s11, 0
 s_sub_u32 s46, 7340032, s99
 s_mov_b32 s47, 0x20000
 s_add_u32 s99, s100, 64
 s_add_u32 s48, s8, s99
 s_addc_u32 s49, s9, 0
 s_sub_u32 s50, 7340032, s99
 s_mov_b32 s51, 0x20000
 s_add_u32 s99, s100, 64
 s_add_u32 s52, s10, s99
 s_addc_u32 s53, s11, 0
 s_sub_u32 s54, 7340032, s99
 s_mov_b32 s55, 0x20000
 s_mov_b32 s100, 0
 s_add_u32 s99, s100, 0
 s_add_u32 s56, s6, s99
 s_addc_u32 s57, s7, 0
 s_sub_u32 s58, 6291456, s99
 s_mov_b32 s59, 0x20000
 s_add_u32 s99, s100, 128
 s_add_u32 s60, s6, s99
 s_addc_u32 s61, s7, 0
 s_sub_u32 s62, 6291456, s99
 s_mov_b32 s63, 0x20000
 s_add_u32 s99, s100, 64
 s_add_u32 s64, s6, s99
 s_addc_u32 s65, s7, 0
 s_sub_u32 s66, 6291456, s99
 s_mov_b32 s67, 0x20000
 s_add_u32 s99, s100, 192
 s_add_u32 s68, s6, s99
 s_addc_u32 s69, s7, 0
 s_sub_u32 s70, 6291456, s99
 s_mov_b32 s71, 0x20000
 s_add_u32 s99, s100, 256
 s_add_u32 s72, s6, s99
 s_addc_u32 s73, s7, 0
 s_sub_u32 s74, 6291456, s99
 s_mov_b32 s75, 0x20000
 s_add_u32 s99, s100, 320
 s_add_u32 s76, s6, s99
 s_addc_u32 s77, s7, 0
 s_sub_u32 s78, 6291456, s99
 s_mov_b32 s79, 0x20000
 s_movk_i32 s14, 7168
 s_movk_i32 s15, 6144
 v_mul_lo_u32 v2, v16, s14
 v_mul_lo_u32 v3, v16, s15
 v_add_u32 v2, v2, v17
 v_add_u32 v3, v3, v17
 s_mov_b32 s90, 458752
 s_mov_b32 s91, 393216
 s_branch L_g1_go
L_g1_setq:
 s_mul_i32 s100, s97, 640
 s_sub_u32 s100, s100, 14336
 s_add_u32 s99, s100, 0
 s_add_u32 s40, s6, s99
 s_addc_u32 s41, s7, 0
 s_sub_u32 s42, 6291456, s99
 s_mov_b32 s43, 0x20000
 s_add_u32 s99, s100, 128
 s_add_u32 s44, s6, s99
 s_addc_u32 s45, s7, 0
 s_sub_u32 s46, 6291456, s99
 s_mov_b32 s47, 0x20000
 s_add_u32 s99, s100, 64
 s_add_u32 s48, s6, s99
 s_addc_u32 s49, s7, 0
 s_sub_u32 s50, 6291456, s99
 s_mov_b32 s51, 0x20000
 s_add_u32 s99, s100, 192
 s_add_u32 s52, s6, s99
 s_addc_u32 s53, s7, 0
 s_sub_u32 s54, 6291456, s99
 s_mov_b32 s55, 0x20000
 s_add_u32 s99, s100, 256
 s_add_u32 s56, s6, s99
 s_addc_u32 s57, s7, 0
 s_sub_u32 s58, 6291456, s99
 s_mov_b32 s59, 0x20000
 s_add_u32 s99, s100, 384
 s_add_u32 s60, s6, s99
 s_addc_u32 s61, s7, 0
 s_sub_u32 s62, 6291456, s99
 s_mov_b32 s63, 0x20000
 s_add_u32 s99, s100, 320
 s_add_u32 s64, s6, s99
 s_addc_u32 s65, s7, 0
 s_sub_u32 s66, 6291456, s99
 s_mov_b32 s67, 0x20000
 s_add_u32 s99, s100, 448
 s_add_u32 s68, s6, s99
 s_addc_u32 s69, s7, 0
 s_sub_u32 s70, 6291456, s99
 s_mov_b32 s71, 0x20000
 s_add_u32 s99, s100, 512
 s_add_u32 s72, s6, s99
 s_addc_u32 s73, s7, 0
 s_sub_u32 s74, 6291456, s99
 s_mov_b32 s75, 0x20000
 s_add_u32 s99, s100, 576
 s_add_u32 s76, s6, s99
 s_addc_u32 s77, s7, 0
 s_sub_u32 s78, 6291456, s99
 s_mov_b32 s79, 0x20000
 s_movk_i32 s14, 6144
 s_movk_i32 s15, 6144
 v_mul_lo_u32 v2, v16, s14
 v_mul_lo_u32 v3, v16, s15
 v_add_u32 v2, v2, v17
 v_add_u32 v3, v3, v17
 s_mov_b32 s90, 393216
 s_mov_b32 s91, 393216
L_g1_go:
 s_cmp_lt_u32 s97, 28
 s_cbranch_scc1 L_g1_vt_done
 s_cmp_eq_u32 s97, 28
 s_cbranch_scc1 L_g1_vt_b
 s_mov_b32 s3, s95
 s_mul_i32 s3, s3, 2560
 v_min_u32 v30, 19, v1
 v_lshlrev_b32 v30, 7, v30
 v_add_u32 v30, s3, v30
 v_min_u32 v30, L_g1_C - L_g1_varC - 4, v30
 s_getpc_b64 s[14:15]
 s_add_u32 s14, s14, L_g1_varC - .
 s_addc_u32 s15, s15, 0
 v_mov_b32 v31, s15
 v_add_co_u32 v30, vcc, s14, v30
 s_nop 1
 v_addc_co_u32 v31, vcc, 0, v31, vcc
 global_load_dword v32, v[30:31], off
 s_branch L_g1_vt_done
L_g1_vt_b:
 s_mov_b32 s3, s95
 s_mul_i32 s3, s3, 2560
 v_min_u32 v30, 19, v1
 v_lshlrev_b32 v30, 7, v30
 v_add_u32 v30, s3, v30
 v_min_u32 v30, L_g1_B - L_g1_varB - 4, v30
 s_getpc_b64 s[14:15]
 s_add_u32 s14, s14, L_g1_varB - .
 s_addc_u32 s15, s15, 0
 v_mov_b32 v31, s15
 v_add_co_u32 v30, vcc, s14, v30
 s_nop 1
 v_addc_co_u32 v31, vcc, 0, v31, vcc
 global_load_dword v32, v[30:31], off
L_g1_vt_done:
 s_and_b32 s14, s98, 0
 s_mul_i32 s14, s14, 16
 s_mov_b32 s9, s14
 s_mov_b32 s10, s14
 s_lshr_b32 s11, s98, 0
 s_bfe_u32 s3, s2, 0x20003
 s_mul_i32 s3, s3, 1
 s_add_u32 s11, s11, s3
 s_cmp_lt_u32 s9, 4
 s_cselect_b32 s3, 1, 3
 s_add_u32 s14, s9, s11
 s_and_b32 s14, s14, s3
 s_andn2_b32 s3, s9, s3
 s_or_b32 s14, s14, s3
 s_mul_i32 s88, s14, s90
 s_mul_i32 s89, s14, s91
 s_lshl_b32 s92, s14, 11
 s_lshl_b32 s99, s95, 10
 s_add_u32 s99, s99, 163840
 s_add_u32 m0, s94, 0
 s_nop 0
 buffer_load_dwordx4 v2, s[40:43], s88 offen lds
 s_add_u32 m0, s94, 8192
 s_nop 0
 buffer_load_dwordx4 v2, s[48:51], s88 offen lds
 s_add_u32 m0, s94, 4096
 s_nop 0
 buffer_load_dwordx4 v2, s[44:47], s88 offen lds
 s_add_u32 m0, s94, 12288
 s_nop 0
 buffer_load_dwordx4 v2, s[52:55], s88 offen lds
 s_add_u32 m0, s94, 16384
 s_nop 0
 buffer_load_dwordx4 v3, s[56:59], s89 offen lds
 v_accvgpr_write_b32 a0, 0
 v_accvgpr_write_b32 a1, 0
 v_accvgpr_write_b32 a2, 0
 v_accvgpr_write_b32 a3, 0
 v_accvgpr_write_b32 a4, 0
 v_accvgpr_write_b32 a5, 0
 v_accvgpr_write_b32 a6, 0
 v_accvgpr_write_b32 a7, 0
 v_accvgpr_write_b32 a8, 0
 v_accvgpr_write_b32 a9, 0
 v_accvgpr_write_b32 a10, 0
 v_accvgpr_write_b32 a11, 0
 v_accvgpr_write_b32 a12, 0
 v_accvgpr_write_b32 a13, 0
 v_accvgpr_write_b32 a14, 0
 v_accvgpr_write_b32 a15, 0
 v_accvgpr_write_b32 a16, 0
 v_accvgpr_write_b32 a17, 0
 v_accvgpr_write_b32 a18, 0
 v_accvgpr_write_b32 a19, 0
 v_accvgpr_write_b32 a20, 0
 v_accvgpr_write_b32 a21, 0
 v_accvgpr_write_b32 a22, 0
 v_accvgpr_write_b32 a23, 0
 v_accvgpr_write_b32 a24, 0
 v_accvgpr_write_b32 a25, 0
 v_accvgpr_write_b32 a26, 0
 v_accvgpr_write_b32 a27, 0
 v_accvgpr_write_b32 a28, 0
 v_accvgpr_write_b32 a29, 0
 v_accvgpr_write_b32 a30, 0
 v_accvgpr_write_b32 a31, 0
 v_accvgpr_write_b32 a32, 0
 v_accvgpr_write_b32 a33, 0
 v_accvgpr_write_b32 a34, 0
 v_accvgpr_write_b32 a35, 0
 v_accvgpr_write_b32 a36, 0
 v_accvgpr_write_b32 a37, 0
 v_accvgpr_write_b32 a38, 0
 v_accvgpr_write_b32 a39, 0
 v_accvgpr_write_b32 a40, 0
 v_accvgpr_write_b32 a41, 0
 v_accvgpr_write_b32 a42, 0
 v_accvgpr_write_b32 a43, 0
 v_accvgpr_write_b32 a44, 0
 v_accvgpr_write_b32 a45, 0
 v_accvgpr_write_b32 a46, 0
 v_accvgpr_write_b32 a47, 0
 v_accvgpr_write_b32 a48, 0
 v_accvgpr_write_b32 a49, 0
 v_accvgpr_write_b32 a50, 0
 v_accvgpr_write_b32 a51, 0
 v_accvgpr_write_b32 a52, 0
 v_accvgpr_write_b32 a53, 0
 v_accvgpr_write_b32 a54, 0
 v_accvgpr_write_b32 a55, 0
 v_accvgpr_write_b32 a56, 0
 v_accvgpr_write_b32 a57, 0
 v_accvgpr_write_b32 a58, 0
 v_accvgpr_write_b32 a59, 0
 v_accvgpr_write_b32 a60, 0
 v_accvgpr_write_b32 a61, 0
 v_accvgpr_write_b32 a62, 0
 v_accvgpr_write_b32 a63, 0
 v_accvgpr_write_b32 a64, 0
 v_accvgpr_write_b32 a65, 0
 v_accvgpr_write_b32 a66, 0
 v_accvgpr_write_b32 a67, 0
 v_accvgpr_write_b32 a68, 0
 v_accvgpr_write_b32 a69, 0
 v_accvgpr_write_b32 a70, 0
 v_accvgpr_write_b32 a71, 0
 v_accvgpr_write_b32 a72, 0
 v_accvgpr_write_b32 a73, 0
 v_accvgpr_write_b32 a74, 0
 v_accvgpr_write_b32 a75, 0
 v_accvgpr_write_b32 a76, 0
 v_accvgpr_write_b32 a77, 0
 v_accvgpr_write_b32 a78, 0
 v_accvgpr_write_b32 a79, 0
 v_accvgpr_write_b32 a80, 0
 v_accvgpr_write_b32 a81, 0
 v_accvgpr_write_b32 a82, 0
 v_accvgpr_write_b32 a83, 0
 v_accvgpr_write_b32 a84, 0
 v_accvgpr_write_b32 a85, 0
 v_accvgpr_write_b32 a86, 0
 v_accvgpr_write_b32 a87, 0
 v_accvgpr_write_b32 a88, 0
 v_accvgpr_write_b32 a89, 0
 v_accvgpr_write_b32 a90, 0
 v_accvgpr_write_b32 a91, 0
 v_accvgpr_write_b32 a92, 0
 v_accvgpr_write_b32 a93, 0
 v_accvgpr_write_b32 a94, 0
 v_accvgpr_write_b32 a95, 0
 v_accvgpr_write_b32 a96, 0
 v_accvgpr_write_b32 a97, 0
 v_accvgpr_write_b32 a98, 0
 v_accvgpr_write_b32 a99, 0
 v_accvgpr_write_b32 a100, 0
 v_accvgpr_write_b32 a101, 0
 v_accvgpr_write_b32 a102, 0
 v_accvgpr_write_b32 a103, 0
 v_accvgpr_write_b32 a104, 0
 v_accvgpr_write_b32 a105, 0
 v_accvgpr_write_b32 a106, 0
 v_accvgpr_write_b32 a107, 0
 v_accvgpr_write_b32 a108, 0
 v_accvgpr_write_b32 a109, 0
 v_accvgpr_write_b32 a110, 0
 v_accvgpr_write_b32 a111, 0
 v_accvgpr_write_b32 a112, 0
 v_accvgpr_write_b32 a113, 0
 v_accvgpr_write_b32 a114, 0
 v_accvgpr_write_b32 a115, 0
 v_accvgpr_write_b32 a116, 0
 v_accvgpr_write_b32 a117, 0
 v_accvgpr_write_b32 a118, 0
 v_accvgpr_write_b32 a119, 0
 v_accvgpr_write_b32 a120, 0
 v_accvgpr_write_b32 a121, 0
 v_accvgpr_write_b32 a122, 0
 v_accvgpr_write_b32 a123, 0
 v_accvgpr_write_b32 a124, 0
 v_accvgpr_write_b32 a125, 0
 v_accvgpr_write_b32 a126, 0
 v_accvgpr_write_b32 a127, 0
 s_or_b32 s3, s101, s95
 s_cbranch_scc1 L_g1_nopub
 s_waitcnt vmcnt(12)
 v_add_u32 v26, 1, v26
 v_max_u32 v26, 1, v26
 s_mov_b64 exec, 1
 buffer_store_dword v26, v27, s[16:19], 0 offen sc1
 s_mov_b64 exec, -1
L_g1_nopub:
 v_lshlrev_b32 v70, 4, v65
 v_lshl_add_u32 v70, v66, 8, v70
 v_lshl_add_u32 v70, v67, 10, v70
 v_lshl_add_u32 v70, v15, 13, v70
 s_lshr_b32 s14, s101, 1
 s_lshl_b32 s14, s14, 15
 s_and_b32 s15, s101, 1
 s_lshl_b32 s15, s15, 7
 s_add_u32 s14, s14, s15
 v_lshlrev_b32 v71, 4, v65
 v_add_u32 v71, 122880, v71
 v_lshl_add_u32 v72, v15, 2, v71
 s_mov_b32 s3, 0xffff0000
 s_waitcnt vmcnt(11)
 v_lshlrev_b32 v96, 16, v80
 v_and_b32 v97, s3, v80
 v_lshlrev_b32 v98, 16, v81
 v_and_b32 v99, s3, v81
 v_lshlrev_b32 v100, 16, v82
 v_and_b32 v101, s3, v82
 v_lshlrev_b32 v102, 16, v83
 v_and_b32 v103, s3, v83
 s_waitcnt vmcnt(10)
 v_lshlrev_b32 v104, 16, v84
 v_and_b32 v105, s3, v84
 v_lshlrev_b32 v106, 16, v85
 v_and_b32 v107, s3, v85
 v_lshlrev_b32 v108, 16, v86
 v_and_b32 v109, s3, v86
 v_lshlrev_b32 v110, 16, v87
 v_and_b32 v111, s3, v87
 s_waitcnt vmcnt(9)
 v_lshlrev_b32 v112, 16, v88
 v_and_b32 v113, s3, v88
 v_lshlrev_b32 v114, 16, v89
 v_and_b32 v115, s3, v89
 v_lshlrev_b32 v116, 16, v90
 v_and_b32 v117, s3, v90
 v_lshlrev_b32 v118, 16, v91
 v_and_b32 v119, s3, v91
 s_waitcnt vmcnt(8)
 v_lshlrev_b32 v120, 16, v92
 v_and_b32 v121, s3, v92
 v_lshlrev_b32 v122, 16, v93
 v_and_b32 v123, s3, v93
 v_lshlrev_b32 v124, 16, v94
 v_and_b32 v125, s3, v94
 v_lshlrev_b32 v126, 16, v95
 v_and_b32 v127, s3, v95
 v_add_f32 v74, v96, v100
 v_add_f32 v75, v97, v101
 v_add_f32 v76, v98, v102
 v_add_f32 v77, v99, v103
 v_add_f32 v74, v74, v104
 v_add_f32 v75, v75, v105
 v_add_f32 v76, v76, v106
 v_add_f32 v77, v77, v107
 v_add_f32 v74, v74, v108
 v_add_f32 v75, v75, v109
 v_add_f32 v76, v76, v110
 v_add_f32 v77, v77, v111
 v_add_f32 v74, v74, v112
 v_add_f32 v75, v75, v113
 v_add_f32 v76, v76, v114
 v_add_f32 v77, v77, v115
 v_add_f32 v74, v74, v116
 v_add_f32 v75, v75, v117
 v_add_f32 v76, v76, v118
 v_add_f32 v77, v77, v119
 v_add_f32 v74, v74, v120
 v_add_f32 v75, v75, v121
 v_add_f32 v76, v76, v122
 v_add_f32 v77, v77, v123
 v_add_f32 v74, v74, v124
 v_add_f32 v75, v75, v125
 v_add_f32 v76, v76, v126
 v_add_f32 v77, v77, v127
 v_add_f32 v74, v74, v75
 v_add_f32 v76, v76, v77
 v_add_f32 v74, v74, v76
 s_nop 1
 v_add_f32_dpp v74, v74, v74 row_ror:8 row_mask:0xf bank_mask:0xf
 v_mov_b32 v75, v74
 s_nop 1
 v_permlane16_swap_b32 v75, v74
 s_nop 1
 v_add_f32 v74, v74, v75
 v_mov_b32 v75, v74
 s_nop 1
 v_permlane32_swap_b32 v75, v74
 s_nop 1
 v_add_f32 v74, v74, v75
 v_mul_f32 v73, 0x3b800000, v74
 v_sub_f32 v96, v96, v73
 v_sub_f32 v97, v97, v73
 v_sub_f32 v98, v98, v73
 v_sub_f32 v99, v99, v73
 v_sub_f32 v100, v100, v73
 v_sub_f32 v101, v101, v73
 v_sub_f32 v102, v102, v73
 v_sub_f32 v103, v103, v73
 v_sub_f32 v104, v104, v73
 v_sub_f32 v105, v105, v73
 v_sub_f32 v106, v106, v73
 v_sub_f32 v107, v107, v73
 v_sub_f32 v108, v108, v73
 v_sub_f32 v109, v109, v73
 v_sub_f32 v110, v110, v73
 v_sub_f32 v111, v111, v73
 v_sub_f32 v112, v112, v73
 v_sub_f32 v113, v113, v73
 v_sub_f32 v114, v114, v73
 v_sub_f32 v115, v115, v73
 v_sub_f32 v116, v116, v73
 v_sub_f32 v117, v117, v73
 v_sub_f32 v118, v118, v73
 v_sub_f32 v119, v119, v73
 v_sub_f32 v120, v120, v73
 v_sub_f32 v121, v121, v73
 v_sub_f32 v122, v122, v73
 v_sub_f32 v123, v123, v73
 v_sub_f32 v124, v124, v73
 v_sub_f32 v125, v125, v73
 v_sub_f32 v126, v126, v73
 v_sub_f32 v127, v127, v73
 v_mul_f32 v74, v96, v96
 v_mul_f32 v75, v97, v97
 v_mul_f32 v76, v98, v98
 v_mul_f32 v77, v99, v99
 v_fmac_f32 v74, v100, v100
 v_fmac_f32 v75, v101, v101
 v_fmac_f32 v76, v102, v102
 v_fmac_f32 v77, v103, v103
 v_fmac_f32 v74, v104, v104
 v_fmac_f32 v75, v105, v105
 v_fmac_f32 v76, v106, v106
 v_fmac_f32 v77, v107, v107
 v_fmac_f32 v74, v108, v108
 v_fmac_f32 v75, v109, v109
 v_fmac_f32 v76, v110, v110
 v_fmac_f32 v77, v111, v111
 v_fmac_f32 v74, v112, v112
 v_fmac_f32 v75, v113, v113
 v_fmac_f32 v76, v114, v114
 v_fmac_f32 v77, v115, v115
 v_fmac_f32 v74, v116, v116
 v_fmac_f32 v75, v117, v117
 v_fmac_f32 v76, v118, v118
 v_fmac_f32 v77, v119, v119
 v_fmac_f32 v74, v120, v120
 v_fmac_f32 v75, v121, v121
 v_fmac_f32 v76, v122, v122
 v_fmac_f32 v77, v123, v123
 v_fmac_f32 v74, v124, v124
 v_fmac_f32 v75, v125, v125
 v_fmac_f32 v76, v126, v126
 v_fmac_f32 v77, v127, v127
 ds_write_b32 v72, v73
 v_add_f32 v74, v74, v75
 v_add_f32 v76, v76, v77
 v_add_f32 v74, v74, v76
 s_nop 1
 v_add_f32_dpp v74, v74, v74 row_ror:8 row_mask:0xf bank_mask:0xf
 v_mov_b32 v75, v74
 s_nop 1
 v_permlane16_swap_b32 v75, v74
 s_nop 1
 v_add_f32 v74, v74, v75
 v_mov_b32 v75, v74
 s_nop 1
 v_permlane32_swap_b32 v75, v74
 s_nop 1
 v_add_f32 v74, v74, v75
 ds_write_b32 v72, v74 offset:128
 s_waitcnt lgkmcnt(0)
 s_barrier
 ds_read_b128 v[76:79], v71
 ds_read_b128 v[80:83], v71 offset:128
 s_waitcnt lgkmcnt(0)
 v_add_f32 v74, v76, v77
 v_add_f32 v75, v78, v79
 v_add_f32 v80, v80, v81
 v_add_f32 v82, v82, v83
 v_add_f32 v74, v74, v75
 v_add_f32 v80, v80, v82
 v_mul_f32 v74, 0.25, v74
 v_sub_f32 v76, v76, v74
 v_sub_f32 v77, v77, v74
 v_sub_f32 v78, v78, v74
 v_sub_f32 v79, v79, v74
 v_mul_f32 v75, v76, v76
 v_fmac_f32 v75, v77, v77
 v_fmac_f32 v75, v78, v78
 v_fmac_f32 v75, v79, v79
 v_fmac_f32 v80, 0x43800000, v75
 v_mov_b32 v77, 0x3727c5ac
 v_fmac_f32 v77, 0x3a800000, v80
 v_rsq_f32 v77, v77
 v_sub_f32 v73, v73, v74
 v_mul_f32 v77, 0x3fb8aa3b, v77
 v_mul_f32 v73, v73, v77
 v_fma_f32 v96, v96, v77, v73
 v_fma_f32 v97, v97, v77, v73
 v_fma_f32 v98, v98, v77, v73
 v_fma_f32 v99, v99, v77, v73
 v_fma_f32 v100, v100, v77, v73
 v_fma_f32 v101, v101, v77, v73
 v_fma_f32 v102, v102, v77, v73
 v_fma_f32 v103, v103, v77, v73
 v_cvt_pk_bf16_f32 v80, v96, v97
 v_cvt_pk_bf16_f32 v81, v98, v99
 v_cvt_pk_bf16_f32 v82, v100, v101
 v_cvt_pk_bf16_f32 v83, v102, v103
 s_add_u32 s15, s14, 0
 buffer_store_dwordx4 v[80:83], v70, s[84:87], s15 offen sc1
 v_fma_f32 v104, v104, v77, v73
 v_fma_f32 v105, v105, v77, v73
 v_fma_f32 v106, v106, v77, v73
 v_fma_f32 v107, v107, v77, v73
 v_fma_f32 v108, v108, v77, v73
 v_fma_f32 v109, v109, v77, v73
 v_fma_f32 v110, v110, v77, v73
 v_fma_f32 v111, v111, v77, v73
 v_cvt_pk_bf16_f32 v84, v104, v105
 v_cvt_pk_bf16_f32 v85, v106, v107
 v_cvt_pk_bf16_f32 v86, v108, v109
 v_cvt_pk_bf16_f32 v87, v110, v111
 s_add_u32 s15, s14, 2048
 buffer_store_dwordx4 v[84:87], v70, s[84:87], s15 offen sc1
 v_fma_f32 v112, v112, v77, v73
 v_fma_f32 v113, v113, v77, v73
 v_fma_f32 v114, v114, v77, v73
 v_fma_f32 v115, v115, v77, v73
 v_fma_f32 v116, v116, v77, v73
 v_fma_f32 v117, v117, v77, v73
 v_fma_f32 v118, v118, v77, v73
 v_fma_f32 v119, v119, v77, v73
 v_cvt_pk_bf16_f32 v88, v112, v113
 v_cvt_pk_bf16_f32 v89, v114, v115
 v_cvt_pk_bf16_f32 v90, v116, v117
 v_cvt_pk_bf16_f32 v91, v118, v119
 s_add_u32 s15, s14, 4096
 buffer_store_dwordx4 v[88:91], v70, s[84:87], s15 offen sc1
 v_fma_f32 v120, v120, v77, v73
 v_fma_f32 v121, v121, v77, v73
 v_fma_f32 v122, v122, v77, v73
 v_fma_f32 v123, v123, v77, v73
 v_fma_f32 v124, v124, v77, v73
 v_fma_f32 v125, v125, v77, v73
 v_fma_f32 v126, v126, v77, v73
 v_fma_f32 v127, v127, v77, v73
 v_cvt_pk_bf16_f32 v92, v120, v121
 v_cvt_pk_bf16_f32 v93, v122, v123
 v_cvt_pk_bf16_f32 v94, v124, v125
 v_cvt_pk_bf16_f32 v95, v126, v127
 s_add_u32 s15, s14, 6144
 buffer_store_dwordx4 v[92:95], v70, s[84:87], s15 offen sc1
 buffer_load_dword v26, v27, s[16:19], 0 offen sc1
 s_lshl_b32 s14, s101, 7
 s_add_u32 s14, s14, 42008576
 s_waitcnt vmcnt(0)
 s_barrier
 s_cmp_lg_u32 s95, 0
 s_cbranch_scc1 L_g1_nosig
L_g1_tag:
 v_readfirstlane_b32 s101, v26
 s_nop 3
 s_cmp_lg_u32 s101, 0
 s_cbranch_scc1 L_g1_tagok
 buffer_load_dword v26, v27, s[16:19], 0 offen sc1
 s_waitcnt vmcnt(0)
 s_branch L_g1_tag
L_g1_tagok:
 s_mov_b64 exec, 1
 buffer_store_dword v26, v27, s[84:87], s14 offen sc1
 s_lshl_b32 s15, s2, 7
 s_add_u32 s15, s15, 41943040
 buffer_store_dword v27, v27, s[84:87], s15 offen sc1
 s_mov_b64 exec, -1
L_g1_nosig:
 s_add_u32 m0, s94, 24576
 s_nop 0
 buffer_load_dwordx4 v3, s[64:67], s89 offen lds
 s_add_u32 m0, s94, 20480
 s_nop 0
 buffer_load_dwordx4 v3, s[60:63], s89 offen lds
 s_add_u32 m0, s94, 28672
 s_nop 0
 buffer_load_dwordx4 v3, s[68:71], s89 offen lds
 s_add_u32 m0, s94, 32768
 s_nop 0
 buffer_load_dwordx4 v3, s[72:75], s89 offen lds
 s_add_u32 m0, s94, 36864
 s_nop 0
 buffer_load_dwordx4 v3, s[76:79], s89 offen lds
 s_add_u32 s9, s9, 1
 s_nop 0
 s_cmp_lt_u32 s9, 4
 s_cselect_b32 s3, 1, 3
 s_add_u32 s100, s9, s11
 s_and_b32 s100, s100, s3
 s_andn2_b32 s3, s9, s3
 s_or_b32 s100, s100, s3
 s_mul_i32 s88, s100, s90
 s_mul_i32 s89, s100, s91
 s_add_u32 s94, s94, 40960
 s_cmp_ge_u32 s94, s99
 s_cselect_b32 s3, 163840, 0
 s_sub_u32 s94, s94, s3
 v_mov_b32 v64, 0
 v_mov_b32 v65, 0
 v_mov_b32 v66, 0
 v_mov_b32 v67, 0
 v_mov_b32 v68, 0
 v_mov_b32 v69, 0
 v_mov_b32 v70, 0
 v_mov_b32 v71, 0
 v_mov_b32 v72, 0
 v_mov_b32 v73, 0
 v_mov_b32 v74, 0
 v_mov_b32 v75, 0
 v_mov_b32 v76, 0
 v_mov_b32 v77, 0
 v_mov_b32 v78, 0
 v_mov_b32 v79, 0
 v_mov_b32 v80, 0
 v_mov_b32 v81, 0
 v_mov_b32 v82, 0
 v_mov_b32 v83, 0
 v_mov_b32 v84, 0
 v_mov_b32 v85, 0
 v_mov_b32 v86, 0
 v_mov_b32 v87, 0
 v_mov_b32 v88, 0
 v_mov_b32 v89, 0
 v_mov_b32 v90, 0
 v_mov_b32 v91, 0
 v_mov_b32 v92, 0
 v_mov_b32 v93, 0
 v_mov_b32 v94, 0
 v_mov_b32 v95, 0
 v_mov_b32 v96, 0
 v_mov_b32 v97, 0
 v_mov_b32 v98, 0
 v_mov_b32 v99, 0
 v_mov_b32 v100, 0
 v_mov_b32 v101, 0
 v_mov_b32 v102, 0
 v_mov_b32 v103, 0
 v_mov_b32 v104, 0
 v_mov_b32 v105, 0
 v_mov_b32 v106, 0
 v_mov_b32 v107, 0
 v_mov_b32 v108, 0
 v_mov_b32 v109, 0
 v_mov_b32 v110, 0
 v_mov_b32 v111, 0
 v_mov_b32 v112, 0
 v_mov_b32 v113, 0
 v_mov_b32 v114, 0
 v_mov_b32 v115, 0
 v_mov_b32 v116, 0
 v_mov_b32 v117, 0
 v_mov_b32 v118, 0
 v_mov_b32 v119, 0
 v_mov_b32 v120, 0
 v_mov_b32 v121, 0
 v_mov_b32 v122, 0
 v_mov_b32 v123, 0
 v_mov_b32 v124, 0
 v_mov_b32 v125, 0
 v_mov_b32 v126, 0
 v_mov_b32 v127, 0
 v_mov_b32 v128, 0
 v_mov_b32 v129, 0
 v_mov_b32 v130, 0
 v_mov_b32 v131, 0
 v_mov_b32 v132, 0
 v_mov_b32 v133, 0
 v_mov_b32 v134, 0
 v_mov_b32 v135, 0
 v_mov_b32 v136, 0
 v_mov_b32 v137, 0
 v_mov_b32 v138, 0
 v_mov_b32 v139, 0
 v_mov_b32 v140, 0
 v_mov_b32 v141, 0
 v_mov_b32 v142, 0
 v_mov_b32 v143, 0
 v_mov_b32 v144, 0
 v_mov_b32 v145, 0
 v_mov_b32 v146, 0
 v_mov_b32 v147, 0
 v_mov_b32 v148, 0
 v_mov_b32 v149, 0
 v_mov_b32 v150, 0
 v_mov_b32 v151, 0
 v_mov_b32 v152, 0
 v_mov_b32 v153, 0
 v_mov_b32 v154, 0
 v_mov_b32 v155, 0
 v_mov_b32 v156, 0
 v_mov_b32 v157, 0
 v_mov_b32 v158, 0
 v_mov_b32 v159, 0
 v_mov_b32 v160, 0
 v_mov_b32 v161, 0
 v_mov_b32 v162, 0
 v_mov_b32 v163, 0
 v_mov_b32 v164, 0
 v_mov_b32 v165, 0
 v_mov_b32 v166, 0
 v_mov_b32 v167, 0
 v_mov_b32 v168, 0
 v_mov_b32 v169, 0
 v_mov_b32 v170, 0
 v_mov_b32 v171, 0
 v_mov_b32 v172, 0
 v_mov_b32 v173, 0
 v_mov_b32 v174, 0
 v_mov_b32 v175, 0
 v_mov_b32 v176, 0
 v_mov_b32 v177, 0
 v_mov_b32 v178, 0
 v_mov_b32 v179, 0
 v_mov_b32 v180, 0
 v_mov_b32 v181, 0
 v_mov_b32 v182, 0
 v_mov_b32 v183, 0
 v_mov_b32 v184, 0
 v_mov_b32 v185, 0
 v_mov_b32 v186, 0
 v_mov_b32 v187, 0
 v_mov_b32 v188, 0
 v_mov_b32 v189, 0
 v_mov_b32 v190, 0
 v_mov_b32 v191, 0
 v_mov_b32 v192, 0
 v_mov_b32 v193, 0
 v_mov_b32 v194, 0
 v_mov_b32 v195, 0
 v_mov_b32 v196, 0
 v_mov_b32 v197, 0
 v_mov_b32 v198, 0
 v_mov_b32 v199, 0
 v_mov_b32 v200, 0
 v_mov_b32 v201, 0
 v_mov_b32 v202, 0
 v_mov_b32 v203, 0
 v_mov_b32 v204, 0
 v_mov_b32 v205, 0
 v_mov_b32 v206, 0
 v_mov_b32 v207, 0
 v_mov_b32 v208, 0
 v_mov_b32 v209, 0
 v_mov_b32 v210, 0
 v_mov_b32 v211, 0
 v_mov_b32 v212, 0
 v_mov_b32 v213, 0
 v_mov_b32 v214, 0
 v_mov_b32 v215, 0
 v_mov_b32 v216, 0
 v_mov_b32 v217, 0
 v_mov_b32 v218, 0
 v_mov_b32 v219, 0
 v_mov_b32 v220, 0
 v_mov_b32 v221, 0
 v_mov_b32 v222, 0
 v_mov_b32 v223, 0
 v_mov_b32 v224, 0
 v_mov_b32 v225, 0
 v_mov_b32 v226, 0
 v_mov_b32 v227, 0
 v_mov_b32 v228, 0
 v_mov_b32 v229, 0
 v_mov_b32 v230, 0
 v_mov_b32 v231, 0
 v_mov_b32 v232, 0
 v_mov_b32 v233, 0
 v_mov_b32 v234, 0
 v_mov_b32 v235, 0
 v_mov_b32 v236, 0
 v_mov_b32 v237, 0
 v_mov_b32 v238, 0
 v_mov_b32 v239, 0
 v_mov_b32 v240, 0
 v_mov_b32 v241, 0
 v_mov_b32 v242, 0
 v_mov_b32 v243, 0
 v_mov_b32 v244, 0
 v_mov_b32 v245, 0
 v_mov_b32 v246, 0
 v_mov_b32 v247, 0
 v_mov_b32 v248, 0
 v_mov_b32 v249, 0
 v_mov_b32 v250, 0
 v_mov_b32 v251, 0
 v_mov_b32 v252, 0
 v_mov_b32 v253, 0
 v_mov_b32 v254, 0
 v_mov_b32 v255, 0
 s_cmp_lg_u32 s95, 0
 s_cbranch_scc1 L_g1_rdy
 s_lshl_b32 s14, s98, 12
 s_add_u32 s14, s14, 42008576
 v_and_b32 v27, 31, v1
 v_lshlrev_b32 v27, 7, v27
 buffer_load_dword v26, v27, s[84:87], s14 offen sc1
 s_sleep 6
L_g1_poll:
 buffer_load_dword v28, v27, s[84:87], s14 offen sc1
 s_waitcnt vmcnt(1)
 v_cmp_ne_u32 vcc, s101, v26
 s_nop 3
 s_cmp_eq_u64 vcc, 0
 s_cbranch_scc1 L_g1_rdy
 buffer_load_dword v26, v27, s[84:87], s14 offen sc1
 s_waitcnt vmcnt(1)
 v_cmp_ne_u32 vcc, s101, v28
 s_nop 3
 s_cmp_eq_u64 vcc, 0
 s_cbranch_scc1 L_g1_rdy
 s_branch L_g1_poll
L_g1_rdy:
 s_barrier
 buffer_load_dwordx4 a[128:131], v8, s[84:87], s92 offen offset:0 sc1
 buffer_load_dwordx4 a[132:135], v8, s[84:87], s92 offen offset:1024 sc1
 buffer_load_dwordx4 a[136:139], v9, s[84:87], s92 offen offset:0 sc1
 buffer_load_dwordx4 a[140:143], v9, s[84:87], s92 offen offset:1024 sc1
 buffer_load_dwordx4 a[144:147], v10, s[84:87], s92 offen offset:0 sc1
 buffer_load_dwordx4 a[148:151], v10, s[84:87], s92 offen offset:1024 sc1
 buffer_load_dwordx4 a[152:155], v11, s[84:87], s92 offen offset:0 sc1
 buffer_load_dwordx4 a[156:159], v11, s[84:87], s92 offen offset:1024 sc1
 s_mov_b32 s80, s4
 s_mov_b32 s81, s5
 s_mov_b32 s82, 0x700000
 s_mov_b32 s83, 0x20000
 s_lshl_b32 s15, s2, 2
 s_add_u32 s15, s15, s95
 s_mul_i32 s14, s15, 7168
 s_lshl_b32 s15, s15, 11
 v_lshlrev_b32 v15, 4, v1
 s_mov_b32 s6, 0x40053526
 s_add_u32 m0, s94, 0
 s_nop 0
 buffer_load_dwordx4 v2, s[40:43], s88 offen lds
 s_add_u32 m0, s94, 8192
 s_nop 0
 buffer_load_dwordx4 v2, s[48:51], s88 offen lds
 s_add_u32 m0, s94, 4096
 s_nop 0
 buffer_load_dwordx4 v2, s[44:47], s88 offen lds
 s_add_u32 m0, s94, 12288
 s_nop 0
 buffer_load_dwordx4 v2, s[52:55], s88 offen lds
 s_add_u32 m0, s94, 16384
 s_nop 0
 buffer_load_dwordx4 v3, s[56:59], s89 offen lds
 s_add_u32 m0, s94, 24576
 s_nop 0
 buffer_load_dwordx4 v3, s[64:67], s89 offen lds
 s_add_u32 m0, s94, 20480
 s_nop 0
 buffer_load_dwordx4 v3, s[60:63], s89 offen lds
 v_mov_b32 v6, v4
 v_mov_b32 v7, v5
 s_movk_i32 s96, 6
 s_waitcnt vmcnt(7)
 s_barrier
 ds_read_b64_tr_b16 v[16:17], v6 offset:0
 ds_read_b64_tr_b16 v[18:19], v6 offset:256
 ds_read_b64_tr_b16 v[20:21], v6 offset:2048
 ds_read_b64_tr_b16 v[22:23], v6 offset:2304
 ds_read_b64_tr_b16 v[24:25], v7 offset:0
 ds_read_b64_tr_b16 v[26:27], v7 offset:256
 ds_read_b64_tr_b16 v[28:29], v7 offset:2048
 ds_read_b64_tr_b16 v[30:31], v7 offset:2304
 ds_read_b64_tr_b16 v[32:33], v6 offset:4096
 ds_read_b64_tr_b16 v[34:35], v6 offset:4352
 ds_read_b64_tr_b16 v[36:37], v6 offset:6144
 ds_read_b64_tr_b16 v[38:39], v6 offset:6400
 s_add_u32 s10, s10, 1
 s_cmp_lt_u32 s10, 4
 s_cselect_b32 s3, 1, 3
 s_add_u32 s92, s10, s11
 s_and_b32 s92, s92, s3
 s_andn2_b32 s3, s10, s3
 s_or_b32 s92, s92, s3
 s_lshl_b32 s92, s92, 11
 s_cmp_ge_u32 s97, 29
 s_cbranch_scc1 L_g1_varC
 s_cmp_eq_u32 s97, 28
 s_cbranch_scc1 L_g1_varB
.p2align 6
 s_waitcnt lgkmcnt(8)
 v_mfma_f32_16x16x32_bf16 a[0:3], v[16:19], a[128:131], a[0:3]
 ds_read_b64_tr_b16 v[40:41], v7 offset:4096
 v_mfma_f32_16x16x32_bf16 a[0:3], v[20:23], a[132:135], a[0:3]
 s_add_u32 m0, s94, 28672
 v_mfma_f32_16x16x32_bf16 a[4:7], v[20:23], a[140:143], a[4:7]
 ds_read_b64_tr_b16 v[42:43], v7 offset:4352
 v_mfma_f32_16x16x32_bf16 a[4:7], v[16:19], a[136:139], a[4:7]
 buffer_load_dwordx4 v3, s[68:71], s89 offen lds
 v_mfma_f32_16x16x32_bf16 a[8:11], v[16:19], a[144:147], a[8:11]
 ds_read_b64_tr_b16 v[44:45], v7 offset:6144
 v_mfma_f32_16x16x32_bf16 a[8:11], v[20:23], a[148:151], a[8:11]
 s_add_u32 m0, s94, 32768
 v_mfma_f32_16x16x32_bf16 a[12:15], v[20:23], a[156:159], a[12:15]
 ds_read_b64_tr_b16 v[46:47], v7 offset:6400
 v_mfma_f32_16x16x32_bf16 a[12:15], v[16:19], a[152:155], a[12:15]
 s_waitcnt lgkmcnt(8)
 buffer_load_dwordx4 v3, s[72:75], s89 offen lds
 v_mfma_f32_16x16x32_bf16 a[16:19], v[24:27], a[128:131], a[16:19]
 ds_read_b64_tr_b16 v[16:17], v6 offset:8192
 v_mfma_f32_16x16x32_bf16 a[16:19], v[28:31], a[132:135], a[16:19]
 s_add_u32 m0, s94, 36864
 v_mfma_f32_16x16x32_bf16 a[20:23], v[28:31], a[140:143], a[20:23]
 ds_read_b64_tr_b16 v[18:19], v6 offset:8448
 v_mfma_f32_16x16x32_bf16 a[20:23], v[24:27], a[136:139], a[20:23]
 buffer_load_dwordx4 v3, s[76:79], s89 offen lds
 v_mfma_f32_16x16x32_bf16 a[24:27], v[24:27], a[144:147], a[24:27]
 ds_read_b64_tr_b16 v[20:21], v6 offset:10240
 v_mfma_f32_16x16x32_bf16 a[24:27], v[28:31], a[148:151], a[24:27]
 s_add_u32 s9, s9, 1
 s_cmp_lt_u32 s9, 4
 s_cselect_b32 s3, 1, 3
 s_add_u32 s100, s9, s11
 s_and_b32 s100, s100, s3
 s_andn2_b32 s3, s9, s3
 s_or_b32 s100, s100, s3
 s_mul_i32 s88, s100, s90
 s_mul_i32 s89, s100, s91
 s_add_u32 s94, s94, 40960
 s_cmp_ge_u32 s94, s99
 s_cselect_b32 s3, 163840, 0
 s_sub_u32 s94, s94, s3
 buffer_load_dwordx4 a[160:163], v8, s[84:87], s92 offen offset:0 sc1
 v_mfma_f32_16x16x32_bf16 a[28:31], v[28:31], a[156:159], a[28:31]
 ds_read_b64_tr_b16 v[22:23], v6 offset:10496
 v_mfma_f32_16x16x32_bf16 a[28:31], v[24:27], a[152:155], a[28:31]
 s_waitcnt lgkmcnt(8)
 v_mfma_f32_16x16x32_bf16 a[32:35], v[32:35], a[128:131], a[32:35]
 ds_read_b64_tr_b16 v[24:25], v7 offset:8192
 v_mfma_f32_16x16x32_bf16 a[32:35], v[36:39], a[132:135], a[32:35]
 buffer_load_dwordx4 a[164:167], v8, s[84:87], s92 offen offset:1024 sc1
 v_mfma_f32_16x16x32_bf16 a[36:39], v[36:39], a[140:143], a[36:39]
 ds_read_b64_tr_b16 v[26:27], v7 offset:8448
 v_mfma_f32_16x16x32_bf16 a[36:39], v[32:35], a[136:139], a[36:39]
 v_mfma_f32_16x16x32_bf16 a[40:43], v[32:35], a[144:147], a[40:43]
 ds_read_b64_tr_b16 v[28:29], v7 offset:10240
 v_mfma_f32_16x16x32_bf16 a[40:43], v[36:39], a[148:151], a[40:43]
 buffer_load_dwordx4 a[168:171], v9, s[84:87], s92 offen offset:0 sc1
 v_mfma_f32_16x16x32_bf16 a[44:47], v[36:39], a[156:159], a[44:47]
 ds_read_b64_tr_b16 v[30:31], v7 offset:10496
 v_mfma_f32_16x16x32_bf16 a[44:47], v[32:35], a[152:155], a[44:47]
 s_waitcnt lgkmcnt(8)
 v_mfma_f32_16x16x32_bf16 a[48:51], v[40:43], a[128:131], a[48:51]
 ds_read_b64_tr_b16 v[32:33], v6 offset:12288
 v_mfma_f32_16x16x32_bf16 a[48:51], v[44:47], a[132:135], a[48:51]
 buffer_load_dwordx4 a[172:175], v9, s[84:87], s92 offen offset:1024 sc1
 v_mfma_f32_16x16x32_bf16 a[52:55], v[44:47], a[140:143], a[52:55]
 ds_read_b64_tr_b16 v[34:35], v6 offset:12544
 v_mfma_f32_16x16x32_bf16 a[52:55], v[40:43], a[136:139], a[52:55]
 v_mfma_f32_16x16x32_bf16 a[56:59], v[40:43], a[144:147], a[56:59]
 ds_read_b64_tr_b16 v[36:37], v6 offset:14336
 v_mfma_f32_16x16x32_bf16 a[56:59], v[44:47], a[148:151], a[56:59]
 buffer_load_dwordx4 a[176:179], v10, s[84:87], s92 offen offset:0 sc1
 v_mfma_f32_16x16x32_bf16 a[60:63], v[44:47], a[156:159], a[60:63]
 ds_read_b64_tr_b16 v[38:39], v6 offset:14592
 v_mfma_f32_16x16x32_bf16 a[60:63], v[40:43], a[152:155], a[60:63]
 s_waitcnt lgkmcnt(8)
 v_mfma_f32_16x16x32_bf16 a[64:67], v[16:19], a[128:131], a[64:67]
 ds_read_b64_tr_b16 v[40:41], v7 offset:12288
 v_mfma_f32_16x16x32_bf16 a[64:67], v[20:23], a[132:135], a[64:67]
 buffer_load_dwordx4 a[180:183], v10, s[84:87], s92 offen offset:1024 sc1
 v_mfma_f32_16x16x32_bf16 a[68:71], v[20:23], a[140:143], a[68:71]
 ds_read_b64_tr_b16 v[42:43], v7 offset:12544
 v_mfma_f32_16x16x32_bf16 a[68:71], v[16:19], a[136:139], a[68:71]
 v_mfma_f32_16x16x32_bf16 a[72:75], v[16:19], a[144:147], a[72:75]
 ds_read_b64_tr_b16 v[44:45], v7 offset:14336
 v_mfma_f32_16x16x32_bf16 a[72:75], v[20:23], a[148:151], a[72:75]
 buffer_load_dwordx4 a[184:187], v11, s[84:87], s92 offen offset:0 sc1
 v_mfma_f32_16x16x32_bf16 a[76:79], v[20:23], a[156:159], a[76:79]
 ds_read_b64_tr_b16 v[46:47], v7 offset:14592
 v_mfma_f32_16x16x32_bf16 a[76:79], v[16:19], a[152:155], a[76:79]
 s_waitcnt lgkmcnt(8)
 v_mfma_f32_16x16x32_bf16 a[80:83], v[24:27], a[128:131], a[80:83]
 ds_read_b64_tr_b16 v[16:17], v6 offset:16384
 v_mfma_f32_16x16x32_bf16 a[80:83], v[28:31], a[132:135], a[80:83]
 buffer_load_dwordx4 a[188:191], v11, s[84:87], s92 offen offset:1024 sc1
 v_mfma_f32_16x16x32_bf16 a[84:87], v[28:31], a[140:143], a[84:87]
 ds_read_b64_tr_b16 v[18:19], v6 offset:16640
 s_add_u32 s10, s10, 1
 s_cmp_lt_u32 s10, 4
 s_cselect_b32 s3, 1, 3
 s_add_u32 s92, s10, s11
 s_and_b32 s92, s92, s3
 s_andn2_b32 s3, s10, s3
 s_or_b32 s92, s92, s3
 s_lshl_b32 s92, s92, 11
 v_mfma_f32_16x16x32_bf16 a[84:87], v[24:27], a[136:139], a[84:87]
 s_add_u32 m0, s94, 0
 v_mfma_f32_16x16x32_bf16 a[88:91], v[24:27], a[144:147], a[88:91]
 ds_read_b64_tr_b16 v[20:21], v6 offset:18432
 v_mfma_f32_16x16x32_bf16 a[88:91], v[28:31], a[148:151], a[88:91]
 buffer_load_dwordx4 v2, s[40:43], s88 offen lds
 v_mfma_f32_16x16x32_bf16 a[92:95], v[28:31], a[156:159], a[92:95]
 ds_read_b64_tr_b16 v[22:23], v6 offset:18688
 v_mfma_f32_16x16x32_bf16 a[92:95], v[24:27], a[152:155], a[92:95]
 s_waitcnt lgkmcnt(8)
 s_add_u32 m0, s94, 8192
 v_mfma_f32_16x16x32_bf16 a[96:99], v[32:35], a[128:131], a[96:99]
 ds_read_b64_tr_b16 v[24:25], v7 offset:16384
 v_mfma_f32_16x16x32_bf16 a[96:99], v[36:39], a[132:135], a[96:99]
 buffer_load_dwordx4 v2, s[48:51], s88 offen lds
 v_mfma_f32_16x16x32_bf16 a[100:103], v[36:39], a[140:143], a[100:103]
 ds_read_b64_tr_b16 v[26:27], v7 offset:16640
 v_mfma_f32_16x16x32_bf16 a[100:103], v[32:35], a[136:139], a[100:103]
 s_add_u32 m0, s94, 4096
 v_mfma_f32_16x16x32_bf16 a[104:107], v[32:35], a[144:147], a[104:107]
 ds_read_b64_tr_b16 v[28:29], v7 offset:18432
 v_mfma_f32_16x16x32_bf16 a[104:107], v[36:39], a[148:151], a[104:107]
 buffer_load_dwordx4 v2, s[44:47], s88 offen lds
 v_mfma_f32_16x16x32_bf16 a[108:111], v[36:39], a[156:159], a[108:111]
 ds_read_b64_tr_b16 v[30:31], v7 offset:18688
 v_mfma_f32_16x16x32_bf16 a[108:111], v[32:35], a[152:155], a[108:111]
 s_waitcnt lgkmcnt(8)
 s_add_u32 m0, s94, 12288
 v_mfma_f32_16x16x32_bf16 a[112:115], v[40:43], a[128:131], a[112:115]
 ds_read_b64_tr_b16 v[32:33], v6 offset:20480
 v_mfma_f32_16x16x32_bf16 a[112:115], v[44:47], a[132:135], a[112:115]
 buffer_load_dwordx4 v2, s[52:55], s88 offen lds
 v_mfma_f32_16x16x32_bf16 a[116:119], v[44:47], a[140:143], a[116:119]
 ds_read_b64_tr_b16 v[34:35], v6 offset:20736
 v_mfma_f32_16x16x32_bf16 a[116:119], v[40:43], a[136:139], a[116:119]
 s_add_u32 m0, s94, 16384
 v_mfma_f32_16x16x32_bf16 a[120:123], v[40:43], a[144:147], a[120:123]
 ds_read_b64_tr_b16 v[36:37], v6 offset:22528
 v_mfma_f32_16x16x32_bf16 a[120:123], v[44:47], a[148:151], a[120:123]
 buffer_load_dwordx4 v3, s[56:59], s89 offen lds
 v_mfma_f32_16x16x32_bf16 a[124:127], v[44:47], a[156:159], a[124:127]
 ds_read_b64_tr_b16 v[38:39], v6 offset:22784
 v_mfma_f32_16x16x32_bf16 a[124:127], v[40:43], a[152:155], a[124:127]
 s_waitcnt lgkmcnt(8)
 s_add_u32 m0, s94, 24576
 v_mfma_f32_16x16x32_bf16 v[64:67], v[16:19], a[128:131], v[64:67]
 ds_read_b64_tr_b16 v[40:41], v7 offset:20480
 v_mfma_f32_16x16x32_bf16 v[64:67], v[20:23], a[132:135], v[64:67]
 buffer_load_dwordx4 v3, s[64:67], s89 offen lds
 v_mfma_f32_16x16x32_bf16 v[68:71], v[20:23], a[140:143], v[68:71]
 ds_read_b64_tr_b16 v[42:43], v7 offset:20736
 v_mfma_f32_16x16x32_bf16 v[68:71], v[16:19], a[136:139], v[68:71]
 s_add_u32 m0, s94, 20480
 v_mfma_f32_16x16x32_bf16 v[72:75], v[16:19], a[144:147], v[72:75]
 ds_read_b64_tr_b16 v[44:45], v7 offset:22528
 v_mfma_f32_16x16x32_bf16 v[72:75], v[20:23], a[148:151], v[72:75]
 buffer_load_dwordx4 v3, s[60:63], s89 offen lds
 v_mfma_f32_16x16x32_bf16 v[76:79], v[20:23], a[156:159], v[76:79]
 ds_read_b64_tr_b16 v[46:47], v7 offset:22784
 v_mfma_f32_16x16x32_bf16 v[76:79], v[16:19], a[152:155], v[76:79]
 s_waitcnt lgkmcnt(8)
 s_add_u32 m0, s94, 28672
 v_mfma_f32_16x16x32_bf16 v[80:83], v[24:27], a[128:131], v[80:83]
 ds_read_b64_tr_b16 v[16:17], v6 offset:24576
 v_mfma_f32_16x16x32_bf16 v[80:83], v[28:31], a[132:135], v[80:83]
 buffer_load_dwordx4 v3, s[68:71], s89 offen lds
 v_mfma_f32_16x16x32_bf16 v[84:87], v[28:31], a[140:143], v[84:87]
 ds_read_b64_tr_b16 v[18:19], v6 offset:24832
 v_mfma_f32_16x16x32_bf16 v[84:87], v[24:27], a[136:139], v[84:87]
 s_add_u32 m0, s94, 32768
 v_mfma_f32_16x16x32_bf16 v[88:91], v[24:27], a[144:147], v[88:91]
 ds_read_b64_tr_b16 v[20:21], v6 offset:26624
 v_mfma_f32_16x16x32_bf16 v[88:91], v[28:31], a[148:151], v[88:91]
 buffer_load_dwordx4 v3, s[72:75], s89 offen lds
 v_mfma_f32_16x16x32_bf16 v[92:95], v[28:31], a[156:159], v[92:95]
 ds_read_b64_tr_b16 v[22:23], v6 offset:26880
 v_mfma_f32_16x16x32_bf16 v[92:95], v[24:27], a[152:155], v[92:95]
 s_waitcnt lgkmcnt(8)
 s_add_u32 m0, s94, 36864
 v_mfma_f32_16x16x32_bf16 v[96:99], v[32:35], a[128:131], v[96:99]
 ds_read_b64_tr_b16 v[24:25], v7 offset:24576
 v_mfma_f32_16x16x32_bf16 v[96:99], v[36:39], a[132:135], v[96:99]
 buffer_load_dwordx4 v3, s[76:79], s89 offen lds
 v_mfma_f32_16x16x32_bf16 v[100:103], v[36:39], a[140:143], v[100:103]
 ds_read_b64_tr_b16 v[26:27], v7 offset:24832
 v_mfma_f32_16x16x32_bf16 v[100:103], v[32:35], a[136:139], v[100:103]
 s_add_u32 s9, s9, 1
 s_cmp_lt_u32 s9, 4
 s_cselect_b32 s3, 1, 3
 s_add_u32 s100, s9, s11
 s_and_b32 s100, s100, s3
 s_andn2_b32 s3, s9, s3
 s_or_b32 s100, s100, s3
 s_mul_i32 s88, s100, s90
 s_mul_i32 s89, s100, s91
 s_add_u32 s94, s94, 40960
 s_cmp_ge_u32 s94, s99
 s_cselect_b32 s3, 163840, 0
 s_sub_u32 s94, s94, s3
 v_mfma_f32_16x16x32_bf16 v[104:107], v[32:35], a[144:147], v[104:107]
 ds_read_b64_tr_b16 v[28:29], v7 offset:26624
 v_mfma_f32_16x16x32_bf16 v[104:107], v[36:39], a[148:151], v[104:107]
 s_add_u32 m0, s94, 0
 v_mfma_f32_16x16x32_bf16 v[108:111], v[36:39], a[156:159], v[108:111]
 ds_read_b64_tr_b16 v[30:31], v7 offset:26880
 v_mfma_f32_16x16x32_bf16 v[108:111], v[32:35], a[152:155], v[108:111]
 s_waitcnt lgkmcnt(8)
 buffer_load_dwordx4 v2, s[40:43], s88 offen lds
 v_mfma_f32_16x16x32_bf16 v[112:115], v[40:43], a[128:131], v[112:115]
 ds_read_b64_tr_b16 v[32:33], v6 offset:28672
 v_mfma_f32_16x16x32_bf16 v[112:115], v[44:47], a[132:135], v[112:115]
 v_mfma_f32_16x16x32_bf16 v[116:119], v[44:47], a[140:143], v[116:119]
 ds_read_b64_tr_b16 v[34:35], v6 offset:28928
 s_add_u32 m0, s94, 8192
 v_mfma_f32_16x16x32_bf16 v[116:119], v[40:43], a[136:139], v[116:119]
 v_mfma_f32_16x16x32_bf16 v[120:123], v[40:43], a[144:147], v[120:123]
 ds_read_b64_tr_b16 v[36:37], v6 offset:30720
 buffer_load_dwordx4 v2, s[48:51], s88 offen lds
 v_mfma_f32_16x16x32_bf16 v[120:123], v[44:47], a[148:151], v[120:123]
 v_mfma_f32_16x16x32_bf16 v[124:127], v[44:47], a[156:159], v[124:127]
 ds_read_b64_tr_b16 v[38:39], v6 offset:30976
 v_mfma_f32_16x16x32_bf16 v[124:127], v[40:43], a[152:155], v[124:127]
 s_waitcnt lgkmcnt(8)
 s_add_u32 m0, s94, 4096
 v_mfma_f32_16x16x32_bf16 v[128:131], v[16:19], a[128:131], v[128:131]
 ds_read_b64_tr_b16 v[40:41], v7 offset:28672
 v_mfma_f32_16x16x32_bf16 v[128:131], v[20:23], a[132:135], v[128:131]
 buffer_load_dwordx4 v2, s[44:47], s88 offen lds
 v_mfma_f32_16x16x32_bf16 v[132:135], v[20:23], a[140:143], v[132:135]
 ds_read_b64_tr_b16 v[42:43], v7 offset:28928
 v_mfma_f32_16x16x32_bf16 v[132:135], v[16:19], a[136:139], v[132:135]
 v_mfma_f32_16x16x32_bf16 v[136:139], v[16:19], a[144:147], v[136:139]
 ds_read_b64_tr_b16 v[44:45], v7 offset:30720
 s_add_u32 m0, s94, 12288
 v_mfma_f32_16x16x32_bf16 v[136:139], v[20:23], a[148:151], v[136:139]
 v_mfma_f32_16x16x32_bf16 v[140:143], v[20:23], a[156:159], v[140:143]
 ds_read_b64_tr_b16 v[46:47], v7 offset:30976
 buffer_load_dwordx4 v2, s[52:55], s88 offen lds
 v_mfma_f32_16x16x32_bf16 v[140:143], v[16:19], a[152:155], v[140:143]
 s_waitcnt lgkmcnt(8)
 v_mfma_f32_16x16x32_bf16 v[144:147], v[24:27], a[128:131], v[144:147]
 ds_read_b64_tr_b16 v[16:17], v6 offset:32768
 v_mfma_f32_16x16x32_bf16 v[144:147], v[28:31], a[132:135], v[144:147]
 s_add_u32 m0, s94, 16384
 v_mfma_f32_16x16x32_bf16 v[148:151], v[28:31], a[140:143], v[148:151]
 ds_read_b64_tr_b16 v[18:19], v6 offset:33024
 v_mfma_f32_16x16x32_bf16 v[148:151], v[24:27], a[136:139], v[148:151]
 buffer_load_dwordx4 v3, s[56:59], s89 offen lds
 v_mfma_f32_16x16x32_bf16 v[152:155], v[24:27], a[144:147], v[152:155]
 ds_read_b64_tr_b16 v[20:21], v6 offset:34816
 v_mfma_f32_16x16x32_bf16 v[152:155], v[28:31], a[148:151], v[152:155]
 v_mfma_f32_16x16x32_bf16 v[156:159], v[28:31], a[156:159], v[156:159]
 ds_read_b64_tr_b16 v[22:23], v6 offset:35072
 s_add_u32 m0, s94, 24576
 v_mfma_f32_16x16x32_bf16 v[156:159], v[24:27], a[152:155], v[156:159]
 s_waitcnt lgkmcnt(8)
 v_mfma_f32_16x16x32_bf16 v[160:163], v[32:35], a[128:131], v[160:163]
 ds_read_b64_tr_b16 v[24:25], v7 offset:32768
 buffer_load_dwordx4 v3, s[64:67], s89 offen lds
 v_mfma_f32_16x16x32_bf16 v[160:163], v[36:39], a[132:135], v[160:163]
 v_mfma_f32_16x16x32_bf16 v[164:167], v[36:39], a[140:143], v[164:167]
 ds_read_b64_tr_b16 v[26:27], v7 offset:33024
 v_mfma_f32_16x16x32_bf16 v[164:167], v[32:35], a[136:139], v[164:167]
 s_add_u32 m0, s94, 20480
 v_mfma_f32_16x16x32_bf16 v[168:171], v[32:35], a[144:147], v[168:171]
 ds_read_b64_tr_b16 v[28:29], v7 offset:34816
 v_mfma_f32_16x16x32_bf16 v[168:171], v[36:39], a[148:151], v[168:171]
 buffer_load_dwordx4 v3, s[60:63], s89 offen lds
 v_mfma_f32_16x16x32_bf16 v[172:175], v[36:39], a[156:159], v[172:175]
 ds_read_b64_tr_b16 v[30:31], v7 offset:35072
 v_mfma_f32_16x16x32_bf16 v[172:175], v[32:35], a[152:155], v[172:175]
 s_waitcnt lgkmcnt(8)
 v_mfma_f32_16x16x32_bf16 v[176:179], v[40:43], a[128:131], v[176:179]
 ds_read_b64_tr_b16 v[32:33], v6 offset:36864
 s_add_u32 m0, s94, 28672
 v_mfma_f32_16x16x32_bf16 v[176:179], v[44:47], a[132:135], v[176:179]
 v_mfma_f32_16x16x32_bf16 v[180:183], v[44:47], a[140:143], v[180:183]
 ds_read_b64_tr_b16 v[34:35], v6 offset:37120
 buffer_load_dwordx4 v3, s[68:71], s89 offen lds
 v_mfma_f32_16x16x32_bf16 v[180:183], v[40:43], a[136:139], v[180:183]
 v_mfma_f32_16x16x32_bf16 v[184:187], v[40:43], a[144:147], v[184:187]
 ds_read_b64_tr_b16 v[36:37], v6 offset:38912
 v_mfma_f32_16x16x32_bf16 v[184:187], v[44:47], a[148:151], v[184:187]
 s_add_u32 m0, s94, 32768
 v_mfma_f32_16x16x32_bf16 v[188:191], v[44:47], a[156:159], v[188:191]
 ds_read_b64_tr_b16 v[38:39], v6 offset:39168
 v_mfma_f32_16x16x32_bf16 v[188:191], v[40:43], a[152:155], v[188:191]
 s_waitcnt lgkmcnt(8)
 buffer_load_dwordx4 v3, s[72:75], s89 offen lds
 v_mfma_f32_16x16x32_bf16 v[192:195], v[16:19], a[128:131], v[192:195]
 ds_read_b64_tr_b16 v[40:41], v7 offset:36864
 v_mfma_f32_16x16x32_bf16 v[192:195], v[20:23], a[132:135], v[192:195]
 v_mfma_f32_16x16x32_bf16 v[196:199], v[20:23], a[140:143], v[196:199]
 ds_read_b64_tr_b16 v[42:43], v7 offset:37120
 s_add_u32 m0, s94, 36864
 v_mfma_f32_16x16x32_bf16 v[196:199], v[16:19], a[136:139], v[196:199]
 v_mfma_f32_16x16x32_bf16 v[200:203], v[16:19], a[144:147], v[200:203]
 ds_read_b64_tr_b16 v[44:45], v7 offset:38912
 buffer_load_dwordx4 v3, s[76:79], s89 offen lds
 v_mfma_f32_16x16x32_bf16 v[200:203], v[20:23], a[148:151], v[200:203]
 v_mfma_f32_16x16x32_bf16 v[204:207], v[20:23], a[156:159], v[204:207]
 ds_read_b64_tr_b16 v[46:47], v7 offset:39168
 v_mfma_f32_16x16x32_bf16 v[204:207], v[16:19], a[152:155], v[204:207]
 s_waitcnt lgkmcnt(8)
 v_mfma_f32_16x16x32_bf16 v[208:211], v[24:27], a[128:131], v[208:211]
 v_mfma_f32_16x16x32_bf16 v[208:211], v[28:31], a[132:135], v[208:211]
 v_mfma_f32_16x16x32_bf16 v[212:215], v[28:31], a[140:143], v[212:215]
 v_mfma_f32_16x16x32_bf16 v[212:215], v[24:27], a[136:139], v[212:215]
 v_mfma_f32_16x16x32_bf16 v[216:219], v[24:27], a[144:147], v[216:219]
 s_add_u32 s93, s93, 40960
 v_mfma_f32_16x16x32_bf16 v[216:219], v[28:31], a[148:151], v[216:219]
 s_cmp_ge_u32 s93, 163840
 v_mfma_f32_16x16x32_bf16 v[220:223], v[28:31], a[156:159], v[220:223]
 s_cselect_b32 s93, 0, s93
 v_mfma_f32_16x16x32_bf16 v[220:223], v[24:27], a[152:155], v[220:223]
 s_waitcnt lgkmcnt(4)
 s_waitcnt vmcnt(20) lgkmcnt(0)
 s_barrier
 v_add_u32 v6, s93, v4
 v_add_u32 v7, s93, v5
 v_mfma_f32_16x16x32_bf16 v[224:227], v[32:35], a[128:131], v[224:227]
 s_add_u32 s9, s9, 1
 ds_read_b64_tr_b16 v[16:17], v6 offset:0
 v_mfma_f32_16x16x32_bf16 v[224:227], v[36:39], a[132:135], v[224:227]
 s_cmp_lt_u32 s9, 4
 ds_read_b64_tr_b16 v[18:19], v6 offset:256
 v_mfma_f32_16x16x32_bf16 v[228:231], v[36:39], a[140:143], v[228:231]
 s_cselect_b32 s3, 1, 3
 ds_read_b64_tr_b16 v[20:21], v6 offset:2048
 v_mfma_f32_16x16x32_bf16 v[228:231], v[32:35], a[136:139], v[228:231]
 s_add_u32 s100, s9, s11
 ds_read_b64_tr_b16 v[22:23], v6 offset:2304
 v_mfma_f32_16x16x32_bf16 v[232:235], v[32:35], a[144:147], v[232:235]
 s_and_b32 s100, s100, s3
 ds_read_b64_tr_b16 v[24:25], v7 offset:0
 v_mfma_f32_16x16x32_bf16 v[232:235], v[36:39], a[148:151], v[232:235]
 s_andn2_b32 s3, s9, s3
 ds_read_b64_tr_b16 v[26:27], v7 offset:256
 v_mfma_f32_16x16x32_bf16 v[236:239], v[36:39], a[156:159], v[236:239]
 s_or_b32 s100, s100, s3
 ds_read_b64_tr_b16 v[28:29], v7 offset:2048
 v_mfma_f32_16x16x32_bf16 v[236:239], v[32:35], a[152:155], v[236:239]
 s_waitcnt lgkmcnt(7)
 ds_read_b64_tr_b16 v[30:31], v7 offset:2304
 v_mfma_f32_16x16x32_bf16 v[240:243], v[40:43], a[128:131], v[240:243]
 s_mul_i32 s88, s100, s90
 ds_read_b64_tr_b16 v[32:33], v6 offset:4096
 v_mfma_f32_16x16x32_bf16 v[240:243], v[44:47], a[132:135], v[240:243]
 s_mul_i32 s89, s100, s91
 v_mfma_f32_16x16x32_bf16 v[244:247], v[44:47], a[140:143], v[244:247]
 s_add_u32 s94, s94, 40960
 ds_read_b64_tr_b16 v[34:35], v6 offset:4352
 v_mfma_f32_16x16x32_bf16 v[244:247], v[40:43], a[136:139], v[244:247]
 s_cmp_ge_u32 s94, s99
 v_mfma_f32_16x16x32_bf16 v[248:251], v[40:43], a[144:147], v[248:251]
 s_cselect_b32 s3, 163840, 0
 ds_read_b64_tr_b16 v[36:37], v6 offset:6144
 v_mfma_f32_16x16x32_bf16 v[248:251], v[44:47], a[148:151], v[248:251]
 s_sub_u32 s94, s94, s3
 v_mfma_f32_16x16x32_bf16 v[252:255], v[44:47], a[156:159], v[252:255]
 ds_read_b64_tr_b16 v[38:39], v6 offset:6400
 v_mfma_f32_16x16x32_bf16 v[252:255], v[40:43], a[152:155], v[252:255]
.p2align 6
L_g1_loopA:
 s_waitcnt lgkmcnt(8)
 v_mfma_f32_16x16x32_bf16 a[0:3], v[16:19], a[160:163], a[0:3]
 ds_read_b64_tr_b16 v[40:41], v7 offset:4096
 v_mfma_f32_16x16x32_bf16 a[0:3], v[20:23], a[164:167], a[0:3]
 v_mfma_f32_16x16x32_bf16 a[4:7], v[20:23], a[172:175], a[4:7]
 ds_read_b64_tr_b16 v[42:43], v7 offset:4352
 v_mfma_f32_16x16x32_bf16 a[4:7], v[16:19], a[168:171], a[4:7]
 buffer_load_dwordx4 a[128:131], v8, s[84:87], s92 offen offset:0 sc1
 v_mfma_f32_16x16x32_bf16 a[8:11], v[16:19], a[176:179], a[8:11]
 ds_read_b64_tr_b16 v[44:45], v7 offset:6144
 v_mfma_f32_16x16x32_bf16 a[8:11], v[20:23], a[180:183], a[8:11]
 v_mfma_f32_16x16x32_bf16 a[12:15], v[20:23], a[188:191], a[12:15]
 ds_read_b64_tr_b16 v[46:47], v7 offset:6400
 v_mfma_f32_16x16x32_bf16 a[12:15], v[16:19], a[184:187], a[12:15]
 s_waitcnt lgkmcnt(8)
 v_mfma_f32_16x16x32_bf16 a[16:19], v[24:27], a[160:163], a[16:19]
 ds_read_b64_tr_b16 v[16:17], v6 offset:8192
 v_mfma_f32_16x16x32_bf16 a[16:19], v[28:31], a[164:167], a[16:19]
 v_mfma_f32_16x16x32_bf16 a[20:23], v[28:31], a[172:175], a[20:23]
 ds_read_b64_tr_b16 v[18:19], v6 offset:8448
 v_mfma_f32_16x16x32_bf16 a[20:23], v[24:27], a[168:171], a[20:23]
 buffer_load_dwordx4 a[132:135], v8, s[84:87], s92 offen offset:1024 sc1
 v_mfma_f32_16x16x32_bf16 a[24:27], v[24:27], a[176:179], a[24:27]
 ds_read_b64_tr_b16 v[20:21], v6 offset:10240
 v_mfma_f32_16x16x32_bf16 a[24:27], v[28:31], a[180:183], a[24:27]
 v_mfma_f32_16x16x32_bf16 a[28:31], v[28:31], a[188:191], a[28:31]
 ds_read_b64_tr_b16 v[22:23], v6 offset:10496
 v_mfma_f32_16x16x32_bf16 a[28:31], v[24:27], a[184:187], a[28:31]
 s_waitcnt lgkmcnt(8)
 v_mfma_f32_16x16x32_bf16 a[32:35], v[32:35], a[160:163], a[32:35]
 ds_read_b64_tr_b16 v[24:25], v7 offset:8192
 v_mfma_f32_16x16x32_bf16 a[32:35], v[36:39], a[164:167], a[32:35]
 v_mfma_f32_16x16x32_bf16 a[36:39], v[36:39], a[172:175], a[36:39]
 ds_read_b64_tr_b16 v[26:27], v7 offset:8448
 v_mfma_f32_16x16x32_bf16 a[36:39], v[32:35], a[168:171], a[36:39]
 buffer_load_dwordx4 a[136:139], v9, s[84:87], s92 offen offset:0 sc1
 v_mfma_f32_16x16x32_bf16 a[40:43], v[32:35], a[176:179], a[40:43]
 ds_read_b64_tr_b16 v[28:29], v7 offset:10240
 v_mfma_f32_16x16x32_bf16 a[40:43], v[36:39], a[180:183], a[40:43]
 v_mfma_f32_16x16x32_bf16 a[44:47], v[36:39], a[188:191], a[44:47]
 ds_read_b64_tr_b16 v[30:31], v7 offset:10496
 v_mfma_f32_16x16x32_bf16 a[44:47], v[32:35], a[184:187], a[44:47]
 s_waitcnt lgkmcnt(8)
 v_mfma_f32_16x16x32_bf16 a[48:51], v[40:43], a[160:163], a[48:51]
 ds_read_b64_tr_b16 v[32:33], v6 offset:12288
 v_mfma_f32_16x16x32_bf16 a[48:51], v[44:47], a[164:167], a[48:51]
 v_mfma_f32_16x16x32_bf16 a[52:55], v[44:47], a[172:175], a[52:55]
 ds_read_b64_tr_b16 v[34:35], v6 offset:12544
 v_mfma_f32_16x16x32_bf16 a[52:55], v[40:43], a[168:171], a[52:55]
 buffer_load_dwordx4 a[140:143], v9, s[84:87], s92 offen offset:1024 sc1
 v_mfma_f32_16x16x32_bf16 a[56:59], v[40:43], a[176:179], a[56:59]
 ds_read_b64_tr_b16 v[36:37], v6 offset:14336
 v_mfma_f32_16x16x32_bf16 a[56:59], v[44:47], a[180:183], a[56:59]
 v_mfma_f32_16x16x32_bf16 a[60:63], v[44:47], a[188:191], a[60:63]
 ds_read_b64_tr_b16 v[38:39], v6 offset:14592
 v_mfma_f32_16x16x32_bf16 a[60:63], v[40:43], a[184:187], a[60:63]
 s_waitcnt lgkmcnt(8)
 v_mfma_f32_16x16x32_bf16 a[64:67], v[16:19], a[160:163], a[64:67]
 ds_read_b64_tr_b16 v[40:41], v7 offset:12288
 v_mfma_f32_16x16x32_bf16 a[64:67], v[20:23], a[164:167], a[64:67]
 v_mfma_f32_16x16x32_bf16 a[68:71], v[20:23], a[172:175], a[68:71]
 ds_read_b64_tr_b16 v[42:43], v7 offset:12544
 v_mfma_f32_16x16x32_bf16 a[68:71], v[16:19], a[168:171], a[68:71]
 buffer_load_dwordx4 a[144:147], v10, s[84:87], s92 offen offset:0 sc1
 v_mfma_f32_16x16x32_bf16 a[72:75], v[16:19], a[176:179], a[72:75]
 ds_read_b64_tr_b16 v[44:45], v7 offset:14336
 v_mfma_f32_16x16x32_bf16 a[72:75], v[20:23], a[180:183], a[72:75]
 v_mfma_f32_16x16x32_bf16 a[76:79], v[20:23], a[188:191], a[76:79]
 ds_read_b64_tr_b16 v[46:47], v7 offset:14592
 v_mfma_f32_16x16x32_bf16 a[76:79], v[16:19], a[184:187], a[76:79]
 s_waitcnt lgkmcnt(8)
 v_mfma_f32_16x16x32_bf16 a[80:83], v[24:27], a[160:163], a[80:83]
 ds_read_b64_tr_b16 v[16:17], v6 offset:16384
 v_mfma_f32_16x16x32_bf16 a[80:83], v[28:31], a[164:167], a[80:83]
 v_mfma_f32_16x16x32_bf16 a[84:87], v[28:31], a[172:175], a[84:87]
 ds_read_b64_tr_b16 v[18:19], v6 offset:16640
 v_mfma_f32_16x16x32_bf16 a[84:87], v[24:27], a[168:171], a[84:87]
 buffer_load_dwordx4 a[148:151], v10, s[84:87], s92 offen offset:1024 sc1
 v_mfma_f32_16x16x32_bf16 a[88:91], v[24:27], a[176:179], a[88:91]
 ds_read_b64_tr_b16 v[20:21], v6 offset:18432
 v_mfma_f32_16x16x32_bf16 a[88:91], v[28:31], a[180:183], a[88:91]
 v_mfma_f32_16x16x32_bf16 a[92:95], v[28:31], a[188:191], a[92:95]
 ds_read_b64_tr_b16 v[22:23], v6 offset:18688
 v_mfma_f32_16x16x32_bf16 a[92:95], v[24:27], a[184:187], a[92:95]
 s_waitcnt lgkmcnt(8)
 v_mfma_f32_16x16x32_bf16 a[96:99], v[32:35], a[160:163], a[96:99]
 ds_read_b64_tr_b16 v[24:25], v7 offset:16384
 v_mfma_f32_16x16x32_bf16 a[96:99], v[36:39], a[164:167], a[96:99]
 v_mfma_f32_16x16x32_bf16 a[100:103], v[36:39], a[172:175], a[100:103]
 ds_read_b64_tr_b16 v[26:27], v7 offset:16640
 v_mfma_f32_16x16x32_bf16 a[100:103], v[32:35], a[168:171], a[100:103]
 buffer_load_dwordx4 a[152:155], v11, s[84:87], s92 offen offset:0 sc1
 v_mfma_f32_16x16x32_bf16 a[104:107], v[32:35], a[176:179], a[104:107]
 ds_read_b64_tr_b16 v[28:29], v7 offset:18432
 v_mfma_f32_16x16x32_bf16 a[104:107], v[36:39], a[180:183], a[104:107]
 v_mfma_f32_16x16x32_bf16 a[108:111], v[36:39], a[188:191], a[108:111]
 ds_read_b64_tr_b16 v[30:31], v7 offset:18688
 v_mfma_f32_16x16x32_bf16 a[108:111], v[32:35], a[184:187], a[108:111]
 s_waitcnt lgkmcnt(8)
 v_mfma_f32_16x16x32_bf16 a[112:115], v[40:43], a[160:163], a[112:115]
 ds_read_b64_tr_b16 v[32:33], v6 offset:20480
 v_mfma_f32_16x16x32_bf16 a[112:115], v[44:47], a[164:167], a[112:115]
 v_mfma_f32_16x16x32_bf16 a[116:119], v[44:47], a[172:175], a[116:119]
 ds_read_b64_tr_b16 v[34:35], v6 offset:20736
 v_mfma_f32_16x16x32_bf16 a[116:119], v[40:43], a[168:171], a[116:119]
 buffer_load_dwordx4 a[156:159], v11, s[84:87], s92 offen offset:1024 sc1
 v_mfma_f32_16x16x32_bf16 a[120:123], v[40:43], a[176:179], a[120:123]
 s_add_u32 s10, s10, 1
 ds_read_b64_tr_b16 v[36:37], v6 offset:22528
 v_mfma_f32_16x16x32_bf16 a[120:123], v[44:47], a[180:183], a[120:123]
 s_cmp_lt_u32 s10, 4
 v_mfma_f32_16x16x32_bf16 a[124:127], v[44:47], a[188:191], a[124:127]
 s_cselect_b32 s3, 1, 3
 ds_read_b64_tr_b16 v[38:39], v6 offset:22784
 v_mfma_f32_16x16x32_bf16 a[124:127], v[40:43], a[184:187], a[124:127]
 s_add_u32 s92, s10, s11
 s_waitcnt lgkmcnt(8)
 v_mfma_f32_16x16x32_bf16 v[64:67], v[16:19], a[160:163], v[64:67]
 ds_read_b64_tr_b16 v[40:41], v7 offset:20480
 v_mfma_f32_16x16x32_bf16 v[64:67], v[20:23], a[164:167], v[64:67]
 s_add_u32 m0, s94, 0
 v_mfma_f32_16x16x32_bf16 v[68:71], v[20:23], a[172:175], v[68:71]
 s_and_b32 s92, s92, s3
 ds_read_b64_tr_b16 v[42:43], v7 offset:20736
 v_mfma_f32_16x16x32_bf16 v[68:71], v[16:19], a[168:171], v[68:71]
 s_andn2_b32 s3, s10, s3
 buffer_load_dwordx4 v2, s[40:43], s88 offen lds
 s_add_u32 m0, s94, 8192
 v_mfma_f32_16x16x32_bf16 v[72:75], v[16:19], a[176:179], v[72:75]
 s_or_b32 s92, s92, s3
 ds_read_b64_tr_b16 v[44:45], v7 offset:22528
 v_mfma_f32_16x16x32_bf16 v[72:75], v[20:23], a[180:183], v[72:75]
 s_lshl_b32 s92, s92, 11
 buffer_load_dwordx4 v2, s[48:51], s88 offen lds
 v_mfma_f32_16x16x32_bf16 v[76:79], v[20:23], a[188:191], v[76:79]
 ds_read_b64_tr_b16 v[46:47], v7 offset:22784
 v_mfma_f32_16x16x32_bf16 v[76:79], v[16:19], a[184:187], v[76:79]
 s_waitcnt lgkmcnt(8)
 v_mfma_f32_16x16x32_bf16 v[80:83], v[24:27], a[160:163], v[80:83]
 ds_read_b64_tr_b16 v[16:17], v6 offset:24576
 v_mfma_f32_16x16x32_bf16 v[80:83], v[28:31], a[164:167], v[80:83]
 v_mfma_f32_16x16x32_bf16 v[84:87], v[28:31], a[172:175], v[84:87]
 ds_read_b64_tr_b16 v[18:19], v6 offset:24832
 v_mfma_f32_16x16x32_bf16 v[84:87], v[24:27], a[168:171], v[84:87]
 v_mfma_f32_16x16x32_bf16 v[88:91], v[24:27], a[176:179], v[88:91]
 ds_read_b64_tr_b16 v[20:21], v6 offset:26624
 v_mfma_f32_16x16x32_bf16 v[88:91], v[28:31], a[180:183], v[88:91]
 v_mfma_f32_16x16x32_bf16 v[92:95], v[28:31], a[188:191], v[92:95]
 ds_read_b64_tr_b16 v[22:23], v6 offset:26880
 v_mfma_f32_16x16x32_bf16 v[92:95], v[24:27], a[184:187], v[92:95]
 s_waitcnt lgkmcnt(8)
 v_mfma_f32_16x16x32_bf16 v[96:99], v[32:35], a[160:163], v[96:99]
 ds_read_b64_tr_b16 v[24:25], v7 offset:24576
 v_mfma_f32_16x16x32_bf16 v[96:99], v[36:39], a[164:167], v[96:99]
 s_add_u32 m0, s94, 4096
 v_mfma_f32_16x16x32_bf16 v[100:103], v[36:39], a[172:175], v[100:103]
 ds_read_b64_tr_b16 v[26:27], v7 offset:24832
 v_mfma_f32_16x16x32_bf16 v[100:103], v[32:35], a[168:171], v[100:103]
 buffer_load_dwordx4 v2, s[44:47], s88 offen lds
 s_add_u32 m0, s94, 12288
 v_mfma_f32_16x16x32_bf16 v[104:107], v[32:35], a[176:179], v[104:107]
 ds_read_b64_tr_b16 v[28:29], v7 offset:26624
 v_mfma_f32_16x16x32_bf16 v[104:107], v[36:39], a[180:183], v[104:107]
 buffer_load_dwordx4 v2, s[52:55], s88 offen lds
 v_mfma_f32_16x16x32_bf16 v[108:111], v[36:39], a[188:191], v[108:111]
 ds_read_b64_tr_b16 v[30:31], v7 offset:26880
 v_mfma_f32_16x16x32_bf16 v[108:111], v[32:35], a[184:187], v[108:111]
 s_waitcnt lgkmcnt(8)
 v_mfma_f32_16x16x32_bf16 v[112:115], v[40:43], a[160:163], v[112:115]
 ds_read_b64_tr_b16 v[32:33], v6 offset:28672
 v_mfma_f32_16x16x32_bf16 v[112:115], v[44:47], a[164:167], v[112:115]
 v_mfma_f32_16x16x32_bf16 v[116:119], v[44:47], a[172:175], v[116:119]
 ds_read_b64_tr_b16 v[34:35], v6 offset:28928
 v_mfma_f32_16x16x32_bf16 v[116:119], v[40:43], a[168:171], v[116:119]
 v_mfma_f32_16x16x32_bf16 v[120:123], v[40:43], a[176:179], v[120:123]
 ds_read_b64_tr_b16 v[36:37], v6 offset:30720
 v_mfma_f32_16x16x32_bf16 v[120:123], v[44:47], a[180:183], v[120:123]
 v_mfma_f32_16x16x32_bf16 v[124:127], v[44:47], a[188:191], v[124:127]
 ds_read_b64_tr_b16 v[38:39], v6 offset:30976
 v_mfma_f32_16x16x32_bf16 v[124:127], v[40:43], a[184:187], v[124:127]
 s_waitcnt lgkmcnt(8)
 v_mfma_f32_16x16x32_bf16 v[128:131], v[16:19], a[160:163], v[128:131]
 ds_read_b64_tr_b16 v[40:41], v7 offset:28672
 v_mfma_f32_16x16x32_bf16 v[128:131], v[20:23], a[164:167], v[128:131]
 s_add_u32 m0, s94, 16384
 v_mfma_f32_16x16x32_bf16 v[132:135], v[20:23], a[172:175], v[132:135]
 ds_read_b64_tr_b16 v[42:43], v7 offset:28928
 v_mfma_f32_16x16x32_bf16 v[132:135], v[16:19], a[168:171], v[132:135]
 buffer_load_dwordx4 v3, s[56:59], s89 offen lds
 s_add_u32 m0, s94, 24576
 v_mfma_f32_16x16x32_bf16 v[136:139], v[16:19], a[176:179], v[136:139]
 ds_read_b64_tr_b16 v[44:45], v7 offset:30720
 v_mfma_f32_16x16x32_bf16 v[136:139], v[20:23], a[180:183], v[136:139]
 buffer_load_dwordx4 v3, s[64:67], s89 offen lds
 v_mfma_f32_16x16x32_bf16 v[140:143], v[20:23], a[188:191], v[140:143]
 ds_read_b64_tr_b16 v[46:47], v7 offset:30976
 v_mfma_f32_16x16x32_bf16 v[140:143], v[16:19], a[184:187], v[140:143]
 s_waitcnt lgkmcnt(8)
 v_mfma_f32_16x16x32_bf16 v[144:147], v[24:27], a[160:163], v[144:147]
 ds_read_b64_tr_b16 v[16:17], v6 offset:32768
 v_mfma_f32_16x16x32_bf16 v[144:147], v[28:31], a[164:167], v[144:147]
 v_mfma_f32_16x16x32_bf16 v[148:151], v[28:31], a[172:175], v[148:151]
 ds_read_b64_tr_b16 v[18:19], v6 offset:33024
 v_mfma_f32_16x16x32_bf16 v[148:151], v[24:27], a[168:171], v[148:151]
 v_mfma_f32_16x16x32_bf16 v[152:155], v[24:27], a[176:179], v[152:155]
 ds_read_b64_tr_b16 v[20:21], v6 offset:34816
 v_mfma_f32_16x16x32_bf16 v[152:155], v[28:31], a[180:183], v[152:155]
 v_mfma_f32_16x16x32_bf16 v[156:159], v[28:31], a[188:191], v[156:159]
 ds_read_b64_tr_b16 v[22:23], v6 offset:35072
 v_mfma_f32_16x16x32_bf16 v[156:159], v[24:27], a[184:187], v[156:159]
 s_waitcnt lgkmcnt(8)
 v_mfma_f32_16x16x32_bf16 v[160:163], v[32:35], a[160:163], v[160:163]
 ds_read_b64_tr_b16 v[24:25], v7 offset:32768
 v_mfma_f32_16x16x32_bf16 v[160:163], v[36:39], a[164:167], v[160:163]
 s_add_u32 m0, s94, 20480
 v_mfma_f32_16x16x32_bf16 v[164:167], v[36:39], a[172:175], v[164:167]
 ds_read_b64_tr_b16 v[26:27], v7 offset:33024
 v_mfma_f32_16x16x32_bf16 v[164:167], v[32:35], a[168:171], v[164:167]
 buffer_load_dwordx4 v3, s[60:63], s89 offen lds
 s_add_u32 m0, s94, 28672
 v_mfma_f32_16x16x32_bf16 v[168:171], v[32:35], a[176:179], v[168:171]
 ds_read_b64_tr_b16 v[28:29], v7 offset:34816
 v_mfma_f32_16x16x32_bf16 v[168:171], v[36:39], a[180:183], v[168:171]
 buffer_load_dwordx4 v3, s[68:71], s89 offen lds
 v_mfma_f32_16x16x32_bf16 v[172:175], v[36:39], a[188:191], v[172:175]
 ds_read_b64_tr_b16 v[30:31], v7 offset:35072
 v_mfma_f32_16x16x32_bf16 v[172:175], v[32:35], a[184:187], v[172:175]
 s_waitcnt lgkmcnt(8)
 v_mfma_f32_16x16x32_bf16 v[176:179], v[40:43], a[160:163], v[176:179]
 ds_read_b64_tr_b16 v[32:33], v6 offset:36864
 v_mfma_f32_16x16x32_bf16 v[176:179], v[44:47], a[164:167], v[176:179]
 v_mfma_f32_16x16x32_bf16 v[180:183], v[44:47], a[172:175], v[180:183]
 ds_read_b64_tr_b16 v[34:35], v6 offset:37120
 v_mfma_f32_16x16x32_bf16 v[180:183], v[40:43], a[168:171], v[180:183]
 v_mfma_f32_16x16x32_bf16 v[184:187], v[40:43], a[176:179], v[184:187]
 ds_read_b64_tr_b16 v[36:37], v6 offset:38912
 v_mfma_f32_16x16x32_bf16 v[184:187], v[44:47], a[180:183], v[184:187]
 v_mfma_f32_16x16x32_bf16 v[188:191], v[44:47], a[188:191], v[188:191]
 ds_read_b64_tr_b16 v[38:39], v6 offset:39168
 v_mfma_f32_16x16x32_bf16 v[188:191], v[40:43], a[184:187], v[188:191]
 s_waitcnt lgkmcnt(8)
 v_mfma_f32_16x16x32_bf16 v[192:195], v[16:19], a[160:163], v[192:195]
 ds_read_b64_tr_b16 v[40:41], v7 offset:36864
 v_mfma_f32_16x16x32_bf16 v[192:195], v[20:23], a[164:167], v[192:195]
 s_add_u32 m0, s94, 32768
 v_mfma_f32_16x16x32_bf16 v[196:199], v[20:23], a[172:175], v[196:199]
 ds_read_b64_tr_b16 v[42:43], v7 offset:37120
 v_mfma_f32_16x16x32_bf16 v[196:199], v[16:19], a[168:171], v[196:199]
 buffer_load_dwordx4 v3, s[72:75], s89 offen lds
 s_add_u32 m0, s94, 36864
 v_mfma_f32_16x16x32_bf16 v[200:203], v[16:19], a[176:179], v[200:203]
 ds_read_b64_tr_b16 v[44:45], v7 offset:38912
 v_mfma_f32_16x16x32_bf16 v[200:203], v[20:23], a[180:183], v[200:203]
 buffer_load_dwordx4 v3, s[76:79], s89 offen lds
 v_mfma_f32_16x16x32_bf16 v[204:207], v[20:23], a[188:191], v[204:207]
 ds_read_b64_tr_b16 v[46:47], v7 offset:39168
 v_mfma_f32_16x16x32_bf16 v[204:207], v[16:19], a[184:187], v[204:207]
 s_waitcnt lgkmcnt(8)
 v_mfma_f32_16x16x32_bf16 v[208:211], v[24:27], a[160:163], v[208:211]
 v_mfma_f32_16x16x32_bf16 v[208:211], v[28:31], a[164:167], v[208:211]
 v_mfma_f32_16x16x32_bf16 v[212:215], v[28:31], a[172:175], v[212:215]
 v_mfma_f32_16x16x32_bf16 v[212:215], v[24:27], a[168:171], v[212:215]
 v_mfma_f32_16x16x32_bf16 v[216:219], v[24:27], a[176:179], v[216:219]
 s_add_u32 s93, s93, 40960
 v_mfma_f32_16x16x32_bf16 v[216:219], v[28:31], a[180:183], v[216:219]
 s_cmp_ge_u32 s93, 163840
 v_mfma_f32_16x16x32_bf16 v[220:223], v[28:31], a[188:191], v[220:223]
 s_cselect_b32 s93, 0, s93
 v_mfma_f32_16x16x32_bf16 v[220:223], v[24:27], a[184:187], v[220:223]
 s_waitcnt lgkmcnt(4)
 s_waitcnt vmcnt(10) lgkmcnt(0)
 s_barrier
 v_add_u32 v6, s93, v4
 v_add_u32 v7, s93, v5
 v_mfma_f32_16x16x32_bf16 v[224:227], v[32:35], a[160:163], v[224:227]
 s_add_u32 s9, s9, 1
 ds_read_b64_tr_b16 v[16:17], v6 offset:0
 v_mfma_f32_16x16x32_bf16 v[224:227], v[36:39], a[164:167], v[224:227]
 s_cmp_lt_u32 s9, 4
 ds_read_b64_tr_b16 v[18:19], v6 offset:256
 v_mfma_f32_16x16x32_bf16 v[228:231], v[36:39], a[172:175], v[228:231]
 s_cselect_b32 s3, 1, 3
 ds_read_b64_tr_b16 v[20:21], v6 offset:2048
 v_mfma_f32_16x16x32_bf16 v[228:231], v[32:35], a[168:171], v[228:231]
 s_add_u32 s100, s9, s11
 ds_read_b64_tr_b16 v[22:23], v6 offset:2304
 v_mfma_f32_16x16x32_bf16 v[232:235], v[32:35], a[176:179], v[232:235]
 s_and_b32 s100, s100, s3
 ds_read_b64_tr_b16 v[24:25], v7 offset:0
 v_mfma_f32_16x16x32_bf16 v[232:235], v[36:39], a[180:183], v[232:235]
 s_andn2_b32 s3, s9, s3
 ds_read_b64_tr_b16 v[26:27], v7 offset:256
 v_mfma_f32_16x16x32_bf16 v[236:239], v[36:39], a[188:191], v[236:239]
 s_or_b32 s100, s100, s3
 ds_read_b64_tr_b16 v[28:29], v7 offset:2048
 v_mfma_f32_16x16x32_bf16 v[236:239], v[32:35], a[184:187], v[236:239]
 s_waitcnt lgkmcnt(7)
 ds_read_b64_tr_b16 v[30:31], v7 offset:2304
 v_mfma_f32_16x16x32_bf16 v[240:243], v[40:43], a[160:163], v[240:243]
 s_mul_i32 s88, s100, s90
 ds_read_b64_tr_b16 v[32:33], v6 offset:4096
 v_mfma_f32_16x16x32_bf16 v[240:243], v[44:47], a[164:167], v[240:243]
 s_mul_i32 s89, s100, s91
 v_mfma_f32_16x16x32_bf16 v[244:247], v[44:47], a[172:175], v[244:247]
 s_add_u32 s94, s94, 40960
 ds_read_b64_tr_b16 v[34:35], v6 offset:4352
 v_mfma_f32_16x16x32_bf16 v[244:247], v[40:43], a[168:171], v[244:247]
 s_cmp_ge_u32 s94, s99
 v_mfma_f32_16x16x32_bf16 v[248:251], v[40:43], a[176:179], v[248:251]
 s_cselect_b32 s3, 163840, 0
 ds_read_b64_tr_b16 v[36:37], v6 offset:6144
 v_mfma_f32_16x16x32_bf16 v[248:251], v[44:47], a[180:183], v[248:251]
 s_sub_u32 s94, s94, s3
 v_mfma_f32_16x16x32_bf16 v[252:255], v[44:47], a[188:191], v[252:255]
 ds_read_b64_tr_b16 v[38:39], v6 offset:6400
 v_mfma_f32_16x16x32_bf16 v[252:255], v[40:43], a[184:187], v[252:255]
 s_sub_u32 s96, s96, 1
 s_cmp_eq_u32 s96, 0
 s_cbranch_scc1 L_g1_outA
 s_cmp_lg_u32 s96, 1
 s_cbranch_scc1 L_g1_ttA
 s_cmp_ge_u32 s97, 23
 s_cbranch_scc1 L_g1_ttQ
 s_cmp_eq_u32 s97, 22
 s_cbranch_scc1 L_g1_ttM
 s_mov_b32 s3, s95
 v_lshrrev_b32 v51, 4, v15
 s_mul_i32 s3, s3, 5120
 v_min_u32 v48, 39, v51
 v_lshlrev_b32 v48, 7, v48
 v_add_u32 v48, s3, v48
 v_min_u32 v48, L_g1_H_fin - L_g1_H - 4, v48
 s_getpc_b64 s[16:17]
 s_add_u32 s16, s16, L_g1_H - .
 s_addc_u32 s17, s17, 0
 v_mov_b32 v49, s17
 v_add_co_u32 v48, vcc, s16, v48
 s_nop 1
 v_addc_co_u32 v49, vcc, 0, v49, vcc
 global_load_dword v50, v[48:49], off
 s_branch L_g1_ttA
L_g1_ttM:
 s_mov_b32 s3, s95
 v_lshrrev_b32 v51, 4, v15
 s_mul_i32 s3, s3, 5120
 v_min_u32 v48, 39, v51
 v_lshlrev_b32 v48, 7, v48
 v_add_u32 v48, s3, v48
 v_min_u32 v48, L_g1_M_fin - L_g1_M - 4, v48
 s_getpc_b64 s[16:17]
 s_add_u32 s16, s16, L_g1_M - .
 s_addc_u32 s17, s17, 0
 v_mov_b32 v49, s17
 v_add_co_u32 v48, vcc, s16, v48
 s_nop 1
 v_addc_co_u32 v49, vcc, 0, v49, vcc
 global_load_dword v50, v[48:49], off
 s_branch L_g1_ttA
L_g1_ttQ:
 s_mov_b32 s3, s95
 v_lshrrev_b32 v51, 4, v15
 s_mul_i32 s3, s3, 5120
 v_min_u32 v48, 39, v51
 v_lshlrev_b32 v48, 7, v48
 v_add_u32 v48, s3, v48
 v_min_u32 v48, L_g1_Q_fin - L_g1_Q - 4, v48
 s_getpc_b64 s[16:17]
 s_add_u32 s16, s16, L_g1_Q - .
 s_addc_u32 s17, s17, 0
 v_mov_b32 v49, s17
 v_add_co_u32 v48, vcc, s16, v48
 s_nop 1
 v_addc_co_u32 v49, vcc, 0, v49, vcc
 global_load_dword v50, v[48:49], off
 s_branch L_g1_ttA
L_g1_ttA:
 s_waitcnt lgkmcnt(8)
 v_mfma_f32_16x16x32_bf16 a[0:3], v[16:19], a[128:131], a[0:3]
 ds_read_b64_tr_b16 v[40:41], v7 offset:4096
 v_mfma_f32_16x16x32_bf16 a[0:3], v[20:23], a[132:135], a[0:3]
 v_mfma_f32_16x16x32_bf16 a[4:7], v[20:23], a[140:143], a[4:7]
 ds_read_b64_tr_b16 v[42:43], v7 offset:4352
 v_mfma_f32_16x16x32_bf16 a[4:7], v[16:19], a[136:139], a[4:7]
 buffer_load_dwordx4 a[160:163], v8, s[84:87], s92 offen offset:0 sc1
 v_mfma_f32_16x16x32_bf16 a[8:11], v[16:19], a[144:147], a[8:11]
 ds_read_b64_tr_b16 v[44:45], v7 offset:6144
 v_mfma_f32_16x16x32_bf16 a[8:11], v[20:23], a[148:151], a[8:11]
 v_mfma_f32_16x16x32_bf16 a[12:15], v[20:23], a[156:159], a[12:15]
 ds_read_b64_tr_b16 v[46:47], v7 offset:6400
 v_mfma_f32_16x16x32_bf16 a[12:15], v[16:19], a[152:155], a[12:15]
 s_waitcnt lgkmcnt(8)
 v_mfma_f32_16x16x32_bf16 a[16:19], v[24:27], a[128:131], a[16:19]
 ds_read_b64_tr_b16 v[16:17], v6 offset:8192
 v_mfma_f32_16x16x32_bf16 a[16:19], v[28:31], a[132:135], a[16:19]
 v_mfma_f32_16x16x32_bf16 a[20:23], v[28:31], a[140:143], a[20:23]
 ds_read_b64_tr_b16 v[18:19], v6 offset:8448
 v_mfma_f32_16x16x32_bf16 a[20:23], v[24:27], a[136:139], a[20:23]
 buffer_load_dwordx4 a[164:167], v8, s[84:87], s92 offen offset:1024 sc1
 v_mfma_f32_16x16x32_bf16 a[24:27], v[24:27], a[144:147], a[24:27]
 ds_read_b64_tr_b16 v[20:21], v6 offset:10240
 v_mfma_f32_16x16x32_bf16 a[24:27], v[28:31], a[148:151], a[24:27]
 v_mfma_f32_16x16x32_bf16 a[28:31], v[28:31], a[156:159], a[28:31]
 ds_read_b64_tr_b16 v[22:23], v6 offset:10496
 v_mfma_f32_16x16x32_bf16 a[28:31], v[24:27], a[152:155], a[28:31]
 s_waitcnt lgkmcnt(8)
 v_mfma_f32_16x16x32_bf16 a[32:35], v[32:35], a[128:131], a[32:35]
 ds_read_b64_tr_b16 v[24:25], v7 offset:8192
 v_mfma_f32_16x16x32_bf16 a[32:35], v[36:39], a[132:135], a[32:35]
 v_mfma_f32_16x16x32_bf16 a[36:39], v[36:39], a[140:143], a[36:39]
 ds_read_b64_tr_b16 v[26:27], v7 offset:8448
 v_mfma_f32_16x16x32_bf16 a[36:39], v[32:35], a[136:139], a[36:39]
 buffer_load_dwordx4 a[168:171], v9, s[84:87], s92 offen offset:0 sc1
 v_mfma_f32_16x16x32_bf16 a[40:43], v[32:35], a[144:147], a[40:43]
 ds_read_b64_tr_b16 v[28:29], v7 offset:10240
 v_mfma_f32_16x16x32_bf16 a[40:43], v[36:39], a[148:151], a[40:43]
 v_mfma_f32_16x16x32_bf16 a[44:47], v[36:39], a[156:159], a[44:47]
 ds_read_b64_tr_b16 v[30:31], v7 offset:10496
 v_mfma_f32_16x16x32_bf16 a[44:47], v[32:35], a[152:155], a[44:47]
 s_waitcnt lgkmcnt(8)
 v_mfma_f32_16x16x32_bf16 a[48:51], v[40:43], a[128:131], a[48:51]
 ds_read_b64_tr_b16 v[32:33], v6 offset:12288
 v_mfma_f32_16x16x32_bf16 a[48:51], v[44:47], a[132:135], a[48:51]
 v_mfma_f32_16x16x32_bf16 a[52:55], v[44:47], a[140:143], a[52:55]
 ds_read_b64_tr_b16 v[34:35], v6 offset:12544
 v_mfma_f32_16x16x32_bf16 a[52:55], v[40:43], a[136:139], a[52:55]
 buffer_load_dwordx4 a[172:175], v9, s[84:87], s92 offen offset:1024 sc1
 v_mfma_f32_16x16x32_bf16 a[56:59], v[40:43], a[144:147], a[56:59]
 ds_read_b64_tr_b16 v[36:37], v6 offset:14336
 v_mfma_f32_16x16x32_bf16 a[56:59], v[44:47], a[148:151], a[56:59]
 v_mfma_f32_16x16x32_bf16 a[60:63], v[44:47], a[156:159], a[60:63]
 ds_read_b64_tr_b16 v[38:39], v6 offset:14592
 v_mfma_f32_16x16x32_bf16 a[60:63], v[40:43], a[152:155], a[60:63]
 s_waitcnt lgkmcnt(8)
 v_mfma_f32_16x16x32_bf16 a[64:67], v[16:19], a[128:131], a[64:67]
 ds_read_b64_tr_b16 v[40:41], v7 offset:12288
 v_mfma_f32_16x16x32_bf16 a[64:67], v[20:23], a[132:135], a[64:67]
 v_mfma_f32_16x16x32_bf16 a[68:71], v[20:23], a[140:143], a[68:71]
 ds_read_b64_tr_b16 v[42:43], v7 offset:12544
 v_mfma_f32_16x16x32_bf16 a[68:71], v[16:19], a[136:139], a[68:71]
 buffer_load_dwordx4 a[176:179], v10, s[84:87], s92 offen offset:0 sc1
 v_mfma_f32_16x16x32_bf16 a[72:75], v[16:19], a[144:147], a[72:75]
 ds_read_b64_tr_b16 v[44:45], v7 offset:14336
 v_mfma_f32_16x16x32_bf16 a[72:75], v[20:23], a[148:151], a[72:75]
 v_mfma_f32_16x16x32_bf16 a[76:79], v[20:23], a[156:159], a[76:79]
 ds_read_b64_tr_b16 v[46:47], v7 offset:14592
 v_mfma_f32_16x16x32_bf16 a[76:79], v[16:19], a[152:155], a[76:79]
 s_waitcnt lgkmcnt(8)
 v_mfma_f32_16x16x32_bf16 a[80:83], v[24:27], a[128:131], a[80:83]
 ds_read_b64_tr_b16 v[16:17], v6 offset:16384
 v_mfma_f32_16x16x32_bf16 a[80:83], v[28:31], a[132:135], a[80:83]
 v_mfma_f32_16x16x32_bf16 a[84:87], v[28:31], a[140:143], a[84:87]
 ds_read_b64_tr_b16 v[18:19], v6 offset:16640
 v_mfma_f32_16x16x32_bf16 a[84:87], v[24:27], a[136:139], a[84:87]
 buffer_load_dwordx4 a[180:183], v10, s[84:87], s92 offen offset:1024 sc1
 v_mfma_f32_16x16x32_bf16 a[88:91], v[24:27], a[144:147], a[88:91]
 ds_read_b64_tr_b16 v[20:21], v6 offset:18432
 v_mfma_f32_16x16x32_bf16 a[88:91], v[28:31], a[148:151], a[88:91]
 v_mfma_f32_16x16x32_bf16 a[92:95], v[28:31], a[156:159], a[92:95]
 ds_read_b64_tr_b16 v[22:23], v6 offset:18688
 v_mfma_f32_16x16x32_bf16 a[92:95], v[24:27], a[152:155], a[92:95]
 s_waitcnt lgkmcnt(8)
 v_mfma_f32_16x16x32_bf16 a[96:99], v[32:35], a[128:131], a[96:99]
 ds_read_b64_tr_b16 v[24:25], v7 offset:16384
 v_mfma_f32_16x16x32_bf16 a[96:99], v[36:39], a[132:135], a[96:99]
 v_mfma_f32_16x16x32_bf16 a[100:103], v[36:39], a[140:143], a[100:103]
 ds_read_b64_tr_b16 v[26:27], v7 offset:16640
 v_mfma_f32_16x16x32_bf16 a[100:103], v[32:35], a[136:139], a[100:103]
 buffer_load_dwordx4 a[184:187], v11, s[84:87], s92 offen offset:0 sc1
 v_mfma_f32_16x16x32_bf16 a[104:107], v[32:35], a[144:147], a[104:107]
 ds_read_b64_tr_b16 v[28:29], v7 offset:18432
 v_mfma_f32_16x16x32_bf16 a[104:107], v[36:39], a[148:151], a[104:107]
 v_mfma_f32_16x16x32_bf16 a[108:111], v[36:39], a[156:159], a[108:111]
 ds_read_b64_tr_b16 v[30:31], v7 offset:18688
 v_mfma_f32_16x16x32_bf16 a[108:111], v[32:35], a[152:155], a[108:111]
 s_waitcnt lgkmcnt(8)
 v_mfma_f32_16x16x32_bf16 a[112:115], v[40:43], a[128:131], a[112:115]
 ds_read_b64_tr_b16 v[32:33], v6 offset:20480
 v_mfma_f32_16x16x32_bf16 a[112:115], v[44:47], a[132:135], a[112:115]
 v_mfma_f32_16x16x32_bf16 a[116:119], v[44:47], a[140:143], a[116:119]
 ds_read_b64_tr_b16 v[34:35], v6 offset:20736
 v_mfma_f32_16x16x32_bf16 a[116:119], v[40:43], a[136:139], a[116:119]
 buffer_load_dwordx4 a[188:191], v11, s[84:87], s92 offen offset:1024 sc1
 v_mfma_f32_16x16x32_bf16 a[120:123], v[40:43], a[144:147], a[120:123]
 s_add_u32 s10, s10, 1
 ds_read_b64_tr_b16 v[36:37], v6 offset:22528
 v_mfma_f32_16x16x32_bf16 a[120:123], v[44:47], a[148:151], a[120:123]
 s_cmp_lt_u32 s10, 4
 v_mfma_f32_16x16x32_bf16 a[124:127], v[44:47], a[156:159], a[124:127]
 s_cselect_b32 s3, 1, 3
 ds_read_b64_tr_b16 v[38:39], v6 offset:22784
 v_mfma_f32_16x16x32_bf16 a[124:127], v[40:43], a[152:155], a[124:127]
 s_add_u32 s92, s10, s11
 s_waitcnt lgkmcnt(8)
 v_mfma_f32_16x16x32_bf16 v[64:67], v[16:19], a[128:131], v[64:67]
 ds_read_b64_tr_b16 v[40:41], v7 offset:20480
 v_mfma_f32_16x16x32_bf16 v[64:67], v[20:23], a[132:135], v[64:67]
 s_add_u32 m0, s94, 0
 v_mfma_f32_16x16x32_bf16 v[68:71], v[20:23], a[140:143], v[68:71]
 s_and_b32 s92, s92, s3
 ds_read_b64_tr_b16 v[42:43], v7 offset:20736
 v_mfma_f32_16x16x32_bf16 v[68:71], v[16:19], a[136:139], v[68:71]
 s_andn2_b32 s3, s10, s3
 buffer_load_dwordx4 v2, s[40:43], s88 offen lds
 s_add_u32 m0, s94, 8192
 v_mfma_f32_16x16x32_bf16 v[72:75], v[16:19], a[144:147], v[72:75]
 s_or_b32 s92, s92, s3
 ds_read_b64_tr_b16 v[44:45], v7 offset:22528
 v_mfma_f32_16x16x32_bf16 v[72:75], v[20:23], a[148:151], v[72:75]
 s_lshl_b32 s92, s92, 11
 buffer_load_dwordx4 v2, s[48:51], s88 offen lds
 v_mfma_f32_16x16x32_bf16 v[76:79], v[20:23], a[156:159], v[76:79]
 ds_read_b64_tr_b16 v[46:47], v7 offset:22784
 v_mfma_f32_16x16x32_bf16 v[76:79], v[16:19], a[152:155], v[76:79]
 s_waitcnt lgkmcnt(8)
 v_mfma_f32_16x16x32_bf16 v[80:83], v[24:27], a[128:131], v[80:83]
 ds_read_b64_tr_b16 v[16:17], v6 offset:24576
 v_mfma_f32_16x16x32_bf16 v[80:83], v[28:31], a[132:135], v[80:83]
 v_mfma_f32_16x16x32_bf16 v[84:87], v[28:31], a[140:143], v[84:87]
 ds_read_b64_tr_b16 v[18:19], v6 offset:24832
 v_mfma_f32_16x16x32_bf16 v[84:87], v[24:27], a[136:139], v[84:87]
 v_mfma_f32_16x16x32_bf16 v[88:91], v[24:27], a[144:147], v[88:91]
 ds_read_b64_tr_b16 v[20:21], v6 offset:26624
 v_mfma_f32_16x16x32_bf16 v[88:91], v[28:31], a[148:151], v[88:91]
 v_mfma_f32_16x16x32_bf16 v[92:95], v[28:31], a[156:159], v[92:95]
 ds_read_b64_tr_b16 v[22:23], v6 offset:26880
 v_mfma_f32_16x16x32_bf16 v[92:95], v[24:27], a[152:155], v[92:95]
 s_waitcnt lgkmcnt(8)
 v_mfma_f32_16x16x32_bf16 v[96:99], v[32:35], a[128:131], v[96:99]
 ds_read_b64_tr_b16 v[24:25], v7 offset:24576
 v_mfma_f32_16x16x32_bf16 v[96:99], v[36:39], a[132:135], v[96:99]
 s_add_u32 m0, s94, 4096
 v_mfma_f32_16x16x32_bf16 v[100:103], v[36:39], a[140:143], v[100:103]
 ds_read_b64_tr_b16 v[26:27], v7 offset:24832
 v_mfma_f32_16x16x32_bf16 v[100:103], v[32:35], a[136:139], v[100:103]
 buffer_load_dwordx4 v2, s[44:47], s88 offen lds
 s_add_u32 m0, s94, 12288
 v_mfma_f32_16x16x32_bf16 v[104:107], v[32:35], a[144:147], v[104:107]
 ds_read_b64_tr_b16 v[28:29], v7 offset:26624
 v_mfma_f32_16x16x32_bf16 v[104:107], v[36:39], a[148:151], v[104:107]
 buffer_load_dwordx4 v2, s[52:55], s88 offen lds
 v_mfma_f32_16x16x32_bf16 v[108:111], v[36:39], a[156:159], v[108:111]
 ds_read_b64_tr_b16 v[30:31], v7 offset:26880
 v_mfma_f32_16x16x32_bf16 v[108:111], v[32:35], a[152:155], v[108:111]
 s_waitcnt lgkmcnt(8)
 v_mfma_f32_16x16x32_bf16 v[112:115], v[40:43], a[128:131], v[112:115]
 ds_read_b64_tr_b16 v[32:33], v6 offset:28672
 v_mfma_f32_16x16x32_bf16 v[112:115], v[44:47], a[132:135], v[112:115]
 v_mfma_f32_16x16x32_bf16 v[116:119], v[44:47], a[140:143], v[116:119]
 ds_read_b64_tr_b16 v[34:35], v6 offset:28928
 v_mfma_f32_16x16x32_bf16 v[116:119], v[40:43], a[136:139], v[116:119]
 v_mfma_f32_16x16x32_bf16 v[120:123], v[40:43], a[144:147], v[120:123]
 ds_read_b64_tr_b16 v[36:37], v6 offset:30720
 v_mfma_f32_16x16x32_bf16 v[120:123], v[44:47], a[148:151], v[120:123]
 v_mfma_f32_16x16x32_bf16 v[124:127], v[44:47], a[156:159], v[124:127]
 ds_read_b64_tr_b16 v[38:39], v6 offset:30976
 v_mfma_f32_16x16x32_bf16 v[124:127], v[40:43], a[152:155], v[124:127]
 s_waitcnt lgkmcnt(8)
 v_mfma_f32_16x16x32_bf16 v[128:131], v[16:19], a[128:131], v[128:131]
 ds_read_b64_tr_b16 v[40:41], v7 offset:28672
 v_mfma_f32_16x16x32_bf16 v[128:131], v[20:23], a[132:135], v[128:131]
 s_add_u32 m0, s94, 16384
 v_mfma_f32_16x16x32_bf16 v[132:135], v[20:23], a[140:143], v[132:135]
 ds_read_b64_tr_b16 v[42:43], v7 offset:28928
 v_mfma_f32_16x16x32_bf16 v[132:135], v[16:19], a[136:139], v[132:135]
 buffer_load_dwordx4 v3, s[56:59], s89 offen lds
 s_add_u32 m0, s94, 24576
 v_mfma_f32_16x16x32_bf16 v[136:139], v[16:19], a[144:147], v[136:139]
 ds_read_b64_tr_b16 v[44:45], v7 offset:30720
 v_mfma_f32_16x16x32_bf16 v[136:139], v[20:23], a[148:151], v[136:139]
 buffer_load_dwordx4 v3, s[64:67], s89 offen lds
 v_mfma_f32_16x16x32_bf16 v[140:143], v[20:23], a[156:159], v[140:143]
 ds_read_b64_tr_b16 v[46:47], v7 offset:30976
 v_mfma_f32_16x16x32_bf16 v[140:143], v[16:19], a[152:155], v[140:143]
 s_waitcnt lgkmcnt(8)
 v_mfma_f32_16x16x32_bf16 v[144:147], v[24:27], a[128:131], v[144:147]
 ds_read_b64_tr_b16 v[16:17], v6 offset:32768
 v_mfma_f32_16x16x32_bf16 v[144:147], v[28:31], a[132:135], v[144:147]
 v_mfma_f32_16x16x32_bf16 v[148:151], v[28:31], a[140:143], v[148:151]
 ds_read_b64_tr_b16 v[18:19], v6 offset:33024
 v_mfma_f32_16x16x32_bf16 v[148:151], v[24:27], a[136:139], v[148:151]
 v_mfma_f32_16x16x32_bf16 v[152:155], v[24:27], a[144:147], v[152:155]
 ds_read_b64_tr_b16 v[20:21], v6 offset:34816
 v_mfma_f32_16x16x32_bf16 v[152:155], v[28:31], a[148:151], v[152:155]
 v_mfma_f32_16x16x32_bf16 v[156:159], v[28:31], a[156:159], v[156:159]
 ds_read_b64_tr_b16 v[22:23], v6 offset:35072
 v_mfma_f32_16x16x32_bf16 v[156:159], v[24:27], a[152:155], v[156:159]
 s_waitcnt lgkmcnt(8)
 v_mfma_f32_16x16x32_bf16 v[160:163], v[32:35], a[128:131], v[160:163]
 ds_read_b64_tr_b16 v[24:25], v7 offset:32768
 v_mfma_f32_16x16x32_bf16 v[160:163], v[36:39], a[132:135], v[160:163]
 s_add_u32 m0, s94, 20480
 v_mfma_f32_16x16x32_bf16 v[164:167], v[36:39], a[140:143], v[164:167]
 ds_read_b64_tr_b16 v[26:27], v7 offset:33024
 v_mfma_f32_16x16x32_bf16 v[164:167], v[32:35], a[136:139], v[164:167]
 buffer_load_dwordx4 v3, s[60:63], s89 offen lds
 s_add_u32 m0, s94, 28672
 v_mfma_f32_16x16x32_bf16 v[168:171], v[32:35], a[144:147], v[168:171]
 ds_read_b64_tr_b16 v[28:29], v7 offset:34816
 v_mfma_f32_16x16x32_bf16 v[168:171], v[36:39], a[148:151], v[168:171]
 buffer_load_dwordx4 v3, s[68:71], s89 offen lds
 v_mfma_f32_16x16x32_bf16 v[172:175], v[36:39], a[156:159], v[172:175]
 ds_read_b64_tr_b16 v[30:31], v7 offset:35072
 v_mfma_f32_16x16x32_bf16 v[172:175], v[32:35], a[152:155], v[172:175]
 s_waitcnt lgkmcnt(8)
 v_mfma_f32_16x16x32_bf16 v[176:179], v[40:43], a[128:131], v[176:179]
 ds_read_b64_tr_b16 v[32:33], v6 offset:36864
 v_mfma_f32_16x16x32_bf16 v[176:179], v[44:47], a[132:135], v[176:179]
 v_mfma_f32_16x16x32_bf16 v[180:183], v[44:47], a[140:143], v[180:183]
 ds_read_b64_tr_b16 v[34:35], v6 offset:37120
 v_mfma_f32_16x16x32_bf16 v[180:183], v[40:43], a[136:139], v[180:183]
 v_mfma_f32_16x16x32_bf16 v[184:187], v[40:43], a[144:147], v[184:187]
 ds_read_b64_tr_b16 v[36:37], v6 offset:38912
 v_mfma_f32_16x16x32_bf16 v[184:187], v[44:47], a[148:151], v[184:187]
 v_mfma_f32_16x16x32_bf16 v[188:191], v[44:47], a[156:159], v[188:191]
 ds_read_b64_tr_b16 v[38:39], v6 offset:39168
 v_mfma_f32_16x16x32_bf16 v[188:191], v[40:43], a[152:155], v[188:191]
 s_waitcnt lgkmcnt(8)
 v_mfma_f32_16x16x32_bf16 v[192:195], v[16:19], a[128:131], v[192:195]
 ds_read_b64_tr_b16 v[40:41], v7 offset:36864
 v_mfma_f32_16x16x32_bf16 v[192:195], v[20:23], a[132:135], v[192:195]
 s_add_u32 m0, s94, 32768
 v_mfma_f32_16x16x32_bf16 v[196:199], v[20:23], a[140:143], v[196:199]
 ds_read_b64_tr_b16 v[42:43], v7 offset:37120
 v_mfma_f32_16x16x32_bf16 v[196:199], v[16:19], a[136:139], v[196:199]
 buffer_load_dwordx4 v3, s[72:75], s89 offen lds
 s_add_u32 m0, s94, 36864
 v_mfma_f32_16x16x32_bf16 v[200:203], v[16:19], a[144:147], v[200:203]
 ds_read_b64_tr_b16 v[44:45], v7 offset:38912
 v_mfma_f32_16x16x32_bf16 v[200:203], v[20:23], a[148:151], v[200:203]
 buffer_load_dwordx4 v3, s[76:79], s89 offen lds
 v_mfma_f32_16x16x32_bf16 v[204:207], v[20:23], a[156:159], v[204:207]
 ds_read_b64_tr_b16 v[46:47], v7 offset:39168
 v_mfma_f32_16x16x32_bf16 v[204:207], v[16:19], a[152:155], v[204:207]
 s_waitcnt lgkmcnt(8)
 v_mfma_f32_16x16x32_bf16 v[208:211], v[24:27], a[128:131], v[208:211]
 v_mfma_f32_16x16x32_bf16 v[208:211], v[28:31], a[132:135], v[208:211]
 v_mfma_f32_16x16x32_bf16 v[212:215], v[28:31], a[140:143], v[212:215]
 v_mfma_f32_16x16x32_bf16 v[212:215], v[24:27], a[136:139], v[212:215]
 v_mfma_f32_16x16x32_bf16 v[216:219], v[24:27], a[144:147], v[216:219]
 s_add_u32 s93, s93, 40960
 v_mfma_f32_16x16x32_bf16 v[216:219], v[28:31], a[148:151], v[216:219]
 s_cmp_ge_u32 s93, 163840
 v_mfma_f32_16x16x32_bf16 v[220:223], v[28:31], a[156:159], v[220:223]
 s_cselect_b32 s93, 0, s93
 v_mfma_f32_16x16x32_bf16 v[220:223], v[24:27], a[152:155], v[220:223]
 s_waitcnt lgkmcnt(4)
 s_waitcnt vmcnt(10) lgkmcnt(0)
 s_barrier
 v_add_u32 v6, s93, v4
 v_add_u32 v7, s93, v5
 v_mfma_f32_16x16x32_bf16 v[224:227], v[32:35], a[128:131], v[224:227]
 s_add_u32 s9, s9, 1
 ds_read_b64_tr_b16 v[16:17], v6 offset:0
 v_mfma_f32_16x16x32_bf16 v[224:227], v[36:39], a[132:135], v[224:227]
 s_cmp_lt_u32 s9, 4
 ds_read_b64_tr_b16 v[18:19], v6 offset:256
 v_mfma_f32_16x16x32_bf16 v[228:231], v[36:39], a[140:143], v[228:231]
 s_cselect_b32 s3, 1, 3
 ds_read_b64_tr_b16 v[20:21], v6 offset:2048
 v_mfma_f32_16x16x32_bf16 v[228:231], v[32:35], a[136:139], v[228:231]
 s_add_u32 s100, s9, s11
 ds_read_b64_tr_b16 v[22:23], v6 offset:2304
 v_mfma_f32_16x16x32_bf16 v[232:235], v[32:35], a[144:147], v[232:235]
 s_and_b32 s100, s100, s3
 ds_read_b64_tr_b16 v[24:25], v7 offset:0
 v_mfma_f32_16x16x32_bf16 v[232:235], v[36:39], a[148:151], v[232:235]
 s_andn2_b32 s3, s9, s3
 ds_read_b64_tr_b16 v[26:27], v7 offset:256
 v_mfma_f32_16x16x32_bf16 v[236:239], v[36:39], a[156:159], v[236:239]
 s_or_b32 s100, s100, s3
 ds_read_b64_tr_b16 v[28:29], v7 offset:2048
 v_mfma_f32_16x16x32_bf16 v[236:239], v[32:35], a[152:155], v[236:239]
 s_waitcnt lgkmcnt(7)
 ds_read_b64_tr_b16 v[30:31], v7 offset:2304
 v_mfma_f32_16x16x32_bf16 v[240:243], v[40:43], a[128:131], v[240:243]
 s_mul_i32 s88, s100, s90
 ds_read_b64_tr_b16 v[32:33], v6 offset:4096
 v_mfma_f32_16x16x32_bf16 v[240:243], v[44:47], a[132:135], v[240:243]
 s_mul_i32 s89, s100, s91
 v_mfma_f32_16x16x32_bf16 v[244:247], v[44:47], a[140:143], v[244:247]
 s_add_u32 s94, s94, 40960
 ds_read_b64_tr_b16 v[34:35], v6 offset:4352
 v_mfma_f32_16x16x32_bf16 v[244:247], v[40:43], a[136:139], v[244:247]
 s_cmp_ge_u32 s94, s99
 v_mfma_f32_16x16x32_bf16 v[248:251], v[40:43], a[144:147], v[248:251]
 s_cselect_b32 s3, 163840, 0
 ds_read_b64_tr_b16 v[36:37], v6 offset:6144
 v_mfma_f32_16x16x32_bf16 v[248:251], v[44:47], a[148:151], v[248:251]
 s_sub_u32 s94, s94, s3
 v_mfma_f32_16x16x32_bf16 v[252:255], v[44:47], a[156:159], v[252:255]
 ds_read_b64_tr_b16 v[38:39], v6 offset:6400
 v_mfma_f32_16x16x32_bf16 v[252:255], v[40:43], a[152:155], v[252:255]
 s_branch L_g1_loopA
L_g1_outA:
 s_cmp_ge_u32 s97, 23
 s_cbranch_scc1 L_g1_Q
 s_cmp_eq_u32 s97, 22
 s_cbranch_scc1 L_g1_M
L_g1_H:
 s_waitcnt lgkmcnt(8)
 v_mfma_f32_16x16x32_bf16 a[0:3], v[16:19], a[128:131], a[0:3]
 ds_read_b64_tr_b16 v[40:41], v7 offset:4096
 v_mfma_f32_16x16x32_bf16 a[0:3], v[20:23], a[132:135], a[0:3]
 buffer_load_dwordx4 a[160:163], v8, s[84:87], s92 offen offset:0 sc1
 v_mfma_f32_16x16x32_bf16 a[4:7], v[20:23], a[140:143], a[4:7]
 v_add_u32 v60, 40960, v4
 v_add_u32 v61, 40960, v5
 ds_read_b64_tr_b16 v[42:43], v7 offset:4352
 v_mfma_f32_16x16x32_bf16 a[4:7], v[16:19], a[136:139], a[4:7]
 v_mfma_f32_16x16x32_bf16 a[8:11], v[16:19], a[144:147], a[8:11]
 ds_read_b64_tr_b16 v[44:45], v7 offset:6144
 v_mfma_f32_16x16x32_bf16 a[8:11], v[20:23], a[148:151], a[8:11]
 buffer_load_dwordx4 a[164:167], v8, s[84:87], s92 offen offset:1024 sc1
 v_mfma_f32_16x16x32_bf16 a[12:15], v[20:23], a[156:159], a[12:15]
 v_add_u32 v62, 81920, v4
 v_add_u32 v63, 81920, v5
 ds_read_b64_tr_b16 v[46:47], v7 offset:6400
 v_mfma_f32_16x16x32_bf16 a[12:15], v[16:19], a[152:155], a[12:15]
 s_waitcnt lgkmcnt(8)
 v_mfma_f32_16x16x32_bf16 a[16:19], v[24:27], a[128:131], a[16:19]
 ds_read_b64_tr_b16 v[16:17], v6 offset:8192
 v_mfma_f32_16x16x32_bf16 a[16:19], v[28:31], a[132:135], a[16:19]
 buffer_load_dwordx4 a[168:171], v9, s[84:87], s92 offen offset:0 sc1
 v_mfma_f32_16x16x32_bf16 a[20:23], v[28:31], a[140:143], a[20:23]
 v_add_u32 v4, 122880, v4
 v_add_u32 v5, 122880, v5
 ds_read_b64_tr_b16 v[18:19], v6 offset:8448
 v_mfma_f32_16x16x32_bf16 a[20:23], v[24:27], a[136:139], a[20:23]
 v_mfma_f32_16x16x32_bf16 a[24:27], v[24:27], a[144:147], a[24:27]
 ds_read_b64_tr_b16 v[20:21], v6 offset:10240
 v_mfma_f32_16x16x32_bf16 a[24:27], v[28:31], a[148:151], a[24:27]
 buffer_load_dwordx4 a[172:175], v9, s[84:87], s92 offen offset:1024 sc1
 v_mfma_f32_16x16x32_bf16 a[28:31], v[28:31], a[156:159], a[28:31]
 ds_read_b64_tr_b16 v[22:23], v6 offset:10496
 v_mfma_f32_16x16x32_bf16 a[28:31], v[24:27], a[152:155], a[28:31]
 s_waitcnt lgkmcnt(8)
 v_mfma_f32_16x16x32_bf16 a[32:35], v[32:35], a[128:131], a[32:35]
 ds_read_b64_tr_b16 v[24:25], v7 offset:8192
 v_mfma_f32_16x16x32_bf16 a[32:35], v[36:39], a[132:135], a[32:35]
 buffer_load_dwordx4 a[176:179], v10, s[84:87], s92 offen offset:0 sc1
 v_mfma_f32_16x16x32_bf16 a[36:39], v[36:39], a[140:143], a[36:39]
 ds_read_b64_tr_b16 v[26:27], v7 offset:8448
 v_mfma_f32_16x16x32_bf16 a[36:39], v[32:35], a[136:139], a[36:39]
 v_mfma_f32_16x16x32_bf16 a[40:43], v[32:35], a[144:147], a[40:43]
 ds_read_b64_tr_b16 v[28:29], v7 offset:10240
 v_mfma_f32_16x16x32_bf16 a[40:43], v[36:39], a[148:151], a[40:43]
 buffer_load_dwordx4 a[180:183], v10, s[84:87], s92 offen offset:1024 sc1
 v_mfma_f32_16x16x32_bf16 a[44:47], v[36:39], a[156:159], a[44:47]
 ds_read_b64_tr_b16 v[30:31], v7 offset:10496
 v_mfma_f32_16x16x32_bf16 a[44:47], v[32:35], a[152:155], a[44:47]
 s_waitcnt lgkmcnt(8)
 v_mfma_f32_16x16x32_bf16 a[48:51], v[40:43], a[128:131], a[48:51]
 ds_read_b64_tr_b16 v[32:33], v6 offset:12288
 v_mfma_f32_16x16x32_bf16 a[48:51], v[44:47], a[132:135], a[48:51]
 buffer_load_dwordx4 a[184:187], v11, s[84:87], s92 offen offset:0 sc1
 v_mfma_f32_16x16x32_bf16 a[52:55], v[44:47], a[140:143], a[52:55]
 ds_read_b64_tr_b16 v[34:35], v6 offset:12544
 v_mfma_f32_16x16x32_bf16 a[52:55], v[40:43], a[136:139], a[52:55]
 v_mfma_f32_16x16x32_bf16 a[56:59], v[40:43], a[144:147], a[56:59]
 ds_read_b64_tr_b16 v[36:37], v6 offset:14336
 v_mfma_f32_16x16x32_bf16 a[56:59], v[44:47], a[148:151], a[56:59]
 buffer_load_dwordx4 a[188:191], v11, s[84:87], s92 offen offset:1024 sc1
 s_add_u32 s10, s10, 1
 s_cmp_lt_u32 s10, 4
 s_cselect_b32 s3, 1, 3
 s_add_u32 s92, s10, s11
 s_and_b32 s92, s92, s3
 s_andn2_b32 s3, s10, s3
 s_or_b32 s92, s92, s3
 s_lshl_b32 s92, s92, 11
 v_mfma_f32_16x16x32_bf16 a[60:63], v[44:47], a[156:159], a[60:63]
 ds_read_b64_tr_b16 v[38:39], v6 offset:14592
 v_mfma_f32_16x16x32_bf16 a[60:63], v[40:43], a[152:155], a[60:63]
 s_waitcnt lgkmcnt(8)
 v_mfma_f32_16x16x32_bf16 a[64:67], v[16:19], a[128:131], a[64:67]
 ds_read_b64_tr_b16 v[40:41], v7 offset:12288
 v_mfma_f32_16x16x32_bf16 a[64:67], v[20:23], a[132:135], a[64:67]
 buffer_load_dwordx4 a[192:195], v8, s[84:87], s92 offen offset:0 sc1
 v_mfma_f32_16x16x32_bf16 a[68:71], v[20:23], a[140:143], a[68:71]
 ds_read_b64_tr_b16 v[42:43], v7 offset:12544
 v_mfma_f32_16x16x32_bf16 a[68:71], v[16:19], a[136:139], a[68:71]
 v_mfma_f32_16x16x32_bf16 a[72:75], v[16:19], a[144:147], a[72:75]
 ds_read_b64_tr_b16 v[44:45], v7 offset:14336
 v_mfma_f32_16x16x32_bf16 a[72:75], v[20:23], a[148:151], a[72:75]
 buffer_load_dwordx4 a[196:199], v8, s[84:87], s92 offen offset:1024 sc1
 v_mfma_f32_16x16x32_bf16 a[76:79], v[20:23], a[156:159], a[76:79]
 ds_read_b64_tr_b16 v[46:47], v7 offset:14592
 v_mfma_f32_16x16x32_bf16 a[76:79], v[16:19], a[152:155], a[76:79]
 s_waitcnt lgkmcnt(8)
 v_mfma_f32_16x16x32_bf16 a[80:83], v[24:27], a[128:131], a[80:83]
 ds_read_b64_tr_b16 v[16:17], v60 offset:0
 v_mfma_f32_16x16x32_bf16 a[80:83], v[28:31], a[132:135], a[80:83]
 buffer_load_dwordx4 a[200:203], v9, s[84:87], s92 offen offset:0 sc1
 v_mfma_f32_16x16x32_bf16 a[84:87], v[28:31], a[140:143], a[84:87]
 ds_read_b64_tr_b16 v[18:19], v60 offset:256
 v_mfma_f32_16x16x32_bf16 a[84:87], v[24:27], a[136:139], a[84:87]
 v_mfma_f32_16x16x32_bf16 a[88:91], v[24:27], a[144:147], a[88:91]
 ds_read_b64_tr_b16 v[20:21], v60 offset:2048
 v_mfma_f32_16x16x32_bf16 a[88:91], v[28:31], a[148:151], a[88:91]
 buffer_load_dwordx4 a[204:207], v9, s[84:87], s92 offen offset:1024 sc1
 v_mfma_f32_16x16x32_bf16 a[92:95], v[28:31], a[156:159], a[92:95]
 ds_read_b64_tr_b16 v[22:23], v60 offset:2304
 v_mfma_f32_16x16x32_bf16 a[92:95], v[24:27], a[152:155], a[92:95]
 s_waitcnt lgkmcnt(8)
 v_mfma_f32_16x16x32_bf16 a[96:99], v[32:35], a[128:131], a[96:99]
 ds_read_b64_tr_b16 v[24:25], v61 offset:0
 v_mfma_f32_16x16x32_bf16 a[96:99], v[36:39], a[132:135], a[96:99]
 buffer_load_dwordx4 a[208:211], v10, s[84:87], s92 offen offset:0 sc1
 v_mfma_f32_16x16x32_bf16 a[100:103], v[36:39], a[140:143], a[100:103]
 ds_read_b64_tr_b16 v[26:27], v61 offset:256
 v_mfma_f32_16x16x32_bf16 a[100:103], v[32:35], a[136:139], a[100:103]
 v_mfma_f32_16x16x32_bf16 a[104:107], v[32:35], a[144:147], a[104:107]
 ds_read_b64_tr_b16 v[28:29], v61 offset:2048
 v_mfma_f32_16x16x32_bf16 a[104:107], v[36:39], a[148:151], a[104:107]
 buffer_load_dwordx4 a[212:215], v10, s[84:87], s92 offen offset:1024 sc1
 v_mfma_f32_16x16x32_bf16 a[108:111], v[36:39], a[156:159], a[108:111]
 ds_read_b64_tr_b16 v[30:31], v61 offset:2304
 v_mfma_f32_16x16x32_bf16 a[108:111], v[32:35], a[152:155], a[108:111]
 s_waitcnt lgkmcnt(8)
 v_mfma_f32_16x16x32_bf16 a[112:115], v[40:43], a[128:131], a[112:115]
 ds_read_b64_tr_b16 v[32:33], v60 offset:4096
 v_mfma_f32_16x16x32_bf16 a[112:115], v[44:47], a[132:135], a[112:115]
 buffer_load_dwordx4 a[216:219], v11, s[84:87], s92 offen offset:0 sc1
 v_mfma_f32_16x16x32_bf16 a[116:119], v[44:47], a[140:143], a[116:119]
 ds_read_b64_tr_b16 v[34:35], v60 offset:4352
 v_mfma_f32_16x16x32_bf16 a[116:119], v[40:43], a[136:139], a[116:119]
 v_mfma_f32_16x16x32_bf16 a[120:123], v[40:43], a[144:147], a[120:123]
 ds_read_b64_tr_b16 v[36:37], v60 offset:6144
 v_mfma_f32_16x16x32_bf16 a[120:123], v[44:47], a[148:151], a[120:123]
 buffer_load_dwordx4 a[220:223], v11, s[84:87], s92 offen offset:1024 sc1
 s_add_u32 s10, s10, 1
 s_cmp_lt_u32 s10, 4
 s_cselect_b32 s3, 1, 3
 s_add_u32 s92, s10, s11
 s_and_b32 s92, s92, s3
 s_andn2_b32 s3, s10, s3
 s_or_b32 s92, s92, s3
 s_lshl_b32 s92, s92, 11
 v_mfma_f32_16x16x32_bf16 a[124:127], v[44:47], a[156:159], a[124:127]
 ds_read_b64_tr_b16 v[38:39], v60 offset:6400
 v_mfma_f32_16x16x32_bf16 a[124:127], v[40:43], a[152:155], a[124:127]
 s_waitcnt vmcnt(8) lgkmcnt(8)
 v_mfma_f32_16x16x32_bf16 a[0:3], v[16:19], a[160:163], a[0:3]
 ds_read_b64_tr_b16 v[40:41], v61 offset:4096
 v_mfma_f32_16x16x32_bf16 a[0:3], v[20:23], a[164:167], a[0:3]
 s_add_u32 m0, s94, 0
 s_nop 0
 buffer_load_dwordx4 v2, s[40:43], s88 offen lds
 v_mfma_f32_16x16x32_bf16 a[4:7], v[20:23], a[172:175], a[4:7]
 ds_read_b64_tr_b16 v[42:43], v61 offset:4352
 v_mfma_f32_16x16x32_bf16 a[4:7], v[16:19], a[168:171], a[4:7]
 v_mfma_f32_16x16x32_bf16 a[8:11], v[16:19], a[176:179], a[8:11]
 ds_read_b64_tr_b16 v[44:45], v61 offset:6144
 v_mfma_f32_16x16x32_bf16 a[8:11], v[20:23], a[180:183], a[8:11]
 s_add_u32 m0, s94, 8192
 s_nop 0
 buffer_load_dwordx4 v2, s[48:51], s88 offen lds
 v_mfma_f32_16x16x32_bf16 a[12:15], v[20:23], a[188:191], a[12:15]
 s_mov_b32 s100, 0x3f317218
 ds_read_b64_tr_b16 v[46:47], v61 offset:6400
 v_mfma_f32_16x16x32_bf16 a[12:15], v[16:19], a[184:187], a[12:15]
 s_waitcnt lgkmcnt(8)
 v_mfma_f32_16x16x32_bf16 a[16:19], v[24:27], a[160:163], a[16:19]
 ds_read_b64_tr_b16 v[16:17], v60 offset:8192
 v_mfma_f32_16x16x32_bf16 a[16:19], v[28:31], a[164:167], a[16:19]
 s_add_u32 m0, s94, 4096
 s_nop 0
 buffer_load_dwordx4 v2, s[44:47], s88 offen lds
 v_mfma_f32_16x16x32_bf16 a[20:23], v[28:31], a[172:175], a[20:23]
 ds_read_b64_tr_b16 v[18:19], v60 offset:8448
 v_mfma_f32_16x16x32_bf16 a[20:23], v[24:27], a[168:171], a[20:23]
 v_mfma_f32_16x16x32_bf16 a[24:27], v[24:27], a[176:179], a[24:27]
 ds_read_b64_tr_b16 v[20:21], v60 offset:10240
 v_mfma_f32_16x16x32_bf16 a[24:27], v[28:31], a[180:183], a[24:27]
 s_add_u32 m0, s94, 12288
 s_nop 0
 buffer_load_dwordx4 v2, s[52:55], s88 offen lds
 v_mfma_f32_16x16x32_bf16 a[28:31], v[28:31], a[188:191], a[28:31]
 ds_read_b64_tr_b16 v[22:23], v60 offset:10496
 v_mfma_f32_16x16x32_bf16 a[28:31], v[24:27], a[184:187], a[28:31]
 s_waitcnt lgkmcnt(8)
 v_mfma_f32_16x16x32_bf16 a[32:35], v[32:35], a[160:163], a[32:35]
 ds_read_b64_tr_b16 v[24:25], v61 offset:8192
 v_mfma_f32_16x16x32_bf16 a[32:35], v[36:39], a[164:167], a[32:35]
 s_add_u32 m0, s94, 16384
 s_nop 0
 buffer_load_dwordx4 v3, s[56:59], s89 offen lds
 v_mfma_f32_16x16x32_bf16 a[36:39], v[36:39], a[172:175], a[36:39]
 ds_read_b64_tr_b16 v[26:27], v61 offset:8448
 v_mfma_f32_16x16x32_bf16 a[36:39], v[32:35], a[168:171], a[36:39]
 v_mfma_f32_16x16x32_bf16 a[40:43], v[32:35], a[176:179], a[40:43]
 ds_read_b64_tr_b16 v[28:29], v61 offset:10240
 v_mfma_f32_16x16x32_bf16 a[40:43], v[36:39], a[180:183], a[40:43]
 s_add_u32 m0, s94, 24576
 s_nop 0
 buffer_load_dwordx4 v3, s[64:67], s89 offen lds
 v_mfma_f32_16x16x32_bf16 a[44:47], v[36:39], a[188:191], a[44:47]
 ds_read_b64_tr_b16 v[30:31], v61 offset:10496
 v_mfma_f32_16x16x32_bf16 a[44:47], v[32:35], a[184:187], a[44:47]
 s_waitcnt lgkmcnt(8)
 v_mfma_f32_16x16x32_bf16 a[48:51], v[40:43], a[160:163], a[48:51]
 ds_read_b64_tr_b16 v[32:33], v60 offset:12288
 v_mfma_f32_16x16x32_bf16 a[48:51], v[44:47], a[164:167], a[48:51]
 s_add_u32 m0, s94, 20480
 s_nop 0
 buffer_load_dwordx4 v3, s[60:63], s89 offen lds
 v_mfma_f32_16x16x32_bf16 a[52:55], v[44:47], a[172:175], a[52:55]
 ds_read_b64_tr_b16 v[34:35], v60 offset:12544
 v_mfma_f32_16x16x32_bf16 a[52:55], v[40:43], a[168:171], a[52:55]
 v_mfma_f32_16x16x32_bf16 a[56:59], v[40:43], a[176:179], a[56:59]
 ds_read_b64_tr_b16 v[36:37], v60 offset:14336
 v_mfma_f32_16x16x32_bf16 a[56:59], v[44:47], a[180:183], a[56:59]
 s_add_u32 m0, s94, 28672
 s_nop 0
 buffer_load_dwordx4 v3, s[68:71], s89 offen lds
 v_mfma_f32_16x16x32_bf16 a[60:63], v[44:47], a[188:191], a[60:63]
 ds_read_b64_tr_b16 v[38:39], v60 offset:14592
 v_mfma_f32_16x16x32_bf16 a[60:63], v[40:43], a[184:187], a[60:63]
 s_waitcnt lgkmcnt(8)
 v_mfma_f32_16x16x32_bf16 a[64:67], v[16:19], a[160:163], a[64:67]
 ds_read_b64_tr_b16 v[40:41], v61 offset:12288
 v_mfma_f32_16x16x32_bf16 a[64:67], v[20:23], a[164:167], a[64:67]
 s_add_u32 m0, s94, 32768
 s_nop 0
 buffer_load_dwordx4 v3, s[72:75], s89 offen lds
 v_mfma_f32_16x16x32_bf16 a[68:71], v[20:23], a[172:175], a[68:71]
 ds_read_b64_tr_b16 v[42:43], v61 offset:12544
 v_mfma_f32_16x16x32_bf16 a[68:71], v[16:19], a[168:171], a[68:71]
 v_mfma_f32_16x16x32_bf16 a[72:75], v[16:19], a[176:179], a[72:75]
 ds_read_b64_tr_b16 v[44:45], v61 offset:14336
 v_mfma_f32_16x16x32_bf16 a[72:75], v[20:23], a[180:183], a[72:75]
 s_add_u32 m0, s94, 36864
 s_nop 0
 buffer_load_dwordx4 v3, s[76:79], s89 offen lds
 v_mfma_f32_16x16x32_bf16 a[76:79], v[20:23], a[188:191], a[76:79]
 ds_read_b64_tr_b16 v[46:47], v61 offset:14592
 v_mfma_f32_16x16x32_bf16 a[76:79], v[16:19], a[184:187], a[76:79]
 s_waitcnt lgkmcnt(8)
 s_waitcnt vmcnt(26)
 s_barrier
 v_mfma_f32_16x16x32_bf16 a[80:83], v[24:27], a[160:163], a[80:83]
 ds_read_b64_tr_b16 v[16:17], v62 offset:0
 v_mfma_f32_16x16x32_bf16 a[80:83], v[28:31], a[164:167], a[80:83]
 buffer_load_dwordx4 a[224:227], v8, s[84:87], s92 offen offset:0 sc1
 v_mfma_f32_16x16x32_bf16 a[84:87], v[28:31], a[172:175], a[84:87]
 ds_read_b64_tr_b16 v[18:19], v62 offset:256
 v_mfma_f32_16x16x32_bf16 a[84:87], v[24:27], a[168:171], a[84:87]
 v_mfma_f32_16x16x32_bf16 a[88:91], v[24:27], a[176:179], a[88:91]
 ds_read_b64_tr_b16 v[20:21], v62 offset:2048
 v_mfma_f32_16x16x32_bf16 a[88:91], v[28:31], a[180:183], a[88:91]
 buffer_load_dwordx4 a[228:231], v8, s[84:87], s92 offen offset:1024 sc1
 v_mfma_f32_16x16x32_bf16 a[92:95], v[28:31], a[188:191], a[92:95]
 ds_read_b64_tr_b16 v[22:23], v62 offset:2304
 v_mfma_f32_16x16x32_bf16 a[92:95], v[24:27], a[184:187], a[92:95]
 s_waitcnt lgkmcnt(8)
 v_mfma_f32_16x16x32_bf16 a[96:99], v[32:35], a[160:163], a[96:99]
 ds_read_b64_tr_b16 v[24:25], v63 offset:0
 v_mfma_f32_16x16x32_bf16 a[96:99], v[36:39], a[164:167], a[96:99]
 buffer_load_dwordx4 a[232:235], v9, s[84:87], s92 offen offset:0 sc1
 v_mfma_f32_16x16x32_bf16 a[100:103], v[36:39], a[172:175], a[100:103]
 ds_read_b64_tr_b16 v[26:27], v63 offset:256
 v_mfma_f32_16x16x32_bf16 a[100:103], v[32:35], a[168:171], a[100:103]
 v_mfma_f32_16x16x32_bf16 a[104:107], v[32:35], a[176:179], a[104:107]
 ds_read_b64_tr_b16 v[28:29], v63 offset:2048
 v_mfma_f32_16x16x32_bf16 a[104:107], v[36:39], a[180:183], a[104:107]
 buffer_load_dwordx4 a[236:239], v9, s[84:87], s92 offen offset:1024 sc1
 v_mfma_f32_16x16x32_bf16 a[108:111], v[36:39], a[188:191], a[108:111]
 ds_read_b64_tr_b16 v[30:31], v63 offset:2304
 v_mfma_f32_16x16x32_bf16 a[108:111], v[32:35], a[184:187], a[108:111]
 s_waitcnt lgkmcnt(8)
 v_mfma_f32_16x16x32_bf16 a[112:115], v[40:43], a[160:163], a[112:115]
 ds_read_b64_tr_b16 v[32:33], v62 offset:4096
 v_mfma_f32_16x16x32_bf16 a[112:115], v[44:47], a[164:167], a[112:115]
 buffer_load_dwordx4 a[240:243], v10, s[84:87], s92 offen offset:0 sc1
 v_mfma_f32_16x16x32_bf16 a[116:119], v[44:47], a[172:175], a[116:119]
 ds_read_b64_tr_b16 v[34:35], v62 offset:4352
 v_mfma_f32_16x16x32_bf16 a[116:119], v[40:43], a[168:171], a[116:119]
 v_mfma_f32_16x16x32_bf16 a[120:123], v[40:43], a[176:179], a[120:123]
 ds_read_b64_tr_b16 v[36:37], v62 offset:6144
 v_mfma_f32_16x16x32_bf16 a[120:123], v[44:47], a[180:183], a[120:123]
 buffer_load_dwordx4 a[244:247], v10, s[84:87], s92 offen offset:1024 sc1
 v_mfma_f32_16x16x32_bf16 a[124:127], v[44:47], a[188:191], a[124:127]
 ds_read_b64_tr_b16 v[38:39], v62 offset:6400
 v_mfma_f32_16x16x32_bf16 a[124:127], v[40:43], a[184:187], a[124:127]
 s_waitcnt vmcnt(16) lgkmcnt(8)
 v_mfma_f32_16x16x32_bf16 a[0:3], v[16:19], a[192:195], a[0:3]
 ds_read_b64_tr_b16 v[40:41], v63 offset:4096
 v_mfma_f32_16x16x32_bf16 a[0:3], v[20:23], a[196:199], a[0:3]
 buffer_load_dwordx4 a[248:251], v11, s[84:87], s92 offen offset:0 sc1
 v_mfma_f32_16x16x32_bf16 a[4:7], v[20:23], a[204:207], a[4:7]
 ds_read_b64_tr_b16 v[42:43], v63 offset:4352
 v_mfma_f32_16x16x32_bf16 a[4:7], v[16:19], a[200:203], a[4:7]
 v_mfma_f32_16x16x32_bf16 a[8:11], v[16:19], a[208:211], a[8:11]
 ds_read_b64_tr_b16 v[44:45], v63 offset:6144
 v_mfma_f32_16x16x32_bf16 a[8:11], v[20:23], a[212:215], a[8:11]
 buffer_load_dwordx4 a[252:255], v11, s[84:87], s92 offen offset:1024 sc1
 v_mfma_f32_16x16x32_bf16 a[12:15], v[20:23], a[220:223], a[12:15]
 ds_read_b64_tr_b16 v[46:47], v63 offset:6400
 v_mfma_f32_16x16x32_bf16 a[12:15], v[16:19], a[216:219], a[12:15]
 s_waitcnt lgkmcnt(8)
 v_mfma_f32_16x16x32_bf16 a[16:19], v[24:27], a[192:195], a[16:19]
 ds_read_b64_tr_b16 v[16:17], v62 offset:8192
 v_mfma_f32_16x16x32_bf16 a[16:19], v[28:31], a[196:199], a[16:19]
 v_mov_b32 v8, v60
 v_mov_b32 v9, v61
 v_mov_b32 v10, v62
 v_mov_b32 v11, v63
 v_mfma_f32_16x16x32_bf16 a[20:23], v[28:31], a[204:207], a[20:23]
 ds_read_b64_tr_b16 v[18:19], v62 offset:8448
 v_mfma_f32_16x16x32_bf16 a[20:23], v[24:27], a[200:203], a[20:23]
 v_mfma_f32_16x16x32_bf16 a[24:27], v[24:27], a[208:211], a[24:27]
 ds_read_b64_tr_b16 v[20:21], v62 offset:10240
 v_mfma_f32_16x16x32_bf16 a[24:27], v[28:31], a[212:215], a[24:27]
 v_mfma_f32_16x16x32_bf16 a[28:31], v[28:31], a[220:223], a[28:31]
 ds_read_b64_tr_b16 v[22:23], v62 offset:10496
 v_mfma_f32_16x16x32_bf16 a[28:31], v[24:27], a[216:219], a[28:31]
 s_waitcnt lgkmcnt(8)
 v_mfma_f32_16x16x32_bf16 a[32:35], v[32:35], a[192:195], a[32:35]
 ds_read_b64_tr_b16 v[24:25], v11 offset:8192
 v_mfma_f32_16x16x32_bf16 a[32:35], v[36:39], a[196:199], a[32:35]
 v_mfma_f32_16x16x32_bf16 a[36:39], v[36:39], a[204:207], a[36:39]
 ds_read_b64_tr_b16 v[26:27], v11 offset:8448
 v_mfma_f32_16x16x32_bf16 a[36:39], v[32:35], a[200:203], a[36:39]
 v_mfma_f32_16x16x32_bf16 a[40:43], v[32:35], a[208:211], a[40:43]
 ds_read_b64_tr_b16 v[28:29], v11 offset:10240
 v_mfma_f32_16x16x32_bf16 a[40:43], v[36:39], a[212:215], a[40:43]
 v_mfma_f32_16x16x32_bf16 a[44:47], v[36:39], a[220:223], a[44:47]
 ds_read_b64_tr_b16 v[30:31], v11 offset:10496
 v_mfma_f32_16x16x32_bf16 a[44:47], v[32:35], a[216:219], a[44:47]
 s_waitcnt lgkmcnt(8)
 v_mfma_f32_16x16x32_bf16 a[48:51], v[40:43], a[192:195], a[48:51]
 ds_read_b64_tr_b16 v[32:33], v10 offset:12288
 v_mfma_f32_16x16x32_bf16 a[48:51], v[44:47], a[196:199], a[48:51]
 v_mfma_f32_16x16x32_bf16 a[52:55], v[44:47], a[204:207], a[52:55]
 ds_read_b64_tr_b16 v[34:35], v10 offset:12544
 v_mfma_f32_16x16x32_bf16 a[52:55], v[40:43], a[200:203], a[52:55]
 v_mfma_f32_16x16x32_bf16 a[56:59], v[40:43], a[208:211], a[56:59]
 ds_read_b64_tr_b16 v[36:37], v10 offset:14336
 v_mfma_f32_16x16x32_bf16 a[56:59], v[44:47], a[212:215], a[56:59]
 v_mfma_f32_16x16x32_bf16 a[60:63], v[44:47], a[220:223], a[60:63]
 ds_read_b64_tr_b16 v[38:39], v10 offset:14592
 v_mfma_f32_16x16x32_bf16 a[60:63], v[40:43], a[216:219], a[60:63]
 s_waitcnt lgkmcnt(8)
 v_mfma_f32_16x16x32_bf16 a[64:67], v[16:19], a[192:195], a[64:67]
 ds_read_b64_tr_b16 v[40:41], v11 offset:12288
 v_mfma_f32_16x16x32_bf16 a[64:67], v[20:23], a[196:199], a[64:67]
 v_mfma_f32_16x16x32_bf16 a[68:71], v[20:23], a[204:207], a[68:71]
 ds_read_b64_tr_b16 v[42:43], v11 offset:12544
 v_mfma_f32_16x16x32_bf16 a[68:71], v[16:19], a[200:203], a[68:71]
 v_mfma_f32_16x16x32_bf16 a[72:75], v[16:19], a[208:211], a[72:75]
 ds_read_b64_tr_b16 v[44:45], v11 offset:14336
 v_mfma_f32_16x16x32_bf16 a[72:75], v[20:23], a[212:215], a[72:75]
 v_mfma_f32_16x16x32_bf16 a[76:79], v[20:23], a[220:223], a[76:79]
 ds_read_b64_tr_b16 v[46:47], v11 offset:14592
 v_mfma_f32_16x16x32_bf16 a[76:79], v[16:19], a[216:219], a[76:79]
 s_waitcnt lgkmcnt(8)
 s_waitcnt vmcnt(8)
 s_barrier
 v_mfma_f32_16x16x32_bf16 a[80:83], v[24:27], a[192:195], a[80:83]
 ds_read_b64_tr_b16 v[16:17], v4 offset:0
 v_mfma_f32_16x16x32_bf16 a[80:83], v[28:31], a[196:199], a[80:83]
 v_mfma_f32_16x16x32_bf16 a[84:87], v[28:31], a[204:207], a[84:87]
 ds_read_b64_tr_b16 v[18:19], v4 offset:256
 v_mfma_f32_16x16x32_bf16 a[84:87], v[24:27], a[200:203], a[84:87]
 v_mfma_f32_16x16x32_bf16 a[88:91], v[24:27], a[208:211], a[88:91]
 ds_read_b64_tr_b16 v[20:21], v4 offset:2048
 v_mfma_f32_16x16x32_bf16 a[88:91], v[28:31], a[212:215], a[88:91]
 v_mfma_f32_16x16x32_bf16 a[92:95], v[28:31], a[220:223], a[92:95]
 ds_read_b64_tr_b16 v[22:23], v4 offset:2304
 v_mfma_f32_16x16x32_bf16 a[92:95], v[24:27], a[216:219], a[92:95]
 s_waitcnt lgkmcnt(8)
 v_mfma_f32_16x16x32_bf16 a[96:99], v[32:35], a[192:195], a[96:99]
 ds_read_b64_tr_b16 v[24:25], v5 offset:0
 v_mfma_f32_16x16x32_bf16 a[96:99], v[36:39], a[196:199], a[96:99]
 v_mfma_f32_16x16x32_bf16 a[100:103], v[36:39], a[204:207], a[100:103]
 ds_read_b64_tr_b16 v[26:27], v5 offset:256
 v_mfma_f32_16x16x32_bf16 a[100:103], v[32:35], a[200:203], a[100:103]
 v_mfma_f32_16x16x32_bf16 a[104:107], v[32:35], a[208:211], a[104:107]
 ds_read_b64_tr_b16 v[28:29], v5 offset:2048
 v_mfma_f32_16x16x32_bf16 a[104:107], v[36:39], a[212:215], a[104:107]
 v_mfma_f32_16x16x32_bf16 a[108:111], v[36:39], a[220:223], a[108:111]
 ds_read_b64_tr_b16 v[30:31], v5 offset:2304
 v_mfma_f32_16x16x32_bf16 a[108:111], v[32:35], a[216:219], a[108:111]
 s_waitcnt lgkmcnt(8)
 v_mfma_f32_16x16x32_bf16 a[112:115], v[40:43], a[192:195], a[112:115]
 ds_read_b64_tr_b16 v[32:33], v4 offset:4096
 v_mfma_f32_16x16x32_bf16 a[112:115], v[44:47], a[196:199], a[112:115]
 v_mfma_f32_16x16x32_bf16 a[116:119], v[44:47], a[204:207], a[116:119]
 ds_read_b64_tr_b16 v[34:35], v4 offset:4352
 v_mfma_f32_16x16x32_bf16 a[116:119], v[40:43], a[200:203], a[116:119]
 v_mfma_f32_16x16x32_bf16 a[120:123], v[40:43], a[208:211], a[120:123]
 ds_read_b64_tr_b16 v[36:37], v4 offset:6144
 v_mfma_f32_16x16x32_bf16 a[120:123], v[44:47], a[212:215], a[120:123]
 v_mfma_f32_16x16x32_bf16 a[124:127], v[44:47], a[220:223], a[124:127]
 ds_read_b64_tr_b16 v[38:39], v4 offset:6400
 v_mfma_f32_16x16x32_bf16 a[124:127], v[40:43], a[216:219], a[124:127]
 s_waitcnt vmcnt(0) lgkmcnt(8)
 v_mfma_f32_16x16x32_bf16 a[0:3], v[16:19], a[224:227], a[0:3]
 ds_read_b64_tr_b16 v[40:41], v5 offset:4096
 v_mfma_f32_16x16x32_bf16 a[0:3], v[20:23], a[228:231], a[0:3]
 v_mfma_f32_16x16x32_bf16 a[4:7], v[20:23], a[236:239], a[4:7]
 ds_read_b64_tr_b16 v[42:43], v5 offset:4352
 v_mfma_f32_16x16x32_bf16 a[4:7], v[16:19], a[232:235], a[4:7]
 v_mfma_f32_16x16x32_bf16 a[8:11], v[16:19], a[240:243], a[8:11]
 ds_read_b64_tr_b16 v[44:45], v5 offset:6144
 v_mfma_f32_16x16x32_bf16 a[8:11], v[20:23], a[244:247], a[8:11]
 v_mfma_f32_16x16x32_bf16 a[12:15], v[20:23], a[252:255], a[12:15]
 ds_read_b64_tr_b16 v[46:47], v5 offset:6400
 v_mfma_f32_16x16x32_bf16 a[12:15], v[16:19], a[248:251], a[12:15]
 s_waitcnt lgkmcnt(8)
 v_mfma_f32_16x16x32_bf16 a[16:19], v[24:27], a[224:227], a[16:19]
 ds_read_b64_tr_b16 v[16:17], v4 offset:8192
 v_mfma_f32_16x16x32_bf16 a[16:19], v[28:31], a[228:231], a[16:19]
 v_lshlrev_b32 v15, 3, v15
 v_mfma_f32_16x16x32_bf16 a[20:23], v[28:31], a[236:239], a[20:23]
 ds_read_b64_tr_b16 v[18:19], v4 offset:8448
 s_mov_b32 s16, s12
 v_mfma_f32_16x16x32_bf16 a[20:23], v[24:27], a[232:235], a[20:23]
 s_mov_b32 s17, s13
 v_mfma_f32_16x16x32_bf16 a[24:27], v[24:27], a[240:243], a[24:27]
 ds_read_b64_tr_b16 v[20:21], v4 offset:10240
 s_mov_b32 s18, 0x0
 v_mfma_f32_16x16x32_bf16 a[24:27], v[28:31], a[244:247], a[24:27]
 s_mov_b32 s19, 0x20000
 v_mfma_f32_16x16x32_bf16 a[28:31], v[28:31], a[252:255], a[28:31]
 ds_read_b64_tr_b16 v[22:23], v4 offset:10496
 s_add_u32 s18, s15, 2048
 v_mfma_f32_16x16x32_bf16 a[28:31], v[24:27], a[248:251], a[28:31]
 s_waitcnt lgkmcnt(8)
 s_add_u32 s82, s14, 7168
 v_mfma_f32_16x16x32_bf16 a[32:35], v[32:35], a[224:227], a[32:35]
 ds_read_b64_tr_b16 v[24:25], v5 offset:8192
 v_lshlrev_b32 v15, 4, v15
 v_mfma_f32_16x16x32_bf16 a[32:35], v[36:39], a[228:231], a[32:35]
 s_nop 0
 v_mfma_f32_16x16x32_bf16 a[36:39], v[36:39], a[236:239], a[36:39]
 ds_read_b64_tr_b16 v[26:27], v5 offset:8448
 v_lshrrev_b32 v0, 1, v15
 v_mfma_f32_16x16x32_bf16 a[36:39], v[32:35], a[232:235], a[36:39]
 v_add_u32 v0, 384, v0
 v_mfma_f32_16x16x32_bf16 a[40:43], v[32:35], a[240:243], a[40:43]
 ds_read_b64_tr_b16 v[28:29], v5 offset:10240
 s_nop 0
 v_mfma_f32_16x16x32_bf16 a[40:43], v[36:39], a[244:247], a[40:43]
 buffer_load_dword v1, v0, s[80:83], s14 offen
 v_mfma_f32_16x16x32_bf16 a[44:47], v[36:39], a[252:255], a[44:47]
 ds_read_b64_tr_b16 v[30:31], v5 offset:10496
 s_mul_i32 s14, s15, 7
 v_mfma_f32_16x16x32_bf16 a[44:47], v[32:35], a[248:251], a[44:47]
 s_waitcnt lgkmcnt(8)
 s_lshr_b32 s14, s14, 4
 v_mfma_f32_16x16x32_bf16 a[48:51], v[40:43], a[224:227], a[48:51]
 ds_read_b64_tr_b16 v[32:33], v4 offset:12288
 s_add_u32 s82, s14, 896
 v_mfma_f32_16x16x32_bf16 a[48:51], v[44:47], a[228:231], a[48:51]
 v_lshrrev_b32 v15, 4, v15
 v_mfma_f32_16x16x32_bf16 a[52:55], v[44:47], a[236:239], a[52:55]
 ds_read_b64_tr_b16 v[34:35], v4 offset:12544
 s_nop 0
 v_mfma_f32_16x16x32_bf16 a[52:55], v[40:43], a[232:235], a[52:55]
 buffer_load_dword v1, v15, s[80:83], s14 offen
 v_mfma_f32_16x16x32_bf16 a[56:59], v[40:43], a[240:243], a[56:59]
 ds_read_b64_tr_b16 v[36:37], v4 offset:14336
 s_add_u32 s14, s14, 917504
 v_mfma_f32_16x16x32_bf16 a[56:59], v[44:47], a[244:247], a[56:59]
 s_add_u32 s82, s14, 896
 v_mfma_f32_16x16x32_bf16 a[60:63], v[44:47], a[252:255], a[60:63]
 ds_read_b64_tr_b16 v[38:39], v4 offset:14592
 buffer_load_dword v1, v15, s[80:83], s14 offen
 v_mfma_f32_16x16x32_bf16 a[60:63], v[40:43], a[248:251], a[60:63]
 s_waitcnt lgkmcnt(8)
 s_lshl_b32 s3, s2, 2
 v_mfma_f32_16x16x32_bf16 a[64:67], v[16:19], a[224:227], a[64:67]
 ds_read_b64_tr_b16 v[40:41], v5 offset:12288
 s_add_u32 s3, s3, s95
 v_mfma_f32_16x16x32_bf16 a[64:67], v[20:23], a[228:231], a[64:67]
 s_and_b32 s3, s3, 255
 v_mfma_f32_16x16x32_bf16 a[68:71], v[20:23], a[236:239], a[68:71]
 ds_read_b64_tr_b16 v[42:43], v5 offset:12544
 s_mul_i32 s3, s3, 128
 v_mfma_f32_16x16x32_bf16 a[68:71], v[16:19], a[232:235], a[68:71]
 v_min_u32 v52, 0, v0
 v_mfma_f32_16x16x32_bf16 a[72:75], v[16:19], a[240:243], a[72:75]
 ds_read_b64_tr_b16 v[44:45], v5 offset:14336
 v_lshlrev_b32 v52, 7, v52
 v_mfma_f32_16x16x32_bf16 a[72:75], v[20:23], a[244:247], a[72:75]
 v_add_u32 v52, s3, v52
 v_mfma_f32_16x16x32_bf16 a[76:79], v[20:23], a[252:255], a[76:79]
 ds_read_b64_tr_b16 v[46:47], v5 offset:14592
 v_min_u32 v52, L_b_end - attfin_kernel - 4, v52
 v_mfma_f32_16x16x32_bf16 a[76:79], v[16:19], a[248:251], a[76:79]
 s_waitcnt lgkmcnt(8)
 s_getpc_b64 s[16:17]
 v_mfma_f32_16x16x32_bf16 a[80:83], v[24:27], a[224:227], a[80:83]
 ds_read_b64_tr_b16 v[16:17], v6 offset:16384
 s_add_u32 s16, s16, attfin_kernel - .
 v_mfma_f32_16x16x32_bf16 a[80:83], v[28:31], a[228:231], a[80:83]
 s_addc_u32 s17, s17, 0
 v_mfma_f32_16x16x32_bf16 a[84:87], v[28:31], a[236:239], a[84:87]
 ds_read_b64_tr_b16 v[18:19], v6 offset:16640
 v_mov_b32 v53, s17
 v_mfma_f32_16x16x32_bf16 a[84:87], v[24:27], a[232:235], a[84:87]
 v_add_co_u32 v52, vcc, s16, v52
 v_mfma_f32_16x16x32_bf16 a[88:91], v[24:27], a[240:243], a[88:91]
 ds_read_b64_tr_b16 v[20:21], v6 offset:18432
 s_nop 1
 v_mfma_f32_16x16x32_bf16 a[88:91], v[28:31], a[244:247], a[88:91]
 v_addc_co_u32 v53, vcc, 0, v53, vcc
 v_mfma_f32_16x16x32_bf16 a[92:95], v[28:31], a[252:255], a[92:95]
 ds_read_b64_tr_b16 v[22:23], v6 offset:18688
 global_load_dword v1, v[52:53], off
 v_mfma_f32_16x16x32_bf16 a[92:95], v[24:27], a[248:251], a[92:95]
 s_waitcnt lgkmcnt(8)
 s_mul_i32 s4, s97, 4
 s_add_u32 s4, s4, 0
 s_lshl_b32 s4, s4, 10
 v_mfma_f32_16x16x32_bf16 a[96:99], v[32:35], a[224:227], a[96:99]
 ds_read_b64_tr_b16 v[24:25], v7 offset:16384
 v_accvgpr_read_b32 v48, a0
 v_accvgpr_read_b32 v49, a1
 v_mfma_f32_16x16x32_bf16 a[96:99], v[36:39], a[228:231], a[96:99]
 v_accvgpr_read_b32 v50, a2
 v_accvgpr_read_b32 v51, a3
 v_mfma_f32_16x16x32_bf16 a[100:103], v[36:39], a[236:239], a[100:103]
 ds_read_b64_tr_b16 v[26:27], v7 offset:16640
 v_exp_f32 v56, -v48
 v_exp_f32 v57, -v49
 v_mfma_f32_16x16x32_bf16 a[100:103], v[32:35], a[232:235], a[100:103]
 v_exp_f32 v58, -v50
 v_exp_f32 v59, -v51
 v_mfma_f32_16x16x32_bf16 a[104:107], v[32:35], a[240:243], a[104:107]
 ds_read_b64_tr_b16 v[28:29], v7 offset:18432
 v_accvgpr_read_b32 v52, a32
 v_accvgpr_read_b32 v53, a33
 v_accvgpr_read_b32 v54, a34
 v_mfma_f32_16x16x32_bf16 a[104:107], v[36:39], a[244:247], a[104:107]
 v_accvgpr_read_b32 v55, a35
 v_mul_f32 v52, v48, v52
 v_mfma_f32_16x16x32_bf16 a[108:111], v[36:39], a[252:255], a[108:111]
 ds_read_b64_tr_b16 v[30:31], v7 offset:18688
 v_mul_f32 v53, v49, v53
 v_mul_f32 v54, v50, v54
 v_mfma_f32_16x16x32_bf16 a[108:111], v[32:35], a[248:251], a[108:111]
 s_waitcnt lgkmcnt(8)
 v_mul_f32 v55, v51, v55
 v_fma_f32 v56, v56, s6, s6
 v_mfma_f32_16x16x32_bf16 a[112:115], v[40:43], a[224:227], a[112:115]
 ds_read_b64_tr_b16 v[32:33], v6 offset:20480
 v_fma_f32 v57, v57, s6, s6
 v_fma_f32 v58, v58, s6, s6
 v_mfma_f32_16x16x32_bf16 a[112:115], v[44:47], a[228:231], a[112:115]
 v_fma_f32 v59, v59, s6, s6
 v_rcp_f32 v56, v56
 v_rcp_f32 v57, v57
 v_mfma_f32_16x16x32_bf16 a[116:119], v[44:47], a[236:239], a[116:119]
 ds_read_b64_tr_b16 v[34:35], v6 offset:20736
 v_rcp_f32 v58, v58
 v_rcp_f32 v59, v59
 v_mfma_f32_16x16x32_bf16 a[116:119], v[40:43], a[232:235], a[116:119]
 v_mul_f32 v52, v52, v56
 v_mul_f32 v53, v53, v57
 v_mfma_f32_16x16x32_bf16 a[120:123], v[40:43], a[240:243], a[120:123]
 ds_read_b64_tr_b16 v[36:37], v6 offset:22528
 v_mul_f32 v54, v54, v58
 v_mul_f32 v55, v55, v59
 v_mfma_f32_16x16x32_bf16 a[120:123], v[44:47], a[244:247], a[120:123]
 v_cvt_pk_bf16_f32 v60, v52, v53
 v_cvt_pk_bf16_f32 v61, v54, v55
 v_mfma_f32_16x16x32_bf16 a[124:127], v[44:47], a[252:255], a[124:127]
 ds_read_b64_tr_b16 v[38:39], v6 offset:22784
 v_accvgpr_read_b32 v48, a16
 v_accvgpr_read_b32 v49, a17
 v_accvgpr_read_b32 v50, a18
 v_mfma_f32_16x16x32_bf16 a[124:127], v[40:43], a[248:251], a[124:127]
 s_waitcnt lgkmcnt(8)
 v_accvgpr_read_b32 v51, a19
 v_exp_f32 v56, -v48
 v_mfma_f32_16x16x32_bf16 v[64:67], v[16:19], a[128:131], v[64:67]
 ds_read_b64_tr_b16 v[40:41], v7 offset:20480
 v_exp_f32 v57, -v49
 v_exp_f32 v58, -v50
 v_mfma_f32_16x16x32_bf16 v[64:67], v[20:23], a[132:135], v[64:67]
 v_exp_f32 v59, -v51
 v_accvgpr_read_b32 v52, a48
 v_mfma_f32_16x16x32_bf16 v[68:71], v[20:23], a[140:143], v[68:71]
 ds_read_b64_tr_b16 v[42:43], v7 offset:20736
 v_accvgpr_read_b32 v53, a49
 v_accvgpr_read_b32 v54, a50
 v_mfma_f32_16x16x32_bf16 v[68:71], v[16:19], a[136:139], v[68:71]
 v_accvgpr_read_b32 v55, a51
 v_mul_f32 v52, v48, v52
 v_mul_f32 v53, v49, v53
 v_mfma_f32_16x16x32_bf16 v[72:75], v[16:19], a[144:147], v[72:75]
 ds_read_b64_tr_b16 v[44:45], v7 offset:22528
 v_mul_f32 v54, v50, v54
 v_mul_f32 v55, v51, v55
 v_mfma_f32_16x16x32_bf16 v[72:75], v[20:23], a[148:151], v[72:75]
 v_fma_f32 v56, v56, s6, s6
 v_fma_f32 v57, v57, s6, s6
 v_mfma_f32_16x16x32_bf16 v[76:79], v[20:23], a[156:159], v[76:79]
 ds_read_b64_tr_b16 v[46:47], v7 offset:22784
 v_fma_f32 v58, v58, s6, s6
 v_fma_f32 v59, v59, s6, s6
 v_mfma_f32_16x16x32_bf16 v[76:79], v[16:19], a[152:155], v[76:79]
 s_waitcnt lgkmcnt(8)
 v_rcp_f32 v56, v56
 v_rcp_f32 v57, v57
 v_mfma_f32_16x16x32_bf16 v[80:83], v[24:27], a[128:131], v[80:83]
 ds_read_b64_tr_b16 v[16:17], v8 offset:16384
 v_rcp_f32 v58, v58
 v_rcp_f32 v59, v59
 v_mul_f32 v52, v52, v56
 v_mfma_f32_16x16x32_bf16 v[80:83], v[28:31], a[132:135], v[80:83]
 v_mul_f32 v53, v53, v57
 v_mul_f32 v54, v54, v58
 v_mfma_f32_16x16x32_bf16 v[84:87], v[28:31], a[140:143], v[84:87]
 ds_read_b64_tr_b16 v[18:19], v8 offset:16640
 v_mul_f32 v55, v55, v59
 v_cvt_pk_bf16_f32 v62, v52, v53
 v_mfma_f32_16x16x32_bf16 v[84:87], v[24:27], a[136:139], v[84:87]
 v_cvt_pk_bf16_f32 v63, v54, v55
 s_add_u32 s5, s4, 0
 v_mfma_f32_16x16x32_bf16 v[88:91], v[24:27], a[144:147], v[88:91]
 ds_read_b64_tr_b16 v[20:21], v8 offset:18432
 buffer_store_dwordx4 v[60:63], v12, s[84:87], s5 offen sc1
 v_accvgpr_read_b32 v48, a4
 v_mfma_f32_16x16x32_bf16 v[88:91], v[28:31], a[148:151], v[88:91]
 v_accvgpr_read_b32 v49, a5
 v_accvgpr_read_b32 v50, a6
 v_accvgpr_read_b32 v51, a7
 v_mfma_f32_16x16x32_bf16 v[92:95], v[28:31], a[156:159], v[92:95]
 ds_read_b64_tr_b16 v[22:23], v8 offset:18688
 v_exp_f32 v56, -v48
 v_exp_f32 v57, -v49
 v_mfma_f32_16x16x32_bf16 v[92:95], v[24:27], a[152:155], v[92:95]
 s_waitcnt lgkmcnt(8)
 v_exp_f32 v58, -v50
 v_exp_f32 v59, -v51
 v_mfma_f32_16x16x32_bf16 v[96:99], v[32:35], a[128:131], v[96:99]
 ds_read_b64_tr_b16 v[24:25], v9 offset:16384
 v_accvgpr_read_b32 v52, a36
 v_accvgpr_read_b32 v53, a37
 v_mfma_f32_16x16x32_bf16 v[96:99], v[36:39], a[132:135], v[96:99]
 v_accvgpr_read_b32 v54, a38
 v_accvgpr_read_b32 v55, a39
 v_mfma_f32_16x16x32_bf16 v[100:103], v[36:39], a[140:143], v[100:103]
 ds_read_b64_tr_b16 v[26:27], v9 offset:16640
 v_mul_f32 v52, v48, v52
 v_mul_f32 v53, v49, v53
 v_mul_f32 v54, v50, v54
 v_mfma_f32_16x16x32_bf16 v[100:103], v[32:35], a[136:139], v[100:103]
 v_mul_f32 v55, v51, v55
 v_fma_f32 v56, v56, s6, s6
 v_mfma_f32_16x16x32_bf16 v[104:107], v[32:35], a[144:147], v[104:107]
 ds_read_b64_tr_b16 v[28:29], v9 offset:18432
 v_fma_f32 v57, v57, s6, s6
 v_fma_f32 v58, v58, s6, s6
 v_mfma_f32_16x16x32_bf16 v[104:107], v[36:39], a[148:151], v[104:107]
 v_fma_f32 v59, v59, s6, s6
 v_rcp_f32 v56, v56
 v_mfma_f32_16x16x32_bf16 v[108:111], v[36:39], a[156:159], v[108:111]
 ds_read_b64_tr_b16 v[30:31], v9 offset:18688
 v_rcp_f32 v57, v57
 v_rcp_f32 v58, v58
 v_mfma_f32_16x16x32_bf16 v[108:111], v[32:35], a[152:155], v[108:111]
 s_waitcnt lgkmcnt(8)
 v_rcp_f32 v59, v59
 v_mul_f32 v52, v52, v56
 v_mul_f32 v53, v53, v57
 v_mfma_f32_16x16x32_bf16 v[112:115], v[40:43], a[128:131], v[112:115]
 ds_read_b64_tr_b16 v[32:33], v8 offset:20480
 v_mul_f32 v54, v54, v58
 v_mul_f32 v55, v55, v59
 v_mfma_f32_16x16x32_bf16 v[112:115], v[44:47], a[132:135], v[112:115]
 v_cvt_pk_bf16_f32 v60, v52, v53
 v_cvt_pk_bf16_f32 v61, v54, v55
 v_mfma_f32_16x16x32_bf16 v[116:119], v[44:47], a[140:143], v[116:119]
 ds_read_b64_tr_b16 v[34:35], v8 offset:20736
 v_accvgpr_read_b32 v48, a20
 v_accvgpr_read_b32 v49, a21
 v_mfma_f32_16x16x32_bf16 v[116:119], v[40:43], a[136:139], v[116:119]
 v_accvgpr_read_b32 v50, a22
 v_accvgpr_read_b32 v51, a23
 v_mfma_f32_16x16x32_bf16 v[120:123], v[40:43], a[144:147], v[120:123]
 ds_read_b64_tr_b16 v[36:37], v8 offset:22528
 v_exp_f32 v56, -v48
 v_exp_f32 v57, -v49
 v_mfma_f32_16x16x32_bf16 v[120:123], v[44:47], a[148:151], v[120:123]
 v_exp_f32 v58, -v50
 v_exp_f32 v59, -v51
 v_accvgpr_read_b32 v52, a52
 v_mfma_f32_16x16x32_bf16 v[124:127], v[44:47], a[156:159], v[124:127]
 ds_read_b64_tr_b16 v[38:39], v8 offset:22784
 v_accvgpr_read_b32 v53, a53
 v_accvgpr_read_b32 v54, a54
 v_mfma_f32_16x16x32_bf16 v[124:127], v[40:43], a[152:155], v[124:127]
 s_waitcnt lgkmcnt(8)
 v_accvgpr_read_b32 v55, a55
 v_mul_f32 v52, v48, v52
 v_mfma_f32_16x16x32_bf16 v[64:67], v[16:19], a[160:163], v[64:67]
 ds_read_b64_tr_b16 v[40:41], v9 offset:20480
 v_mul_f32 v53, v49, v53
 v_mul_f32 v54, v50, v54
 v_mfma_f32_16x16x32_bf16 v[64:67], v[20:23], a[164:167], v[64:67]
 v_mul_f32 v55, v51, v55
 v_fma_f32 v56, v56, s6, s6
 v_mfma_f32_16x16x32_bf16 v[68:71], v[20:23], a[172:175], v[68:71]
 ds_read_b64_tr_b16 v[42:43], v9 offset:20736
 v_fma_f32 v57, v57, s6, s6
 v_fma_f32 v58, v58, s6, s6
 v_fma_f32 v59, v59, s6, s6
 v_mfma_f32_16x16x32_bf16 v[68:71], v[16:19], a[168:171], v[68:71]
 v_rcp_f32 v56, v56
 v_rcp_f32 v57, v57
 v_mfma_f32_16x16x32_bf16 v[72:75], v[16:19], a[176:179], v[72:75]
 ds_read_b64_tr_b16 v[44:45], v9 offset:22528
 v_rcp_f32 v58, v58
 v_rcp_f32 v59, v59
 v_mfma_f32_16x16x32_bf16 v[72:75], v[20:23], a[180:183], v[72:75]
 v_mul_f32 v52, v52, v56
 v_mul_f32 v53, v53, v57
 v_mfma_f32_16x16x32_bf16 v[76:79], v[20:23], a[188:191], v[76:79]
 ds_read_b64_tr_b16 v[46:47], v9 offset:22784
 v_mul_f32 v54, v54, v58
 v_mul_f32 v55, v55, v59
 v_mfma_f32_16x16x32_bf16 v[76:79], v[16:19], a[184:187], v[76:79]
 s_waitcnt lgkmcnt(8)
 v_cvt_pk_bf16_f32 v62, v52, v53
 v_cvt_pk_bf16_f32 v63, v54, v55
 s_add_u32 s5, s4, 114688
 v_mfma_f32_16x16x32_bf16 v[80:83], v[24:27], a[160:163], v[80:83]
 ds_read_b64_tr_b16 v[16:17], v10 offset:16384
 buffer_store_dwordx4 v[60:63], v12, s[84:87], s5 offen sc1
 v_accvgpr_read_b32 v48, a8
 v_mfma_f32_16x16x32_bf16 v[80:83], v[28:31], a[164:167], v[80:83]
 v_accvgpr_read_b32 v49, a9
 v_accvgpr_read_b32 v50, a10
 v_mfma_f32_16x16x32_bf16 v[84:87], v[28:31], a[172:175], v[84:87]
 ds_read_b64_tr_b16 v[18:19], v10 offset:16640
 v_accvgpr_read_b32 v51, a11
 v_exp_f32 v56, -v48
 v_mfma_f32_16x16x32_bf16 v[84:87], v[24:27], a[168:171], v[84:87]
 v_exp_f32 v57, -v49
 v_exp_f32 v58, -v50
 v_mfma_f32_16x16x32_bf16 v[88:91], v[24:27], a[176:179], v[88:91]
 ds_read_b64_tr_b16 v[20:21], v10 offset:18432
 v_exp_f32 v59, -v51
 v_accvgpr_read_b32 v52, a40
 v_accvgpr_read_b32 v53, a41
 v_mfma_f32_16x16x32_bf16 v[88:91], v[28:31], a[180:183], v[88:91]
 v_accvgpr_read_b32 v54, a42
 v_accvgpr_read_b32 v55, a43
 v_mfma_f32_16x16x32_bf16 v[92:95], v[28:31], a[188:191], v[92:95]
 ds_read_b64_tr_b16 v[22:23], v10 offset:18688
 v_mul_f32 v52, v48, v52
 v_mul_f32 v53, v49, v53
 v_mfma_f32_16x16x32_bf16 v[92:95], v[24:27], a[184:187], v[92:95]
 s_waitcnt lgkmcnt(8)
 v_mul_f32 v54, v50, v54
 v_mul_f32 v55, v51, v55
 v_mfma_f32_16x16x32_bf16 v[96:99], v[32:35], a[160:163], v[96:99]
 ds_read_b64_tr_b16 v[24:25], v11 offset:16384
 v_fma_f32 v56, v56, s6, s6
 v_fma_f32 v57, v57, s6, s6
 v_mfma_f32_16x16x32_bf16 v[96:99], v[36:39], a[164:167], v[96:99]
 v_fma_f32 v58, v58, s6, s6
 v_fma_f32 v59, v59, s6, s6
 v_rcp_f32 v56, v56
 v_mfma_f32_16x16x32_bf16 v[100:103], v[36:39], a[172:175], v[100:103]
 ds_read_b64_tr_b16 v[26:27], v11 offset:16640
 v_rcp_f32 v57, v57
 v_rcp_f32 v58, v58
 v_mfma_f32_16x16x32_bf16 v[100:103], v[32:35], a[168:171], v[100:103]
 v_rcp_f32 v59, v59
 v_mul_f32 v52, v52, v56
 v_mfma_f32_16x16x32_bf16 v[104:107], v[32:35], a[176:179], v[104:107]
 ds_read_b64_tr_b16 v[28:29], v11 offset:18432
 v_mul_f32 v53, v53, v57
 v_mul_f32 v54, v54, v58
 v_mfma_f32_16x16x32_bf16 v[104:107], v[36:39], a[180:183], v[104:107]
 v_mul_f32 v55, v55, v59
 v_cvt_pk_bf16_f32 v60, v52, v53
 v_mfma_f32_16x16x32_bf16 v[108:111], v[36:39], a[188:191], v[108:111]
 ds_read_b64_tr_b16 v[30:31], v11 offset:18688
 v_cvt_pk_bf16_f32 v61, v54, v55
 v_accvgpr_read_b32 v48, a24
 v_accvgpr_read_b32 v49, a25
 v_mfma_f32_16x16x32_bf16 v[108:111], v[32:35], a[184:187], v[108:111]
 s_waitcnt lgkmcnt(8)
 v_accvgpr_read_b32 v50, a26
 v_accvgpr_read_b32 v51, a27
 v_mfma_f32_16x16x32_bf16 v[112:115], v[40:43], a[160:163], v[112:115]
 ds_read_b64_tr_b16 v[32:33], v10 offset:20480
 v_exp_f32 v56, -v48
 v_exp_f32 v57, -v49
 v_mfma_f32_16x16x32_bf16 v[112:115], v[44:47], a[164:167], v[112:115]
 v_exp_f32 v58, -v50
 v_exp_f32 v59, -v51
 v_mfma_f32_16x16x32_bf16 v[116:119], v[44:47], a[172:175], v[116:119]
 ds_read_b64_tr_b16 v[34:35], v10 offset:20736
 v_accvgpr_read_b32 v52, a56
 v_accvgpr_read_b32 v53, a57
 v_mfma_f32_16x16x32_bf16 v[116:119], v[40:43], a[168:171], v[116:119]
 v_accvgpr_read_b32 v54, a58
 v_accvgpr_read_b32 v55, a59
 v_mul_f32 v52, v48, v52
 v_mfma_f32_16x16x32_bf16 v[120:123], v[40:43], a[176:179], v[120:123]
 ds_read_b64_tr_b16 v[36:37], v10 offset:22528
 v_mul_f32 v53, v49, v53
 v_mul_f32 v54, v50, v54
 v_mfma_f32_16x16x32_bf16 v[120:123], v[44:47], a[180:183], v[120:123]
 v_mul_f32 v55, v51, v55
 v_fma_f32 v56, v56, s6, s6
 v_mfma_f32_16x16x32_bf16 v[124:127], v[44:47], a[188:191], v[124:127]
 ds_read_b64_tr_b16 v[38:39], v10 offset:22784
 v_fma_f32 v57, v57, s6, s6
 v_fma_f32 v58, v58, s6, s6
 v_mfma_f32_16x16x32_bf16 v[124:127], v[40:43], a[184:187], v[124:127]
 s_waitcnt lgkmcnt(8)
 v_fma_f32 v59, v59, s6, s6
 v_rcp_f32 v56, v56
 v_mfma_f32_16x16x32_bf16 v[64:67], v[16:19], a[192:195], v[64:67]
 ds_read_b64_tr_b16 v[40:41], v11 offset:20480
 v_rcp_f32 v57, v57
 v_rcp_f32 v58, v58
 v_rcp_f32 v59, v59
 v_mfma_f32_16x16x32_bf16 v[64:67], v[20:23], a[196:199], v[64:67]
 v_mul_f32 v52, v52, v56
 v_mul_f32 v53, v53, v57
 v_mfma_f32_16x16x32_bf16 v[68:71], v[20:23], a[204:207], v[68:71]
 ds_read_b64_tr_b16 v[42:43], v11 offset:20736
 v_mul_f32 v54, v54, v58
 v_mul_f32 v55, v55, v59
 v_mfma_f32_16x16x32_bf16 v[68:71], v[16:19], a[200:203], v[68:71]
 v_cvt_pk_bf16_f32 v62, v52, v53
 v_cvt_pk_bf16_f32 v63, v54, v55
 v_mfma_f32_16x16x32_bf16 v[72:75], v[16:19], a[208:211], v[72:75]
 ds_read_b64_tr_b16 v[44:45], v11 offset:22528
 s_add_u32 s5, s4, 229376
 buffer_store_dwordx4 v[60:63], v12, s[84:87], s5 offen sc1
 v_mfma_f32_16x16x32_bf16 v[72:75], v[20:23], a[212:215], v[72:75]
 v_accvgpr_read_b32 v48, a12
 v_accvgpr_read_b32 v49, a13
 v_accvgpr_read_b32 v50, a14
 v_mfma_f32_16x16x32_bf16 v[76:79], v[20:23], a[220:223], v[76:79]
 ds_read_b64_tr_b16 v[46:47], v11 offset:22784
 v_accvgpr_read_b32 v51, a15
 v_exp_f32 v56, -v48
 v_mfma_f32_16x16x32_bf16 v[76:79], v[16:19], a[216:219], v[76:79]
 s_waitcnt lgkmcnt(8)
 v_exp_f32 v57, -v49
 v_exp_f32 v58, -v50
 v_mfma_f32_16x16x32_bf16 v[80:83], v[24:27], a[192:195], v[80:83]
 ds_read_b64_tr_b16 v[16:17], v4 offset:16384
 v_exp_f32 v59, -v51
 v_accvgpr_read_b32 v52, a44
 v_mfma_f32_16x16x32_bf16 v[80:83], v[28:31], a[196:199], v[80:83]
 v_accvgpr_read_b32 v53, a45
 v_accvgpr_read_b32 v54, a46
 v_mfma_f32_16x16x32_bf16 v[84:87], v[28:31], a[204:207], v[84:87]
 ds_read_b64_tr_b16 v[18:19], v4 offset:16640
 v_accvgpr_read_b32 v55, a47
 v_mul_f32 v52, v48, v52
 v_mfma_f32_16x16x32_bf16 v[84:87], v[24:27], a[200:203], v[84:87]
 v_mul_f32 v53, v49, v53
 v_mul_f32 v54, v50, v54
 v_mul_f32 v55, v51, v55
 v_mfma_f32_16x16x32_bf16 v[88:91], v[24:27], a[208:211], v[88:91]
 ds_read_b64_tr_b16 v[20:21], v4 offset:18432
 v_fma_f32 v56, v56, s6, s6
 v_fma_f32 v57, v57, s6, s6
 v_mfma_f32_16x16x32_bf16 v[88:91], v[28:31], a[212:215], v[88:91]
 v_fma_f32 v58, v58, s6, s6
 v_fma_f32 v59, v59, s6, s6
 v_mfma_f32_16x16x32_bf16 v[92:95], v[28:31], a[220:223], v[92:95]
 ds_read_b64_tr_b16 v[22:23], v4 offset:18688
 v_rcp_f32 v56, v56
 v_rcp_f32 v57, v57
 v_mfma_f32_16x16x32_bf16 v[92:95], v[24:27], a[216:219], v[92:95]
 s_waitcnt lgkmcnt(8)
 v_rcp_f32 v58, v58
 v_rcp_f32 v59, v59
 v_mfma_f32_16x16x32_bf16 v[96:99], v[32:35], a[192:195], v[96:99]
 ds_read_b64_tr_b16 v[24:25], v5 offset:16384
 v_mul_f32 v52, v52, v56
 v_mul_f32 v53, v53, v57
 v_mul_f32 v54, v54, v58
 v_mfma_f32_16x16x32_bf16 v[96:99], v[36:39], a[196:199], v[96:99]
 v_mul_f32 v55, v55, v59
 v_cvt_pk_bf16_f32 v60, v52, v53
 v_mfma_f32_16x16x32_bf16 v[100:103], v[36:39], a[204:207], v[100:103]
 ds_read_b64_tr_b16 v[26:27], v5 offset:16640
 v_cvt_pk_bf16_f32 v61, v54, v55
 v_accvgpr_read_b32 v48, a28
 v_mfma_f32_16x16x32_bf16 v[100:103], v[32:35], a[200:203], v[100:103]
 v_accvgpr_read_b32 v49, a29
 v_accvgpr_read_b32 v50, a30
 v_mfma_f32_16x16x32_bf16 v[104:107], v[32:35], a[208:211], v[104:107]
 ds_read_b64_tr_b16 v[28:29], v5 offset:18432
 v_accvgpr_read_b32 v51, a31
 v_exp_f32 v56, -v48
 v_mfma_f32_16x16x32_bf16 v[104:107], v[36:39], a[212:215], v[104:107]
 v_exp_f32 v57, -v49
 v_exp_f32 v58, -v50
 v_exp_f32 v59, -v51
 v_mfma_f32_16x16x32_bf16 v[108:111], v[36:39], a[220:223], v[108:111]
 ds_read_b64_tr_b16 v[30:31], v5 offset:18688
 v_accvgpr_read_b32 v52, a60
 v_accvgpr_read_b32 v53, a61
 v_mfma_f32_16x16x32_bf16 v[108:111], v[32:35], a[216:219], v[108:111]
 s_waitcnt lgkmcnt(8)
 v_accvgpr_read_b32 v54, a62
 v_accvgpr_read_b32 v55, a63
 v_mfma_f32_16x16x32_bf16 v[112:115], v[40:43], a[192:195], v[112:115]
 ds_read_b64_tr_b16 v[32:33], v4 offset:20480
 v_mul_f32 v52, v48, v52
 v_mul_f32 v53, v49, v53
 v_mfma_f32_16x16x32_bf16 v[112:115], v[44:47], a[196:199], v[112:115]
 v_mul_f32 v54, v50, v54
 v_mul_f32 v55, v51, v55
 v_mfma_f32_16x16x32_bf16 v[116:119], v[44:47], a[204:207], v[116:119]
 ds_read_b64_tr_b16 v[34:35], v4 offset:20736
 v_fma_f32 v56, v56, s6, s6
 v_fma_f32 v57, v57, s6, s6
 v_fma_f32 v58, v58, s6, s6
 v_mfma_f32_16x16x32_bf16 v[116:119], v[40:43], a[200:203], v[116:119]
 v_fma_f32 v59, v59, s6, s6
 v_rcp_f32 v56, v56
 v_mfma_f32_16x16x32_bf16 v[120:123], v[40:43], a[208:211], v[120:123]
 ds_read_b64_tr_b16 v[36:37], v4 offset:22528
 v_rcp_f32 v57, v57
 v_rcp_f32 v58, v58
 v_mfma_f32_16x16x32_bf16 v[120:123], v[44:47], a[212:215], v[120:123]
 v_rcp_f32 v59, v59
 v_mul_f32 v52, v52, v56
 v_mfma_f32_16x16x32_bf16 v[124:127], v[44:47], a[220:223], v[124:127]
 ds_read_b64_tr_b16 v[38:39], v4 offset:22784
 v_mul_f32 v53, v53, v57
 v_mul_f32 v54, v54, v58
 v_mfma_f32_16x16x32_bf16 v[124:127], v[40:43], a[216:219], v[124:127]
 s_waitcnt lgkmcnt(8)
 v_mul_f32 v55, v55, v59
 v_cvt_pk_bf16_f32 v62, v52, v53
 v_cvt_pk_bf16_f32 v63, v54, v55
 v_mfma_f32_16x16x32_bf16 v[64:67], v[16:19], a[224:227], v[64:67]
 ds_read_b64_tr_b16 v[40:41], v5 offset:20480
 s_add_u32 s5, s4, 344064
 buffer_store_dwordx4 v[60:63], v12, s[84:87], s5 offen sc1
 v_mfma_f32_16x16x32_bf16 v[64:67], v[20:23], a[228:231], v[64:67]
 s_mul_i32 s4, s97, 4
 s_add_u32 s4, s4, 1
 v_mfma_f32_16x16x32_bf16 v[68:71], v[20:23], a[236:239], v[68:71]
 ds_read_b64_tr_b16 v[42:43], v5 offset:20736
 s_lshl_b32 s4, s4, 10
 v_accvgpr_read_b32 v48, a64
 v_mfma_f32_16x16x32_bf16 v[68:71], v[16:19], a[232:235], v[68:71]
 v_accvgpr_read_b32 v49, a65
 v_accvgpr_read_b32 v50, a66
 v_mfma_f32_16x16x32_bf16 v[72:75], v[16:19], a[240:243], v[72:75]
 ds_read_b64_tr_b16 v[44:45], v5 offset:22528
 v_accvgpr_read_b32 v51, a67
 v_exp_f32 v56, -v48
 v_exp_f32 v57, -v49
 v_mfma_f32_16x16x32_bf16 v[72:75], v[20:23], a[244:247], v[72:75]
 v_exp_f32 v58, -v50
 v_exp_f32 v59, -v51
 v_mfma_f32_16x16x32_bf16 v[76:79], v[20:23], a[252:255], v[76:79]
 ds_read_b64_tr_b16 v[46:47], v5 offset:22784
 v_accvgpr_read_b32 v52, a96
 v_accvgpr_read_b32 v53, a97
 v_mfma_f32_16x16x32_bf16 v[76:79], v[16:19], a[248:251], v[76:79]
 s_waitcnt lgkmcnt(8)
 v_accvgpr_read_b32 v54, a98
 v_accvgpr_read_b32 v55, a99
 v_mfma_f32_16x16x32_bf16 v[80:83], v[24:27], a[224:227], v[80:83]
 ds_read_b64_tr_b16 v[16:17], v6 offset:24576
 v_mul_f32 v52, v48, v52
 v_mul_f32 v53, v49, v53
 v_mfma_f32_16x16x32_bf16 v[80:83], v[28:31], a[228:231], v[80:83]
 v_mul_f32 v54, v50, v54
 v_mul_f32 v55, v51, v55
 v_fma_f32 v56, v56, s6, s6
 v_mfma_f32_16x16x32_bf16 v[84:87], v[28:31], a[236:239], v[84:87]
 ds_read_b64_tr_b16 v[18:19], v6 offset:24832
 v_fma_f32 v57, v57, s6, s6
 v_fma_f32 v58, v58, s6, s6
 v_mfma_f32_16x16x32_bf16 v[84:87], v[24:27], a[232:235], v[84:87]
 v_fma_f32 v59, v59, s6, s6
 v_rcp_f32 v56, v56
 v_mfma_f32_16x16x32_bf16 v[88:91], v[24:27], a[240:243], v[88:91]
 ds_read_b64_tr_b16 v[20:21], v6 offset:26624
 v_rcp_f32 v57, v57
 v_rcp_f32 v58, v58
 v_mfma_f32_16x16x32_bf16 v[88:91], v[28:31], a[244:247], v[88:91]
 v_rcp_f32 v59, v59
 v_mul_f32 v52, v52, v56
 v_mfma_f32_16x16x32_bf16 v[92:95], v[28:31], a[252:255], v[92:95]
 ds_read_b64_tr_b16 v[22:23], v6 offset:26880
 v_mul_f32 v53, v53, v57
 v_mul_f32 v54, v54, v58
 v_mul_f32 v55, v55, v59
 v_mfma_f32_16x16x32_bf16 v[92:95], v[24:27], a[248:251], v[92:95]
 s_waitcnt lgkmcnt(8)
 v_cvt_pk_bf16_f32 v60, v52, v53
 v_cvt_pk_bf16_f32 v61, v54, v55
 v_mfma_f32_16x16x32_bf16 v[96:99], v[32:35], a[224:227], v[96:99]
 ds_read_b64_tr_b16 v[24:25], v7 offset:24576
 v_accvgpr_read_b32 v48, a80
 v_accvgpr_read_b32 v49, a81
 v_mfma_f32_16x16x32_bf16 v[96:99], v[36:39], a[228:231], v[96:99]
 v_accvgpr_read_b32 v50, a82
 v_accvgpr_read_b32 v51, a83
 v_mfma_f32_16x16x32_bf16 v[100:103], v[36:39], a[236:239], v[100:103]
 ds_read_b64_tr_b16 v[26:27], v7 offset:24832
 v_exp_f32 v56, -v48
 v_exp_f32 v57, -v49
 v_mfma_f32_16x16x32_bf16 v[100:103], v[32:35], a[232:235], v[100:103]
 v_exp_f32 v58, -v50
 v_exp_f32 v59, -v51
 v_mfma_f32_16x16x32_bf16 v[104:107], v[32:35], a[240:243], v[104:107]
 ds_read_b64_tr_b16 v[28:29], v7 offset:26624
 v_accvgpr_read_b32 v52, a112
 v_accvgpr_read_b32 v53, a113
 v_accvgpr_read_b32 v54, a114
 v_mfma_f32_16x16x32_bf16 v[104:107], v[36:39], a[244:247], v[104:107]
 v_accvgpr_read_b32 v55, a115
 v_mul_f32 v52, v48, v52
 v_mfma_f32_16x16x32_bf16 v[108:111], v[36:39], a[252:255], v[108:111]
 ds_read_b64_tr_b16 v[30:31], v7 offset:26880
 v_mul_f32 v53, v49, v53
 v_mul_f32 v54, v50, v54
 v_mfma_f32_16x16x32_bf16 v[108:111], v[32:35], a[248:251], v[108:111]
 s_waitcnt lgkmcnt(8)
 v_mul_f32 v55, v51, v55
 v_fma_f32 v56, v56, s6, s6
 v_mfma_f32_16x16x32_bf16 v[112:115], v[40:43], a[224:227], v[112:115]
 ds_read_b64_tr_b16 v[32:33], v6 offset:28672
 v_fma_f32 v57, v57, s6, s6
 v_fma_f32 v58, v58, s6, s6
 v_mfma_f32_16x16x32_bf16 v[112:115], v[44:47], a[228:231], v[112:115]
 v_fma_f32 v59, v59, s6, s6
 v_rcp_f32 v56, v56
 v_rcp_f32 v57, v57
 v_mfma_f32_16x16x32_bf16 v[116:119], v[44:47], a[236:239], v[116:119]
 ds_read_b64_tr_b16 v[34:35], v6 offset:28928
 v_rcp_f32 v58, v58
 v_rcp_f32 v59, v59
 v_mfma_f32_16x16x32_bf16 v[116:119], v[40:43], a[232:235], v[116:119]
 v_mul_f32 v52, v52, v56
 v_mul_f32 v53, v53, v57
 v_mfma_f32_16x16x32_bf16 v[120:123], v[40:43], a[240:243], v[120:123]
 ds_read_b64_tr_b16 v[36:37], v6 offset:30720
 v_mul_f32 v54, v54, v58
 v_mul_f32 v55, v55, v59
 v_mfma_f32_16x16x32_bf16 v[120:123], v[44:47], a[244:247], v[120:123]
 v_cvt_pk_bf16_f32 v62, v52, v53
 v_cvt_pk_bf16_f32 v63, v54, v55
 v_mfma_f32_16x16x32_bf16 v[124:127], v[44:47], a[252:255], v[124:127]
 ds_read_b64_tr_b16 v[38:39], v6 offset:30976
 s_add_u32 s5, s4, 0
 buffer_store_dwordx4 v[60:63], v12, s[84:87], s5 offen sc1
 v_accvgpr_read_b32 v48, a68
 v_mfma_f32_16x16x32_bf16 v[124:127], v[40:43], a[248:251], v[124:127]
 s_waitcnt lgkmcnt(8)
 v_accvgpr_read_b32 v49, a69
 v_accvgpr_read_b32 v50, a70
 v_mfma_f32_16x16x32_bf16 v[128:131], v[16:19], a[128:131], v[128:131]
 ds_read_b64_tr_b16 v[40:41], v7 offset:28672
 v_accvgpr_read_b32 v51, a71
 v_exp_f32 v56, -v48
 v_mfma_f32_16x16x32_bf16 v[128:131], v[20:23], a[132:135], v[128:131]
 v_exp_f32 v57, -v49
 v_exp_f32 v58, -v50
 v_mfma_f32_16x16x32_bf16 v[132:135], v[20:23], a[140:143], v[132:135]
 ds_read_b64_tr_b16 v[42:43], v7 offset:28928
 v_exp_f32 v59, -v51
 v_accvgpr_read_b32 v52, a100
 v_mfma_f32_16x16x32_bf16 v[132:135], v[16:19], a[136:139], v[132:135]
 v_accvgpr_read_b32 v53, a101
 v_accvgpr_read_b32 v54, a102
 v_accvgpr_read_b32 v55, a103
 v_mfma_f32_16x16x32_bf16 v[136:139], v[16:19], a[144:147], v[136:139]
 ds_read_b64_tr_b16 v[44:45], v7 offset:30720
 v_mul_f32 v52, v48, v52
 v_mul_f32 v53, v49, v53
 v_mfma_f32_16x16x32_bf16 v[136:139], v[20:23], a[148:151], v[136:139]
 v_mul_f32 v54, v50, v54
 v_mul_f32 v55, v51, v55
 v_mfma_f32_16x16x32_bf16 v[140:143], v[20:23], a[156:159], v[140:143]
 ds_read_b64_tr_b16 v[46:47], v7 offset:30976
 v_fma_f32 v56, v56, s6, s6
 v_fma_f32 v57, v57, s6, s6
 v_mfma_f32_16x16x32_bf16 v[140:143], v[16:19], a[152:155], v[140:143]
 s_waitcnt lgkmcnt(8)
 v_fma_f32 v58, v58, s6, s6
 v_fma_f32 v59, v59, s6, s6
 v_mfma_f32_16x16x32_bf16 v[144:147], v[24:27], a[128:131], v[144:147]
 ds_read_b64_tr_b16 v[16:17], v8 offset:24576
 v_rcp_f32 v56, v56
 v_rcp_f32 v57, v57
 v_rcp_f32 v58, v58
 v_mfma_f32_16x16x32_bf16 v[144:147], v[28:31], a[132:135], v[144:147]
 v_rcp_f32 v59, v59
 v_mul_f32 v52, v52, v56
 v_mfma_f32_16x16x32_bf16 v[148:151], v[28:31], a[140:143], v[148:151]
 ds_read_b64_tr_b16 v[18:19], v8 offset:24832
 v_mul_f32 v53, v53, v57
 v_mul_f32 v54, v54, v58
 v_mfma_f32_16x16x32_bf16 v[148:151], v[24:27], a[136:139], v[148:151]
 v_mul_f32 v55, v55, v59
 v_cvt_pk_bf16_f32 v60, v52, v53
 v_mfma_f32_16x16x32_bf16 v[152:155], v[24:27], a[144:147], v[152:155]
 ds_read_b64_tr_b16 v[20:21], v8 offset:26624
 v_cvt_pk_bf16_f32 v61, v54, v55
 v_accvgpr_read_b32 v48, a84
 v_mfma_f32_16x16x32_bf16 v[152:155], v[28:31], a[148:151], v[152:155]
 v_accvgpr_read_b32 v49, a85
 v_accvgpr_read_b32 v50, a86
 v_accvgpr_read_b32 v51, a87
 v_mfma_f32_16x16x32_bf16 v[156:159], v[28:31], a[156:159], v[156:159]
 ds_read_b64_tr_b16 v[22:23], v8 offset:26880
 v_exp_f32 v56, -v48
 v_exp_f32 v57, -v49
 v_mfma_f32_16x16x32_bf16 v[156:159], v[24:27], a[152:155], v[156:159]
 s_waitcnt lgkmcnt(8)
 v_exp_f32 v58, -v50
 v_exp_f32 v59, -v51
 v_mfma_f32_16x16x32_bf16 v[160:163], v[32:35], a[128:131], v[160:163]
 ds_read_b64_tr_b16 v[24:25], v9 offset:24576
 v_accvgpr_read_b32 v52, a116
 v_accvgpr_read_b32 v53, a117
 v_mfma_f32_16x16x32_bf16 v[160:163], v[36:39], a[132:135], v[160:163]
 v_accvgpr_read_b32 v54, a118
 v_accvgpr_read_b32 v55, a119
 v_mfma_f32_16x16x32_bf16 v[164:167], v[36:39], a[140:143], v[164:167]
 ds_read_b64_tr_b16 v[26:27], v9 offset:24832
 v_mul_f32 v52, v48, v52
 v_mul_f32 v53, v49, v53
 v_mul_f32 v54, v50, v54
 v_mfma_f32_16x16x32_bf16 v[164:167], v[32:35], a[136:139], v[164:167]
 v_mul_f32 v55, v51, v55
 v_fma_f32 v56, v56, s6, s6
 v_mfma_f32_16x16x32_bf16 v[168:171], v[32:35], a[144:147], v[168:171]
 ds_read_b64_tr_b16 v[28:29], v9 offset:26624
 v_fma_f32 v57, v57, s6, s6
 v_fma_f32 v58, v58, s6, s6
 v_mfma_f32_16x16x32_bf16 v[168:171], v[36:39], a[148:151], v[168:171]
 v_fma_f32 v59, v59, s6, s6
 v_rcp_f32 v56, v56
 v_mfma_f32_16x16x32_bf16 v[172:175], v[36:39], a[156:159], v[172:175]
 ds_read_b64_tr_b16 v[30:31], v9 offset:26880
 v_rcp_f32 v57, v57
 v_rcp_f32 v58, v58
 v_mfma_f32_16x16x32_bf16 v[172:175], v[32:35], a[152:155], v[172:175]
 s_waitcnt lgkmcnt(8)
 v_rcp_f32 v59, v59
 v_mul_f32 v52, v52, v56
 v_mul_f32 v53, v53, v57
 v_mfma_f32_16x16x32_bf16 v[176:179], v[40:43], a[128:131], v[176:179]
 ds_read_b64_tr_b16 v[32:33], v8 offset:28672
 v_mul_f32 v54, v54, v58
 v_mul_f32 v55, v55, v59
 v_mfma_f32_16x16x32_bf16 v[176:179], v[44:47], a[132:135], v[176:179]
 v_cvt_pk_bf16_f32 v62, v52, v53
 v_cvt_pk_bf16_f32 v63, v54, v55
 v_mfma_f32_16x16x32_bf16 v[180:183], v[44:47], a[140:143], v[180:183]
 ds_read_b64_tr_b16 v[34:35], v8 offset:28928
 s_add_u32 s5, s4, 114688
 buffer_store_dwordx4 v[60:63], v12, s[84:87], s5 offen sc1
 v_mfma_f32_16x16x32_bf16 v[180:183], v[40:43], a[136:139], v[180:183]
 v_accvgpr_read_b32 v48, a72
 v_accvgpr_read_b32 v49, a73
 v_mfma_f32_16x16x32_bf16 v[184:187], v[40:43], a[144:147], v[184:187]
 ds_read_b64_tr_b16 v[36:37], v8 offset:30720
 v_accvgpr_read_b32 v50, a74
 v_accvgpr_read_b32 v51, a75
 v_exp_f32 v56, -v48
 v_mfma_f32_16x16x32_bf16 v[184:187], v[44:47], a[148:151], v[184:187]
 v_exp_f32 v57, -v49
 v_exp_f32 v58, -v50
 v_mfma_f32_16x16x32_bf16 v[188:191], v[44:47], a[156:159], v[188:191]
 ds_read_b64_tr_b16 v[38:39], v8 offset:30976
 v_exp_f32 v59, -v51
 v_accvgpr_read_b32 v52, a104
 v_mfma_f32_16x16x32_bf16 v[188:191], v[40:43], a[152:155], v[188:191]
 s_waitcnt lgkmcnt(8)
 v_accvgpr_read_b32 v53, a105
 v_accvgpr_read_b32 v54, a106
 v_mfma_f32_16x16x32_bf16 v[128:131], v[16:19], a[160:163], v[128:131]
 ds_read_b64_tr_b16 v[40:41], v9 offset:28672
 v_accvgpr_read_b32 v55, a107
 v_mul_f32 v52, v48, v52
 v_mfma_f32_16x16x32_bf16 v[128:131], v[20:23], a[164:167], v[128:131]
 v_mul_f32 v53, v49, v53
 v_mul_f32 v54, v50, v54
 v_mfma_f32_16x16x32_bf16 v[132:135], v[20:23], a[172:175], v[132:135]
 ds_read_b64_tr_b16 v[42:43], v9 offset:28928
 v_mul_f32 v55, v51, v55
 v_fma_f32 v56, v56, s6, s6
 v_fma_f32 v57, v57, s6, s6
 v_mfma_f32_16x16x32_bf16 v[132:135], v[16:19], a[168:171], v[132:135]
 v_fma_f32 v58, v58, s6, s6
 v_fma_f32 v59, v59, s6, s6
 v_mfma_f32_16x16x32_bf16 v[136:139], v[16:19], a[176:179], v[136:139]
 ds_read_b64_tr_b16 v[44:45], v9 offset:30720
 v_rcp_f32 v56, v56
 v_rcp_f32 v57, v57
 v_mfma_f32_16x16x32_bf16 v[136:139], v[20:23], a[180:183], v[136:139]
 v_rcp_f32 v58, v58
 v_rcp_f32 v59, v59
 v_mfma_f32_16x16x32_bf16 v[140:143], v[20:23], a[188:191], v[140:143]
 ds_read_b64_tr_b16 v[46:47], v9 offset:30976
 v_mul_f32 v52, v52, v56
 v_mul_f32 v53, v53, v57
 v_mfma_f32_16x16x32_bf16 v[140:143], v[16:19], a[184:187], v[140:143]
 s_waitcnt lgkmcnt(8)
 v_mul_f32 v54, v54, v58
 v_mul_f32 v55, v55, v59
 v_cvt_pk_bf16_f32 v60, v52, v53
 v_mfma_f32_16x16x32_bf16 v[144:147], v[24:27], a[160:163], v[144:147]
 ds_read_b64_tr_b16 v[16:17], v10 offset:24576
 v_cvt_pk_bf16_f32 v61, v54, v55
 v_accvgpr_read_b32 v48, a88
 v_mfma_f32_16x16x32_bf16 v[144:147], v[28:31], a[164:167], v[144:147]
 v_accvgpr_read_b32 v49, a89
 v_accvgpr_read_b32 v50, a90
 v_mfma_f32_16x16x32_bf16 v[148:151], v[28:31], a[172:175], v[148:151]
 ds_read_b64_tr_b16 v[18:19], v10 offset:24832
 v_accvgpr_read_b32 v51, a91
 v_exp_f32 v56, -v48
 v_mfma_f32_16x16x32_bf16 v[148:151], v[24:27], a[168:171], v[148:151]
 v_exp_f32 v57, -v49
 v_exp_f32 v58, -v50
 v_mfma_f32_16x16x32_bf16 v[152:155], v[24:27], a[176:179], v[152:155]
 ds_read_b64_tr_b16 v[20:21], v10 offset:26624
 v_exp_f32 v59, -v51
 v_accvgpr_read_b32 v52, a120
 v_accvgpr_read_b32 v53, a121
 v_mfma_f32_16x16x32_bf16 v[152:155], v[28:31], a[180:183], v[152:155]
 v_accvgpr_read_b32 v54, a122
 v_accvgpr_read_b32 v55, a123
 v_mfma_f32_16x16x32_bf16 v[156:159], v[28:31], a[188:191], v[156:159]
 ds_read_b64_tr_b16 v[22:23], v10 offset:26880
 v_mul_f32 v52, v48, v52
 v_mul_f32 v53, v49, v53
 v_mfma_f32_16x16x32_bf16 v[156:159], v[24:27], a[184:187], v[156:159]
 s_waitcnt lgkmcnt(8)
 v_mul_f32 v54, v50, v54
 v_mul_f32 v55, v51, v55
 v_mfma_f32_16x16x32_bf16 v[160:163], v[32:35], a[160:163], v[160:163]
 ds_read_b64_tr_b16 v[24:25], v11 offset:24576
 v_fma_f32 v56, v56, s6, s6
 v_fma_f32 v57, v57, s6, s6
 v_mfma_f32_16x16x32_bf16 v[160:163], v[36:39], a[164:167], v[160:163]
 v_fma_f32 v58, v58, s6, s6
 v_fma_f32 v59, v59, s6, s6
 v_rcp_f32 v56, v56
 v_mfma_f32_16x16x32_bf16 v[164:167], v[36:39], a[172:175], v[164:167]
 ds_read_b64_tr_b16 v[26:27], v11 offset:24832
 v_rcp_f32 v57, v57
 v_rcp_f32 v58, v58
 v_mfma_f32_16x16x32_bf16 v[164:167], v[32:35], a[168:171], v[164:167]
 v_rcp_f32 v59, v59
 v_mul_f32 v52, v52, v56
 v_mfma_f32_16x16x32_bf16 v[168:171], v[32:35], a[176:179], v[168:171]
 ds_read_b64_tr_b16 v[28:29], v11 offset:26624
 v_mul_f32 v53, v53, v57
 v_mul_f32 v54, v54, v58
 v_mfma_f32_16x16x32_bf16 v[168:171], v[36:39], a[180:183], v[168:171]
 v_mul_f32 v55, v55, v59
 v_cvt_pk_bf16_f32 v62, v52, v53
 v_mfma_f32_16x16x32_bf16 v[172:175], v[36:39], a[188:191], v[172:175]
 ds_read_b64_tr_b16 v[30:31], v11 offset:26880
 v_cvt_pk_bf16_f32 v63, v54, v55
 s_add_u32 s5, s4, 229376
 buffer_store_dwordx4 v[60:63], v12, s[84:87], s5 offen sc1
 v_mfma_f32_16x16x32_bf16 v[172:175], v[32:35], a[184:187], v[172:175]
 s_waitcnt lgkmcnt(8)
 v_accvgpr_read_b32 v48, a76
 v_accvgpr_read_b32 v49, a77
 v_mfma_f32_16x16x32_bf16 v[176:179], v[40:43], a[160:163], v[176:179]
 ds_read_b64_tr_b16 v[32:33], v10 offset:28672
 v_accvgpr_read_b32 v50, a78
 v_accvgpr_read_b32 v51, a79
 v_mfma_f32_16x16x32_bf16 v[176:179], v[44:47], a[164:167], v[176:179]
 v_exp_f32 v56, -v48
 v_exp_f32 v57, -v49
 v_mfma_f32_16x16x32_bf16 v[180:183], v[44:47], a[172:175], v[180:183]
 ds_read_b64_tr_b16 v[34:35], v10 offset:28928
 v_exp_f32 v58, -v50
 v_exp_f32 v59, -v51
 v_mfma_f32_16x16x32_bf16 v[180:183], v[40:43], a[168:171], v[180:183]
 v_accvgpr_read_b32 v52, a108
 v_accvgpr_read_b32 v53, a109
 v_accvgpr_read_b32 v54, a110
 v_mfma_f32_16x16x32_bf16 v[184:187], v[40:43], a[176:179], v[184:187]
 ds_read_b64_tr_b16 v[36:37], v10 offset:30720
 v_accvgpr_read_b32 v55, a111
 v_mul_f32 v52, v48, v52
 v_mfma_f32_16x16x32_bf16 v[184:187], v[44:47], a[180:183], v[184:187]
 v_mul_f32 v53, v49, v53
 v_mul_f32 v54, v50, v54
 v_mfma_f32_16x16x32_bf16 v[188:191], v[44:47], a[188:191], v[188:191]
 ds_read_b64_tr_b16 v[38:39], v10 offset:30976
 v_mul_f32 v55, v51, v55
 v_fma_f32 v56, v56, s6, s6
 v_mfma_f32_16x16x32_bf16 v[188:191], v[40:43], a[184:187], v[188:191]
 s_waitcnt lgkmcnt(8)
 v_fma_f32 v57, v57, s6, s6
 v_fma_f32 v58, v58, s6, s6
 v_mfma_f32_16x16x32_bf16 v[128:131], v[16:19], a[192:195], v[128:131]
 ds_read_b64_tr_b16 v[40:41], v11 offset:28672
 v_fma_f32 v59, v59, s6, s6
 v_rcp_f32 v56, v56
 v_rcp_f32 v57, v57
 v_mfma_f32_16x16x32_bf16 v[128:131], v[20:23], a[196:199], v[128:131]
 v_rcp_f32 v58, v58
 v_rcp_f32 v59, v59
 v_mfma_f32_16x16x32_bf16 v[132:135], v[20:23], a[204:207], v[132:135]
 ds_read_b64_tr_b16 v[42:43], v11 offset:28928
 v_mul_f32 v52, v52, v56
 v_mul_f32 v53, v53, v57
 v_mfma_f32_16x16x32_bf16 v[132:135], v[16:19], a[200:203], v[132:135]
 v_mul_f32 v54, v54, v58
 v_mul_f32 v55, v55, v59
 v_mfma_f32_16x16x32_bf16 v[136:139], v[16:19], a[208:211], v[136:139]
 ds_read_b64_tr_b16 v[44:45], v11 offset:30720
 v_cvt_pk_bf16_f32 v60, v52, v53
 v_cvt_pk_bf16_f32 v61, v54, v55
 v_mfma_f32_16x16x32_bf16 v[136:139], v[20:23], a[212:215], v[136:139]
 v_accvgpr_read_b32 v48, a92
 v_accvgpr_read_b32 v49, a93
 v_accvgpr_read_b32 v50, a94
 v_mfma_f32_16x16x32_bf16 v[140:143], v[20:23], a[220:223], v[140:143]
 ds_read_b64_tr_b16 v[46:47], v11 offset:30976
 v_accvgpr_read_b32 v51, a95
 v_exp_f32 v56, -v48
 v_mfma_f32_16x16x32_bf16 v[140:143], v[16:19], a[216:219], v[140:143]
 s_waitcnt lgkmcnt(8)
 v_exp_f32 v57, -v49
 v_exp_f32 v58, -v50
 v_mfma_f32_16x16x32_bf16 v[144:147], v[24:27], a[192:195], v[144:147]
 ds_read_b64_tr_b16 v[16:17], v4 offset:24576
 v_exp_f32 v59, -v51
 v_accvgpr_read_b32 v52, a124
 v_mfma_f32_16x16x32_bf16 v[144:147], v[28:31], a[196:199], v[144:147]
 v_accvgpr_read_b32 v53, a125
 v_accvgpr_read_b32 v54, a126
 v_mfma_f32_16x16x32_bf16 v[148:151], v[28:31], a[204:207], v[148:151]
 ds_read_b64_tr_b16 v[18:19], v4 offset:24832
 v_accvgpr_read_b32 v55, a127
 v_mul_f32 v52, v48, v52
 v_mul_f32 v53, v49, v53
 v_mfma_f32_16x16x32_bf16 v[148:151], v[24:27], a[200:203], v[148:151]
 v_mul_f32 v54, v50, v54
 v_mul_f32 v55, v51, v55
 v_mfma_f32_16x16x32_bf16 v[152:155], v[24:27], a[208:211], v[152:155]
 ds_read_b64_tr_b16 v[20:21], v4 offset:26624
 v_fma_f32 v56, v56, s6, s6
 v_fma_f32 v57, v57, s6, s6
 v_mfma_f32_16x16x32_bf16 v[152:155], v[28:31], a[212:215], v[152:155]
 v_fma_f32 v58, v58, s6, s6
 v_fma_f32 v59, v59, s6, s6
 v_mfma_f32_16x16x32_bf16 v[156:159], v[28:31], a[220:223], v[156:159]
 ds_read_b64_tr_b16 v[22:23], v4 offset:26880
 v_rcp_f32 v56, v56
 v_rcp_f32 v57, v57
 v_mfma_f32_16x16x32_bf16 v[156:159], v[24:27], a[216:219], v[156:159]
 s_waitcnt lgkmcnt(8)
 v_rcp_f32 v58, v58
 v_rcp_f32 v59, v59
 v_mfma_f32_16x16x32_bf16 v[160:163], v[32:35], a[192:195], v[160:163]
 ds_read_b64_tr_b16 v[24:25], v5 offset:24576
 v_mul_f32 v52, v52, v56
 v_mul_f32 v53, v53, v57
 v_mul_f32 v54, v54, v58
 v_mfma_f32_16x16x32_bf16 v[160:163], v[36:39], a[196:199], v[160:163]
 v_mul_f32 v55, v55, v59
 v_cvt_pk_bf16_f32 v62, v52, v53
 v_mfma_f32_16x16x32_bf16 v[164:167], v[36:39], a[204:207], v[164:167]
 ds_read_b64_tr_b16 v[26:27], v5 offset:24832
 v_cvt_pk_bf16_f32 v63, v54, v55
 s_add_u32 s5, s4, 344064
 v_mfma_f32_16x16x32_bf16 v[164:167], v[32:35], a[200:203], v[164:167]
 buffer_store_dwordx4 v[60:63], v12, s[84:87], s5 offen sc1
 s_mul_i32 s4, s97, 4
 v_mfma_f32_16x16x32_bf16 v[168:171], v[32:35], a[208:211], v[168:171]
 ds_read_b64_tr_b16 v[28:29], v5 offset:26624
 s_add_u32 s4, s4, 2
 s_lshl_b32 s4, s4, 10
 v_mfma_f32_16x16x32_bf16 v[168:171], v[36:39], a[212:215], v[168:171]
 v_exp_f32 v48, -v64
 v_exp_f32 v49, -v65
 v_exp_f32 v50, -v66
 v_mfma_f32_16x16x32_bf16 v[172:175], v[36:39], a[220:223], v[172:175]
 ds_read_b64_tr_b16 v[30:31], v5 offset:26880
 v_exp_f32 v51, -v67
 v_exp_f32 v52, -v80
 v_mfma_f32_16x16x32_bf16 v[172:175], v[32:35], a[216:219], v[172:175]
 s_waitcnt lgkmcnt(8)
 v_exp_f32 v53, -v81
 v_exp_f32 v54, -v82
 v_mfma_f32_16x16x32_bf16 v[176:179], v[40:43], a[192:195], v[176:179]
 ds_read_b64_tr_b16 v[32:33], v4 offset:28672
 v_exp_f32 v55, -v83
 v_mul_f32 v96, v64, v96
 v_mfma_f32_16x16x32_bf16 v[176:179], v[44:47], a[196:199], v[176:179]
 v_mul_f32 v97, v65, v97
 v_mul_f32 v98, v66, v98
 v_mfma_f32_16x16x32_bf16 v[180:183], v[44:47], a[204:207], v[180:183]
 ds_read_b64_tr_b16 v[34:35], v4 offset:28928
 v_mul_f32 v99, v67, v99
 v_mul_f32 v112, v80, v112
 v_mul_f32 v113, v81, v113
 v_mfma_f32_16x16x32_bf16 v[180:183], v[40:43], a[200:203], v[180:183]
 v_mul_f32 v114, v82, v114
 v_mul_f32 v115, v83, v115
 v_mfma_f32_16x16x32_bf16 v[184:187], v[40:43], a[208:211], v[184:187]
 ds_read_b64_tr_b16 v[36:37], v4 offset:30720
 v_fma_f32 v48, v48, s6, s6
 v_fma_f32 v49, v49, s6, s6
 v_mfma_f32_16x16x32_bf16 v[184:187], v[44:47], a[212:215], v[184:187]
 v_fma_f32 v50, v50, s6, s6
 v_fma_f32 v51, v51, s6, s6
 v_mfma_f32_16x16x32_bf16 v[188:191], v[44:47], a[220:223], v[188:191]
 ds_read_b64_tr_b16 v[38:39], v4 offset:30976
 v_fma_f32 v52, v52, s6, s6
 v_fma_f32 v53, v53, s6, s6
 v_mfma_f32_16x16x32_bf16 v[188:191], v[40:43], a[216:219], v[188:191]
 s_waitcnt lgkmcnt(8)
 v_fma_f32 v54, v54, s6, s6
 v_fma_f32 v55, v55, s6, s6
 v_rcp_f32 v48, v48
 v_mfma_f32_16x16x32_bf16 v[128:131], v[16:19], a[224:227], v[128:131]
 ds_read_b64_tr_b16 v[40:41], v5 offset:28672
 v_rcp_f32 v49, v49
 v_rcp_f32 v50, v50
 v_mfma_f32_16x16x32_bf16 v[128:131], v[20:23], a[228:231], v[128:131]
 v_rcp_f32 v51, v51
 v_rcp_f32 v52, v52
 v_mfma_f32_16x16x32_bf16 v[132:135], v[20:23], a[236:239], v[132:135]
 ds_read_b64_tr_b16 v[42:43], v5 offset:28928
 v_rcp_f32 v53, v53
 v_rcp_f32 v54, v54
 v_mfma_f32_16x16x32_bf16 v[132:135], v[16:19], a[232:235], v[132:135]
 v_rcp_f32 v55, v55
 v_mul_f32 v96, v96, v48
 v_mfma_f32_16x16x32_bf16 v[136:139], v[16:19], a[240:243], v[136:139]
 ds_read_b64_tr_b16 v[44:45], v5 offset:30720
 v_mul_f32 v97, v97, v49
 v_mul_f32 v98, v98, v50
 v_mul_f32 v99, v99, v51
 v_mfma_f32_16x16x32_bf16 v[136:139], v[20:23], a[244:247], v[136:139]
 v_mul_f32 v112, v112, v52
 v_mul_f32 v113, v113, v53
 v_mfma_f32_16x16x32_bf16 v[140:143], v[20:23], a[252:255], v[140:143]
 ds_read_b64_tr_b16 v[46:47], v5 offset:30976
 v_mul_f32 v114, v114, v54
 v_mul_f32 v115, v115, v55
 v_mfma_f32_16x16x32_bf16 v[140:143], v[16:19], a[248:251], v[140:143]
 s_waitcnt lgkmcnt(8)
 v_cvt_pk_bf16_f32 v56, v96, v97
 v_cvt_pk_bf16_f32 v57, v98, v99
 v_mfma_f32_16x16x32_bf16 v[144:147], v[24:27], a[224:227], v[144:147]
 ds_read_b64_tr_b16 v[16:17], v6 offset:32768
 v_cvt_pk_bf16_f32 v58, v112, v113
 v_cvt_pk_bf16_f32 v59, v114, v115
 v_mfma_f32_16x16x32_bf16 v[144:147], v[28:31], a[228:231], v[144:147]
 s_add_u32 s5, s4, 0
 buffer_store_dwordx4 v[56:59], v12, s[84:87], s5 offen sc1
 v_exp_f32 v48, -v68
 v_mfma_f32_16x16x32_bf16 v[148:151], v[28:31], a[236:239], v[148:151]
 ds_read_b64_tr_b16 v[18:19], v6 offset:33024
 v_exp_f32 v49, -v69
 v_exp_f32 v50, -v70
 v_mfma_f32_16x16x32_bf16 v[148:151], v[24:27], a[232:235], v[148:151]
 v_exp_f32 v51, -v71
 v_exp_f32 v52, -v84
 v_mfma_f32_16x16x32_bf16 v[152:155], v[24:27], a[240:243], v[152:155]
 ds_read_b64_tr_b16 v[20:21], v6 offset:34816
 v_exp_f32 v53, -v85
 v_exp_f32 v54, -v86
 v_mfma_f32_16x16x32_bf16 v[152:155], v[28:31], a[244:247], v[152:155]
 v_exp_f32 v55, -v87
 v_mul_f32 v100, v68, v100
 v_mfma_f32_16x16x32_bf16 v[156:159], v[28:31], a[252:255], v[156:159]
 ds_read_b64_tr_b16 v[22:23], v6 offset:35072
 v_mul_f32 v101, v69, v101
 v_mul_f32 v102, v70, v102
 v_mul_f32 v103, v71, v103
 v_mfma_f32_16x16x32_bf16 v[156:159], v[24:27], a[248:251], v[156:159]
 s_waitcnt lgkmcnt(8)
 v_mul_f32 v116, v84, v116
 v_mul_f32 v117, v85, v117
 v_mfma_f32_16x16x32_bf16 v[160:163], v[32:35], a[224:227], v[160:163]
 ds_read_b64_tr_b16 v[24:25], v7 offset:32768
 v_mul_f32 v118, v86, v118
 v_mul_f32 v119, v87, v119
 v_mfma_f32_16x16x32_bf16 v[160:163], v[36:39], a[228:231], v[160:163]
 v_fma_f32 v48, v48, s6, s6
 v_fma_f32 v49, v49, s6, s6
 v_mfma_f32_16x16x32_bf16 v[164:167], v[36:39], a[236:239], v[164:167]
 ds_read_b64_tr_b16 v[26:27], v7 offset:33024
 v_fma_f32 v50, v50, s6, s6
 v_fma_f32 v51, v51, s6, s6
 v_mfma_f32_16x16x32_bf16 v[164:167], v[32:35], a[232:235], v[164:167]
 v_fma_f32 v52, v52, s6, s6
 v_fma_f32 v53, v53, s6, s6
 v_fma_f32 v54, v54, s6, s6
 v_mfma_f32_16x16x32_bf16 v[168:171], v[32:35], a[240:243], v[168:171]
 ds_read_b64_tr_b16 v[28:29], v7 offset:34816
 v_fma_f32 v55, v55, s6, s6
 v_rcp_f32 v48, v48
 v_mfma_f32_16x16x32_bf16 v[168:171], v[36:39], a[244:247], v[168:171]
 v_rcp_f32 v49, v49
 v_rcp_f32 v50, v50
 v_mfma_f32_16x16x32_bf16 v[172:175], v[36:39], a[252:255], v[172:175]
 ds_read_b64_tr_b16 v[30:31], v7 offset:35072
 v_rcp_f32 v51, v51
 v_rcp_f32 v52, v52
 v_mfma_f32_16x16x32_bf16 v[172:175], v[32:35], a[248:251], v[172:175]
 s_waitcnt lgkmcnt(8)
 v_rcp_f32 v53, v53
 v_rcp_f32 v54, v54
 v_mfma_f32_16x16x32_bf16 v[176:179], v[40:43], a[224:227], v[176:179]
 ds_read_b64_tr_b16 v[32:33], v6 offset:36864
 v_rcp_f32 v55, v55
 v_mul_f32 v100, v100, v48
 v_mfma_f32_16x16x32_bf16 v[176:179], v[44:47], a[228:231], v[176:179]
 v_mul_f32 v101, v101, v49
 v_mul_f32 v102, v102, v50
 v_mul_f32 v103, v103, v51
 v_mfma_f32_16x16x32_bf16 v[180:183], v[44:47], a[236:239], v[180:183]
 ds_read_b64_tr_b16 v[34:35], v6 offset:37120
 v_mul_f32 v116, v116, v52
 v_mul_f32 v117, v117, v53
 v_mfma_f32_16x16x32_bf16 v[180:183], v[40:43], a[232:235], v[180:183]
 v_mul_f32 v118, v118, v54
 v_mul_f32 v119, v119, v55
 v_mfma_f32_16x16x32_bf16 v[184:187], v[40:43], a[240:243], v[184:187]
 ds_read_b64_tr_b16 v[36:37], v6 offset:38912
 v_cvt_pk_bf16_f32 v60, v100, v101
 v_cvt_pk_bf16_f32 v61, v102, v103
 v_mfma_f32_16x16x32_bf16 v[184:187], v[44:47], a[244:247], v[184:187]
 v_cvt_pk_bf16_f32 v62, v116, v117
 v_cvt_pk_bf16_f32 v63, v118, v119
 v_mfma_f32_16x16x32_bf16 v[188:191], v[44:47], a[252:255], v[188:191]
 ds_read_b64_tr_b16 v[38:39], v6 offset:39168
 s_add_u32 s5, s4, 114688
 buffer_store_dwordx4 v[60:63], v12, s[84:87], s5 offen sc1
 v_exp_f32 v48, -v72
 v_mfma_f32_16x16x32_bf16 v[188:191], v[40:43], a[248:251], v[188:191]
 s_waitcnt lgkmcnt(8)
 v_exp_f32 v49, -v73
 v_exp_f32 v50, -v74
 v_mfma_f32_16x16x32_bf16 v[192:195], v[16:19], a[128:131], v[192:195]
 ds_read_b64_tr_b16 v[40:41], v7 offset:36864
 v_exp_f32 v51, -v75
 v_exp_f32 v52, -v88
 v_mfma_f32_16x16x32_bf16 v[192:195], v[20:23], a[132:135], v[192:195]
 v_exp_f32 v53, -v89
 v_exp_f32 v54, -v90
 v_mfma_f32_16x16x32_bf16 v[196:199], v[20:23], a[140:143], v[196:199]
 ds_read_b64_tr_b16 v[42:43], v7 offset:37120
 v_exp_f32 v55, -v91
 v_mul_f32 v104, v72, v104
 v_mfma_f32_16x16x32_bf16 v[196:199], v[16:19], a[136:139], v[196:199]
 v_mul_f32 v105, v73, v105
 v_mul_f32 v106, v74, v106
 v_mul_f32 v107, v75, v107
 v_mfma_f32_16x16x32_bf16 v[200:203], v[16:19], a[144:147], v[200:203]
 ds_read_b64_tr_b16 v[44:45], v7 offset:38912
 v_mul_f32 v120, v88, v120
 v_mul_f32 v121, v89, v121
 v_mfma_f32_16x16x32_bf16 v[200:203], v[20:23], a[148:151], v[200:203]
 v_mul_f32 v122, v90, v122
 v_mul_f32 v123, v91, v123
 v_mfma_f32_16x16x32_bf16 v[204:207], v[20:23], a[156:159], v[204:207]
 ds_read_b64_tr_b16 v[46:47], v7 offset:39168
 v_fma_f32 v48, v48, s6, s6
 v_fma_f32 v49, v49, s6, s6
 v_mfma_f32_16x16x32_bf16 v[204:207], v[16:19], a[152:155], v[204:207]
 s_waitcnt lgkmcnt(8)
 v_fma_f32 v50, v50, s6, s6
 v_fma_f32 v51, v51, s6, s6
 v_mfma_f32_16x16x32_bf16 v[208:211], v[24:27], a[128:131], v[208:211]
 ds_read_b64_tr_b16 v[16:17], v8 offset:32768
 v_fma_f32 v52, v52, s6, s6
 v_fma_f32 v53, v53, s6, s6
 v_fma_f32 v54, v54, s6, s6
 v_mfma_f32_16x16x32_bf16 v[208:211], v[28:31], a[132:135], v[208:211]
 v_fma_f32 v55, v55, s6, s6
 v_rcp_f32 v48, v48
 v_mfma_f32_16x16x32_bf16 v[212:215], v[28:31], a[140:143], v[212:215]
 ds_read_b64_tr_b16 v[18:19], v8 offset:33024
 v_rcp_f32 v49, v49
 v_rcp_f32 v50, v50
 v_mfma_f32_16x16x32_bf16 v[212:215], v[24:27], a[136:139], v[212:215]
 v_rcp_f32 v51, v51
 v_rcp_f32 v52, v52
 v_mfma_f32_16x16x32_bf16 v[216:219], v[24:27], a[144:147], v[216:219]
 ds_read_b64_tr_b16 v[20:21], v8 offset:34816
 v_rcp_f32 v53, v53
 v_rcp_f32 v54, v54
 v_mfma_f32_16x16x32_bf16 v[216:219], v[28:31], a[148:151], v[216:219]
 v_rcp_f32 v55, v55
 v_mul_f32 v104, v104, v48
 v_mul_f32 v105, v105, v49
 v_mfma_f32_16x16x32_bf16 v[220:223], v[28:31], a[156:159], v[220:223]
 ds_read_b64_tr_b16 v[22:23], v8 offset:35072
 v_mul_f32 v106, v106, v50
 v_mul_f32 v107, v107, v51
 v_mfma_f32_16x16x32_bf16 v[220:223], v[24:27], a[152:155], v[220:223]
 s_waitcnt lgkmcnt(8)
 v_mul_f32 v120, v120, v52
 v_mul_f32 v121, v121, v53
 v_mfma_f32_16x16x32_bf16 v[224:227], v[32:35], a[128:131], v[224:227]
 ds_read_b64_tr_b16 v[24:25], v9 offset:32768
 v_mul_f32 v122, v122, v54
 v_mul_f32 v123, v123, v55
 v_mfma_f32_16x16x32_bf16 v[224:227], v[36:39], a[132:135], v[224:227]
 v_cvt_pk_bf16_f32 v56, v104, v105
 v_cvt_pk_bf16_f32 v57, v106, v107
 v_mfma_f32_16x16x32_bf16 v[228:231], v[36:39], a[140:143], v[228:231]
 ds_read_b64_tr_b16 v[26:27], v9 offset:33024
 v_cvt_pk_bf16_f32 v58, v120, v121
 v_cvt_pk_bf16_f32 v59, v122, v123
 s_add_u32 s5, s4, 229376
 v_mfma_f32_16x16x32_bf16 v[228:231], v[32:35], a[136:139], v[228:231]
 buffer_store_dwordx4 v[56:59], v12, s[84:87], s5 offen sc1
 v_exp_f32 v48, -v76
 v_mfma_f32_16x16x32_bf16 v[232:235], v[32:35], a[144:147], v[232:235]
 ds_read_b64_tr_b16 v[28:29], v9 offset:34816
 v_exp_f32 v49, -v77
 v_exp_f32 v50, -v78
 v_mfma_f32_16x16x32_bf16 v[232:235], v[36:39], a[148:151], v[232:235]
 v_exp_f32 v51, -v79
 v_exp_f32 v52, -v92
 v_mfma_f32_16x16x32_bf16 v[236:239], v[36:39], a[156:159], v[236:239]
 ds_read_b64_tr_b16 v[30:31], v9 offset:35072
 v_exp_f32 v53, -v93
 v_exp_f32 v54, -v94
 v_mfma_f32_16x16x32_bf16 v[236:239], v[32:35], a[152:155], v[236:239]
 s_waitcnt lgkmcnt(8)
 v_exp_f32 v55, -v95
 v_mul_f32 v108, v76, v108
 v_mul_f32 v109, v77, v109
 v_mfma_f32_16x16x32_bf16 v[240:243], v[40:43], a[128:131], v[240:243]
 ds_read_b64_tr_b16 v[32:33], v8 offset:36864
 v_mul_f32 v110, v78, v110
 v_mul_f32 v111, v79, v111
 v_mfma_f32_16x16x32_bf16 v[240:243], v[44:47], a[132:135], v[240:243]
 v_mul_f32 v124, v92, v124
 v_mul_f32 v125, v93, v125
 v_mfma_f32_16x16x32_bf16 v[244:247], v[44:47], a[140:143], v[244:247]
 ds_read_b64_tr_b16 v[34:35], v8 offset:37120
 v_mul_f32 v126, v94, v126
 v_mul_f32 v127, v95, v127
 v_mfma_f32_16x16x32_bf16 v[244:247], v[40:43], a[136:139], v[244:247]
 v_fma_f32 v48, v48, s6, s6
 v_fma_f32 v49, v49, s6, s6
 v_mfma_f32_16x16x32_bf16 v[248:251], v[40:43], a[144:147], v[248:251]
 ds_read_b64_tr_b16 v[36:37], v8 offset:38912
 v_fma_f32 v50, v50, s6, s6
 v_fma_f32 v51, v51, s6, s6
 v_fma_f32 v52, v52, s6, s6
 v_mfma_f32_16x16x32_bf16 v[248:251], v[44:47], a[148:151], v[248:251]
 v_fma_f32 v53, v53, s6, s6
 v_fma_f32 v54, v54, s6, s6
 v_mfma_f32_16x16x32_bf16 v[252:255], v[44:47], a[156:159], v[252:255]
 ds_read_b64_tr_b16 v[38:39], v8 offset:39168
 v_fma_f32 v55, v55, s6, s6
 v_rcp_f32 v48, v48
 v_mfma_f32_16x16x32_bf16 v[252:255], v[40:43], a[152:155], v[252:255]
 s_waitcnt lgkmcnt(8)
 v_rcp_f32 v49, v49
 v_rcp_f32 v50, v50
 v_mfma_f32_16x16x32_bf16 v[192:195], v[16:19], a[160:163], v[192:195]
 ds_read_b64_tr_b16 v[40:41], v9 offset:36864
 v_rcp_f32 v51, v51
 v_rcp_f32 v52, v52
 v_mfma_f32_16x16x32_bf16 v[192:195], v[20:23], a[164:167], v[192:195]
 v_rcp_f32 v53, v53
 v_rcp_f32 v54, v54
 v_rcp_f32 v55, v55
 v_mfma_f32_16x16x32_bf16 v[196:199], v[20:23], a[172:175], v[196:199]
 ds_read_b64_tr_b16 v[42:43], v9 offset:37120
 v_mul_f32 v108, v108, v48
 v_mul_f32 v109, v109, v49
 v_mfma_f32_16x16x32_bf16 v[196:199], v[16:19], a[168:171], v[196:199]
 v_mul_f32 v110, v110, v50
 v_mul_f32 v111, v111, v51
 v_mfma_f32_16x16x32_bf16 v[200:203], v[16:19], a[176:179], v[200:203]
 ds_read_b64_tr_b16 v[44:45], v9 offset:38912
 v_mul_f32 v124, v124, v52
 v_mul_f32 v125, v125, v53
 v_mfma_f32_16x16x32_bf16 v[200:203], v[20:23], a[180:183], v[200:203]
 v_mul_f32 v126, v126, v54
 v_mul_f32 v127, v127, v55
 v_mfma_f32_16x16x32_bf16 v[204:207], v[20:23], a[188:191], v[204:207]
 ds_read_b64_tr_b16 v[46:47], v9 offset:39168
 v_cvt_pk_bf16_f32 v60, v108, v109
 v_cvt_pk_bf16_f32 v61, v110, v111
 v_mfma_f32_16x16x32_bf16 v[204:207], v[16:19], a[184:187], v[204:207]
 s_waitcnt lgkmcnt(8)
 v_cvt_pk_bf16_f32 v62, v124, v125
 v_cvt_pk_bf16_f32 v63, v126, v127
 s_add_u32 s5, s4, 344064
 v_mfma_f32_16x16x32_bf16 v[208:211], v[24:27], a[160:163], v[208:211]
 ds_read_b64_tr_b16 v[16:17], v10 offset:32768
 buffer_store_dwordx4 v[60:63], v12, s[84:87], s5 offen sc1
 s_mul_i32 s4, s97, 4
 v_mfma_f32_16x16x32_bf16 v[208:211], v[28:31], a[164:167], v[208:211]
 s_add_u32 s4, s4, 3
 s_lshl_b32 s4, s4, 10
 v_mfma_f32_16x16x32_bf16 v[212:215], v[28:31], a[172:175], v[212:215]
 ds_read_b64_tr_b16 v[18:19], v10 offset:33024
 v_exp_f32 v48, -v128
 v_exp_f32 v49, -v129
 v_mfma_f32_16x16x32_bf16 v[212:215], v[24:27], a[168:171], v[212:215]
 v_exp_f32 v50, -v130
 v_exp_f32 v51, -v131
 v_mfma_f32_16x16x32_bf16 v[216:219], v[24:27], a[176:179], v[216:219]
 ds_read_b64_tr_b16 v[20:21], v10 offset:34816
 v_exp_f32 v52, -v144
 v_exp_f32 v53, -v145
 v_exp_f32 v54, -v146
 v_mfma_f32_16x16x32_bf16 v[216:219], v[28:31], a[180:183], v[216:219]
 v_exp_f32 v55, -v147
 v_mul_f32 v160, v128, v160
 v_mfma_f32_16x16x32_bf16 v[220:223], v[28:31], a[188:191], v[220:223]
 ds_read_b64_tr_b16 v[22:23], v10 offset:35072
 v_mul_f32 v161, v129, v161
 v_mul_f32 v162, v130, v162
 v_mfma_f32_16x16x32_bf16 v[220:223], v[24:27], a[184:187], v[220:223]
 s_waitcnt lgkmcnt(8)
 v_mul_f32 v163, v131, v163
 v_mul_f32 v176, v144, v176
 v_mfma_f32_16x16x32_bf16 v[224:227], v[32:35], a[160:163], v[224:227]
 ds_read_b64_tr_b16 v[24:25], v11 offset:32768
 v_mul_f32 v177, v145, v177
 v_mul_f32 v178, v146, v178
 v_mfma_f32_16x16x32_bf16 v[224:227], v[36:39], a[164:167], v[224:227]
 v_mul_f32 v179, v147, v179
 v_fma_f32 v48, v48, s6, s6
 v_fma_f32 v49, v49, s6, s6
 v_mfma_f32_16x16x32_bf16 v[228:231], v[36:39], a[172:175], v[228:231]
 ds_read_b64_tr_b16 v[26:27], v11 offset:33024
 v_fma_f32 v50, v50, s6, s6
 v_fma_f32 v51, v51, s6, s6
 v_mfma_f32_16x16x32_bf16 v[228:231], v[32:35], a[168:171], v[228:231]
 v_fma_f32 v52, v52, s6, s6
 v_fma_f32 v53, v53, s6, s6
 v_mfma_f32_16x16x32_bf16 v[232:235], v[32:35], a[176:179], v[232:235]
 ds_read_b64_tr_b16 v[28:29], v11 offset:34816
 v_fma_f32 v54, v54, s6, s6
 v_fma_f32 v55, v55, s6, s6
 v_mfma_f32_16x16x32_bf16 v[232:235], v[36:39], a[180:183], v[232:235]
 v_rcp_f32 v48, v48
 v_rcp_f32 v49, v49
 v_mfma_f32_16x16x32_bf16 v[236:239], v[36:39], a[188:191], v[236:239]
 ds_read_b64_tr_b16 v[30:31], v11 offset:35072
 v_rcp_f32 v50, v50
 v_rcp_f32 v51, v51
 v_rcp_f32 v52, v52
 v_mfma_f32_16x16x32_bf16 v[236:239], v[32:35], a[184:187], v[236:239]
 s_waitcnt lgkmcnt(8)
 v_rcp_f32 v53, v53
 v_rcp_f32 v54, v54
 v_mfma_f32_16x16x32_bf16 v[240:243], v[40:43], a[160:163], v[240:243]
 ds_read_b64_tr_b16 v[32:33], v10 offset:36864
 v_rcp_f32 v55, v55
 v_mul_f32 v160, v160, v48
 v_mfma_f32_16x16x32_bf16 v[240:243], v[44:47], a[164:167], v[240:243]
 v_mul_f32 v161, v161, v49
 v_mul_f32 v162, v162, v50
 v_mfma_f32_16x16x32_bf16 v[244:247], v[44:47], a[172:175], v[244:247]
 ds_read_b64_tr_b16 v[34:35], v10 offset:37120
 v_mul_f32 v163, v163, v51
 v_mul_f32 v176, v176, v52
 v_mfma_f32_16x16x32_bf16 v[244:247], v[40:43], a[168:171], v[244:247]
 v_mul_f32 v177, v177, v53
 v_mul_f32 v178, v178, v54
 v_mul_f32 v179, v179, v55
 v_mfma_f32_16x16x32_bf16 v[248:251], v[40:43], a[176:179], v[248:251]
 ds_read_b64_tr_b16 v[36:37], v10 offset:38912
 v_cvt_pk_bf16_f32 v56, v160, v161
 v_cvt_pk_bf16_f32 v57, v162, v163
 v_mfma_f32_16x16x32_bf16 v[248:251], v[44:47], a[180:183], v[248:251]
 v_cvt_pk_bf16_f32 v58, v176, v177
 v_cvt_pk_bf16_f32 v59, v178, v179
 v_mfma_f32_16x16x32_bf16 v[252:255], v[44:47], a[188:191], v[252:255]
 ds_read_b64_tr_b16 v[38:39], v10 offset:39168
 s_add_u32 s5, s4, 0
 buffer_store_dwordx4 v[56:59], v12, s[84:87], s5 offen sc1
 v_mfma_f32_16x16x32_bf16 v[252:255], v[40:43], a[184:187], v[252:255]
 s_waitcnt lgkmcnt(8)
 v_exp_f32 v48, -v132
 v_exp_f32 v49, -v133
 v_mfma_f32_16x16x32_bf16 v[192:195], v[16:19], a[192:195], v[192:195]
 ds_read_b64_tr_b16 v[40:41], v11 offset:36864
 v_exp_f32 v50, -v134
 v_exp_f32 v51, -v135
 v_exp_f32 v52, -v148
 v_mfma_f32_16x16x32_bf16 v[192:195], v[20:23], a[196:199], v[192:195]
 v_exp_f32 v53, -v149
 v_exp_f32 v54, -v150
 v_mfma_f32_16x16x32_bf16 v[196:199], v[20:23], a[204:207], v[196:199]
 ds_read_b64_tr_b16 v[42:43], v11 offset:37120
 v_exp_f32 v55, -v151
 v_mul_f32 v164, v132, v164
 v_mfma_f32_16x16x32_bf16 v[196:199], v[16:19], a[200:203], v[196:199]
 v_mul_f32 v165, v133, v165
 v_mul_f32 v166, v134, v166
 v_mfma_f32_16x16x32_bf16 v[200:203], v[16:19], a[208:211], v[200:203]
 ds_read_b64_tr_b16 v[44:45], v11 offset:38912
 v_mul_f32 v167, v135, v167
 v_mul_f32 v180, v148, v180
 v_mfma_f32_16x16x32_bf16 v[200:203], v[20:23], a[212:215], v[200:203]
 v_mul_f32 v181, v149, v181
 v_mul_f32 v182, v150, v182
 v_mul_f32 v183, v151, v183
 v_mfma_f32_16x16x32_bf16 v[204:207], v[20:23], a[220:223], v[204:207]
 ds_read_b64_tr_b16 v[46:47], v11 offset:39168
 v_fma_f32 v48, v48, s6, s6
 v_fma_f32 v49, v49, s6, s6
 v_mfma_f32_16x16x32_bf16 v[204:207], v[16:19], a[216:219], v[204:207]
 s_waitcnt lgkmcnt(8)
 v_fma_f32 v50, v50, s6, s6
 v_fma_f32 v51, v51, s6, s6
 v_mfma_f32_16x16x32_bf16 v[208:211], v[24:27], a[192:195], v[208:211]
 ds_read_b64_tr_b16 v[16:17], v4 offset:32768
 v_fma_f32 v52, v52, s6, s6
 v_fma_f32 v53, v53, s6, s6
 v_mfma_f32_16x16x32_bf16 v[208:211], v[28:31], a[196:199], v[208:211]
 v_fma_f32 v54, v54, s6, s6
 v_fma_f32 v55, v55, s6, s6
 v_mfma_f32_16x16x32_bf16 v[212:215], v[28:31], a[204:207], v[212:215]
 ds_read_b64_tr_b16 v[18:19], v4 offset:33024
 v_rcp_f32 v48, v48
 v_rcp_f32 v49, v49
 v_rcp_f32 v50, v50
 v_mfma_f32_16x16x32_bf16 v[212:215], v[24:27], a[200:203], v[212:215]
 v_rcp_f32 v51, v51
 v_rcp_f32 v52, v52
 v_mfma_f32_16x16x32_bf16 v[216:219], v[24:27], a[208:211], v[216:219]
 ds_read_b64_tr_b16 v[20:21], v4 offset:34816
 v_rcp_f32 v53, v53
 v_rcp_f32 v54, v54
 v_mfma_f32_16x16x32_bf16 v[216:219], v[28:31], a[212:215], v[216:219]
 v_rcp_f32 v55, v55
 v_mul_f32 v164, v164, v48
 v_mfma_f32_16x16x32_bf16 v[220:223], v[28:31], a[220:223], v[220:223]
 ds_read_b64_tr_b16 v[22:23], v4 offset:35072
 v_mul_f32 v165, v165, v49
 v_mul_f32 v166, v166, v50
 v_mfma_f32_16x16x32_bf16 v[220:223], v[24:27], a[216:219], v[220:223]
 s_waitcnt lgkmcnt(8)
 v_mul_f32 v167, v167, v51
 v_mul_f32 v180, v180, v52
 v_mul_f32 v181, v181, v53
 v_mfma_f32_16x16x32_bf16 v[224:227], v[32:35], a[192:195], v[224:227]
 ds_read_b64_tr_b16 v[24:25], v5 offset:32768
 v_mul_f32 v182, v182, v54
 v_mul_f32 v183, v183, v55
 v_mfma_f32_16x16x32_bf16 v[224:227], v[36:39], a[196:199], v[224:227]
 v_cvt_pk_bf16_f32 v60, v164, v165
 v_cvt_pk_bf16_f32 v61, v166, v167
 v_mfma_f32_16x16x32_bf16 v[228:231], v[36:39], a[204:207], v[228:231]
 ds_read_b64_tr_b16 v[26:27], v5 offset:33024
 v_cvt_pk_bf16_f32 v62, v180, v181
 v_cvt_pk_bf16_f32 v63, v182, v183
 v_mfma_f32_16x16x32_bf16 v[228:231], v[32:35], a[200:203], v[228:231]
 s_add_u32 s5, s4, 114688
 buffer_store_dwordx4 v[60:63], v12, s[84:87], s5 offen sc1
 v_mfma_f32_16x16x32_bf16 v[232:235], v[32:35], a[208:211], v[232:235]
 ds_read_b64_tr_b16 v[28:29], v5 offset:34816
 v_exp_f32 v48, -v136
 v_exp_f32 v49, -v137
 v_mfma_f32_16x16x32_bf16 v[232:235], v[36:39], a[212:215], v[232:235]
 v_exp_f32 v50, -v138
 v_exp_f32 v51, -v139
 v_exp_f32 v52, -v152
 v_mfma_f32_16x16x32_bf16 v[236:239], v[36:39], a[220:223], v[236:239]
 ds_read_b64_tr_b16 v[30:31], v5 offset:35072
 v_exp_f32 v53, -v153
 v_exp_f32 v54, -v154
 v_mfma_f32_16x16x32_bf16 v[236:239], v[32:35], a[216:219], v[236:239]
 s_waitcnt lgkmcnt(8)
 v_exp_f32 v55, -v155
 v_mul_f32 v168, v136, v168
 v_mfma_f32_16x16x32_bf16 v[240:243], v[40:43], a[192:195], v[240:243]
 ds_read_b64_tr_b16 v[32:33], v4 offset:36864
 v_mul_f32 v169, v137, v169
 v_mul_f32 v170, v138, v170
 v_mfma_f32_16x16x32_bf16 v[240:243], v[44:47], a[196:199], v[240:243]
 v_mul_f32 v171, v139, v171
 v_mul_f32 v184, v152, v184
 v_mfma_f32_16x16x32_bf16 v[244:247], v[44:47], a[204:207], v[244:247]
 ds_read_b64_tr_b16 v[34:35], v4 offset:37120
 v_mul_f32 v185, v153, v185
 v_mul_f32 v186, v154, v186
 v_mul_f32 v187, v155, v187
 v_mfma_f32_16x16x32_bf16 v[244:247], v[40:43], a[200:203], v[244:247]
 v_fma_f32 v48, v48, s6, s6
 v_fma_f32 v49, v49, s6, s6
 v_mfma_f32_16x16x32_bf16 v[248:251], v[40:43], a[208:211], v[248:251]
 ds_read_b64_tr_b16 v[36:37], v4 offset:38912
 v_fma_f32 v50, v50, s6, s6
 v_fma_f32 v51, v51, s6, s6
 v_mfma_f32_16x16x32_bf16 v[248:251], v[44:47], a[212:215], v[248:251]
 v_fma_f32 v52, v52, s6, s6
 v_fma_f32 v53, v53, s6, s6
 v_mfma_f32_16x16x32_bf16 v[252:255], v[44:47], a[220:223], v[252:255]
 ds_read_b64_tr_b16 v[38:39], v4 offset:39168
 v_fma_f32 v54, v54, s6, s6
 v_fma_f32 v55, v55, s6, s6
 v_mfma_f32_16x16x32_bf16 v[252:255], v[40:43], a[216:219], v[252:255]
 s_waitcnt lgkmcnt(8)
 v_rcp_f32 v48, v48
 v_rcp_f32 v49, v49
 v_rcp_f32 v50, v50
 v_mfma_f32_16x16x32_bf16 v[192:195], v[16:19], a[224:227], v[192:195]
 ds_read_b64_tr_b16 v[40:41], v5 offset:36864
 v_rcp_f32 v51, v51
 v_rcp_f32 v52, v52
 v_mfma_f32_16x16x32_bf16 v[192:195], v[20:23], a[228:231], v[192:195]
 v_rcp_f32 v53, v53
 v_rcp_f32 v54, v54
 v_mfma_f32_16x16x32_bf16 v[196:199], v[20:23], a[236:239], v[196:199]
 ds_read_b64_tr_b16 v[42:43], v5 offset:37120
 v_rcp_f32 v55, v55
 v_mul_f32 v168, v168, v48
 v_mfma_f32_16x16x32_bf16 v[196:199], v[16:19], a[232:235], v[196:199]
 v_mul_f32 v169, v169, v49
 v_mul_f32 v170, v170, v50
 v_mfma_f32_16x16x32_bf16 v[200:203], v[16:19], a[240:243], v[200:203]
 ds_read_b64_tr_b16 v[44:45], v5 offset:38912
 v_mul_f32 v171, v171, v51
 v_mul_f32 v184, v184, v52
 v_mul_f32 v185, v185, v53
 v_mfma_f32_16x16x32_bf16 v[200:203], v[20:23], a[244:247], v[200:203]
 v_mul_f32 v186, v186, v54
 v_mul_f32 v187, v187, v55
 v_mfma_f32_16x16x32_bf16 v[204:207], v[20:23], a[252:255], v[204:207]
 ds_read_b64_tr_b16 v[46:47], v5 offset:39168
 v_cvt_pk_bf16_f32 v56, v168, v169
 v_cvt_pk_bf16_f32 v57, v170, v171
 v_mfma_f32_16x16x32_bf16 v[204:207], v[16:19], a[248:251], v[204:207]
 s_waitcnt lgkmcnt(8)
 v_cvt_pk_bf16_f32 v58, v184, v185
 v_cvt_pk_bf16_f32 v59, v186, v187
 v_mfma_f32_16x16x32_bf16 v[208:211], v[24:27], a[224:227], v[208:211]
 s_add_u32 s5, s4, 229376
 buffer_store_dwordx4 v[56:59], v12, s[84:87], s5 offen sc1
 v_mfma_f32_16x16x32_bf16 v[208:211], v[28:31], a[228:231], v[208:211]
 v_exp_f32 v48, -v140
 v_exp_f32 v49, -v141
 v_exp_f32 v50, -v142
 v_mfma_f32_16x16x32_bf16 v[212:215], v[28:31], a[236:239], v[212:215]
 v_exp_f32 v51, -v143
 v_exp_f32 v52, -v156
 v_mfma_f32_16x16x32_bf16 v[212:215], v[24:27], a[232:235], v[212:215]
 v_exp_f32 v53, -v157
 v_exp_f32 v54, -v158
 v_mfma_f32_16x16x32_bf16 v[216:219], v[24:27], a[240:243], v[216:219]
 v_exp_f32 v55, -v159
 v_mul_f32 v172, v140, v172
 v_mfma_f32_16x16x32_bf16 v[216:219], v[28:31], a[244:247], v[216:219]
 v_mul_f32 v173, v141, v173
 v_mul_f32 v174, v142, v174
 v_mfma_f32_16x16x32_bf16 v[220:223], v[28:31], a[252:255], v[220:223]
 v_mul_f32 v175, v143, v175
 v_mul_f32 v188, v156, v188
 v_mul_f32 v189, v157, v189
 v_mfma_f32_16x16x32_bf16 v[220:223], v[24:27], a[248:251], v[220:223]
 s_waitcnt lgkmcnt(4)
 v_mul_f32 v190, v158, v190
 v_mul_f32 v191, v159, v191
 v_mfma_f32_16x16x32_bf16 v[224:227], v[32:35], a[224:227], v[224:227]
 v_fma_f32 v48, v48, s6, s6
 v_fma_f32 v49, v49, s6, s6
 v_mfma_f32_16x16x32_bf16 v[224:227], v[36:39], a[228:231], v[224:227]
 v_fma_f32 v50, v50, s6, s6
 v_fma_f32 v51, v51, s6, s6
 v_mfma_f32_16x16x32_bf16 v[228:231], v[36:39], a[236:239], v[228:231]
 v_fma_f32 v52, v52, s6, s6
 v_fma_f32 v53, v53, s6, s6
 v_mfma_f32_16x16x32_bf16 v[228:231], v[32:35], a[232:235], v[228:231]
 v_fma_f32 v54, v54, s6, s6
 v_fma_f32 v55, v55, s6, s6
 v_rcp_f32 v48, v48
 v_mfma_f32_16x16x32_bf16 v[232:235], v[32:35], a[240:243], v[232:235]
 v_rcp_f32 v49, v49
 v_rcp_f32 v50, v50
 v_mfma_f32_16x16x32_bf16 v[232:235], v[36:39], a[244:247], v[232:235]
 v_rcp_f32 v51, v51
 v_rcp_f32 v52, v52
 v_mfma_f32_16x16x32_bf16 v[236:239], v[36:39], a[252:255], v[236:239]
 v_rcp_f32 v53, v53
 v_rcp_f32 v54, v54
 v_mfma_f32_16x16x32_bf16 v[236:239], v[32:35], a[248:251], v[236:239]
 s_waitcnt lgkmcnt(0)
 v_rcp_f32 v55, v55
 v_mul_f32 v172, v172, v48
 v_mfma_f32_16x16x32_bf16 v[240:243], v[40:43], a[224:227], v[240:243]
 v_mul_f32 v173, v173, v49
 v_mul_f32 v174, v174, v50
 v_mul_f32 v175, v175, v51
 v_mfma_f32_16x16x32_bf16 v[240:243], v[44:47], a[228:231], v[240:243]
 v_mul_f32 v188, v188, v52
 v_mul_f32 v189, v189, v53
 v_mfma_f32_16x16x32_bf16 v[244:247], v[44:47], a[236:239], v[244:247]
 v_mul_f32 v190, v190, v54
 v_mul_f32 v191, v191, v55
 v_mfma_f32_16x16x32_bf16 v[244:247], v[40:43], a[232:235], v[244:247]
 v_cvt_pk_bf16_f32 v60, v172, v173
 v_cvt_pk_bf16_f32 v61, v174, v175
 v_mfma_f32_16x16x32_bf16 v[248:251], v[40:43], a[240:243], v[248:251]
 v_cvt_pk_bf16_f32 v62, v188, v189
 v_cvt_pk_bf16_f32 v63, v190, v191
 v_mfma_f32_16x16x32_bf16 v[248:251], v[44:47], a[244:247], v[248:251]
 s_add_u32 s5, s4, 344064
 buffer_store_dwordx4 v[60:63], v12, s[84:87], s5 offen sc1
 v_mfma_f32_16x16x32_bf16 v[252:255], v[44:47], a[252:255], v[252:255]
 v_mfma_f32_16x16x32_bf16 v[252:255], v[40:43], a[248:251], v[252:255]
 s_nop 7
 s_mov_b32 s7, s6
 s_mul_i32 s4, s97, 1
 s_add_u32 s4, s4, 90
 s_lshl_b32 s4, s4, 10
 v_exp_f32 v48, -v192
 v_exp_f32 v49, -v193
 v_exp_f32 v50, -v194
 v_exp_f32 v51, -v195
 v_exp_f32 v52, -v208
 v_exp_f32 v53, -v209
 v_exp_f32 v54, -v210
 v_exp_f32 v55, -v211
 v_pk_mul_f32 v[224:225], v[192:193], v[224:225]
 v_pk_mul_f32 v[226:227], v[194:195], v[226:227]
 v_pk_mul_f32 v[240:241], v[208:209], v[240:241]
 v_pk_mul_f32 v[242:243], v[210:211], v[242:243]
 v_pk_fma_f32 v[48:49], v[48:49], s[6:7], s[6:7]
 v_pk_fma_f32 v[50:51], v[50:51], s[6:7], s[6:7]
 v_pk_fma_f32 v[52:53], v[52:53], s[6:7], s[6:7]
 v_pk_fma_f32 v[54:55], v[54:55], s[6:7], s[6:7]
 v_rcp_f32 v48, v48
 v_rcp_f32 v49, v49
 v_rcp_f32 v50, v50
 v_rcp_f32 v51, v51
 v_rcp_f32 v52, v52
 v_rcp_f32 v53, v53
 v_rcp_f32 v54, v54
 v_rcp_f32 v55, v55
 v_pk_mul_f32 v[224:225], v[224:225], v[48:49]
 v_pk_mul_f32 v[226:227], v[226:227], v[50:51]
 v_pk_mul_f32 v[240:241], v[240:241], v[52:53]
 v_pk_mul_f32 v[242:243], v[242:243], v[54:55]
 v_cvt_pk_bf16_f32 v56, v224, v225
 v_cvt_pk_bf16_f32 v57, v226, v227
 v_cvt_pk_bf16_f32 v58, v240, v241
 v_cvt_pk_bf16_f32 v59, v242, v243
 s_add_u32 s5, s4, 0
 buffer_store_dwordx4 v[56:59], v12, s[84:87], s5 offen sc1
 v_exp_f32 v48, -v196
 v_exp_f32 v49, -v197
 v_exp_f32 v50, -v198
 v_exp_f32 v51, -v199
 v_exp_f32 v52, -v212
 v_exp_f32 v53, -v213
 v_exp_f32 v54, -v214
 v_exp_f32 v55, -v215
 v_pk_mul_f32 v[228:229], v[196:197], v[228:229]
 v_pk_mul_f32 v[230:231], v[198:199], v[230:231]
 v_pk_mul_f32 v[244:245], v[212:213], v[244:245]
 v_pk_mul_f32 v[246:247], v[214:215], v[246:247]
 v_pk_fma_f32 v[48:49], v[48:49], s[6:7], s[6:7]
 v_pk_fma_f32 v[50:51], v[50:51], s[6:7], s[6:7]
 v_pk_fma_f32 v[52:53], v[52:53], s[6:7], s[6:7]
 v_pk_fma_f32 v[54:55], v[54:55], s[6:7], s[6:7]
 v_rcp_f32 v48, v48
 v_rcp_f32 v49, v49
 v_rcp_f32 v50, v50
 v_rcp_f32 v51, v51
 v_rcp_f32 v52, v52
 v_rcp_f32 v53, v53
 v_rcp_f32 v54, v54
 v_rcp_f32 v55, v55
 v_pk_mul_f32 v[228:229], v[228:229], v[48:49]
 v_pk_mul_f32 v[230:231], v[230:231], v[50:51]
 v_pk_mul_f32 v[244:245], v[244:245], v[52:53]
 v_pk_mul_f32 v[246:247], v[246:247], v[54:55]
 v_cvt_pk_bf16_f32 v60, v228, v229
 v_cvt_pk_bf16_f32 v61, v230, v231
 v_cvt_pk_bf16_f32 v62, v244, v245
 v_cvt_pk_bf16_f32 v63, v246, v247
 s_add_u32 s5, s4, 114688
 buffer_store_dwordx4 v[60:63], v12, s[84:87], s5 offen sc1
 v_exp_f32 v48, -v200
 v_exp_f32 v49, -v201
 v_exp_f32 v50, -v202
 v_exp_f32 v51, -v203
 v_exp_f32 v52, -v216
 v_exp_f32 v53, -v217
 v_exp_f32 v54, -v218
 v_exp_f32 v55, -v219
 v_pk_mul_f32 v[232:233], v[200:201], v[232:233]
 v_pk_mul_f32 v[234:235], v[202:203], v[234:235]
 v_pk_mul_f32 v[248:249], v[216:217], v[248:249]
 v_pk_mul_f32 v[250:251], v[218:219], v[250:251]
 v_pk_fma_f32 v[48:49], v[48:49], s[6:7], s[6:7]
 v_pk_fma_f32 v[50:51], v[50:51], s[6:7], s[6:7]
 v_pk_fma_f32 v[52:53], v[52:53], s[6:7], s[6:7]
 v_pk_fma_f32 v[54:55], v[54:55], s[6:7], s[6:7]
 v_rcp_f32 v48, v48
 v_rcp_f32 v49, v49
 v_rcp_f32 v50, v50
 v_rcp_f32 v51, v51
 v_rcp_f32 v52, v52
 v_rcp_f32 v53, v53
 v_rcp_f32 v54, v54
 v_rcp_f32 v55, v55
 v_pk_mul_f32 v[232:233], v[232:233], v[48:49]
 v_pk_mul_f32 v[234:235], v[234:235], v[50:51]
 v_pk_mul_f32 v[248:249], v[248:249], v[52:53]
 v_pk_mul_f32 v[250:251], v[250:251], v[54:55]
 v_cvt_pk_bf16_f32 v56, v232, v233
 v_cvt_pk_bf16_f32 v57, v234, v235
 v_cvt_pk_bf16_f32 v58, v248, v249
 v_cvt_pk_bf16_f32 v59, v250, v251
 s_add_u32 s5, s4, 229376
 buffer_store_dwordx4 v[56:59], v12, s[84:87], s5 offen sc1
 v_exp_f32 v48, -v204
 v_exp_f32 v49, -v205
 v_exp_f32 v50, -v206
 v_exp_f32 v51, -v207
 v_exp_f32 v52, -v220
 v_exp_f32 v53, -v221
 v_exp_f32 v54, -v222
 v_exp_f32 v55, -v223
 v_pk_mul_f32 v[236:237], v[204:205], v[236:237]
 v_pk_mul_f32 v[238:239], v[206:207], v[238:239]
 v_pk_mul_f32 v[252:253], v[220:221], v[252:253]
 v_pk_mul_f32 v[254:255], v[222:223], v[254:255]
 v_pk_fma_f32 v[48:49], v[48:49], s[6:7], s[6:7]
 v_pk_fma_f32 v[50:51], v[50:51], s[6:7], s[6:7]
 v_pk_fma_f32 v[52:53], v[52:53], s[6:7], s[6:7]
 v_pk_fma_f32 v[54:55], v[54:55], s[6:7], s[6:7]
 v_rcp_f32 v48, v48
 v_rcp_f32 v49, v49
 v_rcp_f32 v50, v50
 v_rcp_f32 v51, v51
 v_rcp_f32 v52, v52
 v_rcp_f32 v53, v53
 v_rcp_f32 v54, v54
 v_rcp_f32 v55, v55
 v_pk_mul_f32 v[236:237], v[236:237], v[48:49]
 v_pk_mul_f32 v[238:239], v[238:239], v[50:51]
 v_pk_mul_f32 v[252:253], v[252:253], v[52:53]
 v_pk_mul_f32 v[254:255], v[254:255], v[54:55]
 v_cvt_pk_bf16_f32 v60, v236, v237
 v_cvt_pk_bf16_f32 v61, v238, v239
 v_cvt_pk_bf16_f32 v62, v252, v253
 v_cvt_pk_bf16_f32 v63, v254, v255
 s_add_u32 s5, s4, 344064
 buffer_store_dwordx4 v[60:63], v12, s[84:87], s5 offen sc1
 s_endpgm
L_g1_H_fin:
L_g1_M:
 s_waitcnt lgkmcnt(8)
 v_mfma_f32_16x16x32_bf16 a[0:3], v[16:19], a[128:131], a[0:3]
 ds_read_b64_tr_b16 v[40:41], v7 offset:4096
 v_mfma_f32_16x16x32_bf16 a[0:3], v[20:23], a[132:135], a[0:3]
 buffer_load_dwordx4 a[160:163], v8, s[84:87], s92 offen offset:0 sc1
 v_mfma_f32_16x16x32_bf16 a[4:7], v[20:23], a[140:143], a[4:7]
 v_add_u32 v60, 40960, v4
 v_add_u32 v61, 40960, v5
 ds_read_b64_tr_b16 v[42:43], v7 offset:4352
 v_mfma_f32_16x16x32_bf16 a[4:7], v[16:19], a[136:139], a[4:7]
 v_mfma_f32_16x16x32_bf16 a[8:11], v[16:19], a[144:147], a[8:11]
 ds_read_b64_tr_b16 v[44:45], v7 offset:6144
 v_mfma_f32_16x16x32_bf16 a[8:11], v[20:23], a[148:151], a[8:11]
 buffer_load_dwordx4 a[164:167], v8, s[84:87], s92 offen offset:1024 sc1
 v_mfma_f32_16x16x32_bf16 a[12:15], v[20:23], a[156:159], a[12:15]
 v_add_u32 v62, 81920, v4
 v_add_u32 v63, 81920, v5
 ds_read_b64_tr_b16 v[46:47], v7 offset:6400
 v_mfma_f32_16x16x32_bf16 a[12:15], v[16:19], a[152:155], a[12:15]
 s_waitcnt lgkmcnt(8)
 v_mfma_f32_16x16x32_bf16 a[16:19], v[24:27], a[128:131], a[16:19]
 ds_read_b64_tr_b16 v[16:17], v6 offset:8192
 v_mfma_f32_16x16x32_bf16 a[16:19], v[28:31], a[132:135], a[16:19]
 buffer_load_dwordx4 a[168:171], v9, s[84:87], s92 offen offset:0 sc1
 v_mfma_f32_16x16x32_bf16 a[20:23], v[28:31], a[140:143], a[20:23]
 v_add_u32 v4, 122880, v4
 v_add_u32 v5, 122880, v5
 ds_read_b64_tr_b16 v[18:19], v6 offset:8448
 v_mfma_f32_16x16x32_bf16 a[20:23], v[24:27], a[136:139], a[20:23]
 v_mfma_f32_16x16x32_bf16 a[24:27], v[24:27], a[144:147], a[24:27]
 ds_read_b64_tr_b16 v[20:21], v6 offset:10240
 v_mfma_f32_16x16x32_bf16 a[24:27], v[28:31], a[148:151], a[24:27]
 buffer_load_dwordx4 a[172:175], v9, s[84:87], s92 offen offset:1024 sc1
 v_mfma_f32_16x16x32_bf16 a[28:31], v[28:31], a[156:159], a[28:31]
 ds_read_b64_tr_b16 v[22:23], v6 offset:10496
 v_mfma_f32_16x16x32_bf16 a[28:31], v[24:27], a[152:155], a[28:31]
 s_waitcnt lgkmcnt(8)
 v_mfma_f32_16x16x32_bf16 a[32:35], v[32:35], a[128:131], a[32:35]
 ds_read_b64_tr_b16 v[24:25], v7 offset:8192
 v_mfma_f32_16x16x32_bf16 a[32:35], v[36:39], a[132:135], a[32:35]
 buffer_load_dwordx4 a[176:179], v10, s[84:87], s92 offen offset:0 sc1
 v_mfma_f32_16x16x32_bf16 a[36:39], v[36:39], a[140:143], a[36:39]
 ds_read_b64_tr_b16 v[26:27], v7 offset:8448
 v_mfma_f32_16x16x32_bf16 a[36:39], v[32:35], a[136:139], a[36:39]
 v_mfma_f32_16x16x32_bf16 a[40:43], v[32:35], a[144:147], a[40:43]
 ds_read_b64_tr_b16 v[28:29], v7 offset:10240
 v_mfma_f32_16x16x32_bf16 a[40:43], v[36:39], a[148:151], a[40:43]
 buffer_load_dwordx4 a[180:183], v10, s[84:87], s92 offen offset:1024 sc1
 v_mfma_f32_16x16x32_bf16 a[44:47], v[36:39], a[156:159], a[44:47]
 ds_read_b64_tr_b16 v[30:31], v7 offset:10496
 v_mfma_f32_16x16x32_bf16 a[44:47], v[32:35], a[152:155], a[44:47]
 s_waitcnt lgkmcnt(8)
 v_mfma_f32_16x16x32_bf16 a[48:51], v[40:43], a[128:131], a[48:51]
 ds_read_b64_tr_b16 v[32:33], v6 offset:12288
 v_mfma_f32_16x16x32_bf16 a[48:51], v[44:47], a[132:135], a[48:51]
 buffer_load_dwordx4 a[184:187], v11, s[84:87], s92 offen offset:0 sc1
 v_mfma_f32_16x16x32_bf16 a[52:55], v[44:47], a[140:143], a[52:55]
 ds_read_b64_tr_b16 v[34:35], v6 offset:12544
 v_mfma_f32_16x16x32_bf16 a[52:55], v[40:43], a[136:139], a[52:55]
 v_mfma_f32_16x16x32_bf16 a[56:59], v[40:43], a[144:147], a[56:59]
 ds_read_b64_tr_b16 v[36:37], v6 offset:14336
 v_mfma_f32_16x16x32_bf16 a[56:59], v[44:47], a[148:151], a[56:59]
 buffer_load_dwordx4 a[188:191], v11, s[84:87], s92 offen offset:1024 sc1
 s_add_u32 s10, s10, 1
 s_cmp_lt_u32 s10, 4
 s_cselect_b32 s3, 1, 3
 s_add_u32 s92, s10, s11
 s_and_b32 s92, s92, s3
 s_andn2_b32 s3, s10, s3
 s_or_b32 s92, s92, s3
 s_lshl_b32 s92, s92, 11
 v_mfma_f32_16x16x32_bf16 a[60:63], v[44:47], a[156:159], a[60:63]
 ds_read_b64_tr_b16 v[38:39], v6 offset:14592
 v_mfma_f32_16x16x32_bf16 a[60:63], v[40:43], a[152:155], a[60:63]
 s_waitcnt lgkmcnt(8)
 v_mfma_f32_16x16x32_bf16 a[64:67], v[16:19], a[128:131], a[64:67]
 ds_read_b64_tr_b16 v[40:41], v7 offset:12288
 v_mfma_f32_16x16x32_bf16 a[64:67], v[20:23], a[132:135], a[64:67]
 buffer_load_dwordx4 a[192:195], v8, s[84:87], s92 offen offset:0 sc1
 v_mfma_f32_16x16x32_bf16 a[68:71], v[20:23], a[140:143], a[68:71]
 ds_read_b64_tr_b16 v[42:43], v7 offset:12544
 v_mfma_f32_16x16x32_bf16 a[68:71], v[16:19], a[136:139], a[68:71]
 v_mfma_f32_16x16x32_bf16 a[72:75], v[16:19], a[144:147], a[72:75]
 ds_read_b64_tr_b16 v[44:45], v7 offset:14336
 v_mfma_f32_16x16x32_bf16 a[72:75], v[20:23], a[148:151], a[72:75]
 buffer_load_dwordx4 a[196:199], v8, s[84:87], s92 offen offset:1024 sc1
 v_mfma_f32_16x16x32_bf16 a[76:79], v[20:23], a[156:159], a[76:79]
 ds_read_b64_tr_b16 v[46:47], v7 offset:14592
 v_mfma_f32_16x16x32_bf16 a[76:79], v[16:19], a[152:155], a[76:79]
 s_waitcnt lgkmcnt(8)
 v_mfma_f32_16x16x32_bf16 a[80:83], v[24:27], a[128:131], a[80:83]
 ds_read_b64_tr_b16 v[16:17], v60 offset:0
 v_mfma_f32_16x16x32_bf16 a[80:83], v[28:31], a[132:135], a[80:83]
 buffer_load_dwordx4 a[200:203], v9, s[84:87], s92 offen offset:0 sc1
 v_mfma_f32_16x16x32_bf16 a[84:87], v[28:31], a[140:143], a[84:87]
 ds_read_b64_tr_b16 v[18:19], v60 offset:256
 v_mfma_f32_16x16x32_bf16 a[84:87], v[24:27], a[136:139], a[84:87]
 v_mfma_f32_16x16x32_bf16 a[88:91], v[24:27], a[144:147], a[88:91]
 ds_read_b64_tr_b16 v[20:21], v60 offset:2048
 v_mfma_f32_16x16x32_bf16 a[88:91], v[28:31], a[148:151], a[88:91]
 buffer_load_dwordx4 a[204:207], v9, s[84:87], s92 offen offset:1024 sc1
 v_mfma_f32_16x16x32_bf16 a[92:95], v[28:31], a[156:159], a[92:95]
 ds_read_b64_tr_b16 v[22:23], v60 offset:2304
 v_mfma_f32_16x16x32_bf16 a[92:95], v[24:27], a[152:155], a[92:95]
 s_waitcnt lgkmcnt(8)
 v_mfma_f32_16x16x32_bf16 a[96:99], v[32:35], a[128:131], a[96:99]
 ds_read_b64_tr_b16 v[24:25], v61 offset:0
 v_mfma_f32_16x16x32_bf16 a[96:99], v[36:39], a[132:135], a[96:99]
 buffer_load_dwordx4 a[208:211], v10, s[84:87], s92 offen offset:0 sc1
 v_mfma_f32_16x16x32_bf16 a[100:103], v[36:39], a[140:143], a[100:103]
 ds_read_b64_tr_b16 v[26:27], v61 offset:256
 v_mfma_f32_16x16x32_bf16 a[100:103], v[32:35], a[136:139], a[100:103]
 v_mfma_f32_16x16x32_bf16 a[104:107], v[32:35], a[144:147], a[104:107]
 ds_read_b64_tr_b16 v[28:29], v61 offset:2048
 v_mfma_f32_16x16x32_bf16 a[104:107], v[36:39], a[148:151], a[104:107]
 buffer_load_dwordx4 a[212:215], v10, s[84:87], s92 offen offset:1024 sc1
 v_mfma_f32_16x16x32_bf16 a[108:111], v[36:39], a[156:159], a[108:111]
 ds_read_b64_tr_b16 v[30:31], v61 offset:2304
 v_mfma_f32_16x16x32_bf16 a[108:111], v[32:35], a[152:155], a[108:111]
 s_waitcnt lgkmcnt(8)
 v_mfma_f32_16x16x32_bf16 a[112:115], v[40:43], a[128:131], a[112:115]
 ds_read_b64_tr_b16 v[32:33], v60 offset:4096
 v_mfma_f32_16x16x32_bf16 a[112:115], v[44:47], a[132:135], a[112:115]
 buffer_load_dwordx4 a[216:219], v11, s[84:87], s92 offen offset:0 sc1
 v_mfma_f32_16x16x32_bf16 a[116:119], v[44:47], a[140:143], a[116:119]
 ds_read_b64_tr_b16 v[34:35], v60 offset:4352
 v_mfma_f32_16x16x32_bf16 a[116:119], v[40:43], a[136:139], a[116:119]
 v_mfma_f32_16x16x32_bf16 a[120:123], v[40:43], a[144:147], a[120:123]
 ds_read_b64_tr_b16 v[36:37], v60 offset:6144
 v_mfma_f32_16x16x32_bf16 a[120:123], v[44:47], a[148:151], a[120:123]
 buffer_load_dwordx4 a[220:223], v11, s[84:87], s92 offen offset:1024 sc1
 s_add_u32 s10, s10, 1
 s_cmp_lt_u32 s10, 4
 s_cselect_b32 s3, 1, 3
 s_add_u32 s92, s10, s11
 s_and_b32 s92, s92, s3
 s_andn2_b32 s3, s10, s3
 s_or_b32 s92, s92, s3
 s_lshl_b32 s92, s92, 11
 v_mfma_f32_16x16x32_bf16 a[124:127], v[44:47], a[156:159], a[124:127]
 ds_read_b64_tr_b16 v[38:39], v60 offset:6400
 v_mfma_f32_16x16x32_bf16 a[124:127], v[40:43], a[152:155], a[124:127]
 s_waitcnt vmcnt(8) lgkmcnt(8)
 v_mfma_f32_16x16x32_bf16 a[0:3], v[16:19], a[160:163], a[0:3]
 ds_read_b64_tr_b16 v[40:41], v61 offset:4096
 v_mfma_f32_16x16x32_bf16 a[0:3], v[20:23], a[164:167], a[0:3]
 s_add_u32 m0, s94, 0
 s_nop 0
 buffer_load_dwordx4 v2, s[40:43], s88 offen lds
 v_mfma_f32_16x16x32_bf16 a[4:7], v[20:23], a[172:175], a[4:7]
 ds_read_b64_tr_b16 v[42:43], v61 offset:4352
 v_mfma_f32_16x16x32_bf16 a[4:7], v[16:19], a[168:171], a[4:7]
 v_mfma_f32_16x16x32_bf16 a[8:11], v[16:19], a[176:179], a[8:11]
 ds_read_b64_tr_b16 v[44:45], v61 offset:6144
 v_mfma_f32_16x16x32_bf16 a[8:11], v[20:23], a[180:183], a[8:11]
 s_add_u32 m0, s94, 8192
 s_nop 0
 buffer_load_dwordx4 v2, s[48:51], s88 offen lds
 v_mfma_f32_16x16x32_bf16 a[12:15], v[20:23], a[188:191], a[12:15]
 s_mov_b32 s100, 0x3f317218
 ds_read_b64_tr_b16 v[46:47], v61 offset:6400
 v_mfma_f32_16x16x32_bf16 a[12:15], v[16:19], a[184:187], a[12:15]
 s_waitcnt lgkmcnt(8)
 v_mfma_f32_16x16x32_bf16 a[16:19], v[24:27], a[160:163], a[16:19]
 ds_read_b64_tr_b16 v[16:17], v60 offset:8192
 v_mfma_f32_16x16x32_bf16 a[16:19], v[28:31], a[164:167], a[16:19]
 s_add_u32 m0, s94, 4096
 s_nop 0
 buffer_load_dwordx4 v2, s[44:47], s88 offen lds
 v_mfma_f32_16x16x32_bf16 a[20:23], v[28:31], a[172:175], a[20:23]
 ds_read_b64_tr_b16 v[18:19], v60 offset:8448
 v_mfma_f32_16x16x32_bf16 a[20:23], v[24:27], a[168:171], a[20:23]
 v_mfma_f32_16x16x32_bf16 a[24:27], v[24:27], a[176:179], a[24:27]
 ds_read_b64_tr_b16 v[20:21], v60 offset:10240
 v_mfma_f32_16x16x32_bf16 a[24:27], v[28:31], a[180:183], a[24:27]
 s_add_u32 m0, s94, 12288
 s_nop 0
 buffer_load_dwordx4 v2, s[52:55], s88 offen lds
 v_mfma_f32_16x16x32_bf16 a[28:31], v[28:31], a[188:191], a[28:31]
 ds_read_b64_tr_b16 v[22:23], v60 offset:10496
 v_mfma_f32_16x16x32_bf16 a[28:31], v[24:27], a[184:187], a[28:31]
 s_waitcnt lgkmcnt(8)
 v_mfma_f32_16x16x32_bf16 a[32:35], v[32:35], a[160:163], a[32:35]
 ds_read_b64_tr_b16 v[24:25], v61 offset:8192
 v_mfma_f32_16x16x32_bf16 a[32:35], v[36:39], a[164:167], a[32:35]
 s_add_u32 m0, s94, 16384
 s_nop 0
 buffer_load_dwordx4 v3, s[56:59], s89 offen lds
 v_mfma_f32_16x16x32_bf16 a[36:39], v[36:39], a[172:175], a[36:39]
 ds_read_b64_tr_b16 v[26:27], v61 offset:8448
 v_mfma_f32_16x16x32_bf16 a[36:39], v[32:35], a[168:171], a[36:39]
 v_mfma_f32_16x16x32_bf16 a[40:43], v[32:35], a[176:179], a[40:43]
 ds_read_b64_tr_b16 v[28:29], v61 offset:10240
 v_mfma_f32_16x16x32_bf16 a[40:43], v[36:39], a[180:183], a[40:43]
 s_add_u32 m0, s94, 24576
 s_nop 0
 buffer_load_dwordx4 v3, s[64:67], s89 offen lds
 v_mfma_f32_16x16x32_bf16 a[44:47], v[36:39], a[188:191], a[44:47]
 ds_read_b64_tr_b16 v[30:31], v61 offset:10496
 v_mfma_f32_16x16x32_bf16 a[44:47], v[32:35], a[184:187], a[44:47]
 s_waitcnt lgkmcnt(8)
 v_mfma_f32_16x16x32_bf16 a[48:51], v[40:43], a[160:163], a[48:51]
 ds_read_b64_tr_b16 v[32:33], v60 offset:12288
 v_mfma_f32_16x16x32_bf16 a[48:51], v[44:47], a[164:167], a[48:51]
 s_add_u32 m0, s94, 20480
 s_nop 0
 buffer_load_dwordx4 v3, s[60:63], s89 offen lds
 v_mfma_f32_16x16x32_bf16 a[52:55], v[44:47], a[172:175], a[52:55]
 ds_read_b64_tr_b16 v[34:35], v60 offset:12544
 v_mfma_f32_16x16x32_bf16 a[52:55], v[40:43], a[168:171], a[52:55]
 v_mfma_f32_16x16x32_bf16 a[56:59], v[40:43], a[176:179], a[56:59]
 ds_read_b64_tr_b16 v[36:37], v60 offset:14336
 v_mfma_f32_16x16x32_bf16 a[56:59], v[44:47], a[180:183], a[56:59]
 s_add_u32 m0, s94, 28672
 s_nop 0
 buffer_load_dwordx4 v3, s[68:71], s89 offen lds
 v_mfma_f32_16x16x32_bf16 a[60:63], v[44:47], a[188:191], a[60:63]
 ds_read_b64_tr_b16 v[38:39], v60 offset:14592
 v_mfma_f32_16x16x32_bf16 a[60:63], v[40:43], a[184:187], a[60:63]
 s_waitcnt lgkmcnt(8)
 v_mfma_f32_16x16x32_bf16 a[64:67], v[16:19], a[160:163], a[64:67]
 ds_read_b64_tr_b16 v[40:41], v61 offset:12288
 v_mfma_f32_16x16x32_bf16 a[64:67], v[20:23], a[164:167], a[64:67]
 s_add_u32 m0, s94, 32768
 s_nop 0
 buffer_load_dwordx4 v3, s[72:75], s89 offen lds
 v_mfma_f32_16x16x32_bf16 a[68:71], v[20:23], a[172:175], a[68:71]
 ds_read_b64_tr_b16 v[42:43], v61 offset:12544
 v_mfma_f32_16x16x32_bf16 a[68:71], v[16:19], a[168:171], a[68:71]
 v_mfma_f32_16x16x32_bf16 a[72:75], v[16:19], a[176:179], a[72:75]
 ds_read_b64_tr_b16 v[44:45], v61 offset:14336
 v_mfma_f32_16x16x32_bf16 a[72:75], v[20:23], a[180:183], a[72:75]
 s_add_u32 m0, s94, 36864
 s_nop 0
 buffer_load_dwordx4 v3, s[76:79], s89 offen lds
 v_mfma_f32_16x16x32_bf16 a[76:79], v[20:23], a[188:191], a[76:79]
 ds_read_b64_tr_b16 v[46:47], v61 offset:14592
 v_mfma_f32_16x16x32_bf16 a[76:79], v[16:19], a[184:187], a[76:79]
 s_waitcnt lgkmcnt(8)
 s_waitcnt vmcnt(26)
 s_barrier
 v_mfma_f32_16x16x32_bf16 a[80:83], v[24:27], a[160:163], a[80:83]
 ds_read_b64_tr_b16 v[16:17], v62 offset:0
 v_mfma_f32_16x16x32_bf16 a[80:83], v[28:31], a[164:167], a[80:83]
 buffer_load_dwordx4 a[224:227], v8, s[84:87], s92 offen offset:0 sc1
 v_mfma_f32_16x16x32_bf16 a[84:87], v[28:31], a[172:175], a[84:87]
 ds_read_b64_tr_b16 v[18:19], v62 offset:256
 v_mfma_f32_16x16x32_bf16 a[84:87], v[24:27], a[168:171], a[84:87]
 v_mfma_f32_16x16x32_bf16 a[88:91], v[24:27], a[176:179], a[88:91]
 ds_read_b64_tr_b16 v[20:21], v62 offset:2048
 v_mfma_f32_16x16x32_bf16 a[88:91], v[28:31], a[180:183], a[88:91]
 buffer_load_dwordx4 a[228:231], v8, s[84:87], s92 offen offset:1024 sc1
 v_mfma_f32_16x16x32_bf16 a[92:95], v[28:31], a[188:191], a[92:95]
 ds_read_b64_tr_b16 v[22:23], v62 offset:2304
 v_mfma_f32_16x16x32_bf16 a[92:95], v[24:27], a[184:187], a[92:95]
 s_waitcnt lgkmcnt(8)
 v_mfma_f32_16x16x32_bf16 a[96:99], v[32:35], a[160:163], a[96:99]
 ds_read_b64_tr_b16 v[24:25], v63 offset:0
 v_mfma_f32_16x16x32_bf16 a[96:99], v[36:39], a[164:167], a[96:99]
 buffer_load_dwordx4 a[232:235], v9, s[84:87], s92 offen offset:0 sc1
 v_mfma_f32_16x16x32_bf16 a[100:103], v[36:39], a[172:175], a[100:103]
 ds_read_b64_tr_b16 v[26:27], v63 offset:256
 v_mfma_f32_16x16x32_bf16 a[100:103], v[32:35], a[168:171], a[100:103]
 v_mfma_f32_16x16x32_bf16 a[104:107], v[32:35], a[176:179], a[104:107]
 ds_read_b64_tr_b16 v[28:29], v63 offset:2048
 v_mfma_f32_16x16x32_bf16 a[104:107], v[36:39], a[180:183], a[104:107]
 buffer_load_dwordx4 a[236:239], v9, s[84:87], s92 offen offset:1024 sc1
 v_mfma_f32_16x16x32_bf16 a[108:111], v[36:39], a[188:191], a[108:111]
 ds_read_b64_tr_b16 v[30:31], v63 offset:2304
 v_mfma_f32_16x16x32_bf16 a[108:111], v[32:35], a[184:187], a[108:111]
 s_waitcnt lgkmcnt(8)
 v_mfma_f32_16x16x32_bf16 a[112:115], v[40:43], a[160:163], a[112:115]
 ds_read_b64_tr_b16 v[32:33], v62 offset:4096
 v_mfma_f32_16x16x32_bf16 a[112:115], v[44:47], a[164:167], a[112:115]
 buffer_load_dwordx4 a[240:243], v10, s[84:87], s92 offen offset:0 sc1
 v_mfma_f32_16x16x32_bf16 a[116:119], v[44:47], a[172:175], a[116:119]
 ds_read_b64_tr_b16 v[34:35], v62 offset:4352
 v_mfma_f32_16x16x32_bf16 a[116:119], v[40:43], a[168:171], a[116:119]
 v_mfma_f32_16x16x32_bf16 a[120:123], v[40:43], a[176:179], a[120:123]
 ds_read_b64_tr_b16 v[36:37], v62 offset:6144
 v_mfma_f32_16x16x32_bf16 a[120:123], v[44:47], a[180:183], a[120:123]
 buffer_load_dwordx4 a[244:247], v10, s[84:87], s92 offen offset:1024 sc1
 v_mfma_f32_16x16x32_bf16 a[124:127], v[44:47], a[188:191], a[124:127]
 ds_read_b64_tr_b16 v[38:39], v62 offset:6400
 v_mfma_f32_16x16x32_bf16 a[124:127], v[40:43], a[184:187], a[124:127]
 s_waitcnt vmcnt(16) lgkmcnt(8)
 v_mfma_f32_16x16x32_bf16 a[0:3], v[16:19], a[192:195], a[0:3]
 ds_read_b64_tr_b16 v[40:41], v63 offset:4096
 v_mfma_f32_16x16x32_bf16 a[0:3], v[20:23], a[196:199], a[0:3]
 buffer_load_dwordx4 a[248:251], v11, s[84:87], s92 offen offset:0 sc1
 v_mfma_f32_16x16x32_bf16 a[4:7], v[20:23], a[204:207], a[4:7]
 ds_read_b64_tr_b16 v[42:43], v63 offset:4352
 v_mfma_f32_16x16x32_bf16 a[4:7], v[16:19], a[200:203], a[4:7]
 v_mfma_f32_16x16x32_bf16 a[8:11], v[16:19], a[208:211], a[8:11]
 ds_read_b64_tr_b16 v[44:45], v63 offset:6144
 v_mfma_f32_16x16x32_bf16 a[8:11], v[20:23], a[212:215], a[8:11]
 buffer_load_dwordx4 a[252:255], v11, s[84:87], s92 offen offset:1024 sc1
 v_mfma_f32_16x16x32_bf16 a[12:15], v[20:23], a[220:223], a[12:15]
 ds_read_b64_tr_b16 v[46:47], v63 offset:6400
 v_mfma_f32_16x16x32_bf16 a[12:15], v[16:19], a[216:219], a[12:15]
 s_waitcnt lgkmcnt(8)
 v_mfma_f32_16x16x32_bf16 a[16:19], v[24:27], a[192:195], a[16:19]
 ds_read_b64_tr_b16 v[16:17], v62 offset:8192
 v_mfma_f32_16x16x32_bf16 a[16:19], v[28:31], a[196:199], a[16:19]
 v_mov_b32 v8, v60
 v_mov_b32 v9, v61
 v_mov_b32 v10, v62
 v_mov_b32 v11, v63
 v_mfma_f32_16x16x32_bf16 a[20:23], v[28:31], a[204:207], a[20:23]
 ds_read_b64_tr_b16 v[18:19], v62 offset:8448
 v_mfma_f32_16x16x32_bf16 a[20:23], v[24:27], a[200:203], a[20:23]
 v_mfma_f32_16x16x32_bf16 a[24:27], v[24:27], a[208:211], a[24:27]
 ds_read_b64_tr_b16 v[20:21], v62 offset:10240
 v_mfma_f32_16x16x32_bf16 a[24:27], v[28:31], a[212:215], a[24:27]
 v_mfma_f32_16x16x32_bf16 a[28:31], v[28:31], a[220:223], a[28:31]
 ds_read_b64_tr_b16 v[22:23], v62 offset:10496
 v_mfma_f32_16x16x32_bf16 a[28:31], v[24:27], a[216:219], a[28:31]
 s_waitcnt lgkmcnt(8)
 v_mfma_f32_16x16x32_bf16 a[32:35], v[32:35], a[192:195], a[32:35]
 ds_read_b64_tr_b16 v[24:25], v11 offset:8192
 v_mfma_f32_16x16x32_bf16 a[32:35], v[36:39], a[196:199], a[32:35]
 v_mfma_f32_16x16x32_bf16 a[36:39], v[36:39], a[204:207], a[36:39]
 ds_read_b64_tr_b16 v[26:27], v11 offset:8448
 v_mfma_f32_16x16x32_bf16 a[36:39], v[32:35], a[200:203], a[36:39]
 v_mfma_f32_16x16x32_bf16 a[40:43], v[32:35], a[208:211], a[40:43]
 ds_read_b64_tr_b16 v[28:29], v11 offset:10240
 v_mfma_f32_16x16x32_bf16 a[40:43], v[36:39], a[212:215], a[40:43]
 v_mfma_f32_16x16x32_bf16 a[44:47], v[36:39], a[220:223], a[44:47]
 ds_read_b64_tr_b16 v[30:31], v11 offset:10496
 v_mfma_f32_16x16x32_bf16 a[44:47], v[32:35], a[216:219], a[44:47]
 s_waitcnt lgkmcnt(8)
 v_mfma_f32_16x16x32_bf16 a[48:51], v[40:43], a[192:195], a[48:51]
 ds_read_b64_tr_b16 v[32:33], v10 offset:12288
 v_mfma_f32_16x16x32_bf16 a[48:51], v[44:47], a[196:199], a[48:51]
 v_mfma_f32_16x16x32_bf16 a[52:55], v[44:47], a[204:207], a[52:55]
 ds_read_b64_tr_b16 v[34:35], v10 offset:12544
 v_mfma_f32_16x16x32_bf16 a[52:55], v[40:43], a[200:203], a[52:55]
 v_mfma_f32_16x16x32_bf16 a[56:59], v[40:43], a[208:211], a[56:59]
 ds_read_b64_tr_b16 v[36:37], v10 offset:14336
 v_mfma_f32_16x16x32_bf16 a[56:59], v[44:47], a[212:215], a[56:59]
 v_mfma_f32_16x16x32_bf16 a[60:63], v[44:47], a[220:223], a[60:63]
 ds_read_b64_tr_b16 v[38:39], v10 offset:14592
 v_mfma_f32_16x16x32_bf16 a[60:63], v[40:43], a[216:219], a[60:63]
 s_waitcnt lgkmcnt(8)
 v_mfma_f32_16x16x32_bf16 a[64:67], v[16:19], a[192:195], a[64:67]
 ds_read_b64_tr_b16 v[40:41], v11 offset:12288
 v_mfma_f32_16x16x32_bf16 a[64:67], v[20:23], a[196:199], a[64:67]
 v_mfma_f32_16x16x32_bf16 a[68:71], v[20:23], a[204:207], a[68:71]
 ds_read_b64_tr_b16 v[42:43], v11 offset:12544
 v_mfma_f32_16x16x32_bf16 a[68:71], v[16:19], a[200:203], a[68:71]
 v_mfma_f32_16x16x32_bf16 a[72:75], v[16:19], a[208:211], a[72:75]
 ds_read_b64_tr_b16 v[44:45], v11 offset:14336
 v_mfma_f32_16x16x32_bf16 a[72:75], v[20:23], a[212:215], a[72:75]
 v_mfma_f32_16x16x32_bf16 a[76:79], v[20:23], a[220:223], a[76:79]
 ds_read_b64_tr_b16 v[46:47], v11 offset:14592
 v_mfma_f32_16x16x32_bf16 a[76:79], v[16:19], a[216:219], a[76:79]
 s_waitcnt lgkmcnt(8)
 s_waitcnt vmcnt(8)
 s_barrier
 v_mfma_f32_16x16x32_bf16 a[80:83], v[24:27], a[192:195], a[80:83]
 ds_read_b64_tr_b16 v[16:17], v4 offset:0
 v_mfma_f32_16x16x32_bf16 a[80:83], v[28:31], a[196:199], a[80:83]
 v_mfma_f32_16x16x32_bf16 a[84:87], v[28:31], a[204:207], a[84:87]
 ds_read_b64_tr_b16 v[18:19], v4 offset:256
 v_mfma_f32_16x16x32_bf16 a[84:87], v[24:27], a[200:203], a[84:87]
 v_mfma_f32_16x16x32_bf16 a[88:91], v[24:27], a[208:211], a[88:91]
 ds_read_b64_tr_b16 v[20:21], v4 offset:2048
 v_mfma_f32_16x16x32_bf16 a[88:91], v[28:31], a[212:215], a[88:91]
 v_mfma_f32_16x16x32_bf16 a[92:95], v[28:31], a[220:223], a[92:95]
 ds_read_b64_tr_b16 v[22:23], v4 offset:2304
 v_mfma_f32_16x16x32_bf16 a[92:95], v[24:27], a[216:219], a[92:95]
 s_waitcnt lgkmcnt(8)
 v_mfma_f32_16x16x32_bf16 a[96:99], v[32:35], a[192:195], a[96:99]
 ds_read_b64_tr_b16 v[24:25], v5 offset:0
 v_mfma_f32_16x16x32_bf16 a[96:99], v[36:39], a[196:199], a[96:99]
 v_mfma_f32_16x16x32_bf16 a[100:103], v[36:39], a[204:207], a[100:103]
 ds_read_b64_tr_b16 v[26:27], v5 offset:256
 v_mfma_f32_16x16x32_bf16 a[100:103], v[32:35], a[200:203], a[100:103]
 v_mfma_f32_16x16x32_bf16 a[104:107], v[32:35], a[208:211], a[104:107]
 ds_read_b64_tr_b16 v[28:29], v5 offset:2048
 v_mfma_f32_16x16x32_bf16 a[104:107], v[36:39], a[212:215], a[104:107]
 v_mfma_f32_16x16x32_bf16 a[108:111], v[36:39], a[220:223], a[108:111]
 ds_read_b64_tr_b16 v[30:31], v5 offset:2304
 v_mfma_f32_16x16x32_bf16 a[108:111], v[32:35], a[216:219], a[108:111]
 s_waitcnt lgkmcnt(8)
 v_mfma_f32_16x16x32_bf16 a[112:115], v[40:43], a[192:195], a[112:115]
 ds_read_b64_tr_b16 v[32:33], v4 offset:4096
 v_mfma_f32_16x16x32_bf16 a[112:115], v[44:47], a[196:199], a[112:115]
 v_mfma_f32_16x16x32_bf16 a[116:119], v[44:47], a[204:207], a[116:119]
 ds_read_b64_tr_b16 v[34:35], v4 offset:4352
 v_mfma_f32_16x16x32_bf16 a[116:119], v[40:43], a[200:203], a[116:119]
 v_mfma_f32_16x16x32_bf16 a[120:123], v[40:43], a[208:211], a[120:123]
 ds_read_b64_tr_b16 v[36:37], v4 offset:6144
 v_mfma_f32_16x16x32_bf16 a[120:123], v[44:47], a[212:215], a[120:123]
 v_mfma_f32_16x16x32_bf16 a[124:127], v[44:47], a[220:223], a[124:127]
 ds_read_b64_tr_b16 v[38:39], v4 offset:6400
 v_mfma_f32_16x16x32_bf16 a[124:127], v[40:43], a[216:219], a[124:127]
 s_waitcnt vmcnt(0) lgkmcnt(8)
 v_mfma_f32_16x16x32_bf16 a[0:3], v[16:19], a[224:227], a[0:3]
 ds_read_b64_tr_b16 v[40:41], v5 offset:4096
 v_mfma_f32_16x16x32_bf16 a[0:3], v[20:23], a[228:231], a[0:3]
 v_mfma_f32_16x16x32_bf16 a[4:7], v[20:23], a[236:239], a[4:7]
 ds_read_b64_tr_b16 v[42:43], v5 offset:4352
 v_mfma_f32_16x16x32_bf16 a[4:7], v[16:19], a[232:235], a[4:7]
 v_mfma_f32_16x16x32_bf16 a[8:11], v[16:19], a[240:243], a[8:11]
 ds_read_b64_tr_b16 v[44:45], v5 offset:6144
 v_mfma_f32_16x16x32_bf16 a[8:11], v[20:23], a[244:247], a[8:11]
 v_mfma_f32_16x16x32_bf16 a[12:15], v[20:23], a[252:255], a[12:15]
 ds_read_b64_tr_b16 v[46:47], v5 offset:6400
 v_mfma_f32_16x16x32_bf16 a[12:15], v[16:19], a[248:251], a[12:15]
 s_waitcnt lgkmcnt(8)
 v_mfma_f32_16x16x32_bf16 a[16:19], v[24:27], a[224:227], a[16:19]
 ds_read_b64_tr_b16 v[16:17], v4 offset:8192
 v_mfma_f32_16x16x32_bf16 a[16:19], v[28:31], a[228:231], a[16:19]
 v_lshlrev_b32 v15, 3, v15
 v_mfma_f32_16x16x32_bf16 a[20:23], v[28:31], a[236:239], a[20:23]
 ds_read_b64_tr_b16 v[18:19], v4 offset:8448
 s_mov_b32 s16, s12
 v_mfma_f32_16x16x32_bf16 a[20:23], v[24:27], a[232:235], a[20:23]
 s_mov_b32 s17, s13
 v_mfma_f32_16x16x32_bf16 a[24:27], v[24:27], a[240:243], a[24:27]
 ds_read_b64_tr_b16 v[20:21], v4 offset:10240
 s_mov_b32 s18, 0x0
 v_mfma_f32_16x16x32_bf16 a[24:27], v[28:31], a[244:247], a[24:27]
 s_mov_b32 s19, 0x20000
 v_mfma_f32_16x16x32_bf16 a[28:31], v[28:31], a[252:255], a[28:31]
 ds_read_b64_tr_b16 v[22:23], v4 offset:10496
 s_add_u32 s18, s15, 2048
 v_mfma_f32_16x16x32_bf16 a[28:31], v[24:27], a[248:251], a[28:31]
 s_waitcnt lgkmcnt(8)
 s_add_u32 s82, s14, 7168
 v_mfma_f32_16x16x32_bf16 a[32:35], v[32:35], a[224:227], a[32:35]
 ds_read_b64_tr_b16 v[24:25], v5 offset:8192
 v_lshlrev_b32 v15, 4, v15
 v_mfma_f32_16x16x32_bf16 a[32:35], v[36:39], a[228:231], a[32:35]
 s_nop 0
 v_mfma_f32_16x16x32_bf16 a[36:39], v[36:39], a[236:239], a[36:39]
 ds_read_b64_tr_b16 v[26:27], v5 offset:8448
 v_lshrrev_b32 v0, 1, v15
 v_mfma_f32_16x16x32_bf16 a[36:39], v[32:35], a[232:235], a[36:39]
 v_add_u32 v0, 384, v0
 v_mfma_f32_16x16x32_bf16 a[40:43], v[32:35], a[240:243], a[40:43]
 ds_read_b64_tr_b16 v[28:29], v5 offset:10240
 s_nop 0
 v_mfma_f32_16x16x32_bf16 a[40:43], v[36:39], a[244:247], a[40:43]
 buffer_load_dword v1, v0, s[80:83], s14 offen
 v_mfma_f32_16x16x32_bf16 a[44:47], v[36:39], a[252:255], a[44:47]
 ds_read_b64_tr_b16 v[30:31], v5 offset:10496
 s_mul_i32 s14, s15, 7
 v_mfma_f32_16x16x32_bf16 a[44:47], v[32:35], a[248:251], a[44:47]
 s_waitcnt lgkmcnt(8)
 s_lshr_b32 s14, s14, 4
 v_mfma_f32_16x16x32_bf16 a[48:51], v[40:43], a[224:227], a[48:51]
 ds_read_b64_tr_b16 v[32:33], v4 offset:12288
 s_add_u32 s82, s14, 896
 v_mfma_f32_16x16x32_bf16 a[48:51], v[44:47], a[228:231], a[48:51]
 v_lshrrev_b32 v15, 4, v15
 v_mfma_f32_16x16x32_bf16 a[52:55], v[44:47], a[236:239], a[52:55]
 ds_read_b64_tr_b16 v[34:35], v4 offset:12544
 s_nop 0
 v_mfma_f32_16x16x32_bf16 a[52:55], v[40:43], a[232:235], a[52:55]
 buffer_load_dword v1, v15, s[80:83], s14 offen
 v_mfma_f32_16x16x32_bf16 a[56:59], v[40:43], a[240:243], a[56:59]
 ds_read_b64_tr_b16 v[36:37], v4 offset:14336
 s_add_u32 s14, s14, 917504
 v_mfma_f32_16x16x32_bf16 a[56:59], v[44:47], a[244:247], a[56:59]
 s_add_u32 s82, s14, 896
 v_mfma_f32_16x16x32_bf16 a[60:63], v[44:47], a[252:255], a[60:63]
 ds_read_b64_tr_b16 v[38:39], v4 offset:14592
 buffer_load_dword v1, v15, s[80:83], s14 offen
 v_mfma_f32_16x16x32_bf16 a[60:63], v[40:43], a[248:251], a[60:63]
 s_waitcnt lgkmcnt(8)
 s_lshl_b32 s3, s2, 2
 v_mfma_f32_16x16x32_bf16 a[64:67], v[16:19], a[224:227], a[64:67]
 ds_read_b64_tr_b16 v[40:41], v5 offset:12288
 s_add_u32 s3, s3, s95
 v_mfma_f32_16x16x32_bf16 a[64:67], v[20:23], a[228:231], a[64:67]
 s_and_b32 s3, s3, 255
 v_mfma_f32_16x16x32_bf16 a[68:71], v[20:23], a[236:239], a[68:71]
 ds_read_b64_tr_b16 v[42:43], v5 offset:12544
 s_mul_i32 s3, s3, 128
 v_mfma_f32_16x16x32_bf16 a[68:71], v[16:19], a[232:235], a[68:71]
 v_min_u32 v52, 0, v0
 v_mfma_f32_16x16x32_bf16 a[72:75], v[16:19], a[240:243], a[72:75]
 ds_read_b64_tr_b16 v[44:45], v5 offset:14336
 v_lshlrev_b32 v52, 7, v52
 v_mfma_f32_16x16x32_bf16 a[72:75], v[20:23], a[244:247], a[72:75]
 v_add_u32 v52, s3, v52
 v_mfma_f32_16x16x32_bf16 a[76:79], v[20:23], a[252:255], a[76:79]
 ds_read_b64_tr_b16 v[46:47], v5 offset:14592
 v_min_u32 v52, L_b_end - attfin_kernel - 4, v52
 v_mfma_f32_16x16x32_bf16 a[76:79], v[16:19], a[248:251], a[76:79]
 s_waitcnt lgkmcnt(8)
 s_getpc_b64 s[16:17]
 v_mfma_f32_16x16x32_bf16 a[80:83], v[24:27], a[224:227], a[80:83]
 ds_read_b64_tr_b16 v[16:17], v6 offset:16384
 s_add_u32 s16, s16, attfin_kernel - .
 v_mfma_f32_16x16x32_bf16 a[80:83], v[28:31], a[228:231], a[80:83]
 s_addc_u32 s17, s17, 0
 v_mfma_f32_16x16x32_bf16 a[84:87], v[28:31], a[236:239], a[84:87]
 ds_read_b64_tr_b16 v[18:19], v6 offset:16640
 v_mov_b32 v53, s17
 v_mfma_f32_16x16x32_bf16 a[84:87], v[24:27], a[232:235], a[84:87]
 v_add_co_u32 v52, vcc, s16, v52
 v_mfma_f32_16x16x32_bf16 a[88:91], v[24:27], a[240:243], a[88:91]
 ds_read_b64_tr_b16 v[20:21], v6 offset:18432
 s_nop 1
 v_mfma_f32_16x16x32_bf16 a[88:91], v[28:31], a[244:247], a[88:91]
 v_addc_co_u32 v53, vcc, 0, v53, vcc
 v_mfma_f32_16x16x32_bf16 a[92:95], v[28:31], a[252:255], a[92:95]
 ds_read_b64_tr_b16 v[22:23], v6 offset:18688
 global_load_dword v1, v[52:53], off
 v_mfma_f32_16x16x32_bf16 a[92:95], v[24:27], a[248:251], a[92:95]
 s_waitcnt lgkmcnt(8)
 s_mul_i32 s4, s97, 4
 s_add_u32 s4, s4, 0
 v_mfma_f32_16x16x32_bf16 a[96:99], v[32:35], a[224:227], a[96:99]
 ds_read_b64_tr_b16 v[24:25], v7 offset:16384
 s_lshl_b32 s4, s4, 10
 v_accvgpr_read_b32 v48, a0
 v_mfma_f32_16x16x32_bf16 a[96:99], v[36:39], a[228:231], a[96:99]
 v_accvgpr_read_b32 v49, a1
 v_accvgpr_read_b32 v50, a2
 v_mfma_f32_16x16x32_bf16 a[100:103], v[36:39], a[236:239], a[100:103]
 ds_read_b64_tr_b16 v[26:27], v7 offset:16640
 v_accvgpr_read_b32 v51, a3
 v_exp_f32 v56, -v48
 v_mfma_f32_16x16x32_bf16 a[100:103], v[32:35], a[232:235], a[100:103]
 v_exp_f32 v57, -v49
 v_exp_f32 v58, -v50
 v_mfma_f32_16x16x32_bf16 a[104:107], v[32:35], a[240:243], a[104:107]
 ds_read_b64_tr_b16 v[28:29], v7 offset:18432
 v_exp_f32 v59, -v51
 v_accvgpr_read_b32 v52, a32
 v_mfma_f32_16x16x32_bf16 a[104:107], v[36:39], a[244:247], a[104:107]
 v_accvgpr_read_b32 v53, a33
 v_accvgpr_read_b32 v54, a34
 v_mfma_f32_16x16x32_bf16 a[108:111], v[36:39], a[252:255], a[108:111]
 ds_read_b64_tr_b16 v[30:31], v7 offset:18688
 v_accvgpr_read_b32 v55, a35
 v_mul_f32 v52, v48, v52
 v_mfma_f32_16x16x32_bf16 a[108:111], v[32:35], a[248:251], a[108:111]
 s_waitcnt lgkmcnt(8)
 v_mul_f32 v53, v49, v53
 v_mul_f32 v54, v50, v54
 v_mfma_f32_16x16x32_bf16 a[112:115], v[40:43], a[224:227], a[112:115]
 ds_read_b64_tr_b16 v[32:33], v6 offset:20480
 v_mul_f32 v55, v51, v55
 v_fma_f32 v56, v56, s6, s6
 v_mfma_f32_16x16x32_bf16 a[112:115], v[44:47], a[228:231], a[112:115]
 v_fma_f32 v57, v57, s6, s6
 v_fma_f32 v58, v58, s6, s6
 v_mfma_f32_16x16x32_bf16 a[116:119], v[44:47], a[236:239], a[116:119]
 ds_read_b64_tr_b16 v[34:35], v6 offset:20736
 v_fma_f32 v59, v59, s6, s6
 v_mfma_f32_16x16x32_bf16 a[116:119], v[40:43], a[232:235], a[116:119]
 v_rcp_f32 v56, v56
 v_rcp_f32 v57, v57
 v_mfma_f32_16x16x32_bf16 a[120:123], v[40:43], a[240:243], a[120:123]
 ds_read_b64_tr_b16 v[36:37], v6 offset:22528
 v_rcp_f32 v58, v58
 v_rcp_f32 v59, v59
 v_mfma_f32_16x16x32_bf16 a[120:123], v[44:47], a[244:247], a[120:123]
 v_mul_f32 v52, v52, v56
 v_mul_f32 v53, v53, v57
 v_mfma_f32_16x16x32_bf16 a[124:127], v[44:47], a[252:255], a[124:127]
 ds_read_b64_tr_b16 v[38:39], v6 offset:22784
 v_mul_f32 v54, v54, v58
 v_mul_f32 v55, v55, v59
 v_mfma_f32_16x16x32_bf16 a[124:127], v[40:43], a[248:251], a[124:127]
 s_waitcnt lgkmcnt(8)
 v_cvt_pk_bf16_f32 v60, v52, v53
 v_cvt_pk_bf16_f32 v61, v54, v55
 v_mfma_f32_16x16x32_bf16 v[64:67], v[16:19], a[128:131], v[64:67]
 ds_read_b64_tr_b16 v[40:41], v7 offset:20480
 v_accvgpr_read_b32 v48, a16
 v_accvgpr_read_b32 v49, a17
 v_mfma_f32_16x16x32_bf16 v[64:67], v[20:23], a[132:135], v[64:67]
 v_accvgpr_read_b32 v50, a18
 v_accvgpr_read_b32 v51, a19
 v_mfma_f32_16x16x32_bf16 v[68:71], v[20:23], a[140:143], v[68:71]
 ds_read_b64_tr_b16 v[42:43], v7 offset:20736
 v_exp_f32 v56, -v48
 v_exp_f32 v57, -v49
 v_mfma_f32_16x16x32_bf16 v[68:71], v[16:19], a[136:139], v[68:71]
 v_exp_f32 v58, -v50
 v_exp_f32 v59, -v51
 v_mfma_f32_16x16x32_bf16 v[72:75], v[16:19], a[144:147], v[72:75]
 ds_read_b64_tr_b16 v[44:45], v7 offset:22528
 v_accvgpr_read_b32 v52, a48
 v_accvgpr_read_b32 v53, a49
 v_mfma_f32_16x16x32_bf16 v[72:75], v[20:23], a[148:151], v[72:75]
 v_accvgpr_read_b32 v54, a50
 v_mfma_f32_16x16x32_bf16 v[76:79], v[20:23], a[156:159], v[76:79]
 ds_read_b64_tr_b16 v[46:47], v7 offset:22784
 v_accvgpr_read_b32 v55, a51
 v_mul_f32 v52, v48, v52
 v_mfma_f32_16x16x32_bf16 v[76:79], v[16:19], a[152:155], v[76:79]
 s_waitcnt lgkmcnt(8)
 v_mul_f32 v53, v49, v53
 v_mul_f32 v54, v50, v54
 v_mfma_f32_16x16x32_bf16 v[80:83], v[24:27], a[128:131], v[80:83]
 ds_read_b64_tr_b16 v[16:17], v8 offset:16384
 v_mul_f32 v55, v51, v55
 v_fma_f32 v56, v56, s6, s6
 v_mfma_f32_16x16x32_bf16 v[80:83], v[28:31], a[132:135], v[80:83]
 v_fma_f32 v57, v57, s6, s6
 v_fma_f32 v58, v58, s6, s6
 v_mfma_f32_16x16x32_bf16 v[84:87], v[28:31], a[140:143], v[84:87]
 ds_read_b64_tr_b16 v[18:19], v8 offset:16640
 v_fma_f32 v59, v59, s6, s6
 v_rcp_f32 v56, v56
 v_mfma_f32_16x16x32_bf16 v[84:87], v[24:27], a[136:139], v[84:87]
 v_rcp_f32 v57, v57
 v_rcp_f32 v58, v58
 v_mfma_f32_16x16x32_bf16 v[88:91], v[24:27], a[144:147], v[88:91]
 ds_read_b64_tr_b16 v[20:21], v8 offset:18432
 v_rcp_f32 v59, v59
 v_mul_f32 v52, v52, v56
 v_mfma_f32_16x16x32_bf16 v[88:91], v[28:31], a[148:151], v[88:91]
 v_mul_f32 v53, v53, v57
 v_mul_f32 v54, v54, v58
 v_mfma_f32_16x16x32_bf16 v[92:95], v[28:31], a[156:159], v[92:95]
 ds_read_b64_tr_b16 v[22:23], v8 offset:18688
 v_mul_f32 v55, v55, v59
 v_cvt_pk_bf16_f32 v62, v52, v53
 v_mfma_f32_16x16x32_bf16 v[92:95], v[24:27], a[152:155], v[92:95]
 s_waitcnt lgkmcnt(8)
 v_cvt_pk_bf16_f32 v63, v54, v55
 s_add_u32 s5, s4, 0
 v_mfma_f32_16x16x32_bf16 v[96:99], v[32:35], a[128:131], v[96:99]
 ds_read_b64_tr_b16 v[24:25], v9 offset:16384
 buffer_store_dwordx4 v[60:63], v12, s[84:87], s5 offen sc1
 v_mfma_f32_16x16x32_bf16 v[96:99], v[36:39], a[132:135], v[96:99]
 v_accvgpr_read_b32 v48, a4
 v_accvgpr_read_b32 v49, a5
 v_mfma_f32_16x16x32_bf16 v[100:103], v[36:39], a[140:143], v[100:103]
 ds_read_b64_tr_b16 v[26:27], v9 offset:16640
 v_accvgpr_read_b32 v50, a6
 v_accvgpr_read_b32 v51, a7
 v_mfma_f32_16x16x32_bf16 v[100:103], v[32:35], a[136:139], v[100:103]
 v_exp_f32 v56, -v48
 v_exp_f32 v57, -v49
 v_mfma_f32_16x16x32_bf16 v[104:107], v[32:35], a[144:147], v[104:107]
 ds_read_b64_tr_b16 v[28:29], v9 offset:18432
 v_exp_f32 v58, -v50
 v_exp_f32 v59, -v51
 v_mfma_f32_16x16x32_bf16 v[104:107], v[36:39], a[148:151], v[104:107]
 v_accvgpr_read_b32 v52, a36
 v_accvgpr_read_b32 v53, a37
 v_mfma_f32_16x16x32_bf16 v[108:111], v[36:39], a[156:159], v[108:111]
 ds_read_b64_tr_b16 v[30:31], v9 offset:18688
 v_accvgpr_read_b32 v54, a38
 v_accvgpr_read_b32 v55, a39
 v_mfma_f32_16x16x32_bf16 v[108:111], v[32:35], a[152:155], v[108:111]
 s_waitcnt lgkmcnt(8)
 v_mul_f32 v52, v48, v52
 v_mul_f32 v53, v49, v53
 v_mfma_f32_16x16x32_bf16 v[112:115], v[40:43], a[128:131], v[112:115]
 ds_read_b64_tr_b16 v[32:33], v8 offset:20480
 v_mul_f32 v54, v50, v54
 v_mul_f32 v55, v51, v55
 v_mfma_f32_16x16x32_bf16 v[112:115], v[44:47], a[132:135], v[112:115]
 v_fma_f32 v56, v56, s6, s6
 v_fma_f32 v57, v57, s6, s6
 v_mfma_f32_16x16x32_bf16 v[116:119], v[44:47], a[140:143], v[116:119]
 ds_read_b64_tr_b16 v[34:35], v8 offset:20736
 v_fma_f32 v58, v58, s6, s6
 v_fma_f32 v59, v59, s6, s6
 v_mfma_f32_16x16x32_bf16 v[116:119], v[40:43], a[136:139], v[116:119]
 v_rcp_f32 v56, v56
 v_mfma_f32_16x16x32_bf16 v[120:123], v[40:43], a[144:147], v[120:123]
 ds_read_b64_tr_b16 v[36:37], v8 offset:22528
 v_rcp_f32 v57, v57
 v_rcp_f32 v58, v58
 v_mfma_f32_16x16x32_bf16 v[120:123], v[44:47], a[148:151], v[120:123]
 v_rcp_f32 v59, v59
 v_mul_f32 v52, v52, v56
 v_mfma_f32_16x16x32_bf16 v[124:127], v[44:47], a[156:159], v[124:127]
 ds_read_b64_tr_b16 v[38:39], v8 offset:22784
 v_mul_f32 v53, v53, v57
 v_mul_f32 v54, v54, v58
 v_mfma_f32_16x16x32_bf16 v[124:127], v[40:43], a[152:155], v[124:127]
 s_waitcnt lgkmcnt(8)
 v_mul_f32 v55, v55, v59
 v_cvt_pk_bf16_f32 v60, v52, v53
 v_mfma_f32_16x16x32_bf16 v[64:67], v[16:19], a[160:163], v[64:67]
 ds_read_b64_tr_b16 v[40:41], v9 offset:20480
 v_cvt_pk_bf16_f32 v61, v54, v55
 v_accvgpr_read_b32 v48, a20
 v_mfma_f32_16x16x32_bf16 v[64:67], v[20:23], a[164:167], v[64:67]
 v_accvgpr_read_b32 v49, a21
 v_accvgpr_read_b32 v50, a22
 v_mfma_f32_16x16x32_bf16 v[68:71], v[20:23], a[172:175], v[68:71]
 ds_read_b64_tr_b16 v[42:43], v9 offset:20736
 v_accvgpr_read_b32 v51, a23
 v_exp_f32 v56, -v48
 v_mfma_f32_16x16x32_bf16 v[68:71], v[16:19], a[168:171], v[68:71]
 v_exp_f32 v57, -v49
 v_exp_f32 v58, -v50
 v_mfma_f32_16x16x32_bf16 v[72:75], v[16:19], a[176:179], v[72:75]
 ds_read_b64_tr_b16 v[44:45], v9 offset:22528
 v_exp_f32 v59, -v51
 v_accvgpr_read_b32 v52, a52
 v_mfma_f32_16x16x32_bf16 v[72:75], v[20:23], a[180:183], v[72:75]
 v_accvgpr_read_b32 v53, a53
 v_accvgpr_read_b32 v54, a54
 v_mfma_f32_16x16x32_bf16 v[76:79], v[20:23], a[188:191], v[76:79]
 ds_read_b64_tr_b16 v[46:47], v9 offset:22784
 v_accvgpr_read_b32 v55, a55
 v_mfma_f32_16x16x32_bf16 v[76:79], v[16:19], a[184:187], v[76:79]
 s_waitcnt lgkmcnt(8)
 v_mul_f32 v52, v48, v52
 v_mul_f32 v53, v49, v53
 v_mfma_f32_16x16x32_bf16 v[80:83], v[24:27], a[160:163], v[80:83]
 ds_read_b64_tr_b16 v[16:17], v10 offset:16384
 v_mul_f32 v54, v50, v54
 v_mul_f32 v55, v51, v55
 v_mfma_f32_16x16x32_bf16 v[80:83], v[28:31], a[164:167], v[80:83]
 v_fma_f32 v56, v56, s6, s6
 v_fma_f32 v57, v57, s6, s6
 v_mfma_f32_16x16x32_bf16 v[84:87], v[28:31], a[172:175], v[84:87]
 ds_read_b64_tr_b16 v[18:19], v10 offset:16640
 v_fma_f32 v58, v58, s6, s6
 v_fma_f32 v59, v59, s6, s6
 v_mfma_f32_16x16x32_bf16 v[84:87], v[24:27], a[168:171], v[84:87]
 v_rcp_f32 v56, v56
 v_rcp_f32 v57, v57
 v_mfma_f32_16x16x32_bf16 v[88:91], v[24:27], a[176:179], v[88:91]
 ds_read_b64_tr_b16 v[20:21], v10 offset:18432
 v_rcp_f32 v58, v58
 v_rcp_f32 v59, v59
 v_mfma_f32_16x16x32_bf16 v[88:91], v[28:31], a[180:183], v[88:91]
 v_mul_f32 v52, v52, v56
 v_mul_f32 v53, v53, v57
 v_mfma_f32_16x16x32_bf16 v[92:95], v[28:31], a[188:191], v[92:95]
 ds_read_b64_tr_b16 v[22:23], v10 offset:18688
 v_mul_f32 v54, v54, v58
 v_mul_f32 v55, v55, v59
 v_mfma_f32_16x16x32_bf16 v[92:95], v[24:27], a[184:187], v[92:95]
 s_waitcnt lgkmcnt(8)
 v_cvt_pk_bf16_f32 v62, v52, v53
 v_cvt_pk_bf16_f32 v63, v54, v55
 v_mfma_f32_16x16x32_bf16 v[96:99], v[32:35], a[160:163], v[96:99]
 ds_read_b64_tr_b16 v[24:25], v11 offset:16384
 s_add_u32 s5, s4, 114688
 buffer_store_dwordx4 v[60:63], v12, s[84:87], s5 offen sc1
 v_mfma_f32_16x16x32_bf16 v[96:99], v[36:39], a[164:167], v[96:99]
 v_accvgpr_read_b32 v48, a8
 v_mfma_f32_16x16x32_bf16 v[100:103], v[36:39], a[172:175], v[100:103]
 ds_read_b64_tr_b16 v[26:27], v11 offset:16640
 v_accvgpr_read_b32 v49, a9
 v_accvgpr_read_b32 v50, a10
 v_mfma_f32_16x16x32_bf16 v[100:103], v[32:35], a[168:171], v[100:103]
 v_accvgpr_read_b32 v51, a11
 v_exp_f32 v56, -v48
 v_mfma_f32_16x16x32_bf16 v[104:107], v[32:35], a[176:179], v[104:107]
 ds_read_b64_tr_b16 v[28:29], v11 offset:18432
 v_exp_f32 v57, -v49
 v_exp_f32 v58, -v50
 v_mfma_f32_16x16x32_bf16 v[104:107], v[36:39], a[180:183], v[104:107]
 v_exp_f32 v59, -v51
 v_accvgpr_read_b32 v52, a40
 v_mfma_f32_16x16x32_bf16 v[108:111], v[36:39], a[188:191], v[108:111]
 ds_read_b64_tr_b16 v[30:31], v11 offset:18688
 v_accvgpr_read_b32 v53, a41
 v_accvgpr_read_b32 v54, a42
 v_mfma_f32_16x16x32_bf16 v[108:111], v[32:35], a[184:187], v[108:111]
 s_waitcnt lgkmcnt(8)
 v_accvgpr_read_b32 v55, a43
 v_mul_f32 v52, v48, v52
 v_mfma_f32_16x16x32_bf16 v[112:115], v[40:43], a[160:163], v[112:115]
 ds_read_b64_tr_b16 v[32:33], v10 offset:20480
 v_mul_f32 v53, v49, v53
 v_mul_f32 v54, v50, v54
 v_mfma_f32_16x16x32_bf16 v[112:115], v[44:47], a[164:167], v[112:115]
 v_mul_f32 v55, v51, v55
 v_fma_f32 v56, v56, s6, s6
 v_mfma_f32_16x16x32_bf16 v[116:119], v[44:47], a[172:175], v[116:119]
 ds_read_b64_tr_b16 v[34:35], v10 offset:20736
 v_fma_f32 v57, v57, s6, s6
 v_fma_f32 v58, v58, s6, s6
 v_mfma_f32_16x16x32_bf16 v[116:119], v[40:43], a[168:171], v[116:119]
 v_fma_f32 v59, v59, s6, s6
 v_rcp_f32 v56, v56
 v_mfma_f32_16x16x32_bf16 v[120:123], v[40:43], a[176:179], v[120:123]
 ds_read_b64_tr_b16 v[36:37], v10 offset:22528
 v_rcp_f32 v57, v57
 v_mfma_f32_16x16x32_bf16 v[120:123], v[44:47], a[180:183], v[120:123]
 v_rcp_f32 v58, v58
 v_rcp_f32 v59, v59
 v_mfma_f32_16x16x32_bf16 v[124:127], v[44:47], a[188:191], v[124:127]
 ds_read_b64_tr_b16 v[38:39], v10 offset:22784
 v_mul_f32 v52, v52, v56
 v_mul_f32 v53, v53, v57
 v_mfma_f32_16x16x32_bf16 v[124:127], v[40:43], a[184:187], v[124:127]
 s_waitcnt lgkmcnt(8)
 v_mul_f32 v54, v54, v58
 v_mul_f32 v55, v55, v59
 v_mfma_f32_16x16x32_bf16 v[64:67], v[16:19], a[192:195], v[64:67]
 ds_read_b64_tr_b16 v[40:41], v11 offset:20480
 v_cvt_pk_bf16_f32 v60, v52, v53
 v_cvt_pk_bf16_f32 v61, v54, v55
 v_mfma_f32_16x16x32_bf16 v[64:67], v[20:23], a[196:199], v[64:67]
 v_accvgpr_read_b32 v48, a24
 v_accvgpr_read_b32 v49, a25
 v_mfma_f32_16x16x32_bf16 v[68:71], v[20:23], a[204:207], v[68:71]
 ds_read_b64_tr_b16 v[42:43], v11 offset:20736
 v_accvgpr_read_b32 v50, a26
 v_accvgpr_read_b32 v51, a27
 v_mfma_f32_16x16x32_bf16 v[68:71], v[16:19], a[200:203], v[68:71]
 v_exp_f32 v56, -v48
 v_exp_f32 v57, -v49
 v_mfma_f32_16x16x32_bf16 v[72:75], v[16:19], a[208:211], v[72:75]
 ds_read_b64_tr_b16 v[44:45], v11 offset:22528
 v_exp_f32 v58, -v50
 v_exp_f32 v59, -v51
 v_mfma_f32_16x16x32_bf16 v[72:75], v[20:23], a[212:215], v[72:75]
 v_accvgpr_read_b32 v52, a56
 v_accvgpr_read_b32 v53, a57
 v_mfma_f32_16x16x32_bf16 v[76:79], v[20:23], a[220:223], v[76:79]
 ds_read_b64_tr_b16 v[46:47], v11 offset:22784
 v_accvgpr_read_b32 v54, a58
 v_accvgpr_read_b32 v55, a59
 v_mfma_f32_16x16x32_bf16 v[76:79], v[16:19], a[216:219], v[76:79]
 s_waitcnt lgkmcnt(8)
 v_mul_f32 v52, v48, v52
 v_mfma_f32_16x16x32_bf16 v[80:83], v[24:27], a[192:195], v[80:83]
 ds_read_b64_tr_b16 v[16:17], v4 offset:16384
 v_mul_f32 v53, v49, v53
 v_mul_f32 v54, v50, v54
 v_mfma_f32_16x16x32_bf16 v[80:83], v[28:31], a[196:199], v[80:83]
 v_mul_f32 v55, v51, v55
 v_fma_f32 v56, v56, s6, s6
 v_mfma_f32_16x16x32_bf16 v[84:87], v[28:31], a[204:207], v[84:87]
 ds_read_b64_tr_b16 v[18:19], v4 offset:16640
 v_fma_f32 v57, v57, s6, s6
 v_fma_f32 v58, v58, s6, s6
 v_mfma_f32_16x16x32_bf16 v[84:87], v[24:27], a[200:203], v[84:87]
 v_fma_f32 v59, v59, s6, s6
 v_rcp_f32 v56, v56
 v_mfma_f32_16x16x32_bf16 v[88:91], v[24:27], a[208:211], v[88:91]
 ds_read_b64_tr_b16 v[20:21], v4 offset:18432
 v_rcp_f32 v57, v57
 v_rcp_f32 v58, v58
 v_mfma_f32_16x16x32_bf16 v[88:91], v[28:31], a[212:215], v[88:91]
 v_rcp_f32 v59, v59
 v_mul_f32 v52, v52, v56
 v_mfma_f32_16x16x32_bf16 v[92:95], v[28:31], a[220:223], v[92:95]
 ds_read_b64_tr_b16 v[22:23], v4 offset:18688
 v_mul_f32 v53, v53, v57
 v_mul_f32 v54, v54, v58
 v_mfma_f32_16x16x32_bf16 v[92:95], v[24:27], a[216:219], v[92:95]
 s_waitcnt lgkmcnt(8)
 v_mul_f32 v55, v55, v59
 v_cvt_pk_bf16_f32 v62, v52, v53
 v_mfma_f32_16x16x32_bf16 v[96:99], v[32:35], a[192:195], v[96:99]
 ds_read_b64_tr_b16 v[24:25], v5 offset:16384
 v_cvt_pk_bf16_f32 v63, v54, v55
 s_add_u32 s5, s4, 229376
 v_mfma_f32_16x16x32_bf16 v[96:99], v[36:39], a[196:199], v[96:99]
 buffer_store_dwordx4 v[60:63], v12, s[84:87], s5 offen sc1
 v_accvgpr_read_b32 v48, a12
 v_mfma_f32_16x16x32_bf16 v[100:103], v[36:39], a[204:207], v[100:103]
 ds_read_b64_tr_b16 v[26:27], v5 offset:16640
 v_accvgpr_read_b32 v49, a13
 v_mfma_f32_16x16x32_bf16 v[100:103], v[32:35], a[200:203], v[100:103]
 v_accvgpr_read_b32 v50, a14
 v_accvgpr_read_b32 v51, a15
 v_mfma_f32_16x16x32_bf16 v[104:107], v[32:35], a[208:211], v[104:107]
 ds_read_b64_tr_b16 v[28:29], v5 offset:18432
 v_exp_f32 v56, -v48
 v_exp_f32 v57, -v49
 v_mfma_f32_16x16x32_bf16 v[104:107], v[36:39], a[212:215], v[104:107]
 v_exp_f32 v58, -v50
 v_exp_f32 v59, -v51
 v_mfma_f32_16x16x32_bf16 v[108:111], v[36:39], a[220:223], v[108:111]
 ds_read_b64_tr_b16 v[30:31], v5 offset:18688
 v_accvgpr_read_b32 v52, a44
 v_accvgpr_read_b32 v53, a45
 v_mfma_f32_16x16x32_bf16 v[108:111], v[32:35], a[216:219], v[108:111]
 s_waitcnt lgkmcnt(8)
 v_accvgpr_read_b32 v54, a46
 v_accvgpr_read_b32 v55, a47
 v_mfma_f32_16x16x32_bf16 v[112:115], v[40:43], a[192:195], v[112:115]
 ds_read_b64_tr_b16 v[32:33], v4 offset:20480
 v_mul_f32 v52, v48, v52
 v_mul_f32 v53, v49, v53
 v_mfma_f32_16x16x32_bf16 v[112:115], v[44:47], a[196:199], v[112:115]
 v_mul_f32 v54, v50, v54
 v_mul_f32 v55, v51, v55
 v_mfma_f32_16x16x32_bf16 v[116:119], v[44:47], a[204:207], v[116:119]
 ds_read_b64_tr_b16 v[34:35], v4 offset:20736
 v_fma_f32 v56, v56, s6, s6
 v_fma_f32 v57, v57, s6, s6
 v_mfma_f32_16x16x32_bf16 v[116:119], v[40:43], a[200:203], v[116:119]
 v_fma_f32 v58, v58, s6, s6
 v_fma_f32 v59, v59, s6, s6
 v_mfma_f32_16x16x32_bf16 v[120:123], v[40:43], a[208:211], v[120:123]
 ds_read_b64_tr_b16 v[36:37], v4 offset:22528
 v_rcp_f32 v56, v56
 v_rcp_f32 v57, v57
 v_mfma_f32_16x16x32_bf16 v[120:123], v[44:47], a[212:215], v[120:123]
 v_rcp_f32 v58, v58
 v_mfma_f32_16x16x32_bf16 v[124:127], v[44:47], a[220:223], v[124:127]
 ds_read_b64_tr_b16 v[38:39], v4 offset:22784
 v_rcp_f32 v59, v59
 v_mul_f32 v52, v52, v56
 v_mfma_f32_16x16x32_bf16 v[124:127], v[40:43], a[216:219], v[124:127]
 s_waitcnt lgkmcnt(8)
 v_mul_f32 v53, v53, v57
 v_mul_f32 v54, v54, v58
 v_mfma_f32_16x16x32_bf16 v[64:67], v[16:19], a[224:227], v[64:67]
 ds_read_b64_tr_b16 v[40:41], v5 offset:20480
 v_mul_f32 v55, v55, v59
 v_cvt_pk_bf16_f32 v60, v52, v53
 v_mfma_f32_16x16x32_bf16 v[64:67], v[20:23], a[228:231], v[64:67]
 v_cvt_pk_bf16_f32 v61, v54, v55
 v_accvgpr_read_b32 v48, a28
 v_mfma_f32_16x16x32_bf16 v[68:71], v[20:23], a[236:239], v[68:71]
 ds_read_b64_tr_b16 v[42:43], v5 offset:20736
 v_accvgpr_read_b32 v49, a29
 v_accvgpr_read_b32 v50, a30
 v_mfma_f32_16x16x32_bf16 v[68:71], v[16:19], a[232:235], v[68:71]
 v_accvgpr_read_b32 v51, a31
 v_exp_f32 v56, -v48
 v_mfma_f32_16x16x32_bf16 v[72:75], v[16:19], a[240:243], v[72:75]
 ds_read_b64_tr_b16 v[44:45], v5 offset:22528
 v_exp_f32 v57, -v49
 v_exp_f32 v58, -v50
 v_mfma_f32_16x16x32_bf16 v[72:75], v[20:23], a[244:247], v[72:75]
 v_exp_f32 v59, -v51
 v_accvgpr_read_b32 v52, a60
 v_mfma_f32_16x16x32_bf16 v[76:79], v[20:23], a[252:255], v[76:79]
 ds_read_b64_tr_b16 v[46:47], v5 offset:22784
 v_accvgpr_read_b32 v53, a61
 v_accvgpr_read_b32 v54, a62
 v_mfma_f32_16x16x32_bf16 v[76:79], v[16:19], a[248:251], v[76:79]
 s_waitcnt lgkmcnt(8)
 v_accvgpr_read_b32 v55, a63
 v_mul_f32 v52, v48, v52
 v_mfma_f32_16x16x32_bf16 v[80:83], v[24:27], a[224:227], v[80:83]
 ds_read_b64_tr_b16 v[16:17], v6 offset:24576
 v_mul_f32 v53, v49, v53
 v_mfma_f32_16x16x32_bf16 v[80:83], v[28:31], a[228:231], v[80:83]
 v_mul_f32 v54, v50, v54
 v_mul_f32 v55, v51, v55
 v_mfma_f32_16x16x32_bf16 v[84:87], v[28:31], a[236:239], v[84:87]
 ds_read_b64_tr_b16 v[18:19], v6 offset:24832
 v_fma_f32 v56, v56, s6, s6
 v_fma_f32 v57, v57, s6, s6
 v_mfma_f32_16x16x32_bf16 v[84:87], v[24:27], a[232:235], v[84:87]
 v_fma_f32 v58, v58, s6, s6
 v_fma_f32 v59, v59, s6, s6
 v_mfma_f32_16x16x32_bf16 v[88:91], v[24:27], a[240:243], v[88:91]
 ds_read_b64_tr_b16 v[20:21], v6 offset:26624
 v_rcp_f32 v56, v56
 v_rcp_f32 v57, v57
 v_mfma_f32_16x16x32_bf16 v[88:91], v[28:31], a[244:247], v[88:91]
 v_rcp_f32 v58, v58
 v_rcp_f32 v59, v59
 v_mfma_f32_16x16x32_bf16 v[92:95], v[28:31], a[252:255], v[92:95]
 ds_read_b64_tr_b16 v[22:23], v6 offset:26880
 v_mul_f32 v52, v52, v56
 v_mul_f32 v53, v53, v57
 v_mfma_f32_16x16x32_bf16 v[92:95], v[24:27], a[248:251], v[92:95]
 s_waitcnt lgkmcnt(8)
 v_mul_f32 v54, v54, v58
 v_mul_f32 v55, v55, v59
 v_mfma_f32_16x16x32_bf16 v[96:99], v[32:35], a[224:227], v[96:99]
 ds_read_b64_tr_b16 v[24:25], v7 offset:24576
 v_cvt_pk_bf16_f32 v62, v52, v53
 v_cvt_pk_bf16_f32 v63, v54, v55
 v_mfma_f32_16x16x32_bf16 v[96:99], v[36:39], a[228:231], v[96:99]
 s_add_u32 s5, s4, 344064
 buffer_store_dwordx4 v[60:63], v12, s[84:87], s5 offen sc1
 v_mfma_f32_16x16x32_bf16 v[100:103], v[36:39], a[236:239], v[100:103]
 ds_read_b64_tr_b16 v[26:27], v7 offset:24832
 s_mul_i32 s4, s97, 4
 s_add_u32 s4, s4, 1
 v_mfma_f32_16x16x32_bf16 v[100:103], v[32:35], a[232:235], v[100:103]
 s_lshl_b32 s4, s4, 10
 v_mfma_f32_16x16x32_bf16 v[104:107], v[32:35], a[240:243], v[104:107]
 ds_read_b64_tr_b16 v[28:29], v7 offset:26624
 v_accvgpr_read_b32 v48, a64
 v_accvgpr_read_b32 v49, a65
 v_mfma_f32_16x16x32_bf16 v[104:107], v[36:39], a[244:247], v[104:107]
 v_accvgpr_read_b32 v50, a66
 v_accvgpr_read_b32 v51, a67
 v_mfma_f32_16x16x32_bf16 v[108:111], v[36:39], a[252:255], v[108:111]
 ds_read_b64_tr_b16 v[30:31], v7 offset:26880
 v_exp_f32 v56, -v48
 v_exp_f32 v57, -v49
 v_mfma_f32_16x16x32_bf16 v[108:111], v[32:35], a[248:251], v[108:111]
 s_waitcnt lgkmcnt(8)
 v_exp_f32 v58, -v50
 v_exp_f32 v59, -v51
 v_mfma_f32_16x16x32_bf16 v[112:115], v[40:43], a[224:227], v[112:115]
 ds_read_b64_tr_b16 v[32:33], v6 offset:28672
 v_accvgpr_read_b32 v52, a96
 v_accvgpr_read_b32 v53, a97
 v_mfma_f32_16x16x32_bf16 v[112:115], v[44:47], a[228:231], v[112:115]
 v_accvgpr_read_b32 v54, a98
 v_accvgpr_read_b32 v55, a99
 v_mfma_f32_16x16x32_bf16 v[116:119], v[44:47], a[236:239], v[116:119]
 ds_read_b64_tr_b16 v[34:35], v6 offset:28928
 v_mul_f32 v52, v48, v52
 v_mul_f32 v53, v49, v53
 v_mfma_f32_16x16x32_bf16 v[116:119], v[40:43], a[232:235], v[116:119]
 v_mul_f32 v54, v50, v54
 v_mul_f32 v55, v51, v55
 v_mfma_f32_16x16x32_bf16 v[120:123], v[40:43], a[240:243], v[120:123]
 ds_read_b64_tr_b16 v[36:37], v6 offset:30720
 v_fma_f32 v56, v56, s6, s6
 v_fma_f32 v57, v57, s6, s6
 v_mfma_f32_16x16x32_bf16 v[120:123], v[44:47], a[244:247], v[120:123]
 v_fma_f32 v58, v58, s6, s6
 v_fma_f32 v59, v59, s6, s6
 v_mfma_f32_16x16x32_bf16 v[124:127], v[44:47], a[252:255], v[124:127]
 ds_read_b64_tr_b16 v[38:39], v6 offset:30976
 v_rcp_f32 v56, v56
 v_rcp_f32 v57, v57
 v_mfma_f32_16x16x32_bf16 v[124:127], v[40:43], a[248:251], v[124:127]
 s_waitcnt lgkmcnt(8)
 v_rcp_f32 v58, v58
 v_mfma_f32_16x16x32_bf16 v[128:131], v[16:19], a[128:131], v[128:131]
 ds_read_b64_tr_b16 v[40:41], v7 offset:28672
 v_rcp_f32 v59, v59
 v_mul_f32 v52, v52, v56
 v_mfma_f32_16x16x32_bf16 v[128:131], v[20:23], a[132:135], v[128:131]
 v_mul_f32 v53, v53, v57
 v_mul_f32 v54, v54, v58
 v_mfma_f32_16x16x32_bf16 v[132:135], v[20:23], a[140:143], v[132:135]
 ds_read_b64_tr_b16 v[42:43], v7 offset:28928
 v_mul_f32 v55, v55, v59
 v_cvt_pk_bf16_f32 v60, v52, v53
 v_mfma_f32_16x16x32_bf16 v[132:135], v[16:19], a[136:139], v[132:135]
 v_cvt_pk_bf16_f32 v61, v54, v55
 v_accvgpr_read_b32 v48, a80
 v_mfma_f32_16x16x32_bf16 v[136:139], v[16:19], a[144:147], v[136:139]
 ds_read_b64_tr_b16 v[44:45], v7 offset:30720
 v_accvgpr_read_b32 v49, a81
 v_accvgpr_read_b32 v50, a82
 v_mfma_f32_16x16x32_bf16 v[136:139], v[20:23], a[148:151], v[136:139]
 v_accvgpr_read_b32 v51, a83
 v_exp_f32 v56, -v48
 v_mfma_f32_16x16x32_bf16 v[140:143], v[20:23], a[156:159], v[140:143]
 ds_read_b64_tr_b16 v[46:47], v7 offset:30976
 v_exp_f32 v57, -v49
 v_exp_f32 v58, -v50
 v_mfma_f32_16x16x32_bf16 v[140:143], v[16:19], a[152:155], v[140:143]
 s_waitcnt lgkmcnt(8)
 v_exp_f32 v59, -v51
 v_accvgpr_read_b32 v52, a112
 v_mfma_f32_16x16x32_bf16 v[144:147], v[24:27], a[128:131], v[144:147]
 ds_read_b64_tr_b16 v[16:17], v8 offset:24576
 v_accvgpr_read_b32 v53, a113
 v_accvgpr_read_b32 v54, a114
 v_mfma_f32_16x16x32_bf16 v[144:147], v[28:31], a[132:135], v[144:147]
 v_accvgpr_read_b32 v55, a115
 v_mul_f32 v52, v48, v52
 v_mfma_f32_16x16x32_bf16 v[148:151], v[28:31], a[140:143], v[148:151]
 ds_read_b64_tr_b16 v[18:19], v8 offset:24832
 v_mul_f32 v53, v49, v53
 v_mfma_f32_16x16x32_bf16 v[148:151], v[24:27], a[136:139], v[148:151]
 v_mul_f32 v54, v50, v54
 v_mul_f32 v55, v51, v55
 v_mfma_f32_16x16x32_bf16 v[152:155], v[24:27], a[144:147], v[152:155]
 ds_read_b64_tr_b16 v[20:21], v8 offset:26624
 v_fma_f32 v56, v56, s6, s6
 v_fma_f32 v57, v57, s6, s6
 v_mfma_f32_16x16x32_bf16 v[152:155], v[28:31], a[148:151], v[152:155]
 v_fma_f32 v58, v58, s6, s6
 v_fma_f32 v59, v59, s6, s6
 v_mfma_f32_16x16x32_bf16 v[156:159], v[28:31], a[156:159], v[156:159]
 ds_read_b64_tr_b16 v[22:23], v8 offset:26880
 v_rcp_f32 v56, v56
 v_rcp_f32 v57, v57
 v_mfma_f32_16x16x32_bf16 v[156:159], v[24:27], a[152:155], v[156:159]
 s_waitcnt lgkmcnt(8)
 v_rcp_f32 v58, v58
 v_rcp_f32 v59, v59
 v_mfma_f32_16x16x32_bf16 v[160:163], v[32:35], a[128:131], v[160:163]
 ds_read_b64_tr_b16 v[24:25], v9 offset:24576
 v_mul_f32 v52, v52, v56
 v_mul_f32 v53, v53, v57
 v_mfma_f32_16x16x32_bf16 v[160:163], v[36:39], a[132:135], v[160:163]
 v_mul_f32 v54, v54, v58
 v_mul_f32 v55, v55, v59
 v_mfma_f32_16x16x32_bf16 v[164:167], v[36:39], a[140:143], v[164:167]
 ds_read_b64_tr_b16 v[26:27], v9 offset:24832
 v_cvt_pk_bf16_f32 v62, v52, v53
 v_cvt_pk_bf16_f32 v63, v54, v55
 v_mfma_f32_16x16x32_bf16 v[164:167], v[32:35], a[136:139], v[164:167]
 s_add_u32 s5, s4, 0
 buffer_store_dwordx4 v[60:63], v12, s[84:87], s5 offen sc1
 v_mfma_f32_16x16x32_bf16 v[168:171], v[32:35], a[144:147], v[168:171]
 ds_read_b64_tr_b16 v[28:29], v9 offset:26624
 v_accvgpr_read_b32 v48, a68
 v_accvgpr_read_b32 v49, a69
 v_mfma_f32_16x16x32_bf16 v[168:171], v[36:39], a[148:151], v[168:171]
 v_accvgpr_read_b32 v50, a70
 v_mfma_f32_16x16x32_bf16 v[172:175], v[36:39], a[156:159], v[172:175]
 ds_read_b64_tr_b16 v[30:31], v9 offset:26880
 v_accvgpr_read_b32 v51, a71
 v_exp_f32 v56, -v48
 v_mfma_f32_16x16x32_bf16 v[172:175], v[32:35], a[152:155], v[172:175]
 s_waitcnt lgkmcnt(8)
 v_exp_f32 v57, -v49
 v_exp_f32 v58, -v50
 v_mfma_f32_16x16x32_bf16 v[176:179], v[40:43], a[128:131], v[176:179]
 ds_read_b64_tr_b16 v[32:33], v8 offset:28672
 v_exp_f32 v59, -v51
 v_accvgpr_read_b32 v52, a100
 v_mfma_f32_16x16x32_bf16 v[176:179], v[44:47], a[132:135], v[176:179]
 v_accvgpr_read_b32 v53, a101
 v_accvgpr_read_b32 v54, a102
 v_mfma_f32_16x16x32_bf16 v[180:183], v[44:47], a[140:143], v[180:183]
 ds_read_b64_tr_b16 v[34:35], v8 offset:28928
 v_accvgpr_read_b32 v55, a103
 v_mul_f32 v52, v48, v52
 v_mfma_f32_16x16x32_bf16 v[180:183], v[40:43], a[136:139], v[180:183]
 v_mul_f32 v53, v49, v53
 v_mul_f32 v54, v50, v54
 v_mfma_f32_16x16x32_bf16 v[184:187], v[40:43], a[144:147], v[184:187]
 ds_read_b64_tr_b16 v[36:37], v8 offset:30720
 v_mul_f32 v55, v51, v55
 v_fma_f32 v56, v56, s6, s6
 v_mfma_f32_16x16x32_bf16 v[184:187], v[44:47], a[148:151], v[184:187]
 v_fma_f32 v57, v57, s6, s6
 v_fma_f32 v58, v58, s6, s6
 v_mfma_f32_16x16x32_bf16 v[188:191], v[44:47], a[156:159], v[188:191]
 ds_read_b64_tr_b16 v[38:39], v8 offset:30976
 v_fma_f32 v59, v59, s6, s6
 v_rcp_f32 v56, v56
 v_mfma_f32_16x16x32_bf16 v[188:191], v[40:43], a[152:155], v[188:191]
 s_waitcnt lgkmcnt(8)
 v_rcp_f32 v57, v57
 v_rcp_f32 v58, v58
 v_mfma_f32_16x16x32_bf16 v[128:131], v[16:19], a[160:163], v[128:131]
 ds_read_b64_tr_b16 v[40:41], v9 offset:28672
 v_rcp_f32 v59, v59
 v_mfma_f32_16x16x32_bf16 v[128:131], v[20:23], a[164:167], v[128:131]
 v_mul_f32 v52, v52, v56
 v_mul_f32 v53, v53, v57
 v_mfma_f32_16x16x32_bf16 v[132:135], v[20:23], a[172:175], v[132:135]
 ds_read_b64_tr_b16 v[42:43], v9 offset:28928
 v_mul_f32 v54, v54, v58
 v_mul_f32 v55, v55, v59
 v_mfma_f32_16x16x32_bf16 v[132:135], v[16:19], a[168:171], v[132:135]
 v_cvt_pk_bf16_f32 v60, v52, v53
 v_cvt_pk_bf16_f32 v61, v54, v55
 v_mfma_f32_16x16x32_bf16 v[136:139], v[16:19], a[176:179], v[136:139]
 ds_read_b64_tr_b16 v[44:45], v9 offset:30720
 v_accvgpr_read_b32 v48, a84
 v_accvgpr_read_b32 v49, a85
 v_mfma_f32_16x16x32_bf16 v[136:139], v[20:23], a[180:183], v[136:139]
 v_accvgpr_read_b32 v50, a86
 v_accvgpr_read_b32 v51, a87
 v_mfma_f32_16x16x32_bf16 v[140:143], v[20:23], a[188:191], v[140:143]
 ds_read_b64_tr_b16 v[46:47], v9 offset:30976
 v_exp_f32 v56, -v48
 v_exp_f32 v57, -v49
 v_mfma_f32_16x16x32_bf16 v[140:143], v[16:19], a[184:187], v[140:143]
 s_waitcnt lgkmcnt(8)
 v_exp_f32 v58, -v50
 v_exp_f32 v59, -v51
 v_mfma_f32_16x16x32_bf16 v[144:147], v[24:27], a[160:163], v[144:147]
 ds_read_b64_tr_b16 v[16:17], v10 offset:24576
 v_accvgpr_read_b32 v52, a116
 v_accvgpr_read_b32 v53, a117
 v_mfma_f32_16x16x32_bf16 v[144:147], v[28:31], a[164:167], v[144:147]
 v_accvgpr_read_b32 v54, a118
 v_accvgpr_read_b32 v55, a119
 v_mfma_f32_16x16x32_bf16 v[148:151], v[28:31], a[172:175], v[148:151]
 ds_read_b64_tr_b16 v[18:19], v10 offset:24832
 v_mul_f32 v52, v48, v52
 v_mul_f32 v53, v49, v53
 v_mfma_f32_16x16x32_bf16 v[148:151], v[24:27], a[168:171], v[148:151]
 v_mul_f32 v54, v50, v54
 v_mfma_f32_16x16x32_bf16 v[152:155], v[24:27], a[176:179], v[152:155]
 ds_read_b64_tr_b16 v[20:21], v10 offset:26624
 v_mul_f32 v55, v51, v55
 v_fma_f32 v56, v56, s6, s6
 v_mfma_f32_16x16x32_bf16 v[152:155], v[28:31], a[180:183], v[152:155]
 v_fma_f32 v57, v57, s6, s6
 v_fma_f32 v58, v58, s6, s6
 v_mfma_f32_16x16x32_bf16 v[156:159], v[28:31], a[188:191], v[156:159]
 ds_read_b64_tr_b16 v[22:23], v10 offset:26880
 v_fma_f32 v59, v59, s6, s6
 v_rcp_f32 v56, v56
 v_mfma_f32_16x16x32_bf16 v[156:159], v[24:27], a[184:187], v[156:159]
 s_waitcnt lgkmcnt(8)
 v_rcp_f32 v57, v57
 v_rcp_f32 v58, v58
 v_mfma_f32_16x16x32_bf16 v[160:163], v[32:35], a[160:163], v[160:163]
 ds_read_b64_tr_b16 v[24:25], v11 offset:24576
 v_rcp_f32 v59, v59
 v_mul_f32 v52, v52, v56
 v_mfma_f32_16x16x32_bf16 v[160:163], v[36:39], a[164:167], v[160:163]
 v_mul_f32 v53, v53, v57
 v_mul_f32 v54, v54, v58
 v_mfma_f32_16x16x32_bf16 v[164:167], v[36:39], a[172:175], v[164:167]
 ds_read_b64_tr_b16 v[26:27], v11 offset:24832
 v_mul_f32 v55, v55, v59
 v_cvt_pk_bf16_f32 v62, v52, v53
 v_mfma_f32_16x16x32_bf16 v[164:167], v[32:35], a[168:171], v[164:167]
 v_cvt_pk_bf16_f32 v63, v54, v55
 s_add_u32 s5, s4, 114688
 v_mfma_f32_16x16x32_bf16 v[168:171], v[32:35], a[176:179], v[168:171]
 ds_read_b64_tr_b16 v[28:29], v11 offset:26624
 buffer_store_dwordx4 v[60:63], v12, s[84:87], s5 offen sc1
 v_accvgpr_read_b32 v48, a72
 v_mfma_f32_16x16x32_bf16 v[168:171], v[36:39], a[180:183], v[168:171]
 v_accvgpr_read_b32 v49, a73
 v_accvgpr_read_b32 v50, a74
 v_mfma_f32_16x16x32_bf16 v[172:175], v[36:39], a[188:191], v[172:175]
 ds_read_b64_tr_b16 v[30:31], v11 offset:26880
 v_accvgpr_read_b32 v51, a75
 v_mfma_f32_16x16x32_bf16 v[172:175], v[32:35], a[184:187], v[172:175]
 s_waitcnt lgkmcnt(8)
 v_exp_f32 v56, -v48
 v_exp_f32 v57, -v49
 v_mfma_f32_16x16x32_bf16 v[176:179], v[40:43], a[160:163], v[176:179]
 ds_read_b64_tr_b16 v[32:33], v10 offset:28672
 v_exp_f32 v58, -v50
 v_exp_f32 v59, -v51
 v_mfma_f32_16x16x32_bf16 v[176:179], v[44:47], a[164:167], v[176:179]
 v_accvgpr_read_b32 v52, a104
 v_accvgpr_read_b32 v53, a105
 v_mfma_f32_16x16x32_bf16 v[180:183], v[44:47], a[172:175], v[180:183]
 ds_read_b64_tr_b16 v[34:35], v10 offset:28928
 v_accvgpr_read_b32 v54, a106
 v_accvgpr_read_b32 v55, a107
 v_mfma_f32_16x16x32_bf16 v[180:183], v[40:43], a[168:171], v[180:183]
 v_mul_f32 v52, v48, v52
 v_mul_f32 v53, v49, v53
 v_mfma_f32_16x16x32_bf16 v[184:187], v[40:43], a[176:179], v[184:187]
 ds_read_b64_tr_b16 v[36:37], v10 offset:30720
 v_mul_f32 v54, v50, v54
 v_mul_f32 v55, v51, v55
 v_mfma_f32_16x16x32_bf16 v[184:187], v[44:47], a[180:183], v[184:187]
 v_fma_f32 v56, v56, s6, s6
 v_fma_f32 v57, v57, s6, s6
 v_mfma_f32_16x16x32_bf16 v[188:191], v[44:47], a[188:191], v[188:191]
 ds_read_b64_tr_b16 v[38:39], v10 offset:30976
 v_fma_f32 v58, v58, s6, s6
 v_fma_f32 v59, v59, s6, s6
 v_mfma_f32_16x16x32_bf16 v[188:191], v[40:43], a[184:187], v[188:191]
 s_waitcnt lgkmcnt(8)
 v_rcp_f32 v56, v56
 v_rcp_f32 v57, v57
 v_mfma_f32_16x16x32_bf16 v[128:131], v[16:19], a[192:195], v[128:131]
 ds_read_b64_tr_b16 v[40:41], v11 offset:28672
 v_rcp_f32 v58, v58
 v_rcp_f32 v59, v59
 v_mfma_f32_16x16x32_bf16 v[128:131], v[20:23], a[196:199], v[128:131]
 v_mul_f32 v52, v52, v56
 v_mfma_f32_16x16x32_bf16 v[132:135], v[20:23], a[204:207], v[132:135]
 ds_read_b64_tr_b16 v[42:43], v11 offset:28928
 v_mul_f32 v53, v53, v57
 v_mul_f32 v54, v54, v58
 v_mfma_f32_16x16x32_bf16 v[132:135], v[16:19], a[200:203], v[132:135]
 v_mul_f32 v55, v55, v59
 v_cvt_pk_bf16_f32 v60, v52, v53
 v_mfma_f32_16x16x32_bf16 v[136:139], v[16:19], a[208:211], v[136:139]
 ds_read_b64_tr_b16 v[44:45], v11 offset:30720
 v_cvt_pk_bf16_f32 v61, v54, v55
 v_accvgpr_read_b32 v48, a88
 v_mfma_f32_16x16x32_bf16 v[136:139], v[20:23], a[212:215], v[136:139]
 v_accvgpr_read_b32 v49, a89
 v_accvgpr_read_b32 v50, a90
 v_mfma_f32_16x16x32_bf16 v[140:143], v[20:23], a[220:223], v[140:143]
 ds_read_b64_tr_b16 v[46:47], v11 offset:30976
 v_accvgpr_read_b32 v51, a91
 v_exp_f32 v56, -v48
 v_mfma_f32_16x16x32_bf16 v[140:143], v[16:19], a[216:219], v[140:143]
 s_waitcnt lgkmcnt(8)
 v_exp_f32 v57, -v49
 v_exp_f32 v58, -v50
 v_mfma_f32_16x16x32_bf16 v[144:147], v[24:27], a[192:195], v[144:147]
 ds_read_b64_tr_b16 v[16:17], v4 offset:24576
 v_exp_f32 v59, -v51
 v_accvgpr_read_b32 v52, a120
 v_mfma_f32_16x16x32_bf16 v[144:147], v[28:31], a[196:199], v[144:147]
 v_accvgpr_read_b32 v53, a121
 v_accvgpr_read_b32 v54, a122
 v_mfma_f32_16x16x32_bf16 v[148:151], v[28:31], a[204:207], v[148:151]
 ds_read_b64_tr_b16 v[18:19], v4 offset:24832
 v_accvgpr_read_b32 v55, a123
 v_mul_f32 v52, v48, v52
 v_mfma_f32_16x16x32_bf16 v[148:151], v[24:27], a[200:203], v[148:151]
 v_mul_f32 v53, v49, v53
 v_mul_f32 v54, v50, v54
 v_mfma_f32_16x16x32_bf16 v[152:155], v[24:27], a[208:211], v[152:155]
 ds_read_b64_tr_b16 v[20:21], v4 offset:26624
 v_mul_f32 v55, v51, v55
 v_mfma_f32_16x16x32_bf16 v[152:155], v[28:31], a[212:215], v[152:155]
 v_fma_f32 v56, v56, s6, s6
 v_fma_f32 v57, v57, s6, s6
 v_mfma_f32_16x16x32_bf16 v[156:159], v[28:31], a[220:223], v[156:159]
 ds_read_b64_tr_b16 v[22:23], v4 offset:26880
 v_fma_f32 v58, v58, s6, s6
 v_fma_f32 v59, v59, s6, s6
 v_mfma_f32_16x16x32_bf16 v[156:159], v[24:27], a[216:219], v[156:159]
 s_waitcnt lgkmcnt(8)
 v_rcp_f32 v56, v56
 v_rcp_f32 v57, v57
 v_mfma_f32_16x16x32_bf16 v[160:163], v[32:35], a[192:195], v[160:163]
 ds_read_b64_tr_b16 v[24:25], v5 offset:24576
 v_rcp_f32 v58, v58
 v_rcp_f32 v59, v59
 v_mfma_f32_16x16x32_bf16 v[160:163], v[36:39], a[196:199], v[160:163]
 v_mul_f32 v52, v52, v56
 v_mul_f32 v53, v53, v57
 v_mfma_f32_16x16x32_bf16 v[164:167], v[36:39], a[204:207], v[164:167]
 ds_read_b64_tr_b16 v[26:27], v5 offset:24832
 v_mul_f32 v54, v54, v58
 v_mul_f32 v55, v55, v59
 v_mfma_f32_16x16x32_bf16 v[164:167], v[32:35], a[200:203], v[164:167]
 v_cvt_pk_bf16_f32 v62, v52, v53
 v_cvt_pk_bf16_f32 v63, v54, v55
 v_mfma_f32_16x16x32_bf16 v[168:171], v[32:35], a[208:211], v[168:171]
 ds_read_b64_tr_b16 v[28:29], v5 offset:26624
 s_add_u32 s5, s4, 229376
 buffer_store_dwordx4 v[60:63], v12, s[84:87], s5 offen sc1
 v_mfma_f32_16x16x32_bf16 v[168:171], v[36:39], a[212:215], v[168:171]
 v_accvgpr_read_b32 v48, a76
 v_accvgpr_read_b32 v49, a77
 v_mfma_f32_16x16x32_bf16 v[172:175], v[36:39], a[220:223], v[172:175]
 ds_read_b64_tr_b16 v[30:31], v5 offset:26880
 v_accvgpr_read_b32 v50, a78
 v_accvgpr_read_b32 v51, a79
 v_mfma_f32_16x16x32_bf16 v[172:175], v[32:35], a[216:219], v[172:175]
 s_waitcnt lgkmcnt(8)
 v_exp_f32 v56, -v48
 v_mfma_f32_16x16x32_bf16 v[176:179], v[40:43], a[192:195], v[176:179]
 ds_read_b64_tr_b16 v[32:33], v4 offset:28672
 v_exp_f32 v57, -v49
 v_exp_f32 v58, -v50
 v_mfma_f32_16x16x32_bf16 v[176:179], v[44:47], a[196:199], v[176:179]
 v_exp_f32 v59, -v51
 v_accvgpr_read_b32 v52, a108
 v_mfma_f32_16x16x32_bf16 v[180:183], v[44:47], a[204:207], v[180:183]
 ds_read_b64_tr_b16 v[34:35], v4 offset:28928
 v_accvgpr_read_b32 v53, a109
 v_accvgpr_read_b32 v54, a110
 v_mfma_f32_16x16x32_bf16 v[180:183], v[40:43], a[200:203], v[180:183]
 v_accvgpr_read_b32 v55, a111
 v_mul_f32 v52, v48, v52
 v_mfma_f32_16x16x32_bf16 v[184:187], v[40:43], a[208:211], v[184:187]
 ds_read_b64_tr_b16 v[36:37], v4 offset:30720
 v_mul_f32 v53, v49, v53
 v_mul_f32 v54, v50, v54
 v_mfma_f32_16x16x32_bf16 v[184:187], v[44:47], a[212:215], v[184:187]
 v_mul_f32 v55, v51, v55
 v_fma_f32 v56, v56, s6, s6
 v_mfma_f32_16x16x32_bf16 v[188:191], v[44:47], a[220:223], v[188:191]
 ds_read_b64_tr_b16 v[38:39], v4 offset:30976
 v_fma_f32 v57, v57, s6, s6
 v_fma_f32 v58, v58, s6, s6
 v_mfma_f32_16x16x32_bf16 v[188:191], v[40:43], a[216:219], v[188:191]
 s_waitcnt lgkmcnt(8)
 v_fma_f32 v59, v59, s6, s6
 v_rcp_f32 v56, v56
 v_mfma_f32_16x16x32_bf16 v[128:131], v[16:19], a[224:227], v[128:131]
 ds_read_b64_tr_b16 v[40:41], v5 offset:28672
 v_rcp_f32 v57, v57
 v_rcp_f32 v58, v58
 v_mfma_f32_16x16x32_bf16 v[128:131], v[20:23], a[228:231], v[128:131]
 v_rcp_f32 v59, v59
 v_mul_f32 v52, v52, v56
 v_mfma_f32_16x16x32_bf16 v[132:135], v[20:23], a[236:239], v[132:135]
 ds_read_b64_tr_b16 v[42:43], v5 offset:28928
 v_mul_f32 v53, v53, v57
 v_mfma_f32_16x16x32_bf16 v[132:135], v[16:19], a[232:235], v[132:135]
 v_mul_f32 v54, v54, v58
 v_mul_f32 v55, v55, v59
 v_mfma_f32_16x16x32_bf16 v[136:139], v[16:19], a[240:243], v[136:139]
 ds_read_b64_tr_b16 v[44:45], v5 offset:30720
 v_cvt_pk_bf16_f32 v60, v52, v53
 v_cvt_pk_bf16_f32 v61, v54, v55
 v_mfma_f32_16x16x32_bf16 v[136:139], v[20:23], a[244:247], v[136:139]
 v_accvgpr_read_b32 v48, a92
 v_accvgpr_read_b32 v49, a93
 v_mfma_f32_16x16x32_bf16 v[140:143], v[20:23], a[252:255], v[140:143]
 ds_read_b64_tr_b16 v[46:47], v5 offset:30976
 v_accvgpr_read_b32 v50, a94
 v_accvgpr_read_b32 v51, a95
 v_mfma_f32_16x16x32_bf16 v[140:143], v[16:19], a[248:251], v[140:143]
 s_waitcnt lgkmcnt(8)
 v_exp_f32 v56, -v48
 v_exp_f32 v57, -v49
 v_mfma_f32_16x16x32_bf16 v[144:147], v[24:27], a[224:227], v[144:147]
 ds_read_b64_tr_b16 v[16:17], v6 offset:32768
 v_exp_f32 v58, -v50
 v_exp_f32 v59, -v51
 v_mfma_f32_16x16x32_bf16 v[144:147], v[28:31], a[228:231], v[144:147]
 v_accvgpr_read_b32 v52, a124
 v_accvgpr_read_b32 v53, a125
 v_mfma_f32_16x16x32_bf16 v[148:151], v[28:31], a[236:239], v[148:151]
 ds_read_b64_tr_b16 v[18:19], v6 offset:33024
 v_accvgpr_read_b32 v54, a126
 v_accvgpr_read_b32 v55, a127
 v_mfma_f32_16x16x32_bf16 v[148:151], v[24:27], a[232:235], v[148:151]
 v_mul_f32 v52, v48, v52
 v_mul_f32 v53, v49, v53
 v_mfma_f32_16x16x32_bf16 v[152:155], v[24:27], a[240:243], v[152:155]
 ds_read_b64_tr_b16 v[20:21], v6 offset:34816
 v_mul_f32 v54, v50, v54
 v_mul_f32 v55, v51, v55
 v_mfma_f32_16x16x32_bf16 v[152:155], v[28:31], a[244:247], v[152:155]
 v_fma_f32 v56, v56, s6, s6
 v_mfma_f32_16x16x32_bf16 v[156:159], v[28:31], a[252:255], v[156:159]
 ds_read_b64_tr_b16 v[22:23], v6 offset:35072
 v_fma_f32 v57, v57, s6, s6
 v_fma_f32 v58, v58, s6, s6
 v_mfma_f32_16x16x32_bf16 v[156:159], v[24:27], a[248:251], v[156:159]
 s_waitcnt lgkmcnt(8)
 v_fma_f32 v59, v59, s6, s6
 v_rcp_f32 v56, v56
 v_mfma_f32_16x16x32_bf16 v[160:163], v[32:35], a[224:227], v[160:163]
 ds_read_b64_tr_b16 v[24:25], v7 offset:32768
 v_rcp_f32 v57, v57
 v_rcp_f32 v58, v58
 v_mfma_f32_16x16x32_bf16 v[160:163], v[36:39], a[228:231], v[160:163]
 v_rcp_f32 v59, v59
 v_mul_f32 v52, v52, v56
 v_mfma_f32_16x16x32_bf16 v[164:167], v[36:39], a[236:239], v[164:167]
 ds_read_b64_tr_b16 v[26:27], v7 offset:33024
 v_mul_f32 v53, v53, v57
 v_mul_f32 v54, v54, v58
 v_mfma_f32_16x16x32_bf16 v[164:167], v[32:35], a[232:235], v[164:167]
 v_mul_f32 v55, v55, v59
 v_cvt_pk_bf16_f32 v62, v52, v53
 v_mfma_f32_16x16x32_bf16 v[168:171], v[32:35], a[240:243], v[168:171]
 ds_read_b64_tr_b16 v[28:29], v7 offset:34816
 v_cvt_pk_bf16_f32 v63, v54, v55
 s_add_u32 s5, s4, 344064
 v_mfma_f32_16x16x32_bf16 v[168:171], v[36:39], a[244:247], v[168:171]
 buffer_store_dwordx4 v[60:63], v12, s[84:87], s5 offen sc1
 s_mul_i32 s4, s97, 10
 v_mfma_f32_16x16x32_bf16 v[172:175], v[36:39], a[252:255], v[172:175]
 ds_read_b64_tr_b16 v[30:31], v7 offset:35072
 s_add_i32 s4, s4, -220
 s_lshr_b32 s8, s4, 5
 v_mfma_f32_16x16x32_bf16 v[172:175], v[32:35], a[248:251], v[172:175]
 s_waitcnt lgkmcnt(8)
 s_and_b32 s4, s4, 31
 s_lshl_b32 s4, s4, 18
 v_mfma_f32_16x16x32_bf16 v[176:179], v[40:43], a[224:227], v[176:179]
 ds_read_b64_tr_b16 v[32:33], v6 offset:36864
 s_cmp_eq_u32 s8, 0
 v_mfma_f32_16x16x32_bf16 v[176:179], v[44:47], a[228:231], v[176:179]
 s_cselect_b32 s7, 0x3e3504f3, s100
 s_cselect_b32 s8, 0, 0x800000
 v_mfma_f32_16x16x32_bf16 v[180:183], v[44:47], a[236:239], v[180:183]
 ds_read_b64_tr_b16 v[34:35], v6 offset:37120
 s_add_u32 s4, s4, s8
 v_mul_f32 v64, s7, v64
 v_mfma_f32_16x16x32_bf16 v[180:183], v[40:43], a[232:235], v[180:183]
 v_mul_f32 v65, s7, v65
 v_mul_f32 v66, s7, v66
 v_mfma_f32_16x16x32_bf16 v[184:187], v[40:43], a[240:243], v[184:187]
 ds_read_b64_tr_b16 v[36:37], v6 offset:38912
 v_mul_f32 v67, s7, v67
 v_mul_f32 v80, s7, v80
 v_mfma_f32_16x16x32_bf16 v[184:187], v[44:47], a[244:247], v[184:187]
 v_mul_f32 v81, s7, v81
 v_mul_f32 v82, s7, v82
 v_mfma_f32_16x16x32_bf16 v[188:191], v[44:47], a[252:255], v[188:191]
 ds_read_b64_tr_b16 v[38:39], v6 offset:39168
 v_mul_f32 v83, s7, v83
 v_cvt_pk_bf16_f32 v56, v64, v65
 v_mfma_f32_16x16x32_bf16 v[188:191], v[40:43], a[248:251], v[188:191]
 s_waitcnt lgkmcnt(8)
 v_cvt_pk_bf16_f32 v57, v66, v67
 v_cvt_pk_bf16_f32 v58, v80, v81
 v_mfma_f32_16x16x32_bf16 v[192:195], v[16:19], a[128:131], v[192:195]
 ds_read_b64_tr_b16 v[40:41], v7 offset:36864
 v_cvt_pk_bf16_f32 v59, v82, v83
 s_add_u32 s5, s4, 0
 v_mfma_f32_16x16x32_bf16 v[192:195], v[20:23], a[132:135], v[192:195]
 buffer_store_dwordx4 v[56:59], v13, s[84:87], s5 offen offset:0 sc1
 v_mul_f32 v68, s7, v68
 v_mfma_f32_16x16x32_bf16 v[196:199], v[20:23], a[140:143], v[196:199]
 ds_read_b64_tr_b16 v[42:43], v7 offset:37120
 v_mul_f32 v69, s7, v69
 v_mul_f32 v70, s7, v70
 v_mfma_f32_16x16x32_bf16 v[196:199], v[16:19], a[136:139], v[196:199]
 v_mul_f32 v71, s7, v71
 v_mul_f32 v84, s7, v84
 v_mfma_f32_16x16x32_bf16 v[200:203], v[16:19], a[144:147], v[200:203]
 ds_read_b64_tr_b16 v[44:45], v7 offset:38912
 v_mul_f32 v85, s7, v85
 v_mfma_f32_16x16x32_bf16 v[200:203], v[20:23], a[148:151], v[200:203]
 v_mul_f32 v86, s7, v86
 v_mul_f32 v87, s7, v87
 v_mfma_f32_16x16x32_bf16 v[204:207], v[20:23], a[156:159], v[204:207]
 ds_read_b64_tr_b16 v[46:47], v7 offset:39168
 v_cvt_pk_bf16_f32 v60, v68, v69
 v_cvt_pk_bf16_f32 v61, v70, v71
 v_mfma_f32_16x16x32_bf16 v[204:207], v[16:19], a[152:155], v[204:207]
 s_waitcnt lgkmcnt(8)
 v_cvt_pk_bf16_f32 v62, v84, v85
 v_cvt_pk_bf16_f32 v63, v86, v87
 v_mfma_f32_16x16x32_bf16 v[208:211], v[24:27], a[128:131], v[208:211]
 ds_read_b64_tr_b16 v[16:17], v8 offset:32768
 s_add_u32 s5, s4, 0
 buffer_store_dwordx4 v[60:63], v13, s[84:87], s5 offen offset:128 sc1
 v_mfma_f32_16x16x32_bf16 v[208:211], v[28:31], a[132:135], v[208:211]
 v_mul_f32 v72, s7, v72
 v_mul_f32 v73, s7, v73
 v_mfma_f32_16x16x32_bf16 v[212:215], v[28:31], a[140:143], v[212:215]
 ds_read_b64_tr_b16 v[18:19], v8 offset:33024
 v_mul_f32 v74, s7, v74
 v_mul_f32 v75, s7, v75
 v_mfma_f32_16x16x32_bf16 v[212:215], v[24:27], a[136:139], v[212:215]
 v_mul_f32 v88, s7, v88
 v_mul_f32 v89, s7, v89
 v_mfma_f32_16x16x32_bf16 v[216:219], v[24:27], a[144:147], v[216:219]
 ds_read_b64_tr_b16 v[20:21], v8 offset:34816
 v_mul_f32 v90, s7, v90
 v_mul_f32 v91, s7, v91
 v_mfma_f32_16x16x32_bf16 v[216:219], v[28:31], a[148:151], v[216:219]
 v_cvt_pk_bf16_f32 v56, v72, v73
 v_cvt_pk_bf16_f32 v57, v74, v75
 v_mfma_f32_16x16x32_bf16 v[220:223], v[28:31], a[156:159], v[220:223]
 ds_read_b64_tr_b16 v[22:23], v8 offset:35072
 v_cvt_pk_bf16_f32 v58, v88, v89
 v_cvt_pk_bf16_f32 v59, v90, v91
 v_mfma_f32_16x16x32_bf16 v[220:223], v[24:27], a[152:155], v[220:223]
 s_waitcnt lgkmcnt(8)
 s_add_u32 s5, s4, 4096
 v_mfma_f32_16x16x32_bf16 v[224:227], v[32:35], a[128:131], v[224:227]
 ds_read_b64_tr_b16 v[24:25], v9 offset:32768
 buffer_store_dwordx4 v[56:59], v13, s[84:87], s5 offen offset:0 sc1
 v_mul_f32 v76, s7, v76
 v_mfma_f32_16x16x32_bf16 v[224:227], v[36:39], a[132:135], v[224:227]
 v_mul_f32 v77, s7, v77
 v_mul_f32 v78, s7, v78
 v_mfma_f32_16x16x32_bf16 v[228:231], v[36:39], a[140:143], v[228:231]
 ds_read_b64_tr_b16 v[26:27], v9 offset:33024
 v_mul_f32 v79, s7, v79
 v_mul_f32 v92, s7, v92
 v_mfma_f32_16x16x32_bf16 v[228:231], v[32:35], a[136:139], v[228:231]
 v_mul_f32 v93, s7, v93
 v_mul_f32 v94, s7, v94
 v_mfma_f32_16x16x32_bf16 v[232:235], v[32:35], a[144:147], v[232:235]
 ds_read_b64_tr_b16 v[28:29], v9 offset:34816
 v_mul_f32 v95, s7, v95
 v_cvt_pk_bf16_f32 v60, v76, v77
 v_mfma_f32_16x16x32_bf16 v[232:235], v[36:39], a[148:151], v[232:235]
 v_cvt_pk_bf16_f32 v61, v78, v79
 v_cvt_pk_bf16_f32 v62, v92, v93
 v_mfma_f32_16x16x32_bf16 v[236:239], v[36:39], a[156:159], v[236:239]
 ds_read_b64_tr_b16 v[30:31], v9 offset:35072
 v_cvt_pk_bf16_f32 v63, v94, v95
 s_add_u32 s5, s4, 4096
 v_mfma_f32_16x16x32_bf16 v[236:239], v[32:35], a[152:155], v[236:239]
 s_waitcnt lgkmcnt(8)
 buffer_store_dwordx4 v[60:63], v13, s[84:87], s5 offen offset:128 sc1
 s_mul_i32 s4, s97, 10
 v_mfma_f32_16x16x32_bf16 v[240:243], v[40:43], a[128:131], v[240:243]
 ds_read_b64_tr_b16 v[32:33], v8 offset:36864
 s_add_i32 s4, s4, -218
 s_lshr_b32 s8, s4, 5
 v_mfma_f32_16x16x32_bf16 v[240:243], v[44:47], a[132:135], v[240:243]
 s_and_b32 s4, s4, 31
 s_lshl_b32 s4, s4, 18
 v_mfma_f32_16x16x32_bf16 v[244:247], v[44:47], a[140:143], v[244:247]
 ds_read_b64_tr_b16 v[34:35], v8 offset:37120
 s_cmp_eq_u32 s8, 0
 v_mfma_f32_16x16x32_bf16 v[244:247], v[40:43], a[136:139], v[244:247]
 s_cselect_b32 s7, 0x3e3504f3, s100
 s_cselect_b32 s8, 0, 0x800000
 v_mfma_f32_16x16x32_bf16 v[248:251], v[40:43], a[144:147], v[248:251]
 ds_read_b64_tr_b16 v[36:37], v8 offset:38912
 s_add_u32 s4, s4, s8
 v_mul_f32 v96, s7, v96
 v_mfma_f32_16x16x32_bf16 v[248:251], v[44:47], a[148:151], v[248:251]
 v_mul_f32 v97, s7, v97
 v_mul_f32 v98, s7, v98
 v_mfma_f32_16x16x32_bf16 v[252:255], v[44:47], a[156:159], v[252:255]
 ds_read_b64_tr_b16 v[38:39], v8 offset:39168
 v_mul_f32 v99, s7, v99
 v_mul_f32 v112, s7, v112
 v_mfma_f32_16x16x32_bf16 v[252:255], v[40:43], a[152:155], v[252:255]
 s_waitcnt lgkmcnt(8)
 v_mul_f32 v113, s7, v113
 v_mul_f32 v114, s7, v114
 v_mfma_f32_16x16x32_bf16 v[192:195], v[16:19], a[160:163], v[192:195]
 ds_read_b64_tr_b16 v[40:41], v9 offset:36864
 v_mul_f32 v115, s7, v115
 v_cvt_pk_bf16_f32 v56, v96, v97
 v_mfma_f32_16x16x32_bf16 v[192:195], v[20:23], a[164:167], v[192:195]
 v_cvt_pk_bf16_f32 v57, v98, v99
 v_cvt_pk_bf16_f32 v58, v112, v113
 v_mfma_f32_16x16x32_bf16 v[196:199], v[20:23], a[172:175], v[196:199]
 ds_read_b64_tr_b16 v[42:43], v9 offset:37120
 v_cvt_pk_bf16_f32 v59, v114, v115
 s_add_u32 s5, s4, 0
 v_mfma_f32_16x16x32_bf16 v[196:199], v[16:19], a[168:171], v[196:199]
 buffer_store_dwordx4 v[56:59], v13, s[84:87], s5 offen offset:0 sc1
 v_mul_f32 v100, s7, v100
 v_mfma_f32_16x16x32_bf16 v[200:203], v[16:19], a[176:179], v[200:203]
 ds_read_b64_tr_b16 v[44:45], v9 offset:38912
 v_mul_f32 v101, s7, v101
 v_mul_f32 v102, s7, v102
 v_mfma_f32_16x16x32_bf16 v[200:203], v[20:23], a[180:183], v[200:203]
 v_mul_f32 v103, s7, v103
 v_mfma_f32_16x16x32_bf16 v[204:207], v[20:23], a[188:191], v[204:207]
 ds_read_b64_tr_b16 v[46:47], v9 offset:39168
 v_mul_f32 v116, s7, v116
 v_mul_f32 v117, s7, v117
 v_mfma_f32_16x16x32_bf16 v[204:207], v[16:19], a[184:187], v[204:207]
 s_waitcnt lgkmcnt(8)
 v_mul_f32 v118, s7, v118
 v_mul_f32 v119, s7, v119
 v_mfma_f32_16x16x32_bf16 v[208:211], v[24:27], a[160:163], v[208:211]
 ds_read_b64_tr_b16 v[16:17], v10 offset:32768
 v_cvt_pk_bf16_f32 v60, v100, v101
 v_cvt_pk_bf16_f32 v61, v102, v103
 v_mfma_f32_16x16x32_bf16 v[208:211], v[28:31], a[164:167], v[208:211]
 v_cvt_pk_bf16_f32 v62, v116, v117
 v_cvt_pk_bf16_f32 v63, v118, v119
 v_mfma_f32_16x16x32_bf16 v[212:215], v[28:31], a[172:175], v[212:215]
 ds_read_b64_tr_b16 v[18:19], v10 offset:33024
 s_add_u32 s5, s4, 0
 buffer_store_dwordx4 v[60:63], v13, s[84:87], s5 offen offset:128 sc1
 v_mfma_f32_16x16x32_bf16 v[212:215], v[24:27], a[168:171], v[212:215]
 v_mul_f32 v104, s7, v104
 v_mul_f32 v105, s7, v105
 v_mfma_f32_16x16x32_bf16 v[216:219], v[24:27], a[176:179], v[216:219]
 ds_read_b64_tr_b16 v[20:21], v10 offset:34816
 v_mul_f32 v106, s7, v106
 v_mul_f32 v107, s7, v107
 v_mfma_f32_16x16x32_bf16 v[216:219], v[28:31], a[180:183], v[216:219]
 v_mul_f32 v120, s7, v120
 v_mul_f32 v121, s7, v121
 v_mfma_f32_16x16x32_bf16 v[220:223], v[28:31], a[188:191], v[220:223]
 ds_read_b64_tr_b16 v[22:23], v10 offset:35072
 v_mul_f32 v122, s7, v122
 v_mul_f32 v123, s7, v123
 v_mfma_f32_16x16x32_bf16 v[220:223], v[24:27], a[184:187], v[220:223]
 s_waitcnt lgkmcnt(8)
 v_cvt_pk_bf16_f32 v56, v104, v105
 v_cvt_pk_bf16_f32 v57, v106, v107
 v_mfma_f32_16x16x32_bf16 v[224:227], v[32:35], a[160:163], v[224:227]
 ds_read_b64_tr_b16 v[24:25], v11 offset:32768
 v_cvt_pk_bf16_f32 v58, v120, v121
 v_mfma_f32_16x16x32_bf16 v[224:227], v[36:39], a[164:167], v[224:227]
 v_cvt_pk_bf16_f32 v59, v122, v123
 s_add_u32 s5, s4, 4096
 v_mfma_f32_16x16x32_bf16 v[228:231], v[36:39], a[172:175], v[228:231]
 ds_read_b64_tr_b16 v[26:27], v11 offset:33024
 buffer_store_dwordx4 v[56:59], v13, s[84:87], s5 offen offset:0 sc1
 v_mul_f32 v108, s7, v108
 v_mfma_f32_16x16x32_bf16 v[228:231], v[32:35], a[168:171], v[228:231]
 v_mul_f32 v109, s7, v109
 v_mul_f32 v110, s7, v110
 v_mfma_f32_16x16x32_bf16 v[232:235], v[32:35], a[176:179], v[232:235]
 ds_read_b64_tr_b16 v[28:29], v11 offset:34816
 v_mul_f32 v111, s7, v111
 v_mul_f32 v124, s7, v124
 v_mfma_f32_16x16x32_bf16 v[232:235], v[36:39], a[180:183], v[232:235]
 v_mul_f32 v125, s7, v125
 v_mul_f32 v126, s7, v126
 v_mfma_f32_16x16x32_bf16 v[236:239], v[36:39], a[188:191], v[236:239]
 ds_read_b64_tr_b16 v[30:31], v11 offset:35072
 v_mul_f32 v127, s7, v127
 v_cvt_pk_bf16_f32 v60, v108, v109
 v_mfma_f32_16x16x32_bf16 v[236:239], v[32:35], a[184:187], v[236:239]
 s_waitcnt lgkmcnt(8)
 v_cvt_pk_bf16_f32 v61, v110, v111
 v_cvt_pk_bf16_f32 v62, v124, v125
 v_mfma_f32_16x16x32_bf16 v[240:243], v[40:43], a[160:163], v[240:243]
 ds_read_b64_tr_b16 v[32:33], v10 offset:36864
 v_cvt_pk_bf16_f32 v63, v126, v127
 s_add_u32 s5, s4, 4096
 v_mfma_f32_16x16x32_bf16 v[240:243], v[44:47], a[164:167], v[240:243]
 buffer_store_dwordx4 v[60:63], v13, s[84:87], s5 offen offset:128 sc1
 s_mul_i32 s4, s97, 10
 v_mfma_f32_16x16x32_bf16 v[244:247], v[44:47], a[172:175], v[244:247]
 ds_read_b64_tr_b16 v[34:35], v10 offset:37120
 s_add_i32 s4, s4, -219
 s_lshr_b32 s8, s4, 5
 v_mfma_f32_16x16x32_bf16 v[244:247], v[40:43], a[168:171], v[244:247]
 s_and_b32 s4, s4, 31
 v_mfma_f32_16x16x32_bf16 v[248:251], v[40:43], a[176:179], v[248:251]
 ds_read_b64_tr_b16 v[36:37], v10 offset:38912
 s_lshl_b32 s4, s4, 18
 s_cmp_eq_u32 s8, 0
 v_mfma_f32_16x16x32_bf16 v[248:251], v[44:47], a[180:183], v[248:251]
 s_cselect_b32 s7, 0x3e3504f3, s100
 s_cselect_b32 s8, 0, 0x800000
 v_mfma_f32_16x16x32_bf16 v[252:255], v[44:47], a[188:191], v[252:255]
 ds_read_b64_tr_b16 v[38:39], v10 offset:39168
 s_add_u32 s4, s4, s8
 v_mul_f32 v128, s7, v128
 v_mfma_f32_16x16x32_bf16 v[252:255], v[40:43], a[184:187], v[252:255]
 s_waitcnt lgkmcnt(8)
 v_mul_f32 v129, s7, v129
 v_mul_f32 v130, s7, v130
 v_mfma_f32_16x16x32_bf16 v[192:195], v[16:19], a[192:195], v[192:195]
 ds_read_b64_tr_b16 v[40:41], v11 offset:36864
 v_mul_f32 v131, s7, v131
 v_mul_f32 v144, s7, v144
 v_mfma_f32_16x16x32_bf16 v[192:195], v[20:23], a[196:199], v[192:195]
 v_mul_f32 v145, s7, v145
 v_mul_f32 v146, s7, v146
 v_mfma_f32_16x16x32_bf16 v[196:199], v[20:23], a[204:207], v[196:199]
 ds_read_b64_tr_b16 v[42:43], v11 offset:37120
 v_mul_f32 v147, s7, v147
 v_cvt_pk_bf16_f32 v56, v128, v129
 v_mfma_f32_16x16x32_bf16 v[196:199], v[16:19], a[200:203], v[196:199]
 v_cvt_pk_bf16_f32 v57, v130, v131
 v_cvt_pk_bf16_f32 v58, v144, v145
 v_mfma_f32_16x16x32_bf16 v[200:203], v[16:19], a[208:211], v[200:203]
 ds_read_b64_tr_b16 v[44:45], v11 offset:38912
 v_cvt_pk_bf16_f32 v59, v146, v147
 s_add_u32 s5, s4, 0
 v_mfma_f32_16x16x32_bf16 v[200:203], v[20:23], a[212:215], v[200:203]
 buffer_store_dwordx4 v[56:59], v13, s[84:87], s5 offen offset:0 sc1
 v_mul_f32 v132, s7, v132
 v_mfma_f32_16x16x32_bf16 v[204:207], v[20:23], a[220:223], v[204:207]
 ds_read_b64_tr_b16 v[46:47], v11 offset:39168
 v_mul_f32 v133, s7, v133
 v_mfma_f32_16x16x32_bf16 v[204:207], v[16:19], a[216:219], v[204:207]
 s_waitcnt lgkmcnt(8)
 v_mul_f32 v134, s7, v134
 v_mul_f32 v135, s7, v135
 v_mfma_f32_16x16x32_bf16 v[208:211], v[24:27], a[192:195], v[208:211]
 ds_read_b64_tr_b16 v[16:17], v4 offset:32768
 v_mul_f32 v148, s7, v148
 v_mul_f32 v149, s7, v149
 v_mfma_f32_16x16x32_bf16 v[208:211], v[28:31], a[196:199], v[208:211]
 v_mul_f32 v150, s7, v150
 v_mul_f32 v151, s7, v151
 v_mfma_f32_16x16x32_bf16 v[212:215], v[28:31], a[204:207], v[212:215]
 ds_read_b64_tr_b16 v[18:19], v4 offset:33024
 v_cvt_pk_bf16_f32 v60, v132, v133
 v_cvt_pk_bf16_f32 v61, v134, v135
 v_mfma_f32_16x16x32_bf16 v[212:215], v[24:27], a[200:203], v[212:215]
 v_cvt_pk_bf16_f32 v62, v148, v149
 v_cvt_pk_bf16_f32 v63, v150, v151
 v_mfma_f32_16x16x32_bf16 v[216:219], v[24:27], a[208:211], v[216:219]
 ds_read_b64_tr_b16 v[20:21], v4 offset:34816
 s_add_u32 s5, s4, 0
 buffer_store_dwordx4 v[60:63], v13, s[84:87], s5 offen offset:128 sc1
 v_mfma_f32_16x16x32_bf16 v[216:219], v[28:31], a[212:215], v[216:219]
 v_mul_f32 v136, s7, v136
 v_mul_f32 v137, s7, v137
 v_mfma_f32_16x16x32_bf16 v[220:223], v[28:31], a[220:223], v[220:223]
 ds_read_b64_tr_b16 v[22:23], v4 offset:35072
 v_mul_f32 v138, s7, v138
 v_mul_f32 v139, s7, v139
 v_mfma_f32_16x16x32_bf16 v[220:223], v[24:27], a[216:219], v[220:223]
 s_waitcnt lgkmcnt(8)
 v_mul_f32 v152, s7, v152
 v_mul_f32 v153, s7, v153
 v_mfma_f32_16x16x32_bf16 v[224:227], v[32:35], a[192:195], v[224:227]
 ds_read_b64_tr_b16 v[24:25], v5 offset:32768
 v_mul_f32 v154, s7, v154
 v_mul_f32 v155, s7, v155
 v_mfma_f32_16x16x32_bf16 v[224:227], v[36:39], a[196:199], v[224:227]
 v_cvt_pk_bf16_f32 v56, v136, v137
 v_mfma_f32_16x16x32_bf16 v[228:231], v[36:39], a[204:207], v[228:231]
 ds_read_b64_tr_b16 v[26:27], v5 offset:33024
 v_cvt_pk_bf16_f32 v57, v138, v139
 v_cvt_pk_bf16_f32 v58, v152, v153
 v_mfma_f32_16x16x32_bf16 v[228:231], v[32:35], a[200:203], v[228:231]
 v_cvt_pk_bf16_f32 v59, v154, v155
 s_add_u32 s5, s4, 4096
 v_mfma_f32_16x16x32_bf16 v[232:235], v[32:35], a[208:211], v[232:235]
 ds_read_b64_tr_b16 v[28:29], v5 offset:34816
 buffer_store_dwordx4 v[56:59], v13, s[84:87], s5 offen offset:0 sc1
 v_mul_f32 v140, s7, v140
 v_mfma_f32_16x16x32_bf16 v[232:235], v[36:39], a[212:215], v[232:235]
 v_mul_f32 v141, s7, v141
 v_mul_f32 v142, s7, v142
 v_mfma_f32_16x16x32_bf16 v[236:239], v[36:39], a[220:223], v[236:239]
 ds_read_b64_tr_b16 v[30:31], v5 offset:35072
 v_mul_f32 v143, s7, v143
 v_mul_f32 v156, s7, v156
 v_mfma_f32_16x16x32_bf16 v[236:239], v[32:35], a[216:219], v[236:239]
 s_waitcnt lgkmcnt(8)
 v_mul_f32 v157, s7, v157
 v_mul_f32 v158, s7, v158
 v_mfma_f32_16x16x32_bf16 v[240:243], v[40:43], a[192:195], v[240:243]
 ds_read_b64_tr_b16 v[32:33], v4 offset:36864
 v_mul_f32 v159, s7, v159
 v_cvt_pk_bf16_f32 v60, v140, v141
 v_mfma_f32_16x16x32_bf16 v[240:243], v[44:47], a[196:199], v[240:243]
 v_cvt_pk_bf16_f32 v61, v142, v143
 v_cvt_pk_bf16_f32 v62, v156, v157
 v_mfma_f32_16x16x32_bf16 v[244:247], v[44:47], a[204:207], v[244:247]
 ds_read_b64_tr_b16 v[34:35], v4 offset:37120
 v_cvt_pk_bf16_f32 v63, v158, v159
 s_add_u32 s5, s4, 4096
 v_mfma_f32_16x16x32_bf16 v[244:247], v[40:43], a[200:203], v[244:247]
 buffer_store_dwordx4 v[60:63], v13, s[84:87], s5 offen offset:128 sc1
 s_mul_i32 s4, s97, 10
 v_mfma_f32_16x16x32_bf16 v[248:251], v[40:43], a[208:211], v[248:251]
 ds_read_b64_tr_b16 v[36:37], v4 offset:38912
 s_add_i32 s4, s4, -217
 v_mfma_f32_16x16x32_bf16 v[248:251], v[44:47], a[212:215], v[248:251]
 s_lshr_b32 s8, s4, 5
 s_and_b32 s4, s4, 31
 v_mfma_f32_16x16x32_bf16 v[252:255], v[44:47], a[220:223], v[252:255]
 ds_read_b64_tr_b16 v[38:39], v4 offset:39168
 s_lshl_b32 s4, s4, 18
 s_cmp_eq_u32 s8, 0
 v_mfma_f32_16x16x32_bf16 v[252:255], v[40:43], a[216:219], v[252:255]
 s_waitcnt lgkmcnt(8)
 s_cselect_b32 s7, 0x3e3504f3, s100
 s_cselect_b32 s8, 0, 0x800000
 v_mfma_f32_16x16x32_bf16 v[192:195], v[16:19], a[224:227], v[192:195]
 ds_read_b64_tr_b16 v[40:41], v5 offset:36864
 s_add_u32 s4, s4, s8
 v_mul_f32 v160, s7, v160
 v_mfma_f32_16x16x32_bf16 v[192:195], v[20:23], a[228:231], v[192:195]
 v_mul_f32 v161, s7, v161
 v_mul_f32 v162, s7, v162
 v_mfma_f32_16x16x32_bf16 v[196:199], v[20:23], a[236:239], v[196:199]
 ds_read_b64_tr_b16 v[42:43], v5 offset:37120
 v_mul_f32 v163, s7, v163
 v_mul_f32 v176, s7, v176
 v_mfma_f32_16x16x32_bf16 v[196:199], v[16:19], a[232:235], v[196:199]
 v_mul_f32 v177, s7, v177
 v_mul_f32 v178, s7, v178
 v_mfma_f32_16x16x32_bf16 v[200:203], v[16:19], a[240:243], v[200:203]
 ds_read_b64_tr_b16 v[44:45], v5 offset:38912
 v_mul_f32 v179, s7, v179
 v_cvt_pk_bf16_f32 v56, v160, v161
 v_mfma_f32_16x16x32_bf16 v[200:203], v[20:23], a[244:247], v[200:203]
 v_cvt_pk_bf16_f32 v57, v162, v163
 v_cvt_pk_bf16_f32 v58, v176, v177
 v_mfma_f32_16x16x32_bf16 v[204:207], v[20:23], a[252:255], v[204:207]
 ds_read_b64_tr_b16 v[46:47], v5 offset:39168
 v_cvt_pk_bf16_f32 v59, v178, v179
 s_add_u32 s5, s4, 0
 v_mfma_f32_16x16x32_bf16 v[204:207], v[16:19], a[248:251], v[204:207]
 s_waitcnt lgkmcnt(8)
 buffer_store_dwordx4 v[56:59], v13, s[84:87], s5 offen offset:0 sc1
 v_mfma_f32_16x16x32_bf16 v[208:211], v[24:27], a[224:227], v[208:211]
 v_mul_f32 v164, s7, v164
 v_mul_f32 v165, s7, v165
 v_mfma_f32_16x16x32_bf16 v[208:211], v[28:31], a[228:231], v[208:211]
 v_mul_f32 v166, s7, v166
 v_mul_f32 v167, s7, v167
 v_mfma_f32_16x16x32_bf16 v[212:215], v[28:31], a[236:239], v[212:215]
 v_mul_f32 v180, s7, v180
 v_mul_f32 v181, s7, v181
 v_mfma_f32_16x16x32_bf16 v[212:215], v[24:27], a[232:235], v[212:215]
 v_mul_f32 v182, s7, v182
 v_mul_f32 v183, s7, v183
 v_mfma_f32_16x16x32_bf16 v[216:219], v[24:27], a[240:243], v[216:219]
 v_cvt_pk_bf16_f32 v60, v164, v165
 v_cvt_pk_bf16_f32 v61, v166, v167
 v_mfma_f32_16x16x32_bf16 v[216:219], v[28:31], a[244:247], v[216:219]
 v_cvt_pk_bf16_f32 v62, v180, v181
 v_cvt_pk_bf16_f32 v63, v182, v183
 v_mfma_f32_16x16x32_bf16 v[220:223], v[28:31], a[252:255], v[220:223]
 s_add_u32 s5, s4, 0
 buffer_store_dwordx4 v[60:63], v13, s[84:87], s5 offen offset:128 sc1
 v_mfma_f32_16x16x32_bf16 v[220:223], v[24:27], a[248:251], v[220:223]
 s_waitcnt lgkmcnt(4)
 v_mul_f32 v168, s7, v168
 v_mul_f32 v169, s7, v169
 v_mfma_f32_16x16x32_bf16 v[224:227], v[32:35], a[224:227], v[224:227]
 v_mul_f32 v170, s7, v170
 v_mul_f32 v171, s7, v171
 v_mfma_f32_16x16x32_bf16 v[224:227], v[36:39], a[228:231], v[224:227]
 v_mul_f32 v184, s7, v184
 v_mul_f32 v185, s7, v185
 v_mfma_f32_16x16x32_bf16 v[228:231], v[36:39], a[236:239], v[228:231]
 v_mul_f32 v186, s7, v186
 v_mfma_f32_16x16x32_bf16 v[228:231], v[32:35], a[232:235], v[228:231]
 v_mul_f32 v187, s7, v187
 v_cvt_pk_bf16_f32 v56, v168, v169
 v_mfma_f32_16x16x32_bf16 v[232:235], v[32:35], a[240:243], v[232:235]
 v_cvt_pk_bf16_f32 v57, v170, v171
 v_cvt_pk_bf16_f32 v58, v184, v185
 v_mfma_f32_16x16x32_bf16 v[232:235], v[36:39], a[244:247], v[232:235]
 v_cvt_pk_bf16_f32 v59, v186, v187
 s_add_u32 s5, s4, 4096
 v_mfma_f32_16x16x32_bf16 v[236:239], v[36:39], a[252:255], v[236:239]
 buffer_store_dwordx4 v[56:59], v13, s[84:87], s5 offen offset:0 sc1
 v_mul_f32 v172, s7, v172
 v_mfma_f32_16x16x32_bf16 v[236:239], v[32:35], a[248:251], v[236:239]
 s_waitcnt lgkmcnt(0)
 v_mul_f32 v173, s7, v173
 v_mul_f32 v174, s7, v174
 v_mfma_f32_16x16x32_bf16 v[240:243], v[40:43], a[224:227], v[240:243]
 v_mul_f32 v175, s7, v175
 v_mul_f32 v188, s7, v188
 v_mfma_f32_16x16x32_bf16 v[240:243], v[44:47], a[228:231], v[240:243]
 v_mul_f32 v189, s7, v189
 v_mul_f32 v190, s7, v190
 v_mfma_f32_16x16x32_bf16 v[244:247], v[44:47], a[236:239], v[244:247]
 v_mul_f32 v191, s7, v191
 v_cvt_pk_bf16_f32 v60, v172, v173
 v_mfma_f32_16x16x32_bf16 v[244:247], v[40:43], a[232:235], v[244:247]
 v_cvt_pk_bf16_f32 v61, v174, v175
 v_cvt_pk_bf16_f32 v62, v188, v189
 v_mfma_f32_16x16x32_bf16 v[248:251], v[40:43], a[240:243], v[248:251]
 v_cvt_pk_bf16_f32 v63, v190, v191
 s_add_u32 s5, s4, 4096
 v_mfma_f32_16x16x32_bf16 v[248:251], v[44:47], a[244:247], v[248:251]
 buffer_store_dwordx4 v[60:63], v13, s[84:87], s5 offen offset:128 sc1
 v_mfma_f32_16x16x32_bf16 v[252:255], v[44:47], a[252:255], v[252:255]
 v_mfma_f32_16x16x32_bf16 v[252:255], v[40:43], a[248:251], v[252:255]
 s_nop 7
 s_mul_i32 s4, s97, 10
 s_add_i32 s4, s4, -216
 s_lshr_b32 s8, s4, 5
 s_and_b32 s4, s4, 31
 s_lshl_b32 s4, s4, 18
 s_cmp_eq_u32 s8, 0
 s_cselect_b32 s7, 0x3e3504f3, s100
 s_cselect_b32 s8, 0, 0x800000
 s_add_u32 s4, s4, s8
 v_mul_f32 v192, s7, v192
 v_mul_f32 v193, s7, v193
 v_mul_f32 v194, s7, v194
 v_mul_f32 v195, s7, v195
 v_mul_f32 v208, s7, v208
 v_mul_f32 v209, s7, v209
 v_mul_f32 v210, s7, v210
 v_mul_f32 v211, s7, v211
 v_cvt_pk_bf16_f32 v56, v192, v193
 v_cvt_pk_bf16_f32 v57, v194, v195
 v_cvt_pk_bf16_f32 v58, v208, v209
 v_cvt_pk_bf16_f32 v59, v210, v211
 s_add_u32 s5, s4, 0
 buffer_store_dwordx4 v[56:59], v13, s[84:87], s5 offen offset:0 sc1
 v_mul_f32 v196, s7, v196
 v_mul_f32 v197, s7, v197
 v_mul_f32 v198, s7, v198
 v_mul_f32 v199, s7, v199
 v_mul_f32 v212, s7, v212
 v_mul_f32 v213, s7, v213
 v_mul_f32 v214, s7, v214
 v_mul_f32 v215, s7, v215
 v_cvt_pk_bf16_f32 v60, v196, v197
 v_cvt_pk_bf16_f32 v61, v198, v199
 v_cvt_pk_bf16_f32 v62, v212, v213
 v_cvt_pk_bf16_f32 v63, v214, v215
 s_add_u32 s5, s4, 0
 buffer_store_dwordx4 v[60:63], v13, s[84:87], s5 offen offset:128 sc1
 v_mul_f32 v200, s7, v200
 v_mul_f32 v201, s7, v201
 v_mul_f32 v202, s7, v202
 v_mul_f32 v203, s7, v203
 v_mul_f32 v216, s7, v216
 v_mul_f32 v217, s7, v217
 v_mul_f32 v218, s7, v218
 v_mul_f32 v219, s7, v219
 v_cvt_pk_bf16_f32 v56, v200, v201
 v_cvt_pk_bf16_f32 v57, v202, v203
 v_cvt_pk_bf16_f32 v58, v216, v217
 v_cvt_pk_bf16_f32 v59, v218, v219
 s_add_u32 s5, s4, 4096
 buffer_store_dwordx4 v[56:59], v13, s[84:87], s5 offen offset:0 sc1
 v_mul_f32 v204, s7, v204
 v_mul_f32 v205, s7, v205
 v_mul_f32 v206, s7, v206
 v_mul_f32 v207, s7, v207
 v_mul_f32 v220, s7, v220
 v_mul_f32 v221, s7, v221
 v_mul_f32 v222, s7, v222
 v_mul_f32 v223, s7, v223
 v_cvt_pk_bf16_f32 v60, v204, v205
 v_cvt_pk_bf16_f32 v61, v206, v207
 v_cvt_pk_bf16_f32 v62, v220, v221
 v_cvt_pk_bf16_f32 v63, v222, v223
 s_add_u32 s5, s4, 4096
 buffer_store_dwordx4 v[60:63], v13, s[84:87], s5 offen offset:128 sc1
 s_mul_i32 s4, s97, 10
 s_add_i32 s4, s4, -215
 s_lshr_b32 s8, s4, 5
 s_and_b32 s4, s4, 31
 s_lshl_b32 s4, s4, 18
 s_cmp_eq_u32 s8, 0
 s_cselect_b32 s7, 0x3e3504f3, s100
 s_cselect_b32 s8, 0, 0x800000
 s_add_u32 s4, s4, s8
 v_mul_f32 v224, s7, v224
 v_mul_f32 v225, s7, v225
 v_mul_f32 v226, s7, v226
 v_mul_f32 v227, s7, v227
 v_mul_f32 v240, s7, v240
 v_mul_f32 v241, s7, v241
 v_mul_f32 v242, s7, v242
 v_mul_f32 v243, s7, v243
 v_cvt_pk_bf16_f32 v56, v224, v225
 v_cvt_pk_bf16_f32 v57, v226, v227
 v_cvt_pk_bf16_f32 v58, v240, v241
 v_cvt_pk_bf16_f32 v59, v242, v243
 s_add_u32 s5, s4, 0
 buffer_store_dwordx4 v[56:59], v13, s[84:87], s5 offen offset:0 sc1
 v_mul_f32 v228, s7, v228
 v_mul_f32 v229, s7, v229
 v_mul_f32 v230, s7, v230
 v_mul_f32 v231, s7, v231
 v_mul_f32 v244, s7, v244
 v_mul_f32 v245, s7, v245
 v_mul_f32 v246, s7, v246
 v_mul_f32 v247, s7, v247
 v_cvt_pk_bf16_f32 v60, v228, v229
 v_cvt_pk_bf16_f32 v61, v230, v231
 v_cvt_pk_bf16_f32 v62, v244, v245
 v_cvt_pk_bf16_f32 v63, v246, v247
 s_add_u32 s5, s4, 0
 buffer_store_dwordx4 v[60:63], v13, s[84:87], s5 offen offset:128 sc1
 v_mul_f32 v232, s7, v232
 v_mul_f32 v233, s7, v233
 v_mul_f32 v234, s7, v234
 v_mul_f32 v235, s7, v235
 v_mul_f32 v248, s7, v248
 v_mul_f32 v249, s7, v249
 v_mul_f32 v250, s7, v250
 v_mul_f32 v251, s7, v251
 v_cvt_pk_bf16_f32 v56, v232, v233
 v_cvt_pk_bf16_f32 v57, v234, v235
 v_cvt_pk_bf16_f32 v58, v248, v249
 v_cvt_pk_bf16_f32 v59, v250, v251
 s_add_u32 s5, s4, 4096
 buffer_store_dwordx4 v[56:59], v13, s[84:87], s5 offen offset:0 sc1
 v_mul_f32 v236, s7, v236
 v_mul_f32 v237, s7, v237
 v_mul_f32 v238, s7, v238
 v_mul_f32 v239, s7, v239
 v_mul_f32 v252, s7, v252
 v_mul_f32 v253, s7, v253
 v_mul_f32 v254, s7, v254
 v_mul_f32 v255, s7, v255
 v_cvt_pk_bf16_f32 v60, v236, v237
 v_cvt_pk_bf16_f32 v61, v238, v239
 v_cvt_pk_bf16_f32 v62, v252, v253
 v_cvt_pk_bf16_f32 v63, v254, v255
 s_add_u32 s5, s4, 4096
 buffer_store_dwordx4 v[60:63], v13, s[84:87], s5 offen offset:128 sc1
 s_endpgm
L_g1_M_fin:
L_g1_Q:
 s_waitcnt lgkmcnt(8)
 v_mfma_f32_16x16x32_bf16 a[0:3], v[16:19], a[128:131], a[0:3]
 ds_read_b64_tr_b16 v[40:41], v7 offset:4096
 v_mfma_f32_16x16x32_bf16 a[0:3], v[20:23], a[132:135], a[0:3]
 buffer_load_dwordx4 a[160:163], v8, s[84:87], s92 offen offset:0 sc1
 v_mfma_f32_16x16x32_bf16 a[4:7], v[20:23], a[140:143], a[4:7]
 v_add_u32 v60, 40960, v4
 v_add_u32 v61, 40960, v5
 ds_read_b64_tr_b16 v[42:43], v7 offset:4352
 v_mfma_f32_16x16x32_bf16 a[4:7], v[16:19], a[136:139], a[4:7]
 v_mfma_f32_16x16x32_bf16 a[8:11], v[16:19], a[144:147], a[8:11]
 ds_read_b64_tr_b16 v[44:45], v7 offset:6144
 v_mfma_f32_16x16x32_bf16 a[8:11], v[20:23], a[148:151], a[8:11]
 buffer_load_dwordx4 a[164:167], v8, s[84:87], s92 offen offset:1024 sc1
 v_mfma_f32_16x16x32_bf16 a[12:15], v[20:23], a[156:159], a[12:15]
 v_add_u32 v62, 81920, v4
 v_add_u32 v63, 81920, v5
 ds_read_b64_tr_b16 v[46:47], v7 offset:6400
 v_mfma_f32_16x16x32_bf16 a[12:15], v[16:19], a[152:155], a[12:15]
 s_waitcnt lgkmcnt(8)
 v_mfma_f32_16x16x32_bf16 a[16:19], v[24:27], a[128:131], a[16:19]
 ds_read_b64_tr_b16 v[16:17], v6 offset:8192
 v_mfma_f32_16x16x32_bf16 a[16:19], v[28:31], a[132:135], a[16:19]
 buffer_load_dwordx4 a[168:171], v9, s[84:87], s92 offen offset:0 sc1
 v_mfma_f32_16x16x32_bf16 a[20:23], v[28:31], a[140:143], a[20:23]
 v_add_u32 v4, 122880, v4
 v_add_u32 v5, 122880, v5
 ds_read_b64_tr_b16 v[18:19], v6 offset:8448
 v_mfma_f32_16x16x32_bf16 a[20:23], v[24:27], a[136:139], a[20:23]
 v_mfma_f32_16x16x32_bf16 a[24:27], v[24:27], a[144:147], a[24:27]
 ds_read_b64_tr_b16 v[20:21], v6 offset:10240
 v_mfma_f32_16x16x32_bf16 a[24:27], v[28:31], a[148:151], a[24:27]
 buffer_load_dwordx4 a[172:175], v9, s[84:87], s92 offen offset:1024 sc1
 v_mfma_f32_16x16x32_bf16 a[28:31], v[28:31], a[156:159], a[28:31]
 ds_read_b64_tr_b16 v[22:23], v6 offset:10496
 v_mfma_f32_16x16x32_bf16 a[28:31], v[24:27], a[152:155], a[28:31]
 s_waitcnt lgkmcnt(8)
 v_mfma_f32_16x16x32_bf16 a[32:35], v[32:35], a[128:131], a[32:35]
 ds_read_b64_tr_b16 v[24:25], v7 offset:8192
 v_mfma_f32_16x16x32_bf16 a[32:35], v[36:39], a[132:135], a[32:35]
 buffer_load_dwordx4 a[176:179], v10, s[84:87], s92 offen offset:0 sc1
 v_mfma_f32_16x16x32_bf16 a[36:39], v[36:39], a[140:143], a[36:39]
 ds_read_b64_tr_b16 v[26:27], v7 offset:8448
 v_mfma_f32_16x16x32_bf16 a[36:39], v[32:35], a[136:139], a[36:39]
 v_mfma_f32_16x16x32_bf16 a[40:43], v[32:35], a[144:147], a[40:43]
 ds_read_b64_tr_b16 v[28:29], v7 offset:10240
 v_mfma_f32_16x16x32_bf16 a[40:43], v[36:39], a[148:151], a[40:43]
 buffer_load_dwordx4 a[180:183], v10, s[84:87], s92 offen offset:1024 sc1
 v_mfma_f32_16x16x32_bf16 a[44:47], v[36:39], a[156:159], a[44:47]
 ds_read_b64_tr_b16 v[30:31], v7 offset:10496
 v_mfma_f32_16x16x32_bf16 a[44:47], v[32:35], a[152:155], a[44:47]
 s_waitcnt lgkmcnt(8)
 v_mfma_f32_16x16x32_bf16 a[48:51], v[40:43], a[128:131], a[48:51]
 ds_read_b64_tr_b16 v[32:33], v6 offset:12288
 v_mfma_f32_16x16x32_bf16 a[48:51], v[44:47], a[132:135], a[48:51]
 buffer_load_dwordx4 a[184:187], v11, s[84:87], s92 offen offset:0 sc1
 v_mfma_f32_16x16x32_bf16 a[52:55], v[44:47], a[140:143], a[52:55]
 ds_read_b64_tr_b16 v[34:35], v6 offset:12544
 v_mfma_f32_16x16x32_bf16 a[52:55], v[40:43], a[136:139], a[52:55]
 v_mfma_f32_16x16x32_bf16 a[56:59], v[40:43], a[144:147], a[56:59]
 ds_read_b64_tr_b16 v[36:37], v6 offset:14336
 v_mfma_f32_16x16x32_bf16 a[56:59], v[44:47], a[148:151], a[56:59]
 buffer_load_dwordx4 a[188:191], v11, s[84:87], s92 offen offset:1024 sc1
 s_add_u32 s10, s10, 1
 s_cmp_lt_u32 s10, 4
 s_cselect_b32 s3, 1, 3
 s_add_u32 s92, s10, s11
 s_and_b32 s92, s92, s3
 s_andn2_b32 s3, s10, s3
 s_or_b32 s92, s92, s3
 s_lshl_b32 s92, s92, 11
 v_mfma_f32_16x16x32_bf16 a[60:63], v[44:47], a[156:159], a[60:63]
 ds_read_b64_tr_b16 v[38:39], v6 offset:14592
 v_mfma_f32_16x16x32_bf16 a[60:63], v[40:43], a[152:155], a[60:63]
 s_waitcnt lgkmcnt(8)
 v_mfma_f32_16x16x32_bf16 a[64:67], v[16:19], a[128:131], a[64:67]
 ds_read_b64_tr_b16 v[40:41], v7 offset:12288
 v_mfma_f32_16x16x32_bf16 a[64:67], v[20:23], a[132:135], a[64:67]
 buffer_load_dwordx4 a[192:195], v8, s[84:87], s92 offen offset:0 sc1
 v_mfma_f32_16x16x32_bf16 a[68:71], v[20:23], a[140:143], a[68:71]
 ds_read_b64_tr_b16 v[42:43], v7 offset:12544
 v_mfma_f32_16x16x32_bf16 a[68:71], v[16:19], a[136:139], a[68:71]
 v_mfma_f32_16x16x32_bf16 a[72:75], v[16:19], a[144:147], a[72:75]
 ds_read_b64_tr_b16 v[44:45], v7 offset:14336
 v_mfma_f32_16x16x32_bf16 a[72:75], v[20:23], a[148:151], a[72:75]
 buffer_load_dwordx4 a[196:199], v8, s[84:87], s92 offen offset:1024 sc1
 v_mfma_f32_16x16x32_bf16 a[76:79], v[20:23], a[156:159], a[76:79]
 ds_read_b64_tr_b16 v[46:47], v7 offset:14592
 v_mfma_f32_16x16x32_bf16 a[76:79], v[16:19], a[152:155], a[76:79]
 s_waitcnt lgkmcnt(8)
 v_mfma_f32_16x16x32_bf16 a[80:83], v[24:27], a[128:131], a[80:83]
 ds_read_b64_tr_b16 v[16:17], v60 offset:0
 v_mfma_f32_16x16x32_bf16 a[80:83], v[28:31], a[132:135], a[80:83]
 buffer_load_dwordx4 a[200:203], v9, s[84:87], s92 offen offset:0 sc1
 v_mfma_f32_16x16x32_bf16 a[84:87], v[28:31], a[140:143], a[84:87]
 ds_read_b64_tr_b16 v[18:19], v60 offset:256
 v_mfma_f32_16x16x32_bf16 a[84:87], v[24:27], a[136:139], a[84:87]
 v_mfma_f32_16x16x32_bf16 a[88:91], v[24:27], a[144:147], a[88:91]
 ds_read_b64_tr_b16 v[20:21], v60 offset:2048
 v_mfma_f32_16x16x32_bf16 a[88:91], v[28:31], a[148:151], a[88:91]
 buffer_load_dwordx4 a[204:207], v9, s[84:87], s92 offen offset:1024 sc1
 v_mfma_f32_16x16x32_bf16 a[92:95], v[28:31], a[156:159], a[92:95]
 ds_read_b64_tr_b16 v[22:23], v60 offset:2304
 v_mfma_f32_16x16x32_bf16 a[92:95], v[24:27], a[152:155], a[92:95]
 s_waitcnt lgkmcnt(8)
 v_mfma_f32_16x16x32_bf16 a[96:99], v[32:35], a[128:131], a[96:99]
 ds_read_b64_tr_b16 v[24:25], v61 offset:0
 v_mfma_f32_16x16x32_bf16 a[96:99], v[36:39], a[132:135], a[96:99]
 buffer_load_dwordx4 a[208:211], v10, s[84:87], s92 offen offset:0 sc1
 v_mfma_f32_16x16x32_bf16 a[100:103], v[36:39], a[140:143], a[100:103]
 ds_read_b64_tr_b16 v[26:27], v61 offset:256
 v_mfma_f32_16x16x32_bf16 a[100:103], v[32:35], a[136:139], a[100:103]
 v_mfma_f32_16x16x32_bf16 a[104:107], v[32:35], a[144:147], a[104:107]
 ds_read_b64_tr_b16 v[28:29], v61 offset:2048
 v_mfma_f32_16x16x32_bf16 a[104:107], v[36:39], a[148:151], a[104:107]
 buffer_load_dwordx4 a[212:215], v10, s[84:87], s92 offen offset:1024 sc1
 v_mfma_f32_16x16x32_bf16 a[108:111], v[36:39], a[156:159], a[108:111]
 ds_read_b64_tr_b16 v[30:31], v61 offset:2304
 v_mfma_f32_16x16x32_bf16 a[108:111], v[32:35], a[152:155], a[108:111]
 s_waitcnt lgkmcnt(8)
 v_mfma_f32_16x16x32_bf16 a[112:115], v[40:43], a[128:131], a[112:115]
 ds_read_b64_tr_b16 v[32:33], v60 offset:4096
 v_mfma_f32_16x16x32_bf16 a[112:115], v[44:47], a[132:135], a[112:115]
 buffer_load_dwordx4 a[216:219], v11, s[84:87], s92 offen offset:0 sc1
 v_mfma_f32_16x16x32_bf16 a[116:119], v[44:47], a[140:143], a[116:119]
 ds_read_b64_tr_b16 v[34:35], v60 offset:4352
 v_mfma_f32_16x16x32_bf16 a[116:119], v[40:43], a[136:139], a[116:119]
 v_mfma_f32_16x16x32_bf16 a[120:123], v[40:43], a[144:147], a[120:123]
 ds_read_b64_tr_b16 v[36:37], v60 offset:6144
 v_mfma_f32_16x16x32_bf16 a[120:123], v[44:47], a[148:151], a[120:123]
 buffer_load_dwordx4 a[220:223], v11, s[84:87], s92 offen offset:1024 sc1
 s_add_u32 s10, s10, 1
 s_cmp_lt_u32 s10, 4
 s_cselect_b32 s3, 1, 3
 s_add_u32 s92, s10, s11
 s_and_b32 s92, s92, s3
 s_andn2_b32 s3, s10, s3
 s_or_b32 s92, s92, s3
 s_lshl_b32 s92, s92, 11
 v_mfma_f32_16x16x32_bf16 a[124:127], v[44:47], a[156:159], a[124:127]
 ds_read_b64_tr_b16 v[38:39], v60 offset:6400
 v_mfma_f32_16x16x32_bf16 a[124:127], v[40:43], a[152:155], a[124:127]
 s_waitcnt vmcnt(8) lgkmcnt(8)
 v_mfma_f32_16x16x32_bf16 a[0:3], v[16:19], a[160:163], a[0:3]
 ds_read_b64_tr_b16 v[40:41], v61 offset:4096
 v_mfma_f32_16x16x32_bf16 a[0:3], v[20:23], a[164:167], a[0:3]
 s_add_u32 m0, s94, 0
 s_nop 0
 buffer_load_dwordx4 v2, s[40:43], s88 offen lds
 v_mfma_f32_16x16x32_bf16 a[4:7], v[20:23], a[172:175], a[4:7]
 ds_read_b64_tr_b16 v[42:43], v61 offset:4352
 v_mfma_f32_16x16x32_bf16 a[4:7], v[16:19], a[168:171], a[4:7]
 v_mfma_f32_16x16x32_bf16 a[8:11], v[16:19], a[176:179], a[8:11]
 ds_read_b64_tr_b16 v[44:45], v61 offset:6144
 v_mfma_f32_16x16x32_bf16 a[8:11], v[20:23], a[180:183], a[8:11]
 s_add_u32 m0, s94, 8192
 s_nop 0
 buffer_load_dwordx4 v2, s[48:51], s88 offen lds
 v_mfma_f32_16x16x32_bf16 a[12:15], v[20:23], a[188:191], a[12:15]
 s_mov_b32 s100, 0x3f317218
 ds_read_b64_tr_b16 v[46:47], v61 offset:6400
 v_mfma_f32_16x16x32_bf16 a[12:15], v[16:19], a[184:187], a[12:15]
 s_waitcnt lgkmcnt(8)
 v_mfma_f32_16x16x32_bf16 a[16:19], v[24:27], a[160:163], a[16:19]
 ds_read_b64_tr_b16 v[16:17], v60 offset:8192
 v_mfma_f32_16x16x32_bf16 a[16:19], v[28:31], a[164:167], a[16:19]
 s_add_u32 m0, s94, 4096
 s_nop 0
 buffer_load_dwordx4 v2, s[44:47], s88 offen lds
 v_mfma_f32_16x16x32_bf16 a[20:23], v[28:31], a[172:175], a[20:23]
 ds_read_b64_tr_b16 v[18:19], v60 offset:8448
 v_mfma_f32_16x16x32_bf16 a[20:23], v[24:27], a[168:171], a[20:23]
 v_mfma_f32_16x16x32_bf16 a[24:27], v[24:27], a[176:179], a[24:27]
 ds_read_b64_tr_b16 v[20:21], v60 offset:10240
 v_mfma_f32_16x16x32_bf16 a[24:27], v[28:31], a[180:183], a[24:27]
 s_add_u32 m0, s94, 12288
 s_nop 0
 buffer_load_dwordx4 v2, s[52:55], s88 offen lds
 v_mfma_f32_16x16x32_bf16 a[28:31], v[28:31], a[188:191], a[28:31]
 ds_read_b64_tr_b16 v[22:23], v60 offset:10496
 v_mfma_f32_16x16x32_bf16 a[28:31], v[24:27], a[184:187], a[28:31]
 s_waitcnt lgkmcnt(8)
 v_mfma_f32_16x16x32_bf16 a[32:35], v[32:35], a[160:163], a[32:35]
 ds_read_b64_tr_b16 v[24:25], v61 offset:8192
 v_mfma_f32_16x16x32_bf16 a[32:35], v[36:39], a[164:167], a[32:35]
 s_add_u32 m0, s94, 16384
 s_nop 0
 buffer_load_dwordx4 v3, s[56:59], s89 offen lds
 v_mfma_f32_16x16x32_bf16 a[36:39], v[36:39], a[172:175], a[36:39]
 ds_read_b64_tr_b16 v[26:27], v61 offset:8448
 v_mfma_f32_16x16x32_bf16 a[36:39], v[32:35], a[168:171], a[36:39]
 v_mfma_f32_16x16x32_bf16 a[40:43], v[32:35], a[176:179], a[40:43]
 ds_read_b64_tr_b16 v[28:29], v61 offset:10240
 v_mfma_f32_16x16x32_bf16 a[40:43], v[36:39], a[180:183], a[40:43]
 s_add_u32 m0, s94, 24576
 s_nop 0
 buffer_load_dwordx4 v3, s[64:67], s89 offen lds
 v_mfma_f32_16x16x32_bf16 a[44:47], v[36:39], a[188:191], a[44:47]
 ds_read_b64_tr_b16 v[30:31], v61 offset:10496
 v_mfma_f32_16x16x32_bf16 a[44:47], v[32:35], a[184:187], a[44:47]
 s_waitcnt lgkmcnt(8)
 v_mfma_f32_16x16x32_bf16 a[48:51], v[40:43], a[160:163], a[48:51]
 ds_read_b64_tr_b16 v[32:33], v60 offset:12288
 v_mfma_f32_16x16x32_bf16 a[48:51], v[44:47], a[164:167], a[48:51]
 s_add_u32 m0, s94, 20480
 s_nop 0
 buffer_load_dwordx4 v3, s[60:63], s89 offen lds
 v_mfma_f32_16x16x32_bf16 a[52:55], v[44:47], a[172:175], a[52:55]
 ds_read_b64_tr_b16 v[34:35], v60 offset:12544
 v_mfma_f32_16x16x32_bf16 a[52:55], v[40:43], a[168:171], a[52:55]
 v_mfma_f32_16x16x32_bf16 a[56:59], v[40:43], a[176:179], a[56:59]
 ds_read_b64_tr_b16 v[36:37], v60 offset:14336
 v_mfma_f32_16x16x32_bf16 a[56:59], v[44:47], a[180:183], a[56:59]
 s_add_u32 m0, s94, 28672
 s_nop 0
 buffer_load_dwordx4 v3, s[68:71], s89 offen lds
 v_mfma_f32_16x16x32_bf16 a[60:63], v[44:47], a[188:191], a[60:63]
 ds_read_b64_tr_b16 v[38:39], v60 offset:14592
 v_mfma_f32_16x16x32_bf16 a[60:63], v[40:43], a[184:187], a[60:63]
 s_waitcnt lgkmcnt(8)
 v_mfma_f32_16x16x32_bf16 a[64:67], v[16:19], a[160:163], a[64:67]
 ds_read_b64_tr_b16 v[40:41], v61 offset:12288
 v_mfma_f32_16x16x32_bf16 a[64:67], v[20:23], a[164:167], a[64:67]
 s_add_u32 m0, s94, 32768
 s_nop 0
 buffer_load_dwordx4 v3, s[72:75], s89 offen lds
 v_mfma_f32_16x16x32_bf16 a[68:71], v[20:23], a[172:175], a[68:71]
 ds_read_b64_tr_b16 v[42:43], v61 offset:12544
 v_mfma_f32_16x16x32_bf16 a[68:71], v[16:19], a[168:171], a[68:71]
 v_mfma_f32_16x16x32_bf16 a[72:75], v[16:19], a[176:179], a[72:75]
 ds_read_b64_tr_b16 v[44:45], v61 offset:14336
 v_mfma_f32_16x16x32_bf16 a[72:75], v[20:23], a[180:183], a[72:75]
 s_add_u32 m0, s94, 36864
 s_nop 0
 buffer_load_dwordx4 v3, s[76:79], s89 offen lds
 v_mfma_f32_16x16x32_bf16 a[76:79], v[20:23], a[188:191], a[76:79]
 ds_read_b64_tr_b16 v[46:47], v61 offset:14592
 v_mfma_f32_16x16x32_bf16 a[76:79], v[16:19], a[184:187], a[76:79]
 s_waitcnt lgkmcnt(8)
 s_waitcnt vmcnt(26)
 s_barrier
 v_mfma_f32_16x16x32_bf16 a[80:83], v[24:27], a[160:163], a[80:83]
 ds_read_b64_tr_b16 v[16:17], v62 offset:0
 v_mfma_f32_16x16x32_bf16 a[80:83], v[28:31], a[164:167], a[80:83]
 buffer_load_dwordx4 a[224:227], v8, s[84:87], s92 offen offset:0 sc1
 v_mfma_f32_16x16x32_bf16 a[84:87], v[28:31], a[172:175], a[84:87]
 ds_read_b64_tr_b16 v[18:19], v62 offset:256
 v_mfma_f32_16x16x32_bf16 a[84:87], v[24:27], a[168:171], a[84:87]
 v_mfma_f32_16x16x32_bf16 a[88:91], v[24:27], a[176:179], a[88:91]
 ds_read_b64_tr_b16 v[20:21], v62 offset:2048
 v_mfma_f32_16x16x32_bf16 a[88:91], v[28:31], a[180:183], a[88:91]
 buffer_load_dwordx4 a[228:231], v8, s[84:87], s92 offen offset:1024 sc1
 v_mfma_f32_16x16x32_bf16 a[92:95], v[28:31], a[188:191], a[92:95]
 ds_read_b64_tr_b16 v[22:23], v62 offset:2304
 v_mfma_f32_16x16x32_bf16 a[92:95], v[24:27], a[184:187], a[92:95]
 s_waitcnt lgkmcnt(8)
 v_mfma_f32_16x16x32_bf16 a[96:99], v[32:35], a[160:163], a[96:99]
 ds_read_b64_tr_b16 v[24:25], v63 offset:0
 v_mfma_f32_16x16x32_bf16 a[96:99], v[36:39], a[164:167], a[96:99]
 buffer_load_dwordx4 a[232:235], v9, s[84:87], s92 offen offset:0 sc1
 v_mfma_f32_16x16x32_bf16 a[100:103], v[36:39], a[172:175], a[100:103]
 ds_read_b64_tr_b16 v[26:27], v63 offset:256
 v_mfma_f32_16x16x32_bf16 a[100:103], v[32:35], a[168:171], a[100:103]
 v_mfma_f32_16x16x32_bf16 a[104:107], v[32:35], a[176:179], a[104:107]
 ds_read_b64_tr_b16 v[28:29], v63 offset:2048
 v_mfma_f32_16x16x32_bf16 a[104:107], v[36:39], a[180:183], a[104:107]
 buffer_load_dwordx4 a[236:239], v9, s[84:87], s92 offen offset:1024 sc1
 v_mfma_f32_16x16x32_bf16 a[108:111], v[36:39], a[188:191], a[108:111]
 ds_read_b64_tr_b16 v[30:31], v63 offset:2304
 v_mfma_f32_16x16x32_bf16 a[108:111], v[32:35], a[184:187], a[108:111]
 s_waitcnt lgkmcnt(8)
 v_mfma_f32_16x16x32_bf16 a[112:115], v[40:43], a[160:163], a[112:115]
 ds_read_b64_tr_b16 v[32:33], v62 offset:4096
 v_mfma_f32_16x16x32_bf16 a[112:115], v[44:47], a[164:167], a[112:115]
 buffer_load_dwordx4 a[240:243], v10, s[84:87], s92 offen offset:0 sc1
 v_mfma_f32_16x16x32_bf16 a[116:119], v[44:47], a[172:175], a[116:119]
 ds_read_b64_tr_b16 v[34:35], v62 offset:4352
 v_mfma_f32_16x16x32_bf16 a[116:119], v[40:43], a[168:171], a[116:119]
 v_mfma_f32_16x16x32_bf16 a[120:123], v[40:43], a[176:179], a[120:123]
 ds_read_b64_tr_b16 v[36:37], v62 offset:6144
 v_mfma_f32_16x16x32_bf16 a[120:123], v[44:47], a[180:183], a[120:123]
 buffer_load_dwordx4 a[244:247], v10, s[84:87], s92 offen offset:1024 sc1
 v_mfma_f32_16x16x32_bf16 a[124:127], v[44:47], a[188:191], a[124:127]
 ds_read_b64_tr_b16 v[38:39], v62 offset:6400
 v_mfma_f32_16x16x32_bf16 a[124:127], v[40:43], a[184:187], a[124:127]
 s_waitcnt vmcnt(16) lgkmcnt(8)
 v_mfma_f32_16x16x32_bf16 a[0:3], v[16:19], a[192:195], a[0:3]
 ds_read_b64_tr_b16 v[40:41], v63 offset:4096
 v_mfma_f32_16x16x32_bf16 a[0:3], v[20:23], a[196:199], a[0:3]
 buffer_load_dwordx4 a[248:251], v11, s[84:87], s92 offen offset:0 sc1
 v_mfma_f32_16x16x32_bf16 a[4:7], v[20:23], a[204:207], a[4:7]
 ds_read_b64_tr_b16 v[42:43], v63 offset:4352
 v_mfma_f32_16x16x32_bf16 a[4:7], v[16:19], a[200:203], a[4:7]
 v_mfma_f32_16x16x32_bf16 a[8:11], v[16:19], a[208:211], a[8:11]
 ds_read_b64_tr_b16 v[44:45], v63 offset:6144
 v_mfma_f32_16x16x32_bf16 a[8:11], v[20:23], a[212:215], a[8:11]
 buffer_load_dwordx4 a[252:255], v11, s[84:87], s92 offen offset:1024 sc1
 v_mfma_f32_16x16x32_bf16 a[12:15], v[20:23], a[220:223], a[12:15]
 ds_read_b64_tr_b16 v[46:47], v63 offset:6400
 v_mfma_f32_16x16x32_bf16 a[12:15], v[16:19], a[216:219], a[12:15]
 s_waitcnt lgkmcnt(8)
 v_mfma_f32_16x16x32_bf16 a[16:19], v[24:27], a[192:195], a[16:19]
 ds_read_b64_tr_b16 v[16:17], v62 offset:8192
 v_mfma_f32_16x16x32_bf16 a[16:19], v[28:31], a[196:199], a[16:19]
 v_mov_b32 v8, v60
 v_mov_b32 v9, v61
 v_mov_b32 v10, v62
 v_mov_b32 v11, v63
 v_mfma_f32_16x16x32_bf16 a[20:23], v[28:31], a[204:207], a[20:23]
 ds_read_b64_tr_b16 v[18:19], v62 offset:8448
 v_mfma_f32_16x16x32_bf16 a[20:23], v[24:27], a[200:203], a[20:23]
 v_mfma_f32_16x16x32_bf16 a[24:27], v[24:27], a[208:211], a[24:27]
 ds_read_b64_tr_b16 v[20:21], v62 offset:10240
 v_mfma_f32_16x16x32_bf16 a[24:27], v[28:31], a[212:215], a[24:27]
 v_mfma_f32_16x16x32_bf16 a[28:31], v[28:31], a[220:223], a[28:31]
 ds_read_b64_tr_b16 v[22:23], v62 offset:10496
 v_mfma_f32_16x16x32_bf16 a[28:31], v[24:27], a[216:219], a[28:31]
 s_waitcnt lgkmcnt(8)
 v_mfma_f32_16x16x32_bf16 a[32:35], v[32:35], a[192:195], a[32:35]
 ds_read_b64_tr_b16 v[24:25], v11 offset:8192
 v_mfma_f32_16x16x32_bf16 a[32:35], v[36:39], a[196:199], a[32:35]
 v_mfma_f32_16x16x32_bf16 a[36:39], v[36:39], a[204:207], a[36:39]
 ds_read_b64_tr_b16 v[26:27], v11 offset:8448
 v_mfma_f32_16x16x32_bf16 a[36:39], v[32:35], a[200:203], a[36:39]
 v_mfma_f32_16x16x32_bf16 a[40:43], v[32:35], a[208:211], a[40:43]
 ds_read_b64_tr_b16 v[28:29], v11 offset:10240
 v_mfma_f32_16x16x32_bf16 a[40:43], v[36:39], a[212:215], a[40:43]
 v_mfma_f32_16x16x32_bf16 a[44:47], v[36:39], a[220:223], a[44:47]
 ds_read_b64_tr_b16 v[30:31], v11 offset:10496
 v_mfma_f32_16x16x32_bf16 a[44:47], v[32:35], a[216:219], a[44:47]
 s_waitcnt lgkmcnt(8)
 v_mfma_f32_16x16x32_bf16 a[48:51], v[40:43], a[192:195], a[48:51]
 ds_read_b64_tr_b16 v[32:33], v10 offset:12288
 v_mfma_f32_16x16x32_bf16 a[48:51], v[44:47], a[196:199], a[48:51]
 v_mfma_f32_16x16x32_bf16 a[52:55], v[44:47], a[204:207], a[52:55]
 ds_read_b64_tr_b16 v[34:35], v10 offset:12544
 v_mfma_f32_16x16x32_bf16 a[52:55], v[40:43], a[200:203], a[52:55]
 v_mfma_f32_16x16x32_bf16 a[56:59], v[40:43], a[208:211], a[56:59]
 ds_read_b64_tr_b16 v[36:37], v10 offset:14336
 v_mfma_f32_16x16x32_bf16 a[56:59], v[44:47], a[212:215], a[56:59]
 v_mfma_f32_16x16x32_bf16 a[60:63], v[44:47], a[220:223], a[60:63]
 ds_read_b64_tr_b16 v[38:39], v10 offset:14592
 v_mfma_f32_16x16x32_bf16 a[60:63], v[40:43], a[216:219], a[60:63]
 s_waitcnt lgkmcnt(8)
 v_mfma_f32_16x16x32_bf16 a[64:67], v[16:19], a[192:195], a[64:67]
 ds_read_b64_tr_b16 v[40:41], v11 offset:12288
 v_mfma_f32_16x16x32_bf16 a[64:67], v[20:23], a[196:199], a[64:67]
 v_mfma_f32_16x16x32_bf16 a[68:71], v[20:23], a[204:207], a[68:71]
 ds_read_b64_tr_b16 v[42:43], v11 offset:12544
 v_mfma_f32_16x16x32_bf16 a[68:71], v[16:19], a[200:203], a[68:71]
 v_mfma_f32_16x16x32_bf16 a[72:75], v[16:19], a[208:211], a[72:75]
 ds_read_b64_tr_b16 v[44:45], v11 offset:14336
 v_mfma_f32_16x16x32_bf16 a[72:75], v[20:23], a[212:215], a[72:75]
 v_mfma_f32_16x16x32_bf16 a[76:79], v[20:23], a[220:223], a[76:79]
 ds_read_b64_tr_b16 v[46:47], v11 offset:14592
 v_mfma_f32_16x16x32_bf16 a[76:79], v[16:19], a[216:219], a[76:79]
 s_waitcnt lgkmcnt(8)
 s_waitcnt vmcnt(8)
 s_barrier
 v_mfma_f32_16x16x32_bf16 a[80:83], v[24:27], a[192:195], a[80:83]
 ds_read_b64_tr_b16 v[16:17], v4 offset:0
 v_mfma_f32_16x16x32_bf16 a[80:83], v[28:31], a[196:199], a[80:83]
 v_mfma_f32_16x16x32_bf16 a[84:87], v[28:31], a[204:207], a[84:87]
 ds_read_b64_tr_b16 v[18:19], v4 offset:256
 v_mfma_f32_16x16x32_bf16 a[84:87], v[24:27], a[200:203], a[84:87]
 v_mfma_f32_16x16x32_bf16 a[88:91], v[24:27], a[208:211], a[88:91]
 ds_read_b64_tr_b16 v[20:21], v4 offset:2048
 v_mfma_f32_16x16x32_bf16 a[88:91], v[28:31], a[212:215], a[88:91]
 v_mfma_f32_16x16x32_bf16 a[92:95], v[28:31], a[220:223], a[92:95]
 ds_read_b64_tr_b16 v[22:23], v4 offset:2304
 v_mfma_f32_16x16x32_bf16 a[92:95], v[24:27], a[216:219], a[92:95]
 s_waitcnt lgkmcnt(8)
 v_mfma_f32_16x16x32_bf16 a[96:99], v[32:35], a[192:195], a[96:99]
 ds_read_b64_tr_b16 v[24:25], v5 offset:0
 v_mfma_f32_16x16x32_bf16 a[96:99], v[36:39], a[196:199], a[96:99]
 v_mfma_f32_16x16x32_bf16 a[100:103], v[36:39], a[204:207], a[100:103]
 ds_read_b64_tr_b16 v[26:27], v5 offset:256
 v_mfma_f32_16x16x32_bf16 a[100:103], v[32:35], a[200:203], a[100:103]
 v_mfma_f32_16x16x32_bf16 a[104:107], v[32:35], a[208:211], a[104:107]
 ds_read_b64_tr_b16 v[28:29], v5 offset:2048
 v_mfma_f32_16x16x32_bf16 a[104:107], v[36:39], a[212:215], a[104:107]
 v_mfma_f32_16x16x32_bf16 a[108:111], v[36:39], a[220:223], a[108:111]
 ds_read_b64_tr_b16 v[30:31], v5 offset:2304
 v_mfma_f32_16x16x32_bf16 a[108:111], v[32:35], a[216:219], a[108:111]
 s_waitcnt lgkmcnt(8)
 v_mfma_f32_16x16x32_bf16 a[112:115], v[40:43], a[192:195], a[112:115]
 ds_read_b64_tr_b16 v[32:33], v4 offset:4096
 v_mfma_f32_16x16x32_bf16 a[112:115], v[44:47], a[196:199], a[112:115]
 v_mfma_f32_16x16x32_bf16 a[116:119], v[44:47], a[204:207], a[116:119]
 ds_read_b64_tr_b16 v[34:35], v4 offset:4352
 v_mfma_f32_16x16x32_bf16 a[116:119], v[40:43], a[200:203], a[116:119]
 v_mfma_f32_16x16x32_bf16 a[120:123], v[40:43], a[208:211], a[120:123]
 ds_read_b64_tr_b16 v[36:37], v4 offset:6144
 v_mfma_f32_16x16x32_bf16 a[120:123], v[44:47], a[212:215], a[120:123]
 v_mfma_f32_16x16x32_bf16 a[124:127], v[44:47], a[220:223], a[124:127]
 ds_read_b64_tr_b16 v[38:39], v4 offset:6400
 v_mfma_f32_16x16x32_bf16 a[124:127], v[40:43], a[216:219], a[124:127]
 s_waitcnt vmcnt(0) lgkmcnt(8)
 v_mfma_f32_16x16x32_bf16 a[0:3], v[16:19], a[224:227], a[0:3]
 ds_read_b64_tr_b16 v[40:41], v5 offset:4096
 v_mfma_f32_16x16x32_bf16 a[0:3], v[20:23], a[228:231], a[0:3]
 v_mfma_f32_16x16x32_bf16 a[4:7], v[20:23], a[236:239], a[4:7]
 ds_read_b64_tr_b16 v[42:43], v5 offset:4352
 v_mfma_f32_16x16x32_bf16 a[4:7], v[16:19], a[232:235], a[4:7]
 v_mfma_f32_16x16x32_bf16 a[8:11], v[16:19], a[240:243], a[8:11]
 ds_read_b64_tr_b16 v[44:45], v5 offset:6144
 v_mfma_f32_16x16x32_bf16 a[8:11], v[20:23], a[244:247], a[8:11]
 v_mfma_f32_16x16x32_bf16 a[12:15], v[20:23], a[252:255], a[12:15]
 ds_read_b64_tr_b16 v[46:47], v5 offset:6400
 v_mfma_f32_16x16x32_bf16 a[12:15], v[16:19], a[248:251], a[12:15]
 s_waitcnt lgkmcnt(8)
 v_mfma_f32_16x16x32_bf16 a[16:19], v[24:27], a[224:227], a[16:19]
 ds_read_b64_tr_b16 v[16:17], v4 offset:8192
 v_mfma_f32_16x16x32_bf16 a[16:19], v[28:31], a[228:231], a[16:19]
 v_lshlrev_b32 v15, 3, v15
 v_mfma_f32_16x16x32_bf16 a[20:23], v[28:31], a[236:239], a[20:23]
 ds_read_b64_tr_b16 v[18:19], v4 offset:8448
 s_mov_b32 s16, s12
 v_mfma_f32_16x16x32_bf16 a[20:23], v[24:27], a[232:235], a[20:23]
 s_mov_b32 s17, s13
 v_mfma_f32_16x16x32_bf16 a[24:27], v[24:27], a[240:243], a[24:27]
 ds_read_b64_tr_b16 v[20:21], v4 offset:10240
 s_mov_b32 s18, 0x0
 v_mfma_f32_16x16x32_bf16 a[24:27], v[28:31], a[244:247], a[24:27]
 s_mov_b32 s19, 0x20000
 v_mfma_f32_16x16x32_bf16 a[28:31], v[28:31], a[252:255], a[28:31]
 ds_read_b64_tr_b16 v[22:23], v4 offset:10496
 s_add_u32 s18, s15, 2048
 v_mfma_f32_16x16x32_bf16 a[28:31], v[24:27], a[248:251], a[28:31]
 s_waitcnt lgkmcnt(8)
 s_add_u32 s82, s14, 7168
 v_mfma_f32_16x16x32_bf16 a[32:35], v[32:35], a[224:227], a[32:35]
 ds_read_b64_tr_b16 v[24:25], v5 offset:8192
 v_lshlrev_b32 v15, 4, v15
 v_mfma_f32_16x16x32_bf16 a[32:35], v[36:39], a[228:231], a[32:35]
 s_nop 0
 v_mfma_f32_16x16x32_bf16 a[36:39], v[36:39], a[236:239], a[36:39]
 ds_read_b64_tr_b16 v[26:27], v5 offset:8448
 v_lshrrev_b32 v0, 1, v15
 v_mfma_f32_16x16x32_bf16 a[36:39], v[32:35], a[232:235], a[36:39]
 v_add_u32 v0, 384, v0
 v_mfma_f32_16x16x32_bf16 a[40:43], v[32:35], a[240:243], a[40:43]
 ds_read_b64_tr_b16 v[28:29], v5 offset:10240
 s_nop 0
 v_mfma_f32_16x16x32_bf16 a[40:43], v[36:39], a[244:247], a[40:43]
 buffer_load_dword v1, v0, s[80:83], s14 offen
 v_mfma_f32_16x16x32_bf16 a[44:47], v[36:39], a[252:255], a[44:47]
 ds_read_b64_tr_b16 v[30:31], v5 offset:10496
 s_mul_i32 s14, s15, 7
 v_mfma_f32_16x16x32_bf16 a[44:47], v[32:35], a[248:251], a[44:47]
 s_waitcnt lgkmcnt(8)
 s_lshr_b32 s14, s14, 4
 v_mfma_f32_16x16x32_bf16 a[48:51], v[40:43], a[224:227], a[48:51]
 ds_read_b64_tr_b16 v[32:33], v4 offset:12288
 s_add_u32 s82, s14, 896
 v_mfma_f32_16x16x32_bf16 a[48:51], v[44:47], a[228:231], a[48:51]
 v_lshrrev_b32 v15, 4, v15
 v_mfma_f32_16x16x32_bf16 a[52:55], v[44:47], a[236:239], a[52:55]
 ds_read_b64_tr_b16 v[34:35], v4 offset:12544
 s_nop 0
 v_mfma_f32_16x16x32_bf16 a[52:55], v[40:43], a[232:235], a[52:55]
 buffer_load_dword v1, v15, s[80:83], s14 offen
 v_mfma_f32_16x16x32_bf16 a[56:59], v[40:43], a[240:243], a[56:59]
 ds_read_b64_tr_b16 v[36:37], v4 offset:14336
 s_add_u32 s14, s14, 917504
 v_mfma_f32_16x16x32_bf16 a[56:59], v[44:47], a[244:247], a[56:59]
 s_add_u32 s82, s14, 896
 v_mfma_f32_16x16x32_bf16 a[60:63], v[44:47], a[252:255], a[60:63]
 ds_read_b64_tr_b16 v[38:39], v4 offset:14592
 buffer_load_dword v1, v15, s[80:83], s14 offen
 v_mfma_f32_16x16x32_bf16 a[60:63], v[40:43], a[248:251], a[60:63]
 s_waitcnt lgkmcnt(8)
 s_lshl_b32 s3, s2, 2
 v_mfma_f32_16x16x32_bf16 a[64:67], v[16:19], a[224:227], a[64:67]
 ds_read_b64_tr_b16 v[40:41], v5 offset:12288
 s_add_u32 s3, s3, s95
 v_mfma_f32_16x16x32_bf16 a[64:67], v[20:23], a[228:231], a[64:67]
 s_and_b32 s3, s3, 255
 v_mfma_f32_16x16x32_bf16 a[68:71], v[20:23], a[236:239], a[68:71]
 ds_read_b64_tr_b16 v[42:43], v5 offset:12544
 s_mul_i32 s3, s3, 128
 v_mfma_f32_16x16x32_bf16 a[68:71], v[16:19], a[232:235], a[68:71]
 v_min_u32 v52, 0, v0
 v_mfma_f32_16x16x32_bf16 a[72:75], v[16:19], a[240:243], a[72:75]
 ds_read_b64_tr_b16 v[44:45], v5 offset:14336
 v_lshlrev_b32 v52, 7, v52
 v_mfma_f32_16x16x32_bf16 a[72:75], v[20:23], a[244:247], a[72:75]
 v_add_u32 v52, s3, v52
 v_mfma_f32_16x16x32_bf16 a[76:79], v[20:23], a[252:255], a[76:79]
 ds_read_b64_tr_b16 v[46:47], v5 offset:14592
 v_min_u32 v52, L_b_end - attfin_kernel - 4, v52
 v_mfma_f32_16x16x32_bf16 a[76:79], v[16:19], a[248:251], a[76:79]
 s_waitcnt lgkmcnt(8)
 s_getpc_b64 s[16:17]
 v_mfma_f32_16x16x32_bf16 a[80:83], v[24:27], a[224:227], a[80:83]
 ds_read_b64_tr_b16 v[16:17], v6 offset:16384
 s_add_u32 s16, s16, attfin_kernel - .
 v_mfma_f32_16x16x32_bf16 a[80:83], v[28:31], a[228:231], a[80:83]
 s_addc_u32 s17, s17, 0
 v_mfma_f32_16x16x32_bf16 a[84:87], v[28:31], a[236:239], a[84:87]
 ds_read_b64_tr_b16 v[18:19], v6 offset:16640
 v_mov_b32 v53, s17
 v_mfma_f32_16x16x32_bf16 a[84:87], v[24:27], a[232:235], a[84:87]
 v_add_co_u32 v52, vcc, s16, v52
 v_mfma_f32_16x16x32_bf16 a[88:91], v[24:27], a[240:243], a[88:91]
 ds_read_b64_tr_b16 v[20:21], v6 offset:18432
 s_nop 1
 v_mfma_f32_16x16x32_bf16 a[88:91], v[28:31], a[244:247], a[88:91]
 v_addc_co_u32 v53, vcc, 0, v53, vcc
 v_mfma_f32_16x16x32_bf16 a[92:95], v[28:31], a[252:255], a[92:95]
 ds_read_b64_tr_b16 v[22:23], v6 offset:18688
 global_load_dword v1, v[52:53], off
 v_mfma_f32_16x16x32_bf16 a[92:95], v[24:27], a[248:251], a[92:95]
 s_waitcnt lgkmcnt(8)
 s_mul_i32 s4, s97, 10
 s_add_i32 s4, s4, -224
 v_mfma_f32_16x16x32_bf16 a[96:99], v[32:35], a[224:227], a[96:99]
 ds_read_b64_tr_b16 v[24:25], v7 offset:16384
 s_lshr_b32 s8, s4, 5
 s_and_b32 s4, s4, 31
 v_mfma_f32_16x16x32_bf16 a[96:99], v[36:39], a[228:231], a[96:99]
 s_lshl_b32 s4, s4, 18
 v_mfma_f32_16x16x32_bf16 a[100:103], v[36:39], a[236:239], a[100:103]
 ds_read_b64_tr_b16 v[26:27], v7 offset:16640
 s_cmp_eq_u32 s8, 0
 s_cselect_b32 s7, 0x3e3504f3, s100
 v_mfma_f32_16x16x32_bf16 a[100:103], v[32:35], a[232:235], a[100:103]
 s_cselect_b32 s8, 0, 0x800000
 s_add_u32 s4, s4, s8
 v_mfma_f32_16x16x32_bf16 a[104:107], v[32:35], a[240:243], a[104:107]
 ds_read_b64_tr_b16 v[28:29], v7 offset:18432
 v_accvgpr_read_b32 v48, a0
 v_mfma_f32_16x16x32_bf16 a[104:107], v[36:39], a[244:247], a[104:107]
 v_accvgpr_read_b32 v49, a1
 v_accvgpr_read_b32 v50, a2
 v_mfma_f32_16x16x32_bf16 a[108:111], v[36:39], a[252:255], a[108:111]
 ds_read_b64_tr_b16 v[30:31], v7 offset:18688
 v_accvgpr_read_b32 v51, a3
 v_mfma_f32_16x16x32_bf16 a[108:111], v[32:35], a[248:251], a[108:111]
 s_waitcnt lgkmcnt(8)
 v_accvgpr_read_b32 v52, a16
 v_accvgpr_read_b32 v53, a17
 v_mfma_f32_16x16x32_bf16 a[112:115], v[40:43], a[224:227], a[112:115]
 ds_read_b64_tr_b16 v[32:33], v6 offset:20480
 v_accvgpr_read_b32 v54, a18
 v_accvgpr_read_b32 v55, a19
 v_mfma_f32_16x16x32_bf16 a[112:115], v[44:47], a[228:231], a[112:115]
 v_mul_f32 v48, s7, v48
 v_mfma_f32_16x16x32_bf16 a[116:119], v[44:47], a[236:239], a[116:119]
 ds_read_b64_tr_b16 v[34:35], v6 offset:20736
 v_mul_f32 v49, s7, v49
 v_mul_f32 v50, s7, v50
 v_mfma_f32_16x16x32_bf16 a[116:119], v[40:43], a[232:235], a[116:119]
 v_mul_f32 v51, s7, v51
 v_mul_f32 v52, s7, v52
 v_mfma_f32_16x16x32_bf16 a[120:123], v[40:43], a[240:243], a[120:123]
 ds_read_b64_tr_b16 v[36:37], v6 offset:22528
 v_mul_f32 v53, s7, v53
 v_mfma_f32_16x16x32_bf16 a[120:123], v[44:47], a[244:247], a[120:123]
 v_mul_f32 v54, s7, v54
 v_mul_f32 v55, s7, v55
 v_mfma_f32_16x16x32_bf16 a[124:127], v[44:47], a[252:255], a[124:127]
 ds_read_b64_tr_b16 v[38:39], v6 offset:22784
 v_cvt_pk_bf16_f32 v56, v48, v49
 v_mfma_f32_16x16x32_bf16 a[124:127], v[40:43], a[248:251], a[124:127]
 s_waitcnt lgkmcnt(8)
 v_cvt_pk_bf16_f32 v57, v50, v51
 v_cvt_pk_bf16_f32 v58, v52, v53
 v_mfma_f32_16x16x32_bf16 v[64:67], v[16:19], a[128:131], v[64:67]
 ds_read_b64_tr_b16 v[40:41], v7 offset:20480
 v_cvt_pk_bf16_f32 v59, v54, v55
 s_add_u32 s5, s4, 0
 v_mfma_f32_16x16x32_bf16 v[64:67], v[20:23], a[132:135], v[64:67]
 buffer_store_dwordx4 v[56:59], v13, s[84:87], s5 offen offset:0 sc1
 v_mfma_f32_16x16x32_bf16 v[68:71], v[20:23], a[140:143], v[68:71]
 ds_read_b64_tr_b16 v[42:43], v7 offset:20736
 v_accvgpr_read_b32 v48, a4
 v_accvgpr_read_b32 v49, a5
 v_mfma_f32_16x16x32_bf16 v[68:71], v[16:19], a[136:139], v[68:71]
 v_accvgpr_read_b32 v50, a6
 v_accvgpr_read_b32 v51, a7
 v_mfma_f32_16x16x32_bf16 v[72:75], v[16:19], a[144:147], v[72:75]
 ds_read_b64_tr_b16 v[44:45], v7 offset:22528
 v_accvgpr_read_b32 v52, a20
 v_mfma_f32_16x16x32_bf16 v[72:75], v[20:23], a[148:151], v[72:75]
 v_accvgpr_read_b32 v53, a21
 v_accvgpr_read_b32 v54, a22
 v_mfma_f32_16x16x32_bf16 v[76:79], v[20:23], a[156:159], v[76:79]
 ds_read_b64_tr_b16 v[46:47], v7 offset:22784
 v_accvgpr_read_b32 v55, a23
 v_mfma_f32_16x16x32_bf16 v[76:79], v[16:19], a[152:155], v[76:79]
 s_waitcnt lgkmcnt(8)
 v_mul_f32 v48, s7, v48
 v_mul_f32 v49, s7, v49
 v_mfma_f32_16x16x32_bf16 v[80:83], v[24:27], a[128:131], v[80:83]
 ds_read_b64_tr_b16 v[16:17], v8 offset:16384
 v_mul_f32 v50, s7, v50
 v_mul_f32 v51, s7, v51
 v_mfma_f32_16x16x32_bf16 v[80:83], v[28:31], a[132:135], v[80:83]
 v_mul_f32 v52, s7, v52
 v_mfma_f32_16x16x32_bf16 v[84:87], v[28:31], a[140:143], v[84:87]
 ds_read_b64_tr_b16 v[18:19], v8 offset:16640
 v_mul_f32 v53, s7, v53
 v_mul_f32 v54, s7, v54
 v_mfma_f32_16x16x32_bf16 v[84:87], v[24:27], a[136:139], v[84:87]
 v_mul_f32 v55, s7, v55
 v_cvt_pk_bf16_f32 v60, v48, v49
 v_mfma_f32_16x16x32_bf16 v[88:91], v[24:27], a[144:147], v[88:91]
 ds_read_b64_tr_b16 v[20:21], v8 offset:18432
 v_cvt_pk_bf16_f32 v61, v50, v51
 v_mfma_f32_16x16x32_bf16 v[88:91], v[28:31], a[148:151], v[88:91]
 v_cvt_pk_bf16_f32 v62, v52, v53
 v_cvt_pk_bf16_f32 v63, v54, v55
 v_mfma_f32_16x16x32_bf16 v[92:95], v[28:31], a[156:159], v[92:95]
 ds_read_b64_tr_b16 v[22:23], v8 offset:18688
 s_add_u32 s5, s4, 0
 v_mfma_f32_16x16x32_bf16 v[92:95], v[24:27], a[152:155], v[92:95]
 s_waitcnt lgkmcnt(8)
 buffer_store_dwordx4 v[60:63], v13, s[84:87], s5 offen offset:128 sc1
 v_accvgpr_read_b32 v48, a8
 v_mfma_f32_16x16x32_bf16 v[96:99], v[32:35], a[128:131], v[96:99]
 ds_read_b64_tr_b16 v[24:25], v9 offset:16384
 v_accvgpr_read_b32 v49, a9
 v_accvgpr_read_b32 v50, a10
 v_mfma_f32_16x16x32_bf16 v[96:99], v[36:39], a[132:135], v[96:99]
 v_accvgpr_read_b32 v51, a11
 v_mfma_f32_16x16x32_bf16 v[100:103], v[36:39], a[140:143], v[100:103]
 ds_read_b64_tr_b16 v[26:27], v9 offset:16640
 v_accvgpr_read_b32 v52, a24
 v_accvgpr_read_b32 v53, a25
 v_mfma_f32_16x16x32_bf16 v[100:103], v[32:35], a[136:139], v[100:103]
 v_accvgpr_read_b32 v54, a26
 v_accvgpr_read_b32 v55, a27
 v_mfma_f32_16x16x32_bf16 v[104:107], v[32:35], a[144:147], v[104:107]
 ds_read_b64_tr_b16 v[28:29], v9 offset:18432
 v_mul_f32 v48, s7, v48
 v_mfma_f32_16x16x32_bf16 v[104:107], v[36:39], a[148:151], v[104:107]
 v_mul_f32 v49, s7, v49
 v_mul_f32 v50, s7, v50
 v_mfma_f32_16x16x32_bf16 v[108:111], v[36:39], a[156:159], v[108:111]
 ds_read_b64_tr_b16 v[30:31], v9 offset:18688
 v_mul_f32 v51, s7, v51
 v_mfma_f32_16x16x32_bf16 v[108:111], v[32:35], a[152:155], v[108:111]
 s_waitcnt lgkmcnt(8)
 v_mul_f32 v52, s7, v52
 v_mul_f32 v53, s7, v53
 v_mfma_f32_16x16x32_bf16 v[112:115], v[40:43], a[128:131], v[112:115]
 ds_read_b64_tr_b16 v[32:33], v8 offset:20480
 v_mul_f32 v54, s7, v54
 v_mul_f32 v55, s7, v55
 v_mfma_f32_16x16x32_bf16 v[112:115], v[44:47], a[132:135], v[112:115]
 v_cvt_pk_bf16_f32 v56, v48, v49
 v_mfma_f32_16x16x32_bf16 v[116:119], v[44:47], a[140:143], v[116:119]
 ds_read_b64_tr_b16 v[34:35], v8 offset:20736
 v_cvt_pk_bf16_f32 v57, v50, v51
 v_cvt_pk_bf16_f32 v58, v52, v53
 v_mfma_f32_16x16x32_bf16 v[116:119], v[40:43], a[136:139], v[116:119]
 v_cvt_pk_bf16_f32 v59, v54, v55
 s_add_u32 s5, s4, 4096
 v_mfma_f32_16x16x32_bf16 v[120:123], v[40:43], a[144:147], v[120:123]
 ds_read_b64_tr_b16 v[36:37], v8 offset:22528
 buffer_store_dwordx4 v[56:59], v13, s[84:87], s5 offen offset:0 sc1
 v_mfma_f32_16x16x32_bf16 v[120:123], v[44:47], a[148:151], v[120:123]
 v_accvgpr_read_b32 v48, a12
 v_accvgpr_read_b32 v49, a13
 v_mfma_f32_16x16x32_bf16 v[124:127], v[44:47], a[156:159], v[124:127]
 ds_read_b64_tr_b16 v[38:39], v8 offset:22784
 v_accvgpr_read_b32 v50, a14
 v_mfma_f32_16x16x32_bf16 v[124:127], v[40:43], a[152:155], v[124:127]
 s_waitcnt lgkmcnt(8)
 v_accvgpr_read_b32 v51, a15
 v_accvgpr_read_b32 v52, a28
 v_mfma_f32_16x16x32_bf16 v[64:67], v[16:19], a[160:163], v[64:67]
 ds_read_b64_tr_b16 v[40:41], v9 offset:20480
 v_accvgpr_read_b32 v53, a29
 v_accvgpr_read_b32 v54, a30
 v_mfma_f32_16x16x32_bf16 v[64:67], v[20:23], a[164:167], v[64:67]
 v_accvgpr_read_b32 v55, a31
 v_mfma_f32_16x16x32_bf16 v[68:71], v[20:23], a[172:175], v[68:71]
 ds_read_b64_tr_b16 v[42:43], v9 offset:20736
 v_mul_f32 v48, s7, v48
 v_mul_f32 v49, s7, v49
 v_mfma_f32_16x16x32_bf16 v[68:71], v[16:19], a[168:171], v[68:71]
 v_mul_f32 v50, s7, v50
 v_mul_f32 v51, s7, v51
 v_mfma_f32_16x16x32_bf16 v[72:75], v[16:19], a[176:179], v[72:75]
 ds_read_b64_tr_b16 v[44:45], v9 offset:22528
 v_mul_f32 v52, s7, v52
 v_mfma_f32_16x16x32_bf16 v[72:75], v[20:23], a[180:183], v[72:75]
 v_mul_f32 v53, s7, v53
 v_mul_f32 v54, s7, v54
 v_mfma_f32_16x16x32_bf16 v[76:79], v[20:23], a[188:191], v[76:79]
 ds_read_b64_tr_b16 v[46:47], v9 offset:22784
 v_mul_f32 v55, s7, v55
 v_mfma_f32_16x16x32_bf16 v[76:79], v[16:19], a[184:187], v[76:79]
 s_waitcnt lgkmcnt(8)
 v_cvt_pk_bf16_f32 v60, v48, v49
 v_cvt_pk_bf16_f32 v61, v50, v51
 v_mfma_f32_16x16x32_bf16 v[80:83], v[24:27], a[160:163], v[80:83]
 ds_read_b64_tr_b16 v[16:17], v10 offset:16384
 v_cvt_pk_bf16_f32 v62, v52, v53
 v_cvt_pk_bf16_f32 v63, v54, v55
 v_mfma_f32_16x16x32_bf16 v[80:83], v[28:31], a[164:167], v[80:83]
 s_add_u32 s5, s4, 4096
 v_mfma_f32_16x16x32_bf16 v[84:87], v[28:31], a[172:175], v[84:87]
 ds_read_b64_tr_b16 v[18:19], v10 offset:16640
 buffer_store_dwordx4 v[60:63], v13, s[84:87], s5 offen offset:128 sc1
 s_mul_i32 s4, s97, 10
 v_mfma_f32_16x16x32_bf16 v[84:87], v[24:27], a[168:171], v[84:87]
 s_add_i32 s4, s4, -222
 s_lshr_b32 s8, s4, 5
 v_mfma_f32_16x16x32_bf16 v[88:91], v[24:27], a[176:179], v[88:91]
 ds_read_b64_tr_b16 v[20:21], v10 offset:18432
 s_and_b32 s4, s4, 31
 v_mfma_f32_16x16x32_bf16 v[88:91], v[28:31], a[180:183], v[88:91]
 s_lshl_b32 s4, s4, 18
 s_cmp_eq_u32 s8, 0
 v_mfma_f32_16x16x32_bf16 v[92:95], v[28:31], a[188:191], v[92:95]
 ds_read_b64_tr_b16 v[22:23], v10 offset:18688
 s_cselect_b32 s7, 0x3e3504f3, s100
 v_mfma_f32_16x16x32_bf16 v[92:95], v[24:27], a[184:187], v[92:95]
 s_waitcnt lgkmcnt(8)
 s_cselect_b32 s8, 0, 0x800000
 s_add_u32 s4, s4, s8
 v_mfma_f32_16x16x32_bf16 v[96:99], v[32:35], a[160:163], v[96:99]
 ds_read_b64_tr_b16 v[24:25], v11 offset:16384
 v_accvgpr_read_b32 v48, a32
 v_accvgpr_read_b32 v49, a33
 v_mfma_f32_16x16x32_bf16 v[96:99], v[36:39], a[164:167], v[96:99]
 v_accvgpr_read_b32 v50, a34
 v_mfma_f32_16x16x32_bf16 v[100:103], v[36:39], a[172:175], v[100:103]
 ds_read_b64_tr_b16 v[26:27], v11 offset:16640
 v_accvgpr_read_b32 v51, a35
 v_accvgpr_read_b32 v52, a48
 v_mfma_f32_16x16x32_bf16 v[100:103], v[32:35], a[168:171], v[100:103]
 v_accvgpr_read_b32 v53, a49
 v_accvgpr_read_b32 v54, a50
 v_mfma_f32_16x16x32_bf16 v[104:107], v[32:35], a[176:179], v[104:107]
 ds_read_b64_tr_b16 v[28:29], v11 offset:18432
 v_accvgpr_read_b32 v55, a51
 v_mfma_f32_16x16x32_bf16 v[104:107], v[36:39], a[180:183], v[104:107]
 v_mul_f32 v48, s7, v48
 v_mul_f32 v49, s7, v49
 v_mfma_f32_16x16x32_bf16 v[108:111], v[36:39], a[188:191], v[108:111]
 ds_read_b64_tr_b16 v[30:31], v11 offset:18688
 v_mul_f32 v50, s7, v50
 v_mfma_f32_16x16x32_bf16 v[108:111], v[32:35], a[184:187], v[108:111]
 s_waitcnt lgkmcnt(8)
 v_mul_f32 v51, s7, v51
 v_mul_f32 v52, s7, v52
 v_mfma_f32_16x16x32_bf16 v[112:115], v[40:43], a[160:163], v[112:115]
 ds_read_b64_tr_b16 v[32:33], v10 offset:20480
 v_mul_f32 v53, s7, v53
 v_mul_f32 v54, s7, v54
 v_mfma_f32_16x16x32_bf16 v[112:115], v[44:47], a[164:167], v[112:115]
 v_mul_f32 v55, s7, v55
 v_mfma_f32_16x16x32_bf16 v[116:119], v[44:47], a[172:175], v[116:119]
 ds_read_b64_tr_b16 v[34:35], v10 offset:20736
 v_cvt_pk_bf16_f32 v56, v48, v49
 v_cvt_pk_bf16_f32 v57, v50, v51
 v_mfma_f32_16x16x32_bf16 v[116:119], v[40:43], a[168:171], v[116:119]
 v_cvt_pk_bf16_f32 v58, v52, v53
 v_cvt_pk_bf16_f32 v59, v54, v55
 v_mfma_f32_16x16x32_bf16 v[120:123], v[40:43], a[176:179], v[120:123]
 ds_read_b64_tr_b16 v[36:37], v10 offset:22528
 s_add_u32 s5, s4, 0
 v_mfma_f32_16x16x32_bf16 v[120:123], v[44:47], a[180:183], v[120:123]
 buffer_store_dwordx4 v[56:59], v13, s[84:87], s5 offen offset:0 sc1
 v_accvgpr_read_b32 v48, a36
 v_mfma_f32_16x16x32_bf16 v[124:127], v[44:47], a[188:191], v[124:127]
 ds_read_b64_tr_b16 v[38:39], v10 offset:22784
 v_accvgpr_read_b32 v49, a37
 v_mfma_f32_16x16x32_bf16 v[124:127], v[40:43], a[184:187], v[124:127]
 s_waitcnt lgkmcnt(8)
 v_accvgpr_read_b32 v50, a38
 v_accvgpr_read_b32 v51, a39
 v_mfma_f32_16x16x32_bf16 v[64:67], v[16:19], a[192:195], v[64:67]
 ds_read_b64_tr_b16 v[40:41], v11 offset:20480
 v_accvgpr_read_b32 v52, a52
 v_accvgpr_read_b32 v53, a53
 v_mfma_f32_16x16x32_bf16 v[64:67], v[20:23], a[196:199], v[64:67]
 v_accvgpr_read_b32 v54, a54
 v_mfma_f32_16x16x32_bf16 v[68:71], v[20:23], a[204:207], v[68:71]
 ds_read_b64_tr_b16 v[42:43], v11 offset:20736
 v_accvgpr_read_b32 v55, a55
 v_mul_f32 v48, s7, v48
 v_mfma_f32_16x16x32_bf16 v[68:71], v[16:19], a[200:203], v[68:71]
 v_mul_f32 v49, s7, v49
 v_mul_f32 v50, s7, v50
 v_mfma_f32_16x16x32_bf16 v[72:75], v[16:19], a[208:211], v[72:75]
 ds_read_b64_tr_b16 v[44:45], v11 offset:22528
 v_mul_f32 v51, s7, v51
 v_mfma_f32_16x16x32_bf16 v[72:75], v[20:23], a[212:215], v[72:75]
 v_mul_f32 v52, s7, v52
 v_mul_f32 v53, s7, v53
 v_mfma_f32_16x16x32_bf16 v[76:79], v[20:23], a[220:223], v[76:79]
 ds_read_b64_tr_b16 v[46:47], v11 offset:22784
 v_mul_f32 v54, s7, v54
 v_mfma_f32_16x16x32_bf16 v[76:79], v[16:19], a[216:219], v[76:79]
 s_waitcnt lgkmcnt(8)
 v_mul_f32 v55, s7, v55
 v_cvt_pk_bf16_f32 v60, v48, v49
 v_mfma_f32_16x16x32_bf16 v[80:83], v[24:27], a[192:195], v[80:83]
 ds_read_b64_tr_b16 v[16:17], v4 offset:16384
 v_cvt_pk_bf16_f32 v61, v50, v51
 v_cvt_pk_bf16_f32 v62, v52, v53
 v_mfma_f32_16x16x32_bf16 v[80:83], v[28:31], a[196:199], v[80:83]
 v_cvt_pk_bf16_f32 v63, v54, v55
 v_mfma_f32_16x16x32_bf16 v[84:87], v[28:31], a[204:207], v[84:87]
 ds_read_b64_tr_b16 v[18:19], v4 offset:16640
 s_add_u32 s5, s4, 0
 buffer_store_dwordx4 v[60:63], v13, s[84:87], s5 offen offset:128 sc1
 v_mfma_f32_16x16x32_bf16 v[84:87], v[24:27], a[200:203], v[84:87]
 v_accvgpr_read_b32 v48, a40
 v_accvgpr_read_b32 v49, a41
 v_mfma_f32_16x16x32_bf16 v[88:91], v[24:27], a[208:211], v[88:91]
 ds_read_b64_tr_b16 v[20:21], v4 offset:18432
 v_accvgpr_read_b32 v50, a42
 v_mfma_f32_16x16x32_bf16 v[88:91], v[28:31], a[212:215], v[88:91]
 v_accvgpr_read_b32 v51, a43
 v_accvgpr_read_b32 v52, a56
 v_mfma_f32_16x16x32_bf16 v[92:95], v[28:31], a[220:223], v[92:95]
 ds_read_b64_tr_b16 v[22:23], v4 offset:18688
 v_accvgpr_read_b32 v53, a57
 v_mfma_f32_16x16x32_bf16 v[92:95], v[24:27], a[216:219], v[92:95]
 s_waitcnt lgkmcnt(8)
 v_accvgpr_read_b32 v54, a58
 v_accvgpr_read_b32 v55, a59
 v_mfma_f32_16x16x32_bf16 v[96:99], v[32:35], a[192:195], v[96:99]
 ds_read_b64_tr_b16 v[24:25], v5 offset:16384
 v_mul_f32 v48, s7, v48
 v_mul_f32 v49, s7, v49
 v_mfma_f32_16x16x32_bf16 v[96:99], v[36:39], a[196:199], v[96:99]
 v_mul_f32 v50, s7, v50
 v_mfma_f32_16x16x32_bf16 v[100:103], v[36:39], a[204:207], v[100:103]
 ds_read_b64_tr_b16 v[26:27], v5 offset:16640
 v_mul_f32 v51, s7, v51
 v_mul_f32 v52, s7, v52
 v_mfma_f32_16x16x32_bf16 v[100:103], v[32:35], a[200:203], v[100:103]
 v_mul_f32 v53, s7, v53
 v_mul_f32 v54, s7, v54
 v_mfma_f32_16x16x32_bf16 v[104:107], v[32:35], a[208:211], v[104:107]
 ds_read_b64_tr_b16 v[28:29], v5 offset:18432
 v_mul_f32 v55, s7, v55
 v_mfma_f32_16x16x32_bf16 v[104:107], v[36:39], a[212:215], v[104:107]
 v_cvt_pk_bf16_f32 v56, v48, v49
 v_cvt_pk_bf16_f32 v57, v50, v51
 v_mfma_f32_16x16x32_bf16 v[108:111], v[36:39], a[220:223], v[108:111]
 ds_read_b64_tr_b16 v[30:31], v5 offset:18688
 v_cvt_pk_bf16_f32 v58, v52, v53
 v_mfma_f32_16x16x32_bf16 v[108:111], v[32:35], a[216:219], v[108:111]
 s_waitcnt lgkmcnt(8)
 v_cvt_pk_bf16_f32 v59, v54, v55
 s_add_u32 s5, s4, 4096
 v_mfma_f32_16x16x32_bf16 v[112:115], v[40:43], a[192:195], v[112:115]
 ds_read_b64_tr_b16 v[32:33], v4 offset:20480
 buffer_store_dwordx4 v[56:59], v13, s[84:87], s5 offen offset:0 sc1
 v_accvgpr_read_b32 v48, a44
 v_mfma_f32_16x16x32_bf16 v[112:115], v[44:47], a[196:199], v[112:115]
 v_accvgpr_read_b32 v49, a45
 v_mfma_f32_16x16x32_bf16 v[116:119], v[44:47], a[204:207], v[116:119]
 ds_read_b64_tr_b16 v[34:35], v4 offset:20736
 v_accvgpr_read_b32 v50, a46
 v_accvgpr_read_b32 v51, a47
 v_mfma_f32_16x16x32_bf16 v[116:119], v[40:43], a[200:203], v[116:119]
 v_accvgpr_read_b32 v52, a60
 v_accvgpr_read_b32 v53, a61
 v_mfma_f32_16x16x32_bf16 v[120:123], v[40:43], a[208:211], v[120:123]
 ds_read_b64_tr_b16 v[36:37], v4 offset:22528
 v_accvgpr_read_b32 v54, a62
 v_mfma_f32_16x16x32_bf16 v[120:123], v[44:47], a[212:215], v[120:123]
 v_accvgpr_read_b32 v55, a63
 v_mul_f32 v48, s7, v48
 v_mfma_f32_16x16x32_bf16 v[124:127], v[44:47], a[220:223], v[124:127]
 ds_read_b64_tr_b16 v[38:39], v4 offset:22784
 v_mul_f32 v49, s7, v49
 v_mfma_f32_16x16x32_bf16 v[124:127], v[40:43], a[216:219], v[124:127]
 s_waitcnt lgkmcnt(8)
 v_mul_f32 v50, s7, v50
 v_mul_f32 v51, s7, v51
 v_mfma_f32_16x16x32_bf16 v[64:67], v[16:19], a[224:227], v[64:67]
 ds_read_b64_tr_b16 v[40:41], v5 offset:20480
 v_mul_f32 v52, s7, v52
 v_mul_f32 v53, s7, v53
 v_mfma_f32_16x16x32_bf16 v[64:67], v[20:23], a[228:231], v[64:67]
 v_mul_f32 v54, s7, v54
 v_mfma_f32_16x16x32_bf16 v[68:71], v[20:23], a[236:239], v[68:71]
 ds_read_b64_tr_b16 v[42:43], v5 offset:20736
 v_mul_f32 v55, s7, v55
 v_cvt_pk_bf16_f32 v60, v48, v49
 v_mfma_f32_16x16x32_bf16 v[68:71], v[16:19], a[232:235], v[68:71]
 v_cvt_pk_bf16_f32 v61, v50, v51
 v_cvt_pk_bf16_f32 v62, v52, v53
 v_mfma_f32_16x16x32_bf16 v[72:75], v[16:19], a[240:243], v[72:75]
 ds_read_b64_tr_b16 v[44:45], v5 offset:22528
 v_cvt_pk_bf16_f32 v63, v54, v55
 v_mfma_f32_16x16x32_bf16 v[72:75], v[20:23], a[244:247], v[72:75]
 s_add_u32 s5, s4, 4096
 buffer_store_dwordx4 v[60:63], v13, s[84:87], s5 offen offset:128 sc1
 v_mfma_f32_16x16x32_bf16 v[76:79], v[20:23], a[252:255], v[76:79]
 ds_read_b64_tr_b16 v[46:47], v5 offset:22784
 s_mul_i32 s4, s97, 10
 v_mfma_f32_16x16x32_bf16 v[76:79], v[16:19], a[248:251], v[76:79]
 s_waitcnt lgkmcnt(8)
 s_add_i32 s4, s4, -223
 s_lshr_b32 s8, s4, 5
 v_mfma_f32_16x16x32_bf16 v[80:83], v[24:27], a[224:227], v[80:83]
 ds_read_b64_tr_b16 v[16:17], v6 offset:24576
 s_and_b32 s4, s4, 31
 s_lshl_b32 s4, s4, 18
 v_mfma_f32_16x16x32_bf16 v[80:83], v[28:31], a[228:231], v[80:83]
 s_cmp_eq_u32 s8, 0
 v_mfma_f32_16x16x32_bf16 v[84:87], v[28:31], a[236:239], v[84:87]
 ds_read_b64_tr_b16 v[18:19], v6 offset:24832
 s_cselect_b32 s7, 0x3e3504f3, s100
 s_cselect_b32 s8, 0, 0x800000
 v_mfma_f32_16x16x32_bf16 v[84:87], v[24:27], a[232:235], v[84:87]
 s_add_u32 s4, s4, s8
 v_accvgpr_read_b32 v48, a64
 v_mfma_f32_16x16x32_bf16 v[88:91], v[24:27], a[240:243], v[88:91]
 ds_read_b64_tr_b16 v[20:21], v6 offset:26624
 v_accvgpr_read_b32 v49, a65
 v_mfma_f32_16x16x32_bf16 v[88:91], v[28:31], a[244:247], v[88:91]
 v_accvgpr_read_b32 v50, a66
 v_accvgpr_read_b32 v51, a67
 v_mfma_f32_16x16x32_bf16 v[92:95], v[28:31], a[252:255], v[92:95]
 ds_read_b64_tr_b16 v[22:23], v6 offset:26880
 v_accvgpr_read_b32 v52, a80
 v_mfma_f32_16x16x32_bf16 v[92:95], v[24:27], a[248:251], v[92:95]
 s_waitcnt lgkmcnt(8)
 v_accvgpr_read_b32 v53, a81
 v_accvgpr_read_b32 v54, a82
 v_mfma_f32_16x16x32_bf16 v[96:99], v[32:35], a[224:227], v[96:99]
 ds_read_b64_tr_b16 v[24:25], v7 offset:24576
 v_accvgpr_read_b32 v55, a83
 v_mul_f32 v48, s7, v48
 v_mfma_f32_16x16x32_bf16 v[96:99], v[36:39], a[228:231], v[96:99]
 v_mul_f32 v49, s7, v49
 v_mfma_f32_16x16x32_bf16 v[100:103], v[36:39], a[236:239], v[100:103]
 ds_read_b64_tr_b16 v[26:27], v7 offset:24832
 v_mul_f32 v50, s7, v50
 v_mul_f32 v51, s7, v51
 v_mfma_f32_16x16x32_bf16 v[100:103], v[32:35], a[232:235], v[100:103]
 v_mul_f32 v52, s7, v52
 v_mfma_f32_16x16x32_bf16 v[104:107], v[32:35], a[240:243], v[104:107]
 ds_read_b64_tr_b16 v[28:29], v7 offset:26624
 v_mul_f32 v53, s7, v53
 v_mul_f32 v54, s7, v54
 v_mfma_f32_16x16x32_bf16 v[104:107], v[36:39], a[244:247], v[104:107]
 v_mul_f32 v55, s7, v55
 v_cvt_pk_bf16_f32 v56, v48, v49
 v_mfma_f32_16x16x32_bf16 v[108:111], v[36:39], a[252:255], v[108:111]
 ds_read_b64_tr_b16 v[30:31], v7 offset:26880
 v_cvt_pk_bf16_f32 v57, v50, v51
 v_mfma_f32_16x16x32_bf16 v[108:111], v[32:35], a[248:251], v[108:111]
 s_waitcnt lgkmcnt(8)
 v_cvt_pk_bf16_f32 v58, v52, v53
 v_cvt_pk_bf16_f32 v59, v54, v55
 v_mfma_f32_16x16x32_bf16 v[112:115], v[40:43], a[224:227], v[112:115]
 ds_read_b64_tr_b16 v[32:33], v6 offset:28672
 s_add_u32 s5, s4, 0
 buffer_store_dwordx4 v[56:59], v13, s[84:87], s5 offen offset:0 sc1
 v_mfma_f32_16x16x32_bf16 v[112:115], v[44:47], a[228:231], v[112:115]
 v_accvgpr_read_b32 v48, a68
 v_mfma_f32_16x16x32_bf16 v[116:119], v[44:47], a[236:239], v[116:119]
 ds_read_b64_tr_b16 v[34:35], v6 offset:28928
 v_accvgpr_read_b32 v49, a69
 v_accvgpr_read_b32 v50, a70
 v_mfma_f32_16x16x32_bf16 v[116:119], v[40:43], a[232:235], v[116:119]
 v_accvgpr_read_b32 v51, a71
 v_mfma_f32_16x16x32_bf16 v[120:123], v[40:43], a[240:243], v[120:123]
 ds_read_b64_tr_b16 v[36:37], v6 offset:30720
 v_accvgpr_read_b32 v52, a84
 v_accvgpr_read_b32 v53, a85
 v_mfma_f32_16x16x32_bf16 v[120:123], v[44:47], a[244:247], v[120:123]
 v_accvgpr_read_b32 v54, a86
 v_accvgpr_read_b32 v55, a87
 v_mfma_f32_16x16x32_bf16 v[124:127], v[44:47], a[252:255], v[124:127]
 ds_read_b64_tr_b16 v[38:39], v6 offset:30976
 v_mul_f32 v48, s7, v48
 v_mfma_f32_16x16x32_bf16 v[124:127], v[40:43], a[248:251], v[124:127]
 s_waitcnt lgkmcnt(8)
 v_mul_f32 v49, s7, v49
 v_mul_f32 v50, s7, v50
 v_mfma_f32_16x16x32_bf16 v[128:131], v[16:19], a[128:131], v[128:131]
 ds_read_b64_tr_b16 v[40:41], v7 offset:28672
 v_mul_f32 v51, s7, v51
 v_mul_f32 v52, s7, v52
 v_mfma_f32_16x16x32_bf16 v[128:131], v[20:23], a[132:135], v[128:131]
 v_mul_f32 v53, s7, v53
 v_mfma_f32_16x16x32_bf16 v[132:135], v[20:23], a[140:143], v[132:135]
 ds_read_b64_tr_b16 v[42:43], v7 offset:28928
 v_mul_f32 v54, s7, v54
 v_mul_f32 v55, s7, v55
 v_mfma_f32_16x16x32_bf16 v[132:135], v[16:19], a[136:139], v[132:135]
 v_cvt_pk_bf16_f32 v60, v48, v49
 v_mfma_f32_16x16x32_bf16 v[136:139], v[16:19], a[144:147], v[136:139]
 ds_read_b64_tr_b16 v[44:45], v7 offset:30720
 v_cvt_pk_bf16_f32 v61, v50, v51
 v_cvt_pk_bf16_f32 v62, v52, v53
 v_mfma_f32_16x16x32_bf16 v[136:139], v[20:23], a[148:151], v[136:139]
 v_cvt_pk_bf16_f32 v63, v54, v55
 s_add_u32 s5, s4, 0
 v_mfma_f32_16x16x32_bf16 v[140:143], v[20:23], a[156:159], v[140:143]
 ds_read_b64_tr_b16 v[46:47], v7 offset:30976
 buffer_store_dwordx4 v[60:63], v13, s[84:87], s5 offen offset:128 sc1
 v_mfma_f32_16x16x32_bf16 v[140:143], v[16:19], a[152:155], v[140:143]
 s_waitcnt lgkmcnt(8)
 v_accvgpr_read_b32 v48, a72
 v_accvgpr_read_b32 v49, a73
 v_mfma_f32_16x16x32_bf16 v[144:147], v[24:27], a[128:131], v[144:147]
 ds_read_b64_tr_b16 v[16:17], v8 offset:24576
 v_accvgpr_read_b32 v50, a74
 v_accvgpr_read_b32 v51, a75
 v_mfma_f32_16x16x32_bf16 v[144:147], v[28:31], a[132:135], v[144:147]
 v_accvgpr_read_b32 v52, a88
 v_mfma_f32_16x16x32_bf16 v[148:151], v[28:31], a[140:143], v[148:151]
 ds_read_b64_tr_b16 v[18:19], v8 offset:24832
 v_accvgpr_read_b32 v53, a89
 v_accvgpr_read_b32 v54, a90
 v_mfma_f32_16x16x32_bf16 v[148:151], v[24:27], a[136:139], v[148:151]
 v_accvgpr_read_b32 v55, a91
 v_mfma_f32_16x16x32_bf16 v[152:155], v[24:27], a[144:147], v[152:155]
 ds_read_b64_tr_b16 v[20:21], v8 offset:26624
 v_mul_f32 v48, s7, v48
 v_mul_f32 v49, s7, v49
 v_mfma_f32_16x16x32_bf16 v[152:155], v[28:31], a[148:151], v[152:155]
 v_mul_f32 v50, s7, v50
 v_mul_f32 v51, s7, v51
 v_mfma_f32_16x16x32_bf16 v[156:159], v[28:31], a[156:159], v[156:159]
 ds_read_b64_tr_b16 v[22:23], v8 offset:26880
 v_mul_f32 v52, s7, v52
 v_mfma_f32_16x16x32_bf16 v[156:159], v[24:27], a[152:155], v[156:159]
 s_waitcnt lgkmcnt(8)
 v_mul_f32 v53, s7, v53
 v_mul_f32 v54, s7, v54
 v_mfma_f32_16x16x32_bf16 v[160:163], v[32:35], a[128:131], v[160:163]
 ds_read_b64_tr_b16 v[24:25], v9 offset:24576
 v_mul_f32 v55, s7, v55
 v_cvt_pk_bf16_f32 v56, v48, v49
 v_mfma_f32_16x16x32_bf16 v[160:163], v[36:39], a[132:135], v[160:163]
 v_cvt_pk_bf16_f32 v57, v50, v51
 v_mfma_f32_16x16x32_bf16 v[164:167], v[36:39], a[140:143], v[164:167]
 ds_read_b64_tr_b16 v[26:27], v9 offset:24832
 v_cvt_pk_bf16_f32 v58, v52, v53
 v_cvt_pk_bf16_f32 v59, v54, v55
 v_mfma_f32_16x16x32_bf16 v[164:167], v[32:35], a[136:139], v[164:167]
 s_add_u32 s5, s4, 4096
 v_mfma_f32_16x16x32_bf16 v[168:171], v[32:35], a[144:147], v[168:171]
 ds_read_b64_tr_b16 v[28:29], v9 offset:26624
 buffer_store_dwordx4 v[56:59], v13, s[84:87], s5 offen offset:0 sc1
 v_accvgpr_read_b32 v48, a76
 v_mfma_f32_16x16x32_bf16 v[168:171], v[36:39], a[148:151], v[168:171]
 v_accvgpr_read_b32 v49, a77
 v_accvgpr_read_b32 v50, a78
 v_mfma_f32_16x16x32_bf16 v[172:175], v[36:39], a[156:159], v[172:175]
 ds_read_b64_tr_b16 v[30:31], v9 offset:26880
 v_accvgpr_read_b32 v51, a79
 v_mfma_f32_16x16x32_bf16 v[172:175], v[32:35], a[152:155], v[172:175]
 s_waitcnt lgkmcnt(8)
 v_accvgpr_read_b32 v52, a92
 v_accvgpr_read_b32 v53, a93
 v_mfma_f32_16x16x32_bf16 v[176:179], v[40:43], a[128:131], v[176:179]
 ds_read_b64_tr_b16 v[32:33], v8 offset:28672
 v_accvgpr_read_b32 v54, a94
 v_accvgpr_read_b32 v55, a95
 v_mfma_f32_16x16x32_bf16 v[176:179], v[44:47], a[132:135], v[176:179]
 v_mul_f32 v48, s7, v48
 v_mfma_f32_16x16x32_bf16 v[180:183], v[44:47], a[140:143], v[180:183]
 ds_read_b64_tr_b16 v[34:35], v8 offset:28928
 v_mul_f32 v49, s7, v49
 v_mul_f32 v50, s7, v50
 v_mfma_f32_16x16x32_bf16 v[180:183], v[40:43], a[136:139], v[180:183]
 v_mul_f32 v51, s7, v51
 v_mfma_f32_16x16x32_bf16 v[184:187], v[40:43], a[144:147], v[184:187]
 ds_read_b64_tr_b16 v[36:37], v8 offset:30720
 v_mul_f32 v52, s7, v52
 v_mul_f32 v53, s7, v53
 v_mfma_f32_16x16x32_bf16 v[184:187], v[44:47], a[148:151], v[184:187]
 v_mul_f32 v54, s7, v54
 v_mul_f32 v55, s7, v55
 v_mfma_f32_16x16x32_bf16 v[188:191], v[44:47], a[156:159], v[188:191]
 ds_read_b64_tr_b16 v[38:39], v8 offset:30976
 v_cvt_pk_bf16_f32 v60, v48, v49
 v_mfma_f32_16x16x32_bf16 v[188:191], v[40:43], a[152:155], v[188:191]
 s_waitcnt lgkmcnt(8)
 v_cvt_pk_bf16_f32 v61, v50, v51
 v_cvt_pk_bf16_f32 v62, v52, v53
 v_mfma_f32_16x16x32_bf16 v[128:131], v[16:19], a[160:163], v[128:131]
 ds_read_b64_tr_b16 v[40:41], v9 offset:28672
 v_cvt_pk_bf16_f32 v63, v54, v55
 s_add_u32 s5, s4, 4096
 v_mfma_f32_16x16x32_bf16 v[128:131], v[20:23], a[164:167], v[128:131]
 buffer_store_dwordx4 v[60:63], v13, s[84:87], s5 offen offset:128 sc1
 v_mfma_f32_16x16x32_bf16 v[132:135], v[20:23], a[172:175], v[132:135]
 ds_read_b64_tr_b16 v[42:43], v9 offset:28928
 s_mul_i32 s4, s97, 10
 s_add_i32 s4, s4, -221
 v_mfma_f32_16x16x32_bf16 v[132:135], v[16:19], a[168:171], v[132:135]
 s_lshr_b32 s8, s4, 5
 v_mfma_f32_16x16x32_bf16 v[136:139], v[16:19], a[176:179], v[136:139]
 ds_read_b64_tr_b16 v[44:45], v9 offset:30720
 s_and_b32 s4, s4, 31
 s_lshl_b32 s4, s4, 18
 v_mfma_f32_16x16x32_bf16 v[136:139], v[20:23], a[180:183], v[136:139]
 s_cmp_eq_u32 s8, 0
 s_cselect_b32 s7, 0x3e3504f3, s100
 v_mfma_f32_16x16x32_bf16 v[140:143], v[20:23], a[188:191], v[140:143]
 ds_read_b64_tr_b16 v[46:47], v9 offset:30976
 s_cselect_b32 s8, 0, 0x800000
 v_mfma_f32_16x16x32_bf16 v[140:143], v[16:19], a[184:187], v[140:143]
 s_waitcnt lgkmcnt(8)
 s_add_u32 s4, s4, s8
 v_accvgpr_read_b32 v48, a96
 v_mfma_f32_16x16x32_bf16 v[144:147], v[24:27], a[160:163], v[144:147]
 ds_read_b64_tr_b16 v[16:17], v10 offset:24576
 v_accvgpr_read_b32 v49, a97
 v_accvgpr_read_b32 v50, a98
 v_mfma_f32_16x16x32_bf16 v[144:147], v[28:31], a[164:167], v[144:147]
 v_accvgpr_read_b32 v51, a99
 v_mfma_f32_16x16x32_bf16 v[148:151], v[28:31], a[172:175], v[148:151]
 ds_read_b64_tr_b16 v[18:19], v10 offset:24832
 v_accvgpr_read_b32 v52, a112
 v_accvgpr_read_b32 v53, a113
 v_mfma_f32_16x16x32_bf16 v[148:151], v[24:27], a[168:171], v[148:151]
 v_accvgpr_read_b32 v54, a114
 v_mfma_f32_16x16x32_bf16 v[152:155], v[24:27], a[176:179], v[152:155]
 ds_read_b64_tr_b16 v[20:21], v10 offset:26624
 v_accvgpr_read_b32 v55, a115
 v_mul_f32 v48, s7, v48
 v_mfma_f32_16x16x32_bf16 v[152:155], v[28:31], a[180:183], v[152:155]
 v_mul_f32 v49, s7, v49
 v_mul_f32 v50, s7, v50
 v_mfma_f32_16x16x32_bf16 v[156:159], v[28:31], a[188:191], v[156:159]
 ds_read_b64_tr_b16 v[22:23], v10 offset:26880
 v_mul_f32 v51, s7, v51
 v_mfma_f32_16x16x32_bf16 v[156:159], v[24:27], a[184:187], v[156:159]
 s_waitcnt lgkmcnt(8)
 v_mul_f32 v52, s7, v52
 v_mul_f32 v53, s7, v53
 v_mfma_f32_16x16x32_bf16 v[160:163], v[32:35], a[160:163], v[160:163]
 ds_read_b64_tr_b16 v[24:25], v11 offset:24576
 v_mul_f32 v54, s7, v54
 v_mul_f32 v55, s7, v55
 v_mfma_f32_16x16x32_bf16 v[160:163], v[36:39], a[164:167], v[160:163]
 v_cvt_pk_bf16_f32 v56, v48, v49
 v_mfma_f32_16x16x32_bf16 v[164:167], v[36:39], a[172:175], v[164:167]
 ds_read_b64_tr_b16 v[26:27], v11 offset:24832
 v_cvt_pk_bf16_f32 v57, v50, v51
 v_cvt_pk_bf16_f32 v58, v52, v53
 v_mfma_f32_16x16x32_bf16 v[164:167], v[32:35], a[168:171], v[164:167]
 v_cvt_pk_bf16_f32 v59, v54, v55
 v_mfma_f32_16x16x32_bf16 v[168:171], v[32:35], a[176:179], v[168:171]
 ds_read_b64_tr_b16 v[28:29], v11 offset:26624
 s_add_u32 s5, s4, 0
 buffer_store_dwordx4 v[56:59], v13, s[84:87], s5 offen offset:0 sc1
 v_mfma_f32_16x16x32_bf16 v[168:171], v[36:39], a[180:183], v[168:171]
 v_accvgpr_read_b32 v48, a100
 v_accvgpr_read_b32 v49, a101
 v_mfma_f32_16x16x32_bf16 v[172:175], v[36:39], a[188:191], v[172:175]
 ds_read_b64_tr_b16 v[30:31], v11 offset:26880
 v_accvgpr_read_b32 v50, a102
 v_mfma_f32_16x16x32_bf16 v[172:175], v[32:35], a[184:187], v[172:175]
 s_waitcnt lgkmcnt(8)
 v_accvgpr_read_b32 v51, a103
 v_accvgpr_read_b32 v52, a116
 v_mfma_f32_16x16x32_bf16 v[176:179], v[40:43], a[160:163], v[176:179]
 ds_read_b64_tr_b16 v[32:33], v10 offset:28672
 v_accvgpr_read_b32 v53, a117
 v_accvgpr_read_b32 v54, a118
 v_mfma_f32_16x16x32_bf16 v[176:179], v[44:47], a[164:167], v[176:179]
 v_accvgpr_read_b32 v55, a119
 v_mfma_f32_16x16x32_bf16 v[180:183], v[44:47], a[172:175], v[180:183]
 ds_read_b64_tr_b16 v[34:35], v10 offset:28928
 v_mul_f32 v48, s7, v48
 v_mul_f32 v49, s7, v49
 v_mfma_f32_16x16x32_bf16 v[180:183], v[40:43], a[168:171], v[180:183]
 v_mul_f32 v50, s7, v50
 v_mfma_f32_16x16x32_bf16 v[184:187], v[40:43], a[176:179], v[184:187]
 ds_read_b64_tr_b16 v[36:37], v10 offset:30720
 v_mul_f32 v51, s7, v51
 v_mul_f32 v52, s7, v52
 v_mfma_f32_16x16x32_bf16 v[184:187], v[44:47], a[180:183], v[184:187]
 v_mul_f32 v53, s7, v53
 v_mul_f32 v54, s7, v54
 v_mfma_f32_16x16x32_bf16 v[188:191], v[44:47], a[188:191], v[188:191]
 ds_read_b64_tr_b16 v[38:39], v10 offset:30976
 v_mul_f32 v55, s7, v55
 v_mfma_f32_16x16x32_bf16 v[188:191], v[40:43], a[184:187], v[188:191]
 s_waitcnt lgkmcnt(8)
 v_cvt_pk_bf16_f32 v60, v48, v49
 v_cvt_pk_bf16_f32 v61, v50, v51
 v_mfma_f32_16x16x32_bf16 v[128:131], v[16:19], a[192:195], v[128:131]
 ds_read_b64_tr_b16 v[40:41], v11 offset:28672
 v_cvt_pk_bf16_f32 v62, v52, v53
 v_cvt_pk_bf16_f32 v63, v54, v55
 v_mfma_f32_16x16x32_bf16 v[128:131], v[20:23], a[196:199], v[128:131]
 s_add_u32 s5, s4, 0
 v_mfma_f32_16x16x32_bf16 v[132:135], v[20:23], a[204:207], v[132:135]
 ds_read_b64_tr_b16 v[42:43], v11 offset:28928
 buffer_store_dwordx4 v[60:63], v13, s[84:87], s5 offen offset:128 sc1
 v_accvgpr_read_b32 v48, a104
 v_mfma_f32_16x16x32_bf16 v[132:135], v[16:19], a[200:203], v[132:135]
 v_accvgpr_read_b32 v49, a105
 v_mfma_f32_16x16x32_bf16 v[136:139], v[16:19], a[208:211], v[136:139]
 ds_read_b64_tr_b16 v[44:45], v11 offset:30720
 v_accvgpr_read_b32 v50, a106
 v_accvgpr_read_b32 v51, a107
 v_mfma_f32_16x16x32_bf16 v[136:139], v[20:23], a[212:215], v[136:139]
 v_accvgpr_read_b32 v52, a120
 v_accvgpr_read_b32 v53, a121
 v_mfma_f32_16x16x32_bf16 v[140:143], v[20:23], a[220:223], v[140:143]
 ds_read_b64_tr_b16 v[46:47], v11 offset:30976
 v_accvgpr_read_b32 v54, a122
 v_mfma_f32_16x16x32_bf16 v[140:143], v[16:19], a[216:219], v[140:143]
 s_waitcnt lgkmcnt(8)
 v_accvgpr_read_b32 v55, a123
 v_mul_f32 v48, s7, v48
 v_mfma_f32_16x16x32_bf16 v[144:147], v[24:27], a[192:195], v[144:147]
 ds_read_b64_tr_b16 v[16:17], v4 offset:24576
 v_mul_f32 v49, s7, v49
 v_mul_f32 v50, s7, v50
 v_mfma_f32_16x16x32_bf16 v[144:147], v[28:31], a[196:199], v[144:147]
 v_mul_f32 v51, s7, v51
 v_mfma_f32_16x16x32_bf16 v[148:151], v[28:31], a[204:207], v[148:151]
 ds_read_b64_tr_b16 v[18:19], v4 offset:24832
 v_mul_f32 v52, s7, v52
 v_mul_f32 v53, s7, v53
 v_mfma_f32_16x16x32_bf16 v[148:151], v[24:27], a[200:203], v[148:151]
 v_mul_f32 v54, s7, v54
 v_mfma_f32_16x16x32_bf16 v[152:155], v[24:27], a[208:211], v[152:155]
 ds_read_b64_tr_b16 v[20:21], v4 offset:26624
 v_mul_f32 v55, s7, v55
 v_cvt_pk_bf16_f32 v56, v48, v49
 v_mfma_f32_16x16x32_bf16 v[152:155], v[28:31], a[212:215], v[152:155]
 v_cvt_pk_bf16_f32 v57, v50, v51
 v_cvt_pk_bf16_f32 v58, v52, v53
 v_mfma_f32_16x16x32_bf16 v[156:159], v[28:31], a[220:223], v[156:159]
 ds_read_b64_tr_b16 v[22:23], v4 offset:26880
 v_cvt_pk_bf16_f32 v59, v54, v55
 v_mfma_f32_16x16x32_bf16 v[156:159], v[24:27], a[216:219], v[156:159]
 s_waitcnt lgkmcnt(8)
 s_add_u32 s5, s4, 4096
 buffer_store_dwordx4 v[56:59], v13, s[84:87], s5 offen offset:0 sc1
 v_mfma_f32_16x16x32_bf16 v[160:163], v[32:35], a[192:195], v[160:163]
 ds_read_b64_tr_b16 v[24:25], v5 offset:24576
 v_accvgpr_read_b32 v48, a108
 v_accvgpr_read_b32 v49, a109
 v_mfma_f32_16x16x32_bf16 v[160:163], v[36:39], a[196:199], v[160:163]
 v_accvgpr_read_b32 v50, a110
 v_mfma_f32_16x16x32_bf16 v[164:167], v[36:39], a[204:207], v[164:167]
 ds_read_b64_tr_b16 v[26:27], v5 offset:24832
 v_accvgpr_read_b32 v51, a111
 v_accvgpr_read_b32 v52, a124
 v_mfma_f32_16x16x32_bf16 v[164:167], v[32:35], a[200:203], v[164:167]
 v_accvgpr_read_b32 v53, a125
 v_mfma_f32_16x16x32_bf16 v[168:171], v[32:35], a[208:211], v[168:171]
 ds_read_b64_tr_b16 v[28:29], v5 offset:26624
 v_accvgpr_read_b32 v54, a126
 v_accvgpr_read_b32 v55, a127
 v_mfma_f32_16x16x32_bf16 v[168:171], v[36:39], a[212:215], v[168:171]
 v_mul_f32 v48, s7, v48
 v_mul_f32 v49, s7, v49
 v_mfma_f32_16x16x32_bf16 v[172:175], v[36:39], a[220:223], v[172:175]
 ds_read_b64_tr_b16 v[30:31], v5 offset:26880
 v_mul_f32 v50, s7, v50
 v_mfma_f32_16x16x32_bf16 v[172:175], v[32:35], a[216:219], v[172:175]
 s_waitcnt lgkmcnt(8)
 v_mul_f32 v51, s7, v51
 v_mul_f32 v52, s7, v52
 v_mfma_f32_16x16x32_bf16 v[176:179], v[40:43], a[192:195], v[176:179]
 ds_read_b64_tr_b16 v[32:33], v4 offset:28672
 v_mul_f32 v53, s7, v53
 v_mul_f32 v54, s7, v54
 v_mfma_f32_16x16x32_bf16 v[176:179], v[44:47], a[196:199], v[176:179]
 v_mul_f32 v55, s7, v55
 v_mfma_f32_16x16x32_bf16 v[180:183], v[44:47], a[204:207], v[180:183]
 ds_read_b64_tr_b16 v[34:35], v4 offset:28928
 v_cvt_pk_bf16_f32 v60, v48, v49
 v_cvt_pk_bf16_f32 v61, v50, v51
 v_mfma_f32_16x16x32_bf16 v[180:183], v[40:43], a[200:203], v[180:183]
 v_cvt_pk_bf16_f32 v62, v52, v53
 v_mfma_f32_16x16x32_bf16 v[184:187], v[40:43], a[208:211], v[184:187]
 ds_read_b64_tr_b16 v[36:37], v4 offset:30720
 v_cvt_pk_bf16_f32 v63, v54, v55
 s_add_u32 s5, s4, 4096
 v_mfma_f32_16x16x32_bf16 v[184:187], v[44:47], a[212:215], v[184:187]
 buffer_store_dwordx4 v[60:63], v13, s[84:87], s5 offen offset:128 sc1
 s_mul_i32 s4, s97, 10
 v_mfma_f32_16x16x32_bf16 v[188:191], v[44:47], a[220:223], v[188:191]
 ds_read_b64_tr_b16 v[38:39], v4 offset:30976
 s_add_i32 s4, s4, -220
 v_mfma_f32_16x16x32_bf16 v[188:191], v[40:43], a[216:219], v[188:191]
 s_waitcnt lgkmcnt(8)
 s_lshr_b32 s8, s4, 5
 s_and_b32 s4, s4, 31
 v_mfma_f32_16x16x32_bf16 v[128:131], v[16:19], a[224:227], v[128:131]
 ds_read_b64_tr_b16 v[40:41], v5 offset:28672
 s_lshl_b32 s4, s4, 18
 s_cmp_eq_u32 s8, 0
 v_mfma_f32_16x16x32_bf16 v[128:131], v[20:23], a[228:231], v[128:131]
 s_cselect_b32 s7, 0x3e3504f3, s100
 v_mfma_f32_16x16x32_bf16 v[132:135], v[20:23], a[236:239], v[132:135]
 ds_read_b64_tr_b16 v[42:43], v5 offset:28928
 s_cselect_b32 s8, 0, 0x800000
 s_add_u32 s4, s4, s8
 v_mfma_f32_16x16x32_bf16 v[132:135], v[16:19], a[232:235], v[132:135]
 v_mul_f32 v64, s7, v64
 v_mfma_f32_16x16x32_bf16 v[136:139], v[16:19], a[240:243], v[136:139]
 ds_read_b64_tr_b16 v[44:45], v5 offset:30720
 v_mul_f32 v65, s7, v65
 v_mul_f32 v66, s7, v66
 v_mfma_f32_16x16x32_bf16 v[136:139], v[20:23], a[244:247], v[136:139]
 v_mul_f32 v67, s7, v67
 v_mul_f32 v80, s7, v80
 v_mfma_f32_16x16x32_bf16 v[140:143], v[20:23], a[252:255], v[140:143]
 ds_read_b64_tr_b16 v[46:47], v5 offset:30976
 v_mul_f32 v81, s7, v81
 v_mfma_f32_16x16x32_bf16 v[140:143], v[16:19], a[248:251], v[140:143]
 s_waitcnt lgkmcnt(8)
 v_mul_f32 v82, s7, v82
 v_mul_f32 v83, s7, v83
 v_mfma_f32_16x16x32_bf16 v[144:147], v[24:27], a[224:227], v[144:147]
 ds_read_b64_tr_b16 v[16:17], v6 offset:32768
 v_cvt_pk_bf16_f32 v56, v64, v65
 v_cvt_pk_bf16_f32 v57, v66, v67
 v_mfma_f32_16x16x32_bf16 v[144:147], v[28:31], a[228:231], v[144:147]
 v_cvt_pk_bf16_f32 v58, v80, v81
 v_mfma_f32_16x16x32_bf16 v[148:151], v[28:31], a[236:239], v[148:151]
 ds_read_b64_tr_b16 v[18:19], v6 offset:33024
 v_cvt_pk_bf16_f32 v59, v82, v83
 s_add_u32 s5, s4, 0
 v_mfma_f32_16x16x32_bf16 v[148:151], v[24:27], a[232:235], v[148:151]
 buffer_store_dwordx4 v[56:59], v13, s[84:87], s5 offen offset:0 sc1
 v_mfma_f32_16x16x32_bf16 v[152:155], v[24:27], a[240:243], v[152:155]
 ds_read_b64_tr_b16 v[20:21], v6 offset:34816
 v_mul_f32 v68, s7, v68
 v_mul_f32 v69, s7, v69
 v_mfma_f32_16x16x32_bf16 v[152:155], v[28:31], a[244:247], v[152:155]
 v_mul_f32 v70, s7, v70
 v_mul_f32 v71, s7, v71
 v_mfma_f32_16x16x32_bf16 v[156:159], v[28:31], a[252:255], v[156:159]
 ds_read_b64_tr_b16 v[22:23], v6 offset:35072
 v_mul_f32 v84, s7, v84
 v_mfma_f32_16x16x32_bf16 v[156:159], v[24:27], a[248:251], v[156:159]
 s_waitcnt lgkmcnt(8)
 v_mul_f32 v85, s7, v85
 v_mul_f32 v86, s7, v86
 v_mfma_f32_16x16x32_bf16 v[160:163], v[32:35], a[224:227], v[160:163]
 ds_read_b64_tr_b16 v[24:25], v7 offset:32768
 v_mul_f32 v87, s7, v87
 v_cvt_pk_bf16_f32 v60, v68, v69
 v_mfma_f32_16x16x32_bf16 v[160:163], v[36:39], a[228:231], v[160:163]
 v_cvt_pk_bf16_f32 v61, v70, v71
 v_mfma_f32_16x16x32_bf16 v[164:167], v[36:39], a[236:239], v[164:167]
 ds_read_b64_tr_b16 v[26:27], v7 offset:33024
 v_cvt_pk_bf16_f32 v62, v84, v85
 v_cvt_pk_bf16_f32 v63, v86, v87
 v_mfma_f32_16x16x32_bf16 v[164:167], v[32:35], a[232:235], v[164:167]
 s_add_u32 s5, s4, 0
 v_mfma_f32_16x16x32_bf16 v[168:171], v[32:35], a[240:243], v[168:171]
 ds_read_b64_tr_b16 v[28:29], v7 offset:34816
 buffer_store_dwordx4 v[60:63], v13, s[84:87], s5 offen offset:128 sc1
 v_mul_f32 v72, s7, v72
 v_mfma_f32_16x16x32_bf16 v[168:171], v[36:39], a[244:247], v[168:171]
 v_mul_f32 v73, s7, v73
 v_mul_f32 v74, s7, v74
 v_mfma_f32_16x16x32_bf16 v[172:175], v[36:39], a[252:255], v[172:175]
 ds_read_b64_tr_b16 v[30:31], v7 offset:35072
 v_mul_f32 v75, s7, v75
 v_mfma_f32_16x16x32_bf16 v[172:175], v[32:35], a[248:251], v[172:175]
 s_waitcnt lgkmcnt(8)
 v_mul_f32 v88, s7, v88
 v_mul_f32 v89, s7, v89
 v_mfma_f32_16x16x32_bf16 v[176:179], v[40:43], a[224:227], v[176:179]
 ds_read_b64_tr_b16 v[32:33], v6 offset:36864
 v_mul_f32 v90, s7, v90
 v_mfma_f32_16x16x32_bf16 v[176:179], v[44:47], a[228:231], v[176:179]
 v_mul_f32 v91, s7, v91
 v_cvt_pk_bf16_f32 v56, v72, v73
 v_mfma_f32_16x16x32_bf16 v[180:183], v[44:47], a[236:239], v[180:183]
 ds_read_b64_tr_b16 v[34:35], v6 offset:37120
 v_cvt_pk_bf16_f32 v57, v74, v75
 v_cvt_pk_bf16_f32 v58, v88, v89
 v_mfma_f32_16x16x32_bf16 v[180:183], v[40:43], a[232:235], v[180:183]
 v_cvt_pk_bf16_f32 v59, v90, v91
 v_mfma_f32_16x16x32_bf16 v[184:187], v[40:43], a[240:243], v[184:187]
 ds_read_b64_tr_b16 v[36:37], v6 offset:38912
 s_add_u32 s5, s4, 4096
 buffer_store_dwordx4 v[56:59], v13, s[84:87], s5 offen offset:0 sc1
 v_mfma_f32_16x16x32_bf16 v[184:187], v[44:47], a[244:247], v[184:187]
 v_mul_f32 v76, s7, v76
 v_mul_f32 v77, s7, v77
 v_mfma_f32_16x16x32_bf16 v[188:191], v[44:47], a[252:255], v[188:191]
 ds_read_b64_tr_b16 v[38:39], v6 offset:39168
 v_mul_f32 v78, s7, v78
 v_mfma_f32_16x16x32_bf16 v[188:191], v[40:43], a[248:251], v[188:191]
 s_waitcnt lgkmcnt(8)
 v_mul_f32 v79, s7, v79
 v_mul_f32 v92, s7, v92
 v_mfma_f32_16x16x32_bf16 v[192:195], v[16:19], a[128:131], v[192:195]
 ds_read_b64_tr_b16 v[40:41], v7 offset:36864
 v_mul_f32 v93, s7, v93
 v_mfma_f32_16x16x32_bf16 v[192:195], v[20:23], a[132:135], v[192:195]
 v_mul_f32 v94, s7, v94
 v_mul_f32 v95, s7, v95
 v_mfma_f32_16x16x32_bf16 v[196:199], v[20:23], a[140:143], v[196:199]
 ds_read_b64_tr_b16 v[42:43], v7 offset:37120
 v_cvt_pk_bf16_f32 v60, v76, v77
 v_cvt_pk_bf16_f32 v61, v78, v79
 v_mfma_f32_16x16x32_bf16 v[196:199], v[16:19], a[136:139], v[196:199]
 v_cvt_pk_bf16_f32 v62, v92, v93
 v_mfma_f32_16x16x32_bf16 v[200:203], v[16:19], a[144:147], v[200:203]
 ds_read_b64_tr_b16 v[44:45], v7 offset:38912
 v_cvt_pk_bf16_f32 v63, v94, v95
 s_add_u32 s5, s4, 4096
 v_mfma_f32_16x16x32_bf16 v[200:203], v[20:23], a[148:151], v[200:203]
 buffer_store_dwordx4 v[60:63], v13, s[84:87], s5 offen offset:128 sc1
 s_mul_i32 s4, s97, 10
 v_mfma_f32_16x16x32_bf16 v[204:207], v[20:23], a[156:159], v[204:207]
 ds_read_b64_tr_b16 v[46:47], v7 offset:39168
 s_add_i32 s4, s4, -218
 v_mfma_f32_16x16x32_bf16 v[204:207], v[16:19], a[152:155], v[204:207]
 s_waitcnt lgkmcnt(8)
 s_lshr_b32 s8, s4, 5
 s_and_b32 s4, s4, 31
 v_mfma_f32_16x16x32_bf16 v[208:211], v[24:27], a[128:131], v[208:211]
 ds_read_b64_tr_b16 v[16:17], v8 offset:32768
 s_lshl_b32 s4, s4, 18
 v_mfma_f32_16x16x32_bf16 v[208:211], v[28:31], a[132:135], v[208:211]
 s_cmp_eq_u32 s8, 0
 s_cselect_b32 s7, 0x3e3504f3, s100
 v_mfma_f32_16x16x32_bf16 v[212:215], v[28:31], a[140:143], v[212:215]
 ds_read_b64_tr_b16 v[18:19], v8 offset:33024
 s_cselect_b32 s8, 0, 0x800000
 s_add_u32 s4, s4, s8
 v_mfma_f32_16x16x32_bf16 v[212:215], v[24:27], a[136:139], v[212:215]
 v_mul_f32 v96, s7, v96
 v_mfma_f32_16x16x32_bf16 v[216:219], v[24:27], a[144:147], v[216:219]
 ds_read_b64_tr_b16 v[20:21], v8 offset:34816
 v_mul_f32 v97, s7, v97
 v_mul_f32 v98, s7, v98
 v_mfma_f32_16x16x32_bf16 v[216:219], v[28:31], a[148:151], v[216:219]
 v_mul_f32 v99, s7, v99
 v_mul_f32 v112, s7, v112
 v_mfma_f32_16x16x32_bf16 v[220:223], v[28:31], a[156:159], v[220:223]
 ds_read_b64_tr_b16 v[22:23], v8 offset:35072
 v_mul_f32 v113, s7, v113
 v_mfma_f32_16x16x32_bf16 v[220:223], v[24:27], a[152:155], v[220:223]
 s_waitcnt lgkmcnt(8)
 v_mul_f32 v114, s7, v114
 v_mul_f32 v115, s7, v115
 v_mfma_f32_16x16x32_bf16 v[224:227], v[32:35], a[128:131], v[224:227]
 ds_read_b64_tr_b16 v[24:25], v9 offset:32768
 v_cvt_pk_bf16_f32 v56, v96, v97
 v_mfma_f32_16x16x32_bf16 v[224:227], v[36:39], a[132:135], v[224:227]
 v_cvt_pk_bf16_f32 v57, v98, v99
 v_cvt_pk_bf16_f32 v58, v112, v113
 v_mfma_f32_16x16x32_bf16 v[228:231], v[36:39], a[140:143], v[228:231]
 ds_read_b64_tr_b16 v[26:27], v9 offset:33024
 v_cvt_pk_bf16_f32 v59, v114, v115
 s_add_u32 s5, s4, 0
 v_mfma_f32_16x16x32_bf16 v[228:231], v[32:35], a[136:139], v[228:231]
 buffer_store_dwordx4 v[56:59], v13, s[84:87], s5 offen offset:0 sc1
 v_mfma_f32_16x16x32_bf16 v[232:235], v[32:35], a[144:147], v[232:235]
 ds_read_b64_tr_b16 v[28:29], v9 offset:34816
 v_mul_f32 v100, s7, v100
 v_mul_f32 v101, s7, v101
 v_mfma_f32_16x16x32_bf16 v[232:235], v[36:39], a[148:151], v[232:235]
 v_mul_f32 v102, s7, v102
 v_mul_f32 v103, s7, v103
 v_mfma_f32_16x16x32_bf16 v[236:239], v[36:39], a[156:159], v[236:239]
 ds_read_b64_tr_b16 v[30:31], v9 offset:35072
 v_mul_f32 v116, s7, v116
 v_mfma_f32_16x16x32_bf16 v[236:239], v[32:35], a[152:155], v[236:239]
 s_waitcnt lgkmcnt(8)
 v_mul_f32 v117, s7, v117
 v_mul_f32 v118, s7, v118
 v_mfma_f32_16x16x32_bf16 v[240:243], v[40:43], a[128:131], v[240:243]
 ds_read_b64_tr_b16 v[32:33], v8 offset:36864
 v_mul_f32 v119, s7, v119
 v_mfma_f32_16x16x32_bf16 v[240:243], v[44:47], a[132:135], v[240:243]
 v_cvt_pk_bf16_f32 v60, v100, v101
 v_cvt_pk_bf16_f32 v61, v102, v103
 v_mfma_f32_16x16x32_bf16 v[244:247], v[44:47], a[140:143], v[244:247]
 ds_read_b64_tr_b16 v[34:35], v8 offset:37120
 v_cvt_pk_bf16_f32 v62, v116, v117
 v_cvt_pk_bf16_f32 v63, v118, v119
 v_mfma_f32_16x16x32_bf16 v[244:247], v[40:43], a[136:139], v[244:247]
 s_add_u32 s5, s4, 0
 v_mfma_f32_16x16x32_bf16 v[248:251], v[40:43], a[144:147], v[248:251]
 ds_read_b64_tr_b16 v[36:37], v8 offset:38912
 buffer_store_dwordx4 v[60:63], v13, s[84:87], s5 offen offset:128 sc1
 v_mul_f32 v104, s7, v104
 v_mfma_f32_16x16x32_bf16 v[248:251], v[44:47], a[148:151], v[248:251]
 v_mul_f32 v105, s7, v105
 v_mul_f32 v106, s7, v106
 v_mfma_f32_16x16x32_bf16 v[252:255], v[44:47], a[156:159], v[252:255]
 ds_read_b64_tr_b16 v[38:39], v8 offset:39168
 v_mul_f32 v107, s7, v107
 v_mfma_f32_16x16x32_bf16 v[252:255], v[40:43], a[152:155], v[252:255]
 s_waitcnt lgkmcnt(8)
 v_mul_f32 v120, s7, v120
 v_mul_f32 v121, s7, v121
 v_mfma_f32_16x16x32_bf16 v[192:195], v[16:19], a[160:163], v[192:195]
 ds_read_b64_tr_b16 v[40:41], v9 offset:36864
 v_mul_f32 v122, s7, v122
 v_mfma_f32_16x16x32_bf16 v[192:195], v[20:23], a[164:167], v[192:195]
 v_mul_f32 v123, s7, v123
 v_cvt_pk_bf16_f32 v56, v104, v105
 v_mfma_f32_16x16x32_bf16 v[196:199], v[20:23], a[172:175], v[196:199]
 ds_read_b64_tr_b16 v[42:43], v9 offset:37120
 v_cvt_pk_bf16_f32 v57, v106, v107
 v_cvt_pk_bf16_f32 v58, v120, v121
 v_mfma_f32_16x16x32_bf16 v[196:199], v[16:19], a[168:171], v[196:199]
 v_cvt_pk_bf16_f32 v59, v122, v123
 v_mfma_f32_16x16x32_bf16 v[200:203], v[16:19], a[176:179], v[200:203]
 ds_read_b64_tr_b16 v[44:45], v9 offset:38912
 s_add_u32 s5, s4, 4096
 buffer_store_dwordx4 v[56:59], v13, s[84:87], s5 offen offset:0 sc1
 v_mfma_f32_16x16x32_bf16 v[200:203], v[20:23], a[180:183], v[200:203]
 v_mul_f32 v108, s7, v108
 v_mul_f32 v109, s7, v109
 v_mfma_f32_16x16x32_bf16 v[204:207], v[20:23], a[188:191], v[204:207]
 ds_read_b64_tr_b16 v[46:47], v9 offset:39168
 v_mul_f32 v110, s7, v110
 v_mfma_f32_16x16x32_bf16 v[204:207], v[16:19], a[184:187], v[204:207]
 s_waitcnt lgkmcnt(8)
 v_mul_f32 v111, s7, v111
 v_mul_f32 v124, s7, v124
 v_mfma_f32_16x16x32_bf16 v[208:211], v[24:27], a[160:163], v[208:211]
 ds_read_b64_tr_b16 v[16:17], v10 offset:32768
 v_mul_f32 v125, s7, v125
 v_mfma_f32_16x16x32_bf16 v[208:211], v[28:31], a[164:167], v[208:211]
 v_mul_f32 v126, s7, v126
 v_mul_f32 v127, s7, v127
 v_mfma_f32_16x16x32_bf16 v[212:215], v[28:31], a[172:175], v[212:215]
 ds_read_b64_tr_b16 v[18:19], v10 offset:33024
 v_cvt_pk_bf16_f32 v60, v108, v109
 v_cvt_pk_bf16_f32 v61, v110, v111
 v_mfma_f32_16x16x32_bf16 v[212:215], v[24:27], a[168:171], v[212:215]
 v_cvt_pk_bf16_f32 v62, v124, v125
 v_mfma_f32_16x16x32_bf16 v[216:219], v[24:27], a[176:179], v[216:219]
 ds_read_b64_tr_b16 v[20:21], v10 offset:34816
 v_cvt_pk_bf16_f32 v63, v126, v127
 s_add_u32 s5, s4, 4096
 v_mfma_f32_16x16x32_bf16 v[216:219], v[28:31], a[180:183], v[216:219]
 buffer_store_dwordx4 v[60:63], v13, s[84:87], s5 offen offset:128 sc1
 s_mul_i32 s4, s97, 10
 v_mfma_f32_16x16x32_bf16 v[220:223], v[28:31], a[188:191], v[220:223]
 ds_read_b64_tr_b16 v[22:23], v10 offset:35072
 s_add_i32 s4, s4, -219
 v_mfma_f32_16x16x32_bf16 v[220:223], v[24:27], a[184:187], v[220:223]
 s_waitcnt lgkmcnt(8)
 s_lshr_b32 s8, s4, 5
 s_and_b32 s4, s4, 31
 v_mfma_f32_16x16x32_bf16 v[224:227], v[32:35], a[160:163], v[224:227]
 ds_read_b64_tr_b16 v[24:25], v11 offset:32768
 s_lshl_b32 s4, s4, 18
 v_mfma_f32_16x16x32_bf16 v[224:227], v[36:39], a[164:167], v[224:227]
 s_cmp_eq_u32 s8, 0
 s_cselect_b32 s7, 0x3e3504f3, s100
 v_mfma_f32_16x16x32_bf16 v[228:231], v[36:39], a[172:175], v[228:231]
 ds_read_b64_tr_b16 v[26:27], v11 offset:33024
 s_cselect_b32 s8, 0, 0x800000
 s_add_u32 s4, s4, s8
 v_mfma_f32_16x16x32_bf16 v[228:231], v[32:35], a[168:171], v[228:231]
 v_mul_f32 v128, s7, v128
 v_mfma_f32_16x16x32_bf16 v[232:235], v[32:35], a[176:179], v[232:235]
 ds_read_b64_tr_b16 v[28:29], v11 offset:34816
 v_mul_f32 v129, s7, v129
 v_mul_f32 v130, s7, v130
 v_mfma_f32_16x16x32_bf16 v[232:235], v[36:39], a[180:183], v[232:235]
 v_mul_f32 v131, s7, v131
 v_mul_f32 v144, s7, v144
 v_mfma_f32_16x16x32_bf16 v[236:239], v[36:39], a[188:191], v[236:239]
 ds_read_b64_tr_b16 v[30:31], v11 offset:35072
 v_mul_f32 v145, s7, v145
 v_mfma_f32_16x16x32_bf16 v[236:239], v[32:35], a[184:187], v[236:239]
 s_waitcnt lgkmcnt(8)
 v_mul_f32 v146, s7, v146
 v_mul_f32 v147, s7, v147
 v_mfma_f32_16x16x32_bf16 v[240:243], v[40:43], a[160:163], v[240:243]
 ds_read_b64_tr_b16 v[32:33], v10 offset:36864
 v_cvt_pk_bf16_f32 v56, v128, v129
 v_mfma_f32_16x16x32_bf16 v[240:243], v[44:47], a[164:167], v[240:243]
 v_cvt_pk_bf16_f32 v57, v130, v131
 v_cvt_pk_bf16_f32 v58, v144, v145
 v_mfma_f32_16x16x32_bf16 v[244:247], v[44:47], a[172:175], v[244:247]
 ds_read_b64_tr_b16 v[34:35], v10 offset:37120
 v_cvt_pk_bf16_f32 v59, v146, v147
 s_add_u32 s5, s4, 0
 v_mfma_f32_16x16x32_bf16 v[244:247], v[40:43], a[168:171], v[244:247]
 buffer_store_dwordx4 v[56:59], v13, s[84:87], s5 offen offset:0 sc1
 v_mfma_f32_16x16x32_bf16 v[248:251], v[40:43], a[176:179], v[248:251]
 ds_read_b64_tr_b16 v[36:37], v10 offset:38912
 v_mul_f32 v132, s7, v132
 v_mul_f32 v133, s7, v133
 v_mfma_f32_16x16x32_bf16 v[248:251], v[44:47], a[180:183], v[248:251]
 v_mul_f32 v134, s7, v134
 v_mul_f32 v135, s7, v135
 v_mfma_f32_16x16x32_bf16 v[252:255], v[44:47], a[188:191], v[252:255]
 ds_read_b64_tr_b16 v[38:39], v10 offset:39168
 v_mul_f32 v148, s7, v148
 v_mfma_f32_16x16x32_bf16 v[252:255], v[40:43], a[184:187], v[252:255]
 s_waitcnt lgkmcnt(8)
 v_mul_f32 v149, s7, v149
 v_mul_f32 v150, s7, v150
 v_mfma_f32_16x16x32_bf16 v[192:195], v[16:19], a[192:195], v[192:195]
 ds_read_b64_tr_b16 v[40:41], v11 offset:36864
 v_mul_f32 v151, s7, v151
 v_mfma_f32_16x16x32_bf16 v[192:195], v[20:23], a[196:199], v[192:195]
 v_cvt_pk_bf16_f32 v60, v132, v133
 v_cvt_pk_bf16_f32 v61, v134, v135
 v_mfma_f32_16x16x32_bf16 v[196:199], v[20:23], a[204:207], v[196:199]
 ds_read_b64_tr_b16 v[42:43], v11 offset:37120
 v_cvt_pk_bf16_f32 v62, v148, v149
 v_cvt_pk_bf16_f32 v63, v150, v151
 v_mfma_f32_16x16x32_bf16 v[196:199], v[16:19], a[200:203], v[196:199]
 s_add_u32 s5, s4, 0
 v_mfma_f32_16x16x32_bf16 v[200:203], v[16:19], a[208:211], v[200:203]
 ds_read_b64_tr_b16 v[44:45], v11 offset:38912
 buffer_store_dwordx4 v[60:63], v13, s[84:87], s5 offen offset:128 sc1
 v_mul_f32 v136, s7, v136
 v_mfma_f32_16x16x32_bf16 v[200:203], v[20:23], a[212:215], v[200:203]
 v_mul_f32 v137, s7, v137
 v_mul_f32 v138, s7, v138
 v_mfma_f32_16x16x32_bf16 v[204:207], v[20:23], a[220:223], v[204:207]
 ds_read_b64_tr_b16 v[46:47], v11 offset:39168
 v_mul_f32 v139, s7, v139
 v_mfma_f32_16x16x32_bf16 v[204:207], v[16:19], a[216:219], v[204:207]
 s_waitcnt lgkmcnt(8)
 v_mul_f32 v152, s7, v152
 v_mul_f32 v153, s7, v153
 v_mfma_f32_16x16x32_bf16 v[208:211], v[24:27], a[192:195], v[208:211]
 ds_read_b64_tr_b16 v[16:17], v4 offset:32768
 v_mul_f32 v154, s7, v154
 v_mfma_f32_16x16x32_bf16 v[208:211], v[28:31], a[196:199], v[208:211]
 v_mul_f32 v155, s7, v155
 v_cvt_pk_bf16_f32 v56, v136, v137
 v_mfma_f32_16x16x32_bf16 v[212:215], v[28:31], a[204:207], v[212:215]
 ds_read_b64_tr_b16 v[18:19], v4 offset:33024
 v_cvt_pk_bf16_f32 v57, v138, v139
 v_cvt_pk_bf16_f32 v58, v152, v153
 v_mfma_f32_16x16x32_bf16 v[212:215], v[24:27], a[200:203], v[212:215]
 v_cvt_pk_bf16_f32 v59, v154, v155
 v_mfma_f32_16x16x32_bf16 v[216:219], v[24:27], a[208:211], v[216:219]
 ds_read_b64_tr_b16 v[20:21], v4 offset:34816
 s_add_u32 s5, s4, 4096
 buffer_store_dwordx4 v[56:59], v13, s[84:87], s5 offen offset:0 sc1
 v_mfma_f32_16x16x32_bf16 v[216:219], v[28:31], a[212:215], v[216:219]
 v_mul_f32 v140, s7, v140
 v_mul_f32 v141, s7, v141
 v_mfma_f32_16x16x32_bf16 v[220:223], v[28:31], a[220:223], v[220:223]
 ds_read_b64_tr_b16 v[22:23], v4 offset:35072
 v_mul_f32 v142, s7, v142
 v_mfma_f32_16x16x32_bf16 v[220:223], v[24:27], a[216:219], v[220:223]
 s_waitcnt lgkmcnt(8)
 v_mul_f32 v143, s7, v143
 v_mul_f32 v156, s7, v156
 v_mfma_f32_16x16x32_bf16 v[224:227], v[32:35], a[192:195], v[224:227]
 ds_read_b64_tr_b16 v[24:25], v5 offset:32768
 v_mul_f32 v157, s7, v157
 v_mfma_f32_16x16x32_bf16 v[224:227], v[36:39], a[196:199], v[224:227]
 v_mul_f32 v158, s7, v158
 v_mul_f32 v159, s7, v159
 v_mfma_f32_16x16x32_bf16 v[228:231], v[36:39], a[204:207], v[228:231]
 ds_read_b64_tr_b16 v[26:27], v5 offset:33024
 v_cvt_pk_bf16_f32 v60, v140, v141
 v_cvt_pk_bf16_f32 v61, v142, v143
 v_mfma_f32_16x16x32_bf16 v[228:231], v[32:35], a[200:203], v[228:231]
 v_cvt_pk_bf16_f32 v62, v156, v157
 v_mfma_f32_16x16x32_bf16 v[232:235], v[32:35], a[208:211], v[232:235]
 ds_read_b64_tr_b16 v[28:29], v5 offset:34816
 v_cvt_pk_bf16_f32 v63, v158, v159
 s_add_u32 s5, s4, 4096
 v_mfma_f32_16x16x32_bf16 v[232:235], v[36:39], a[212:215], v[232:235]
 buffer_store_dwordx4 v[60:63], v13, s[84:87], s5 offen offset:128 sc1
 s_mul_i32 s4, s97, 10
 v_mfma_f32_16x16x32_bf16 v[236:239], v[36:39], a[220:223], v[236:239]
 ds_read_b64_tr_b16 v[30:31], v5 offset:35072
 s_add_i32 s4, s4, -217
 v_mfma_f32_16x16x32_bf16 v[236:239], v[32:35], a[216:219], v[236:239]
 s_waitcnt lgkmcnt(8)
 s_lshr_b32 s8, s4, 5
 s_and_b32 s4, s4, 31
 v_mfma_f32_16x16x32_bf16 v[240:243], v[40:43], a[192:195], v[240:243]
 ds_read_b64_tr_b16 v[32:33], v4 offset:36864
 s_lshl_b32 s4, s4, 18
 v_mfma_f32_16x16x32_bf16 v[240:243], v[44:47], a[196:199], v[240:243]
 s_cmp_eq_u32 s8, 0
 s_cselect_b32 s7, 0x3e3504f3, s100
 v_mfma_f32_16x16x32_bf16 v[244:247], v[44:47], a[204:207], v[244:247]
 ds_read_b64_tr_b16 v[34:35], v4 offset:37120
 s_cselect_b32 s8, 0, 0x800000
 s_add_u32 s4, s4, s8
 v_mfma_f32_16x16x32_bf16 v[244:247], v[40:43], a[200:203], v[244:247]
 v_mul_f32 v160, s7, v160
 v_mfma_f32_16x16x32_bf16 v[248:251], v[40:43], a[208:211], v[248:251]
 ds_read_b64_tr_b16 v[36:37], v4 offset:38912
 v_mul_f32 v161, s7, v161
 v_mul_f32 v162, s7, v162
 v_mfma_f32_16x16x32_bf16 v[248:251], v[44:47], a[212:215], v[248:251]
 v_mul_f32 v163, s7, v163
 v_mul_f32 v176, s7, v176
 v_mfma_f32_16x16x32_bf16 v[252:255], v[44:47], a[220:223], v[252:255]
 ds_read_b64_tr_b16 v[38:39], v4 offset:39168
 v_mul_f32 v177, s7, v177
 v_mfma_f32_16x16x32_bf16 v[252:255], v[40:43], a[216:219], v[252:255]
 s_waitcnt lgkmcnt(8)
 v_mul_f32 v178, s7, v178
 v_mul_f32 v179, s7, v179
 v_mfma_f32_16x16x32_bf16 v[192:195], v[16:19], a[224:227], v[192:195]
 ds_read_b64_tr_b16 v[40:41], v5 offset:36864
 v_cvt_pk_bf16_f32 v56, v160, v161
 v_mfma_f32_16x16x32_bf16 v[192:195], v[20:23], a[228:231], v[192:195]
 v_cvt_pk_bf16_f32 v57, v162, v163
 v_cvt_pk_bf16_f32 v58, v176, v177
 v_mfma_f32_16x16x32_bf16 v[196:199], v[20:23], a[236:239], v[196:199]
 ds_read_b64_tr_b16 v[42:43], v5 offset:37120
 v_cvt_pk_bf16_f32 v59, v178, v179
 s_add_u32 s5, s4, 0
 v_mfma_f32_16x16x32_bf16 v[196:199], v[16:19], a[232:235], v[196:199]
 buffer_store_dwordx4 v[56:59], v13, s[84:87], s5 offen offset:0 sc1
 v_mfma_f32_16x16x32_bf16 v[200:203], v[16:19], a[240:243], v[200:203]
 ds_read_b64_tr_b16 v[44:45], v5 offset:38912
 v_mul_f32 v164, s7, v164
 v_mul_f32 v165, s7, v165
 v_mfma_f32_16x16x32_bf16 v[200:203], v[20:23], a[244:247], v[200:203]
 v_mul_f32 v166, s7, v166
 v_mul_f32 v167, s7, v167
 v_mfma_f32_16x16x32_bf16 v[204:207], v[20:23], a[252:255], v[204:207]
 ds_read_b64_tr_b16 v[46:47], v5 offset:39168
 v_mul_f32 v180, s7, v180
 v_mfma_f32_16x16x32_bf16 v[204:207], v[16:19], a[248:251], v[204:207]
 s_waitcnt lgkmcnt(8)
 v_mul_f32 v181, s7, v181
 v_mul_f32 v182, s7, v182
 v_mfma_f32_16x16x32_bf16 v[208:211], v[24:27], a[224:227], v[208:211]
 v_mul_f32 v183, s7, v183
 v_mfma_f32_16x16x32_bf16 v[208:211], v[28:31], a[228:231], v[208:211]
 v_cvt_pk_bf16_f32 v60, v164, v165
 v_cvt_pk_bf16_f32 v61, v166, v167
 v_mfma_f32_16x16x32_bf16 v[212:215], v[28:31], a[236:239], v[212:215]
 v_cvt_pk_bf16_f32 v62, v180, v181
 v_cvt_pk_bf16_f32 v63, v182, v183
 v_mfma_f32_16x16x32_bf16 v[212:215], v[24:27], a[232:235], v[212:215]
 s_add_u32 s5, s4, 0
 v_mfma_f32_16x16x32_bf16 v[216:219], v[24:27], a[240:243], v[216:219]
 buffer_store_dwordx4 v[60:63], v13, s[84:87], s5 offen offset:128 sc1
 v_mul_f32 v168, s7, v168
 v_mfma_f32_16x16x32_bf16 v[216:219], v[28:31], a[244:247], v[216:219]
 v_mul_f32 v169, s7, v169
 v_mul_f32 v170, s7, v170
 v_mfma_f32_16x16x32_bf16 v[220:223], v[28:31], a[252:255], v[220:223]
 v_mul_f32 v171, s7, v171
 v_mfma_f32_16x16x32_bf16 v[220:223], v[24:27], a[248:251], v[220:223]
 s_waitcnt lgkmcnt(4)
 v_mul_f32 v184, s7, v184
 v_mul_f32 v185, s7, v185
 v_mfma_f32_16x16x32_bf16 v[224:227], v[32:35], a[224:227], v[224:227]
 v_mul_f32 v186, s7, v186
 v_mfma_f32_16x16x32_bf16 v[224:227], v[36:39], a[228:231], v[224:227]
 v_mul_f32 v187, s7, v187
 v_cvt_pk_bf16_f32 v56, v168, v169
 v_mfma_f32_16x16x32_bf16 v[228:231], v[36:39], a[236:239], v[228:231]
 v_cvt_pk_bf16_f32 v57, v170, v171
 v_cvt_pk_bf16_f32 v58, v184, v185
 v_mfma_f32_16x16x32_bf16 v[228:231], v[32:35], a[232:235], v[228:231]
 v_cvt_pk_bf16_f32 v59, v186, v187
 v_mfma_f32_16x16x32_bf16 v[232:235], v[32:35], a[240:243], v[232:235]
 s_add_u32 s5, s4, 4096
 buffer_store_dwordx4 v[56:59], v13, s[84:87], s5 offen offset:0 sc1
 v_mfma_f32_16x16x32_bf16 v[232:235], v[36:39], a[244:247], v[232:235]
 v_mul_f32 v172, s7, v172
 v_mul_f32 v173, s7, v173
 v_mfma_f32_16x16x32_bf16 v[236:239], v[36:39], a[252:255], v[236:239]
 v_mul_f32 v174, s7, v174
 v_mfma_f32_16x16x32_bf16 v[236:239], v[32:35], a[248:251], v[236:239]
 s_waitcnt lgkmcnt(0)
 v_mul_f32 v175, s7, v175
 v_mul_f32 v188, s7, v188
 v_mfma_f32_16x16x32_bf16 v[240:243], v[40:43], a[224:227], v[240:243]
 v_mul_f32 v189, s7, v189
 v_mfma_f32_16x16x32_bf16 v[240:243], v[44:47], a[228:231], v[240:243]
 v_mul_f32 v190, s7, v190
 v_mul_f32 v191, s7, v191
 v_mfma_f32_16x16x32_bf16 v[244:247], v[44:47], a[236:239], v[244:247]
 v_cvt_pk_bf16_f32 v60, v172, v173
 v_cvt_pk_bf16_f32 v61, v174, v175
 v_mfma_f32_16x16x32_bf16 v[244:247], v[40:43], a[232:235], v[244:247]
 v_cvt_pk_bf16_f32 v62, v188, v189
 v_mfma_f32_16x16x32_bf16 v[248:251], v[40:43], a[240:243], v[248:251]
 v_cvt_pk_bf16_f32 v63, v190, v191
 s_add_u32 s5, s4, 4096
 v_mfma_f32_16x16x32_bf16 v[248:251], v[44:47], a[244:247], v[248:251]
 buffer_store_dwordx4 v[60:63], v13, s[84:87], s5 offen offset:128 sc1
 v_mfma_f32_16x16x32_bf16 v[252:255], v[44:47], a[252:255], v[252:255]
 v_mfma_f32_16x16x32_bf16 v[252:255], v[40:43], a[248:251], v[252:255]
 s_nop 7
 s_mul_i32 s4, s97, 10
 s_add_i32 s4, s4, -216
 s_lshr_b32 s8, s4, 5
 s_and_b32 s4, s4, 31
 s_lshl_b32 s4, s4, 18
 s_cmp_eq_u32 s8, 0
 s_cselect_b32 s7, 0x3e3504f3, s100
 s_cselect_b32 s8, 0, 0x800000
 s_add_u32 s4, s4, s8
 v_mul_f32 v192, s7, v192
 v_mul_f32 v193, s7, v193
 v_mul_f32 v194, s7, v194
 v_mul_f32 v195, s7, v195
 v_mul_f32 v208, s7, v208
 v_mul_f32 v209, s7, v209
 v_mul_f32 v210, s7, v210
 v_mul_f32 v211, s7, v211
 v_cvt_pk_bf16_f32 v56, v192, v193
 v_cvt_pk_bf16_f32 v57, v194, v195
 v_cvt_pk_bf16_f32 v58, v208, v209
 v_cvt_pk_bf16_f32 v59, v210, v211
 s_add_u32 s5, s4, 0
 buffer_store_dwordx4 v[56:59], v13, s[84:87], s5 offen offset:0 sc1
 v_mul_f32 v196, s7, v196
 v_mul_f32 v197, s7, v197
 v_mul_f32 v198, s7, v198
 v_mul_f32 v199, s7, v199
 v_mul_f32 v212, s7, v212
 v_mul_f32 v213, s7, v213
 v_mul_f32 v214, s7, v214
 v_mul_f32 v215, s7, v215
 v_cvt_pk_bf16_f32 v60, v196, v197
 v_cvt_pk_bf16_f32 v61, v198, v199
 v_cvt_pk_bf16_f32 v62, v212, v213
 v_cvt_pk_bf16_f32 v63, v214, v215
 s_add_u32 s5, s4, 0
 buffer_store_dwordx4 v[60:63], v13, s[84:87], s5 offen offset:128 sc1
 v_mul_f32 v200, s7, v200
 v_mul_f32 v201, s7, v201
 v_mul_f32 v202, s7, v202
 v_mul_f32 v203, s7, v203
 v_mul_f32 v216, s7, v216
 v_mul_f32 v217, s7, v217
 v_mul_f32 v218, s7, v218
 v_mul_f32 v219, s7, v219
 v_cvt_pk_bf16_f32 v56, v200, v201
 v_cvt_pk_bf16_f32 v57, v202, v203
 v_cvt_pk_bf16_f32 v58, v216, v217
 v_cvt_pk_bf16_f32 v59, v218, v219
 s_add_u32 s5, s4, 4096
 buffer_store_dwordx4 v[56:59], v13, s[84:87], s5 offen offset:0 sc1
 v_mul_f32 v204, s7, v204
 v_mul_f32 v205, s7, v205
 v_mul_f32 v206, s7, v206
 v_mul_f32 v207, s7, v207
 v_mul_f32 v220, s7, v220
 v_mul_f32 v221, s7, v221
 v_mul_f32 v222, s7, v222
 v_mul_f32 v223, s7, v223
 v_cvt_pk_bf16_f32 v60, v204, v205
 v_cvt_pk_bf16_f32 v61, v206, v207
 v_cvt_pk_bf16_f32 v62, v220, v221
 v_cvt_pk_bf16_f32 v63, v222, v223
 s_add_u32 s5, s4, 4096
 buffer_store_dwordx4 v[60:63], v13, s[84:87], s5 offen offset:128 sc1
 s_mul_i32 s4, s97, 10
 s_add_i32 s4, s4, -215
 s_lshr_b32 s8, s4, 5
 s_and_b32 s4, s4, 31
 s_lshl_b32 s4, s4, 18
 s_cmp_eq_u32 s8, 0
 s_cselect_b32 s7, 0x3e3504f3, s100
 s_cselect_b32 s8, 0, 0x800000
 s_add_u32 s4, s4, s8
 v_mul_f32 v224, s7, v224
 v_mul_f32 v225, s7, v225
 v_mul_f32 v226, s7, v226
 v_mul_f32 v227, s7, v227
 v_mul_f32 v240, s7, v240
 v_mul_f32 v241, s7, v241
 v_mul_f32 v242, s7, v242
 v_mul_f32 v243, s7, v243
 v_cvt_pk_bf16_f32 v56, v224, v225
 v_cvt_pk_bf16_f32 v57, v226, v227
 v_cvt_pk_bf16_f32 v58, v240, v241
 v_cvt_pk_bf16_f32 v59, v242, v243
 s_add_u32 s5, s4, 0
 buffer_store_dwordx4 v[56:59], v13, s[84:87], s5 offen offset:0 sc1
 v_mul_f32 v228, s7, v228
 v_mul_f32 v229, s7, v229
 v_mul_f32 v230, s7, v230
 v_mul_f32 v231, s7, v231
 v_mul_f32 v244, s7, v244
 v_mul_f32 v245, s7, v245
 v_mul_f32 v246, s7, v246
 v_mul_f32 v247, s7, v247
 v_cvt_pk_bf16_f32 v60, v228, v229
 v_cvt_pk_bf16_f32 v61, v230, v231
 v_cvt_pk_bf16_f32 v62, v244, v245
 v_cvt_pk_bf16_f32 v63, v246, v247
 s_add_u32 s5, s4, 0
 buffer_store_dwordx4 v[60:63], v13, s[84:87], s5 offen offset:128 sc1
 v_mul_f32 v232, s7, v232
 v_mul_f32 v233, s7, v233
 v_mul_f32 v234, s7, v234
 v_mul_f32 v235, s7, v235
 v_mul_f32 v248, s7, v248
 v_mul_f32 v249, s7, v249
 v_mul_f32 v250, s7, v250
 v_mul_f32 v251, s7, v251
 v_cvt_pk_bf16_f32 v56, v232, v233
 v_cvt_pk_bf16_f32 v57, v234, v235
 v_cvt_pk_bf16_f32 v58, v248, v249
 v_cvt_pk_bf16_f32 v59, v250, v251
 s_add_u32 s5, s4, 4096
 buffer_store_dwordx4 v[56:59], v13, s[84:87], s5 offen offset:0 sc1
 v_mul_f32 v236, s7, v236
 v_mul_f32 v237, s7, v237
 v_mul_f32 v238, s7, v238
 v_mul_f32 v239, s7, v239
 v_mul_f32 v252, s7, v252
 v_mul_f32 v253, s7, v253
 v_mul_f32 v254, s7, v254
 v_mul_f32 v255, s7, v255
 v_cvt_pk_bf16_f32 v60, v236, v237
 v_cvt_pk_bf16_f32 v61, v238, v239
 v_cvt_pk_bf16_f32 v62, v252, v253
 v_cvt_pk_bf16_f32 v63, v254, v255
 s_add_u32 s5, s4, 4096
 buffer_store_dwordx4 v[60:63], v13, s[84:87], s5 offen offset:128 sc1
 s_endpgm
L_g1_Q_fin:
L_g1_varB:
.p2align 6
 s_waitcnt lgkmcnt(8)
 v_mfma_f32_16x16x32_bf16 a[0:3], v[16:19], a[128:131], a[0:3]
 ds_read_b64_tr_b16 v[40:41], v7 offset:4096
 v_mfma_f32_16x16x32_bf16 a[0:3], v[20:23], a[132:135], a[0:3]
 s_add_u32 m0, s94, 28672
 v_mfma_f32_16x16x32_bf16 a[4:7], v[20:23], a[140:143], a[4:7]
 ds_read_b64_tr_b16 v[42:43], v7 offset:4352
 v_mfma_f32_16x16x32_bf16 a[4:7], v[16:19], a[136:139], a[4:7]
 buffer_load_dwordx4 v3, s[68:71], s89 offen lds
 v_mfma_f32_16x16x32_bf16 a[8:11], v[16:19], a[144:147], a[8:11]
 ds_read_b64_tr_b16 v[44:45], v7 offset:6144
 v_mfma_f32_16x16x32_bf16 a[8:11], v[20:23], a[148:151], a[8:11]
 s_add_u32 m0, s94, 32768
 v_mfma_f32_16x16x32_bf16 a[12:15], v[20:23], a[156:159], a[12:15]
 ds_read_b64_tr_b16 v[46:47], v7 offset:6400
 v_mfma_f32_16x16x32_bf16 a[12:15], v[16:19], a[152:155], a[12:15]
 s_waitcnt lgkmcnt(8)
 buffer_load_dwordx4 v3, s[72:75], s89 offen lds
 v_mfma_f32_16x16x32_bf16 a[16:19], v[24:27], a[128:131], a[16:19]
 ds_read_b64_tr_b16 v[16:17], v6 offset:8192
 v_mfma_f32_16x16x32_bf16 a[16:19], v[28:31], a[132:135], a[16:19]
 s_add_u32 m0, s94, 36864
 v_mfma_f32_16x16x32_bf16 a[20:23], v[28:31], a[140:143], a[20:23]
 ds_read_b64_tr_b16 v[18:19], v6 offset:8448
 v_mfma_f32_16x16x32_bf16 a[20:23], v[24:27], a[136:139], a[20:23]
 buffer_load_dwordx4 v3, s[76:79], s89 offen lds
 v_mfma_f32_16x16x32_bf16 a[24:27], v[24:27], a[144:147], a[24:27]
 ds_read_b64_tr_b16 v[20:21], v6 offset:10240
 v_mfma_f32_16x16x32_bf16 a[24:27], v[28:31], a[148:151], a[24:27]
 s_add_u32 s9, s9, 1
 s_cmp_lt_u32 s9, 4
 s_cselect_b32 s3, 1, 3
 s_add_u32 s100, s9, s11
 s_and_b32 s100, s100, s3
 s_andn2_b32 s3, s9, s3
 s_or_b32 s100, s100, s3
 s_mul_i32 s88, s100, s90
 s_mul_i32 s89, s100, s91
 s_add_u32 s94, s94, 40960
 s_cmp_ge_u32 s94, s99
 s_cselect_b32 s3, 163840, 0
 s_sub_u32 s94, s94, s3
 buffer_load_dwordx4 a[160:163], v8, s[84:87], s92 offen offset:0 sc1
 v_mfma_f32_16x16x32_bf16 a[28:31], v[28:31], a[156:159], a[28:31]
 ds_read_b64_tr_b16 v[22:23], v6 offset:10496
 v_mfma_f32_16x16x32_bf16 a[28:31], v[24:27], a[152:155], a[28:31]
 s_waitcnt lgkmcnt(8)
 v_mfma_f32_16x16x32_bf16 a[32:35], v[32:35], a[128:131], a[32:35]
 ds_read_b64_tr_b16 v[24:25], v7 offset:8192
 v_mfma_f32_16x16x32_bf16 a[32:35], v[36:39], a[132:135], a[32:35]
 buffer_load_dwordx4 a[164:167], v8, s[84:87], s92 offen offset:1024 sc1
 v_mfma_f32_16x16x32_bf16 a[36:39], v[36:39], a[140:143], a[36:39]
 ds_read_b64_tr_b16 v[26:27], v7 offset:8448
 v_mfma_f32_16x16x32_bf16 a[36:39], v[32:35], a[136:139], a[36:39]
 v_mfma_f32_16x16x32_bf16 a[40:43], v[32:35], a[144:147], a[40:43]
 ds_read_b64_tr_b16 v[28:29], v7 offset:10240
 v_mfma_f32_16x16x32_bf16 a[40:43], v[36:39], a[148:151], a[40:43]
 buffer_load_dwordx4 a[168:171], v9, s[84:87], s92 offen offset:0 sc1
 v_mfma_f32_16x16x32_bf16 a[44:47], v[36:39], a[156:159], a[44:47]
 ds_read_b64_tr_b16 v[30:31], v7 offset:10496
 v_mfma_f32_16x16x32_bf16 a[44:47], v[32:35], a[152:155], a[44:47]
 s_waitcnt lgkmcnt(8)
 v_mfma_f32_16x16x32_bf16 a[48:51], v[40:43], a[128:131], a[48:51]
 ds_read_b64_tr_b16 v[32:33], v6 offset:12288
 v_mfma_f32_16x16x32_bf16 a[48:51], v[44:47], a[132:135], a[48:51]
 buffer_load_dwordx4 a[172:175], v9, s[84:87], s92 offen offset:1024 sc1
 v_mfma_f32_16x16x32_bf16 a[52:55], v[44:47], a[140:143], a[52:55]
 ds_read_b64_tr_b16 v[34:35], v6 offset:12544
 v_mfma_f32_16x16x32_bf16 a[52:55], v[40:43], a[136:139], a[52:55]
 v_mfma_f32_16x16x32_bf16 a[56:59], v[40:43], a[144:147], a[56:59]
 ds_read_b64_tr_b16 v[36:37], v6 offset:14336
 v_mfma_f32_16x16x32_bf16 a[56:59], v[44:47], a[148:151], a[56:59]
 buffer_load_dwordx4 a[176:179], v10, s[84:87], s92 offen offset:0 sc1
 v_mfma_f32_16x16x32_bf16 a[60:63], v[44:47], a[156:159], a[60:63]
 ds_read_b64_tr_b16 v[38:39], v6 offset:14592
 v_mfma_f32_16x16x32_bf16 a[60:63], v[40:43], a[152:155], a[60:63]
 s_waitcnt lgkmcnt(8)
 v_mfma_f32_16x16x32_bf16 a[64:67], v[16:19], a[128:131], a[64:67]
 ds_read_b64_tr_b16 v[40:41], v7 offset:12288
 v_mfma_f32_16x16x32_bf16 a[64:67], v[20:23], a[132:135], a[64:67]
 buffer_load_dwordx4 a[180:183], v10, s[84:87], s92 offen offset:1024 sc1
 v_mfma_f32_16x16x32_bf16 a[68:71], v[20:23], a[140:143], a[68:71]
 ds_read_b64_tr_b16 v[42:43], v7 offset:12544
 v_mfma_f32_16x16x32_bf16 a[68:71], v[16:19], a[136:139], a[68:71]
 v_mfma_f32_16x16x32_bf16 a[72:75], v[16:19], a[144:147], a[72:75]
 ds_read_b64_tr_b16 v[44:45], v7 offset:14336
 v_mfma_f32_16x16x32_bf16 a[72:75], v[20:23], a[148:151], a[72:75]
 buffer_load_dwordx4 a[184:187], v11, s[84:87], s92 offen offset:0 sc1
 v_mfma_f32_16x16x32_bf16 a[76:79], v[20:23], a[156:159], a[76:79]
 ds_read_b64_tr_b16 v[46:47], v7 offset:14592
 v_mfma_f32_16x16x32_bf16 a[76:79], v[16:19], a[152:155], a[76:79]
 s_waitcnt lgkmcnt(8)
 v_mfma_f32_16x16x32_bf16 a[80:83], v[24:27], a[128:131], a[80:83]
 ds_read_b64_tr_b16 v[16:17], v6 offset:16384
 v_mfma_f32_16x16x32_bf16 a[80:83], v[28:31], a[132:135], a[80:83]
 buffer_load_dwordx4 a[188:191], v11, s[84:87], s92 offen offset:1024 sc1
 v_mfma_f32_16x16x32_bf16 a[84:87], v[28:31], a[140:143], a[84:87]
 ds_read_b64_tr_b16 v[18:19], v6 offset:16640
 s_add_u32 s10, s10, 1
 s_cmp_lt_u32 s10, 4
 s_cselect_b32 s3, 1, 3
 s_add_u32 s92, s10, s11
 s_and_b32 s92, s92, s3
 s_andn2_b32 s3, s10, s3
 s_or_b32 s92, s92, s3
 s_lshl_b32 s92, s92, 11
 v_mfma_f32_16x16x32_bf16 a[84:87], v[24:27], a[136:139], a[84:87]
 s_add_u32 m0, s94, 0
 v_mfma_f32_16x16x32_bf16 a[88:91], v[24:27], a[144:147], a[88:91]
 ds_read_b64_tr_b16 v[20:21], v6 offset:18432
 v_mfma_f32_16x16x32_bf16 a[88:91], v[28:31], a[148:151], a[88:91]
 buffer_load_dwordx4 v2, s[40:43], s88 offen lds
 v_mfma_f32_16x16x32_bf16 a[92:95], v[28:31], a[156:159], a[92:95]
 ds_read_b64_tr_b16 v[22:23], v6 offset:18688
 v_mfma_f32_16x16x32_bf16 a[92:95], v[24:27], a[152:155], a[92:95]
 s_waitcnt lgkmcnt(8)
 s_add_u32 m0, s94, 8192
 v_mfma_f32_16x16x32_bf16 a[96:99], v[32:35], a[128:131], a[96:99]
 ds_read_b64_tr_b16 v[24:25], v7 offset:16384
 v_mfma_f32_16x16x32_bf16 a[96:99], v[36:39], a[132:135], a[96:99]
 buffer_load_dwordx4 v2, s[48:51], s88 offen lds
 v_mfma_f32_16x16x32_bf16 a[100:103], v[36:39], a[140:143], a[100:103]
 ds_read_b64_tr_b16 v[26:27], v7 offset:16640
 v_mfma_f32_16x16x32_bf16 a[100:103], v[32:35], a[136:139], a[100:103]
 s_add_u32 m0, s94, 4096
 v_mfma_f32_16x16x32_bf16 a[104:107], v[32:35], a[144:147], a[104:107]
 ds_read_b64_tr_b16 v[28:29], v7 offset:18432
 v_mfma_f32_16x16x32_bf16 a[104:107], v[36:39], a[148:151], a[104:107]
 buffer_load_dwordx4 v2, s[44:47], s88 offen lds
 v_mfma_f32_16x16x32_bf16 a[108:111], v[36:39], a[156:159], a[108:111]
 ds_read_b64_tr_b16 v[30:31], v7 offset:18688
 v_mfma_f32_16x16x32_bf16 a[108:111], v[32:35], a[152:155], a[108:111]
 s_waitcnt lgkmcnt(8)
 s_add_u32 m0, s94, 12288
 v_mfma_f32_16x16x32_bf16 a[112:115], v[40:43], a[128:131], a[112:115]
 ds_read_b64_tr_b16 v[32:33], v6 offset:20480
 v_mfma_f32_16x16x32_bf16 a[112:115], v[44:47], a[132:135], a[112:115]
 buffer_load_dwordx4 v2, s[52:55], s88 offen lds
 v_mfma_f32_16x16x32_bf16 a[116:119], v[44:47], a[140:143], a[116:119]
 ds_read_b64_tr_b16 v[34:35], v6 offset:20736
 v_mfma_f32_16x16x32_bf16 a[116:119], v[40:43], a[136:139], a[116:119]
 s_add_u32 m0, s94, 16384
 v_mfma_f32_16x16x32_bf16 a[120:123], v[40:43], a[144:147], a[120:123]
 ds_read_b64_tr_b16 v[36:37], v6 offset:22528
 v_mfma_f32_16x16x32_bf16 a[120:123], v[44:47], a[148:151], a[120:123]
 buffer_load_dwordx4 v3, s[56:59], s89 offen lds
 v_mfma_f32_16x16x32_bf16 a[124:127], v[44:47], a[156:159], a[124:127]
 ds_read_b64_tr_b16 v[38:39], v6 offset:22784
 v_mfma_f32_16x16x32_bf16 a[124:127], v[40:43], a[152:155], a[124:127]
 s_waitcnt lgkmcnt(8)
 s_add_u32 m0, s94, 24576
 v_mfma_f32_16x16x32_bf16 v[64:67], v[16:19], a[128:131], v[64:67]
 ds_read_b64_tr_b16 v[40:41], v7 offset:20480
 v_mfma_f32_16x16x32_bf16 v[64:67], v[20:23], a[132:135], v[64:67]
 buffer_load_dwordx4 v3, s[64:67], s89 offen lds
 v_mfma_f32_16x16x32_bf16 v[68:71], v[20:23], a[140:143], v[68:71]
 ds_read_b64_tr_b16 v[42:43], v7 offset:20736
 v_mfma_f32_16x16x32_bf16 v[68:71], v[16:19], a[136:139], v[68:71]
 s_add_u32 m0, s94, 20480
 v_mfma_f32_16x16x32_bf16 v[72:75], v[16:19], a[144:147], v[72:75]
 ds_read_b64_tr_b16 v[44:45], v7 offset:22528
 v_mfma_f32_16x16x32_bf16 v[72:75], v[20:23], a[148:151], v[72:75]
 buffer_load_dwordx4 v3, s[60:63], s89 offen lds
 v_mfma_f32_16x16x32_bf16 v[76:79], v[20:23], a[156:159], v[76:79]
 ds_read_b64_tr_b16 v[46:47], v7 offset:22784
 v_mfma_f32_16x16x32_bf16 v[76:79], v[16:19], a[152:155], v[76:79]
 s_waitcnt lgkmcnt(8)
 s_add_u32 m0, s94, 28672
 v_mfma_f32_16x16x32_bf16 v[80:83], v[24:27], a[128:131], v[80:83]
 ds_read_b64_tr_b16 v[16:17], v6 offset:24576
 v_mfma_f32_16x16x32_bf16 v[80:83], v[28:31], a[132:135], v[80:83]
 buffer_load_dwordx4 v3, s[68:71], s89 offen lds
 v_mfma_f32_16x16x32_bf16 v[84:87], v[28:31], a[140:143], v[84:87]
 ds_read_b64_tr_b16 v[18:19], v6 offset:24832
 v_mfma_f32_16x16x32_bf16 v[84:87], v[24:27], a[136:139], v[84:87]
 s_add_u32 m0, s94, 32768
 v_mfma_f32_16x16x32_bf16 v[88:91], v[24:27], a[144:147], v[88:91]
 ds_read_b64_tr_b16 v[20:21], v6 offset:26624
 v_mfma_f32_16x16x32_bf16 v[88:91], v[28:31], a[148:151], v[88:91]
 buffer_load_dwordx4 v3, s[72:75], s89 offen lds
 v_mfma_f32_16x16x32_bf16 v[92:95], v[28:31], a[156:159], v[92:95]
 ds_read_b64_tr_b16 v[22:23], v6 offset:26880
 v_mfma_f32_16x16x32_bf16 v[92:95], v[24:27], a[152:155], v[92:95]
 s_waitcnt lgkmcnt(8)
 s_add_u32 m0, s94, 36864
 v_mfma_f32_16x16x32_bf16 v[96:99], v[32:35], a[128:131], v[96:99]
 ds_read_b64_tr_b16 v[24:25], v7 offset:24576
 v_mfma_f32_16x16x32_bf16 v[96:99], v[36:39], a[132:135], v[96:99]
 buffer_load_dwordx4 v3, s[76:79], s89 offen lds
 v_mfma_f32_16x16x32_bf16 v[100:103], v[36:39], a[140:143], v[100:103]
 ds_read_b64_tr_b16 v[26:27], v7 offset:24832
 v_mfma_f32_16x16x32_bf16 v[100:103], v[32:35], a[136:139], v[100:103]
 s_add_u32 s9, s9, 1
 s_cmp_lt_u32 s9, 4
 s_cselect_b32 s3, 1, 3
 s_add_u32 s100, s9, s11
 s_and_b32 s100, s100, s3
 s_andn2_b32 s3, s9, s3
 s_or_b32 s100, s100, s3
 s_mul_i32 s88, s100, s90
 s_mul_i32 s89, s100, s91
 s_add_u32 s94, s94, 40960
 s_cmp_ge_u32 s94, s99
 s_cselect_b32 s3, 163840, 0
 s_sub_u32 s94, s94, s3
 v_mfma_f32_16x16x32_bf16 v[104:107], v[32:35], a[144:147], v[104:107]
 ds_read_b64_tr_b16 v[28:29], v7 offset:26624
 v_mfma_f32_16x16x32_bf16 v[104:107], v[36:39], a[148:151], v[104:107]
 s_add_u32 m0, s94, 0
 v_mfma_f32_16x16x32_bf16 v[108:111], v[36:39], a[156:159], v[108:111]
 ds_read_b64_tr_b16 v[30:31], v7 offset:26880
 v_mfma_f32_16x16x32_bf16 v[108:111], v[32:35], a[152:155], v[108:111]
 s_waitcnt lgkmcnt(8)
 buffer_load_dwordx4 v2, s[40:43], s88 offen lds
 v_mfma_f32_16x16x32_bf16 v[112:115], v[40:43], a[128:131], v[112:115]
 ds_read_b64_tr_b16 v[32:33], v6 offset:28672
 v_mfma_f32_16x16x32_bf16 v[112:115], v[44:47], a[132:135], v[112:115]
 v_mfma_f32_16x16x32_bf16 v[116:119], v[44:47], a[140:143], v[116:119]
 ds_read_b64_tr_b16 v[34:35], v6 offset:28928
 s_add_u32 m0, s94, 8192
 v_mfma_f32_16x16x32_bf16 v[116:119], v[40:43], a[136:139], v[116:119]
 v_mfma_f32_16x16x32_bf16 v[120:123], v[40:43], a[144:147], v[120:123]
 ds_read_b64_tr_b16 v[36:37], v6 offset:30720
 buffer_load_dwordx4 v2, s[48:51], s88 offen lds
 v_mfma_f32_16x16x32_bf16 v[120:123], v[44:47], a[148:151], v[120:123]
 v_mfma_f32_16x16x32_bf16 v[124:127], v[44:47], a[156:159], v[124:127]
 ds_read_b64_tr_b16 v[38:39], v6 offset:30976
 v_mfma_f32_16x16x32_bf16 v[124:127], v[40:43], a[152:155], v[124:127]
 s_waitcnt lgkmcnt(8)
 s_add_u32 m0, s94, 4096
 v_mfma_f32_16x16x32_bf16 v[128:131], v[16:19], a[128:131], v[128:131]
 ds_read_b64_tr_b16 v[40:41], v7 offset:28672
 v_mfma_f32_16x16x32_bf16 v[128:131], v[20:23], a[132:135], v[128:131]
 buffer_load_dwordx4 v2, s[44:47], s88 offen lds
 v_mfma_f32_16x16x32_bf16 v[132:135], v[20:23], a[140:143], v[132:135]
 ds_read_b64_tr_b16 v[42:43], v7 offset:28928
 v_mfma_f32_16x16x32_bf16 v[132:135], v[16:19], a[136:139], v[132:135]
 v_mfma_f32_16x16x32_bf16 v[136:139], v[16:19], a[144:147], v[136:139]
 ds_read_b64_tr_b16 v[44:45], v7 offset:30720
 s_add_u32 m0, s94, 12288
 v_mfma_f32_16x16x32_bf16 v[136:139], v[20:23], a[148:151], v[136:139]
 v_mfma_f32_16x16x32_bf16 v[140:143], v[20:23], a[156:159], v[140:143]
 ds_read_b64_tr_b16 v[46:47], v7 offset:30976
 buffer_load_dwordx4 v2, s[52:55], s88 offen lds
 v_mfma_f32_16x16x32_bf16 v[140:143], v[16:19], a[152:155], v[140:143]
 s_waitcnt lgkmcnt(8)
 v_mfma_f32_16x16x32_bf16 v[144:147], v[24:27], a[128:131], v[144:147]
 ds_read_b64_tr_b16 v[16:17], v6 offset:32768
 v_mfma_f32_16x16x32_bf16 v[144:147], v[28:31], a[132:135], v[144:147]
 s_add_u32 m0, s94, 16384
 v_mfma_f32_16x16x32_bf16 v[148:151], v[28:31], a[140:143], v[148:151]
 ds_read_b64_tr_b16 v[18:19], v6 offset:33024
 v_mfma_f32_16x16x32_bf16 v[148:151], v[24:27], a[136:139], v[148:151]
 buffer_load_dwordx4 v3, s[56:59], s89 offen lds
 v_mfma_f32_16x16x32_bf16 v[152:155], v[24:27], a[144:147], v[152:155]
 ds_read_b64_tr_b16 v[20:21], v6 offset:34816
 v_mfma_f32_16x16x32_bf16 v[152:155], v[28:31], a[148:151], v[152:155]
 v_mfma_f32_16x16x32_bf16 v[156:159], v[28:31], a[156:159], v[156:159]
 ds_read_b64_tr_b16 v[22:23], v6 offset:35072
 s_add_u32 m0, s94, 24576
 v_mfma_f32_16x16x32_bf16 v[156:159], v[24:27], a[152:155], v[156:159]
 s_waitcnt lgkmcnt(8)
 v_mfma_f32_16x16x32_bf16 v[160:163], v[32:35], a[128:131], v[160:163]
 ds_read_b64_tr_b16 v[24:25], v7 offset:32768
 buffer_load_dwordx4 v3, s[64:67], s89 offen lds
 v_mfma_f32_16x16x32_bf16 v[160:163], v[36:39], a[132:135], v[160:163]
 v_mfma_f32_16x16x32_bf16 v[164:167], v[36:39], a[140:143], v[164:167]
 ds_read_b64_tr_b16 v[26:27], v7 offset:33024
 v_mfma_f32_16x16x32_bf16 v[164:167], v[32:35], a[136:139], v[164:167]
 s_add_u32 m0, s94, 20480
 v_mfma_f32_16x16x32_bf16 v[168:171], v[32:35], a[144:147], v[168:171]
 ds_read_b64_tr_b16 v[28:29], v7 offset:34816
 v_mfma_f32_16x16x32_bf16 v[168:171], v[36:39], a[148:151], v[168:171]
 buffer_load_dwordx4 v3, s[60:63], s89 offen lds
 v_mfma_f32_16x16x32_bf16 v[172:175], v[36:39], a[156:159], v[172:175]
 ds_read_b64_tr_b16 v[30:31], v7 offset:35072
 v_mfma_f32_16x16x32_bf16 v[172:175], v[32:35], a[152:155], v[172:175]
 s_waitcnt lgkmcnt(8)
 v_mfma_f32_16x16x32_bf16 v[176:179], v[40:43], a[128:131], v[176:179]
 ds_read_b64_tr_b16 v[32:33], v6 offset:36864
 s_add_u32 m0, s94, 28672
 v_mfma_f32_16x16x32_bf16 v[176:179], v[44:47], a[132:135], v[176:179]
 v_mfma_f32_16x16x32_bf16 v[180:183], v[44:47], a[140:143], v[180:183]
 ds_read_b64_tr_b16 v[34:35], v6 offset:37120
 buffer_load_dwordx4 v3, s[68:71], s89 offen lds
 v_mfma_f32_16x16x32_bf16 v[180:183], v[40:43], a[136:139], v[180:183]
 v_mfma_f32_16x16x32_bf16 v[184:187], v[40:43], a[144:147], v[184:187]
 ds_read_b64_tr_b16 v[36:37], v6 offset:38912
 v_mfma_f32_16x16x32_bf16 v[184:187], v[44:47], a[148:151], v[184:187]
 s_add_u32 m0, s94, 32768
 v_mfma_f32_16x16x32_bf16 v[188:191], v[44:47], a[156:159], v[188:191]
 ds_read_b64_tr_b16 v[38:39], v6 offset:39168
 v_mfma_f32_16x16x32_bf16 v[188:191], v[40:43], a[152:155], v[188:191]
 s_waitcnt lgkmcnt(8)
 buffer_load_dwordx4 v3, s[72:75], s89 offen lds
 v_mfma_f32_16x16x32_bf16 v[192:195], a[128:131], v[16:19], v[192:195]
 ds_read_b64_tr_b16 v[40:41], v7 offset:36864
 v_mfma_f32_16x16x32_bf16 v[192:195], a[132:135], v[20:23], v[192:195]
 v_mfma_f32_16x16x32_bf16 v[196:199], a[140:143], v[20:23], v[196:199]
 ds_read_b64_tr_b16 v[42:43], v7 offset:37120
 s_add_u32 m0, s94, 36864
 v_mfma_f32_16x16x32_bf16 v[196:199], a[136:139], v[16:19], v[196:199]
 v_mfma_f32_16x16x32_bf16 v[200:203], a[144:147], v[16:19], v[200:203]
 ds_read_b64_tr_b16 v[44:45], v7 offset:38912
 buffer_load_dwordx4 v3, s[76:79], s89 offen lds
 v_mfma_f32_16x16x32_bf16 v[200:203], a[148:151], v[20:23], v[200:203]
 v_mfma_f32_16x16x32_bf16 v[204:207], a[156:159], v[20:23], v[204:207]
 ds_read_b64_tr_b16 v[46:47], v7 offset:39168
 v_mfma_f32_16x16x32_bf16 v[204:207], a[152:155], v[16:19], v[204:207]
 s_waitcnt lgkmcnt(8)
 v_mfma_f32_16x16x32_bf16 v[208:211], a[128:131], v[24:27], v[208:211]
 v_mfma_f32_16x16x32_bf16 v[208:211], a[132:135], v[28:31], v[208:211]
 v_mfma_f32_16x16x32_bf16 v[212:215], a[140:143], v[28:31], v[212:215]
 v_mfma_f32_16x16x32_bf16 v[212:215], a[136:139], v[24:27], v[212:215]
 v_mfma_f32_16x16x32_bf16 v[216:219], a[144:147], v[24:27], v[216:219]
 s_add_u32 s93, s93, 40960
 v_mfma_f32_16x16x32_bf16 v[216:219], a[148:151], v[28:31], v[216:219]
 s_cmp_ge_u32 s93, 163840
 v_mfma_f32_16x16x32_bf16 v[220:223], a[156:159], v[28:31], v[220:223]
 s_cselect_b32 s93, 0, s93
 v_mfma_f32_16x16x32_bf16 v[220:223], a[152:155], v[24:27], v[220:223]
 s_waitcnt lgkmcnt(4)
 s_waitcnt vmcnt(20) lgkmcnt(0)
 s_barrier
 v_add_u32 v6, s93, v4
 v_add_u32 v7, s93, v5
 v_mfma_f32_16x16x32_bf16 v[224:227], a[128:131], v[32:35], v[224:227]
 s_add_u32 s9, s9, 1
 ds_read_b64_tr_b16 v[16:17], v6 offset:0
 v_mfma_f32_16x16x32_bf16 v[224:227], a[132:135], v[36:39], v[224:227]
 s_cmp_lt_u32 s9, 4
 ds_read_b64_tr_b16 v[18:19], v6 offset:256
 v_mfma_f32_16x16x32_bf16 v[228:231], a[140:143], v[36:39], v[228:231]
 s_cselect_b32 s3, 1, 3
 ds_read_b64_tr_b16 v[20:21], v6 offset:2048
 v_mfma_f32_16x16x32_bf16 v[228:231], a[136:139], v[32:35], v[228:231]
 s_add_u32 s100, s9, s11
 ds_read_b64_tr_b16 v[22:23], v6 offset:2304
 v_mfma_f32_16x16x32_bf16 v[232:235], a[144:147], v[32:35], v[232:235]
 s_and_b32 s100, s100, s3
 ds_read_b64_tr_b16 v[24:25], v7 offset:0
 v_mfma_f32_16x16x32_bf16 v[232:235], a[148:151], v[36:39], v[232:235]
 s_andn2_b32 s3, s9, s3
 ds_read_b64_tr_b16 v[26:27], v7 offset:256
 v_mfma_f32_16x16x32_bf16 v[236:239], a[156:159], v[36:39], v[236:239]
 s_or_b32 s100, s100, s3
 ds_read_b64_tr_b16 v[28:29], v7 offset:2048
 v_mfma_f32_16x16x32_bf16 v[236:239], a[152:155], v[32:35], v[236:239]
 s_waitcnt lgkmcnt(7)
 ds_read_b64_tr_b16 v[30:31], v7 offset:2304
 v_mfma_f32_16x16x32_bf16 v[240:243], a[128:131], v[40:43], v[240:243]
 s_mul_i32 s88, s100, s90
 ds_read_b64_tr_b16 v[32:33], v6 offset:4096
 v_mfma_f32_16x16x32_bf16 v[240:243], a[132:135], v[44:47], v[240:243]
 s_mul_i32 s89, s100, s91
 v_mfma_f32_16x16x32_bf16 v[244:247], a[140:143], v[44:47], v[244:247]
 s_add_u32 s94, s94, 40960
 ds_read_b64_tr_b16 v[34:35], v6 offset:4352
 v_mfma_f32_16x16x32_bf16 v[244:247], a[136:139], v[40:43], v[244:247]
 s_cmp_ge_u32 s94, s99
 v_mfma_f32_16x16x32_bf16 v[248:251], a[144:147], v[40:43], v[248:251]
 s_cselect_b32 s3, 163840, 0
 ds_read_b64_tr_b16 v[36:37], v6 offset:6144
 v_mfma_f32_16x16x32_bf16 v[248:251], a[148:151], v[44:47], v[248:251]
 s_sub_u32 s94, s94, s3
 v_mfma_f32_16x16x32_bf16 v[252:255], a[156:159], v[44:47], v[252:255]
 ds_read_b64_tr_b16 v[38:39], v6 offset:6400
 v_mfma_f32_16x16x32_bf16 v[252:255], a[152:155], v[40:43], v[252:255]
.p2align 6
L_g1_loopB:
 s_waitcnt lgkmcnt(8)
 v_mfma_f32_16x16x32_bf16 a[0:3], v[16:19], a[160:163], a[0:3]
 ds_read_b64_tr_b16 v[40:41], v7 offset:4096
 v_mfma_f32_16x16x32_bf16 a[0:3], v[20:23], a[164:167], a[0:3]
 v_mfma_f32_16x16x32_bf16 a[4:7], v[20:23], a[172:175], a[4:7]
 ds_read_b64_tr_b16 v[42:43], v7 offset:4352
 v_mfma_f32_16x16x32_bf16 a[4:7], v[16:19], a[168:171], a[4:7]
 buffer_load_dwordx4 a[128:131], v8, s[84:87], s92 offen offset:0 sc1
 v_mfma_f32_16x16x32_bf16 a[8:11], v[16:19], a[176:179], a[8:11]
 ds_read_b64_tr_b16 v[44:45], v7 offset:6144
 v_mfma_f32_16x16x32_bf16 a[8:11], v[20:23], a[180:183], a[8:11]
 v_mfma_f32_16x16x32_bf16 a[12:15], v[20:23], a[188:191], a[12:15]
 ds_read_b64_tr_b16 v[46:47], v7 offset:6400
 v_mfma_f32_16x16x32_bf16 a[12:15], v[16:19], a[184:187], a[12:15]
 s_waitcnt lgkmcnt(8)
 v_mfma_f32_16x16x32_bf16 a[16:19], v[24:27], a[160:163], a[16:19]
 ds_read_b64_tr_b16 v[16:17], v6 offset:8192
 v_mfma_f32_16x16x32_bf16 a[16:19], v[28:31], a[164:167], a[16:19]
 v_mfma_f32_16x16x32_bf16 a[20:23], v[28:31], a[172:175], a[20:23]
 ds_read_b64_tr_b16 v[18:19], v6 offset:8448
 v_mfma_f32_16x16x32_bf16 a[20:23], v[24:27], a[168:171], a[20:23]
 buffer_load_dwordx4 a[132:135], v8, s[84:87], s92 offen offset:1024 sc1
 v_mfma_f32_16x16x32_bf16 a[24:27], v[24:27], a[176:179], a[24:27]
 ds_read_b64_tr_b16 v[20:21], v6 offset:10240
 v_mfma_f32_16x16x32_bf16 a[24:27], v[28:31], a[180:183], a[24:27]
 v_mfma_f32_16x16x32_bf16 a[28:31], v[28:31], a[188:191], a[28:31]
 ds_read_b64_tr_b16 v[22:23], v6 offset:10496
 v_mfma_f32_16x16x32_bf16 a[28:31], v[24:27], a[184:187], a[28:31]
 s_waitcnt lgkmcnt(8)
 v_mfma_f32_16x16x32_bf16 a[32:35], v[32:35], a[160:163], a[32:35]
 ds_read_b64_tr_b16 v[24:25], v7 offset:8192
 v_mfma_f32_16x16x32_bf16 a[32:35], v[36:39], a[164:167], a[32:35]
 v_mfma_f32_16x16x32_bf16 a[36:39], v[36:39], a[172:175], a[36:39]
 ds_read_b64_tr_b16 v[26:27], v7 offset:8448
 v_mfma_f32_16x16x32_bf16 a[36:39], v[32:35], a[168:171], a[36:39]
 buffer_load_dwordx4 a[136:139], v9, s[84:87], s92 offen offset:0 sc1
 v_mfma_f32_16x16x32_bf16 a[40:43], v[32:35], a[176:179], a[40:43]
 ds_read_b64_tr_b16 v[28:29], v7 offset:10240
 v_mfma_f32_16x16x32_bf16 a[40:43], v[36:39], a[180:183], a[40:43]
 v_mfma_f32_16x16x32_bf16 a[44:47], v[36:39], a[188:191], a[44:47]
 ds_read_b64_tr_b16 v[30:31], v7 offset:10496
 v_mfma_f32_16x16x32_bf16 a[44:47], v[32:35], a[184:187], a[44:47]
 s_waitcnt lgkmcnt(8)
 v_mfma_f32_16x16x32_bf16 a[48:51], v[40:43], a[160:163], a[48:51]
 ds_read_b64_tr_b16 v[32:33], v6 offset:12288
 v_mfma_f32_16x16x32_bf16 a[48:51], v[44:47], a[164:167], a[48:51]
 v_mfma_f32_16x16x32_bf16 a[52:55], v[44:47], a[172:175], a[52:55]
 ds_read_b64_tr_b16 v[34:35], v6 offset:12544
 v_mfma_f32_16x16x32_bf16 a[52:55], v[40:43], a[168:171], a[52:55]
 buffer_load_dwordx4 a[140:143], v9, s[84:87], s92 offen offset:1024 sc1
 v_mfma_f32_16x16x32_bf16 a[56:59], v[40:43], a[176:179], a[56:59]
 ds_read_b64_tr_b16 v[36:37], v6 offset:14336
 v_mfma_f32_16x16x32_bf16 a[56:59], v[44:47], a[180:183], a[56:59]
 v_mfma_f32_16x16x32_bf16 a[60:63], v[44:47], a[188:191], a[60:63]
 ds_read_b64_tr_b16 v[38:39], v6 offset:14592
 v_mfma_f32_16x16x32_bf16 a[60:63], v[40:43], a[184:187], a[60:63]
 s_waitcnt lgkmcnt(8)
 v_mfma_f32_16x16x32_bf16 a[64:67], v[16:19], a[160:163], a[64:67]
 ds_read_b64_tr_b16 v[40:41], v7 offset:12288
 v_mfma_f32_16x16x32_bf16 a[64:67], v[20:23], a[164:167], a[64:67]
 v_mfma_f32_16x16x32_bf16 a[68:71], v[20:23], a[172:175], a[68:71]
 ds_read_b64_tr_b16 v[42:43], v7 offset:12544
 v_mfma_f32_16x16x32_bf16 a[68:71], v[16:19], a[168:171], a[68:71]
 buffer_load_dwordx4 a[144:147], v10, s[84:87], s92 offen offset:0 sc1
 v_mfma_f32_16x16x32_bf16 a[72:75], v[16:19], a[176:179], a[72:75]
 ds_read_b64_tr_b16 v[44:45], v7 offset:14336
 v_mfma_f32_16x16x32_bf16 a[72:75], v[20:23], a[180:183], a[72:75]
 v_mfma_f32_16x16x32_bf16 a[76:79], v[20:23], a[188:191], a[76:79]
 ds_read_b64_tr_b16 v[46:47], v7 offset:14592
 v_mfma_f32_16x16x32_bf16 a[76:79], v[16:19], a[184:187], a[76:79]
 s_waitcnt lgkmcnt(8)
 v_mfma_f32_16x16x32_bf16 a[80:83], v[24:27], a[160:163], a[80:83]
 ds_read_b64_tr_b16 v[16:17], v6 offset:16384
 v_mfma_f32_16x16x32_bf16 a[80:83], v[28:31], a[164:167], a[80:83]
 v_mfma_f32_16x16x32_bf16 a[84:87], v[28:31], a[172:175], a[84:87]
 ds_read_b64_tr_b16 v[18:19], v6 offset:16640
 v_mfma_f32_16x16x32_bf16 a[84:87], v[24:27], a[168:171], a[84:87]
 buffer_load_dwordx4 a[148:151], v10, s[84:87], s92 offen offset:1024 sc1
 v_mfma_f32_16x16x32_bf16 a[88:91], v[24:27], a[176:179], a[88:91]
 ds_read_b64_tr_b16 v[20:21], v6 offset:18432
 v_mfma_f32_16x16x32_bf16 a[88:91], v[28:31], a[180:183], a[88:91]
 v_mfma_f32_16x16x32_bf16 a[92:95], v[28:31], a[188:191], a[92:95]
 ds_read_b64_tr_b16 v[22:23], v6 offset:18688
 v_mfma_f32_16x16x32_bf16 a[92:95], v[24:27], a[184:187], a[92:95]
 s_waitcnt lgkmcnt(8)
 v_mfma_f32_16x16x32_bf16 a[96:99], v[32:35], a[160:163], a[96:99]
 ds_read_b64_tr_b16 v[24:25], v7 offset:16384
 v_mfma_f32_16x16x32_bf16 a[96:99], v[36:39], a[164:167], a[96:99]
 v_mfma_f32_16x16x32_bf16 a[100:103], v[36:39], a[172:175], a[100:103]
 ds_read_b64_tr_b16 v[26:27], v7 offset:16640
 v_mfma_f32_16x16x32_bf16 a[100:103], v[32:35], a[168:171], a[100:103]
 buffer_load_dwordx4 a[152:155], v11, s[84:87], s92 offen offset:0 sc1
 v_mfma_f32_16x16x32_bf16 a[104:107], v[32:35], a[176:179], a[104:107]
 ds_read_b64_tr_b16 v[28:29], v7 offset:18432
 v_mfma_f32_16x16x32_bf16 a[104:107], v[36:39], a[180:183], a[104:107]
 v_mfma_f32_16x16x32_bf16 a[108:111], v[36:39], a[188:191], a[108:111]
 ds_read_b64_tr_b16 v[30:31], v7 offset:18688
 v_mfma_f32_16x16x32_bf16 a[108:111], v[32:35], a[184:187], a[108:111]
 s_waitcnt lgkmcnt(8)
 v_mfma_f32_16x16x32_bf16 a[112:115], v[40:43], a[160:163], a[112:115]
 ds_read_b64_tr_b16 v[32:33], v6 offset:20480
 v_mfma_f32_16x16x32_bf16 a[112:115], v[44:47], a[164:167], a[112:115]
 v_mfma_f32_16x16x32_bf16 a[116:119], v[44:47], a[172:175], a[116:119]
 ds_read_b64_tr_b16 v[34:35], v6 offset:20736
 v_mfma_f32_16x16x32_bf16 a[116:119], v[40:43], a[168:171], a[116:119]
 buffer_load_dwordx4 a[156:159], v11, s[84:87], s92 offen offset:1024 sc1
 v_mfma_f32_16x16x32_bf16 a[120:123], v[40:43], a[176:179], a[120:123]
 s_add_u32 s10, s10, 1
 ds_read_b64_tr_b16 v[36:37], v6 offset:22528
 v_mfma_f32_16x16x32_bf16 a[120:123], v[44:47], a[180:183], a[120:123]
 s_cmp_lt_u32 s10, 4
 v_mfma_f32_16x16x32_bf16 a[124:127], v[44:47], a[188:191], a[124:127]
 s_cselect_b32 s3, 1, 3
 ds_read_b64_tr_b16 v[38:39], v6 offset:22784
 v_mfma_f32_16x16x32_bf16 a[124:127], v[40:43], a[184:187], a[124:127]
 s_add_u32 s92, s10, s11
 s_waitcnt lgkmcnt(8)
 v_mfma_f32_16x16x32_bf16 v[64:67], v[16:19], a[160:163], v[64:67]
 ds_read_b64_tr_b16 v[40:41], v7 offset:20480
 v_mfma_f32_16x16x32_bf16 v[64:67], v[20:23], a[164:167], v[64:67]
 s_add_u32 m0, s94, 0
 v_mfma_f32_16x16x32_bf16 v[68:71], v[20:23], a[172:175], v[68:71]
 s_and_b32 s92, s92, s3
 ds_read_b64_tr_b16 v[42:43], v7 offset:20736
 v_mfma_f32_16x16x32_bf16 v[68:71], v[16:19], a[168:171], v[68:71]
 s_andn2_b32 s3, s10, s3
 buffer_load_dwordx4 v2, s[40:43], s88 offen lds
 s_add_u32 m0, s94, 8192
 v_mfma_f32_16x16x32_bf16 v[72:75], v[16:19], a[176:179], v[72:75]
 s_or_b32 s92, s92, s3
 ds_read_b64_tr_b16 v[44:45], v7 offset:22528
 v_mfma_f32_16x16x32_bf16 v[72:75], v[20:23], a[180:183], v[72:75]
 s_lshl_b32 s92, s92, 11
 buffer_load_dwordx4 v2, s[48:51], s88 offen lds
 v_mfma_f32_16x16x32_bf16 v[76:79], v[20:23], a[188:191], v[76:79]
 ds_read_b64_tr_b16 v[46:47], v7 offset:22784
 v_mfma_f32_16x16x32_bf16 v[76:79], v[16:19], a[184:187], v[76:79]
 s_waitcnt lgkmcnt(8)
 v_mfma_f32_16x16x32_bf16 v[80:83], v[24:27], a[160:163], v[80:83]
 ds_read_b64_tr_b16 v[16:17], v6 offset:24576
 v_mfma_f32_16x16x32_bf16 v[80:83], v[28:31], a[164:167], v[80:83]
 v_mfma_f32_16x16x32_bf16 v[84:87], v[28:31], a[172:175], v[84:87]
 ds_read_b64_tr_b16 v[18:19], v6 offset:24832
 v_mfma_f32_16x16x32_bf16 v[84:87], v[24:27], a[168:171], v[84:87]
 v_mfma_f32_16x16x32_bf16 v[88:91], v[24:27], a[176:179], v[88:91]
 ds_read_b64_tr_b16 v[20:21], v6 offset:26624
 v_mfma_f32_16x16x32_bf16 v[88:91], v[28:31], a[180:183], v[88:91]
 v_mfma_f32_16x16x32_bf16 v[92:95], v[28:31], a[188:191], v[92:95]
 ds_read_b64_tr_b16 v[22:23], v6 offset:26880
 v_mfma_f32_16x16x32_bf16 v[92:95], v[24:27], a[184:187], v[92:95]
 s_waitcnt lgkmcnt(8)
 v_mfma_f32_16x16x32_bf16 v[96:99], v[32:35], a[160:163], v[96:99]
 ds_read_b64_tr_b16 v[24:25], v7 offset:24576
 v_mfma_f32_16x16x32_bf16 v[96:99], v[36:39], a[164:167], v[96:99]
 s_add_u32 m0, s94, 4096
 v_mfma_f32_16x16x32_bf16 v[100:103], v[36:39], a[172:175], v[100:103]
 ds_read_b64_tr_b16 v[26:27], v7 offset:24832
 v_mfma_f32_16x16x32_bf16 v[100:103], v[32:35], a[168:171], v[100:103]
 buffer_load_dwordx4 v2, s[44:47], s88 offen lds
 s_add_u32 m0, s94, 12288
 v_mfma_f32_16x16x32_bf16 v[104:107], v[32:35], a[176:179], v[104:107]
 ds_read_b64_tr_b16 v[28:29], v7 offset:26624
 v_mfma_f32_16x16x32_bf16 v[104:107], v[36:39], a[180:183], v[104:107]
 buffer_load_dwordx4 v2, s[52:55], s88 offen lds
 v_mfma_f32_16x16x32_bf16 v[108:111], v[36:39], a[188:191], v[108:111]
 ds_read_b64_tr_b16 v[30:31], v7 offset:26880
 v_mfma_f32_16x16x32_bf16 v[108:111], v[32:35], a[184:187], v[108:111]
 s_waitcnt lgkmcnt(8)
 v_mfma_f32_16x16x32_bf16 v[112:115], v[40:43], a[160:163], v[112:115]
 ds_read_b64_tr_b16 v[32:33], v6 offset:28672
 v_mfma_f32_16x16x32_bf16 v[112:115], v[44:47], a[164:167], v[112:115]
 v_mfma_f32_16x16x32_bf16 v[116:119], v[44:47], a[172:175], v[116:119]
 ds_read_b64_tr_b16 v[34:35], v6 offset:28928
 v_mfma_f32_16x16x32_bf16 v[116:119], v[40:43], a[168:171], v[116:119]
 v_mfma_f32_16x16x32_bf16 v[120:123], v[40:43], a[176:179], v[120:123]
 ds_read_b64_tr_b16 v[36:37], v6 offset:30720
 v_mfma_f32_16x16x32_bf16 v[120:123], v[44:47], a[180:183], v[120:123]
 v_mfma_f32_16x16x32_bf16 v[124:127], v[44:47], a[188:191], v[124:127]
 ds_read_b64_tr_b16 v[38:39], v6 offset:30976
 v_mfma_f32_16x16x32_bf16 v[124:127], v[40:43], a[184:187], v[124:127]
 s_waitcnt lgkmcnt(8)
 v_mfma_f32_16x16x32_bf16 v[128:131], v[16:19], a[160:163], v[128:131]
 ds_read_b64_tr_b16 v[40:41], v7 offset:28672
 v_mfma_f32_16x16x32_bf16 v[128:131], v[20:23], a[164:167], v[128:131]
 s_add_u32 m0, s94, 16384
 v_mfma_f32_16x16x32_bf16 v[132:135], v[20:23], a[172:175], v[132:135]
 ds_read_b64_tr_b16 v[42:43], v7 offset:28928
 v_mfma_f32_16x16x32_bf16 v[132:135], v[16:19], a[168:171], v[132:135]
 buffer_load_dwordx4 v3, s[56:59], s89 offen lds
 s_add_u32 m0, s94, 24576
 v_mfma_f32_16x16x32_bf16 v[136:139], v[16:19], a[176:179], v[136:139]
 ds_read_b64_tr_b16 v[44:45], v7 offset:30720
 v_mfma_f32_16x16x32_bf16 v[136:139], v[20:23], a[180:183], v[136:139]
 buffer_load_dwordx4 v3, s[64:67], s89 offen lds
 v_mfma_f32_16x16x32_bf16 v[140:143], v[20:23], a[188:191], v[140:143]
 ds_read_b64_tr_b16 v[46:47], v7 offset:30976
 v_mfma_f32_16x16x32_bf16 v[140:143], v[16:19], a[184:187], v[140:143]
 s_waitcnt lgkmcnt(8)
 v_mfma_f32_16x16x32_bf16 v[144:147], v[24:27], a[160:163], v[144:147]
 ds_read_b64_tr_b16 v[16:17], v6 offset:32768
 v_mfma_f32_16x16x32_bf16 v[144:147], v[28:31], a[164:167], v[144:147]
 v_mfma_f32_16x16x32_bf16 v[148:151], v[28:31], a[172:175], v[148:151]
 ds_read_b64_tr_b16 v[18:19], v6 offset:33024
 v_mfma_f32_16x16x32_bf16 v[148:151], v[24:27], a[168:171], v[148:151]
 v_mfma_f32_16x16x32_bf16 v[152:155], v[24:27], a[176:179], v[152:155]
 ds_read_b64_tr_b16 v[20:21], v6 offset:34816
 v_mfma_f32_16x16x32_bf16 v[152:155], v[28:31], a[180:183], v[152:155]
 v_mfma_f32_16x16x32_bf16 v[156:159], v[28:31], a[188:191], v[156:159]
 ds_read_b64_tr_b16 v[22:23], v6 offset:35072
 v_mfma_f32_16x16x32_bf16 v[156:159], v[24:27], a[184:187], v[156:159]
 s_waitcnt lgkmcnt(8)
 v_mfma_f32_16x16x32_bf16 v[160:163], v[32:35], a[160:163], v[160:163]
 ds_read_b64_tr_b16 v[24:25], v7 offset:32768
 v_mfma_f32_16x16x32_bf16 v[160:163], v[36:39], a[164:167], v[160:163]
 s_add_u32 m0, s94, 20480
 v_mfma_f32_16x16x32_bf16 v[164:167], v[36:39], a[172:175], v[164:167]
 ds_read_b64_tr_b16 v[26:27], v7 offset:33024
 v_mfma_f32_16x16x32_bf16 v[164:167], v[32:35], a[168:171], v[164:167]
 buffer_load_dwordx4 v3, s[60:63], s89 offen lds
 s_add_u32 m0, s94, 28672
 v_mfma_f32_16x16x32_bf16 v[168:171], v[32:35], a[176:179], v[168:171]
 ds_read_b64_tr_b16 v[28:29], v7 offset:34816
 v_mfma_f32_16x16x32_bf16 v[168:171], v[36:39], a[180:183], v[168:171]
 buffer_load_dwordx4 v3, s[68:71], s89 offen lds
 v_mfma_f32_16x16x32_bf16 v[172:175], v[36:39], a[188:191], v[172:175]
 ds_read_b64_tr_b16 v[30:31], v7 offset:35072
 v_mfma_f32_16x16x32_bf16 v[172:175], v[32:35], a[184:187], v[172:175]
 s_waitcnt lgkmcnt(8)
 v_mfma_f32_16x16x32_bf16 v[176:179], v[40:43], a[160:163], v[176:179]
 ds_read_b64_tr_b16 v[32:33], v6 offset:36864
 v_mfma_f32_16x16x32_bf16 v[176:179], v[44:47], a[164:167], v[176:179]
 v_mfma_f32_16x16x32_bf16 v[180:183], v[44:47], a[172:175], v[180:183]
 ds_read_b64_tr_b16 v[34:35], v6 offset:37120
 v_mfma_f32_16x16x32_bf16 v[180:183], v[40:43], a[168:171], v[180:183]
 v_mfma_f32_16x16x32_bf16 v[184:187], v[40:43], a[176:179], v[184:187]
 ds_read_b64_tr_b16 v[36:37], v6 offset:38912
 v_mfma_f32_16x16x32_bf16 v[184:187], v[44:47], a[180:183], v[184:187]
 v_mfma_f32_16x16x32_bf16 v[188:191], v[44:47], a[188:191], v[188:191]
 ds_read_b64_tr_b16 v[38:39], v6 offset:39168
 v_mfma_f32_16x16x32_bf16 v[188:191], v[40:43], a[184:187], v[188:191]
 s_waitcnt lgkmcnt(8)
 v_mfma_f32_16x16x32_bf16 v[192:195], a[160:163], v[16:19], v[192:195]
 ds_read_b64_tr_b16 v[40:41], v7 offset:36864
 v_mfma_f32_16x16x32_bf16 v[192:195], a[164:167], v[20:23], v[192:195]
 s_add_u32 m0, s94, 32768
 v_mfma_f32_16x16x32_bf16 v[196:199], a[172:175], v[20:23], v[196:199]
 ds_read_b64_tr_b16 v[42:43], v7 offset:37120
 v_mfma_f32_16x16x32_bf16 v[196:199], a[168:171], v[16:19], v[196:199]
 buffer_load_dwordx4 v3, s[72:75], s89 offen lds
 s_add_u32 m0, s94, 36864
 v_mfma_f32_16x16x32_bf16 v[200:203], a[176:179], v[16:19], v[200:203]
 ds_read_b64_tr_b16 v[44:45], v7 offset:38912
 v_mfma_f32_16x16x32_bf16 v[200:203], a[180:183], v[20:23], v[200:203]
 buffer_load_dwordx4 v3, s[76:79], s89 offen lds
 v_mfma_f32_16x16x32_bf16 v[204:207], a[188:191], v[20:23], v[204:207]
 ds_read_b64_tr_b16 v[46:47], v7 offset:39168
 v_mfma_f32_16x16x32_bf16 v[204:207], a[184:187], v[16:19], v[204:207]
 s_waitcnt lgkmcnt(8)
 v_mfma_f32_16x16x32_bf16 v[208:211], a[160:163], v[24:27], v[208:211]
 v_mfma_f32_16x16x32_bf16 v[208:211], a[164:167], v[28:31], v[208:211]
 v_mfma_f32_16x16x32_bf16 v[212:215], a[172:175], v[28:31], v[212:215]
 v_mfma_f32_16x16x32_bf16 v[212:215], a[168:171], v[24:27], v[212:215]
 v_mfma_f32_16x16x32_bf16 v[216:219], a[176:179], v[24:27], v[216:219]
 s_add_u32 s93, s93, 40960
 v_mfma_f32_16x16x32_bf16 v[216:219], a[180:183], v[28:31], v[216:219]
 s_cmp_ge_u32 s93, 163840
 v_mfma_f32_16x16x32_bf16 v[220:223], a[188:191], v[28:31], v[220:223]
 s_cselect_b32 s93, 0, s93
 v_mfma_f32_16x16x32_bf16 v[220:223], a[184:187], v[24:27], v[220:223]
 s_waitcnt lgkmcnt(4)
 s_waitcnt vmcnt(10) lgkmcnt(0)
 s_barrier
 v_add_u32 v6, s93, v4
 v_add_u32 v7, s93, v5
 v_mfma_f32_16x16x32_bf16 v[224:227], a[160:163], v[32:35], v[224:227]
 s_add_u32 s9, s9, 1
 ds_read_b64_tr_b16 v[16:17], v6 offset:0
 v_mfma_f32_16x16x32_bf16 v[224:227], a[164:167], v[36:39], v[224:227]
 s_cmp_lt_u32 s9, 4
 ds_read_b64_tr_b16 v[18:19], v6 offset:256
 v_mfma_f32_16x16x32_bf16 v[228:231], a[172:175], v[36:39], v[228:231]
 s_cselect_b32 s3, 1, 3
 ds_read_b64_tr_b16 v[20:21], v6 offset:2048
 v_mfma_f32_16x16x32_bf16 v[228:231], a[168:171], v[32:35], v[228:231]
 s_add_u32 s100, s9, s11
 ds_read_b64_tr_b16 v[22:23], v6 offset:2304
 v_mfma_f32_16x16x32_bf16 v[232:235], a[176:179], v[32:35], v[232:235]
 s_and_b32 s100, s100, s3
 ds_read_b64_tr_b16 v[24:25], v7 offset:0
 v_mfma_f32_16x16x32_bf16 v[232:235], a[180:183], v[36:39], v[232:235]
 s_andn2_b32 s3, s9, s3
 ds_read_b64_tr_b16 v[26:27], v7 offset:256
 v_mfma_f32_16x16x32_bf16 v[236:239], a[188:191], v[36:39], v[236:239]
 s_or_b32 s100, s100, s3
 ds_read_b64_tr_b16 v[28:29], v7 offset:2048
 v_mfma_f32_16x16x32_bf16 v[236:239], a[184:187], v[32:35], v[236:239]
 s_waitcnt lgkmcnt(7)
 ds_read_b64_tr_b16 v[30:31], v7 offset:2304
 v_mfma_f32_16x16x32_bf16 v[240:243], a[160:163], v[40:43], v[240:243]
 s_mul_i32 s88, s100, s90
 ds_read_b64_tr_b16 v[32:33], v6 offset:4096
 v_mfma_f32_16x16x32_bf16 v[240:243], a[164:167], v[44:47], v[240:243]
 s_mul_i32 s89, s100, s91
 v_mfma_f32_16x16x32_bf16 v[244:247], a[172:175], v[44:47], v[244:247]
 s_add_u32 s94, s94, 40960
 ds_read_b64_tr_b16 v[34:35], v6 offset:4352
 v_mfma_f32_16x16x32_bf16 v[244:247], a[168:171], v[40:43], v[244:247]
 s_cmp_ge_u32 s94, s99
 v_mfma_f32_16x16x32_bf16 v[248:251], a[176:179], v[40:43], v[248:251]
 s_cselect_b32 s3, 163840, 0
 ds_read_b64_tr_b16 v[36:37], v6 offset:6144
 v_mfma_f32_16x16x32_bf16 v[248:251], a[180:183], v[44:47], v[248:251]
 s_sub_u32 s94, s94, s3
 v_mfma_f32_16x16x32_bf16 v[252:255], a[188:191], v[44:47], v[252:255]
 ds_read_b64_tr_b16 v[38:39], v6 offset:6400
 v_mfma_f32_16x16x32_bf16 v[252:255], a[184:187], v[40:43], v[252:255]
 s_sub_u32 s96, s96, 1
 s_cmp_eq_u32 s96, 0
 s_cbranch_scc1 L_g1_outB
 s_cmp_lg_u32 s96, 1
 s_cbranch_scc1 L_g1_ttB
 s_mov_b32 s3, s95
 v_lshrrev_b32 v51, 4, v15
 s_mul_i32 s3, s3, 5120
 v_min_u32 v48, 39, v51
 v_lshlrev_b32 v48, 7, v48
 v_add_u32 v48, s3, v48
 v_min_u32 v48, L_g1_B_fin - L_g1_B - 4, v48
 s_getpc_b64 s[16:17]
 s_add_u32 s16, s16, L_g1_B - .
 s_addc_u32 s17, s17, 0
 v_mov_b32 v49, s17
 v_add_co_u32 v48, vcc, s16, v48
 s_nop 1
 v_addc_co_u32 v49, vcc, 0, v49, vcc
 global_load_dword v50, v[48:49], off
 s_branch L_g1_ttB
L_g1_ttB:
 s_waitcnt lgkmcnt(8)
 v_mfma_f32_16x16x32_bf16 a[0:3], v[16:19], a[128:131], a[0:3]
 ds_read_b64_tr_b16 v[40:41], v7 offset:4096
 v_mfma_f32_16x16x32_bf16 a[0:3], v[20:23], a[132:135], a[0:3]
 v_mfma_f32_16x16x32_bf16 a[4:7], v[20:23], a[140:143], a[4:7]
 ds_read_b64_tr_b16 v[42:43], v7 offset:4352
 v_mfma_f32_16x16x32_bf16 a[4:7], v[16:19], a[136:139], a[4:7]
 buffer_load_dwordx4 a[160:163], v8, s[84:87], s92 offen offset:0 sc1
 v_mfma_f32_16x16x32_bf16 a[8:11], v[16:19], a[144:147], a[8:11]
 ds_read_b64_tr_b16 v[44:45], v7 offset:6144
 v_mfma_f32_16x16x32_bf16 a[8:11], v[20:23], a[148:151], a[8:11]
 v_mfma_f32_16x16x32_bf16 a[12:15], v[20:23], a[156:159], a[12:15]
 ds_read_b64_tr_b16 v[46:47], v7 offset:6400
 v_mfma_f32_16x16x32_bf16 a[12:15], v[16:19], a[152:155], a[12:15]
 s_waitcnt lgkmcnt(8)
 v_mfma_f32_16x16x32_bf16 a[16:19], v[24:27], a[128:131], a[16:19]
 ds_read_b64_tr_b16 v[16:17], v6 offset:8192
 v_mfma_f32_16x16x32_bf16 a[16:19], v[28:31], a[132:135], a[16:19]
 v_mfma_f32_16x16x32_bf16 a[20:23], v[28:31], a[140:143], a[20:23]
 ds_read_b64_tr_b16 v[18:19], v6 offset:8448
 v_mfma_f32_16x16x32_bf16 a[20:23], v[24:27], a[136:139], a[20:23]
 buffer_load_dwordx4 a[164:167], v8, s[84:87], s92 offen offset:1024 sc1
 v_mfma_f32_16x16x32_bf16 a[24:27], v[24:27], a[144:147], a[24:27]
 ds_read_b64_tr_b16 v[20:21], v6 offset:10240
 v_mfma_f32_16x16x32_bf16 a[24:27], v[28:31], a[148:151], a[24:27]
 v_mfma_f32_16x16x32_bf16 a[28:31], v[28:31], a[156:159], a[28:31]
 ds_read_b64_tr_b16 v[22:23], v6 offset:10496
 v_mfma_f32_16x16x32_bf16 a[28:31], v[24:27], a[152:155], a[28:31]
 s_waitcnt lgkmcnt(8)
 v_mfma_f32_16x16x32_bf16 a[32:35], v[32:35], a[128:131], a[32:35]
 ds_read_b64_tr_b16 v[24:25], v7 offset:8192
 v_mfma_f32_16x16x32_bf16 a[32:35], v[36:39], a[132:135], a[32:35]
 v_mfma_f32_16x16x32_bf16 a[36:39], v[36:39], a[140:143], a[36:39]
 ds_read_b64_tr_b16 v[26:27], v7 offset:8448
 v_mfma_f32_16x16x32_bf16 a[36:39], v[32:35], a[136:139], a[36:39]
 buffer_load_dwordx4 a[168:171], v9, s[84:87], s92 offen offset:0 sc1
 v_mfma_f32_16x16x32_bf16 a[40:43], v[32:35], a[144:147], a[40:43]
 ds_read_b64_tr_b16 v[28:29], v7 offset:10240
 v_mfma_f32_16x16x32_bf16 a[40:43], v[36:39], a[148:151], a[40:43]
 v_mfma_f32_16x16x32_bf16 a[44:47], v[36:39], a[156:159], a[44:47]
 ds_read_b64_tr_b16 v[30:31], v7 offset:10496
 v_mfma_f32_16x16x32_bf16 a[44:47], v[32:35], a[152:155], a[44:47]
 s_waitcnt lgkmcnt(8)
 v_mfma_f32_16x16x32_bf16 a[48:51], v[40:43], a[128:131], a[48:51]
 ds_read_b64_tr_b16 v[32:33], v6 offset:12288
 v_mfma_f32_16x16x32_bf16 a[48:51], v[44:47], a[132:135], a[48:51]
 v_mfma_f32_16x16x32_bf16 a[52:55], v[44:47], a[140:143], a[52:55]
 ds_read_b64_tr_b16 v[34:35], v6 offset:12544
 v_mfma_f32_16x16x32_bf16 a[52:55], v[40:43], a[136:139], a[52:55]
 buffer_load_dwordx4 a[172:175], v9, s[84:87], s92 offen offset:1024 sc1
 v_mfma_f32_16x16x32_bf16 a[56:59], v[40:43], a[144:147], a[56:59]
 ds_read_b64_tr_b16 v[36:37], v6 offset:14336
 v_mfma_f32_16x16x32_bf16 a[56:59], v[44:47], a[148:151], a[56:59]
 v_mfma_f32_16x16x32_bf16 a[60:63], v[44:47], a[156:159], a[60:63]
 ds_read_b64_tr_b16 v[38:39], v6 offset:14592
 v_mfma_f32_16x16x32_bf16 a[60:63], v[40:43], a[152:155], a[60:63]
 s_waitcnt lgkmcnt(8)
 v_mfma_f32_16x16x32_bf16 a[64:67], v[16:19], a[128:131], a[64:67]
 ds_read_b64_tr_b16 v[40:41], v7 offset:12288
 v_mfma_f32_16x16x32_bf16 a[64:67], v[20:23], a[132:135], a[64:67]
 v_mfma_f32_16x16x32_bf16 a[68:71], v[20:23], a[140:143], a[68:71]
 ds_read_b64_tr_b16 v[42:43], v7 offset:12544
 v_mfma_f32_16x16x32_bf16 a[68:71], v[16:19], a[136:139], a[68:71]
 buffer_load_dwordx4 a[176:179], v10, s[84:87], s92 offen offset:0 sc1
 v_mfma_f32_16x16x32_bf16 a[72:75], v[16:19], a[144:147], a[72:75]
 ds_read_b64_tr_b16 v[44:45], v7 offset:14336
 v_mfma_f32_16x16x32_bf16 a[72:75], v[20:23], a[148:151], a[72:75]
 v_mfma_f32_16x16x32_bf16 a[76:79], v[20:23], a[156:159], a[76:79]
 ds_read_b64_tr_b16 v[46:47], v7 offset:14592
 v_mfma_f32_16x16x32_bf16 a[76:79], v[16:19], a[152:155], a[76:79]
 s_waitcnt lgkmcnt(8)
 v_mfma_f32_16x16x32_bf16 a[80:83], v[24:27], a[128:131], a[80:83]
 ds_read_b64_tr_b16 v[16:17], v6 offset:16384
 v_mfma_f32_16x16x32_bf16 a[80:83], v[28:31], a[132:135], a[80:83]
 v_mfma_f32_16x16x32_bf16 a[84:87], v[28:31], a[140:143], a[84:87]
 ds_read_b64_tr_b16 v[18:19], v6 offset:16640
 v_mfma_f32_16x16x32_bf16 a[84:87], v[24:27], a[136:139], a[84:87]
 buffer_load_dwordx4 a[180:183], v10, s[84:87], s92 offen offset:1024 sc1
 v_mfma_f32_16x16x32_bf16 a[88:91], v[24:27], a[144:147], a[88:91]
 ds_read_b64_tr_b16 v[20:21], v6 offset:18432
 v_mfma_f32_16x16x32_bf16 a[88:91], v[28:31], a[148:151], a[88:91]
 v_mfma_f32_16x16x32_bf16 a[92:95], v[28:31], a[156:159], a[92:95]
 ds_read_b64_tr_b16 v[22:23], v6 offset:18688
 v_mfma_f32_16x16x32_bf16 a[92:95], v[24:27], a[152:155], a[92:95]
 s_waitcnt lgkmcnt(8)
 v_mfma_f32_16x16x32_bf16 a[96:99], v[32:35], a[128:131], a[96:99]
 ds_read_b64_tr_b16 v[24:25], v7 offset:16384
 v_mfma_f32_16x16x32_bf16 a[96:99], v[36:39], a[132:135], a[96:99]
 v_mfma_f32_16x16x32_bf16 a[100:103], v[36:39], a[140:143], a[100:103]
 ds_read_b64_tr_b16 v[26:27], v7 offset:16640
 v_mfma_f32_16x16x32_bf16 a[100:103], v[32:35], a[136:139], a[100:103]
 buffer_load_dwordx4 a[184:187], v11, s[84:87], s92 offen offset:0 sc1
 v_mfma_f32_16x16x32_bf16 a[104:107], v[32:35], a[144:147], a[104:107]
 ds_read_b64_tr_b16 v[28:29], v7 offset:18432
 v_mfma_f32_16x16x32_bf16 a[104:107], v[36:39], a[148:151], a[104:107]
 v_mfma_f32_16x16x32_bf16 a[108:111], v[36:39], a[156:159], a[108:111]
 ds_read_b64_tr_b16 v[30:31], v7 offset:18688
 v_mfma_f32_16x16x32_bf16 a[108:111], v[32:35], a[152:155], a[108:111]
 s_waitcnt lgkmcnt(8)
 v_mfma_f32_16x16x32_bf16 a[112:115], v[40:43], a[128:131], a[112:115]
 ds_read_b64_tr_b16 v[32:33], v6 offset:20480
 v_mfma_f32_16x16x32_bf16 a[112:115], v[44:47], a[132:135], a[112:115]
 v_mfma_f32_16x16x32_bf16 a[116:119], v[44:47], a[140:143], a[116:119]
 ds_read_b64_tr_b16 v[34:35], v6 offset:20736
 v_mfma_f32_16x16x32_bf16 a[116:119], v[40:43], a[136:139], a[116:119]
 buffer_load_dwordx4 a[188:191], v11, s[84:87], s92 offen offset:1024 sc1
 v_mfma_f32_16x16x32_bf16 a[120:123], v[40:43], a[144:147], a[120:123]
 s_add_u32 s10, s10, 1
 ds_read_b64_tr_b16 v[36:37], v6 offset:22528
 v_mfma_f32_16x16x32_bf16 a[120:123], v[44:47], a[148:151], a[120:123]
 s_cmp_lt_u32 s10, 4
 v_mfma_f32_16x16x32_bf16 a[124:127], v[44:47], a[156:159], a[124:127]
 s_cselect_b32 s3, 1, 3
 ds_read_b64_tr_b16 v[38:39], v6 offset:22784
 v_mfma_f32_16x16x32_bf16 a[124:127], v[40:43], a[152:155], a[124:127]
 s_add_u32 s92, s10, s11
 s_waitcnt lgkmcnt(8)
 v_mfma_f32_16x16x32_bf16 v[64:67], v[16:19], a[128:131], v[64:67]
 ds_read_b64_tr_b16 v[40:41], v7 offset:20480
 v_mfma_f32_16x16x32_bf16 v[64:67], v[20:23], a[132:135], v[64:67]
 s_add_u32 m0, s94, 0
 v_mfma_f32_16x16x32_bf16 v[68:71], v[20:23], a[140:143], v[68:71]
 s_and_b32 s92, s92, s3
 ds_read_b64_tr_b16 v[42:43], v7 offset:20736
 v_mfma_f32_16x16x32_bf16 v[68:71], v[16:19], a[136:139], v[68:71]
 s_andn2_b32 s3, s10, s3
 buffer_load_dwordx4 v2, s[40:43], s88 offen lds
 s_add_u32 m0, s94, 8192
 v_mfma_f32_16x16x32_bf16 v[72:75], v[16:19], a[144:147], v[72:75]
 s_or_b32 s92, s92, s3
 ds_read_b64_tr_b16 v[44:45], v7 offset:22528
 v_mfma_f32_16x16x32_bf16 v[72:75], v[20:23], a[148:151], v[72:75]
 s_lshl_b32 s92, s92, 11
 buffer_load_dwordx4 v2, s[48:51], s88 offen lds
 v_mfma_f32_16x16x32_bf16 v[76:79], v[20:23], a[156:159], v[76:79]
 ds_read_b64_tr_b16 v[46:47], v7 offset:22784
 v_mfma_f32_16x16x32_bf16 v[76:79], v[16:19], a[152:155], v[76:79]
 s_waitcnt lgkmcnt(8)
 v_mfma_f32_16x16x32_bf16 v[80:83], v[24:27], a[128:131], v[80:83]
 ds_read_b64_tr_b16 v[16:17], v6 offset:24576
 v_mfma_f32_16x16x32_bf16 v[80:83], v[28:31], a[132:135], v[80:83]
 v_mfma_f32_16x16x32_bf16 v[84:87], v[28:31], a[140:143], v[84:87]
 ds_read_b64_tr_b16 v[18:19], v6 offset:24832
 v_mfma_f32_16x16x32_bf16 v[84:87], v[24:27], a[136:139], v[84:87]
 v_mfma_f32_16x16x32_bf16 v[88:91], v[24:27], a[144:147], v[88:91]
 ds_read_b64_tr_b16 v[20:21], v6 offset:26624
 v_mfma_f32_16x16x32_bf16 v[88:91], v[28:31], a[148:151], v[88:91]
 v_mfma_f32_16x16x32_bf16 v[92:95], v[28:31], a[156:159], v[92:95]
 ds_read_b64_tr_b16 v[22:23], v6 offset:26880
 v_mfma_f32_16x16x32_bf16 v[92:95], v[24:27], a[152:155], v[92:95]
 s_waitcnt lgkmcnt(8)
 v_mfma_f32_16x16x32_bf16 v[96:99], v[32:35], a[128:131], v[96:99]
 ds_read_b64_tr_b16 v[24:25], v7 offset:24576
 v_mfma_f32_16x16x32_bf16 v[96:99], v[36:39], a[132:135], v[96:99]
 s_add_u32 m0, s94, 4096
 v_mfma_f32_16x16x32_bf16 v[100:103], v[36:39], a[140:143], v[100:103]
 ds_read_b64_tr_b16 v[26:27], v7 offset:24832
 v_mfma_f32_16x16x32_bf16 v[100:103], v[32:35], a[136:139], v[100:103]
 buffer_load_dwordx4 v2, s[44:47], s88 offen lds
 s_add_u32 m0, s94, 12288
 v_mfma_f32_16x16x32_bf16 v[104:107], v[32:35], a[144:147], v[104:107]
 ds_read_b64_tr_b16 v[28:29], v7 offset:26624
 v_mfma_f32_16x16x32_bf16 v[104:107], v[36:39], a[148:151], v[104:107]
 buffer_load_dwordx4 v2, s[52:55], s88 offen lds
 v_mfma_f32_16x16x32_bf16 v[108:111], v[36:39], a[156:159], v[108:111]
 ds_read_b64_tr_b16 v[30:31], v7 offset:26880
 v_mfma_f32_16x16x32_bf16 v[108:111], v[32:35], a[152:155], v[108:111]
 s_waitcnt lgkmcnt(8)
 v_mfma_f32_16x16x32_bf16 v[112:115], v[40:43], a[128:131], v[112:115]
 ds_read_b64_tr_b16 v[32:33], v6 offset:28672
 v_mfma_f32_16x16x32_bf16 v[112:115], v[44:47], a[132:135], v[112:115]
 v_mfma_f32_16x16x32_bf16 v[116:119], v[44:47], a[140:143], v[116:119]
 ds_read_b64_tr_b16 v[34:35], v6 offset:28928
 v_mfma_f32_16x16x32_bf16 v[116:119], v[40:43], a[136:139], v[116:119]
 v_mfma_f32_16x16x32_bf16 v[120:123], v[40:43], a[144:147], v[120:123]
 ds_read_b64_tr_b16 v[36:37], v6 offset:30720
 v_mfma_f32_16x16x32_bf16 v[120:123], v[44:47], a[148:151], v[120:123]
 v_mfma_f32_16x16x32_bf16 v[124:127], v[44:47], a[156:159], v[124:127]
 ds_read_b64_tr_b16 v[38:39], v6 offset:30976
 v_mfma_f32_16x16x32_bf16 v[124:127], v[40:43], a[152:155], v[124:127]
 s_waitcnt lgkmcnt(8)
 v_mfma_f32_16x16x32_bf16 v[128:131], v[16:19], a[128:131], v[128:131]
 ds_read_b64_tr_b16 v[40:41], v7 offset:28672
 v_mfma_f32_16x16x32_bf16 v[128:131], v[20:23], a[132:135], v[128:131]
 s_add_u32 m0, s94, 16384
 v_mfma_f32_16x16x32_bf16 v[132:135], v[20:23], a[140:143], v[132:135]
 ds_read_b64_tr_b16 v[42:43], v7 offset:28928
 v_mfma_f32_16x16x32_bf16 v[132:135], v[16:19], a[136:139], v[132:135]
 buffer_load_dwordx4 v3, s[56:59], s89 offen lds
 s_add_u32 m0, s94, 24576
 v_mfma_f32_16x16x32_bf16 v[136:139], v[16:19], a[144:147], v[136:139]
 ds_read_b64_tr_b16 v[44:45], v7 offset:30720
 v_mfma_f32_16x16x32_bf16 v[136:139], v[20:23], a[148:151], v[136:139]
 buffer_load_dwordx4 v3, s[64:67], s89 offen lds
 v_mfma_f32_16x16x32_bf16 v[140:143], v[20:23], a[156:159], v[140:143]
 ds_read_b64_tr_b16 v[46:47], v7 offset:30976
 v_mfma_f32_16x16x32_bf16 v[140:143], v[16:19], a[152:155], v[140:143]
 s_waitcnt lgkmcnt(8)
 v_mfma_f32_16x16x32_bf16 v[144:147], v[24:27], a[128:131], v[144:147]
 ds_read_b64_tr_b16 v[16:17], v6 offset:32768
 v_mfma_f32_16x16x32_bf16 v[144:147], v[28:31], a[132:135], v[144:147]
 v_mfma_f32_16x16x32_bf16 v[148:151], v[28:31], a[140:143], v[148:151]
 ds_read_b64_tr_b16 v[18:19], v6 offset:33024
 v_mfma_f32_16x16x32_bf16 v[148:151], v[24:27], a[136:139], v[148:151]
 v_mfma_f32_16x16x32_bf16 v[152:155], v[24:27], a[144:147], v[152:155]
 ds_read_b64_tr_b16 v[20:21], v6 offset:34816
 v_mfma_f32_16x16x32_bf16 v[152:155], v[28:31], a[148:151], v[152:155]
 v_mfma_f32_16x16x32_bf16 v[156:159], v[28:31], a[156:159], v[156:159]
 ds_read_b64_tr_b16 v[22:23], v6 offset:35072
 v_mfma_f32_16x16x32_bf16 v[156:159], v[24:27], a[152:155], v[156:159]
 s_waitcnt lgkmcnt(8)
 v_mfma_f32_16x16x32_bf16 v[160:163], v[32:35], a[128:131], v[160:163]
 ds_read_b64_tr_b16 v[24:25], v7 offset:32768
 v_mfma_f32_16x16x32_bf16 v[160:163], v[36:39], a[132:135], v[160:163]
 s_add_u32 m0, s94, 20480
 v_mfma_f32_16x16x32_bf16 v[164:167], v[36:39], a[140:143], v[164:167]
 ds_read_b64_tr_b16 v[26:27], v7 offset:33024
 v_mfma_f32_16x16x32_bf16 v[164:167], v[32:35], a[136:139], v[164:167]
 buffer_load_dwordx4 v3, s[60:63], s89 offen lds
 s_add_u32 m0, s94, 28672
 v_mfma_f32_16x16x32_bf16 v[168:171], v[32:35], a[144:147], v[168:171]
 ds_read_b64_tr_b16 v[28:29], v7 offset:34816
 v_mfma_f32_16x16x32_bf16 v[168:171], v[36:39], a[148:151], v[168:171]
 buffer_load_dwordx4 v3, s[68:71], s89 offen lds
 v_mfma_f32_16x16x32_bf16 v[172:175], v[36:39], a[156:159], v[172:175]
 ds_read_b64_tr_b16 v[30:31], v7 offset:35072
 v_mfma_f32_16x16x32_bf16 v[172:175], v[32:35], a[152:155], v[172:175]
 s_waitcnt lgkmcnt(8)
 v_mfma_f32_16x16x32_bf16 v[176:179], v[40:43], a[128:131], v[176:179]
 ds_read_b64_tr_b16 v[32:33], v6 offset:36864
 v_mfma_f32_16x16x32_bf16 v[176:179], v[44:47], a[132:135], v[176:179]
 v_mfma_f32_16x16x32_bf16 v[180:183], v[44:47], a[140:143], v[180:183]
 ds_read_b64_tr_b16 v[34:35], v6 offset:37120
 v_mfma_f32_16x16x32_bf16 v[180:183], v[40:43], a[136:139], v[180:183]
 v_mfma_f32_16x16x32_bf16 v[184:187], v[40:43], a[144:147], v[184:187]
 ds_read_b64_tr_b16 v[36:37], v6 offset:38912
 v_mfma_f32_16x16x32_bf16 v[184:187], v[44:47], a[148:151], v[184:187]
 v_mfma_f32_16x16x32_bf16 v[188:191], v[44:47], a[156:159], v[188:191]
 ds_read_b64_tr_b16 v[38:39], v6 offset:39168
 v_mfma_f32_16x16x32_bf16 v[188:191], v[40:43], a[152:155], v[188:191]
 s_waitcnt lgkmcnt(8)
 v_mfma_f32_16x16x32_bf16 v[192:195], a[128:131], v[16:19], v[192:195]
 ds_read_b64_tr_b16 v[40:41], v7 offset:36864
 v_mfma_f32_16x16x32_bf16 v[192:195], a[132:135], v[20:23], v[192:195]
 s_add_u32 m0, s94, 32768
 v_mfma_f32_16x16x32_bf16 v[196:199], a[140:143], v[20:23], v[196:199]
 ds_read_b64_tr_b16 v[42:43], v7 offset:37120
 v_mfma_f32_16x16x32_bf16 v[196:199], a[136:139], v[16:19], v[196:199]
 buffer_load_dwordx4 v3, s[72:75], s89 offen lds
 s_add_u32 m0, s94, 36864
 v_mfma_f32_16x16x32_bf16 v[200:203], a[144:147], v[16:19], v[200:203]
 ds_read_b64_tr_b16 v[44:45], v7 offset:38912
 v_mfma_f32_16x16x32_bf16 v[200:203], a[148:151], v[20:23], v[200:203]
 buffer_load_dwordx4 v3, s[76:79], s89 offen lds
 v_mfma_f32_16x16x32_bf16 v[204:207], a[156:159], v[20:23], v[204:207]
 ds_read_b64_tr_b16 v[46:47], v7 offset:39168
 v_mfma_f32_16x16x32_bf16 v[204:207], a[152:155], v[16:19], v[204:207]
 s_waitcnt lgkmcnt(8)
 v_mfma_f32_16x16x32_bf16 v[208:211], a[128:131], v[24:27], v[208:211]
 v_mfma_f32_16x16x32_bf16 v[208:211], a[132:135], v[28:31], v[208:211]
 v_mfma_f32_16x16x32_bf16 v[212:215], a[140:143], v[28:31], v[212:215]
 v_mfma_f32_16x16x32_bf16 v[212:215], a[136:139], v[24:27], v[212:215]
 v_mfma_f32_16x16x32_bf16 v[216:219], a[144:147], v[24:27], v[216:219]
 s_add_u32 s93, s93, 40960
 v_mfma_f32_16x16x32_bf16 v[216:219], a[148:151], v[28:31], v[216:219]
 s_cmp_ge_u32 s93, 163840
 v_mfma_f32_16x16x32_bf16 v[220:223], a[156:159], v[28:31], v[220:223]
 s_cselect_b32 s93, 0, s93
 v_mfma_f32_16x16x32_bf16 v[220:223], a[152:155], v[24:27], v[220:223]
 s_waitcnt lgkmcnt(4)
 s_waitcnt vmcnt(10) lgkmcnt(0)
 s_barrier
 v_add_u32 v6, s93, v4
 v_add_u32 v7, s93, v5
 v_mfma_f32_16x16x32_bf16 v[224:227], a[128:131], v[32:35], v[224:227]
 s_add_u32 s9, s9, 1
 ds_read_b64_tr_b16 v[16:17], v6 offset:0
 v_mfma_f32_16x16x32_bf16 v[224:227], a[132:135], v[36:39], v[224:227]
 s_cmp_lt_u32 s9, 4
 ds_read_b64_tr_b16 v[18:19], v6 offset:256
 v_mfma_f32_16x16x32_bf16 v[228:231], a[140:143], v[36:39], v[228:231]
 s_cselect_b32 s3, 1, 3
 ds_read_b64_tr_b16 v[20:21], v6 offset:2048
 v_mfma_f32_16x16x32_bf16 v[228:231], a[136:139], v[32:35], v[228:231]
 s_add_u32 s100, s9, s11
 ds_read_b64_tr_b16 v[22:23], v6 offset:2304
 v_mfma_f32_16x16x32_bf16 v[232:235], a[144:147], v[32:35], v[232:235]
 s_and_b32 s100, s100, s3
 ds_read_b64_tr_b16 v[24:25], v7 offset:0
 v_mfma_f32_16x16x32_bf16 v[232:235], a[148:151], v[36:39], v[232:235]
 s_andn2_b32 s3, s9, s3
 ds_read_b64_tr_b16 v[26:27], v7 offset:256
 v_mfma_f32_16x16x32_bf16 v[236:239], a[156:159], v[36:39], v[236:239]
 s_or_b32 s100, s100, s3
 ds_read_b64_tr_b16 v[28:29], v7 offset:2048
 v_mfma_f32_16x16x32_bf16 v[236:239], a[152:155], v[32:35], v[236:239]
 s_waitcnt lgkmcnt(7)
 ds_read_b64_tr_b16 v[30:31], v7 offset:2304
 v_mfma_f32_16x16x32_bf16 v[240:243], a[128:131], v[40:43], v[240:243]
 s_mul_i32 s88, s100, s90
 ds_read_b64_tr_b16 v[32:33], v6 offset:4096
 v_mfma_f32_16x16x32_bf16 v[240:243], a[132:135], v[44:47], v[240:243]
 s_mul_i32 s89, s100, s91
 v_mfma_f32_16x16x32_bf16 v[244:247], a[140:143], v[44:47], v[244:247]
 s_add_u32 s94, s94, 40960
 ds_read_b64_tr_b16 v[34:35], v6 offset:4352
 v_mfma_f32_16x16x32_bf16 v[244:247], a[136:139], v[40:43], v[244:247]
 s_cmp_ge_u32 s94, s99
 v_mfma_f32_16x16x32_bf16 v[248:251], a[144:147], v[40:43], v[248:251]
 s_cselect_b32 s3, 163840, 0
 ds_read_b64_tr_b16 v[36:37], v6 offset:6144
 v_mfma_f32_16x16x32_bf16 v[248:251], a[148:151], v[44:47], v[248:251]
 s_sub_u32 s94, s94, s3
 v_mfma_f32_16x16x32_bf16 v[252:255], a[156:159], v[44:47], v[252:255]
 ds_read_b64_tr_b16 v[38:39], v6 offset:6400
 v_mfma_f32_16x16x32_bf16 v[252:255], a[152:155], v[40:43], v[252:255]
 s_branch L_g1_loopB
L_g1_outB:
L_g1_B:
 s_waitcnt lgkmcnt(8)
 v_mfma_f32_16x16x32_bf16 a[0:3], v[16:19], a[128:131], a[0:3]
 ds_read_b64_tr_b16 v[40:41], v7 offset:4096
 v_mfma_f32_16x16x32_bf16 a[0:3], v[20:23], a[132:135], a[0:3]
 buffer_load_dwordx4 a[160:163], v8, s[84:87], s92 offen offset:0 sc1
 v_mfma_f32_16x16x32_bf16 a[4:7], v[20:23], a[140:143], a[4:7]
 v_add_u32 v60, 40960, v4
 v_add_u32 v61, 40960, v5
 ds_read_b64_tr_b16 v[42:43], v7 offset:4352
 v_mfma_f32_16x16x32_bf16 a[4:7], v[16:19], a[136:139], a[4:7]
 v_mfma_f32_16x16x32_bf16 a[8:11], v[16:19], a[144:147], a[8:11]
 ds_read_b64_tr_b16 v[44:45], v7 offset:6144
 v_mfma_f32_16x16x32_bf16 a[8:11], v[20:23], a[148:151], a[8:11]
 buffer_load_dwordx4 a[164:167], v8, s[84:87], s92 offen offset:1024 sc1
 v_mfma_f32_16x16x32_bf16 a[12:15], v[20:23], a[156:159], a[12:15]
 v_add_u32 v62, 81920, v4
 v_add_u32 v63, 81920, v5
 ds_read_b64_tr_b16 v[46:47], v7 offset:6400
 v_mfma_f32_16x16x32_bf16 a[12:15], v[16:19], a[152:155], a[12:15]
 s_waitcnt lgkmcnt(8)
 v_mfma_f32_16x16x32_bf16 a[16:19], v[24:27], a[128:131], a[16:19]
 ds_read_b64_tr_b16 v[16:17], v6 offset:8192
 v_mfma_f32_16x16x32_bf16 a[16:19], v[28:31], a[132:135], a[16:19]
 buffer_load_dwordx4 a[168:171], v9, s[84:87], s92 offen offset:0 sc1
 v_mfma_f32_16x16x32_bf16 a[20:23], v[28:31], a[140:143], a[20:23]
 v_add_u32 v4, 122880, v4
 v_add_u32 v5, 122880, v5
 ds_read_b64_tr_b16 v[18:19], v6 offset:8448
 v_mfma_f32_16x16x32_bf16 a[20:23], v[24:27], a[136:139], a[20:23]
 v_mfma_f32_16x16x32_bf16 a[24:27], v[24:27], a[144:147], a[24:27]
 ds_read_b64_tr_b16 v[20:21], v6 offset:10240
 v_mfma_f32_16x16x32_bf16 a[24:27], v[28:31], a[148:151], a[24:27]
 buffer_load_dwordx4 a[172:175], v9, s[84:87], s92 offen offset:1024 sc1
 v_mfma_f32_16x16x32_bf16 a[28:31], v[28:31], a[156:159], a[28:31]
 ds_read_b64_tr_b16 v[22:23], v6 offset:10496
 v_mfma_f32_16x16x32_bf16 a[28:31], v[24:27], a[152:155], a[28:31]
 s_waitcnt lgkmcnt(8)
 v_mfma_f32_16x16x32_bf16 a[32:35], v[32:35], a[128:131], a[32:35]
 ds_read_b64_tr_b16 v[24:25], v7 offset:8192
 v_mfma_f32_16x16x32_bf16 a[32:35], v[36:39], a[132:135], a[32:35]
 buffer_load_dwordx4 a[176:179], v10, s[84:87], s92 offen offset:0 sc1
 v_mfma_f32_16x16x32_bf16 a[36:39], v[36:39], a[140:143], a[36:39]
 ds_read_b64_tr_b16 v[26:27], v7 offset:8448
 v_mfma_f32_16x16x32_bf16 a[36:39], v[32:35], a[136:139], a[36:39]
 v_mfma_f32_16x16x32_bf16 a[40:43], v[32:35], a[144:147], a[40:43]
 ds_read_b64_tr_b16 v[28:29], v7 offset:10240
 v_mfma_f32_16x16x32_bf16 a[40:43], v[36:39], a[148:151], a[40:43]
 buffer_load_dwordx4 a[180:183], v10, s[84:87], s92 offen offset:1024 sc1
 v_mfma_f32_16x16x32_bf16 a[44:47], v[36:39], a[156:159], a[44:47]
 ds_read_b64_tr_b16 v[30:31], v7 offset:10496
 v_mfma_f32_16x16x32_bf16 a[44:47], v[32:35], a[152:155], a[44:47]
 s_waitcnt lgkmcnt(8)
 v_mfma_f32_16x16x32_bf16 a[48:51], v[40:43], a[128:131], a[48:51]
 ds_read_b64_tr_b16 v[32:33], v6 offset:12288
 v_mfma_f32_16x16x32_bf16 a[48:51], v[44:47], a[132:135], a[48:51]
 buffer_load_dwordx4 a[184:187], v11, s[84:87], s92 offen offset:0 sc1
 v_mfma_f32_16x16x32_bf16 a[52:55], v[44:47], a[140:143], a[52:55]
 ds_read_b64_tr_b16 v[34:35], v6 offset:12544
 v_mfma_f32_16x16x32_bf16 a[52:55], v[40:43], a[136:139], a[52:55]
 v_mfma_f32_16x16x32_bf16 a[56:59], v[40:43], a[144:147], a[56:59]
 ds_read_b64_tr_b16 v[36:37], v6 offset:14336
 v_mfma_f32_16x16x32_bf16 a[56:59], v[44:47], a[148:151], a[56:59]
 buffer_load_dwordx4 a[188:191], v11, s[84:87], s92 offen offset:1024 sc1
 s_add_u32 s10, s10, 1
 s_cmp_lt_u32 s10, 4
 s_cselect_b32 s3, 1, 3
 s_add_u32 s92, s10, s11
 s_and_b32 s92, s92, s3
 s_andn2_b32 s3, s10, s3
 s_or_b32 s92, s92, s3
 s_lshl_b32 s92, s92, 11
 v_mfma_f32_16x16x32_bf16 a[60:63], v[44:47], a[156:159], a[60:63]
 ds_read_b64_tr_b16 v[38:39], v6 offset:14592
 v_mfma_f32_16x16x32_bf16 a[60:63], v[40:43], a[152:155], a[60:63]
 s_waitcnt lgkmcnt(8)
 v_mfma_f32_16x16x32_bf16 a[64:67], v[16:19], a[128:131], a[64:67]
 ds_read_b64_tr_b16 v[40:41], v7 offset:12288
 v_mfma_f32_16x16x32_bf16 a[64:67], v[20:23], a[132:135], a[64:67]
 buffer_load_dwordx4 a[192:195], v8, s[84:87], s92 offen offset:0 sc1
 v_mfma_f32_16x16x32_bf16 a[68:71], v[20:23], a[140:143], a[68:71]
 ds_read_b64_tr_b16 v[42:43], v7 offset:12544
 v_mfma_f32_16x16x32_bf16 a[68:71], v[16:19], a[136:139], a[68:71]
 v_mfma_f32_16x16x32_bf16 a[72:75], v[16:19], a[144:147], a[72:75]
 ds_read_b64_tr_b16 v[44:45], v7 offset:14336
 v_mfma_f32_16x16x32_bf16 a[72:75], v[20:23], a[148:151], a[72:75]
 buffer_load_dwordx4 a[196:199], v8, s[84:87], s92 offen offset:1024 sc1
 v_mfma_f32_16x16x32_bf16 a[76:79], v[20:23], a[156:159], a[76:79]
 ds_read_b64_tr_b16 v[46:47], v7 offset:14592
 v_mfma_f32_16x16x32_bf16 a[76:79], v[16:19], a[152:155], a[76:79]
 s_waitcnt lgkmcnt(8)
 v_mfma_f32_16x16x32_bf16 a[80:83], v[24:27], a[128:131], a[80:83]
 ds_read_b64_tr_b16 v[16:17], v60 offset:0
 v_mfma_f32_16x16x32_bf16 a[80:83], v[28:31], a[132:135], a[80:83]
 buffer_load_dwordx4 a[200:203], v9, s[84:87], s92 offen offset:0 sc1
 v_mfma_f32_16x16x32_bf16 a[84:87], v[28:31], a[140:143], a[84:87]
 ds_read_b64_tr_b16 v[18:19], v60 offset:256
 v_mfma_f32_16x16x32_bf16 a[84:87], v[24:27], a[136:139], a[84:87]
 v_mfma_f32_16x16x32_bf16 a[88:91], v[24:27], a[144:147], a[88:91]
 ds_read_b64_tr_b16 v[20:21], v60 offset:2048
 v_mfma_f32_16x16x32_bf16 a[88:91], v[28:31], a[148:151], a[88:91]
 buffer_load_dwordx4 a[204:207], v9, s[84:87], s92 offen offset:1024 sc1
 v_mfma_f32_16x16x32_bf16 a[92:95], v[28:31], a[156:159], a[92:95]
 ds_read_b64_tr_b16 v[22:23], v60 offset:2304
 v_mfma_f32_16x16x32_bf16 a[92:95], v[24:27], a[152:155], a[92:95]
 s_waitcnt lgkmcnt(8)
 v_mfma_f32_16x16x32_bf16 a[96:99], v[32:35], a[128:131], a[96:99]
 ds_read_b64_tr_b16 v[24:25], v61 offset:0
 v_mfma_f32_16x16x32_bf16 a[96:99], v[36:39], a[132:135], a[96:99]
 buffer_load_dwordx4 a[208:211], v10, s[84:87], s92 offen offset:0 sc1
 v_mfma_f32_16x16x32_bf16 a[100:103], v[36:39], a[140:143], a[100:103]
 ds_read_b64_tr_b16 v[26:27], v61 offset:256
 v_mfma_f32_16x16x32_bf16 a[100:103], v[32:35], a[136:139], a[100:103]
 v_mfma_f32_16x16x32_bf16 a[104:107], v[32:35], a[144:147], a[104:107]
 ds_read_b64_tr_b16 v[28:29], v61 offset:2048
 v_mfma_f32_16x16x32_bf16 a[104:107], v[36:39], a[148:151], a[104:107]
 buffer_load_dwordx4 a[212:215], v10, s[84:87], s92 offen offset:1024 sc1
 v_mfma_f32_16x16x32_bf16 a[108:111], v[36:39], a[156:159], a[108:111]
 ds_read_b64_tr_b16 v[30:31], v61 offset:2304
 v_mfma_f32_16x16x32_bf16 a[108:111], v[32:35], a[152:155], a[108:111]
 s_waitcnt lgkmcnt(8)
 v_mfma_f32_16x16x32_bf16 a[112:115], v[40:43], a[128:131], a[112:115]
 ds_read_b64_tr_b16 v[32:33], v60 offset:4096
 v_mfma_f32_16x16x32_bf16 a[112:115], v[44:47], a[132:135], a[112:115]
 buffer_load_dwordx4 a[216:219], v11, s[84:87], s92 offen offset:0 sc1
 v_mfma_f32_16x16x32_bf16 a[116:119], v[44:47], a[140:143], a[116:119]
 ds_read_b64_tr_b16 v[34:35], v60 offset:4352
 v_mfma_f32_16x16x32_bf16 a[116:119], v[40:43], a[136:139], a[116:119]
 v_mfma_f32_16x16x32_bf16 a[120:123], v[40:43], a[144:147], a[120:123]
 ds_read_b64_tr_b16 v[36:37], v60 offset:6144
 v_mfma_f32_16x16x32_bf16 a[120:123], v[44:47], a[148:151], a[120:123]
 buffer_load_dwordx4 a[220:223], v11, s[84:87], s92 offen offset:1024 sc1
 s_add_u32 s10, s10, 1
 s_cmp_lt_u32 s10, 4
 s_cselect_b32 s3, 1, 3
 s_add_u32 s92, s10, s11
 s_and_b32 s92, s92, s3
 s_andn2_b32 s3, s10, s3
 s_or_b32 s92, s92, s3
 s_lshl_b32 s92, s92, 11
 v_mfma_f32_16x16x32_bf16 a[124:127], v[44:47], a[156:159], a[124:127]
 ds_read_b64_tr_b16 v[38:39], v60 offset:6400
 v_mfma_f32_16x16x32_bf16 a[124:127], v[40:43], a[152:155], a[124:127]
 s_waitcnt vmcnt(8) lgkmcnt(8)
 v_mfma_f32_16x16x32_bf16 a[0:3], v[16:19], a[160:163], a[0:3]
 ds_read_b64_tr_b16 v[40:41], v61 offset:4096
 v_mfma_f32_16x16x32_bf16 a[0:3], v[20:23], a[164:167], a[0:3]
 s_add_u32 m0, s94, 0
 s_nop 0
 buffer_load_dwordx4 v2, s[40:43], s88 offen lds
 v_mfma_f32_16x16x32_bf16 a[4:7], v[20:23], a[172:175], a[4:7]
 ds_read_b64_tr_b16 v[42:43], v61 offset:4352
 v_mfma_f32_16x16x32_bf16 a[4:7], v[16:19], a[168:171], a[4:7]
 v_mfma_f32_16x16x32_bf16 a[8:11], v[16:19], a[176:179], a[8:11]
 ds_read_b64_tr_b16 v[44:45], v61 offset:6144
 v_mfma_f32_16x16x32_bf16 a[8:11], v[20:23], a[180:183], a[8:11]
 s_add_u32 m0, s94, 8192
 s_nop 0
 buffer_load_dwordx4 v2, s[48:51], s88 offen lds
 v_mfma_f32_16x16x32_bf16 a[12:15], v[20:23], a[188:191], a[12:15]
 s_mov_b32 s100, 0x3f317218
 ds_read_b64_tr_b16 v[46:47], v61 offset:6400
 v_mfma_f32_16x16x32_bf16 a[12:15], v[16:19], a[184:187], a[12:15]
 s_waitcnt lgkmcnt(8)
 v_mfma_f32_16x16x32_bf16 a[16:19], v[24:27], a[160:163], a[16:19]
 ds_read_b64_tr_b16 v[16:17], v60 offset:8192
 v_mfma_f32_16x16x32_bf16 a[16:19], v[28:31], a[164:167], a[16:19]
 s_add_u32 m0, s94, 4096
 s_nop 0
 buffer_load_dwordx4 v2, s[44:47], s88 offen lds
 v_mfma_f32_16x16x32_bf16 a[20:23], v[28:31], a[172:175], a[20:23]
 ds_read_b64_tr_b16 v[18:19], v60 offset:8448
 v_mfma_f32_16x16x32_bf16 a[20:23], v[24:27], a[168:171], a[20:23]
 v_mfma_f32_16x16x32_bf16 a[24:27], v[24:27], a[176:179], a[24:27]
 ds_read_b64_tr_b16 v[20:21], v60 offset:10240
 v_mfma_f32_16x16x32_bf16 a[24:27], v[28:31], a[180:183], a[24:27]
 s_add_u32 m0, s94, 12288
 s_nop 0
 buffer_load_dwordx4 v2, s[52:55], s88 offen lds
 v_mfma_f32_16x16x32_bf16 a[28:31], v[28:31], a[188:191], a[28:31]
 ds_read_b64_tr_b16 v[22:23], v60 offset:10496
 v_mfma_f32_16x16x32_bf16 a[28:31], v[24:27], a[184:187], a[28:31]
 s_waitcnt lgkmcnt(8)
 v_mfma_f32_16x16x32_bf16 a[32:35], v[32:35], a[160:163], a[32:35]
 ds_read_b64_tr_b16 v[24:25], v61 offset:8192
 v_mfma_f32_16x16x32_bf16 a[32:35], v[36:39], a[164:167], a[32:35]
 s_add_u32 m0, s94, 16384
 s_nop 0
 buffer_load_dwordx4 v3, s[56:59], s89 offen lds
 v_mfma_f32_16x16x32_bf16 a[36:39], v[36:39], a[172:175], a[36:39]
 ds_read_b64_tr_b16 v[26:27], v61 offset:8448
 v_mfma_f32_16x16x32_bf16 a[36:39], v[32:35], a[168:171], a[36:39]
 v_mfma_f32_16x16x32_bf16 a[40:43], v[32:35], a[176:179], a[40:43]
 ds_read_b64_tr_b16 v[28:29], v61 offset:10240
 v_mfma_f32_16x16x32_bf16 a[40:43], v[36:39], a[180:183], a[40:43]
 s_add_u32 m0, s94, 24576
 s_nop 0
 buffer_load_dwordx4 v3, s[64:67], s89 offen lds
 v_mfma_f32_16x16x32_bf16 a[44:47], v[36:39], a[188:191], a[44:47]
 ds_read_b64_tr_b16 v[30:31], v61 offset:10496
 v_mfma_f32_16x16x32_bf16 a[44:47], v[32:35], a[184:187], a[44:47]
 s_waitcnt lgkmcnt(8)
 v_mfma_f32_16x16x32_bf16 a[48:51], v[40:43], a[160:163], a[48:51]
 ds_read_b64_tr_b16 v[32:33], v60 offset:12288
 v_mfma_f32_16x16x32_bf16 a[48:51], v[44:47], a[164:167], a[48:51]
 s_add_u32 m0, s94, 20480
 s_nop 0
 buffer_load_dwordx4 v3, s[60:63], s89 offen lds
 v_mfma_f32_16x16x32_bf16 a[52:55], v[44:47], a[172:175], a[52:55]
 ds_read_b64_tr_b16 v[34:35], v60 offset:12544
 v_mfma_f32_16x16x32_bf16 a[52:55], v[40:43], a[168:171], a[52:55]
 v_mfma_f32_16x16x32_bf16 a[56:59], v[40:43], a[176:179], a[56:59]
 ds_read_b64_tr_b16 v[36:37], v60 offset:14336
 v_mfma_f32_16x16x32_bf16 a[56:59], v[44:47], a[180:183], a[56:59]
 s_add_u32 m0, s94, 28672
 s_nop 0
 buffer_load_dwordx4 v3, s[68:71], s89 offen lds
 v_mfma_f32_16x16x32_bf16 a[60:63], v[44:47], a[188:191], a[60:63]
 ds_read_b64_tr_b16 v[38:39], v60 offset:14592
 v_mfma_f32_16x16x32_bf16 a[60:63], v[40:43], a[184:187], a[60:63]
 s_waitcnt lgkmcnt(8)
 v_mfma_f32_16x16x32_bf16 a[64:67], v[16:19], a[160:163], a[64:67]
 ds_read_b64_tr_b16 v[40:41], v61 offset:12288
 v_mfma_f32_16x16x32_bf16 a[64:67], v[20:23], a[164:167], a[64:67]
 s_add_u32 m0, s94, 32768
 s_nop 0
 buffer_load_dwordx4 v3, s[72:75], s89 offen lds
 v_mfma_f32_16x16x32_bf16 a[68:71], v[20:23], a[172:175], a[68:71]
 ds_read_b64_tr_b16 v[42:43], v61 offset:12544
 v_mfma_f32_16x16x32_bf16 a[68:71], v[16:19], a[168:171], a[68:71]
 v_mfma_f32_16x16x32_bf16 a[72:75], v[16:19], a[176:179], a[72:75]
 ds_read_b64_tr_b16 v[44:45], v61 offset:14336
 v_mfma_f32_16x16x32_bf16 a[72:75], v[20:23], a[180:183], a[72:75]
 s_add_u32 m0, s94, 36864
 s_nop 0
 buffer_load_dwordx4 v3, s[76:79], s89 offen lds
 v_mfma_f32_16x16x32_bf16 a[76:79], v[20:23], a[188:191], a[76:79]
 ds_read_b64_tr_b16 v[46:47], v61 offset:14592
 v_mfma_f32_16x16x32_bf16 a[76:79], v[16:19], a[184:187], a[76:79]
 s_waitcnt lgkmcnt(8)
 s_waitcnt vmcnt(26)
 s_barrier
 v_mfma_f32_16x16x32_bf16 a[80:83], v[24:27], a[160:163], a[80:83]
 ds_read_b64_tr_b16 v[16:17], v62 offset:0
 v_mfma_f32_16x16x32_bf16 a[80:83], v[28:31], a[164:167], a[80:83]
 buffer_load_dwordx4 a[224:227], v8, s[84:87], s92 offen offset:0 sc1
 v_mfma_f32_16x16x32_bf16 a[84:87], v[28:31], a[172:175], a[84:87]
 ds_read_b64_tr_b16 v[18:19], v62 offset:256
 v_mfma_f32_16x16x32_bf16 a[84:87], v[24:27], a[168:171], a[84:87]
 v_mfma_f32_16x16x32_bf16 a[88:91], v[24:27], a[176:179], a[88:91]
 ds_read_b64_tr_b16 v[20:21], v62 offset:2048
 v_mfma_f32_16x16x32_bf16 a[88:91], v[28:31], a[180:183], a[88:91]
 buffer_load_dwordx4 a[228:231], v8, s[84:87], s92 offen offset:1024 sc1
 v_mfma_f32_16x16x32_bf16 a[92:95], v[28:31], a[188:191], a[92:95]
 ds_read_b64_tr_b16 v[22:23], v62 offset:2304
 v_mfma_f32_16x16x32_bf16 a[92:95], v[24:27], a[184:187], a[92:95]
 s_waitcnt lgkmcnt(8)
 v_mfma_f32_16x16x32_bf16 a[96:99], v[32:35], a[160:163], a[96:99]
 ds_read_b64_tr_b16 v[24:25], v63 offset:0
 v_mfma_f32_16x16x32_bf16 a[96:99], v[36:39], a[164:167], a[96:99]
 buffer_load_dwordx4 a[232:235], v9, s[84:87], s92 offen offset:0 sc1
 v_mfma_f32_16x16x32_bf16 a[100:103], v[36:39], a[172:175], a[100:103]
 ds_read_b64_tr_b16 v[26:27], v63 offset:256
 v_mfma_f32_16x16x32_bf16 a[100:103], v[32:35], a[168:171], a[100:103]
 v_mfma_f32_16x16x32_bf16 a[104:107], v[32:35], a[176:179], a[104:107]
 ds_read_b64_tr_b16 v[28:29], v63 offset:2048
 v_mfma_f32_16x16x32_bf16 a[104:107], v[36:39], a[180:183], a[104:107]
 buffer_load_dwordx4 a[236:239], v9, s[84:87], s92 offen offset:1024 sc1
 v_mfma_f32_16x16x32_bf16 a[108:111], v[36:39], a[188:191], a[108:111]
 ds_read_b64_tr_b16 v[30:31], v63 offset:2304
 v_mfma_f32_16x16x32_bf16 a[108:111], v[32:35], a[184:187], a[108:111]
 s_waitcnt lgkmcnt(8)
 v_mfma_f32_16x16x32_bf16 a[112:115], v[40:43], a[160:163], a[112:115]
 ds_read_b64_tr_b16 v[32:33], v62 offset:4096
 v_mfma_f32_16x16x32_bf16 a[112:115], v[44:47], a[164:167], a[112:115]
 buffer_load_dwordx4 a[240:243], v10, s[84:87], s92 offen offset:0 sc1
 v_mfma_f32_16x16x32_bf16 a[116:119], v[44:47], a[172:175], a[116:119]
 ds_read_b64_tr_b16 v[34:35], v62 offset:4352
 v_mfma_f32_16x16x32_bf16 a[116:119], v[40:43], a[168:171], a[116:119]
 v_mfma_f32_16x16x32_bf16 a[120:123], v[40:43], a[176:179], a[120:123]
 ds_read_b64_tr_b16 v[36:37], v62 offset:6144
 v_mfma_f32_16x16x32_bf16 a[120:123], v[44:47], a[180:183], a[120:123]
 buffer_load_dwordx4 a[244:247], v10, s[84:87], s92 offen offset:1024 sc1
 v_mfma_f32_16x16x32_bf16 a[124:127], v[44:47], a[188:191], a[124:127]
 ds_read_b64_tr_b16 v[38:39], v62 offset:6400
 v_mfma_f32_16x16x32_bf16 a[124:127], v[40:43], a[184:187], a[124:127]
 s_waitcnt vmcnt(16) lgkmcnt(8)
 v_mfma_f32_16x16x32_bf16 a[0:3], v[16:19], a[192:195], a[0:3]
 ds_read_b64_tr_b16 v[40:41], v63 offset:4096
 v_mfma_f32_16x16x32_bf16 a[0:3], v[20:23], a[196:199], a[0:3]
 buffer_load_dwordx4 a[248:251], v11, s[84:87], s92 offen offset:0 sc1
 v_mfma_f32_16x16x32_bf16 a[4:7], v[20:23], a[204:207], a[4:7]
 ds_read_b64_tr_b16 v[42:43], v63 offset:4352
 v_mfma_f32_16x16x32_bf16 a[4:7], v[16:19], a[200:203], a[4:7]
 v_mfma_f32_16x16x32_bf16 a[8:11], v[16:19], a[208:211], a[8:11]
 ds_read_b64_tr_b16 v[44:45], v63 offset:6144
 v_mfma_f32_16x16x32_bf16 a[8:11], v[20:23], a[212:215], a[8:11]
 buffer_load_dwordx4 a[252:255], v11, s[84:87], s92 offen offset:1024 sc1
 v_mfma_f32_16x16x32_bf16 a[12:15], v[20:23], a[220:223], a[12:15]
 ds_read_b64_tr_b16 v[46:47], v63 offset:6400
 v_mfma_f32_16x16x32_bf16 a[12:15], v[16:19], a[216:219], a[12:15]
 s_waitcnt lgkmcnt(8)
 v_mfma_f32_16x16x32_bf16 a[16:19], v[24:27], a[192:195], a[16:19]
 ds_read_b64_tr_b16 v[16:17], v62 offset:8192
 v_mfma_f32_16x16x32_bf16 a[16:19], v[28:31], a[196:199], a[16:19]
 v_mov_b32 v8, v60
 v_mov_b32 v9, v61
 v_mov_b32 v10, v62
 v_mov_b32 v11, v63
 v_mfma_f32_16x16x32_bf16 a[20:23], v[28:31], a[204:207], a[20:23]
 ds_read_b64_tr_b16 v[18:19], v62 offset:8448
 v_mfma_f32_16x16x32_bf16 a[20:23], v[24:27], a[200:203], a[20:23]
 v_mfma_f32_16x16x32_bf16 a[24:27], v[24:27], a[208:211], a[24:27]
 ds_read_b64_tr_b16 v[20:21], v62 offset:10240
 v_mfma_f32_16x16x32_bf16 a[24:27], v[28:31], a[212:215], a[24:27]
 v_mfma_f32_16x16x32_bf16 a[28:31], v[28:31], a[220:223], a[28:31]
 ds_read_b64_tr_b16 v[22:23], v62 offset:10496
 v_mfma_f32_16x16x32_bf16 a[28:31], v[24:27], a[216:219], a[28:31]
 s_waitcnt lgkmcnt(8)
 v_mfma_f32_16x16x32_bf16 a[32:35], v[32:35], a[192:195], a[32:35]
 ds_read_b64_tr_b16 v[24:25], v11 offset:8192
 v_mfma_f32_16x16x32_bf16 a[32:35], v[36:39], a[196:199], a[32:35]
 v_mfma_f32_16x16x32_bf16 a[36:39], v[36:39], a[204:207], a[36:39]
 ds_read_b64_tr_b16 v[26:27], v11 offset:8448
 v_mfma_f32_16x16x32_bf16 a[36:39], v[32:35], a[200:203], a[36:39]
 v_mfma_f32_16x16x32_bf16 a[40:43], v[32:35], a[208:211], a[40:43]
 ds_read_b64_tr_b16 v[28:29], v11 offset:10240
 v_mfma_f32_16x16x32_bf16 a[40:43], v[36:39], a[212:215], a[40:43]
 v_mfma_f32_16x16x32_bf16 a[44:47], v[36:39], a[220:223], a[44:47]
 ds_read_b64_tr_b16 v[30:31], v11 offset:10496
 v_mfma_f32_16x16x32_bf16 a[44:47], v[32:35], a[216:219], a[44:47]
 s_waitcnt lgkmcnt(8)
 v_mfma_f32_16x16x32_bf16 a[48:51], v[40:43], a[192:195], a[48:51]
 ds_read_b64_tr_b16 v[32:33], v10 offset:12288
 v_mfma_f32_16x16x32_bf16 a[48:51], v[44:47], a[196:199], a[48:51]
 v_mfma_f32_16x16x32_bf16 a[52:55], v[44:47], a[204:207], a[52:55]
 ds_read_b64_tr_b16 v[34:35], v10 offset:12544
 v_mfma_f32_16x16x32_bf16 a[52:55], v[40:43], a[200:203], a[52:55]
 v_mfma_f32_16x16x32_bf16 a[56:59], v[40:43], a[208:211], a[56:59]
 ds_read_b64_tr_b16 v[36:37], v10 offset:14336
 v_mfma_f32_16x16x32_bf16 a[56:59], v[44:47], a[212:215], a[56:59]
 v_mfma_f32_16x16x32_bf16 a[60:63], v[44:47], a[220:223], a[60:63]
 ds_read_b64_tr_b16 v[38:39], v10 offset:14592
 v_mfma_f32_16x16x32_bf16 a[60:63], v[40:43], a[216:219], a[60:63]
 s_waitcnt lgkmcnt(8)
 v_mfma_f32_16x16x32_bf16 a[64:67], v[16:19], a[192:195], a[64:67]
 ds_read_b64_tr_b16 v[40:41], v11 offset:12288
 v_mfma_f32_16x16x32_bf16 a[64:67], v[20:23], a[196:199], a[64:67]
 v_mfma_f32_16x16x32_bf16 a[68:71], v[20:23], a[204:207], a[68:71]
 ds_read_b64_tr_b16 v[42:43], v11 offset:12544
 v_mfma_f32_16x16x32_bf16 a[68:71], v[16:19], a[200:203], a[68:71]
 v_mfma_f32_16x16x32_bf16 a[72:75], v[16:19], a[208:211], a[72:75]
 ds_read_b64_tr_b16 v[44:45], v11 offset:14336
 v_mfma_f32_16x16x32_bf16 a[72:75], v[20:23], a[212:215], a[72:75]
 v_mfma_f32_16x16x32_bf16 a[76:79], v[20:23], a[220:223], a[76:79]
 ds_read_b64_tr_b16 v[46:47], v11 offset:14592
 v_mfma_f32_16x16x32_bf16 a[76:79], v[16:19], a[216:219], a[76:79]
 s_waitcnt lgkmcnt(8)
 s_waitcnt vmcnt(8)
 s_barrier
 v_mfma_f32_16x16x32_bf16 a[80:83], v[24:27], a[192:195], a[80:83]
 ds_read_b64_tr_b16 v[16:17], v4 offset:0
 v_mfma_f32_16x16x32_bf16 a[80:83], v[28:31], a[196:199], a[80:83]
 v_mfma_f32_16x16x32_bf16 a[84:87], v[28:31], a[204:207], a[84:87]
 ds_read_b64_tr_b16 v[18:19], v4 offset:256
 v_mfma_f32_16x16x32_bf16 a[84:87], v[24:27], a[200:203], a[84:87]
 v_mfma_f32_16x16x32_bf16 a[88:91], v[24:27], a[208:211], a[88:91]
 ds_read_b64_tr_b16 v[20:21], v4 offset:2048
 v_mfma_f32_16x16x32_bf16 a[88:91], v[28:31], a[212:215], a[88:91]
 v_mfma_f32_16x16x32_bf16 a[92:95], v[28:31], a[220:223], a[92:95]
 ds_read_b64_tr_b16 v[22:23], v4 offset:2304
 v_mfma_f32_16x16x32_bf16 a[92:95], v[24:27], a[216:219], a[92:95]
 s_waitcnt lgkmcnt(8)
 v_mfma_f32_16x16x32_bf16 a[96:99], v[32:35], a[192:195], a[96:99]
 ds_read_b64_tr_b16 v[24:25], v5 offset:0
 v_mfma_f32_16x16x32_bf16 a[96:99], v[36:39], a[196:199], a[96:99]
 v_mfma_f32_16x16x32_bf16 a[100:103], v[36:39], a[204:207], a[100:103]
 ds_read_b64_tr_b16 v[26:27], v5 offset:256
 v_mfma_f32_16x16x32_bf16 a[100:103], v[32:35], a[200:203], a[100:103]
 v_mfma_f32_16x16x32_bf16 a[104:107], v[32:35], a[208:211], a[104:107]
 ds_read_b64_tr_b16 v[28:29], v5 offset:2048
 v_mfma_f32_16x16x32_bf16 a[104:107], v[36:39], a[212:215], a[104:107]
 v_mfma_f32_16x16x32_bf16 a[108:111], v[36:39], a[220:223], a[108:111]
 ds_read_b64_tr_b16 v[30:31], v5 offset:2304
 v_mfma_f32_16x16x32_bf16 a[108:111], v[32:35], a[216:219], a[108:111]
 s_waitcnt lgkmcnt(8)
 v_mfma_f32_16x16x32_bf16 a[112:115], v[40:43], a[192:195], a[112:115]
 ds_read_b64_tr_b16 v[32:33], v4 offset:4096
 v_mfma_f32_16x16x32_bf16 a[112:115], v[44:47], a[196:199], a[112:115]
 v_mfma_f32_16x16x32_bf16 a[116:119], v[44:47], a[204:207], a[116:119]
 ds_read_b64_tr_b16 v[34:35], v4 offset:4352
 v_mfma_f32_16x16x32_bf16 a[116:119], v[40:43], a[200:203], a[116:119]
 v_mfma_f32_16x16x32_bf16 a[120:123], v[40:43], a[208:211], a[120:123]
 ds_read_b64_tr_b16 v[36:37], v4 offset:6144
 v_mfma_f32_16x16x32_bf16 a[120:123], v[44:47], a[212:215], a[120:123]
 v_mfma_f32_16x16x32_bf16 a[124:127], v[44:47], a[220:223], a[124:127]
 ds_read_b64_tr_b16 v[38:39], v4 offset:6400
 v_mfma_f32_16x16x32_bf16 a[124:127], v[40:43], a[216:219], a[124:127]
 s_waitcnt vmcnt(0) lgkmcnt(8)
 v_mfma_f32_16x16x32_bf16 a[0:3], v[16:19], a[224:227], a[0:3]
 ds_read_b64_tr_b16 v[40:41], v5 offset:4096
 v_mfma_f32_16x16x32_bf16 a[0:3], v[20:23], a[228:231], a[0:3]
 v_mfma_f32_16x16x32_bf16 a[4:7], v[20:23], a[236:239], a[4:7]
 ds_read_b64_tr_b16 v[42:43], v5 offset:4352
 v_mfma_f32_16x16x32_bf16 a[4:7], v[16:19], a[232:235], a[4:7]
 v_mfma_f32_16x16x32_bf16 a[8:11], v[16:19], a[240:243], a[8:11]
 ds_read_b64_tr_b16 v[44:45], v5 offset:6144
 v_mfma_f32_16x16x32_bf16 a[8:11], v[20:23], a[244:247], a[8:11]
 v_mfma_f32_16x16x32_bf16 a[12:15], v[20:23], a[252:255], a[12:15]
 ds_read_b64_tr_b16 v[46:47], v5 offset:6400
 v_mfma_f32_16x16x32_bf16 a[12:15], v[16:19], a[248:251], a[12:15]
 s_waitcnt lgkmcnt(8)
 v_mfma_f32_16x16x32_bf16 a[16:19], v[24:27], a[224:227], a[16:19]
 ds_read_b64_tr_b16 v[16:17], v4 offset:8192
 v_mfma_f32_16x16x32_bf16 a[16:19], v[28:31], a[228:231], a[16:19]
 v_lshlrev_b32 v15, 3, v15
 v_mfma_f32_16x16x32_bf16 a[20:23], v[28:31], a[236:239], a[20:23]
 ds_read_b64_tr_b16 v[18:19], v4 offset:8448
 s_mov_b32 s16, s12
 v_mfma_f32_16x16x32_bf16 a[20:23], v[24:27], a[232:235], a[20:23]
 s_mov_b32 s17, s13
 v_mfma_f32_16x16x32_bf16 a[24:27], v[24:27], a[240:243], a[24:27]
 ds_read_b64_tr_b16 v[20:21], v4 offset:10240
 s_mov_b32 s18, 0x0
 v_mfma_f32_16x16x32_bf16 a[24:27], v[28:31], a[244:247], a[24:27]
 s_mov_b32 s19, 0x20000
 v_mfma_f32_16x16x32_bf16 a[28:31], v[28:31], a[252:255], a[28:31]
 ds_read_b64_tr_b16 v[22:23], v4 offset:10496
 s_add_u32 s18, s15, 2048
 v_mfma_f32_16x16x32_bf16 a[28:31], v[24:27], a[248:251], a[28:31]
 s_waitcnt lgkmcnt(8)
 s_add_u32 s82, s14, 7168
 v_mfma_f32_16x16x32_bf16 a[32:35], v[32:35], a[224:227], a[32:35]
 ds_read_b64_tr_b16 v[24:25], v5 offset:8192
 v_lshlrev_b32 v15, 4, v15
 v_mfma_f32_16x16x32_bf16 a[32:35], v[36:39], a[228:231], a[32:35]
 s_nop 0
 v_mfma_f32_16x16x32_bf16 a[36:39], v[36:39], a[236:239], a[36:39]
 ds_read_b64_tr_b16 v[26:27], v5 offset:8448
 v_lshrrev_b32 v0, 1, v15
 v_mfma_f32_16x16x32_bf16 a[36:39], v[32:35], a[232:235], a[36:39]
 v_add_u32 v0, 384, v0
 v_mfma_f32_16x16x32_bf16 a[40:43], v[32:35], a[240:243], a[40:43]
 ds_read_b64_tr_b16 v[28:29], v5 offset:10240
 s_nop 0
 v_mfma_f32_16x16x32_bf16 a[40:43], v[36:39], a[244:247], a[40:43]
 buffer_load_dword v1, v0, s[80:83], s14 offen
 v_mfma_f32_16x16x32_bf16 a[44:47], v[36:39], a[252:255], a[44:47]
 ds_read_b64_tr_b16 v[30:31], v5 offset:10496
 s_mul_i32 s14, s15, 7
 v_mfma_f32_16x16x32_bf16 a[44:47], v[32:35], a[248:251], a[44:47]
 s_waitcnt lgkmcnt(8)
 s_lshr_b32 s14, s14, 4
 v_mfma_f32_16x16x32_bf16 a[48:51], v[40:43], a[224:227], a[48:51]
 ds_read_b64_tr_b16 v[32:33], v4 offset:12288
 s_add_u32 s82, s14, 896
 v_mfma_f32_16x16x32_bf16 a[48:51], v[44:47], a[228:231], a[48:51]
 v_lshrrev_b32 v15, 4, v15
 v_mfma_f32_16x16x32_bf16 a[52:55], v[44:47], a[236:239], a[52:55]
 ds_read_b64_tr_b16 v[34:35], v4 offset:12544
 s_nop 0
 v_mfma_f32_16x16x32_bf16 a[52:55], v[40:43], a[232:235], a[52:55]
 buffer_load_dword v1, v15, s[80:83], s14 offen
 v_mfma_f32_16x16x32_bf16 a[56:59], v[40:43], a[240:243], a[56:59]
 ds_read_b64_tr_b16 v[36:37], v4 offset:14336
 s_add_u32 s14, s14, 917504
 v_mfma_f32_16x16x32_bf16 a[56:59], v[44:47], a[244:247], a[56:59]
 s_add_u32 s82, s14, 896
 v_mfma_f32_16x16x32_bf16 a[60:63], v[44:47], a[252:255], a[60:63]
 ds_read_b64_tr_b16 v[38:39], v4 offset:14592
 buffer_load_dword v1, v15, s[80:83], s14 offen
 v_mfma_f32_16x16x32_bf16 a[60:63], v[40:43], a[248:251], a[60:63]
 s_waitcnt lgkmcnt(8)
 s_lshl_b32 s3, s2, 2
 v_mfma_f32_16x16x32_bf16 a[64:67], v[16:19], a[224:227], a[64:67]
 ds_read_b64_tr_b16 v[40:41], v5 offset:12288
 s_add_u32 s3, s3, s95
 v_mfma_f32_16x16x32_bf16 a[64:67], v[20:23], a[228:231], a[64:67]
 s_and_b32 s3, s3, 255
 v_mfma_f32_16x16x32_bf16 a[68:71], v[20:23], a[236:239], a[68:71]
 ds_read_b64_tr_b16 v[42:43], v5 offset:12544
 s_mul_i32 s3, s3, 128
 v_mfma_f32_16x16x32_bf16 a[68:71], v[16:19], a[232:235], a[68:71]
 v_min_u32 v52, 0, v0
 v_mfma_f32_16x16x32_bf16 a[72:75], v[16:19], a[240:243], a[72:75]
 ds_read_b64_tr_b16 v[44:45], v5 offset:14336
 v_lshlrev_b32 v52, 7, v52
 v_mfma_f32_16x16x32_bf16 a[72:75], v[20:23], a[244:247], a[72:75]
 v_add_u32 v52, s3, v52
 v_mfma_f32_16x16x32_bf16 a[76:79], v[20:23], a[252:255], a[76:79]
 ds_read_b64_tr_b16 v[46:47], v5 offset:14592
 v_min_u32 v52, L_b_end - attfin_kernel - 4, v52
 v_mfma_f32_16x16x32_bf16 a[76:79], v[16:19], a[248:251], a[76:79]
 s_waitcnt lgkmcnt(8)
 s_getpc_b64 s[16:17]
 v_mfma_f32_16x16x32_bf16 a[80:83], v[24:27], a[224:227], a[80:83]
 ds_read_b64_tr_b16 v[16:17], v6 offset:16384
 s_add_u32 s16, s16, attfin_kernel - .
 v_mfma_f32_16x16x32_bf16 a[80:83], v[28:31], a[228:231], a[80:83]
 s_addc_u32 s17, s17, 0
 v_mfma_f32_16x16x32_bf16 a[84:87], v[28:31], a[236:239], a[84:87]
 ds_read_b64_tr_b16 v[18:19], v6 offset:16640
 v_mov_b32 v53, s17
 v_mfma_f32_16x16x32_bf16 a[84:87], v[24:27], a[232:235], a[84:87]
 v_add_co_u32 v52, vcc, s16, v52
 v_mfma_f32_16x16x32_bf16 a[88:91], v[24:27], a[240:243], a[88:91]
 ds_read_b64_tr_b16 v[20:21], v6 offset:18432
 s_nop 1
 v_mfma_f32_16x16x32_bf16 a[88:91], v[28:31], a[244:247], a[88:91]
 v_addc_co_u32 v53, vcc, 0, v53, vcc
 v_mfma_f32_16x16x32_bf16 a[92:95], v[28:31], a[252:255], a[92:95]
 ds_read_b64_tr_b16 v[22:23], v6 offset:18688
 global_load_dword v1, v[52:53], off
 v_mfma_f32_16x16x32_bf16 a[92:95], v[24:27], a[248:251], a[92:95]
 s_waitcnt lgkmcnt(8)
 s_mul_i32 s4, s97, 10
 s_add_i32 s4, s4, -224
 v_mfma_f32_16x16x32_bf16 a[96:99], v[32:35], a[224:227], a[96:99]
 ds_read_b64_tr_b16 v[24:25], v7 offset:16384
 s_lshr_b32 s8, s4, 5
 s_and_b32 s4, s4, 31
 v_mfma_f32_16x16x32_bf16 a[96:99], v[36:39], a[228:231], a[96:99]
 s_lshl_b32 s4, s4, 18
 v_mfma_f32_16x16x32_bf16 a[100:103], v[36:39], a[236:239], a[100:103]
 ds_read_b64_tr_b16 v[26:27], v7 offset:16640
 s_cmp_eq_u32 s8, 0
 s_cselect_b32 s7, 0x3e3504f3, s100
 v_mfma_f32_16x16x32_bf16 a[100:103], v[32:35], a[232:235], a[100:103]
 s_cselect_b32 s8, 0, 0x800000
 s_add_u32 s4, s4, s8
 v_mfma_f32_16x16x32_bf16 a[104:107], v[32:35], a[240:243], a[104:107]
 ds_read_b64_tr_b16 v[28:29], v7 offset:18432
 v_accvgpr_read_b32 v48, a0
 v_mfma_f32_16x16x32_bf16 a[104:107], v[36:39], a[244:247], a[104:107]
 v_accvgpr_read_b32 v49, a1
 v_accvgpr_read_b32 v50, a2
 v_mfma_f32_16x16x32_bf16 a[108:111], v[36:39], a[252:255], a[108:111]
 ds_read_b64_tr_b16 v[30:31], v7 offset:18688
 v_accvgpr_read_b32 v51, a3
 v_mfma_f32_16x16x32_bf16 a[108:111], v[32:35], a[248:251], a[108:111]
 s_waitcnt lgkmcnt(8)
 v_accvgpr_read_b32 v52, a16
 v_accvgpr_read_b32 v53, a17
 v_mfma_f32_16x16x32_bf16 a[112:115], v[40:43], a[224:227], a[112:115]
 ds_read_b64_tr_b16 v[32:33], v6 offset:20480
 v_accvgpr_read_b32 v54, a18
 v_accvgpr_read_b32 v55, a19
 v_mfma_f32_16x16x32_bf16 a[112:115], v[44:47], a[228:231], a[112:115]
 v_mul_f32 v48, s7, v48
 v_mfma_f32_16x16x32_bf16 a[116:119], v[44:47], a[236:239], a[116:119]
 ds_read_b64_tr_b16 v[34:35], v6 offset:20736
 v_mul_f32 v49, s7, v49
 v_mul_f32 v50, s7, v50
 v_mfma_f32_16x16x32_bf16 a[116:119], v[40:43], a[232:235], a[116:119]
 v_mul_f32 v51, s7, v51
 v_mul_f32 v52, s7, v52
 v_mfma_f32_16x16x32_bf16 a[120:123], v[40:43], a[240:243], a[120:123]
 ds_read_b64_tr_b16 v[36:37], v6 offset:22528
 v_mul_f32 v53, s7, v53
 v_mfma_f32_16x16x32_bf16 a[120:123], v[44:47], a[244:247], a[120:123]
 v_mul_f32 v54, s7, v54
 v_mul_f32 v55, s7, v55
 v_mfma_f32_16x16x32_bf16 a[124:127], v[44:47], a[252:255], a[124:127]
 ds_read_b64_tr_b16 v[38:39], v6 offset:22784
 v_cvt_pk_bf16_f32 v56, v48, v49
 v_mfma_f32_16x16x32_bf16 a[124:127], v[40:43], a[248:251], a[124:127]
 s_waitcnt lgkmcnt(8)
 v_cvt_pk_bf16_f32 v57, v50, v51
 v_cvt_pk_bf16_f32 v58, v52, v53
 v_mfma_f32_16x16x32_bf16 v[64:67], v[16:19], a[128:131], v[64:67]
 ds_read_b64_tr_b16 v[40:41], v7 offset:20480
 v_cvt_pk_bf16_f32 v59, v54, v55
 s_add_u32 s5, s4, 0
 v_mfma_f32_16x16x32_bf16 v[64:67], v[20:23], a[132:135], v[64:67]
 buffer_store_dwordx4 v[56:59], v13, s[84:87], s5 offen offset:0 sc1
 v_mfma_f32_16x16x32_bf16 v[68:71], v[20:23], a[140:143], v[68:71]
 ds_read_b64_tr_b16 v[42:43], v7 offset:20736
 v_accvgpr_read_b32 v48, a4
 v_accvgpr_read_b32 v49, a5
 v_mfma_f32_16x16x32_bf16 v[68:71], v[16:19], a[136:139], v[68:71]
 v_accvgpr_read_b32 v50, a6
 v_accvgpr_read_b32 v51, a7
 v_mfma_f32_16x16x32_bf16 v[72:75], v[16:19], a[144:147], v[72:75]
 ds_read_b64_tr_b16 v[44:45], v7 offset:22528
 v_accvgpr_read_b32 v52, a20
 v_mfma_f32_16x16x32_bf16 v[72:75], v[20:23], a[148:151], v[72:75]
 v_accvgpr_read_b32 v53, a21
 v_accvgpr_read_b32 v54, a22
 v_mfma_f32_16x16x32_bf16 v[76:79], v[20:23], a[156:159], v[76:79]
 ds_read_b64_tr_b16 v[46:47], v7 offset:22784
 v_accvgpr_read_b32 v55, a23
 v_mfma_f32_16x16x32_bf16 v[76:79], v[16:19], a[152:155], v[76:79]
 s_waitcnt lgkmcnt(8)
 v_mul_f32 v48, s7, v48
 v_mul_f32 v49, s7, v49
 v_mfma_f32_16x16x32_bf16 v[80:83], v[24:27], a[128:131], v[80:83]
 ds_read_b64_tr_b16 v[16:17], v8 offset:16384
 v_mul_f32 v50, s7, v50
 v_mul_f32 v51, s7, v51
 v_mfma_f32_16x16x32_bf16 v[80:83], v[28:31], a[132:135], v[80:83]
 v_mul_f32 v52, s7, v52
 v_mfma_f32_16x16x32_bf16 v[84:87], v[28:31], a[140:143], v[84:87]
 ds_read_b64_tr_b16 v[18:19], v8 offset:16640
 v_mul_f32 v53, s7, v53
 v_mul_f32 v54, s7, v54
 v_mfma_f32_16x16x32_bf16 v[84:87], v[24:27], a[136:139], v[84:87]
 v_mul_f32 v55, s7, v55
 v_cvt_pk_bf16_f32 v60, v48, v49
 v_mfma_f32_16x16x32_bf16 v[88:91], v[24:27], a[144:147], v[88:91]
 ds_read_b64_tr_b16 v[20:21], v8 offset:18432
 v_cvt_pk_bf16_f32 v61, v50, v51
 v_mfma_f32_16x16x32_bf16 v[88:91], v[28:31], a[148:151], v[88:91]
 v_cvt_pk_bf16_f32 v62, v52, v53
 v_cvt_pk_bf16_f32 v63, v54, v55
 v_mfma_f32_16x16x32_bf16 v[92:95], v[28:31], a[156:159], v[92:95]
 ds_read_b64_tr_b16 v[22:23], v8 offset:18688
 s_add_u32 s5, s4, 0
 v_mfma_f32_16x16x32_bf16 v[92:95], v[24:27], a[152:155], v[92:95]
 s_waitcnt lgkmcnt(8)
 buffer_store_dwordx4 v[60:63], v13, s[84:87], s5 offen offset:128 sc1
 v_accvgpr_read_b32 v48, a8
 v_mfma_f32_16x16x32_bf16 v[96:99], v[32:35], a[128:131], v[96:99]
 ds_read_b64_tr_b16 v[24:25], v9 offset:16384
 v_accvgpr_read_b32 v49, a9
 v_accvgpr_read_b32 v50, a10
 v_mfma_f32_16x16x32_bf16 v[96:99], v[36:39], a[132:135], v[96:99]
 v_accvgpr_read_b32 v51, a11
 v_mfma_f32_16x16x32_bf16 v[100:103], v[36:39], a[140:143], v[100:103]
 ds_read_b64_tr_b16 v[26:27], v9 offset:16640
 v_accvgpr_read_b32 v52, a24
 v_accvgpr_read_b32 v53, a25
 v_mfma_f32_16x16x32_bf16 v[100:103], v[32:35], a[136:139], v[100:103]
 v_accvgpr_read_b32 v54, a26
 v_accvgpr_read_b32 v55, a27
 v_mfma_f32_16x16x32_bf16 v[104:107], v[32:35], a[144:147], v[104:107]
 ds_read_b64_tr_b16 v[28:29], v9 offset:18432
 v_mul_f32 v48, s7, v48
 v_mfma_f32_16x16x32_bf16 v[104:107], v[36:39], a[148:151], v[104:107]
 v_mul_f32 v49, s7, v49
 v_mul_f32 v50, s7, v50
 v_mfma_f32_16x16x32_bf16 v[108:111], v[36:39], a[156:159], v[108:111]
 ds_read_b64_tr_b16 v[30:31], v9 offset:18688
 v_mul_f32 v51, s7, v51
 v_mfma_f32_16x16x32_bf16 v[108:111], v[32:35], a[152:155], v[108:111]
 s_waitcnt lgkmcnt(8)
 v_mul_f32 v52, s7, v52
 v_mul_f32 v53, s7, v53
 v_mfma_f32_16x16x32_bf16 v[112:115], v[40:43], a[128:131], v[112:115]
 ds_read_b64_tr_b16 v[32:33], v8 offset:20480
 v_mul_f32 v54, s7, v54
 v_mul_f32 v55, s7, v55
 v_mfma_f32_16x16x32_bf16 v[112:115], v[44:47], a[132:135], v[112:115]
 v_cvt_pk_bf16_f32 v56, v48, v49
 v_mfma_f32_16x16x32_bf16 v[116:119], v[44:47], a[140:143], v[116:119]
 ds_read_b64_tr_b16 v[34:35], v8 offset:20736
 v_cvt_pk_bf16_f32 v57, v50, v51
 v_cvt_pk_bf16_f32 v58, v52, v53
 v_mfma_f32_16x16x32_bf16 v[116:119], v[40:43], a[136:139], v[116:119]
 v_cvt_pk_bf16_f32 v59, v54, v55
 s_add_u32 s5, s4, 4096
 v_mfma_f32_16x16x32_bf16 v[120:123], v[40:43], a[144:147], v[120:123]
 ds_read_b64_tr_b16 v[36:37], v8 offset:22528
 buffer_store_dwordx4 v[56:59], v13, s[84:87], s5 offen offset:0 sc1
 v_mfma_f32_16x16x32_bf16 v[120:123], v[44:47], a[148:151], v[120:123]
 v_accvgpr_read_b32 v48, a12
 v_accvgpr_read_b32 v49, a13
 v_mfma_f32_16x16x32_bf16 v[124:127], v[44:47], a[156:159], v[124:127]
 ds_read_b64_tr_b16 v[38:39], v8 offset:22784
 v_accvgpr_read_b32 v50, a14
 v_mfma_f32_16x16x32_bf16 v[124:127], v[40:43], a[152:155], v[124:127]
 s_waitcnt lgkmcnt(8)
 v_accvgpr_read_b32 v51, a15
 v_accvgpr_read_b32 v52, a28
 v_mfma_f32_16x16x32_bf16 v[64:67], v[16:19], a[160:163], v[64:67]
 ds_read_b64_tr_b16 v[40:41], v9 offset:20480
 v_accvgpr_read_b32 v53, a29
 v_accvgpr_read_b32 v54, a30
 v_mfma_f32_16x16x32_bf16 v[64:67], v[20:23], a[164:167], v[64:67]
 v_accvgpr_read_b32 v55, a31
 v_mfma_f32_16x16x32_bf16 v[68:71], v[20:23], a[172:175], v[68:71]
 ds_read_b64_tr_b16 v[42:43], v9 offset:20736
 v_mul_f32 v48, s7, v48
 v_mul_f32 v49, s7, v49
 v_mfma_f32_16x16x32_bf16 v[68:71], v[16:19], a[168:171], v[68:71]
 v_mul_f32 v50, s7, v50
 v_mul_f32 v51, s7, v51
 v_mfma_f32_16x16x32_bf16 v[72:75], v[16:19], a[176:179], v[72:75]
 ds_read_b64_tr_b16 v[44:45], v9 offset:22528
 v_mul_f32 v52, s7, v52
 v_mfma_f32_16x16x32_bf16 v[72:75], v[20:23], a[180:183], v[72:75]
 v_mul_f32 v53, s7, v53
 v_mul_f32 v54, s7, v54
 v_mfma_f32_16x16x32_bf16 v[76:79], v[20:23], a[188:191], v[76:79]
 ds_read_b64_tr_b16 v[46:47], v9 offset:22784
 v_mul_f32 v55, s7, v55
 v_mfma_f32_16x16x32_bf16 v[76:79], v[16:19], a[184:187], v[76:79]
 s_waitcnt lgkmcnt(8)
 v_cvt_pk_bf16_f32 v60, v48, v49
 v_cvt_pk_bf16_f32 v61, v50, v51
 v_mfma_f32_16x16x32_bf16 v[80:83], v[24:27], a[160:163], v[80:83]
 ds_read_b64_tr_b16 v[16:17], v10 offset:16384
 v_cvt_pk_bf16_f32 v62, v52, v53
 v_cvt_pk_bf16_f32 v63, v54, v55
 v_mfma_f32_16x16x32_bf16 v[80:83], v[28:31], a[164:167], v[80:83]
 s_add_u32 s5, s4, 4096
 v_mfma_f32_16x16x32_bf16 v[84:87], v[28:31], a[172:175], v[84:87]
 ds_read_b64_tr_b16 v[18:19], v10 offset:16640
 buffer_store_dwordx4 v[60:63], v13, s[84:87], s5 offen offset:128 sc1
 s_mul_i32 s4, s97, 10
 v_mfma_f32_16x16x32_bf16 v[84:87], v[24:27], a[168:171], v[84:87]
 s_add_i32 s4, s4, -222
 s_lshr_b32 s8, s4, 5
 v_mfma_f32_16x16x32_bf16 v[88:91], v[24:27], a[176:179], v[88:91]
 ds_read_b64_tr_b16 v[20:21], v10 offset:18432
 s_and_b32 s4, s4, 31
 v_mfma_f32_16x16x32_bf16 v[88:91], v[28:31], a[180:183], v[88:91]
 s_lshl_b32 s4, s4, 18
 s_cmp_eq_u32 s8, 0
 v_mfma_f32_16x16x32_bf16 v[92:95], v[28:31], a[188:191], v[92:95]
 ds_read_b64_tr_b16 v[22:23], v10 offset:18688
 s_cselect_b32 s7, 0x3e3504f3, s100
 v_mfma_f32_16x16x32_bf16 v[92:95], v[24:27], a[184:187], v[92:95]
 s_waitcnt lgkmcnt(8)
 s_cselect_b32 s8, 0, 0x800000
 s_add_u32 s4, s4, s8
 v_mfma_f32_16x16x32_bf16 v[96:99], v[32:35], a[160:163], v[96:99]
 ds_read_b64_tr_b16 v[24:25], v11 offset:16384
 v_accvgpr_read_b32 v48, a32
 v_accvgpr_read_b32 v49, a33
 v_mfma_f32_16x16x32_bf16 v[96:99], v[36:39], a[164:167], v[96:99]
 v_accvgpr_read_b32 v50, a34
 v_mfma_f32_16x16x32_bf16 v[100:103], v[36:39], a[172:175], v[100:103]
 ds_read_b64_tr_b16 v[26:27], v11 offset:16640
 v_accvgpr_read_b32 v51, a35
 v_accvgpr_read_b32 v52, a48
 v_mfma_f32_16x16x32_bf16 v[100:103], v[32:35], a[168:171], v[100:103]
 v_accvgpr_read_b32 v53, a49
 v_accvgpr_read_b32 v54, a50
 v_mfma_f32_16x16x32_bf16 v[104:107], v[32:35], a[176:179], v[104:107]
 ds_read_b64_tr_b16 v[28:29], v11 offset:18432
 v_accvgpr_read_b32 v55, a51
 v_mfma_f32_16x16x32_bf16 v[104:107], v[36:39], a[180:183], v[104:107]
 v_mul_f32 v48, s7, v48
 v_mul_f32 v49, s7, v49
 v_mfma_f32_16x16x32_bf16 v[108:111], v[36:39], a[188:191], v[108:111]
 ds_read_b64_tr_b16 v[30:31], v11 offset:18688
 v_mul_f32 v50, s7, v50
 v_mfma_f32_16x16x32_bf16 v[108:111], v[32:35], a[184:187], v[108:111]
 s_waitcnt lgkmcnt(8)
 v_mul_f32 v51, s7, v51
 v_mul_f32 v52, s7, v52
 v_mfma_f32_16x16x32_bf16 v[112:115], v[40:43], a[160:163], v[112:115]
 ds_read_b64_tr_b16 v[32:33], v10 offset:20480
 v_mul_f32 v53, s7, v53
 v_mul_f32 v54, s7, v54
 v_mfma_f32_16x16x32_bf16 v[112:115], v[44:47], a[164:167], v[112:115]
 v_mul_f32 v55, s7, v55
 v_mfma_f32_16x16x32_bf16 v[116:119], v[44:47], a[172:175], v[116:119]
 ds_read_b64_tr_b16 v[34:35], v10 offset:20736
 v_cvt_pk_bf16_f32 v56, v48, v49
 v_cvt_pk_bf16_f32 v57, v50, v51
 v_mfma_f32_16x16x32_bf16 v[116:119], v[40:43], a[168:171], v[116:119]
 v_cvt_pk_bf16_f32 v58, v52, v53
 v_cvt_pk_bf16_f32 v59, v54, v55
 v_mfma_f32_16x16x32_bf16 v[120:123], v[40:43], a[176:179], v[120:123]
 ds_read_b64_tr_b16 v[36:37], v10 offset:22528
 s_add_u32 s5, s4, 0
 v_mfma_f32_16x16x32_bf16 v[120:123], v[44:47], a[180:183], v[120:123]
 buffer_store_dwordx4 v[56:59], v13, s[84:87], s5 offen offset:0 sc1
 v_accvgpr_read_b32 v48, a36
 v_mfma_f32_16x16x32_bf16 v[124:127], v[44:47], a[188:191], v[124:127]
 ds_read_b64_tr_b16 v[38:39], v10 offset:22784
 v_accvgpr_read_b32 v49, a37
 v_mfma_f32_16x16x32_bf16 v[124:127], v[40:43], a[184:187], v[124:127]
 s_waitcnt lgkmcnt(8)
 v_accvgpr_read_b32 v50, a38
 v_accvgpr_read_b32 v51, a39
 v_mfma_f32_16x16x32_bf16 v[64:67], v[16:19], a[192:195], v[64:67]
 ds_read_b64_tr_b16 v[40:41], v11 offset:20480
 v_accvgpr_read_b32 v52, a52
 v_accvgpr_read_b32 v53, a53
 v_mfma_f32_16x16x32_bf16 v[64:67], v[20:23], a[196:199], v[64:67]
 v_accvgpr_read_b32 v54, a54
 v_mfma_f32_16x16x32_bf16 v[68:71], v[20:23], a[204:207], v[68:71]
 ds_read_b64_tr_b16 v[42:43], v11 offset:20736
 v_accvgpr_read_b32 v55, a55
 v_mul_f32 v48, s7, v48
 v_mfma_f32_16x16x32_bf16 v[68:71], v[16:19], a[200:203], v[68:71]
 v_mul_f32 v49, s7, v49
 v_mul_f32 v50, s7, v50
 v_mfma_f32_16x16x32_bf16 v[72:75], v[16:19], a[208:211], v[72:75]
 ds_read_b64_tr_b16 v[44:45], v11 offset:22528
 v_mul_f32 v51, s7, v51
 v_mfma_f32_16x16x32_bf16 v[72:75], v[20:23], a[212:215], v[72:75]
 v_mul_f32 v52, s7, v52
 v_mul_f32 v53, s7, v53
 v_mfma_f32_16x16x32_bf16 v[76:79], v[20:23], a[220:223], v[76:79]
 ds_read_b64_tr_b16 v[46:47], v11 offset:22784
 v_mul_f32 v54, s7, v54
 v_mfma_f32_16x16x32_bf16 v[76:79], v[16:19], a[216:219], v[76:79]
 s_waitcnt lgkmcnt(8)
 v_mul_f32 v55, s7, v55
 v_cvt_pk_bf16_f32 v60, v48, v49
 v_mfma_f32_16x16x32_bf16 v[80:83], v[24:27], a[192:195], v[80:83]
 ds_read_b64_tr_b16 v[16:17], v4 offset:16384
 v_cvt_pk_bf16_f32 v61, v50, v51
 v_cvt_pk_bf16_f32 v62, v52, v53
 v_mfma_f32_16x16x32_bf16 v[80:83], v[28:31], a[196:199], v[80:83]
 v_cvt_pk_bf16_f32 v63, v54, v55
 v_mfma_f32_16x16x32_bf16 v[84:87], v[28:31], a[204:207], v[84:87]
 ds_read_b64_tr_b16 v[18:19], v4 offset:16640
 s_add_u32 s5, s4, 0
 buffer_store_dwordx4 v[60:63], v13, s[84:87], s5 offen offset:128 sc1
 v_mfma_f32_16x16x32_bf16 v[84:87], v[24:27], a[200:203], v[84:87]
 v_accvgpr_read_b32 v48, a40
 v_accvgpr_read_b32 v49, a41
 v_mfma_f32_16x16x32_bf16 v[88:91], v[24:27], a[208:211], v[88:91]
 ds_read_b64_tr_b16 v[20:21], v4 offset:18432
 v_accvgpr_read_b32 v50, a42
 v_mfma_f32_16x16x32_bf16 v[88:91], v[28:31], a[212:215], v[88:91]
 v_accvgpr_read_b32 v51, a43
 v_accvgpr_read_b32 v52, a56
 v_mfma_f32_16x16x32_bf16 v[92:95], v[28:31], a[220:223], v[92:95]
 ds_read_b64_tr_b16 v[22:23], v4 offset:18688
 v_accvgpr_read_b32 v53, a57
 v_mfma_f32_16x16x32_bf16 v[92:95], v[24:27], a[216:219], v[92:95]
 s_waitcnt lgkmcnt(8)
 v_accvgpr_read_b32 v54, a58
 v_accvgpr_read_b32 v55, a59
 v_mfma_f32_16x16x32_bf16 v[96:99], v[32:35], a[192:195], v[96:99]
 ds_read_b64_tr_b16 v[24:25], v5 offset:16384
 v_mul_f32 v48, s7, v48
 v_mul_f32 v49, s7, v49
 v_mfma_f32_16x16x32_bf16 v[96:99], v[36:39], a[196:199], v[96:99]
 v_mul_f32 v50, s7, v50
 v_mfma_f32_16x16x32_bf16 v[100:103], v[36:39], a[204:207], v[100:103]
 ds_read_b64_tr_b16 v[26:27], v5 offset:16640
 v_mul_f32 v51, s7, v51
 v_mul_f32 v52, s7, v52
 v_mfma_f32_16x16x32_bf16 v[100:103], v[32:35], a[200:203], v[100:103]
 v_mul_f32 v53, s7, v53
 v_mul_f32 v54, s7, v54
 v_mfma_f32_16x16x32_bf16 v[104:107], v[32:35], a[208:211], v[104:107]
 ds_read_b64_tr_b16 v[28:29], v5 offset:18432
 v_mul_f32 v55, s7, v55
 v_mfma_f32_16x16x32_bf16 v[104:107], v[36:39], a[212:215], v[104:107]
 v_cvt_pk_bf16_f32 v56, v48, v49
 v_cvt_pk_bf16_f32 v57, v50, v51
 v_mfma_f32_16x16x32_bf16 v[108:111], v[36:39], a[220:223], v[108:111]
 ds_read_b64_tr_b16 v[30:31], v5 offset:18688
 v_cvt_pk_bf16_f32 v58, v52, v53
 v_mfma_f32_16x16x32_bf16 v[108:111], v[32:35], a[216:219], v[108:111]
 s_waitcnt lgkmcnt(8)
 v_cvt_pk_bf16_f32 v59, v54, v55
 s_add_u32 s5, s4, 4096
 v_mfma_f32_16x16x32_bf16 v[112:115], v[40:43], a[192:195], v[112:115]
 ds_read_b64_tr_b16 v[32:33], v4 offset:20480
 buffer_store_dwordx4 v[56:59], v13, s[84:87], s5 offen offset:0 sc1
 v_accvgpr_read_b32 v48, a44
 v_mfma_f32_16x16x32_bf16 v[112:115], v[44:47], a[196:199], v[112:115]
 v_accvgpr_read_b32 v49, a45
 v_mfma_f32_16x16x32_bf16 v[116:119], v[44:47], a[204:207], v[116:119]
 ds_read_b64_tr_b16 v[34:35], v4 offset:20736
 v_accvgpr_read_b32 v50, a46
 v_accvgpr_read_b32 v51, a47
 v_mfma_f32_16x16x32_bf16 v[116:119], v[40:43], a[200:203], v[116:119]
 v_accvgpr_read_b32 v52, a60
 v_accvgpr_read_b32 v53, a61
 v_mfma_f32_16x16x32_bf16 v[120:123], v[40:43], a[208:211], v[120:123]
 ds_read_b64_tr_b16 v[36:37], v4 offset:22528
 v_accvgpr_read_b32 v54, a62
 v_mfma_f32_16x16x32_bf16 v[120:123], v[44:47], a[212:215], v[120:123]
 v_accvgpr_read_b32 v55, a63
 v_mul_f32 v48, s7, v48
 v_mfma_f32_16x16x32_bf16 v[124:127], v[44:47], a[220:223], v[124:127]
 ds_read_b64_tr_b16 v[38:39], v4 offset:22784
 v_mul_f32 v49, s7, v49
 v_mfma_f32_16x16x32_bf16 v[124:127], v[40:43], a[216:219], v[124:127]
 s_waitcnt lgkmcnt(8)
 v_mul_f32 v50, s7, v50
 v_mul_f32 v51, s7, v51
 v_mfma_f32_16x16x32_bf16 v[64:67], v[16:19], a[224:227], v[64:67]
 ds_read_b64_tr_b16 v[40:41], v5 offset:20480
 v_mul_f32 v52, s7, v52
 v_mul_f32 v53, s7, v53
 v_mfma_f32_16x16x32_bf16 v[64:67], v[20:23], a[228:231], v[64:67]
 v_mul_f32 v54, s7, v54
 v_mfma_f32_16x16x32_bf16 v[68:71], v[20:23], a[236:239], v[68:71]
 ds_read_b64_tr_b16 v[42:43], v5 offset:20736
 v_mul_f32 v55, s7, v55
 v_cvt_pk_bf16_f32 v60, v48, v49
 v_mfma_f32_16x16x32_bf16 v[68:71], v[16:19], a[232:235], v[68:71]
 v_cvt_pk_bf16_f32 v61, v50, v51
 v_cvt_pk_bf16_f32 v62, v52, v53
 v_mfma_f32_16x16x32_bf16 v[72:75], v[16:19], a[240:243], v[72:75]
 ds_read_b64_tr_b16 v[44:45], v5 offset:22528
 v_cvt_pk_bf16_f32 v63, v54, v55
 v_mfma_f32_16x16x32_bf16 v[72:75], v[20:23], a[244:247], v[72:75]
 s_add_u32 s5, s4, 4096
 buffer_store_dwordx4 v[60:63], v13, s[84:87], s5 offen offset:128 sc1
 v_mfma_f32_16x16x32_bf16 v[76:79], v[20:23], a[252:255], v[76:79]
 ds_read_b64_tr_b16 v[46:47], v5 offset:22784
 s_mul_i32 s4, s97, 10
 v_mfma_f32_16x16x32_bf16 v[76:79], v[16:19], a[248:251], v[76:79]
 s_waitcnt lgkmcnt(8)
 s_add_i32 s4, s4, -223
 s_lshr_b32 s8, s4, 5
 v_mfma_f32_16x16x32_bf16 v[80:83], v[24:27], a[224:227], v[80:83]
 ds_read_b64_tr_b16 v[16:17], v6 offset:24576
 s_and_b32 s4, s4, 31
 s_lshl_b32 s4, s4, 18
 v_mfma_f32_16x16x32_bf16 v[80:83], v[28:31], a[228:231], v[80:83]
 s_cmp_eq_u32 s8, 0
 v_mfma_f32_16x16x32_bf16 v[84:87], v[28:31], a[236:239], v[84:87]
 ds_read_b64_tr_b16 v[18:19], v6 offset:24832
 s_cselect_b32 s7, 0x3e3504f3, s100
 s_cselect_b32 s8, 0, 0x800000
 v_mfma_f32_16x16x32_bf16 v[84:87], v[24:27], a[232:235], v[84:87]
 s_add_u32 s4, s4, s8
 v_accvgpr_read_b32 v48, a64
 v_mfma_f32_16x16x32_bf16 v[88:91], v[24:27], a[240:243], v[88:91]
 ds_read_b64_tr_b16 v[20:21], v6 offset:26624
 v_accvgpr_read_b32 v49, a65
 v_mfma_f32_16x16x32_bf16 v[88:91], v[28:31], a[244:247], v[88:91]
 v_accvgpr_read_b32 v50, a66
 v_accvgpr_read_b32 v51, a67
 v_mfma_f32_16x16x32_bf16 v[92:95], v[28:31], a[252:255], v[92:95]
 ds_read_b64_tr_b16 v[22:23], v6 offset:26880
 v_accvgpr_read_b32 v52, a80
 v_mfma_f32_16x16x32_bf16 v[92:95], v[24:27], a[248:251], v[92:95]
 s_waitcnt lgkmcnt(8)
 v_accvgpr_read_b32 v53, a81
 v_accvgpr_read_b32 v54, a82
 v_mfma_f32_16x16x32_bf16 v[96:99], v[32:35], a[224:227], v[96:99]
 ds_read_b64_tr_b16 v[24:25], v7 offset:24576
 v_accvgpr_read_b32 v55, a83
 v_mul_f32 v48, s7, v48
 v_mfma_f32_16x16x32_bf16 v[96:99], v[36:39], a[228:231], v[96:99]
 v_mul_f32 v49, s7, v49
 v_mfma_f32_16x16x32_bf16 v[100:103], v[36:39], a[236:239], v[100:103]
 ds_read_b64_tr_b16 v[26:27], v7 offset:24832
 v_mul_f32 v50, s7, v50
 v_mul_f32 v51, s7, v51
 v_mfma_f32_16x16x32_bf16 v[100:103], v[32:35], a[232:235], v[100:103]
 v_mul_f32 v52, s7, v52
 v_mfma_f32_16x16x32_bf16 v[104:107], v[32:35], a[240:243], v[104:107]
 ds_read_b64_tr_b16 v[28:29], v7 offset:26624
 v_mul_f32 v53, s7, v53
 v_mul_f32 v54, s7, v54
 v_mfma_f32_16x16x32_bf16 v[104:107], v[36:39], a[244:247], v[104:107]
 v_mul_f32 v55, s7, v55
 v_cvt_pk_bf16_f32 v56, v48, v49
 v_mfma_f32_16x16x32_bf16 v[108:111], v[36:39], a[252:255], v[108:111]
 ds_read_b64_tr_b16 v[30:31], v7 offset:26880
 v_cvt_pk_bf16_f32 v57, v50, v51
 v_mfma_f32_16x16x32_bf16 v[108:111], v[32:35], a[248:251], v[108:111]
 s_waitcnt lgkmcnt(8)
 v_cvt_pk_bf16_f32 v58, v52, v53
 v_cvt_pk_bf16_f32 v59, v54, v55
 v_mfma_f32_16x16x32_bf16 v[112:115], v[40:43], a[224:227], v[112:115]
 ds_read_b64_tr_b16 v[32:33], v6 offset:28672
 s_add_u32 s5, s4, 0
 buffer_store_dwordx4 v[56:59], v13, s[84:87], s5 offen offset:0 sc1
 v_mfma_f32_16x16x32_bf16 v[112:115], v[44:47], a[228:231], v[112:115]
 v_accvgpr_read_b32 v48, a68
 v_mfma_f32_16x16x32_bf16 v[116:119], v[44:47], a[236:239], v[116:119]
 ds_read_b64_tr_b16 v[34:35], v6 offset:28928
 v_accvgpr_read_b32 v49, a69
 v_accvgpr_read_b32 v50, a70
 v_mfma_f32_16x16x32_bf16 v[116:119], v[40:43], a[232:235], v[116:119]
 v_accvgpr_read_b32 v51, a71
 v_mfma_f32_16x16x32_bf16 v[120:123], v[40:43], a[240:243], v[120:123]
 ds_read_b64_tr_b16 v[36:37], v6 offset:30720
 v_accvgpr_read_b32 v52, a84
 v_accvgpr_read_b32 v53, a85
 v_mfma_f32_16x16x32_bf16 v[120:123], v[44:47], a[244:247], v[120:123]
 v_accvgpr_read_b32 v54, a86
 v_accvgpr_read_b32 v55, a87
 v_mfma_f32_16x16x32_bf16 v[124:127], v[44:47], a[252:255], v[124:127]
 ds_read_b64_tr_b16 v[38:39], v6 offset:30976
 v_mul_f32 v48, s7, v48
 v_mfma_f32_16x16x32_bf16 v[124:127], v[40:43], a[248:251], v[124:127]
 s_waitcnt lgkmcnt(8)
 v_mul_f32 v49, s7, v49
 v_mul_f32 v50, s7, v50
 v_mfma_f32_16x16x32_bf16 v[128:131], v[16:19], a[128:131], v[128:131]
 ds_read_b64_tr_b16 v[40:41], v7 offset:28672
 v_mul_f32 v51, s7, v51
 v_mul_f32 v52, s7, v52
 v_mfma_f32_16x16x32_bf16 v[128:131], v[20:23], a[132:135], v[128:131]
 v_mul_f32 v53, s7, v53
 v_mfma_f32_16x16x32_bf16 v[132:135], v[20:23], a[140:143], v[132:135]
 ds_read_b64_tr_b16 v[42:43], v7 offset:28928
 v_mul_f32 v54, s7, v54
 v_mul_f32 v55, s7, v55
 v_mfma_f32_16x16x32_bf16 v[132:135], v[16:19], a[136:139], v[132:135]
 v_cvt_pk_bf16_f32 v60, v48, v49
 v_mfma_f32_16x16x32_bf16 v[136:139], v[16:19], a[144:147], v[136:139]
 ds_read_b64_tr_b16 v[44:45], v7 offset:30720
 v_cvt_pk_bf16_f32 v61, v50, v51
 v_cvt_pk_bf16_f32 v62, v52, v53
 v_mfma_f32_16x16x32_bf16 v[136:139], v[20:23], a[148:151], v[136:139]
 v_cvt_pk_bf16_f32 v63, v54, v55
 s_add_u32 s5, s4, 0
 v_mfma_f32_16x16x32_bf16 v[140:143], v[20:23], a[156:159], v[140:143]
 ds_read_b64_tr_b16 v[46:47], v7 offset:30976
 buffer_store_dwordx4 v[60:63], v13, s[84:87], s5 offen offset:128 sc1
 v_mfma_f32_16x16x32_bf16 v[140:143], v[16:19], a[152:155], v[140:143]
 s_waitcnt lgkmcnt(8)
 v_accvgpr_read_b32 v48, a72
 v_accvgpr_read_b32 v49, a73
 v_mfma_f32_16x16x32_bf16 v[144:147], v[24:27], a[128:131], v[144:147]
 ds_read_b64_tr_b16 v[16:17], v8 offset:24576
 v_accvgpr_read_b32 v50, a74
 v_accvgpr_read_b32 v51, a75
 v_mfma_f32_16x16x32_bf16 v[144:147], v[28:31], a[132:135], v[144:147]
 v_accvgpr_read_b32 v52, a88
 v_mfma_f32_16x16x32_bf16 v[148:151], v[28:31], a[140:143], v[148:151]
 ds_read_b64_tr_b16 v[18:19], v8 offset:24832
 v_accvgpr_read_b32 v53, a89
 v_accvgpr_read_b32 v54, a90
 v_mfma_f32_16x16x32_bf16 v[148:151], v[24:27], a[136:139], v[148:151]
 v_accvgpr_read_b32 v55, a91
 v_mfma_f32_16x16x32_bf16 v[152:155], v[24:27], a[144:147], v[152:155]
 ds_read_b64_tr_b16 v[20:21], v8 offset:26624
 v_mul_f32 v48, s7, v48
 v_mul_f32 v49, s7, v49
 v_mfma_f32_16x16x32_bf16 v[152:155], v[28:31], a[148:151], v[152:155]
 v_mul_f32 v50, s7, v50
 v_mul_f32 v51, s7, v51
 v_mfma_f32_16x16x32_bf16 v[156:159], v[28:31], a[156:159], v[156:159]
 ds_read_b64_tr_b16 v[22:23], v8 offset:26880
 v_mul_f32 v52, s7, v52
 v_mfma_f32_16x16x32_bf16 v[156:159], v[24:27], a[152:155], v[156:159]
 s_waitcnt lgkmcnt(8)
 v_mul_f32 v53, s7, v53
 v_mul_f32 v54, s7, v54
 v_mfma_f32_16x16x32_bf16 v[160:163], v[32:35], a[128:131], v[160:163]
 ds_read_b64_tr_b16 v[24:25], v9 offset:24576
 v_mul_f32 v55, s7, v55
 v_cvt_pk_bf16_f32 v56, v48, v49
 v_mfma_f32_16x16x32_bf16 v[160:163], v[36:39], a[132:135], v[160:163]
 v_cvt_pk_bf16_f32 v57, v50, v51
 v_mfma_f32_16x16x32_bf16 v[164:167], v[36:39], a[140:143], v[164:167]
 ds_read_b64_tr_b16 v[26:27], v9 offset:24832
 v_cvt_pk_bf16_f32 v58, v52, v53
 v_cvt_pk_bf16_f32 v59, v54, v55
 v_mfma_f32_16x16x32_bf16 v[164:167], v[32:35], a[136:139], v[164:167]
 s_add_u32 s5, s4, 4096
 v_mfma_f32_16x16x32_bf16 v[168:171], v[32:35], a[144:147], v[168:171]
 ds_read_b64_tr_b16 v[28:29], v9 offset:26624
 buffer_store_dwordx4 v[56:59], v13, s[84:87], s5 offen offset:0 sc1
 v_accvgpr_read_b32 v48, a76
 v_mfma_f32_16x16x32_bf16 v[168:171], v[36:39], a[148:151], v[168:171]
 v_accvgpr_read_b32 v49, a77
 v_accvgpr_read_b32 v50, a78
 v_mfma_f32_16x16x32_bf16 v[172:175], v[36:39], a[156:159], v[172:175]
 ds_read_b64_tr_b16 v[30:31], v9 offset:26880
 v_accvgpr_read_b32 v51, a79
 v_mfma_f32_16x16x32_bf16 v[172:175], v[32:35], a[152:155], v[172:175]
 s_waitcnt lgkmcnt(8)
 v_accvgpr_read_b32 v52, a92
 v_accvgpr_read_b32 v53, a93
 v_mfma_f32_16x16x32_bf16 v[176:179], v[40:43], a[128:131], v[176:179]
 ds_read_b64_tr_b16 v[32:33], v8 offset:28672
 v_accvgpr_read_b32 v54, a94
 v_accvgpr_read_b32 v55, a95
 v_mfma_f32_16x16x32_bf16 v[176:179], v[44:47], a[132:135], v[176:179]
 v_mul_f32 v48, s7, v48
 v_mfma_f32_16x16x32_bf16 v[180:183], v[44:47], a[140:143], v[180:183]
 ds_read_b64_tr_b16 v[34:35], v8 offset:28928
 v_mul_f32 v49, s7, v49
 v_mul_f32 v50, s7, v50
 v_mfma_f32_16x16x32_bf16 v[180:183], v[40:43], a[136:139], v[180:183]
 v_mul_f32 v51, s7, v51
 v_mfma_f32_16x16x32_bf16 v[184:187], v[40:43], a[144:147], v[184:187]
 ds_read_b64_tr_b16 v[36:37], v8 offset:30720
 v_mul_f32 v52, s7, v52
 v_mul_f32 v53, s7, v53
 v_mfma_f32_16x16x32_bf16 v[184:187], v[44:47], a[148:151], v[184:187]
 v_mul_f32 v54, s7, v54
 v_mul_f32 v55, s7, v55
 v_mfma_f32_16x16x32_bf16 v[188:191], v[44:47], a[156:159], v[188:191]
 ds_read_b64_tr_b16 v[38:39], v8 offset:30976
 v_cvt_pk_bf16_f32 v60, v48, v49
 v_mfma_f32_16x16x32_bf16 v[188:191], v[40:43], a[152:155], v[188:191]
 s_waitcnt lgkmcnt(8)
 v_cvt_pk_bf16_f32 v61, v50, v51
 v_cvt_pk_bf16_f32 v62, v52, v53
 v_mfma_f32_16x16x32_bf16 v[128:131], v[16:19], a[160:163], v[128:131]
 ds_read_b64_tr_b16 v[40:41], v9 offset:28672
 v_cvt_pk_bf16_f32 v63, v54, v55
 s_add_u32 s5, s4, 4096
 v_mfma_f32_16x16x32_bf16 v[128:131], v[20:23], a[164:167], v[128:131]
 buffer_store_dwordx4 v[60:63], v13, s[84:87], s5 offen offset:128 sc1
 v_mfma_f32_16x16x32_bf16 v[132:135], v[20:23], a[172:175], v[132:135]
 ds_read_b64_tr_b16 v[42:43], v9 offset:28928
 s_mul_i32 s4, s97, 10
 s_add_i32 s4, s4, -221
 v_mfma_f32_16x16x32_bf16 v[132:135], v[16:19], a[168:171], v[132:135]
 s_lshr_b32 s8, s4, 5
 v_mfma_f32_16x16x32_bf16 v[136:139], v[16:19], a[176:179], v[136:139]
 ds_read_b64_tr_b16 v[44:45], v9 offset:30720
 s_and_b32 s4, s4, 31
 s_lshl_b32 s4, s4, 18
 v_mfma_f32_16x16x32_bf16 v[136:139], v[20:23], a[180:183], v[136:139]
 s_cmp_eq_u32 s8, 0
 s_cselect_b32 s7, 0x3e3504f3, s100
 v_mfma_f32_16x16x32_bf16 v[140:143], v[20:23], a[188:191], v[140:143]
 ds_read_b64_tr_b16 v[46:47], v9 offset:30976
 s_cselect_b32 s8, 0, 0x800000
 v_mfma_f32_16x16x32_bf16 v[140:143], v[16:19], a[184:187], v[140:143]
 s_waitcnt lgkmcnt(8)
 s_add_u32 s4, s4, s8
 v_accvgpr_read_b32 v48, a96
 v_mfma_f32_16x16x32_bf16 v[144:147], v[24:27], a[160:163], v[144:147]
 ds_read_b64_tr_b16 v[16:17], v10 offset:24576
 v_accvgpr_read_b32 v49, a97
 v_accvgpr_read_b32 v50, a98
 v_mfma_f32_16x16x32_bf16 v[144:147], v[28:31], a[164:167], v[144:147]
 v_accvgpr_read_b32 v51, a99
 v_mfma_f32_16x16x32_bf16 v[148:151], v[28:31], a[172:175], v[148:151]
 ds_read_b64_tr_b16 v[18:19], v10 offset:24832
 v_accvgpr_read_b32 v52, a112
 v_accvgpr_read_b32 v53, a113
 v_mfma_f32_16x16x32_bf16 v[148:151], v[24:27], a[168:171], v[148:151]
 v_accvgpr_read_b32 v54, a114
 v_mfma_f32_16x16x32_bf16 v[152:155], v[24:27], a[176:179], v[152:155]
 ds_read_b64_tr_b16 v[20:21], v10 offset:26624
 v_accvgpr_read_b32 v55, a115
 v_mul_f32 v48, s7, v48
 v_mfma_f32_16x16x32_bf16 v[152:155], v[28:31], a[180:183], v[152:155]
 v_mul_f32 v49, s7, v49
 v_mul_f32 v50, s7, v50
 v_mfma_f32_16x16x32_bf16 v[156:159], v[28:31], a[188:191], v[156:159]
 ds_read_b64_tr_b16 v[22:23], v10 offset:26880
 v_mul_f32 v51, s7, v51
 v_mfma_f32_16x16x32_bf16 v[156:159], v[24:27], a[184:187], v[156:159]
 s_waitcnt lgkmcnt(8)
 v_mul_f32 v52, s7, v52
 v_mul_f32 v53, s7, v53
 v_mfma_f32_16x16x32_bf16 v[160:163], v[32:35], a[160:163], v[160:163]
 ds_read_b64_tr_b16 v[24:25], v11 offset:24576
 v_mul_f32 v54, s7, v54
 v_mul_f32 v55, s7, v55
 v_mfma_f32_16x16x32_bf16 v[160:163], v[36:39], a[164:167], v[160:163]
 v_cvt_pk_bf16_f32 v56, v48, v49
 v_mfma_f32_16x16x32_bf16 v[164:167], v[36:39], a[172:175], v[164:167]
 ds_read_b64_tr_b16 v[26:27], v11 offset:24832
 v_cvt_pk_bf16_f32 v57, v50, v51
 v_cvt_pk_bf16_f32 v58, v52, v53
 v_mfma_f32_16x16x32_bf16 v[164:167], v[32:35], a[168:171], v[164:167]
 v_cvt_pk_bf16_f32 v59, v54, v55
 v_mfma_f32_16x16x32_bf16 v[168:171], v[32:35], a[176:179], v[168:171]
 ds_read_b64_tr_b16 v[28:29], v11 offset:26624
 s_add_u32 s5, s4, 0
 buffer_store_dwordx4 v[56:59], v13, s[84:87], s5 offen offset:0 sc1
 v_mfma_f32_16x16x32_bf16 v[168:171], v[36:39], a[180:183], v[168:171]
 v_accvgpr_read_b32 v48, a100
 v_accvgpr_read_b32 v49, a101
 v_mfma_f32_16x16x32_bf16 v[172:175], v[36:39], a[188:191], v[172:175]
 ds_read_b64_tr_b16 v[30:31], v11 offset:26880
 v_accvgpr_read_b32 v50, a102
 v_mfma_f32_16x16x32_bf16 v[172:175], v[32:35], a[184:187], v[172:175]
 s_waitcnt lgkmcnt(8)
 v_accvgpr_read_b32 v51, a103
 v_accvgpr_read_b32 v52, a116
 v_mfma_f32_16x16x32_bf16 v[176:179], v[40:43], a[160:163], v[176:179]
 ds_read_b64_tr_b16 v[32:33], v10 offset:28672
 v_accvgpr_read_b32 v53, a117
 v_accvgpr_read_b32 v54, a118
 v_mfma_f32_16x16x32_bf16 v[176:179], v[44:47], a[164:167], v[176:179]
 v_accvgpr_read_b32 v55, a119
 v_mfma_f32_16x16x32_bf16 v[180:183], v[44:47], a[172:175], v[180:183]
 ds_read_b64_tr_b16 v[34:35], v10 offset:28928
 v_mul_f32 v48, s7, v48
 v_mul_f32 v49, s7, v49
 v_mfma_f32_16x16x32_bf16 v[180:183], v[40:43], a[168:171], v[180:183]
 v_mul_f32 v50, s7, v50
 v_mfma_f32_16x16x32_bf16 v[184:187], v[40:43], a[176:179], v[184:187]
 ds_read_b64_tr_b16 v[36:37], v10 offset:30720
 v_mul_f32 v51, s7, v51
 v_mul_f32 v52, s7, v52
 v_mfma_f32_16x16x32_bf16 v[184:187], v[44:47], a[180:183], v[184:187]
 v_mul_f32 v53, s7, v53
 v_mul_f32 v54, s7, v54
 v_mfma_f32_16x16x32_bf16 v[188:191], v[44:47], a[188:191], v[188:191]
 ds_read_b64_tr_b16 v[38:39], v10 offset:30976
 v_mul_f32 v55, s7, v55
 v_mfma_f32_16x16x32_bf16 v[188:191], v[40:43], a[184:187], v[188:191]
 s_waitcnt lgkmcnt(8)
 v_cvt_pk_bf16_f32 v60, v48, v49
 v_cvt_pk_bf16_f32 v61, v50, v51
 v_mfma_f32_16x16x32_bf16 v[128:131], v[16:19], a[192:195], v[128:131]
 ds_read_b64_tr_b16 v[40:41], v11 offset:28672
 v_cvt_pk_bf16_f32 v62, v52, v53
 v_cvt_pk_bf16_f32 v63, v54, v55
 v_mfma_f32_16x16x32_bf16 v[128:131], v[20:23], a[196:199], v[128:131]
 s_add_u32 s5, s4, 0
 v_mfma_f32_16x16x32_bf16 v[132:135], v[20:23], a[204:207], v[132:135]
 ds_read_b64_tr_b16 v[42:43], v11 offset:28928
 buffer_store_dwordx4 v[60:63], v13, s[84:87], s5 offen offset:128 sc1
 v_accvgpr_read_b32 v48, a104
 v_mfma_f32_16x16x32_bf16 v[132:135], v[16:19], a[200:203], v[132:135]
 v_accvgpr_read_b32 v49, a105
 v_mfma_f32_16x16x32_bf16 v[136:139], v[16:19], a[208:211], v[136:139]
 ds_read_b64_tr_b16 v[44:45], v11 offset:30720
 v_accvgpr_read_b32 v50, a106
 v_accvgpr_read_b32 v51, a107
 v_mfma_f32_16x16x32_bf16 v[136:139], v[20:23], a[212:215], v[136:139]
 v_accvgpr_read_b32 v52, a120
 v_accvgpr_read_b32 v53, a121
 v_mfma_f32_16x16x32_bf16 v[140:143], v[20:23], a[220:223], v[140:143]
 ds_read_b64_tr_b16 v[46:47], v11 offset:30976
 v_accvgpr_read_b32 v54, a122
 v_mfma_f32_16x16x32_bf16 v[140:143], v[16:19], a[216:219], v[140:143]
 s_waitcnt lgkmcnt(8)
 v_accvgpr_read_b32 v55, a123
 v_mul_f32 v48, s7, v48
 v_mfma_f32_16x16x32_bf16 v[144:147], v[24:27], a[192:195], v[144:147]
 ds_read_b64_tr_b16 v[16:17], v4 offset:24576
 v_mul_f32 v49, s7, v49
 v_mul_f32 v50, s7, v50
 v_mfma_f32_16x16x32_bf16 v[144:147], v[28:31], a[196:199], v[144:147]
 v_mul_f32 v51, s7, v51
 v_mfma_f32_16x16x32_bf16 v[148:151], v[28:31], a[204:207], v[148:151]
 ds_read_b64_tr_b16 v[18:19], v4 offset:24832
 v_mul_f32 v52, s7, v52
 v_mul_f32 v53, s7, v53
 v_mfma_f32_16x16x32_bf16 v[148:151], v[24:27], a[200:203], v[148:151]
 v_mul_f32 v54, s7, v54
 v_mfma_f32_16x16x32_bf16 v[152:155], v[24:27], a[208:211], v[152:155]
 ds_read_b64_tr_b16 v[20:21], v4 offset:26624
 v_mul_f32 v55, s7, v55
 v_cvt_pk_bf16_f32 v56, v48, v49
 v_mfma_f32_16x16x32_bf16 v[152:155], v[28:31], a[212:215], v[152:155]
 v_cvt_pk_bf16_f32 v57, v50, v51
 v_cvt_pk_bf16_f32 v58, v52, v53
 v_mfma_f32_16x16x32_bf16 v[156:159], v[28:31], a[220:223], v[156:159]
 ds_read_b64_tr_b16 v[22:23], v4 offset:26880
 v_cvt_pk_bf16_f32 v59, v54, v55
 v_mfma_f32_16x16x32_bf16 v[156:159], v[24:27], a[216:219], v[156:159]
 s_waitcnt lgkmcnt(8)
 s_add_u32 s5, s4, 4096
 buffer_store_dwordx4 v[56:59], v13, s[84:87], s5 offen offset:0 sc1
 v_mfma_f32_16x16x32_bf16 v[160:163], v[32:35], a[192:195], v[160:163]
 ds_read_b64_tr_b16 v[24:25], v5 offset:24576
 v_accvgpr_read_b32 v48, a108
 v_accvgpr_read_b32 v49, a109
 v_mfma_f32_16x16x32_bf16 v[160:163], v[36:39], a[196:199], v[160:163]
 v_accvgpr_read_b32 v50, a110
 v_mfma_f32_16x16x32_bf16 v[164:167], v[36:39], a[204:207], v[164:167]
 ds_read_b64_tr_b16 v[26:27], v5 offset:24832
 v_accvgpr_read_b32 v51, a111
 v_accvgpr_read_b32 v52, a124
 v_mfma_f32_16x16x32_bf16 v[164:167], v[32:35], a[200:203], v[164:167]
 v_accvgpr_read_b32 v53, a125
 v_mfma_f32_16x16x32_bf16 v[168:171], v[32:35], a[208:211], v[168:171]
 ds_read_b64_tr_b16 v[28:29], v5 offset:26624
 v_accvgpr_read_b32 v54, a126
 v_accvgpr_read_b32 v55, a127
 v_mfma_f32_16x16x32_bf16 v[168:171], v[36:39], a[212:215], v[168:171]
 v_mul_f32 v48, s7, v48
 v_mul_f32 v49, s7, v49
 v_mfma_f32_16x16x32_bf16 v[172:175], v[36:39], a[220:223], v[172:175]
 ds_read_b64_tr_b16 v[30:31], v5 offset:26880
 v_mul_f32 v50, s7, v50
 v_mfma_f32_16x16x32_bf16 v[172:175], v[32:35], a[216:219], v[172:175]
 s_waitcnt lgkmcnt(8)
 v_mul_f32 v51, s7, v51
 v_mul_f32 v52, s7, v52
 v_mfma_f32_16x16x32_bf16 v[176:179], v[40:43], a[192:195], v[176:179]
 ds_read_b64_tr_b16 v[32:33], v4 offset:28672
 v_mul_f32 v53, s7, v53
 v_mul_f32 v54, s7, v54
 v_mfma_f32_16x16x32_bf16 v[176:179], v[44:47], a[196:199], v[176:179]
 v_mul_f32 v55, s7, v55
 v_mfma_f32_16x16x32_bf16 v[180:183], v[44:47], a[204:207], v[180:183]
 ds_read_b64_tr_b16 v[34:35], v4 offset:28928
 v_cvt_pk_bf16_f32 v60, v48, v49
 v_cvt_pk_bf16_f32 v61, v50, v51
 v_mfma_f32_16x16x32_bf16 v[180:183], v[40:43], a[200:203], v[180:183]
 v_cvt_pk_bf16_f32 v62, v52, v53
 v_mfma_f32_16x16x32_bf16 v[184:187], v[40:43], a[208:211], v[184:187]
 ds_read_b64_tr_b16 v[36:37], v4 offset:30720
 v_cvt_pk_bf16_f32 v63, v54, v55
 s_add_u32 s5, s4, 4096
 v_mfma_f32_16x16x32_bf16 v[184:187], v[44:47], a[212:215], v[184:187]
 buffer_store_dwordx4 v[60:63], v13, s[84:87], s5 offen offset:128 sc1
 s_mul_i32 s4, s97, 10
 v_mfma_f32_16x16x32_bf16 v[188:191], v[44:47], a[220:223], v[188:191]
 ds_read_b64_tr_b16 v[38:39], v4 offset:30976
 s_add_i32 s4, s4, -220
 v_mfma_f32_16x16x32_bf16 v[188:191], v[40:43], a[216:219], v[188:191]
 s_waitcnt lgkmcnt(8)
 s_lshr_b32 s8, s4, 5
 s_and_b32 s4, s4, 31
 v_mfma_f32_16x16x32_bf16 v[128:131], v[16:19], a[224:227], v[128:131]
 ds_read_b64_tr_b16 v[40:41], v5 offset:28672
 s_lshl_b32 s4, s4, 18
 s_cmp_eq_u32 s8, 0
 v_mfma_f32_16x16x32_bf16 v[128:131], v[20:23], a[228:231], v[128:131]
 s_cselect_b32 s7, 0x3e3504f3, s100
 v_mfma_f32_16x16x32_bf16 v[132:135], v[20:23], a[236:239], v[132:135]
 ds_read_b64_tr_b16 v[42:43], v5 offset:28928
 s_cselect_b32 s8, 0, 0x800000
 s_add_u32 s4, s4, s8
 v_mfma_f32_16x16x32_bf16 v[132:135], v[16:19], a[232:235], v[132:135]
 v_mul_f32 v64, s7, v64
 v_mfma_f32_16x16x32_bf16 v[136:139], v[16:19], a[240:243], v[136:139]
 ds_read_b64_tr_b16 v[44:45], v5 offset:30720
 v_mul_f32 v65, s7, v65
 v_mul_f32 v66, s7, v66
 v_mfma_f32_16x16x32_bf16 v[136:139], v[20:23], a[244:247], v[136:139]
 v_mul_f32 v67, s7, v67
 v_mul_f32 v80, s7, v80
 v_mfma_f32_16x16x32_bf16 v[140:143], v[20:23], a[252:255], v[140:143]
 ds_read_b64_tr_b16 v[46:47], v5 offset:30976
 v_mul_f32 v81, s7, v81
 v_mfma_f32_16x16x32_bf16 v[140:143], v[16:19], a[248:251], v[140:143]
 s_waitcnt lgkmcnt(8)
 v_mul_f32 v82, s7, v82
 v_mul_f32 v83, s7, v83
 v_mfma_f32_16x16x32_bf16 v[144:147], v[24:27], a[224:227], v[144:147]
 ds_read_b64_tr_b16 v[16:17], v6 offset:32768
 v_cvt_pk_bf16_f32 v56, v64, v65
 v_cvt_pk_bf16_f32 v57, v66, v67
 v_mfma_f32_16x16x32_bf16 v[144:147], v[28:31], a[228:231], v[144:147]
 v_cvt_pk_bf16_f32 v58, v80, v81
 v_mfma_f32_16x16x32_bf16 v[148:151], v[28:31], a[236:239], v[148:151]
 ds_read_b64_tr_b16 v[18:19], v6 offset:33024
 v_cvt_pk_bf16_f32 v59, v82, v83
 s_add_u32 s5, s4, 0
 v_mfma_f32_16x16x32_bf16 v[148:151], v[24:27], a[232:235], v[148:151]
 buffer_store_dwordx4 v[56:59], v13, s[84:87], s5 offen offset:0 sc1
 v_mfma_f32_16x16x32_bf16 v[152:155], v[24:27], a[240:243], v[152:155]
 ds_read_b64_tr_b16 v[20:21], v6 offset:34816
 v_mul_f32 v68, s7, v68
 v_mul_f32 v69, s7, v69
 v_mfma_f32_16x16x32_bf16 v[152:155], v[28:31], a[244:247], v[152:155]
 v_mul_f32 v70, s7, v70
 v_mul_f32 v71, s7, v71
 v_mfma_f32_16x16x32_bf16 v[156:159], v[28:31], a[252:255], v[156:159]
 ds_read_b64_tr_b16 v[22:23], v6 offset:35072
 v_mul_f32 v84, s7, v84
 v_mfma_f32_16x16x32_bf16 v[156:159], v[24:27], a[248:251], v[156:159]
 s_waitcnt lgkmcnt(8)
 v_mul_f32 v85, s7, v85
 v_mul_f32 v86, s7, v86
 v_mfma_f32_16x16x32_bf16 v[160:163], v[32:35], a[224:227], v[160:163]
 ds_read_b64_tr_b16 v[24:25], v7 offset:32768
 v_mul_f32 v87, s7, v87
 v_cvt_pk_bf16_f32 v60, v68, v69
 v_mfma_f32_16x16x32_bf16 v[160:163], v[36:39], a[228:231], v[160:163]
 v_cvt_pk_bf16_f32 v61, v70, v71
 v_mfma_f32_16x16x32_bf16 v[164:167], v[36:39], a[236:239], v[164:167]
 ds_read_b64_tr_b16 v[26:27], v7 offset:33024
 v_cvt_pk_bf16_f32 v62, v84, v85
 v_cvt_pk_bf16_f32 v63, v86, v87
 v_mfma_f32_16x16x32_bf16 v[164:167], v[32:35], a[232:235], v[164:167]
 s_add_u32 s5, s4, 0
 v_mfma_f32_16x16x32_bf16 v[168:171], v[32:35], a[240:243], v[168:171]
 ds_read_b64_tr_b16 v[28:29], v7 offset:34816
 buffer_store_dwordx4 v[60:63], v13, s[84:87], s5 offen offset:128 sc1
 v_mul_f32 v72, s7, v72
 v_mfma_f32_16x16x32_bf16 v[168:171], v[36:39], a[244:247], v[168:171]
 v_mul_f32 v73, s7, v73
 v_mul_f32 v74, s7, v74
 v_mfma_f32_16x16x32_bf16 v[172:175], v[36:39], a[252:255], v[172:175]
 ds_read_b64_tr_b16 v[30:31], v7 offset:35072
 v_mul_f32 v75, s7, v75
 v_mfma_f32_16x16x32_bf16 v[172:175], v[32:35], a[248:251], v[172:175]
 s_waitcnt lgkmcnt(8)
 v_mul_f32 v88, s7, v88
 v_mul_f32 v89, s7, v89
 v_mfma_f32_16x16x32_bf16 v[176:179], v[40:43], a[224:227], v[176:179]
 ds_read_b64_tr_b16 v[32:33], v6 offset:36864
 v_mul_f32 v90, s7, v90
 v_mfma_f32_16x16x32_bf16 v[176:179], v[44:47], a[228:231], v[176:179]
 v_mul_f32 v91, s7, v91
 v_cvt_pk_bf16_f32 v56, v72, v73
 v_mfma_f32_16x16x32_bf16 v[180:183], v[44:47], a[236:239], v[180:183]
 ds_read_b64_tr_b16 v[34:35], v6 offset:37120
 v_cvt_pk_bf16_f32 v57, v74, v75
 v_cvt_pk_bf16_f32 v58, v88, v89
 v_mfma_f32_16x16x32_bf16 v[180:183], v[40:43], a[232:235], v[180:183]
 v_cvt_pk_bf16_f32 v59, v90, v91
 v_mfma_f32_16x16x32_bf16 v[184:187], v[40:43], a[240:243], v[184:187]
 ds_read_b64_tr_b16 v[36:37], v6 offset:38912
 s_add_u32 s5, s4, 4096
 buffer_store_dwordx4 v[56:59], v13, s[84:87], s5 offen offset:0 sc1
 v_mfma_f32_16x16x32_bf16 v[184:187], v[44:47], a[244:247], v[184:187]
 v_mul_f32 v76, s7, v76
 v_mul_f32 v77, s7, v77
 v_mfma_f32_16x16x32_bf16 v[188:191], v[44:47], a[252:255], v[188:191]
 ds_read_b64_tr_b16 v[38:39], v6 offset:39168
 v_mul_f32 v78, s7, v78
 v_mfma_f32_16x16x32_bf16 v[188:191], v[40:43], a[248:251], v[188:191]
 s_waitcnt lgkmcnt(8)
 v_mul_f32 v79, s7, v79
 v_mul_f32 v92, s7, v92
 v_mfma_f32_16x16x32_bf16 v[192:195], a[128:131], v[16:19], v[192:195]
 ds_read_b64_tr_b16 v[40:41], v7 offset:36864
 v_mul_f32 v93, s7, v93
 v_mfma_f32_16x16x32_bf16 v[192:195], a[132:135], v[20:23], v[192:195]
 v_mul_f32 v94, s7, v94
 v_mul_f32 v95, s7, v95
 v_mfma_f32_16x16x32_bf16 v[196:199], a[140:143], v[20:23], v[196:199]
 ds_read_b64_tr_b16 v[42:43], v7 offset:37120
 v_cvt_pk_bf16_f32 v60, v76, v77
 v_cvt_pk_bf16_f32 v61, v78, v79
 v_mfma_f32_16x16x32_bf16 v[196:199], a[136:139], v[16:19], v[196:199]
 v_cvt_pk_bf16_f32 v62, v92, v93
 v_mfma_f32_16x16x32_bf16 v[200:203], a[144:147], v[16:19], v[200:203]
 ds_read_b64_tr_b16 v[44:45], v7 offset:38912
 v_cvt_pk_bf16_f32 v63, v94, v95
 s_add_u32 s5, s4, 4096
 v_mfma_f32_16x16x32_bf16 v[200:203], a[148:151], v[20:23], v[200:203]
 buffer_store_dwordx4 v[60:63], v13, s[84:87], s5 offen offset:128 sc1
 s_mul_i32 s4, s97, 10
 v_mfma_f32_16x16x32_bf16 v[204:207], a[156:159], v[20:23], v[204:207]
 ds_read_b64_tr_b16 v[46:47], v7 offset:39168
 s_add_i32 s4, s4, -218
 v_mfma_f32_16x16x32_bf16 v[204:207], a[152:155], v[16:19], v[204:207]
 s_waitcnt lgkmcnt(8)
 s_lshr_b32 s8, s4, 5
 s_and_b32 s4, s4, 31
 v_mfma_f32_16x16x32_bf16 v[208:211], a[128:131], v[24:27], v[208:211]
 ds_read_b64_tr_b16 v[16:17], v8 offset:32768
 s_lshl_b32 s4, s4, 18
 v_mfma_f32_16x16x32_bf16 v[208:211], a[132:135], v[28:31], v[208:211]
 s_cmp_eq_u32 s8, 0
 s_cselect_b32 s7, 0x3e3504f3, s100
 v_mfma_f32_16x16x32_bf16 v[212:215], a[140:143], v[28:31], v[212:215]
 ds_read_b64_tr_b16 v[18:19], v8 offset:33024
 s_cselect_b32 s8, 0, 0x800000
 s_add_u32 s4, s4, s8
 v_mfma_f32_16x16x32_bf16 v[212:215], a[136:139], v[24:27], v[212:215]
 v_mul_f32 v96, s7, v96
 v_mfma_f32_16x16x32_bf16 v[216:219], a[144:147], v[24:27], v[216:219]
 ds_read_b64_tr_b16 v[20:21], v8 offset:34816
 v_mul_f32 v97, s7, v97
 v_mul_f32 v98, s7, v98
 v_mfma_f32_16x16x32_bf16 v[216:219], a[148:151], v[28:31], v[216:219]
 v_mul_f32 v99, s7, v99
 v_mul_f32 v112, s7, v112
 v_mfma_f32_16x16x32_bf16 v[220:223], a[156:159], v[28:31], v[220:223]
 ds_read_b64_tr_b16 v[22:23], v8 offset:35072
 v_mul_f32 v113, s7, v113
 v_mfma_f32_16x16x32_bf16 v[220:223], a[152:155], v[24:27], v[220:223]
 s_waitcnt lgkmcnt(8)
 v_mul_f32 v114, s7, v114
 v_mul_f32 v115, s7, v115
 v_mfma_f32_16x16x32_bf16 v[224:227], a[128:131], v[32:35], v[224:227]
 ds_read_b64_tr_b16 v[24:25], v9 offset:32768
 v_cvt_pk_bf16_f32 v56, v96, v97
 v_mfma_f32_16x16x32_bf16 v[224:227], a[132:135], v[36:39], v[224:227]
 v_cvt_pk_bf16_f32 v57, v98, v99
 v_cvt_pk_bf16_f32 v58, v112, v113
 v_mfma_f32_16x16x32_bf16 v[228:231], a[140:143], v[36:39], v[228:231]
 ds_read_b64_tr_b16 v[26:27], v9 offset:33024
 v_cvt_pk_bf16_f32 v59, v114, v115
 s_add_u32 s5, s4, 0
 v_mfma_f32_16x16x32_bf16 v[228:231], a[136:139], v[32:35], v[228:231]
 buffer_store_dwordx4 v[56:59], v13, s[84:87], s5 offen offset:0 sc1
 v_mfma_f32_16x16x32_bf16 v[232:235], a[144:147], v[32:35], v[232:235]
 ds_read_b64_tr_b16 v[28:29], v9 offset:34816
 v_mul_f32 v100, s7, v100
 v_mul_f32 v101, s7, v101
 v_mfma_f32_16x16x32_bf16 v[232:235], a[148:151], v[36:39], v[232:235]
 v_mul_f32 v102, s7, v102
 v_mul_f32 v103, s7, v103
 v_mfma_f32_16x16x32_bf16 v[236:239], a[156:159], v[36:39], v[236:239]
 ds_read_b64_tr_b16 v[30:31], v9 offset:35072
 v_mul_f32 v116, s7, v116
 v_mfma_f32_16x16x32_bf16 v[236:239], a[152:155], v[32:35], v[236:239]
 s_waitcnt lgkmcnt(8)
 v_mul_f32 v117, s7, v117
 v_mul_f32 v118, s7, v118
 v_mfma_f32_16x16x32_bf16 v[240:243], a[128:131], v[40:43], v[240:243]
 ds_read_b64_tr_b16 v[32:33], v8 offset:36864
 v_mul_f32 v119, s7, v119
 v_mfma_f32_16x16x32_bf16 v[240:243], a[132:135], v[44:47], v[240:243]
 v_cvt_pk_bf16_f32 v60, v100, v101
 v_cvt_pk_bf16_f32 v61, v102, v103
 v_mfma_f32_16x16x32_bf16 v[244:247], a[140:143], v[44:47], v[244:247]
 ds_read_b64_tr_b16 v[34:35], v8 offset:37120
 v_cvt_pk_bf16_f32 v62, v116, v117
 v_cvt_pk_bf16_f32 v63, v118, v119
 v_mfma_f32_16x16x32_bf16 v[244:247], a[136:139], v[40:43], v[244:247]
 s_add_u32 s5, s4, 0
 v_mfma_f32_16x16x32_bf16 v[248:251], a[144:147], v[40:43], v[248:251]
 ds_read_b64_tr_b16 v[36:37], v8 offset:38912
 buffer_store_dwordx4 v[60:63], v13, s[84:87], s5 offen offset:128 sc1
 v_mul_f32 v104, s7, v104
 v_mfma_f32_16x16x32_bf16 v[248:251], a[148:151], v[44:47], v[248:251]
 v_mul_f32 v105, s7, v105
 v_mul_f32 v106, s7, v106
 v_mfma_f32_16x16x32_bf16 v[252:255], a[156:159], v[44:47], v[252:255]
 ds_read_b64_tr_b16 v[38:39], v8 offset:39168
 v_mul_f32 v107, s7, v107
 v_mfma_f32_16x16x32_bf16 v[252:255], a[152:155], v[40:43], v[252:255]
 s_waitcnt lgkmcnt(8)
 v_mul_f32 v120, s7, v120
 v_mul_f32 v121, s7, v121
 v_mfma_f32_16x16x32_bf16 v[192:195], a[160:163], v[16:19], v[192:195]
 ds_read_b64_tr_b16 v[40:41], v9 offset:36864
 v_mul_f32 v122, s7, v122
 v_mfma_f32_16x16x32_bf16 v[192:195], a[164:167], v[20:23], v[192:195]
 v_mul_f32 v123, s7, v123
 v_cvt_pk_bf16_f32 v56, v104, v105
 v_mfma_f32_16x16x32_bf16 v[196:199], a[172:175], v[20:23], v[196:199]
 ds_read_b64_tr_b16 v[42:43], v9 offset:37120
 v_cvt_pk_bf16_f32 v57, v106, v107
 v_cvt_pk_bf16_f32 v58, v120, v121
 v_mfma_f32_16x16x32_bf16 v[196:199], a[168:171], v[16:19], v[196:199]
 v_cvt_pk_bf16_f32 v59, v122, v123
 v_mfma_f32_16x16x32_bf16 v[200:203], a[176:179], v[16:19], v[200:203]
 ds_read_b64_tr_b16 v[44:45], v9 offset:38912
 s_add_u32 s5, s4, 4096
 buffer_store_dwordx4 v[56:59], v13, s[84:87], s5 offen offset:0 sc1
 v_mfma_f32_16x16x32_bf16 v[200:203], a[180:183], v[20:23], v[200:203]
 v_mul_f32 v108, s7, v108
 v_mul_f32 v109, s7, v109
 v_mfma_f32_16x16x32_bf16 v[204:207], a[188:191], v[20:23], v[204:207]
 ds_read_b64_tr_b16 v[46:47], v9 offset:39168
 v_mul_f32 v110, s7, v110
 v_mfma_f32_16x16x32_bf16 v[204:207], a[184:187], v[16:19], v[204:207]
 s_waitcnt lgkmcnt(8)
 v_mul_f32 v111, s7, v111
 v_mul_f32 v124, s7, v124
 v_mfma_f32_16x16x32_bf16 v[208:211], a[160:163], v[24:27], v[208:211]
 ds_read_b64_tr_b16 v[16:17], v10 offset:32768
 v_mul_f32 v125, s7, v125
 v_mfma_f32_16x16x32_bf16 v[208:211], a[164:167], v[28:31], v[208:211]
 v_mul_f32 v126, s7, v126
 v_mul_f32 v127, s7, v127
 v_mfma_f32_16x16x32_bf16 v[212:215], a[172:175], v[28:31], v[212:215]
 ds_read_b64_tr_b16 v[18:19], v10 offset:33024
 v_cvt_pk_bf16_f32 v60, v108, v109
 v_cvt_pk_bf16_f32 v61, v110, v111
 v_mfma_f32_16x16x32_bf16 v[212:215], a[168:171], v[24:27], v[212:215]
 v_cvt_pk_bf16_f32 v62, v124, v125
 v_mfma_f32_16x16x32_bf16 v[216:219], a[176:179], v[24:27], v[216:219]
 ds_read_b64_tr_b16 v[20:21], v10 offset:34816
 v_cvt_pk_bf16_f32 v63, v126, v127
 s_add_u32 s5, s4, 4096
 v_mfma_f32_16x16x32_bf16 v[216:219], a[180:183], v[28:31], v[216:219]
 buffer_store_dwordx4 v[60:63], v13, s[84:87], s5 offen offset:128 sc1
 s_mul_i32 s4, s97, 10
 v_mfma_f32_16x16x32_bf16 v[220:223], a[188:191], v[28:31], v[220:223]
 ds_read_b64_tr_b16 v[22:23], v10 offset:35072
 s_add_i32 s4, s4, -219
 v_mfma_f32_16x16x32_bf16 v[220:223], a[184:187], v[24:27], v[220:223]
 s_waitcnt lgkmcnt(8)
 s_lshr_b32 s8, s4, 5
 s_and_b32 s4, s4, 31
 v_mfma_f32_16x16x32_bf16 v[224:227], a[160:163], v[32:35], v[224:227]
 ds_read_b64_tr_b16 v[24:25], v11 offset:32768
 s_lshl_b32 s4, s4, 18
 v_mfma_f32_16x16x32_bf16 v[224:227], a[164:167], v[36:39], v[224:227]
 s_cmp_eq_u32 s8, 0
 s_cselect_b32 s7, 0x3e3504f3, s100
 v_mfma_f32_16x16x32_bf16 v[228:231], a[172:175], v[36:39], v[228:231]
 ds_read_b64_tr_b16 v[26:27], v11 offset:33024
 s_cselect_b32 s8, 0, 0x800000
 s_add_u32 s4, s4, s8
 v_mfma_f32_16x16x32_bf16 v[228:231], a[168:171], v[32:35], v[228:231]
 v_mul_f32 v128, s7, v128
 v_mfma_f32_16x16x32_bf16 v[232:235], a[176:179], v[32:35], v[232:235]
 ds_read_b64_tr_b16 v[28:29], v11 offset:34816
 v_mul_f32 v129, s7, v129
 v_mul_f32 v130, s7, v130
 v_mfma_f32_16x16x32_bf16 v[232:235], a[180:183], v[36:39], v[232:235]
 v_mul_f32 v131, s7, v131
 v_mul_f32 v144, s7, v144
 v_mfma_f32_16x16x32_bf16 v[236:239], a[188:191], v[36:39], v[236:239]
 ds_read_b64_tr_b16 v[30:31], v11 offset:35072
 v_mul_f32 v145, s7, v145
 v_mfma_f32_16x16x32_bf16 v[236:239], a[184:187], v[32:35], v[236:239]
 s_waitcnt lgkmcnt(8)
 v_mul_f32 v146, s7, v146
 v_mul_f32 v147, s7, v147
 v_mfma_f32_16x16x32_bf16 v[240:243], a[160:163], v[40:43], v[240:243]
 ds_read_b64_tr_b16 v[32:33], v10 offset:36864
 v_cvt_pk_bf16_f32 v56, v128, v129
 v_mfma_f32_16x16x32_bf16 v[240:243], a[164:167], v[44:47], v[240:243]
 v_cvt_pk_bf16_f32 v57, v130, v131
 v_cvt_pk_bf16_f32 v58, v144, v145
 v_mfma_f32_16x16x32_bf16 v[244:247], a[172:175], v[44:47], v[244:247]
 ds_read_b64_tr_b16 v[34:35], v10 offset:37120
 v_cvt_pk_bf16_f32 v59, v146, v147
 s_add_u32 s5, s4, 0
 v_mfma_f32_16x16x32_bf16 v[244:247], a[168:171], v[40:43], v[244:247]
 buffer_store_dwordx4 v[56:59], v13, s[84:87], s5 offen offset:0 sc1
 v_mfma_f32_16x16x32_bf16 v[248:251], a[176:179], v[40:43], v[248:251]
 ds_read_b64_tr_b16 v[36:37], v10 offset:38912
 v_mul_f32 v132, s7, v132
 v_mul_f32 v133, s7, v133
 v_mfma_f32_16x16x32_bf16 v[248:251], a[180:183], v[44:47], v[248:251]
 v_mul_f32 v134, s7, v134
 v_mul_f32 v135, s7, v135
 v_mfma_f32_16x16x32_bf16 v[252:255], a[188:191], v[44:47], v[252:255]
 ds_read_b64_tr_b16 v[38:39], v10 offset:39168
 v_mul_f32 v148, s7, v148
 v_mfma_f32_16x16x32_bf16 v[252:255], a[184:187], v[40:43], v[252:255]
 s_waitcnt lgkmcnt(8)
 v_mul_f32 v149, s7, v149
 v_mul_f32 v150, s7, v150
 v_mfma_f32_16x16x32_bf16 v[192:195], a[192:195], v[16:19], v[192:195]
 ds_read_b64_tr_b16 v[40:41], v11 offset:36864
 v_mul_f32 v151, s7, v151
 v_mfma_f32_16x16x32_bf16 v[192:195], a[196:199], v[20:23], v[192:195]
 v_cvt_pk_bf16_f32 v60, v132, v133
 v_cvt_pk_bf16_f32 v61, v134, v135
 v_mfma_f32_16x16x32_bf16 v[196:199], a[204:207], v[20:23], v[196:199]
 ds_read_b64_tr_b16 v[42:43], v11 offset:37120
 v_cvt_pk_bf16_f32 v62, v148, v149
 v_cvt_pk_bf16_f32 v63, v150, v151
 v_mfma_f32_16x16x32_bf16 v[196:199], a[200:203], v[16:19], v[196:199]
 s_add_u32 s5, s4, 0
 v_mfma_f32_16x16x32_bf16 v[200:203], a[208:211], v[16:19], v[200:203]
 ds_read_b64_tr_b16 v[44:45], v11 offset:38912
 buffer_store_dwordx4 v[60:63], v13, s[84:87], s5 offen offset:128 sc1
 v_mul_f32 v136, s7, v136
 v_mfma_f32_16x16x32_bf16 v[200:203], a[212:215], v[20:23], v[200:203]
 v_mul_f32 v137, s7, v137
 v_mul_f32 v138, s7, v138
 v_mfma_f32_16x16x32_bf16 v[204:207], a[220:223], v[20:23], v[204:207]
 ds_read_b64_tr_b16 v[46:47], v11 offset:39168
 v_mul_f32 v139, s7, v139
 v_mfma_f32_16x16x32_bf16 v[204:207], a[216:219], v[16:19], v[204:207]
 s_waitcnt lgkmcnt(8)
 v_mul_f32 v152, s7, v152
 v_mul_f32 v153, s7, v153
 v_mfma_f32_16x16x32_bf16 v[208:211], a[192:195], v[24:27], v[208:211]
 ds_read_b64_tr_b16 v[16:17], v4 offset:32768
 v_mul_f32 v154, s7, v154
 v_mfma_f32_16x16x32_bf16 v[208:211], a[196:199], v[28:31], v[208:211]
 v_mul_f32 v155, s7, v155
 v_cvt_pk_bf16_f32 v56, v136, v137
 v_mfma_f32_16x16x32_bf16 v[212:215], a[204:207], v[28:31], v[212:215]
 ds_read_b64_tr_b16 v[18:19], v4 offset:33024
 v_cvt_pk_bf16_f32 v57, v138, v139
 v_cvt_pk_bf16_f32 v58, v152, v153
 v_mfma_f32_16x16x32_bf16 v[212:215], a[200:203], v[24:27], v[212:215]
 v_cvt_pk_bf16_f32 v59, v154, v155
 v_mfma_f32_16x16x32_bf16 v[216:219], a[208:211], v[24:27], v[216:219]
 ds_read_b64_tr_b16 v[20:21], v4 offset:34816
 s_add_u32 s5, s4, 4096
 buffer_store_dwordx4 v[56:59], v13, s[84:87], s5 offen offset:0 sc1
 v_mfma_f32_16x16x32_bf16 v[216:219], a[212:215], v[28:31], v[216:219]
 v_mul_f32 v140, s7, v140
 v_mul_f32 v141, s7, v141
 v_mfma_f32_16x16x32_bf16 v[220:223], a[220:223], v[28:31], v[220:223]
 ds_read_b64_tr_b16 v[22:23], v4 offset:35072
 v_mul_f32 v142, s7, v142
 v_mfma_f32_16x16x32_bf16 v[220:223], a[216:219], v[24:27], v[220:223]
 s_waitcnt lgkmcnt(8)
 v_mul_f32 v143, s7, v143
 v_mul_f32 v156, s7, v156
 v_mfma_f32_16x16x32_bf16 v[224:227], a[192:195], v[32:35], v[224:227]
 ds_read_b64_tr_b16 v[24:25], v5 offset:32768
 v_mul_f32 v157, s7, v157
 v_mfma_f32_16x16x32_bf16 v[224:227], a[196:199], v[36:39], v[224:227]
 v_mul_f32 v158, s7, v158
 v_mul_f32 v159, s7, v159
 v_mfma_f32_16x16x32_bf16 v[228:231], a[204:207], v[36:39], v[228:231]
 ds_read_b64_tr_b16 v[26:27], v5 offset:33024
 v_cvt_pk_bf16_f32 v60, v140, v141
 v_cvt_pk_bf16_f32 v61, v142, v143
 v_mfma_f32_16x16x32_bf16 v[228:231], a[200:203], v[32:35], v[228:231]
 v_cvt_pk_bf16_f32 v62, v156, v157
 v_mfma_f32_16x16x32_bf16 v[232:235], a[208:211], v[32:35], v[232:235]
 ds_read_b64_tr_b16 v[28:29], v5 offset:34816
 v_cvt_pk_bf16_f32 v63, v158, v159
 s_add_u32 s5, s4, 4096
 v_mfma_f32_16x16x32_bf16 v[232:235], a[212:215], v[36:39], v[232:235]
 buffer_store_dwordx4 v[60:63], v13, s[84:87], s5 offen offset:128 sc1
 s_mul_i32 s4, s97, 10
 v_mfma_f32_16x16x32_bf16 v[236:239], a[220:223], v[36:39], v[236:239]
 ds_read_b64_tr_b16 v[30:31], v5 offset:35072
 s_add_i32 s4, s4, -217
 v_mfma_f32_16x16x32_bf16 v[236:239], a[216:219], v[32:35], v[236:239]
 s_waitcnt lgkmcnt(8)
 s_lshr_b32 s8, s4, 5
 s_and_b32 s4, s4, 31
 v_mfma_f32_16x16x32_bf16 v[240:243], a[192:195], v[40:43], v[240:243]
 ds_read_b64_tr_b16 v[32:33], v4 offset:36864
 s_lshl_b32 s4, s4, 18
 v_mfma_f32_16x16x32_bf16 v[240:243], a[196:199], v[44:47], v[240:243]
 s_cmp_eq_u32 s8, 0
 s_cselect_b32 s7, 0x3e3504f3, s100
 v_mfma_f32_16x16x32_bf16 v[244:247], a[204:207], v[44:47], v[244:247]
 ds_read_b64_tr_b16 v[34:35], v4 offset:37120
 s_cselect_b32 s8, 0, 0x800000
 s_add_u32 s4, s4, s8
 v_mfma_f32_16x16x32_bf16 v[244:247], a[200:203], v[40:43], v[244:247]
 v_mul_f32 v160, s7, v160
 v_mfma_f32_16x16x32_bf16 v[248:251], a[208:211], v[40:43], v[248:251]
 ds_read_b64_tr_b16 v[36:37], v4 offset:38912
 v_mul_f32 v161, s7, v161
 v_mul_f32 v162, s7, v162
 v_mfma_f32_16x16x32_bf16 v[248:251], a[212:215], v[44:47], v[248:251]
 v_mul_f32 v163, s7, v163
 v_mul_f32 v176, s7, v176
 v_mfma_f32_16x16x32_bf16 v[252:255], a[220:223], v[44:47], v[252:255]
 ds_read_b64_tr_b16 v[38:39], v4 offset:39168
 v_mul_f32 v177, s7, v177
 v_mfma_f32_16x16x32_bf16 v[252:255], a[216:219], v[40:43], v[252:255]
 s_waitcnt lgkmcnt(8)
 v_mul_f32 v178, s7, v178
 v_mul_f32 v179, s7, v179
 v_mfma_f32_16x16x32_bf16 v[192:195], a[224:227], v[16:19], v[192:195]
 ds_read_b64_tr_b16 v[40:41], v5 offset:36864
 v_cvt_pk_bf16_f32 v56, v160, v161
 v_mfma_f32_16x16x32_bf16 v[192:195], a[228:231], v[20:23], v[192:195]
 v_cvt_pk_bf16_f32 v57, v162, v163
 v_cvt_pk_bf16_f32 v58, v176, v177
 v_mfma_f32_16x16x32_bf16 v[196:199], a[236:239], v[20:23], v[196:199]
 ds_read_b64_tr_b16 v[42:43], v5 offset:37120
 v_cvt_pk_bf16_f32 v59, v178, v179
 s_add_u32 s5, s4, 0
 v_mfma_f32_16x16x32_bf16 v[196:199], a[232:235], v[16:19], v[196:199]
 buffer_store_dwordx4 v[56:59], v13, s[84:87], s5 offen offset:0 sc1
 v_mfma_f32_16x16x32_bf16 v[200:203], a[240:243], v[16:19], v[200:203]
 ds_read_b64_tr_b16 v[44:45], v5 offset:38912
 v_mul_f32 v164, s7, v164
 v_mul_f32 v165, s7, v165
 v_mfma_f32_16x16x32_bf16 v[200:203], a[244:247], v[20:23], v[200:203]
 v_mul_f32 v166, s7, v166
 v_mul_f32 v167, s7, v167
 v_mfma_f32_16x16x32_bf16 v[204:207], a[252:255], v[20:23], v[204:207]
 ds_read_b64_tr_b16 v[46:47], v5 offset:39168
 v_mul_f32 v180, s7, v180
 v_mfma_f32_16x16x32_bf16 v[204:207], a[248:251], v[16:19], v[204:207]
 s_waitcnt lgkmcnt(8)
 v_mul_f32 v181, s7, v181
 v_mul_f32 v182, s7, v182
 v_mfma_f32_16x16x32_bf16 v[208:211], a[224:227], v[24:27], v[208:211]
 v_mul_f32 v183, s7, v183
 v_mfma_f32_16x16x32_bf16 v[208:211], a[228:231], v[28:31], v[208:211]
 v_cvt_pk_bf16_f32 v60, v164, v165
 v_cvt_pk_bf16_f32 v61, v166, v167
 v_mfma_f32_16x16x32_bf16 v[212:215], a[236:239], v[28:31], v[212:215]
 v_cvt_pk_bf16_f32 v62, v180, v181
 v_cvt_pk_bf16_f32 v63, v182, v183
 v_mfma_f32_16x16x32_bf16 v[212:215], a[232:235], v[24:27], v[212:215]
 s_add_u32 s5, s4, 0
 v_mfma_f32_16x16x32_bf16 v[216:219], a[240:243], v[24:27], v[216:219]
 buffer_store_dwordx4 v[60:63], v13, s[84:87], s5 offen offset:128 sc1
 v_mul_f32 v168, s7, v168
 v_mfma_f32_16x16x32_bf16 v[216:219], a[244:247], v[28:31], v[216:219]
 v_mul_f32 v169, s7, v169
 v_mul_f32 v170, s7, v170
 v_mfma_f32_16x16x32_bf16 v[220:223], a[252:255], v[28:31], v[220:223]
 v_mul_f32 v171, s7, v171
 v_mfma_f32_16x16x32_bf16 v[220:223], a[248:251], v[24:27], v[220:223]
 s_waitcnt lgkmcnt(4)
 v_mul_f32 v184, s7, v184
 v_mul_f32 v185, s7, v185
 v_mfma_f32_16x16x32_bf16 v[224:227], a[224:227], v[32:35], v[224:227]
 v_mul_f32 v186, s7, v186
 v_mfma_f32_16x16x32_bf16 v[224:227], a[228:231], v[36:39], v[224:227]
 v_mul_f32 v187, s7, v187
 v_cvt_pk_bf16_f32 v56, v168, v169
 v_mfma_f32_16x16x32_bf16 v[228:231], a[236:239], v[36:39], v[228:231]
 v_cvt_pk_bf16_f32 v57, v170, v171
 v_cvt_pk_bf16_f32 v58, v184, v185
 v_mfma_f32_16x16x32_bf16 v[228:231], a[232:235], v[32:35], v[228:231]
 v_cvt_pk_bf16_f32 v59, v186, v187
 v_mfma_f32_16x16x32_bf16 v[232:235], a[240:243], v[32:35], v[232:235]
 s_add_u32 s5, s4, 4096
 buffer_store_dwordx4 v[56:59], v13, s[84:87], s5 offen offset:0 sc1
 v_mfma_f32_16x16x32_bf16 v[232:235], a[244:247], v[36:39], v[232:235]
 v_mul_f32 v172, s7, v172
 v_mul_f32 v173, s7, v173
 v_mfma_f32_16x16x32_bf16 v[236:239], a[252:255], v[36:39], v[236:239]
 v_mul_f32 v174, s7, v174
 v_mfma_f32_16x16x32_bf16 v[236:239], a[248:251], v[32:35], v[236:239]
 s_waitcnt lgkmcnt(0)
 v_mul_f32 v175, s7, v175
 v_mul_f32 v188, s7, v188
 v_mfma_f32_16x16x32_bf16 v[240:243], a[224:227], v[40:43], v[240:243]
 v_mul_f32 v189, s7, v189
 v_mfma_f32_16x16x32_bf16 v[240:243], a[228:231], v[44:47], v[240:243]
 v_mul_f32 v190, s7, v190
 v_mul_f32 v191, s7, v191
 v_mfma_f32_16x16x32_bf16 v[244:247], a[236:239], v[44:47], v[244:247]
 v_cvt_pk_bf16_f32 v60, v172, v173
 v_cvt_pk_bf16_f32 v61, v174, v175
 v_mfma_f32_16x16x32_bf16 v[244:247], a[232:235], v[40:43], v[244:247]
 v_cvt_pk_bf16_f32 v62, v188, v189
 v_mfma_f32_16x16x32_bf16 v[248:251], a[240:243], v[40:43], v[248:251]
 v_cvt_pk_bf16_f32 v63, v190, v191
 s_add_u32 s5, s4, 4096
 v_mfma_f32_16x16x32_bf16 v[248:251], a[244:247], v[44:47], v[248:251]
 buffer_store_dwordx4 v[60:63], v13, s[84:87], s5 offen offset:128 sc1
 v_mfma_f32_16x16x32_bf16 v[252:255], a[252:255], v[44:47], v[252:255]
 v_mfma_f32_16x16x32_bf16 v[252:255], a[248:251], v[40:43], v[252:255]
 s_nop 7
 s_mul_i32 s4, s97, 10
 s_add_i32 s4, s4, -216
 s_lshr_b32 s8, s4, 5
 s_and_b32 s4, s4, 31
 s_lshl_b32 s4, s4, 18
 s_cmp_eq_u32 s8, 0
 s_cselect_b32 s7, 0x3e3504f3, s100
 s_cselect_b32 s8, 0, 0x800000
 s_add_u32 s4, s4, s8
 v_mul_f32 v192, s7, v192
 v_mul_f32 v193, s7, v193
 v_mul_f32 v194, s7, v194
 v_mul_f32 v195, s7, v195
 v_mul_f32 v196, s7, v196
 v_mul_f32 v197, s7, v197
 v_mul_f32 v198, s7, v198
 v_mul_f32 v199, s7, v199
 v_cvt_pk_bf16_f32 v56, v192, v193
 v_cvt_pk_bf16_f32 v57, v194, v195
 v_cvt_pk_bf16_f32 v58, v196, v197
 v_cvt_pk_bf16_f32 v59, v198, v199
 s_add_u32 s5, s4, 0
 buffer_store_dwordx4 v[56:59], v14, s[84:87], s5 offen offset:2048 sc1
 v_mul_f32 v200, s7, v200
 v_mul_f32 v201, s7, v201
 v_mul_f32 v202, s7, v202
 v_mul_f32 v203, s7, v203
 v_mul_f32 v204, s7, v204
 v_mul_f32 v205, s7, v205
 v_mul_f32 v206, s7, v206
 v_mul_f32 v207, s7, v207
 v_cvt_pk_bf16_f32 v60, v200, v201
 v_cvt_pk_bf16_f32 v61, v202, v203
 v_cvt_pk_bf16_f32 v62, v204, v205
 v_cvt_pk_bf16_f32 v63, v206, v207
 s_add_u32 s5, s4, 4096
 buffer_store_dwordx4 v[60:63], v14, s[84:87], s5 offen offset:2048 sc1
 v_mul_f32 v208, s7, v208
 v_mul_f32 v209, s7, v209
 v_mul_f32 v210, s7, v210
 v_mul_f32 v211, s7, v211
 v_mul_f32 v212, s7, v212
 v_mul_f32 v213, s7, v213
 v_mul_f32 v214, s7, v214
 v_mul_f32 v215, s7, v215
 v_cvt_pk_bf16_f32 v56, v208, v209
 v_cvt_pk_bf16_f32 v57, v210, v211
 v_cvt_pk_bf16_f32 v58, v212, v213
 v_cvt_pk_bf16_f32 v59, v214, v215
 s_add_u32 s5, s4, 0
 buffer_store_dwordx4 v[56:59], v14, s[84:87], s5 offen offset:2304 sc1
 v_mul_f32 v216, s7, v216
 v_mul_f32 v217, s7, v217
 v_mul_f32 v218, s7, v218
 v_mul_f32 v219, s7, v219
 v_mul_f32 v220, s7, v220
 v_mul_f32 v221, s7, v221
 v_mul_f32 v222, s7, v222
 v_mul_f32 v223, s7, v223
 v_cvt_pk_bf16_f32 v60, v216, v217
 v_cvt_pk_bf16_f32 v61, v218, v219
 v_cvt_pk_bf16_f32 v62, v220, v221
 v_cvt_pk_bf16_f32 v63, v222, v223
 s_add_u32 s5, s4, 4096
 buffer_store_dwordx4 v[60:63], v14, s[84:87], s5 offen offset:2304 sc1
 s_mul_i32 s4, s97, 10
 s_add_i32 s4, s4, -215
 s_lshr_b32 s8, s4, 5
 s_and_b32 s4, s4, 31
 s_lshl_b32 s4, s4, 18
 s_cmp_eq_u32 s8, 0
 s_cselect_b32 s7, 0x3e3504f3, s100
 s_cselect_b32 s8, 0, 0x800000
 s_add_u32 s4, s4, s8
 v_mul_f32 v224, s7, v224
 v_mul_f32 v225, s7, v225
 v_mul_f32 v226, s7, v226
 v_mul_f32 v227, s7, v227
 v_mul_f32 v228, s7, v228
 v_mul_f32 v229, s7, v229
 v_mul_f32 v230, s7, v230
 v_mul_f32 v231, s7, v231
 v_cvt_pk_bf16_f32 v56, v224, v225
 v_cvt_pk_bf16_f32 v57, v226, v227
 v_cvt_pk_bf16_f32 v58, v228, v229
 v_cvt_pk_bf16_f32 v59, v230, v231
 s_add_u32 s5, s4, 0
 buffer_store_dwordx4 v[56:59], v14, s[84:87], s5 offen offset:2048 sc1
 v_mul_f32 v232, s7, v232
 v_mul_f32 v233, s7, v233
 v_mul_f32 v234, s7, v234
 v_mul_f32 v235, s7, v235
 v_mul_f32 v236, s7, v236
 v_mul_f32 v237, s7, v237
 v_mul_f32 v238, s7, v238
 v_mul_f32 v239, s7, v239
 v_cvt_pk_bf16_f32 v60, v232, v233
 v_cvt_pk_bf16_f32 v61, v234, v235
 v_cvt_pk_bf16_f32 v62, v236, v237
 v_cvt_pk_bf16_f32 v63, v238, v239
 s_add_u32 s5, s4, 4096
 buffer_store_dwordx4 v[60:63], v14, s[84:87], s5 offen offset:2048 sc1
 v_mul_f32 v240, s7, v240
 v_mul_f32 v241, s7, v241
 v_mul_f32 v242, s7, v242
 v_mul_f32 v243, s7, v243
 v_mul_f32 v244, s7, v244
 v_mul_f32 v245, s7, v245
 v_mul_f32 v246, s7, v246
 v_mul_f32 v247, s7, v247
 v_cvt_pk_bf16_f32 v56, v240, v241
 v_cvt_pk_bf16_f32 v57, v242, v243
 v_cvt_pk_bf16_f32 v58, v244, v245
 v_cvt_pk_bf16_f32 v59, v246, v247
 s_add_u32 s5, s4, 0
 buffer_store_dwordx4 v[56:59], v14, s[84:87], s5 offen offset:2304 sc1
 v_mul_f32 v248, s7, v248
 v_mul_f32 v249, s7, v249
 v_mul_f32 v250, s7, v250
 v_mul_f32 v251, s7, v251
 v_mul_f32 v252, s7, v252
 v_mul_f32 v253, s7, v253
 v_mul_f32 v254, s7, v254
 v_mul_f32 v255, s7, v255
 v_cvt_pk_bf16_f32 v60, v248, v249
 v_cvt_pk_bf16_f32 v61, v250, v251
 v_cvt_pk_bf16_f32 v62, v252, v253
 v_cvt_pk_bf16_f32 v63, v254, v255
 s_add_u32 s5, s4, 4096
 buffer_store_dwordx4 v[60:63], v14, s[84:87], s5 offen offset:2304 sc1
 s_endpgm
L_g1_B_fin:
L_g1_varC:
.p2align 6
 s_waitcnt lgkmcnt(8)
 v_mfma_f32_16x16x32_bf16 a[0:3], a[128:131], v[16:19], a[0:3]
 ds_read_b64_tr_b16 v[40:41], v7 offset:4096
 v_mfma_f32_16x16x32_bf16 a[0:3], a[132:135], v[20:23], a[0:3]
 s_add_u32 m0, s94, 28672
 v_mfma_f32_16x16x32_bf16 a[4:7], a[140:143], v[20:23], a[4:7]
 ds_read_b64_tr_b16 v[42:43], v7 offset:4352
 v_mfma_f32_16x16x32_bf16 a[4:7], a[136:139], v[16:19], a[4:7]
 buffer_load_dwordx4 v3, s[68:71], s89 offen lds
 v_mfma_f32_16x16x32_bf16 a[8:11], a[144:147], v[16:19], a[8:11]
 ds_read_b64_tr_b16 v[44:45], v7 offset:6144
 v_mfma_f32_16x16x32_bf16 a[8:11], a[148:151], v[20:23], a[8:11]
 s_add_u32 m0, s94, 32768
 v_mfma_f32_16x16x32_bf16 a[12:15], a[156:159], v[20:23], a[12:15]
 ds_read_b64_tr_b16 v[46:47], v7 offset:6400
 v_mfma_f32_16x16x32_bf16 a[12:15], a[152:155], v[16:19], a[12:15]
 s_waitcnt lgkmcnt(8)
 buffer_load_dwordx4 v3, s[72:75], s89 offen lds
 v_mfma_f32_16x16x32_bf16 a[16:19], a[128:131], v[24:27], a[16:19]
 ds_read_b64_tr_b16 v[16:17], v6 offset:8192
 v_mfma_f32_16x16x32_bf16 a[16:19], a[132:135], v[28:31], a[16:19]
 s_add_u32 m0, s94, 36864
 v_mfma_f32_16x16x32_bf16 a[20:23], a[140:143], v[28:31], a[20:23]
 ds_read_b64_tr_b16 v[18:19], v6 offset:8448
 v_mfma_f32_16x16x32_bf16 a[20:23], a[136:139], v[24:27], a[20:23]
 buffer_load_dwordx4 v3, s[76:79], s89 offen lds
 v_mfma_f32_16x16x32_bf16 a[24:27], a[144:147], v[24:27], a[24:27]
 ds_read_b64_tr_b16 v[20:21], v6 offset:10240
 v_mfma_f32_16x16x32_bf16 a[24:27], a[148:151], v[28:31], a[24:27]
 s_add_u32 s9, s9, 1
 s_cmp_lt_u32 s9, 4
 s_cselect_b32 s3, 1, 3
 s_add_u32 s100, s9, s11
 s_and_b32 s100, s100, s3
 s_andn2_b32 s3, s9, s3
 s_or_b32 s100, s100, s3
 s_mul_i32 s88, s100, s90
 s_mul_i32 s89, s100, s91
 s_add_u32 s94, s94, 40960
 s_cmp_ge_u32 s94, s99
 s_cselect_b32 s3, 163840, 0
 s_sub_u32 s94, s94, s3
 buffer_load_dwordx4 a[160:163], v8, s[84:87], s92 offen offset:0 sc1
 v_mfma_f32_16x16x32_bf16 a[28:31], a[156:159], v[28:31], a[28:31]
 ds_read_b64_tr_b16 v[22:23], v6 offset:10496
 v_mfma_f32_16x16x32_bf16 a[28:31], a[152:155], v[24:27], a[28:31]
 s_waitcnt lgkmcnt(8)
 v_mfma_f32_16x16x32_bf16 a[32:35], a[128:131], v[32:35], a[32:35]
 ds_read_b64_tr_b16 v[24:25], v7 offset:8192
 v_mfma_f32_16x16x32_bf16 a[32:35], a[132:135], v[36:39], a[32:35]
 buffer_load_dwordx4 a[164:167], v8, s[84:87], s92 offen offset:1024 sc1
 v_mfma_f32_16x16x32_bf16 a[36:39], a[140:143], v[36:39], a[36:39]
 ds_read_b64_tr_b16 v[26:27], v7 offset:8448
 v_mfma_f32_16x16x32_bf16 a[36:39], a[136:139], v[32:35], a[36:39]
 v_mfma_f32_16x16x32_bf16 a[40:43], a[144:147], v[32:35], a[40:43]
 ds_read_b64_tr_b16 v[28:29], v7 offset:10240
 v_mfma_f32_16x16x32_bf16 a[40:43], a[148:151], v[36:39], a[40:43]
 buffer_load_dwordx4 a[168:171], v9, s[84:87], s92 offen offset:0 sc1
 v_mfma_f32_16x16x32_bf16 a[44:47], a[156:159], v[36:39], a[44:47]
 ds_read_b64_tr_b16 v[30:31], v7 offset:10496
 v_mfma_f32_16x16x32_bf16 a[44:47], a[152:155], v[32:35], a[44:47]
 s_waitcnt lgkmcnt(8)
 v_mfma_f32_16x16x32_bf16 a[48:51], a[128:131], v[40:43], a[48:51]
 ds_read_b64_tr_b16 v[32:33], v6 offset:12288
 v_mfma_f32_16x16x32_bf16 a[48:51], a[132:135], v[44:47], a[48:51]
 buffer_load_dwordx4 a[172:175], v9, s[84:87], s92 offen offset:1024 sc1
 v_mfma_f32_16x16x32_bf16 a[52:55], a[140:143], v[44:47], a[52:55]
 ds_read_b64_tr_b16 v[34:35], v6 offset:12544
 v_mfma_f32_16x16x32_bf16 a[52:55], a[136:139], v[40:43], a[52:55]
 v_mfma_f32_16x16x32_bf16 a[56:59], a[144:147], v[40:43], a[56:59]
 ds_read_b64_tr_b16 v[36:37], v6 offset:14336
 v_mfma_f32_16x16x32_bf16 a[56:59], a[148:151], v[44:47], a[56:59]
 buffer_load_dwordx4 a[176:179], v10, s[84:87], s92 offen offset:0 sc1
 v_mfma_f32_16x16x32_bf16 a[60:63], a[156:159], v[44:47], a[60:63]
 ds_read_b64_tr_b16 v[38:39], v6 offset:14592
 v_mfma_f32_16x16x32_bf16 a[60:63], a[152:155], v[40:43], a[60:63]
 s_waitcnt lgkmcnt(8)
 v_mfma_f32_16x16x32_bf16 a[64:67], a[128:131], v[16:19], a[64:67]
 ds_read_b64_tr_b16 v[40:41], v7 offset:12288
 v_mfma_f32_16x16x32_bf16 a[64:67], a[132:135], v[20:23], a[64:67]
 buffer_load_dwordx4 a[180:183], v10, s[84:87], s92 offen offset:1024 sc1
 v_mfma_f32_16x16x32_bf16 a[68:71], a[140:143], v[20:23], a[68:71]
 ds_read_b64_tr_b16 v[42:43], v7 offset:12544
 v_mfma_f32_16x16x32_bf16 a[68:71], a[136:139], v[16:19], a[68:71]
 v_mfma_f32_16x16x32_bf16 a[72:75], a[144:147], v[16:19], a[72:75]
 ds_read_b64_tr_b16 v[44:45], v7 offset:14336
 v_mfma_f32_16x16x32_bf16 a[72:75], a[148:151], v[20:23], a[72:75]
 buffer_load_dwordx4 a[184:187], v11, s[84:87], s92 offen offset:0 sc1
 v_mfma_f32_16x16x32_bf16 a[76:79], a[156:159], v[20:23], a[76:79]
 ds_read_b64_tr_b16 v[46:47], v7 offset:14592
 v_mfma_f32_16x16x32_bf16 a[76:79], a[152:155], v[16:19], a[76:79]
 s_waitcnt lgkmcnt(8)
 v_mfma_f32_16x16x32_bf16 a[80:83], a[128:131], v[24:27], a[80:83]
 ds_read_b64_tr_b16 v[16:17], v6 offset:16384
 v_mfma_f32_16x16x32_bf16 a[80:83], a[132:135], v[28:31], a[80:83]
 buffer_load_dwordx4 a[188:191], v11, s[84:87], s92 offen offset:1024 sc1
 v_mfma_f32_16x16x32_bf16 a[84:87], a[140:143], v[28:31], a[84:87]
 ds_read_b64_tr_b16 v[18:19], v6 offset:16640
 s_add_u32 s10, s10, 1
 s_cmp_lt_u32 s10, 4
 s_cselect_b32 s3, 1, 3
 s_add_u32 s92, s10, s11
 s_and_b32 s92, s92, s3
 s_andn2_b32 s3, s10, s3
 s_or_b32 s92, s92, s3
 s_lshl_b32 s92, s92, 11
 v_mfma_f32_16x16x32_bf16 a[84:87], a[136:139], v[24:27], a[84:87]
 s_add_u32 m0, s94, 0
 v_mfma_f32_16x16x32_bf16 a[88:91], a[144:147], v[24:27], a[88:91]
 ds_read_b64_tr_b16 v[20:21], v6 offset:18432
 v_mfma_f32_16x16x32_bf16 a[88:91], a[148:151], v[28:31], a[88:91]
 buffer_load_dwordx4 v2, s[40:43], s88 offen lds
 v_mfma_f32_16x16x32_bf16 a[92:95], a[156:159], v[28:31], a[92:95]
 ds_read_b64_tr_b16 v[22:23], v6 offset:18688
 v_mfma_f32_16x16x32_bf16 a[92:95], a[152:155], v[24:27], a[92:95]
 s_waitcnt lgkmcnt(8)
 s_add_u32 m0, s94, 8192
 v_mfma_f32_16x16x32_bf16 a[96:99], a[128:131], v[32:35], a[96:99]
 ds_read_b64_tr_b16 v[24:25], v7 offset:16384
 v_mfma_f32_16x16x32_bf16 a[96:99], a[132:135], v[36:39], a[96:99]
 buffer_load_dwordx4 v2, s[48:51], s88 offen lds
 v_mfma_f32_16x16x32_bf16 a[100:103], a[140:143], v[36:39], a[100:103]
 ds_read_b64_tr_b16 v[26:27], v7 offset:16640
 v_mfma_f32_16x16x32_bf16 a[100:103], a[136:139], v[32:35], a[100:103]
 s_add_u32 m0, s94, 4096
 v_mfma_f32_16x16x32_bf16 a[104:107], a[144:147], v[32:35], a[104:107]
 ds_read_b64_tr_b16 v[28:29], v7 offset:18432
 v_mfma_f32_16x16x32_bf16 a[104:107], a[148:151], v[36:39], a[104:107]
 buffer_load_dwordx4 v2, s[44:47], s88 offen lds
 v_mfma_f32_16x16x32_bf16 a[108:111], a[156:159], v[36:39], a[108:111]
 ds_read_b64_tr_b16 v[30:31], v7 offset:18688
 v_mfma_f32_16x16x32_bf16 a[108:111], a[152:155], v[32:35], a[108:111]
 s_waitcnt lgkmcnt(8)
 s_add_u32 m0, s94, 12288
 v_mfma_f32_16x16x32_bf16 a[112:115], a[128:131], v[40:43], a[112:115]
 ds_read_b64_tr_b16 v[32:33], v6 offset:20480
 v_mfma_f32_16x16x32_bf16 a[112:115], a[132:135], v[44:47], a[112:115]
 buffer_load_dwordx4 v2, s[52:55], s88 offen lds
 v_mfma_f32_16x16x32_bf16 a[116:119], a[140:143], v[44:47], a[116:119]
 ds_read_b64_tr_b16 v[34:35], v6 offset:20736
 v_mfma_f32_16x16x32_bf16 a[116:119], a[136:139], v[40:43], a[116:119]
 s_add_u32 m0, s94, 16384
 v_mfma_f32_16x16x32_bf16 a[120:123], a[144:147], v[40:43], a[120:123]
 ds_read_b64_tr_b16 v[36:37], v6 offset:22528
 v_mfma_f32_16x16x32_bf16 a[120:123], a[148:151], v[44:47], a[120:123]
 buffer_load_dwordx4 v3, s[56:59], s89 offen lds
 v_mfma_f32_16x16x32_bf16 a[124:127], a[156:159], v[44:47], a[124:127]
 ds_read_b64_tr_b16 v[38:39], v6 offset:22784
 v_mfma_f32_16x16x32_bf16 a[124:127], a[152:155], v[40:43], a[124:127]
 s_waitcnt lgkmcnt(8)
 s_add_u32 m0, s94, 24576
 v_mfma_f32_16x16x32_bf16 v[64:67], a[128:131], v[16:19], v[64:67]
 ds_read_b64_tr_b16 v[40:41], v7 offset:20480
 v_mfma_f32_16x16x32_bf16 v[64:67], a[132:135], v[20:23], v[64:67]
 buffer_load_dwordx4 v3, s[64:67], s89 offen lds
 v_mfma_f32_16x16x32_bf16 v[68:71], a[140:143], v[20:23], v[68:71]
 ds_read_b64_tr_b16 v[42:43], v7 offset:20736
 v_mfma_f32_16x16x32_bf16 v[68:71], a[136:139], v[16:19], v[68:71]
 s_add_u32 m0, s94, 20480
 v_mfma_f32_16x16x32_bf16 v[72:75], a[144:147], v[16:19], v[72:75]
 ds_read_b64_tr_b16 v[44:45], v7 offset:22528
 v_mfma_f32_16x16x32_bf16 v[72:75], a[148:151], v[20:23], v[72:75]
 buffer_load_dwordx4 v3, s[60:63], s89 offen lds
 v_mfma_f32_16x16x32_bf16 v[76:79], a[156:159], v[20:23], v[76:79]
 ds_read_b64_tr_b16 v[46:47], v7 offset:22784
 v_mfma_f32_16x16x32_bf16 v[76:79], a[152:155], v[16:19], v[76:79]
 s_waitcnt lgkmcnt(8)
 s_add_u32 m0, s94, 28672
 v_mfma_f32_16x16x32_bf16 v[80:83], a[128:131], v[24:27], v[80:83]
 ds_read_b64_tr_b16 v[16:17], v6 offset:24576
 v_mfma_f32_16x16x32_bf16 v[80:83], a[132:135], v[28:31], v[80:83]
 buffer_load_dwordx4 v3, s[68:71], s89 offen lds
 v_mfma_f32_16x16x32_bf16 v[84:87], a[140:143], v[28:31], v[84:87]
 ds_read_b64_tr_b16 v[18:19], v6 offset:24832
 v_mfma_f32_16x16x32_bf16 v[84:87], a[136:139], v[24:27], v[84:87]
 s_add_u32 m0, s94, 32768
 v_mfma_f32_16x16x32_bf16 v[88:91], a[144:147], v[24:27], v[88:91]
 ds_read_b64_tr_b16 v[20:21], v6 offset:26624
 v_mfma_f32_16x16x32_bf16 v[88:91], a[148:151], v[28:31], v[88:91]
 buffer_load_dwordx4 v3, s[72:75], s89 offen lds
 v_mfma_f32_16x16x32_bf16 v[92:95], a[156:159], v[28:31], v[92:95]
 ds_read_b64_tr_b16 v[22:23], v6 offset:26880
 v_mfma_f32_16x16x32_bf16 v[92:95], a[152:155], v[24:27], v[92:95]
 s_waitcnt lgkmcnt(8)
 s_add_u32 m0, s94, 36864
 v_mfma_f32_16x16x32_bf16 v[96:99], a[128:131], v[32:35], v[96:99]
 ds_read_b64_tr_b16 v[24:25], v7 offset:24576
 v_mfma_f32_16x16x32_bf16 v[96:99], a[132:135], v[36:39], v[96:99]
 buffer_load_dwordx4 v3, s[76:79], s89 offen lds
 v_mfma_f32_16x16x32_bf16 v[100:103], a[140:143], v[36:39], v[100:103]
 ds_read_b64_tr_b16 v[26:27], v7 offset:24832
 v_mfma_f32_16x16x32_bf16 v[100:103], a[136:139], v[32:35], v[100:103]
 s_add_u32 s9, s9, 1
 s_cmp_lt_u32 s9, 4
 s_cselect_b32 s3, 1, 3
 s_add_u32 s100, s9, s11
 s_and_b32 s100, s100, s3
 s_andn2_b32 s3, s9, s3
 s_or_b32 s100, s100, s3
 s_mul_i32 s88, s100, s90
 s_mul_i32 s89, s100, s91
 s_add_u32 s94, s94, 40960
 s_cmp_ge_u32 s94, s99
 s_cselect_b32 s3, 163840, 0
 s_sub_u32 s94, s94, s3
 v_mfma_f32_16x16x32_bf16 v[104:107], a[144:147], v[32:35], v[104:107]
 ds_read_b64_tr_b16 v[28:29], v7 offset:26624
 v_mfma_f32_16x16x32_bf16 v[104:107], a[148:151], v[36:39], v[104:107]
 s_add_u32 m0, s94, 0
 v_mfma_f32_16x16x32_bf16 v[108:111], a[156:159], v[36:39], v[108:111]
 ds_read_b64_tr_b16 v[30:31], v7 offset:26880
 v_mfma_f32_16x16x32_bf16 v[108:111], a[152:155], v[32:35], v[108:111]
 s_waitcnt lgkmcnt(8)
 buffer_load_dwordx4 v2, s[40:43], s88 offen lds
 v_mfma_f32_16x16x32_bf16 v[112:115], a[128:131], v[40:43], v[112:115]
 ds_read_b64_tr_b16 v[32:33], v6 offset:28672
 v_mfma_f32_16x16x32_bf16 v[112:115], a[132:135], v[44:47], v[112:115]
 v_mfma_f32_16x16x32_bf16 v[116:119], a[140:143], v[44:47], v[116:119]
 ds_read_b64_tr_b16 v[34:35], v6 offset:28928
 s_add_u32 m0, s94, 8192
 v_mfma_f32_16x16x32_bf16 v[116:119], a[136:139], v[40:43], v[116:119]
 v_mfma_f32_16x16x32_bf16 v[120:123], a[144:147], v[40:43], v[120:123]
 ds_read_b64_tr_b16 v[36:37], v6 offset:30720
 buffer_load_dwordx4 v2, s[48:51], s88 offen lds
 v_mfma_f32_16x16x32_bf16 v[120:123], a[148:151], v[44:47], v[120:123]
 v_mfma_f32_16x16x32_bf16 v[124:127], a[156:159], v[44:47], v[124:127]
 ds_read_b64_tr_b16 v[38:39], v6 offset:30976
 v_mfma_f32_16x16x32_bf16 v[124:127], a[152:155], v[40:43], v[124:127]
 s_waitcnt lgkmcnt(8)
 s_add_u32 m0, s94, 4096
 v_mfma_f32_16x16x32_bf16 v[128:131], a[128:131], v[16:19], v[128:131]
 ds_read_b64_tr_b16 v[40:41], v7 offset:28672
 v_mfma_f32_16x16x32_bf16 v[128:131], a[132:135], v[20:23], v[128:131]
 buffer_load_dwordx4 v2, s[44:47], s88 offen lds
 v_mfma_f32_16x16x32_bf16 v[132:135], a[140:143], v[20:23], v[132:135]
 ds_read_b64_tr_b16 v[42:43], v7 offset:28928
 v_mfma_f32_16x16x32_bf16 v[132:135], a[136:139], v[16:19], v[132:135]
 v_mfma_f32_16x16x32_bf16 v[136:139], a[144:147], v[16:19], v[136:139]
 ds_read_b64_tr_b16 v[44:45], v7 offset:30720
 s_add_u32 m0, s94, 12288
 v_mfma_f32_16x16x32_bf16 v[136:139], a[148:151], v[20:23], v[136:139]
 v_mfma_f32_16x16x32_bf16 v[140:143], a[156:159], v[20:23], v[140:143]
 ds_read_b64_tr_b16 v[46:47], v7 offset:30976
 buffer_load_dwordx4 v2, s[52:55], s88 offen lds
 v_mfma_f32_16x16x32_bf16 v[140:143], a[152:155], v[16:19], v[140:143]
 s_waitcnt lgkmcnt(8)
 v_mfma_f32_16x16x32_bf16 v[144:147], a[128:131], v[24:27], v[144:147]
 ds_read_b64_tr_b16 v[16:17], v6 offset:32768
 v_mfma_f32_16x16x32_bf16 v[144:147], a[132:135], v[28:31], v[144:147]
 s_add_u32 m0, s94, 16384
 v_mfma_f32_16x16x32_bf16 v[148:151], a[140:143], v[28:31], v[148:151]
 ds_read_b64_tr_b16 v[18:19], v6 offset:33024
 v_mfma_f32_16x16x32_bf16 v[148:151], a[136:139], v[24:27], v[148:151]
 buffer_load_dwordx4 v3, s[56:59], s89 offen lds
 v_mfma_f32_16x16x32_bf16 v[152:155], a[144:147], v[24:27], v[152:155]
 ds_read_b64_tr_b16 v[20:21], v6 offset:34816
 v_mfma_f32_16x16x32_bf16 v[152:155], a[148:151], v[28:31], v[152:155]
 v_mfma_f32_16x16x32_bf16 v[156:159], a[156:159], v[28:31], v[156:159]
 ds_read_b64_tr_b16 v[22:23], v6 offset:35072
 s_add_u32 m0, s94, 24576
 v_mfma_f32_16x16x32_bf16 v[156:159], a[152:155], v[24:27], v[156:159]
 s_waitcnt lgkmcnt(8)
 v_mfma_f32_16x16x32_bf16 v[160:163], a[128:131], v[32:35], v[160:163]
 ds_read_b64_tr_b16 v[24:25], v7 offset:32768
 buffer_load_dwordx4 v3, s[64:67], s89 offen lds
 v_mfma_f32_16x16x32_bf16 v[160:163], a[132:135], v[36:39], v[160:163]
 v_mfma_f32_16x16x32_bf16 v[164:167], a[140:143], v[36:39], v[164:167]
 ds_read_b64_tr_b16 v[26:27], v7 offset:33024
 v_mfma_f32_16x16x32_bf16 v[164:167], a[136:139], v[32:35], v[164:167]
 s_add_u32 m0, s94, 20480
 v_mfma_f32_16x16x32_bf16 v[168:171], a[144:147], v[32:35], v[168:171]
 ds_read_b64_tr_b16 v[28:29], v7 offset:34816
 v_mfma_f32_16x16x32_bf16 v[168:171], a[148:151], v[36:39], v[168:171]
 buffer_load_dwordx4 v3, s[60:63], s89 offen lds
 v_mfma_f32_16x16x32_bf16 v[172:175], a[156:159], v[36:39], v[172:175]
 ds_read_b64_tr_b16 v[30:31], v7 offset:35072
 v_mfma_f32_16x16x32_bf16 v[172:175], a[152:155], v[32:35], v[172:175]
 s_waitcnt lgkmcnt(8)
 v_mfma_f32_16x16x32_bf16 v[176:179], a[128:131], v[40:43], v[176:179]
 ds_read_b64_tr_b16 v[32:33], v6 offset:36864
 s_add_u32 m0, s94, 28672
 v_mfma_f32_16x16x32_bf16 v[176:179], a[132:135], v[44:47], v[176:179]
 v_mfma_f32_16x16x32_bf16 v[180:183], a[140:143], v[44:47], v[180:183]
 ds_read_b64_tr_b16 v[34:35], v6 offset:37120
 buffer_load_dwordx4 v3, s[68:71], s89 offen lds
 v_mfma_f32_16x16x32_bf16 v[180:183], a[136:139], v[40:43], v[180:183]
 v_mfma_f32_16x16x32_bf16 v[184:187], a[144:147], v[40:43], v[184:187]
 ds_read_b64_tr_b16 v[36:37], v6 offset:38912
 v_mfma_f32_16x16x32_bf16 v[184:187], a[148:151], v[44:47], v[184:187]
 s_add_u32 m0, s94, 32768
 v_mfma_f32_16x16x32_bf16 v[188:191], a[156:159], v[44:47], v[188:191]
 ds_read_b64_tr_b16 v[38:39], v6 offset:39168
 v_mfma_f32_16x16x32_bf16 v[188:191], a[152:155], v[40:43], v[188:191]
 s_waitcnt lgkmcnt(8)
 buffer_load_dwordx4 v3, s[72:75], s89 offen lds
 v_mfma_f32_16x16x32_bf16 v[192:195], a[128:131], v[16:19], v[192:195]
 ds_read_b64_tr_b16 v[40:41], v7 offset:36864
 v_mfma_f32_16x16x32_bf16 v[192:195], a[132:135], v[20:23], v[192:195]
 v_mfma_f32_16x16x32_bf16 v[196:199], a[140:143], v[20:23], v[196:199]
 ds_read_b64_tr_b16 v[42:43], v7 offset:37120
 s_add_u32 m0, s94, 36864
 v_mfma_f32_16x16x32_bf16 v[196:199], a[136:139], v[16:19], v[196:199]
 v_mfma_f32_16x16x32_bf16 v[200:203], a[144:147], v[16:19], v[200:203]
 ds_read_b64_tr_b16 v[44:45], v7 offset:38912
 buffer_load_dwordx4 v3, s[76:79], s89 offen lds
 v_mfma_f32_16x16x32_bf16 v[200:203], a[148:151], v[20:23], v[200:203]
 v_mfma_f32_16x16x32_bf16 v[204:207], a[156:159], v[20:23], v[204:207]
 ds_read_b64_tr_b16 v[46:47], v7 offset:39168
 v_mfma_f32_16x16x32_bf16 v[204:207], a[152:155], v[16:19], v[204:207]
 s_waitcnt lgkmcnt(8)
 v_mfma_f32_16x16x32_bf16 v[208:211], a[128:131], v[24:27], v[208:211]
 v_mfma_f32_16x16x32_bf16 v[208:211], a[132:135], v[28:31], v[208:211]
 v_mfma_f32_16x16x32_bf16 v[212:215], a[140:143], v[28:31], v[212:215]
 v_mfma_f32_16x16x32_bf16 v[212:215], a[136:139], v[24:27], v[212:215]
 v_mfma_f32_16x16x32_bf16 v[216:219], a[144:147], v[24:27], v[216:219]
 s_add_u32 s93, s93, 40960
 v_mfma_f32_16x16x32_bf16 v[216:219], a[148:151], v[28:31], v[216:219]
 s_cmp_ge_u32 s93, 163840
 v_mfma_f32_16x16x32_bf16 v[220:223], a[156:159], v[28:31], v[220:223]
 s_cselect_b32 s93, 0, s93
 v_mfma_f32_16x16x32_bf16 v[220:223], a[152:155], v[24:27], v[220:223]
 s_waitcnt lgkmcnt(4)
 s_waitcnt vmcnt(20) lgkmcnt(0)
 s_barrier
 v_add_u32 v6, s93, v4
 v_add_u32 v7, s93, v5
 v_mfma_f32_16x16x32_bf16 v[224:227], a[128:131], v[32:35], v[224:227]
 s_add_u32 s9, s9, 1
 ds_read_b64_tr_b16 v[16:17], v6 offset:0
 v_mfma_f32_16x16x32_bf16 v[224:227], a[132:135], v[36:39], v[224:227]
 s_cmp_lt_u32 s9, 4
 ds_read_b64_tr_b16 v[18:19], v6 offset:256
 v_mfma_f32_16x16x32_bf16 v[228:231], a[140:143], v[36:39], v[228:231]
 s_cselect_b32 s3, 1, 3
 ds_read_b64_tr_b16 v[20:21], v6 offset:2048
 v_mfma_f32_16x16x32_bf16 v[228:231], a[136:139], v[32:35], v[228:231]
 s_add_u32 s100, s9, s11
 ds_read_b64_tr_b16 v[22:23], v6 offset:2304
 v_mfma_f32_16x16x32_bf16 v[232:235], a[144:147], v[32:35], v[232:235]
 s_and_b32 s100, s100, s3
 ds_read_b64_tr_b16 v[24:25], v7 offset:0
 v_mfma_f32_16x16x32_bf16 v[232:235], a[148:151], v[36:39], v[232:235]
 s_andn2_b32 s3, s9, s3
 ds_read_b64_tr_b16 v[26:27], v7 offset:256
 v_mfma_f32_16x16x32_bf16 v[236:239], a[156:159], v[36:39], v[236:239]
 s_or_b32 s100, s100, s3
 ds_read_b64_tr_b16 v[28:29], v7 offset:2048
 v_mfma_f32_16x16x32_bf16 v[236:239], a[152:155], v[32:35], v[236:239]
 s_waitcnt lgkmcnt(7)
 ds_read_b64_tr_b16 v[30:31], v7 offset:2304
 v_mfma_f32_16x16x32_bf16 v[240:243], a[128:131], v[40:43], v[240:243]
 s_mul_i32 s88, s100, s90
 ds_read_b64_tr_b16 v[32:33], v6 offset:4096
 v_mfma_f32_16x16x32_bf16 v[240:243], a[132:135], v[44:47], v[240:243]
 s_mul_i32 s89, s100, s91
 v_mfma_f32_16x16x32_bf16 v[244:247], a[140:143], v[44:47], v[244:247]
 s_add_u32 s94, s94, 40960
 ds_read_b64_tr_b16 v[34:35], v6 offset:4352
 v_mfma_f32_16x16x32_bf16 v[244:247], a[136:139], v[40:43], v[244:247]
 s_cmp_ge_u32 s94, s99
 v_mfma_f32_16x16x32_bf16 v[248:251], a[144:147], v[40:43], v[248:251]
 s_cselect_b32 s3, 163840, 0
 ds_read_b64_tr_b16 v[36:37], v6 offset:6144
 v_mfma_f32_16x16x32_bf16 v[248:251], a[148:151], v[44:47], v[248:251]
 s_sub_u32 s94, s94, s3
 v_mfma_f32_16x16x32_bf16 v[252:255], a[156:159], v[44:47], v[252:255]
 ds_read_b64_tr_b16 v[38:39], v6 offset:6400
 v_mfma_f32_16x16x32_bf16 v[252:255], a[152:155], v[40:43], v[252:255]
.p2align 6
L_g1_loopC:
 s_waitcnt lgkmcnt(8)
 v_mfma_f32_16x16x32_bf16 a[0:3], a[160:163], v[16:19], a[0:3]
 ds_read_b64_tr_b16 v[40:41], v7 offset:4096
 v_mfma_f32_16x16x32_bf16 a[0:3], a[164:167], v[20:23], a[0:3]
 v_mfma_f32_16x16x32_bf16 a[4:7], a[172:175], v[20:23], a[4:7]
 ds_read_b64_tr_b16 v[42:43], v7 offset:4352
 v_mfma_f32_16x16x32_bf16 a[4:7], a[168:171], v[16:19], a[4:7]
 buffer_load_dwordx4 a[128:131], v8, s[84:87], s92 offen offset:0 sc1
 v_mfma_f32_16x16x32_bf16 a[8:11], a[176:179], v[16:19], a[8:11]
 ds_read_b64_tr_b16 v[44:45], v7 offset:6144
 v_mfma_f32_16x16x32_bf16 a[8:11], a[180:183], v[20:23], a[8:11]
 v_mfma_f32_16x16x32_bf16 a[12:15], a[188:191], v[20:23], a[12:15]
 ds_read_b64_tr_b16 v[46:47], v7 offset:6400
 v_mfma_f32_16x16x32_bf16 a[12:15], a[184:187], v[16:19], a[12:15]
 s_waitcnt lgkmcnt(8)
 v_mfma_f32_16x16x32_bf16 a[16:19], a[160:163], v[24:27], a[16:19]
 ds_read_b64_tr_b16 v[16:17], v6 offset:8192
 v_mfma_f32_16x16x32_bf16 a[16:19], a[164:167], v[28:31], a[16:19]
 v_mfma_f32_16x16x32_bf16 a[20:23], a[172:175], v[28:31], a[20:23]
 ds_read_b64_tr_b16 v[18:19], v6 offset:8448
 v_mfma_f32_16x16x32_bf16 a[20:23], a[168:171], v[24:27], a[20:23]
 buffer_load_dwordx4 a[132:135], v8, s[84:87], s92 offen offset:1024 sc1
 v_mfma_f32_16x16x32_bf16 a[24:27], a[176:179], v[24:27], a[24:27]
 ds_read_b64_tr_b16 v[20:21], v6 offset:10240
 v_mfma_f32_16x16x32_bf16 a[24:27], a[180:183], v[28:31], a[24:27]
 v_mfma_f32_16x16x32_bf16 a[28:31], a[188:191], v[28:31], a[28:31]
 ds_read_b64_tr_b16 v[22:23], v6 offset:10496
 v_mfma_f32_16x16x32_bf16 a[28:31], a[184:187], v[24:27], a[28:31]
 s_waitcnt lgkmcnt(8)
 v_mfma_f32_16x16x32_bf16 a[32:35], a[160:163], v[32:35], a[32:35]
 ds_read_b64_tr_b16 v[24:25], v7 offset:8192
 v_mfma_f32_16x16x32_bf16 a[32:35], a[164:167], v[36:39], a[32:35]
 v_mfma_f32_16x16x32_bf16 a[36:39], a[172:175], v[36:39], a[36:39]
 ds_read_b64_tr_b16 v[26:27], v7 offset:8448
 v_mfma_f32_16x16x32_bf16 a[36:39], a[168:171], v[32:35], a[36:39]
 buffer_load_dwordx4 a[136:139], v9, s[84:87], s92 offen offset:0 sc1
 v_mfma_f32_16x16x32_bf16 a[40:43], a[176:179], v[32:35], a[40:43]
 ds_read_b64_tr_b16 v[28:29], v7 offset:10240
 v_mfma_f32_16x16x32_bf16 a[40:43], a[180:183], v[36:39], a[40:43]
 v_mfma_f32_16x16x32_bf16 a[44:47], a[188:191], v[36:39], a[44:47]
 ds_read_b64_tr_b16 v[30:31], v7 offset:10496
 v_mfma_f32_16x16x32_bf16 a[44:47], a[184:187], v[32:35], a[44:47]
 s_waitcnt lgkmcnt(8)
 v_mfma_f32_16x16x32_bf16 a[48:51], a[160:163], v[40:43], a[48:51]
 ds_read_b64_tr_b16 v[32:33], v6 offset:12288
 v_mfma_f32_16x16x32_bf16 a[48:51], a[164:167], v[44:47], a[48:51]
 v_mfma_f32_16x16x32_bf16 a[52:55], a[172:175], v[44:47], a[52:55]
 ds_read_b64_tr_b16 v[34:35], v6 offset:12544
 v_mfma_f32_16x16x32_bf16 a[52:55], a[168:171], v[40:43], a[52:55]
 buffer_load_dwordx4 a[140:143], v9, s[84:87], s92 offen offset:1024 sc1
 v_mfma_f32_16x16x32_bf16 a[56:59], a[176:179], v[40:43], a[56:59]
 ds_read_b64_tr_b16 v[36:37], v6 offset:14336
 v_mfma_f32_16x16x32_bf16 a[56:59], a[180:183], v[44:47], a[56:59]
 v_mfma_f32_16x16x32_bf16 a[60:63], a[188:191], v[44:47], a[60:63]
 ds_read_b64_tr_b16 v[38:39], v6 offset:14592
 v_mfma_f32_16x16x32_bf16 a[60:63], a[184:187], v[40:43], a[60:63]
 s_waitcnt lgkmcnt(8)
 v_mfma_f32_16x16x32_bf16 a[64:67], a[160:163], v[16:19], a[64:67]
 ds_read_b64_tr_b16 v[40:41], v7 offset:12288
 v_mfma_f32_16x16x32_bf16 a[64:67], a[164:167], v[20:23], a[64:67]
 v_mfma_f32_16x16x32_bf16 a[68:71], a[172:175], v[20:23], a[68:71]
 ds_read_b64_tr_b16 v[42:43], v7 offset:12544
 v_mfma_f32_16x16x32_bf16 a[68:71], a[168:171], v[16:19], a[68:71]
 buffer_load_dwordx4 a[144:147], v10, s[84:87], s92 offen offset:0 sc1
 v_mfma_f32_16x16x32_bf16 a[72:75], a[176:179], v[16:19], a[72:75]
 ds_read_b64_tr_b16 v[44:45], v7 offset:14336
 v_mfma_f32_16x16x32_bf16 a[72:75], a[180:183], v[20:23], a[72:75]
 v_mfma_f32_16x16x32_bf16 a[76:79], a[188:191], v[20:23], a[76:79]
 ds_read_b64_tr_b16 v[46:47], v7 offset:14592
 v_mfma_f32_16x16x32_bf16 a[76:79], a[184:187], v[16:19], a[76:79]
 s_waitcnt lgkmcnt(8)
 v_mfma_f32_16x16x32_bf16 a[80:83], a[160:163], v[24:27], a[80:83]
 ds_read_b64_tr_b16 v[16:17], v6 offset:16384
 v_mfma_f32_16x16x32_bf16 a[80:83], a[164:167], v[28:31], a[80:83]
 v_mfma_f32_16x16x32_bf16 a[84:87], a[172:175], v[28:31], a[84:87]
 ds_read_b64_tr_b16 v[18:19], v6 offset:16640
 v_mfma_f32_16x16x32_bf16 a[84:87], a[168:171], v[24:27], a[84:87]
 buffer_load_dwordx4 a[148:151], v10, s[84:87], s92 offen offset:1024 sc1
 v_mfma_f32_16x16x32_bf16 a[88:91], a[176:179], v[24:27], a[88:91]
 ds_read_b64_tr_b16 v[20:21], v6 offset:18432
 v_mfma_f32_16x16x32_bf16 a[88:91], a[180:183], v[28:31], a[88:91]
 v_mfma_f32_16x16x32_bf16 a[92:95], a[188:191], v[28:31], a[92:95]
 ds_read_b64_tr_b16 v[22:23], v6 offset:18688
 v_mfma_f32_16x16x32_bf16 a[92:95], a[184:187], v[24:27], a[92:95]
 s_waitcnt lgkmcnt(8)
 v_mfma_f32_16x16x32_bf16 a[96:99], a[160:163], v[32:35], a[96:99]
 ds_read_b64_tr_b16 v[24:25], v7 offset:16384
 v_mfma_f32_16x16x32_bf16 a[96:99], a[164:167], v[36:39], a[96:99]
 v_mfma_f32_16x16x32_bf16 a[100:103], a[172:175], v[36:39], a[100:103]
 ds_read_b64_tr_b16 v[26:27], v7 offset:16640
 v_mfma_f32_16x16x32_bf16 a[100:103], a[168:171], v[32:35], a[100:103]
 buffer_load_dwordx4 a[152:155], v11, s[84:87], s92 offen offset:0 sc1
 v_mfma_f32_16x16x32_bf16 a[104:107], a[176:179], v[32:35], a[104:107]
 ds_read_b64_tr_b16 v[28:29], v7 offset:18432
 v_mfma_f32_16x16x32_bf16 a[104:107], a[180:183], v[36:39], a[104:107]
 v_mfma_f32_16x16x32_bf16 a[108:111], a[188:191], v[36:39], a[108:111]
 ds_read_b64_tr_b16 v[30:31], v7 offset:18688
 v_mfma_f32_16x16x32_bf16 a[108:111], a[184:187], v[32:35], a[108:111]
 s_waitcnt lgkmcnt(8)
 v_mfma_f32_16x16x32_bf16 a[112:115], a[160:163], v[40:43], a[112:115]
 ds_read_b64_tr_b16 v[32:33], v6 offset:20480
 v_mfma_f32_16x16x32_bf16 a[112:115], a[164:167], v[44:47], a[112:115]
 v_mfma_f32_16x16x32_bf16 a[116:119], a[172:175], v[44:47], a[116:119]
 ds_read_b64_tr_b16 v[34:35], v6 offset:20736
 v_mfma_f32_16x16x32_bf16 a[116:119], a[168:171], v[40:43], a[116:119]
 buffer_load_dwordx4 a[156:159], v11, s[84:87], s92 offen offset:1024 sc1
 v_mfma_f32_16x16x32_bf16 a[120:123], a[176:179], v[40:43], a[120:123]
 s_add_u32 s10, s10, 1
 ds_read_b64_tr_b16 v[36:37], v6 offset:22528
 v_mfma_f32_16x16x32_bf16 a[120:123], a[180:183], v[44:47], a[120:123]
 s_cmp_lt_u32 s10, 4
 v_mfma_f32_16x16x32_bf16 a[124:127], a[188:191], v[44:47], a[124:127]
 s_cselect_b32 s3, 1, 3
 ds_read_b64_tr_b16 v[38:39], v6 offset:22784
 v_mfma_f32_16x16x32_bf16 a[124:127], a[184:187], v[40:43], a[124:127]
 s_add_u32 s92, s10, s11
 s_waitcnt lgkmcnt(8)
 v_mfma_f32_16x16x32_bf16 v[64:67], a[160:163], v[16:19], v[64:67]
 ds_read_b64_tr_b16 v[40:41], v7 offset:20480
 v_mfma_f32_16x16x32_bf16 v[64:67], a[164:167], v[20:23], v[64:67]
 s_add_u32 m0, s94, 0
 v_mfma_f32_16x16x32_bf16 v[68:71], a[172:175], v[20:23], v[68:71]
 s_and_b32 s92, s92, s3
 ds_read_b64_tr_b16 v[42:43], v7 offset:20736
 v_mfma_f32_16x16x32_bf16 v[68:71], a[168:171], v[16:19], v[68:71]
 s_andn2_b32 s3, s10, s3
 buffer_load_dwordx4 v2, s[40:43], s88 offen lds
 s_add_u32 m0, s94, 8192
 v_mfma_f32_16x16x32_bf16 v[72:75], a[176:179], v[16:19], v[72:75]
 s_or_b32 s92, s92, s3
 ds_read_b64_tr_b16 v[44:45], v7 offset:22528
 v_mfma_f32_16x16x32_bf16 v[72:75], a[180:183], v[20:23], v[72:75]
 s_lshl_b32 s92, s92, 11
 buffer_load_dwordx4 v2, s[48:51], s88 offen lds
 v_mfma_f32_16x16x32_bf16 v[76:79], a[188:191], v[20:23], v[76:79]
 ds_read_b64_tr_b16 v[46:47], v7 offset:22784
 v_mfma_f32_16x16x32_bf16 v[76:79], a[184:187], v[16:19], v[76:79]
 s_waitcnt lgkmcnt(8)
 v_mfma_f32_16x16x32_bf16 v[80:83], a[160:163], v[24:27], v[80:83]
 ds_read_b64_tr_b16 v[16:17], v6 offset:24576
 v_mfma_f32_16x16x32_bf16 v[80:83], a[164:167], v[28:31], v[80:83]
 v_mfma_f32_16x16x32_bf16 v[84:87], a[172:175], v[28:31], v[84:87]
 ds_read_b64_tr_b16 v[18:19], v6 offset:24832
 v_mfma_f32_16x16x32_bf16 v[84:87], a[168:171], v[24:27], v[84:87]
 v_mfma_f32_16x16x32_bf16 v[88:91], a[176:179], v[24:27], v[88:91]
 ds_read_b64_tr_b16 v[20:21], v6 offset:26624
 v_mfma_f32_16x16x32_bf16 v[88:91], a[180:183], v[28:31], v[88:91]
 v_mfma_f32_16x16x32_bf16 v[92:95], a[188:191], v[28:31], v[92:95]
 ds_read_b64_tr_b16 v[22:23], v6 offset:26880
 v_mfma_f32_16x16x32_bf16 v[92:95], a[184:187], v[24:27], v[92:95]
 s_waitcnt lgkmcnt(8)
 v_mfma_f32_16x16x32_bf16 v[96:99], a[160:163], v[32:35], v[96:99]
 ds_read_b64_tr_b16 v[24:25], v7 offset:24576
 v_mfma_f32_16x16x32_bf16 v[96:99], a[164:167], v[36:39], v[96:99]
 s_add_u32 m0, s94, 4096
 v_mfma_f32_16x16x32_bf16 v[100:103], a[172:175], v[36:39], v[100:103]
 ds_read_b64_tr_b16 v[26:27], v7 offset:24832
 v_mfma_f32_16x16x32_bf16 v[100:103], a[168:171], v[32:35], v[100:103]
 buffer_load_dwordx4 v2, s[44:47], s88 offen lds
 s_add_u32 m0, s94, 12288
 v_mfma_f32_16x16x32_bf16 v[104:107], a[176:179], v[32:35], v[104:107]
 ds_read_b64_tr_b16 v[28:29], v7 offset:26624
 v_mfma_f32_16x16x32_bf16 v[104:107], a[180:183], v[36:39], v[104:107]
 buffer_load_dwordx4 v2, s[52:55], s88 offen lds
 v_mfma_f32_16x16x32_bf16 v[108:111], a[188:191], v[36:39], v[108:111]
 ds_read_b64_tr_b16 v[30:31], v7 offset:26880
 v_mfma_f32_16x16x32_bf16 v[108:111], a[184:187], v[32:35], v[108:111]
 s_waitcnt lgkmcnt(8)
 v_mfma_f32_16x16x32_bf16 v[112:115], a[160:163], v[40:43], v[112:115]
 ds_read_b64_tr_b16 v[32:33], v6 offset:28672
 v_mfma_f32_16x16x32_bf16 v[112:115], a[164:167], v[44:47], v[112:115]
 v_mfma_f32_16x16x32_bf16 v[116:119], a[172:175], v[44:47], v[116:119]
 ds_read_b64_tr_b16 v[34:35], v6 offset:28928
 v_mfma_f32_16x16x32_bf16 v[116:119], a[168:171], v[40:43], v[116:119]
 v_mfma_f32_16x16x32_bf16 v[120:123], a[176:179], v[40:43], v[120:123]
 ds_read_b64_tr_b16 v[36:37], v6 offset:30720
 v_mfma_f32_16x16x32_bf16 v[120:123], a[180:183], v[44:47], v[120:123]
 v_mfma_f32_16x16x32_bf16 v[124:127], a[188:191], v[44:47], v[124:127]
 ds_read_b64_tr_b16 v[38:39], v6 offset:30976
 v_mfma_f32_16x16x32_bf16 v[124:127], a[184:187], v[40:43], v[124:127]
 s_waitcnt lgkmcnt(8)
 v_mfma_f32_16x16x32_bf16 v[128:131], a[160:163], v[16:19], v[128:131]
 ds_read_b64_tr_b16 v[40:41], v7 offset:28672
 v_mfma_f32_16x16x32_bf16 v[128:131], a[164:167], v[20:23], v[128:131]
 s_add_u32 m0, s94, 16384
 v_mfma_f32_16x16x32_bf16 v[132:135], a[172:175], v[20:23], v[132:135]
 ds_read_b64_tr_b16 v[42:43], v7 offset:28928
 v_mfma_f32_16x16x32_bf16 v[132:135], a[168:171], v[16:19], v[132:135]
 buffer_load_dwordx4 v3, s[56:59], s89 offen lds
 s_add_u32 m0, s94, 24576
 v_mfma_f32_16x16x32_bf16 v[136:139], a[176:179], v[16:19], v[136:139]
 ds_read_b64_tr_b16 v[44:45], v7 offset:30720
 v_mfma_f32_16x16x32_bf16 v[136:139], a[180:183], v[20:23], v[136:139]
 buffer_load_dwordx4 v3, s[64:67], s89 offen lds
 v_mfma_f32_16x16x32_bf16 v[140:143], a[188:191], v[20:23], v[140:143]
 ds_read_b64_tr_b16 v[46:47], v7 offset:30976
 v_mfma_f32_16x16x32_bf16 v[140:143], a[184:187], v[16:19], v[140:143]
 s_waitcnt lgkmcnt(8)
 v_mfma_f32_16x16x32_bf16 v[144:147], a[160:163], v[24:27], v[144:147]
 ds_read_b64_tr_b16 v[16:17], v6 offset:32768
 v_mfma_f32_16x16x32_bf16 v[144:147], a[164:167], v[28:31], v[144:147]
 v_mfma_f32_16x16x32_bf16 v[148:151], a[172:175], v[28:31], v[148:151]
 ds_read_b64_tr_b16 v[18:19], v6 offset:33024
 v_mfma_f32_16x16x32_bf16 v[148:151], a[168:171], v[24:27], v[148:151]
 v_mfma_f32_16x16x32_bf16 v[152:155], a[176:179], v[24:27], v[152:155]
 ds_read_b64_tr_b16 v[20:21], v6 offset:34816
 v_mfma_f32_16x16x32_bf16 v[152:155], a[180:183], v[28:31], v[152:155]
 v_mfma_f32_16x16x32_bf16 v[156:159], a[188:191], v[28:31], v[156:159]
 ds_read_b64_tr_b16 v[22:23], v6 offset:35072
 v_mfma_f32_16x16x32_bf16 v[156:159], a[184:187], v[24:27], v[156:159]
 s_waitcnt lgkmcnt(8)
 v_mfma_f32_16x16x32_bf16 v[160:163], a[160:163], v[32:35], v[160:163]
 ds_read_b64_tr_b16 v[24:25], v7 offset:32768
 v_mfma_f32_16x16x32_bf16 v[160:163], a[164:167], v[36:39], v[160:163]
 s_add_u32 m0, s94, 20480
 v_mfma_f32_16x16x32_bf16 v[164:167], a[172:175], v[36:39], v[164:167]
 ds_read_b64_tr_b16 v[26:27], v7 offset:33024
 v_mfma_f32_16x16x32_bf16 v[164:167], a[168:171], v[32:35], v[164:167]
 buffer_load_dwordx4 v3, s[60:63], s89 offen lds
 s_add_u32 m0, s94, 28672
 v_mfma_f32_16x16x32_bf16 v[168:171], a[176:179], v[32:35], v[168:171]
 ds_read_b64_tr_b16 v[28:29], v7 offset:34816
 v_mfma_f32_16x16x32_bf16 v[168:171], a[180:183], v[36:39], v[168:171]
 buffer_load_dwordx4 v3, s[68:71], s89 offen lds
 v_mfma_f32_16x16x32_bf16 v[172:175], a[188:191], v[36:39], v[172:175]
 ds_read_b64_tr_b16 v[30:31], v7 offset:35072
 v_mfma_f32_16x16x32_bf16 v[172:175], a[184:187], v[32:35], v[172:175]
 s_waitcnt lgkmcnt(8)
 v_mfma_f32_16x16x32_bf16 v[176:179], a[160:163], v[40:43], v[176:179]
 ds_read_b64_tr_b16 v[32:33], v6 offset:36864
 v_mfma_f32_16x16x32_bf16 v[176:179], a[164:167], v[44:47], v[176:179]
 v_mfma_f32_16x16x32_bf16 v[180:183], a[172:175], v[44:47], v[180:183]
 ds_read_b64_tr_b16 v[34:35], v6 offset:37120
 v_mfma_f32_16x16x32_bf16 v[180:183], a[168:171], v[40:43], v[180:183]
 v_mfma_f32_16x16x32_bf16 v[184:187], a[176:179], v[40:43], v[184:187]
 ds_read_b64_tr_b16 v[36:37], v6 offset:38912
 v_mfma_f32_16x16x32_bf16 v[184:187], a[180:183], v[44:47], v[184:187]
 v_mfma_f32_16x16x32_bf16 v[188:191], a[188:191], v[44:47], v[188:191]
 ds_read_b64_tr_b16 v[38:39], v6 offset:39168
 v_mfma_f32_16x16x32_bf16 v[188:191], a[184:187], v[40:43], v[188:191]
 s_waitcnt lgkmcnt(8)
 v_mfma_f32_16x16x32_bf16 v[192:195], a[160:163], v[16:19], v[192:195]
 ds_read_b64_tr_b16 v[40:41], v7 offset:36864
 v_mfma_f32_16x16x32_bf16 v[192:195], a[164:167], v[20:23], v[192:195]
 s_add_u32 m0, s94, 32768
 v_mfma_f32_16x16x32_bf16 v[196:199], a[172:175], v[20:23], v[196:199]
 ds_read_b64_tr_b16 v[42:43], v7 offset:37120
 v_mfma_f32_16x16x32_bf16 v[196:199], a[168:171], v[16:19], v[196:199]
 buffer_load_dwordx4 v3, s[72:75], s89 offen lds
 s_add_u32 m0, s94, 36864
 v_mfma_f32_16x16x32_bf16 v[200:203], a[176:179], v[16:19], v[200:203]
 ds_read_b64_tr_b16 v[44:45], v7 offset:38912
 v_mfma_f32_16x16x32_bf16 v[200:203], a[180:183], v[20:23], v[200:203]
 buffer_load_dwordx4 v3, s[76:79], s89 offen lds
 v_mfma_f32_16x16x32_bf16 v[204:207], a[188:191], v[20:23], v[204:207]
 ds_read_b64_tr_b16 v[46:47], v7 offset:39168
 v_mfma_f32_16x16x32_bf16 v[204:207], a[184:187], v[16:19], v[204:207]
 s_waitcnt lgkmcnt(8)
 v_mfma_f32_16x16x32_bf16 v[208:211], a[160:163], v[24:27], v[208:211]
 v_mfma_f32_16x16x32_bf16 v[208:211], a[164:167], v[28:31], v[208:211]
 v_mfma_f32_16x16x32_bf16 v[212:215], a[172:175], v[28:31], v[212:215]
 v_mfma_f32_16x16x32_bf16 v[212:215], a[168:171], v[24:27], v[212:215]
 v_mfma_f32_16x16x32_bf16 v[216:219], a[176:179], v[24:27], v[216:219]
 s_add_u32 s93, s93, 40960
 v_mfma_f32_16x16x32_bf16 v[216:219], a[180:183], v[28:31], v[216:219]
 s_cmp_ge_u32 s93, 163840
 v_mfma_f32_16x16x32_bf16 v[220:223], a[188:191], v[28:31], v[220:223]
 s_cselect_b32 s93, 0, s93
 v_mfma_f32_16x16x32_bf16 v[220:223], a[184:187], v[24:27], v[220:223]
 s_waitcnt lgkmcnt(4)
 s_waitcnt vmcnt(10) lgkmcnt(0)
 s_barrier
 v_add_u32 v6, s93, v4
 v_add_u32 v7, s93, v5
 v_mfma_f32_16x16x32_bf16 v[224:227], a[160:163], v[32:35], v[224:227]
 s_add_u32 s9, s9, 1
 ds_read_b64_tr_b16 v[16:17], v6 offset:0
 v_mfma_f32_16x16x32_bf16 v[224:227], a[164:167], v[36:39], v[224:227]
 s_cmp_lt_u32 s9, 4
 ds_read_b64_tr_b16 v[18:19], v6 offset:256
 v_mfma_f32_16x16x32_bf16 v[228:231], a[172:175], v[36:39], v[228:231]
 s_cselect_b32 s3, 1, 3
 ds_read_b64_tr_b16 v[20:21], v6 offset:2048
 v_mfma_f32_16x16x32_bf16 v[228:231], a[168:171], v[32:35], v[228:231]
 s_add_u32 s100, s9, s11
 ds_read_b64_tr_b16 v[22:23], v6 offset:2304
 v_mfma_f32_16x16x32_bf16 v[232:235], a[176:179], v[32:35], v[232:235]
 s_and_b32 s100, s100, s3
 ds_read_b64_tr_b16 v[24:25], v7 offset:0
 v_mfma_f32_16x16x32_bf16 v[232:235], a[180:183], v[36:39], v[232:235]
 s_andn2_b32 s3, s9, s3
 ds_read_b64_tr_b16 v[26:27], v7 offset:256
 v_mfma_f32_16x16x32_bf16 v[236:239], a[188:191], v[36:39], v[236:239]
 s_or_b32 s100, s100, s3
 ds_read_b64_tr_b16 v[28:29], v7 offset:2048
 v_mfma_f32_16x16x32_bf16 v[236:239], a[184:187], v[32:35], v[236:239]
 s_waitcnt lgkmcnt(7)
 ds_read_b64_tr_b16 v[30:31], v7 offset:2304
 v_mfma_f32_16x16x32_bf16 v[240:243], a[160:163], v[40:43], v[240:243]
 s_mul_i32 s88, s100, s90
 ds_read_b64_tr_b16 v[32:33], v6 offset:4096
 v_mfma_f32_16x16x32_bf16 v[240:243], a[164:167], v[44:47], v[240:243]
 s_mul_i32 s89, s100, s91
 v_mfma_f32_16x16x32_bf16 v[244:247], a[172:175], v[44:47], v[244:247]
 s_add_u32 s94, s94, 40960
 ds_read_b64_tr_b16 v[34:35], v6 offset:4352
 v_mfma_f32_16x16x32_bf16 v[244:247], a[168:171], v[40:43], v[244:247]
 s_cmp_ge_u32 s94, s99
 v_mfma_f32_16x16x32_bf16 v[248:251], a[176:179], v[40:43], v[248:251]
 s_cselect_b32 s3, 163840, 0
 ds_read_b64_tr_b16 v[36:37], v6 offset:6144
 v_mfma_f32_16x16x32_bf16 v[248:251], a[180:183], v[44:47], v[248:251]
 s_sub_u32 s94, s94, s3
 v_mfma_f32_16x16x32_bf16 v[252:255], a[188:191], v[44:47], v[252:255]
 ds_read_b64_tr_b16 v[38:39], v6 offset:6400
 v_mfma_f32_16x16x32_bf16 v[252:255], a[184:187], v[40:43], v[252:255]
 s_sub_u32 s96, s96, 1
 s_cmp_eq_u32 s96, 0
 s_cbranch_scc1 L_g1_outC
 s_cmp_lg_u32 s96, 1
 s_cbranch_scc1 L_g1_ttC
 s_mov_b32 s3, s95
 v_lshrrev_b32 v51, 4, v15
 s_mul_i32 s3, s3, 5120
 v_min_u32 v48, 39, v51
 v_lshlrev_b32 v48, 7, v48
 v_add_u32 v48, s3, v48
 v_min_u32 v48, L_g1_C_fin - L_g1_C - 4, v48
 s_getpc_b64 s[16:17]
 s_add_u32 s16, s16, L_g1_C - .
 s_addc_u32 s17, s17, 0
 v_mov_b32 v49, s17
 v_add_co_u32 v48, vcc, s16, v48
 s_nop 1
 v_addc_co_u32 v49, vcc, 0, v49, vcc
 global_load_dword v50, v[48:49], off
 s_branch L_g1_ttC
L_g1_ttC:
 s_waitcnt lgkmcnt(8)
 v_mfma_f32_16x16x32_bf16 a[0:3], a[128:131], v[16:19], a[0:3]
 ds_read_b64_tr_b16 v[40:41], v7 offset:4096
 v_mfma_f32_16x16x32_bf16 a[0:3], a[132:135], v[20:23], a[0:3]
 v_mfma_f32_16x16x32_bf16 a[4:7], a[140:143], v[20:23], a[4:7]
 ds_read_b64_tr_b16 v[42:43], v7 offset:4352
 v_mfma_f32_16x16x32_bf16 a[4:7], a[136:139], v[16:19], a[4:7]
 buffer_load_dwordx4 a[160:163], v8, s[84:87], s92 offen offset:0 sc1
 v_mfma_f32_16x16x32_bf16 a[8:11], a[144:147], v[16:19], a[8:11]
 ds_read_b64_tr_b16 v[44:45], v7 offset:6144
 v_mfma_f32_16x16x32_bf16 a[8:11], a[148:151], v[20:23], a[8:11]
 v_mfma_f32_16x16x32_bf16 a[12:15], a[156:159], v[20:23], a[12:15]
 ds_read_b64_tr_b16 v[46:47], v7 offset:6400
 v_mfma_f32_16x16x32_bf16 a[12:15], a[152:155], v[16:19], a[12:15]
 s_waitcnt lgkmcnt(8)
 v_mfma_f32_16x16x32_bf16 a[16:19], a[128:131], v[24:27], a[16:19]
 ds_read_b64_tr_b16 v[16:17], v6 offset:8192
 v_mfma_f32_16x16x32_bf16 a[16:19], a[132:135], v[28:31], a[16:19]
 v_mfma_f32_16x16x32_bf16 a[20:23], a[140:143], v[28:31], a[20:23]
 ds_read_b64_tr_b16 v[18:19], v6 offset:8448
 v_mfma_f32_16x16x32_bf16 a[20:23], a[136:139], v[24:27], a[20:23]
 buffer_load_dwordx4 a[164:167], v8, s[84:87], s92 offen offset:1024 sc1
 v_mfma_f32_16x16x32_bf16 a[24:27], a[144:147], v[24:27], a[24:27]
 ds_read_b64_tr_b16 v[20:21], v6 offset:10240
 v_mfma_f32_16x16x32_bf16 a[24:27], a[148:151], v[28:31], a[24:27]
 v_mfma_f32_16x16x32_bf16 a[28:31], a[156:159], v[28:31], a[28:31]
 ds_read_b64_tr_b16 v[22:23], v6 offset:10496
 v_mfma_f32_16x16x32_bf16 a[28:31], a[152:155], v[24:27], a[28:31]
 s_waitcnt lgkmcnt(8)
 v_mfma_f32_16x16x32_bf16 a[32:35], a[128:131], v[32:35], a[32:35]
 ds_read_b64_tr_b16 v[24:25], v7 offset:8192
 v_mfma_f32_16x16x32_bf16 a[32:35], a[132:135], v[36:39], a[32:35]
 v_mfma_f32_16x16x32_bf16 a[36:39], a[140:143], v[36:39], a[36:39]
 ds_read_b64_tr_b16 v[26:27], v7 offset:8448
 v_mfma_f32_16x16x32_bf16 a[36:39], a[136:139], v[32:35], a[36:39]
 buffer_load_dwordx4 a[168:171], v9, s[84:87], s92 offen offset:0 sc1
 v_mfma_f32_16x16x32_bf16 a[40:43], a[144:147], v[32:35], a[40:43]
 ds_read_b64_tr_b16 v[28:29], v7 offset:10240
 v_mfma_f32_16x16x32_bf16 a[40:43], a[148:151], v[36:39], a[40:43]
 v_mfma_f32_16x16x32_bf16 a[44:47], a[156:159], v[36:39], a[44:47]
 ds_read_b64_tr_b16 v[30:31], v7 offset:10496
 v_mfma_f32_16x16x32_bf16 a[44:47], a[152:155], v[32:35], a[44:47]
 s_waitcnt lgkmcnt(8)
 v_mfma_f32_16x16x32_bf16 a[48:51], a[128:131], v[40:43], a[48:51]
 ds_read_b64_tr_b16 v[32:33], v6 offset:12288
 v_mfma_f32_16x16x32_bf16 a[48:51], a[132:135], v[44:47], a[48:51]
 v_mfma_f32_16x16x32_bf16 a[52:55], a[140:143], v[44:47], a[52:55]
 ds_read_b64_tr_b16 v[34:35], v6 offset:12544
 v_mfma_f32_16x16x32_bf16 a[52:55], a[136:139], v[40:43], a[52:55]
 buffer_load_dwordx4 a[172:175], v9, s[84:87], s92 offen offset:1024 sc1
 v_mfma_f32_16x16x32_bf16 a[56:59], a[144:147], v[40:43], a[56:59]
 ds_read_b64_tr_b16 v[36:37], v6 offset:14336
 v_mfma_f32_16x16x32_bf16 a[56:59], a[148:151], v[44:47], a[56:59]
 v_mfma_f32_16x16x32_bf16 a[60:63], a[156:159], v[44:47], a[60:63]
 ds_read_b64_tr_b16 v[38:39], v6 offset:14592
 v_mfma_f32_16x16x32_bf16 a[60:63], a[152:155], v[40:43], a[60:63]
 s_waitcnt lgkmcnt(8)
 v_mfma_f32_16x16x32_bf16 a[64:67], a[128:131], v[16:19], a[64:67]
 ds_read_b64_tr_b16 v[40:41], v7 offset:12288
 v_mfma_f32_16x16x32_bf16 a[64:67], a[132:135], v[20:23], a[64:67]
 v_mfma_f32_16x16x32_bf16 a[68:71], a[140:143], v[20:23], a[68:71]
 ds_read_b64_tr_b16 v[42:43], v7 offset:12544
 v_mfma_f32_16x16x32_bf16 a[68:71], a[136:139], v[16:19], a[68:71]
 buffer_load_dwordx4 a[176:179], v10, s[84:87], s92 offen offset:0 sc1
 v_mfma_f32_16x16x32_bf16 a[72:75], a[144:147], v[16:19], a[72:75]
 ds_read_b64_tr_b16 v[44:45], v7 offset:14336
 v_mfma_f32_16x16x32_bf16 a[72:75], a[148:151], v[20:23], a[72:75]
 v_mfma_f32_16x16x32_bf16 a[76:79], a[156:159], v[20:23], a[76:79]
 ds_read_b64_tr_b16 v[46:47], v7 offset:14592
 v_mfma_f32_16x16x32_bf16 a[76:79], a[152:155], v[16:19], a[76:79]
 s_waitcnt lgkmcnt(8)
 v_mfma_f32_16x16x32_bf16 a[80:83], a[128:131], v[24:27], a[80:83]
 ds_read_b64_tr_b16 v[16:17], v6 offset:16384
 v_mfma_f32_16x16x32_bf16 a[80:83], a[132:135], v[28:31], a[80:83]
 v_mfma_f32_16x16x32_bf16 a[84:87], a[140:143], v[28:31], a[84:87]
 ds_read_b64_tr_b16 v[18:19], v6 offset:16640
 v_mfma_f32_16x16x32_bf16 a[84:87], a[136:139], v[24:27], a[84:87]
 buffer_load_dwordx4 a[180:183], v10, s[84:87], s92 offen offset:1024 sc1
 v_mfma_f32_16x16x32_bf16 a[88:91], a[144:147], v[24:27], a[88:91]
 ds_read_b64_tr_b16 v[20:21], v6 offset:18432
 v_mfma_f32_16x16x32_bf16 a[88:91], a[148:151], v[28:31], a[88:91]
 v_mfma_f32_16x16x32_bf16 a[92:95], a[156:159], v[28:31], a[92:95]
 ds_read_b64_tr_b16 v[22:23], v6 offset:18688
 v_mfma_f32_16x16x32_bf16 a[92:95], a[152:155], v[24:27], a[92:95]
 s_waitcnt lgkmcnt(8)
 v_mfma_f32_16x16x32_bf16 a[96:99], a[128:131], v[32:35], a[96:99]
 ds_read_b64_tr_b16 v[24:25], v7 offset:16384
 v_mfma_f32_16x16x32_bf16 a[96:99], a[132:135], v[36:39], a[96:99]
 v_mfma_f32_16x16x32_bf16 a[100:103], a[140:143], v[36:39], a[100:103]
 ds_read_b64_tr_b16 v[26:27], v7 offset:16640
 v_mfma_f32_16x16x32_bf16 a[100:103], a[136:139], v[32:35], a[100:103]
 buffer_load_dwordx4 a[184:187], v11, s[84:87], s92 offen offset:0 sc1
 v_mfma_f32_16x16x32_bf16 a[104:107], a[144:147], v[32:35], a[104:107]
 ds_read_b64_tr_b16 v[28:29], v7 offset:18432
 v_mfma_f32_16x16x32_bf16 a[104:107], a[148:151], v[36:39], a[104:107]
 v_mfma_f32_16x16x32_bf16 a[108:111], a[156:159], v[36:39], a[108:111]
 ds_read_b64_tr_b16 v[30:31], v7 offset:18688
 v_mfma_f32_16x16x32_bf16 a[108:111], a[152:155], v[32:35], a[108:111]
 s_waitcnt lgkmcnt(8)
 v_mfma_f32_16x16x32_bf16 a[112:115], a[128:131], v[40:43], a[112:115]
 ds_read_b64_tr_b16 v[32:33], v6 offset:20480
 v_mfma_f32_16x16x32_bf16 a[112:115], a[132:135], v[44:47], a[112:115]
 v_mfma_f32_16x16x32_bf16 a[116:119], a[140:143], v[44:47], a[116:119]
 ds_read_b64_tr_b16 v[34:35], v6 offset:20736
 v_mfma_f32_16x16x32_bf16 a[116:119], a[136:139], v[40:43], a[116:119]
 buffer_load_dwordx4 a[188:191], v11, s[84:87], s92 offen offset:1024 sc1
 v_mfma_f32_16x16x32_bf16 a[120:123], a[144:147], v[40:43], a[120:123]
 s_add_u32 s10, s10, 1
 ds_read_b64_tr_b16 v[36:37], v6 offset:22528
 v_mfma_f32_16x16x32_bf16 a[120:123], a[148:151], v[44:47], a[120:123]
 s_cmp_lt_u32 s10, 4
 v_mfma_f32_16x16x32_bf16 a[124:127], a[156:159], v[44:47], a[124:127]
 s_cselect_b32 s3, 1, 3
 ds_read_b64_tr_b16 v[38:39], v6 offset:22784
 v_mfma_f32_16x16x32_bf16 a[124:127], a[152:155], v[40:43], a[124:127]
 s_add_u32 s92, s10, s11
 s_waitcnt lgkmcnt(8)
 v_mfma_f32_16x16x32_bf16 v[64:67], a[128:131], v[16:19], v[64:67]
 ds_read_b64_tr_b16 v[40:41], v7 offset:20480
 v_mfma_f32_16x16x32_bf16 v[64:67], a[132:135], v[20:23], v[64:67]
 s_add_u32 m0, s94, 0
 v_mfma_f32_16x16x32_bf16 v[68:71], a[140:143], v[20:23], v[68:71]
 s_and_b32 s92, s92, s3
 ds_read_b64_tr_b16 v[42:43], v7 offset:20736
 v_mfma_f32_16x16x32_bf16 v[68:71], a[136:139], v[16:19], v[68:71]
 s_andn2_b32 s3, s10, s3
 buffer_load_dwordx4 v2, s[40:43], s88 offen lds
 s_add_u32 m0, s94, 8192
 v_mfma_f32_16x16x32_bf16 v[72:75], a[144:147], v[16:19], v[72:75]
 s_or_b32 s92, s92, s3
 ds_read_b64_tr_b16 v[44:45], v7 offset:22528
 v_mfma_f32_16x16x32_bf16 v[72:75], a[148:151], v[20:23], v[72:75]
 s_lshl_b32 s92, s92, 11
 buffer_load_dwordx4 v2, s[48:51], s88 offen lds
 v_mfma_f32_16x16x32_bf16 v[76:79], a[156:159], v[20:23], v[76:79]
 ds_read_b64_tr_b16 v[46:47], v7 offset:22784
 v_mfma_f32_16x16x32_bf16 v[76:79], a[152:155], v[16:19], v[76:79]
 s_waitcnt lgkmcnt(8)
 v_mfma_f32_16x16x32_bf16 v[80:83], a[128:131], v[24:27], v[80:83]
 ds_read_b64_tr_b16 v[16:17], v6 offset:24576
 v_mfma_f32_16x16x32_bf16 v[80:83], a[132:135], v[28:31], v[80:83]
 v_mfma_f32_16x16x32_bf16 v[84:87], a[140:143], v[28:31], v[84:87]
 ds_read_b64_tr_b16 v[18:19], v6 offset:24832
 v_mfma_f32_16x16x32_bf16 v[84:87], a[136:139], v[24:27], v[84:87]
 v_mfma_f32_16x16x32_bf16 v[88:91], a[144:147], v[24:27], v[88:91]
 ds_read_b64_tr_b16 v[20:21], v6 offset:26624
 v_mfma_f32_16x16x32_bf16 v[88:91], a[148:151], v[28:31], v[88:91]
 v_mfma_f32_16x16x32_bf16 v[92:95], a[156:159], v[28:31], v[92:95]
 ds_read_b64_tr_b16 v[22:23], v6 offset:26880
 v_mfma_f32_16x16x32_bf16 v[92:95], a[152:155], v[24:27], v[92:95]
 s_waitcnt lgkmcnt(8)
 v_mfma_f32_16x16x32_bf16 v[96:99], a[128:131], v[32:35], v[96:99]
 ds_read_b64_tr_b16 v[24:25], v7 offset:24576
 v_mfma_f32_16x16x32_bf16 v[96:99], a[132:135], v[36:39], v[96:99]
 s_add_u32 m0, s94, 4096
 v_mfma_f32_16x16x32_bf16 v[100:103], a[140:143], v[36:39], v[100:103]
 ds_read_b64_tr_b16 v[26:27], v7 offset:24832
 v_mfma_f32_16x16x32_bf16 v[100:103], a[136:139], v[32:35], v[100:103]
 buffer_load_dwordx4 v2, s[44:47], s88 offen lds
 s_add_u32 m0, s94, 12288
 v_mfma_f32_16x16x32_bf16 v[104:107], a[144:147], v[32:35], v[104:107]
 ds_read_b64_tr_b16 v[28:29], v7 offset:26624
 v_mfma_f32_16x16x32_bf16 v[104:107], a[148:151], v[36:39], v[104:107]
 buffer_load_dwordx4 v2, s[52:55], s88 offen lds
 v_mfma_f32_16x16x32_bf16 v[108:111], a[156:159], v[36:39], v[108:111]
 ds_read_b64_tr_b16 v[30:31], v7 offset:26880
 v_mfma_f32_16x16x32_bf16 v[108:111], a[152:155], v[32:35], v[108:111]
 s_waitcnt lgkmcnt(8)
 v_mfma_f32_16x16x32_bf16 v[112:115], a[128:131], v[40:43], v[112:115]
 ds_read_b64_tr_b16 v[32:33], v6 offset:28672
 v_mfma_f32_16x16x32_bf16 v[112:115], a[132:135], v[44:47], v[112:115]
 v_mfma_f32_16x16x32_bf16 v[116:119], a[140:143], v[44:47], v[116:119]
 ds_read_b64_tr_b16 v[34:35], v6 offset:28928
 v_mfma_f32_16x16x32_bf16 v[116:119], a[136:139], v[40:43], v[116:119]
 v_mfma_f32_16x16x32_bf16 v[120:123], a[144:147], v[40:43], v[120:123]
 ds_read_b64_tr_b16 v[36:37], v6 offset:30720
 v_mfma_f32_16x16x32_bf16 v[120:123], a[148:151], v[44:47], v[120:123]
 v_mfma_f32_16x16x32_bf16 v[124:127], a[156:159], v[44:47], v[124:127]
 ds_read_b64_tr_b16 v[38:39], v6 offset:30976
 v_mfma_f32_16x16x32_bf16 v[124:127], a[152:155], v[40:43], v[124:127]
 s_waitcnt lgkmcnt(8)
 v_mfma_f32_16x16x32_bf16 v[128:131], a[128:131], v[16:19], v[128:131]
 ds_read_b64_tr_b16 v[40:41], v7 offset:28672
 v_mfma_f32_16x16x32_bf16 v[128:131], a[132:135], v[20:23], v[128:131]
 s_add_u32 m0, s94, 16384
 v_mfma_f32_16x16x32_bf16 v[132:135], a[140:143], v[20:23], v[132:135]
 ds_read_b64_tr_b16 v[42:43], v7 offset:28928
 v_mfma_f32_16x16x32_bf16 v[132:135], a[136:139], v[16:19], v[132:135]
 buffer_load_dwordx4 v3, s[56:59], s89 offen lds
 s_add_u32 m0, s94, 24576
 v_mfma_f32_16x16x32_bf16 v[136:139], a[144:147], v[16:19], v[136:139]
 ds_read_b64_tr_b16 v[44:45], v7 offset:30720
 v_mfma_f32_16x16x32_bf16 v[136:139], a[148:151], v[20:23], v[136:139]
 buffer_load_dwordx4 v3, s[64:67], s89 offen lds
 v_mfma_f32_16x16x32_bf16 v[140:143], a[156:159], v[20:23], v[140:143]
 ds_read_b64_tr_b16 v[46:47], v7 offset:30976
 v_mfma_f32_16x16x32_bf16 v[140:143], a[152:155], v[16:19], v[140:143]
 s_waitcnt lgkmcnt(8)
 v_mfma_f32_16x16x32_bf16 v[144:147], a[128:131], v[24:27], v[144:147]
 ds_read_b64_tr_b16 v[16:17], v6 offset:32768
 v_mfma_f32_16x16x32_bf16 v[144:147], a[132:135], v[28:31], v[144:147]
 v_mfma_f32_16x16x32_bf16 v[148:151], a[140:143], v[28:31], v[148:151]
 ds_read_b64_tr_b16 v[18:19], v6 offset:33024
 v_mfma_f32_16x16x32_bf16 v[148:151], a[136:139], v[24:27], v[148:151]
 v_mfma_f32_16x16x32_bf16 v[152:155], a[144:147], v[24:27], v[152:155]
 ds_read_b64_tr_b16 v[20:21], v6 offset:34816
 v_mfma_f32_16x16x32_bf16 v[152:155], a[148:151], v[28:31], v[152:155]
 v_mfma_f32_16x16x32_bf16 v[156:159], a[156:159], v[28:31], v[156:159]
 ds_read_b64_tr_b16 v[22:23], v6 offset:35072
 v_mfma_f32_16x16x32_bf16 v[156:159], a[152:155], v[24:27], v[156:159]
 s_waitcnt lgkmcnt(8)
 v_mfma_f32_16x16x32_bf16 v[160:163], a[128:131], v[32:35], v[160:163]
 ds_read_b64_tr_b16 v[24:25], v7 offset:32768
 v_mfma_f32_16x16x32_bf16 v[160:163], a[132:135], v[36:39], v[160:163]
 s_add_u32 m0, s94, 20480
 v_mfma_f32_16x16x32_bf16 v[164:167], a[140:143], v[36:39], v[164:167]
 ds_read_b64_tr_b16 v[26:27], v7 offset:33024
 v_mfma_f32_16x16x32_bf16 v[164:167], a[136:139], v[32:35], v[164:167]
 buffer_load_dwordx4 v3, s[60:63], s89 offen lds
 s_add_u32 m0, s94, 28672
 v_mfma_f32_16x16x32_bf16 v[168:171], a[144:147], v[32:35], v[168:171]
 ds_read_b64_tr_b16 v[28:29], v7 offset:34816
 v_mfma_f32_16x16x32_bf16 v[168:171], a[148:151], v[36:39], v[168:171]
 buffer_load_dwordx4 v3, s[68:71], s89 offen lds
 v_mfma_f32_16x16x32_bf16 v[172:175], a[156:159], v[36:39], v[172:175]
 ds_read_b64_tr_b16 v[30:31], v7 offset:35072
 v_mfma_f32_16x16x32_bf16 v[172:175], a[152:155], v[32:35], v[172:175]
 s_waitcnt lgkmcnt(8)
 v_mfma_f32_16x16x32_bf16 v[176:179], a[128:131], v[40:43], v[176:179]
 ds_read_b64_tr_b16 v[32:33], v6 offset:36864
 v_mfma_f32_16x16x32_bf16 v[176:179], a[132:135], v[44:47], v[176:179]
 v_mfma_f32_16x16x32_bf16 v[180:183], a[140:143], v[44:47], v[180:183]
 ds_read_b64_tr_b16 v[34:35], v6 offset:37120
 v_mfma_f32_16x16x32_bf16 v[180:183], a[136:139], v[40:43], v[180:183]
 v_mfma_f32_16x16x32_bf16 v[184:187], a[144:147], v[40:43], v[184:187]
 ds_read_b64_tr_b16 v[36:37], v6 offset:38912
 v_mfma_f32_16x16x32_bf16 v[184:187], a[148:151], v[44:47], v[184:187]
 v_mfma_f32_16x16x32_bf16 v[188:191], a[156:159], v[44:47], v[188:191]
 ds_read_b64_tr_b16 v[38:39], v6 offset:39168
 v_mfma_f32_16x16x32_bf16 v[188:191], a[152:155], v[40:43], v[188:191]
 s_waitcnt lgkmcnt(8)
 v_mfma_f32_16x16x32_bf16 v[192:195], a[128:131], v[16:19], v[192:195]
 ds_read_b64_tr_b16 v[40:41], v7 offset:36864
 v_mfma_f32_16x16x32_bf16 v[192:195], a[132:135], v[20:23], v[192:195]
 s_add_u32 m0, s94, 32768
 v_mfma_f32_16x16x32_bf16 v[196:199], a[140:143], v[20:23], v[196:199]
 ds_read_b64_tr_b16 v[42:43], v7 offset:37120
 v_mfma_f32_16x16x32_bf16 v[196:199], a[136:139], v[16:19], v[196:199]
 buffer_load_dwordx4 v3, s[72:75], s89 offen lds
 s_add_u32 m0, s94, 36864
 v_mfma_f32_16x16x32_bf16 v[200:203], a[144:147], v[16:19], v[200:203]
 ds_read_b64_tr_b16 v[44:45], v7 offset:38912
 v_mfma_f32_16x16x32_bf16 v[200:203], a[148:151], v[20:23], v[200:203]
 buffer_load_dwordx4 v3, s[76:79], s89 offen lds
 v_mfma_f32_16x16x32_bf16 v[204:207], a[156:159], v[20:23], v[204:207]
 ds_read_b64_tr_b16 v[46:47], v7 offset:39168
 v_mfma_f32_16x16x32_bf16 v[204:207], a[152:155], v[16:19], v[204:207]
 s_waitcnt lgkmcnt(8)
 v_mfma_f32_16x16x32_bf16 v[208:211], a[128:131], v[24:27], v[208:211]
 v_mfma_f32_16x16x32_bf16 v[208:211], a[132:135], v[28:31], v[208:211]
 v_mfma_f32_16x16x32_bf16 v[212:215], a[140:143], v[28:31], v[212:215]
 v_mfma_f32_16x16x32_bf16 v[212:215], a[136:139], v[24:27], v[212:215]
 v_mfma_f32_16x16x32_bf16 v[216:219], a[144:147], v[24:27], v[216:219]
 s_add_u32 s93, s93, 40960
 v_mfma_f32_16x16x32_bf16 v[216:219], a[148:151], v[28:31], v[216:219]
 s_cmp_ge_u32 s93, 163840
 v_mfma_f32_16x16x32_bf16 v[220:223], a[156:159], v[28:31], v[220:223]
 s_cselect_b32 s93, 0, s93
 v_mfma_f32_16x16x32_bf16 v[220:223], a[152:155], v[24:27], v[220:223]
 s_waitcnt lgkmcnt(4)
 s_waitcnt vmcnt(10) lgkmcnt(0)
 s_barrier
 v_add_u32 v6, s93, v4
 v_add_u32 v7, s93, v5
 v_mfma_f32_16x16x32_bf16 v[224:227], a[128:131], v[32:35], v[224:227]
 s_add_u32 s9, s9, 1
 ds_read_b64_tr_b16 v[16:17], v6 offset:0
 v_mfma_f32_16x16x32_bf16 v[224:227], a[132:135], v[36:39], v[224:227]
 s_cmp_lt_u32 s9, 4
 ds_read_b64_tr_b16 v[18:19], v6 offset:256
 v_mfma_f32_16x16x32_bf16 v[228:231], a[140:143], v[36:39], v[228:231]
 s_cselect_b32 s3, 1, 3
 ds_read_b64_tr_b16 v[20:21], v6 offset:2048
 v_mfma_f32_16x16x32_bf16 v[228:231], a[136:139], v[32:35], v[228:231]
 s_add_u32 s100, s9, s11
 ds_read_b64_tr_b16 v[22:23], v6 offset:2304
 v_mfma_f32_16x16x32_bf16 v[232:235], a[144:147], v[32:35], v[232:235]
 s_and_b32 s100, s100, s3
 ds_read_b64_tr_b16 v[24:25], v7 offset:0
 v_mfma_f32_16x16x32_bf16 v[232:235], a[148:151], v[36:39], v[232:235]
 s_andn2_b32 s3, s9, s3
 ds_read_b64_tr_b16 v[26:27], v7 offset:256
 v_mfma_f32_16x16x32_bf16 v[236:239], a[156:159], v[36:39], v[236:239]
 s_or_b32 s100, s100, s3
 ds_read_b64_tr_b16 v[28:29], v7 offset:2048
 v_mfma_f32_16x16x32_bf16 v[236:239], a[152:155], v[32:35], v[236:239]
 s_waitcnt lgkmcnt(7)
 ds_read_b64_tr_b16 v[30:31], v7 offset:2304
 v_mfma_f32_16x16x32_bf16 v[240:243], a[128:131], v[40:43], v[240:243]
 s_mul_i32 s88, s100, s90
 ds_read_b64_tr_b16 v[32:33], v6 offset:4096
 v_mfma_f32_16x16x32_bf16 v[240:243], a[132:135], v[44:47], v[240:243]
 s_mul_i32 s89, s100, s91
 v_mfma_f32_16x16x32_bf16 v[244:247], a[140:143], v[44:47], v[244:247]
 s_add_u32 s94, s94, 40960
 ds_read_b64_tr_b16 v[34:35], v6 offset:4352
 v_mfma_f32_16x16x32_bf16 v[244:247], a[136:139], v[40:43], v[244:247]
 s_cmp_ge_u32 s94, s99
 v_mfma_f32_16x16x32_bf16 v[248:251], a[144:147], v[40:43], v[248:251]
 s_cselect_b32 s3, 163840, 0
 ds_read_b64_tr_b16 v[36:37], v6 offset:6144
 v_mfma_f32_16x16x32_bf16 v[248:251], a[148:151], v[44:47], v[248:251]
 s_sub_u32 s94, s94, s3
 v_mfma_f32_16x16x32_bf16 v[252:255], a[156:159], v[44:47], v[252:255]
 ds_read_b64_tr_b16 v[38:39], v6 offset:6400
 v_mfma_f32_16x16x32_bf16 v[252:255], a[152:155], v[40:43], v[252:255]
 s_branch L_g1_loopC
L_g1_outC:
L_g1_C:
 s_waitcnt lgkmcnt(8)
 v_mfma_f32_16x16x32_bf16 a[0:3], a[128:131], v[16:19], a[0:3]
 ds_read_b64_tr_b16 v[40:41], v7 offset:4096
 v_mfma_f32_16x16x32_bf16 a[0:3], a[132:135], v[20:23], a[0:3]
 buffer_load_dwordx4 a[160:163], v8, s[84:87], s92 offen offset:0 sc1
 v_mfma_f32_16x16x32_bf16 a[4:7], a[140:143], v[20:23], a[4:7]
 v_add_u32 v60, 40960, v4
 v_add_u32 v61, 40960, v5
 ds_read_b64_tr_b16 v[42:43], v7 offset:4352
 v_mfma_f32_16x16x32_bf16 a[4:7], a[136:139], v[16:19], a[4:7]
 v_mfma_f32_16x16x32_bf16 a[8:11], a[144:147], v[16:19], a[8:11]
 ds_read_b64_tr_b16 v[44:45], v7 offset:6144
 v_mfma_f32_16x16x32_bf16 a[8:11], a[148:151], v[20:23], a[8:11]
 buffer_load_dwordx4 a[164:167], v8, s[84:87], s92 offen offset:1024 sc1
 v_mfma_f32_16x16x32_bf16 a[12:15], a[156:159], v[20:23], a[12:15]
 v_add_u32 v62, 81920, v4
 v_add_u32 v63, 81920, v5
 ds_read_b64_tr_b16 v[46:47], v7 offset:6400
 v_mfma_f32_16x16x32_bf16 a[12:15], a[152:155], v[16:19], a[12:15]
 s_waitcnt lgkmcnt(8)
 v_mfma_f32_16x16x32_bf16 a[16:19], a[128:131], v[24:27], a[16:19]
 ds_read_b64_tr_b16 v[16:17], v6 offset:8192
 v_mfma_f32_16x16x32_bf16 a[16:19], a[132:135], v[28:31], a[16:19]
 buffer_load_dwordx4 a[168:171], v9, s[84:87], s92 offen offset:0 sc1
 v_mfma_f32_16x16x32_bf16 a[20:23], a[140:143], v[28:31], a[20:23]
 v_add_u32 v4, 122880, v4
 v_add_u32 v5, 122880, v5
 ds_read_b64_tr_b16 v[18:19], v6 offset:8448
 v_mfma_f32_16x16x32_bf16 a[20:23], a[136:139], v[24:27], a[20:23]
 v_mfma_f32_16x16x32_bf16 a[24:27], a[144:147], v[24:27], a[24:27]
 ds_read_b64_tr_b16 v[20:21], v6 offset:10240
 v_mfma_f32_16x16x32_bf16 a[24:27], a[148:151], v[28:31], a[24:27]
 buffer_load_dwordx4 a[172:175], v9, s[84:87], s92 offen offset:1024 sc1
 v_mfma_f32_16x16x32_bf16 a[28:31], a[156:159], v[28:31], a[28:31]
 ds_read_b64_tr_b16 v[22:23], v6 offset:10496
 v_mfma_f32_16x16x32_bf16 a[28:31], a[152:155], v[24:27], a[28:31]
 s_waitcnt lgkmcnt(8)
 v_mfma_f32_16x16x32_bf16 a[32:35], a[128:131], v[32:35], a[32:35]
 ds_read_b64_tr_b16 v[24:25], v7 offset:8192
 v_mfma_f32_16x16x32_bf16 a[32:35], a[132:135], v[36:39], a[32:35]
 buffer_load_dwordx4 a[176:179], v10, s[84:87], s92 offen offset:0 sc1
 v_mfma_f32_16x16x32_bf16 a[36:39], a[140:143], v[36:39], a[36:39]
 ds_read_b64_tr_b16 v[26:27], v7 offset:8448
 v_mfma_f32_16x16x32_bf16 a[36:39], a[136:139], v[32:35], a[36:39]
 v_mfma_f32_16x16x32_bf16 a[40:43], a[144:147], v[32:35], a[40:43]
 ds_read_b64_tr_b16 v[28:29], v7 offset:10240
 v_mfma_f32_16x16x32_bf16 a[40:43], a[148:151], v[36:39], a[40:43]
 buffer_load_dwordx4 a[180:183], v10, s[84:87], s92 offen offset:1024 sc1
 v_mfma_f32_16x16x32_bf16 a[44:47], a[156:159], v[36:39], a[44:47]
 ds_read_b64_tr_b16 v[30:31], v7 offset:10496
 v_mfma_f32_16x16x32_bf16 a[44:47], a[152:155], v[32:35], a[44:47]
 s_waitcnt lgkmcnt(8)
 v_mfma_f32_16x16x32_bf16 a[48:51], a[128:131], v[40:43], a[48:51]
 ds_read_b64_tr_b16 v[32:33], v6 offset:12288
 v_mfma_f32_16x16x32_bf16 a[48:51], a[132:135], v[44:47], a[48:51]
 buffer_load_dwordx4 a[184:187], v11, s[84:87], s92 offen offset:0 sc1
 v_mfma_f32_16x16x32_bf16 a[52:55], a[140:143], v[44:47], a[52:55]
 ds_read_b64_tr_b16 v[34:35], v6 offset:12544
 v_mfma_f32_16x16x32_bf16 a[52:55], a[136:139], v[40:43], a[52:55]
 v_mfma_f32_16x16x32_bf16 a[56:59], a[144:147], v[40:43], a[56:59]
 ds_read_b64_tr_b16 v[36:37], v6 offset:14336
 v_mfma_f32_16x16x32_bf16 a[56:59], a[148:151], v[44:47], a[56:59]
 buffer_load_dwordx4 a[188:191], v11, s[84:87], s92 offen offset:1024 sc1
 s_add_u32 s10, s10, 1
 s_cmp_lt_u32 s10, 4
 s_cselect_b32 s3, 1, 3
 s_add_u32 s92, s10, s11
 s_and_b32 s92, s92, s3
 s_andn2_b32 s3, s10, s3
 s_or_b32 s92, s92, s3
 s_lshl_b32 s92, s92, 11
 v_mfma_f32_16x16x32_bf16 a[60:63], a[156:159], v[44:47], a[60:63]
 ds_read_b64_tr_b16 v[38:39], v6 offset:14592
 v_mfma_f32_16x16x32_bf16 a[60:63], a[152:155], v[40:43], a[60:63]
 s_waitcnt lgkmcnt(8)
 v_mfma_f32_16x16x32_bf16 a[64:67], a[128:131], v[16:19], a[64:67]
 ds_read_b64_tr_b16 v[40:41], v7 offset:12288
 v_mfma_f32_16x16x32_bf16 a[64:67], a[132:135], v[20:23], a[64:67]
 buffer_load_dwordx4 a[192:195], v8, s[84:87], s92 offen offset:0 sc1
 v_mfma_f32_16x16x32_bf16 a[68:71], a[140:143], v[20:23], a[68:71]
 ds_read_b64_tr_b16 v[42:43], v7 offset:12544
 v_mfma_f32_16x16x32_bf16 a[68:71], a[136:139], v[16:19], a[68:71]
 v_mfma_f32_16x16x32_bf16 a[72:75], a[144:147], v[16:19], a[72:75]
 ds_read_b64_tr_b16 v[44:45], v7 offset:14336
 v_mfma_f32_16x16x32_bf16 a[72:75], a[148:151], v[20:23], a[72:75]
 buffer_load_dwordx4 a[196:199], v8, s[84:87], s92 offen offset:1024 sc1
 v_mfma_f32_16x16x32_bf16 a[76:79], a[156:159], v[20:23], a[76:79]
 ds_read_b64_tr_b16 v[46:47], v7 offset:14592
 v_mfma_f32_16x16x32_bf16 a[76:79], a[152:155], v[16:19], a[76:79]
 s_waitcnt lgkmcnt(8)
 v_mfma_f32_16x16x32_bf16 a[80:83], a[128:131], v[24:27], a[80:83]
 ds_read_b64_tr_b16 v[16:17], v60 offset:0
 v_mfma_f32_16x16x32_bf16 a[80:83], a[132:135], v[28:31], a[80:83]
 buffer_load_dwordx4 a[200:203], v9, s[84:87], s92 offen offset:0 sc1
 v_mfma_f32_16x16x32_bf16 a[84:87], a[140:143], v[28:31], a[84:87]
 ds_read_b64_tr_b16 v[18:19], v60 offset:256
 v_mfma_f32_16x16x32_bf16 a[84:87], a[136:139], v[24:27], a[84:87]
 v_mfma_f32_16x16x32_bf16 a[88:91], a[144:147], v[24:27], a[88:91]
 ds_read_b64_tr_b16 v[20:21], v60 offset:2048
 v_mfma_f32_16x16x32_bf16 a[88:91], a[148:151], v[28:31], a[88:91]
 buffer_load_dwordx4 a[204:207], v9, s[84:87], s92 offen offset:1024 sc1
 v_mfma_f32_16x16x32_bf16 a[92:95], a[156:159], v[28:31], a[92:95]
 ds_read_b64_tr_b16 v[22:23], v60 offset:2304
 v_mfma_f32_16x16x32_bf16 a[92:95], a[152:155], v[24:27], a[92:95]
 s_waitcnt lgkmcnt(8)
 v_mfma_f32_16x16x32_bf16 a[96:99], a[128:131], v[32:35], a[96:99]
 ds_read_b64_tr_b16 v[24:25], v61 offset:0
 v_mfma_f32_16x16x32_bf16 a[96:99], a[132:135], v[36:39], a[96:99]
 buffer_load_dwordx4 a[208:211], v10, s[84:87], s92 offen offset:0 sc1
 v_mfma_f32_16x16x32_bf16 a[100:103], a[140:143], v[36:39], a[100:103]
 ds_read_b64_tr_b16 v[26:27], v61 offset:256
 v_mfma_f32_16x16x32_bf16 a[100:103], a[136:139], v[32:35], a[100:103]
 v_mfma_f32_16x16x32_bf16 a[104:107], a[144:147], v[32:35], a[104:107]
 ds_read_b64_tr_b16 v[28:29], v61 offset:2048
 v_mfma_f32_16x16x32_bf16 a[104:107], a[148:151], v[36:39], a[104:107]
 buffer_load_dwordx4 a[212:215], v10, s[84:87], s92 offen offset:1024 sc1
 v_mfma_f32_16x16x32_bf16 a[108:111], a[156:159], v[36:39], a[108:111]
 ds_read_b64_tr_b16 v[30:31], v61 offset:2304
 v_mfma_f32_16x16x32_bf16 a[108:111], a[152:155], v[32:35], a[108:111]
 s_waitcnt lgkmcnt(8)
 v_mfma_f32_16x16x32_bf16 a[112:115], a[128:131], v[40:43], a[112:115]
 ds_read_b64_tr_b16 v[32:33], v60 offset:4096
 v_mfma_f32_16x16x32_bf16 a[112:115], a[132:135], v[44:47], a[112:115]
 buffer_load_dwordx4 a[216:219], v11, s[84:87], s92 offen offset:0 sc1
 v_mfma_f32_16x16x32_bf16 a[116:119], a[140:143], v[44:47], a[116:119]
 ds_read_b64_tr_b16 v[34:35], v60 offset:4352
 v_mfma_f32_16x16x32_bf16 a[116:119], a[136:139], v[40:43], a[116:119]
 v_mfma_f32_16x16x32_bf16 a[120:123], a[144:147], v[40:43], a[120:123]
 ds_read_b64_tr_b16 v[36:37], v60 offset:6144
 v_mfma_f32_16x16x32_bf16 a[120:123], a[148:151], v[44:47], a[120:123]
 buffer_load_dwordx4 a[220:223], v11, s[84:87], s92 offen offset:1024 sc1
 s_add_u32 s10, s10, 1
 s_cmp_lt_u32 s10, 4
 s_cselect_b32 s3, 1, 3
 s_add_u32 s92, s10, s11
 s_and_b32 s92, s92, s3
 s_andn2_b32 s3, s10, s3
 s_or_b32 s92, s92, s3
 s_lshl_b32 s92, s92, 11
 v_mfma_f32_16x16x32_bf16 a[124:127], a[156:159], v[44:47], a[124:127]
 ds_read_b64_tr_b16 v[38:39], v60 offset:6400
 v_mfma_f32_16x16x32_bf16 a[124:127], a[152:155], v[40:43], a[124:127]
 s_waitcnt vmcnt(8) lgkmcnt(8)
 v_mfma_f32_16x16x32_bf16 a[0:3], a[160:163], v[16:19], a[0:3]
 ds_read_b64_tr_b16 v[40:41], v61 offset:4096
 v_mfma_f32_16x16x32_bf16 a[0:3], a[164:167], v[20:23], a[0:3]
 s_add_u32 m0, s94, 0
 s_nop 0
 buffer_load_dwordx4 v2, s[40:43], s88 offen lds
 v_mfma_f32_16x16x32_bf16 a[4:7], a[172:175], v[20:23], a[4:7]
 ds_read_b64_tr_b16 v[42:43], v61 offset:4352
 v_mfma_f32_16x16x32_bf16 a[4:7], a[168:171], v[16:19], a[4:7]
 v_mfma_f32_16x16x32_bf16 a[8:11], a[176:179], v[16:19], a[8:11]
 ds_read_b64_tr_b16 v[44:45], v61 offset:6144
 v_mfma_f32_16x16x32_bf16 a[8:11], a[180:183], v[20:23], a[8:11]
 s_add_u32 m0, s94, 8192
 s_nop 0
 buffer_load_dwordx4 v2, s[48:51], s88 offen lds
 v_mfma_f32_16x16x32_bf16 a[12:15], a[188:191], v[20:23], a[12:15]
 s_mov_b32 s100, 0x3f317218
 ds_read_b64_tr_b16 v[46:47], v61 offset:6400
 v_mfma_f32_16x16x32_bf16 a[12:15], a[184:187], v[16:19], a[12:15]
 s_waitcnt lgkmcnt(8)
 v_mfma_f32_16x16x32_bf16 a[16:19], a[160:163], v[24:27], a[16:19]
 ds_read_b64_tr_b16 v[16:17], v60 offset:8192
 v_mfma_f32_16x16x32_bf16 a[16:19], a[164:167], v[28:31], a[16:19]
 s_add_u32 m0, s94, 4096
 s_nop 0
 buffer_load_dwordx4 v2, s[44:47], s88 offen lds
 v_mfma_f32_16x16x32_bf16 a[20:23], a[172:175], v[28:31], a[20:23]
 ds_read_b64_tr_b16 v[18:19], v60 offset:8448
 v_mfma_f32_16x16x32_bf16 a[20:23], a[168:171], v[24:27], a[20:23]
 v_mfma_f32_16x16x32_bf16 a[24:27], a[176:179], v[24:27], a[24:27]
 ds_read_b64_tr_b16 v[20:21], v60 offset:10240
 v_mfma_f32_16x16x32_bf16 a[24:27], a[180:183], v[28:31], a[24:27]
 s_add_u32 m0, s94, 12288
 s_nop 0
 buffer_load_dwordx4 v2, s[52:55], s88 offen lds
 v_mfma_f32_16x16x32_bf16 a[28:31], a[188:191], v[28:31], a[28:31]
 ds_read_b64_tr_b16 v[22:23], v60 offset:10496
 v_mfma_f32_16x16x32_bf16 a[28:31], a[184:187], v[24:27], a[28:31]
 s_waitcnt lgkmcnt(8)
 v_mfma_f32_16x16x32_bf16 a[32:35], a[160:163], v[32:35], a[32:35]
 ds_read_b64_tr_b16 v[24:25], v61 offset:8192
 v_mfma_f32_16x16x32_bf16 a[32:35], a[164:167], v[36:39], a[32:35]
 s_add_u32 m0, s94, 16384
 s_nop 0
 buffer_load_dwordx4 v3, s[56:59], s89 offen lds
 v_mfma_f32_16x16x32_bf16 a[36:39], a[172:175], v[36:39], a[36:39]
 ds_read_b64_tr_b16 v[26:27], v61 offset:8448
 v_mfma_f32_16x16x32_bf16 a[36:39], a[168:171], v[32:35], a[36:39]
 v_mfma_f32_16x16x32_bf16 a[40:43], a[176:179], v[32:35], a[40:43]
 ds_read_b64_tr_b16 v[28:29], v61 offset:10240
 v_mfma_f32_16x16x32_bf16 a[40:43], a[180:183], v[36:39], a[40:43]
 s_add_u32 m0, s94, 24576
 s_nop 0
 buffer_load_dwordx4 v3, s[64:67], s89 offen lds
 v_mfma_f32_16x16x32_bf16 a[44:47], a[188:191], v[36:39], a[44:47]
 ds_read_b64_tr_b16 v[30:31], v61 offset:10496
 v_mfma_f32_16x16x32_bf16 a[44:47], a[184:187], v[32:35], a[44:47]
 s_waitcnt lgkmcnt(8)
 v_mfma_f32_16x16x32_bf16 a[48:51], a[160:163], v[40:43], a[48:51]
 ds_read_b64_tr_b16 v[32:33], v60 offset:12288
 v_mfma_f32_16x16x32_bf16 a[48:51], a[164:167], v[44:47], a[48:51]
 s_add_u32 m0, s94, 20480
 s_nop 0
 buffer_load_dwordx4 v3, s[60:63], s89 offen lds
 v_mfma_f32_16x16x32_bf16 a[52:55], a[172:175], v[44:47], a[52:55]
 ds_read_b64_tr_b16 v[34:35], v60 offset:12544
 v_mfma_f32_16x16x32_bf16 a[52:55], a[168:171], v[40:43], a[52:55]
 v_mfma_f32_16x16x32_bf16 a[56:59], a[176:179], v[40:43], a[56:59]
 ds_read_b64_tr_b16 v[36:37], v60 offset:14336
 v_mfma_f32_16x16x32_bf16 a[56:59], a[180:183], v[44:47], a[56:59]
 s_add_u32 m0, s94, 28672
 s_nop 0
 buffer_load_dwordx4 v3, s[68:71], s89 offen lds
 v_mfma_f32_16x16x32_bf16 a[60:63], a[188:191], v[44:47], a[60:63]
 ds_read_b64_tr_b16 v[38:39], v60 offset:14592
 v_mfma_f32_16x16x32_bf16 a[60:63], a[184:187], v[40:43], a[60:63]
 s_waitcnt lgkmcnt(8)
 v_mfma_f32_16x16x32_bf16 a[64:67], a[160:163], v[16:19], a[64:67]
 ds_read_b64_tr_b16 v[40:41], v61 offset:12288
 v_mfma_f32_16x16x32_bf16 a[64:67], a[164:167], v[20:23], a[64:67]
 s_add_u32 m0, s94, 32768
 s_nop 0
 buffer_load_dwordx4 v3, s[72:75], s89 offen lds
 v_mfma_f32_16x16x32_bf16 a[68:71], a[172:175], v[20:23], a[68:71]
 ds_read_b64_tr_b16 v[42:43], v61 offset:12544
 v_mfma_f32_16x16x32_bf16 a[68:71], a[168:171], v[16:19], a[68:71]
 v_mfma_f32_16x16x32_bf16 a[72:75], a[176:179], v[16:19], a[72:75]
 ds_read_b64_tr_b16 v[44:45], v61 offset:14336
 v_mfma_f32_16x16x32_bf16 a[72:75], a[180:183], v[20:23], a[72:75]
 s_add_u32 m0, s94, 36864
 s_nop 0
 buffer_load_dwordx4 v3, s[76:79], s89 offen lds
 v_mfma_f32_16x16x32_bf16 a[76:79], a[188:191], v[20:23], a[76:79]
 ds_read_b64_tr_b16 v[46:47], v61 offset:14592
 v_mfma_f32_16x16x32_bf16 a[76:79], a[184:187], v[16:19], a[76:79]
 s_waitcnt lgkmcnt(8)
 s_waitcnt vmcnt(26)
 s_barrier
 v_mfma_f32_16x16x32_bf16 a[80:83], a[160:163], v[24:27], a[80:83]
 ds_read_b64_tr_b16 v[16:17], v62 offset:0
 v_mfma_f32_16x16x32_bf16 a[80:83], a[164:167], v[28:31], a[80:83]
 buffer_load_dwordx4 a[224:227], v8, s[84:87], s92 offen offset:0 sc1
 v_mfma_f32_16x16x32_bf16 a[84:87], a[172:175], v[28:31], a[84:87]
 ds_read_b64_tr_b16 v[18:19], v62 offset:256
 v_mfma_f32_16x16x32_bf16 a[84:87], a[168:171], v[24:27], a[84:87]
 v_mfma_f32_16x16x32_bf16 a[88:91], a[176:179], v[24:27], a[88:91]
 ds_read_b64_tr_b16 v[20:21], v62 offset:2048
 v_mfma_f32_16x16x32_bf16 a[88:91], a[180:183], v[28:31], a[88:91]
 buffer_load_dwordx4 a[228:231], v8, s[84:87], s92 offen offset:1024 sc1
 v_mfma_f32_16x16x32_bf16 a[92:95], a[188:191], v[28:31], a[92:95]
 ds_read_b64_tr_b16 v[22:23], v62 offset:2304
 v_mfma_f32_16x16x32_bf16 a[92:95], a[184:187], v[24:27], a[92:95]
 s_waitcnt lgkmcnt(8)
 v_mfma_f32_16x16x32_bf16 a[96:99], a[160:163], v[32:35], a[96:99]
 ds_read_b64_tr_b16 v[24:25], v63 offset:0
 v_mfma_f32_16x16x32_bf16 a[96:99], a[164:167], v[36:39], a[96:99]
 buffer_load_dwordx4 a[232:235], v9, s[84:87], s92 offen offset:0 sc1
 v_mfma_f32_16x16x32_bf16 a[100:103], a[172:175], v[36:39], a[100:103]
 ds_read_b64_tr_b16 v[26:27], v63 offset:256
 v_mfma_f32_16x16x32_bf16 a[100:103], a[168:171], v[32:35], a[100:103]
 v_mfma_f32_16x16x32_bf16 a[104:107], a[176:179], v[32:35], a[104:107]
 ds_read_b64_tr_b16 v[28:29], v63 offset:2048
 v_mfma_f32_16x16x32_bf16 a[104:107], a[180:183], v[36:39], a[104:107]
 buffer_load_dwordx4 a[236:239], v9, s[84:87], s92 offen offset:1024 sc1
 v_mfma_f32_16x16x32_bf16 a[108:111], a[188:191], v[36:39], a[108:111]
 ds_read_b64_tr_b16 v[30:31], v63 offset:2304
 v_mfma_f32_16x16x32_bf16 a[108:111], a[184:187], v[32:35], a[108:111]
 s_waitcnt lgkmcnt(8)
 v_mfma_f32_16x16x32_bf16 a[112:115], a[160:163], v[40:43], a[112:115]
 ds_read_b64_tr_b16 v[32:33], v62 offset:4096
 v_mfma_f32_16x16x32_bf16 a[112:115], a[164:167], v[44:47], a[112:115]
 buffer_load_dwordx4 a[240:243], v10, s[84:87], s92 offen offset:0 sc1
 v_mfma_f32_16x16x32_bf16 a[116:119], a[172:175], v[44:47], a[116:119]
 ds_read_b64_tr_b16 v[34:35], v62 offset:4352
 v_mfma_f32_16x16x32_bf16 a[116:119], a[168:171], v[40:43], a[116:119]
 v_mfma_f32_16x16x32_bf16 a[120:123], a[176:179], v[40:43], a[120:123]
 ds_read_b64_tr_b16 v[36:37], v62 offset:6144
 v_mfma_f32_16x16x32_bf16 a[120:123], a[180:183], v[44:47], a[120:123]
 buffer_load_dwordx4 a[244:247], v10, s[84:87], s92 offen offset:1024 sc1
 v_mfma_f32_16x16x32_bf16 a[124:127], a[188:191], v[44:47], a[124:127]
 ds_read_b64_tr_b16 v[38:39], v62 offset:6400
 v_mfma_f32_16x16x32_bf16 a[124:127], a[184:187], v[40:43], a[124:127]
 s_waitcnt vmcnt(16) lgkmcnt(8)
 v_mfma_f32_16x16x32_bf16 a[0:3], a[192:195], v[16:19], a[0:3]
 ds_read_b64_tr_b16 v[40:41], v63 offset:4096
 v_mfma_f32_16x16x32_bf16 a[0:3], a[196:199], v[20:23], a[0:3]
 buffer_load_dwordx4 a[248:251], v11, s[84:87], s92 offen offset:0 sc1
 v_mfma_f32_16x16x32_bf16 a[4:7], a[204:207], v[20:23], a[4:7]
 ds_read_b64_tr_b16 v[42:43], v63 offset:4352
 v_mfma_f32_16x16x32_bf16 a[4:7], a[200:203], v[16:19], a[4:7]
 v_mfma_f32_16x16x32_bf16 a[8:11], a[208:211], v[16:19], a[8:11]
 ds_read_b64_tr_b16 v[44:45], v63 offset:6144
 v_mfma_f32_16x16x32_bf16 a[8:11], a[212:215], v[20:23], a[8:11]
 buffer_load_dwordx4 a[252:255], v11, s[84:87], s92 offen offset:1024 sc1
 v_mfma_f32_16x16x32_bf16 a[12:15], a[220:223], v[20:23], a[12:15]
 ds_read_b64_tr_b16 v[46:47], v63 offset:6400
 v_mfma_f32_16x16x32_bf16 a[12:15], a[216:219], v[16:19], a[12:15]
 s_waitcnt lgkmcnt(8)
 v_mfma_f32_16x16x32_bf16 a[16:19], a[192:195], v[24:27], a[16:19]
 ds_read_b64_tr_b16 v[16:17], v62 offset:8192
 v_mfma_f32_16x16x32_bf16 a[16:19], a[196:199], v[28:31], a[16:19]
 v_mov_b32 v8, v60
 v_mov_b32 v9, v61
 v_mov_b32 v10, v62
 v_mov_b32 v11, v63
 v_mfma_f32_16x16x32_bf16 a[20:23], a[204:207], v[28:31], a[20:23]
 ds_read_b64_tr_b16 v[18:19], v62 offset:8448
 v_mfma_f32_16x16x32_bf16 a[20:23], a[200:203], v[24:27], a[20:23]
 v_mfma_f32_16x16x32_bf16 a[24:27], a[208:211], v[24:27], a[24:27]
 ds_read_b64_tr_b16 v[20:21], v62 offset:10240
 v_mfma_f32_16x16x32_bf16 a[24:27], a[212:215], v[28:31], a[24:27]
 v_mfma_f32_16x16x32_bf16 a[28:31], a[220:223], v[28:31], a[28:31]
 ds_read_b64_tr_b16 v[22:23], v62 offset:10496
 v_mfma_f32_16x16x32_bf16 a[28:31], a[216:219], v[24:27], a[28:31]
 s_waitcnt lgkmcnt(8)
 v_mfma_f32_16x16x32_bf16 a[32:35], a[192:195], v[32:35], a[32:35]
 ds_read_b64_tr_b16 v[24:25], v11 offset:8192
 v_mfma_f32_16x16x32_bf16 a[32:35], a[196:199], v[36:39], a[32:35]
 v_mfma_f32_16x16x32_bf16 a[36:39], a[204:207], v[36:39], a[36:39]
 ds_read_b64_tr_b16 v[26:27], v11 offset:8448
 v_mfma_f32_16x16x32_bf16 a[36:39], a[200:203], v[32:35], a[36:39]
 v_mfma_f32_16x16x32_bf16 a[40:43], a[208:211], v[32:35], a[40:43]
 ds_read_b64_tr_b16 v[28:29], v11 offset:10240
 v_mfma_f32_16x16x32_bf16 a[40:43], a[212:215], v[36:39], a[40:43]
 v_mfma_f32_16x16x32_bf16 a[44:47], a[220:223], v[36:39], a[44:47]
 ds_read_b64_tr_b16 v[30:31], v11 offset:10496
 v_mfma_f32_16x16x32_bf16 a[44:47], a[216:219], v[32:35], a[44:47]
 s_waitcnt lgkmcnt(8)
 v_mfma_f32_16x16x32_bf16 a[48:51], a[192:195], v[40:43], a[48:51]
 ds_read_b64_tr_b16 v[32:33], v10 offset:12288
 v_mfma_f32_16x16x32_bf16 a[48:51], a[196:199], v[44:47], a[48:51]
 v_mfma_f32_16x16x32_bf16 a[52:55], a[204:207], v[44:47], a[52:55]
 ds_read_b64_tr_b16 v[34:35], v10 offset:12544
 v_mfma_f32_16x16x32_bf16 a[52:55], a[200:203], v[40:43], a[52:55]
 v_mfma_f32_16x16x32_bf16 a[56:59], a[208:211], v[40:43], a[56:59]
 ds_read_b64_tr_b16 v[36:37], v10 offset:14336
 v_mfma_f32_16x16x32_bf16 a[56:59], a[212:215], v[44:47], a[56:59]
 v_mfma_f32_16x16x32_bf16 a[60:63], a[220:223], v[44:47], a[60:63]
 ds_read_b64_tr_b16 v[38:39], v10 offset:14592
 v_mfma_f32_16x16x32_bf16 a[60:63], a[216:219], v[40:43], a[60:63]
 s_waitcnt lgkmcnt(8)
 v_mfma_f32_16x16x32_bf16 a[64:67], a[192:195], v[16:19], a[64:67]
 ds_read_b64_tr_b16 v[40:41], v11 offset:12288
 v_mfma_f32_16x16x32_bf16 a[64:67], a[196:199], v[20:23], a[64:67]
 v_mfma_f32_16x16x32_bf16 a[68:71], a[204:207], v[20:23], a[68:71]
 ds_read_b64_tr_b16 v[42:43], v11 offset:12544
 v_mfma_f32_16x16x32_bf16 a[68:71], a[200:203], v[16:19], a[68:71]
 v_mfma_f32_16x16x32_bf16 a[72:75], a[208:211], v[16:19], a[72:75]
 ds_read_b64_tr_b16 v[44:45], v11 offset:14336
 v_mfma_f32_16x16x32_bf16 a[72:75], a[212:215], v[20:23], a[72:75]
 v_mfma_f32_16x16x32_bf16 a[76:79], a[220:223], v[20:23], a[76:79]
 ds_read_b64_tr_b16 v[46:47], v11 offset:14592
 v_mfma_f32_16x16x32_bf16 a[76:79], a[216:219], v[16:19], a[76:79]
 s_waitcnt lgkmcnt(8)
 s_waitcnt vmcnt(8)
 s_barrier
 v_mfma_f32_16x16x32_bf16 a[80:83], a[192:195], v[24:27], a[80:83]
 ds_read_b64_tr_b16 v[16:17], v4 offset:0
 v_mfma_f32_16x16x32_bf16 a[80:83], a[196:199], v[28:31], a[80:83]
 v_mfma_f32_16x16x32_bf16 a[84:87], a[204:207], v[28:31], a[84:87]
 ds_read_b64_tr_b16 v[18:19], v4 offset:256
 v_mfma_f32_16x16x32_bf16 a[84:87], a[200:203], v[24:27], a[84:87]
 v_mfma_f32_16x16x32_bf16 a[88:91], a[208:211], v[24:27], a[88:91]
 ds_read_b64_tr_b16 v[20:21], v4 offset:2048
 v_mfma_f32_16x16x32_bf16 a[88:91], a[212:215], v[28:31], a[88:91]
 v_mfma_f32_16x16x32_bf16 a[92:95], a[220:223], v[28:31], a[92:95]
 ds_read_b64_tr_b16 v[22:23], v4 offset:2304
 v_mfma_f32_16x16x32_bf16 a[92:95], a[216:219], v[24:27], a[92:95]
 s_waitcnt lgkmcnt(8)
 v_mfma_f32_16x16x32_bf16 a[96:99], a[192:195], v[32:35], a[96:99]
 ds_read_b64_tr_b16 v[24:25], v5 offset:0
 v_mfma_f32_16x16x32_bf16 a[96:99], a[196:199], v[36:39], a[96:99]
 v_mfma_f32_16x16x32_bf16 a[100:103], a[204:207], v[36:39], a[100:103]
 ds_read_b64_tr_b16 v[26:27], v5 offset:256
 v_mfma_f32_16x16x32_bf16 a[100:103], a[200:203], v[32:35], a[100:103]
 v_mfma_f32_16x16x32_bf16 a[104:107], a[208:211], v[32:35], a[104:107]
 ds_read_b64_tr_b16 v[28:29], v5 offset:2048
 v_mfma_f32_16x16x32_bf16 a[104:107], a[212:215], v[36:39], a[104:107]
 v_mfma_f32_16x16x32_bf16 a[108:111], a[220:223], v[36:39], a[108:111]
 ds_read_b64_tr_b16 v[30:31], v5 offset:2304
 v_mfma_f32_16x16x32_bf16 a[108:111], a[216:219], v[32:35], a[108:111]
 s_waitcnt lgkmcnt(8)
 v_mfma_f32_16x16x32_bf16 a[112:115], a[192:195], v[40:43], a[112:115]
 ds_read_b64_tr_b16 v[32:33], v4 offset:4096
 v_mfma_f32_16x16x32_bf16 a[112:115], a[196:199], v[44:47], a[112:115]
 v_mfma_f32_16x16x32_bf16 a[116:119], a[204:207], v[44:47], a[116:119]
 ds_read_b64_tr_b16 v[34:35], v4 offset:4352
 v_mfma_f32_16x16x32_bf16 a[116:119], a[200:203], v[40:43], a[116:119]
 v_mfma_f32_16x16x32_bf16 a[120:123], a[208:211], v[40:43], a[120:123]
 ds_read_b64_tr_b16 v[36:37], v4 offset:6144
 v_mfma_f32_16x16x32_bf16 a[120:123], a[212:215], v[44:47], a[120:123]
 v_mfma_f32_16x16x32_bf16 a[124:127], a[220:223], v[44:47], a[124:127]
 ds_read_b64_tr_b16 v[38:39], v4 offset:6400
 v_mfma_f32_16x16x32_bf16 a[124:127], a[216:219], v[40:43], a[124:127]
 s_waitcnt vmcnt(0) lgkmcnt(8)
 v_mfma_f32_16x16x32_bf16 a[0:3], a[224:227], v[16:19], a[0:3]
 ds_read_b64_tr_b16 v[40:41], v5 offset:4096
 v_mfma_f32_16x16x32_bf16 a[0:3], a[228:231], v[20:23], a[0:3]
 v_mfma_f32_16x16x32_bf16 a[4:7], a[236:239], v[20:23], a[4:7]
 ds_read_b64_tr_b16 v[42:43], v5 offset:4352
 v_mfma_f32_16x16x32_bf16 a[4:7], a[232:235], v[16:19], a[4:7]
 v_mfma_f32_16x16x32_bf16 a[8:11], a[240:243], v[16:19], a[8:11]
 ds_read_b64_tr_b16 v[44:45], v5 offset:6144
 v_mfma_f32_16x16x32_bf16 a[8:11], a[244:247], v[20:23], a[8:11]
 v_mfma_f32_16x16x32_bf16 a[12:15], a[252:255], v[20:23], a[12:15]
 ds_read_b64_tr_b16 v[46:47], v5 offset:6400
 v_mfma_f32_16x16x32_bf16 a[12:15], a[248:251], v[16:19], a[12:15]
 s_waitcnt lgkmcnt(8)
 v_mfma_f32_16x16x32_bf16 a[16:19], a[224:227], v[24:27], a[16:19]
 ds_read_b64_tr_b16 v[16:17], v4 offset:8192
 v_mfma_f32_16x16x32_bf16 a[16:19], a[228:231], v[28:31], a[16:19]
 v_lshlrev_b32 v15, 3, v15
 v_mfma_f32_16x16x32_bf16 a[20:23], a[236:239], v[28:31], a[20:23]
 ds_read_b64_tr_b16 v[18:19], v4 offset:8448
 s_mov_b32 s16, s12
 v_mfma_f32_16x16x32_bf16 a[20:23], a[232:235], v[24:27], a[20:23]
 s_mov_b32 s17, s13
 v_mfma_f32_16x16x32_bf16 a[24:27], a[240:243], v[24:27], a[24:27]
 ds_read_b64_tr_b16 v[20:21], v4 offset:10240
 s_mov_b32 s18, 0x0
 v_mfma_f32_16x16x32_bf16 a[24:27], a[244:247], v[28:31], a[24:27]
 s_mov_b32 s19, 0x20000
 v_mfma_f32_16x16x32_bf16 a[28:31], a[252:255], v[28:31], a[28:31]
 ds_read_b64_tr_b16 v[22:23], v4 offset:10496
 s_add_u32 s18, s15, 2048
 v_mfma_f32_16x16x32_bf16 a[28:31], a[248:251], v[24:27], a[28:31]
 s_waitcnt lgkmcnt(8)
 s_add_u32 s82, s14, 7168
 v_mfma_f32_16x16x32_bf16 a[32:35], a[224:227], v[32:35], a[32:35]
 ds_read_b64_tr_b16 v[24:25], v5 offset:8192
 v_lshlrev_b32 v15, 4, v15
 v_mfma_f32_16x16x32_bf16 a[32:35], a[228:231], v[36:39], a[32:35]
 s_nop 0
 v_mfma_f32_16x16x32_bf16 a[36:39], a[236:239], v[36:39], a[36:39]
 ds_read_b64_tr_b16 v[26:27], v5 offset:8448
 v_lshrrev_b32 v0, 1, v15
 v_mfma_f32_16x16x32_bf16 a[36:39], a[232:235], v[32:35], a[36:39]
 v_add_u32 v0, 384, v0
 v_mfma_f32_16x16x32_bf16 a[40:43], a[240:243], v[32:35], a[40:43]
 ds_read_b64_tr_b16 v[28:29], v5 offset:10240
 s_nop 0
 v_mfma_f32_16x16x32_bf16 a[40:43], a[244:247], v[36:39], a[40:43]
 buffer_load_dword v1, v0, s[80:83], s14 offen
 v_mfma_f32_16x16x32_bf16 a[44:47], a[252:255], v[36:39], a[44:47]
 ds_read_b64_tr_b16 v[30:31], v5 offset:10496
 s_mul_i32 s14, s15, 7
 v_mfma_f32_16x16x32_bf16 a[44:47], a[248:251], v[32:35], a[44:47]
 s_waitcnt lgkmcnt(8)
 s_lshr_b32 s14, s14, 4
 v_mfma_f32_16x16x32_bf16 a[48:51], a[224:227], v[40:43], a[48:51]
 ds_read_b64_tr_b16 v[32:33], v4 offset:12288
 s_add_u32 s82, s14, 896
 v_mfma_f32_16x16x32_bf16 a[48:51], a[228:231], v[44:47], a[48:51]
 v_lshrrev_b32 v15, 4, v15
 v_mfma_f32_16x16x32_bf16 a[52:55], a[236:239], v[44:47], a[52:55]
 ds_read_b64_tr_b16 v[34:35], v4 offset:12544
 s_nop 0
 v_mfma_f32_16x16x32_bf16 a[52:55], a[232:235], v[40:43], a[52:55]
 buffer_load_dword v1, v15, s[80:83], s14 offen
 v_mfma_f32_16x16x32_bf16 a[56:59], a[240:243], v[40:43], a[56:59]
 ds_read_b64_tr_b16 v[36:37], v4 offset:14336
 s_add_u32 s14, s14, 917504
 v_mfma_f32_16x16x32_bf16 a[56:59], a[244:247], v[44:47], a[56:59]
 s_add_u32 s82, s14, 896
 v_mfma_f32_16x16x32_bf16 a[60:63], a[252:255], v[44:47], a[60:63]
 ds_read_b64_tr_b16 v[38:39], v4 offset:14592
 buffer_load_dword v1, v15, s[80:83], s14 offen
 v_mfma_f32_16x16x32_bf16 a[60:63], a[248:251], v[40:43], a[60:63]
 s_waitcnt lgkmcnt(8)
 s_lshl_b32 s3, s2, 2
 v_mfma_f32_16x16x32_bf16 a[64:67], a[224:227], v[16:19], a[64:67]
 ds_read_b64_tr_b16 v[40:41], v5 offset:12288
 s_add_u32 s3, s3, s95
 v_mfma_f32_16x16x32_bf16 a[64:67], a[228:231], v[20:23], a[64:67]
 s_and_b32 s3, s3, 255
 v_mfma_f32_16x16x32_bf16 a[68:71], a[236:239], v[20:23], a[68:71]
 ds_read_b64_tr_b16 v[42:43], v5 offset:12544
 s_mul_i32 s3, s3, 128
 v_mfma_f32_16x16x32_bf16 a[68:71], a[232:235], v[16:19], a[68:71]
 v_min_u32 v52, 0, v0
 v_mfma_f32_16x16x32_bf16 a[72:75], a[240:243], v[16:19], a[72:75]
 ds_read_b64_tr_b16 v[44:45], v5 offset:14336
 v_lshlrev_b32 v52, 7, v52
 v_mfma_f32_16x16x32_bf16 a[72:75], a[244:247], v[20:23], a[72:75]
 v_add_u32 v52, s3, v52
 v_mfma_f32_16x16x32_bf16 a[76:79], a[252:255], v[20:23], a[76:79]
 ds_read_b64_tr_b16 v[46:47], v5 offset:14592
 v_min_u32 v52, L_b_end - attfin_kernel - 4, v52
 v_mfma_f32_16x16x32_bf16 a[76:79], a[248:251], v[16:19], a[76:79]
 s_waitcnt lgkmcnt(8)
 s_getpc_b64 s[16:17]
 v_mfma_f32_16x16x32_bf16 a[80:83], a[224:227], v[24:27], a[80:83]
 ds_read_b64_tr_b16 v[16:17], v6 offset:16384
 s_add_u32 s16, s16, attfin_kernel - .
 v_mfma_f32_16x16x32_bf16 a[80:83], a[228:231], v[28:31], a[80:83]
 s_addc_u32 s17, s17, 0
 v_mfma_f32_16x16x32_bf16 a[84:87], a[236:239], v[28:31], a[84:87]
 ds_read_b64_tr_b16 v[18:19], v6 offset:16640
 v_mov_b32 v53, s17
 v_mfma_f32_16x16x32_bf16 a[84:87], a[232:235], v[24:27], a[84:87]
 v_add_co_u32 v52, vcc, s16, v52
 v_mfma_f32_16x16x32_bf16 a[88:91], a[240:243], v[24:27], a[88:91]
 ds_read_b64_tr_b16 v[20:21], v6 offset:18432
 s_nop 1
 v_mfma_f32_16x16x32_bf16 a[88:91], a[244:247], v[28:31], a[88:91]
 v_addc_co_u32 v53, vcc, 0, v53, vcc
 v_mfma_f32_16x16x32_bf16 a[92:95], a[252:255], v[28:31], a[92:95]
 ds_read_b64_tr_b16 v[22:23], v6 offset:18688
 global_load_dword v1, v[52:53], off
 v_mfma_f32_16x16x32_bf16 a[92:95], a[248:251], v[24:27], a[92:95]
 s_waitcnt lgkmcnt(8)
 s_mul_i32 s4, s97, 10
 s_add_i32 s4, s4, -224
 v_mfma_f32_16x16x32_bf16 a[96:99], a[224:227], v[32:35], a[96:99]
 ds_read_b64_tr_b16 v[24:25], v7 offset:16384
 s_lshr_b32 s8, s4, 5
 s_and_b32 s4, s4, 31
 v_mfma_f32_16x16x32_bf16 a[96:99], a[228:231], v[36:39], a[96:99]
 s_lshl_b32 s4, s4, 18
 v_mfma_f32_16x16x32_bf16 a[100:103], a[236:239], v[36:39], a[100:103]
 ds_read_b64_tr_b16 v[26:27], v7 offset:16640
 s_cmp_eq_u32 s8, 0
 s_cselect_b32 s7, 0x3e3504f3, s100
 v_mfma_f32_16x16x32_bf16 a[100:103], a[232:235], v[32:35], a[100:103]
 s_cselect_b32 s8, 0, 0x800000
 s_add_u32 s4, s4, s8
 v_mfma_f32_16x16x32_bf16 a[104:107], a[240:243], v[32:35], a[104:107]
 ds_read_b64_tr_b16 v[28:29], v7 offset:18432
 v_accvgpr_read_b32 v48, a0
 v_mfma_f32_16x16x32_bf16 a[104:107], a[244:247], v[36:39], a[104:107]
 v_accvgpr_read_b32 v49, a1
 v_accvgpr_read_b32 v50, a2
 v_mfma_f32_16x16x32_bf16 a[108:111], a[252:255], v[36:39], a[108:111]
 ds_read_b64_tr_b16 v[30:31], v7 offset:18688
 v_accvgpr_read_b32 v51, a3
 v_mfma_f32_16x16x32_bf16 a[108:111], a[248:251], v[32:35], a[108:111]
 s_waitcnt lgkmcnt(8)
 v_accvgpr_read_b32 v52, a4
 v_accvgpr_read_b32 v53, a5
 v_mfma_f32_16x16x32_bf16 a[112:115], a[224:227], v[40:43], a[112:115]
 ds_read_b64_tr_b16 v[32:33], v6 offset:20480
 v_accvgpr_read_b32 v54, a6
 v_accvgpr_read_b32 v55, a7
 v_mfma_f32_16x16x32_bf16 a[112:115], a[228:231], v[44:47], a[112:115]
 v_mul_f32 v48, s7, v48
 v_mfma_f32_16x16x32_bf16 a[116:119], a[236:239], v[44:47], a[116:119]
 ds_read_b64_tr_b16 v[34:35], v6 offset:20736
 v_mul_f32 v49, s7, v49
 v_mul_f32 v50, s7, v50
 v_mfma_f32_16x16x32_bf16 a[116:119], a[232:235], v[40:43], a[116:119]
 v_mul_f32 v51, s7, v51
 v_mul_f32 v52, s7, v52
 v_mfma_f32_16x16x32_bf16 a[120:123], a[240:243], v[40:43], a[120:123]
 ds_read_b64_tr_b16 v[36:37], v6 offset:22528
 v_mul_f32 v53, s7, v53
 v_mfma_f32_16x16x32_bf16 a[120:123], a[244:247], v[44:47], a[120:123]
 v_mul_f32 v54, s7, v54
 v_mul_f32 v55, s7, v55
 v_mfma_f32_16x16x32_bf16 a[124:127], a[252:255], v[44:47], a[124:127]
 ds_read_b64_tr_b16 v[38:39], v6 offset:22784
 v_cvt_pk_bf16_f32 v56, v48, v49
 v_mfma_f32_16x16x32_bf16 a[124:127], a[248:251], v[40:43], a[124:127]
 s_waitcnt lgkmcnt(8)
 v_cvt_pk_bf16_f32 v57, v50, v51
 v_cvt_pk_bf16_f32 v58, v52, v53
 v_mfma_f32_16x16x32_bf16 v[64:67], a[128:131], v[16:19], v[64:67]
 ds_read_b64_tr_b16 v[40:41], v7 offset:20480
 v_cvt_pk_bf16_f32 v59, v54, v55
 s_add_u32 s5, s4, 0
 v_mfma_f32_16x16x32_bf16 v[64:67], a[132:135], v[20:23], v[64:67]
 buffer_store_dwordx4 v[56:59], v14, s[84:87], s5 offen offset:2048 sc1
 v_mfma_f32_16x16x32_bf16 v[68:71], a[140:143], v[20:23], v[68:71]
 ds_read_b64_tr_b16 v[42:43], v7 offset:20736
 v_accvgpr_read_b32 v48, a8
 v_accvgpr_read_b32 v49, a9
 v_mfma_f32_16x16x32_bf16 v[68:71], a[136:139], v[16:19], v[68:71]
 v_accvgpr_read_b32 v50, a10
 v_accvgpr_read_b32 v51, a11
 v_mfma_f32_16x16x32_bf16 v[72:75], a[144:147], v[16:19], v[72:75]
 ds_read_b64_tr_b16 v[44:45], v7 offset:22528
 v_accvgpr_read_b32 v52, a12
 v_mfma_f32_16x16x32_bf16 v[72:75], a[148:151], v[20:23], v[72:75]
 v_accvgpr_read_b32 v53, a13
 v_accvgpr_read_b32 v54, a14
 v_mfma_f32_16x16x32_bf16 v[76:79], a[156:159], v[20:23], v[76:79]
 ds_read_b64_tr_b16 v[46:47], v7 offset:22784
 v_accvgpr_read_b32 v55, a15
 v_mfma_f32_16x16x32_bf16 v[76:79], a[152:155], v[16:19], v[76:79]
 s_waitcnt lgkmcnt(8)
 v_mul_f32 v48, s7, v48
 v_mul_f32 v49, s7, v49
 v_mfma_f32_16x16x32_bf16 v[80:83], a[128:131], v[24:27], v[80:83]
 ds_read_b64_tr_b16 v[16:17], v8 offset:16384
 v_mul_f32 v50, s7, v50
 v_mul_f32 v51, s7, v51
 v_mfma_f32_16x16x32_bf16 v[80:83], a[132:135], v[28:31], v[80:83]
 v_mul_f32 v52, s7, v52
 v_mfma_f32_16x16x32_bf16 v[84:87], a[140:143], v[28:31], v[84:87]
 ds_read_b64_tr_b16 v[18:19], v8 offset:16640
 v_mul_f32 v53, s7, v53
 v_mul_f32 v54, s7, v54
 v_mfma_f32_16x16x32_bf16 v[84:87], a[136:139], v[24:27], v[84:87]
 v_mul_f32 v55, s7, v55
 v_cvt_pk_bf16_f32 v60, v48, v49
 v_mfma_f32_16x16x32_bf16 v[88:91], a[144:147], v[24:27], v[88:91]
 ds_read_b64_tr_b16 v[20:21], v8 offset:18432
 v_cvt_pk_bf16_f32 v61, v50, v51
 v_mfma_f32_16x16x32_bf16 v[88:91], a[148:151], v[28:31], v[88:91]
 v_cvt_pk_bf16_f32 v62, v52, v53
 v_cvt_pk_bf16_f32 v63, v54, v55
 v_mfma_f32_16x16x32_bf16 v[92:95], a[156:159], v[28:31], v[92:95]
 ds_read_b64_tr_b16 v[22:23], v8 offset:18688
 s_add_u32 s5, s4, 4096
 v_mfma_f32_16x16x32_bf16 v[92:95], a[152:155], v[24:27], v[92:95]
 s_waitcnt lgkmcnt(8)
 buffer_store_dwordx4 v[60:63], v14, s[84:87], s5 offen offset:2048 sc1
 v_accvgpr_read_b32 v48, a16
 v_mfma_f32_16x16x32_bf16 v[96:99], a[128:131], v[32:35], v[96:99]
 ds_read_b64_tr_b16 v[24:25], v9 offset:16384
 v_accvgpr_read_b32 v49, a17
 v_accvgpr_read_b32 v50, a18
 v_mfma_f32_16x16x32_bf16 v[96:99], a[132:135], v[36:39], v[96:99]
 v_accvgpr_read_b32 v51, a19
 v_mfma_f32_16x16x32_bf16 v[100:103], a[140:143], v[36:39], v[100:103]
 ds_read_b64_tr_b16 v[26:27], v9 offset:16640
 v_accvgpr_read_b32 v52, a20
 v_accvgpr_read_b32 v53, a21
 v_mfma_f32_16x16x32_bf16 v[100:103], a[136:139], v[32:35], v[100:103]
 v_accvgpr_read_b32 v54, a22
 v_accvgpr_read_b32 v55, a23
 v_mfma_f32_16x16x32_bf16 v[104:107], a[144:147], v[32:35], v[104:107]
 ds_read_b64_tr_b16 v[28:29], v9 offset:18432
 v_mul_f32 v48, s7, v48
 v_mfma_f32_16x16x32_bf16 v[104:107], a[148:151], v[36:39], v[104:107]
 v_mul_f32 v49, s7, v49
 v_mul_f32 v50, s7, v50
 v_mfma_f32_16x16x32_bf16 v[108:111], a[156:159], v[36:39], v[108:111]
 ds_read_b64_tr_b16 v[30:31], v9 offset:18688
 v_mul_f32 v51, s7, v51
 v_mfma_f32_16x16x32_bf16 v[108:111], a[152:155], v[32:35], v[108:111]
 s_waitcnt lgkmcnt(8)
 v_mul_f32 v52, s7, v52
 v_mul_f32 v53, s7, v53
 v_mfma_f32_16x16x32_bf16 v[112:115], a[128:131], v[40:43], v[112:115]
 ds_read_b64_tr_b16 v[32:33], v8 offset:20480
 v_mul_f32 v54, s7, v54
 v_mul_f32 v55, s7, v55
 v_mfma_f32_16x16x32_bf16 v[112:115], a[132:135], v[44:47], v[112:115]
 v_cvt_pk_bf16_f32 v56, v48, v49
 v_mfma_f32_16x16x32_bf16 v[116:119], a[140:143], v[44:47], v[116:119]
 ds_read_b64_tr_b16 v[34:35], v8 offset:20736
 v_cvt_pk_bf16_f32 v57, v50, v51
 v_cvt_pk_bf16_f32 v58, v52, v53
 v_mfma_f32_16x16x32_bf16 v[116:119], a[136:139], v[40:43], v[116:119]
 v_cvt_pk_bf16_f32 v59, v54, v55
 s_add_u32 s5, s4, 0
 v_mfma_f32_16x16x32_bf16 v[120:123], a[144:147], v[40:43], v[120:123]
 ds_read_b64_tr_b16 v[36:37], v8 offset:22528
 buffer_store_dwordx4 v[56:59], v14, s[84:87], s5 offen offset:2304 sc1
 v_mfma_f32_16x16x32_bf16 v[120:123], a[148:151], v[44:47], v[120:123]
 v_accvgpr_read_b32 v48, a24
 v_accvgpr_read_b32 v49, a25
 v_mfma_f32_16x16x32_bf16 v[124:127], a[156:159], v[44:47], v[124:127]
 ds_read_b64_tr_b16 v[38:39], v8 offset:22784
 v_accvgpr_read_b32 v50, a26
 v_mfma_f32_16x16x32_bf16 v[124:127], a[152:155], v[40:43], v[124:127]
 s_waitcnt lgkmcnt(8)
 v_accvgpr_read_b32 v51, a27
 v_accvgpr_read_b32 v52, a28
 v_mfma_f32_16x16x32_bf16 v[64:67], a[160:163], v[16:19], v[64:67]
 ds_read_b64_tr_b16 v[40:41], v9 offset:20480
 v_accvgpr_read_b32 v53, a29
 v_accvgpr_read_b32 v54, a30
 v_mfma_f32_16x16x32_bf16 v[64:67], a[164:167], v[20:23], v[64:67]
 v_accvgpr_read_b32 v55, a31
 v_mfma_f32_16x16x32_bf16 v[68:71], a[172:175], v[20:23], v[68:71]
 ds_read_b64_tr_b16 v[42:43], v9 offset:20736
 v_mul_f32 v48, s7, v48
 v_mul_f32 v49, s7, v49
 v_mfma_f32_16x16x32_bf16 v[68:71], a[168:171], v[16:19], v[68:71]
 v_mul_f32 v50, s7, v50
 v_mul_f32 v51, s7, v51
 v_mfma_f32_16x16x32_bf16 v[72:75], a[176:179], v[16:19], v[72:75]
 ds_read_b64_tr_b16 v[44:45], v9 offset:22528
 v_mul_f32 v52, s7, v52
 v_mfma_f32_16x16x32_bf16 v[72:75], a[180:183], v[20:23], v[72:75]
 v_mul_f32 v53, s7, v53
 v_mul_f32 v54, s7, v54
 v_mfma_f32_16x16x32_bf16 v[76:79], a[188:191], v[20:23], v[76:79]
 ds_read_b64_tr_b16 v[46:47], v9 offset:22784
 v_mul_f32 v55, s7, v55
 v_mfma_f32_16x16x32_bf16 v[76:79], a[184:187], v[16:19], v[76:79]
 s_waitcnt lgkmcnt(8)
 v_cvt_pk_bf16_f32 v60, v48, v49
 v_cvt_pk_bf16_f32 v61, v50, v51
 v_mfma_f32_16x16x32_bf16 v[80:83], a[160:163], v[24:27], v[80:83]
 ds_read_b64_tr_b16 v[16:17], v10 offset:16384
 v_cvt_pk_bf16_f32 v62, v52, v53
 v_cvt_pk_bf16_f32 v63, v54, v55
 v_mfma_f32_16x16x32_bf16 v[80:83], a[164:167], v[28:31], v[80:83]
 s_add_u32 s5, s4, 4096
 v_mfma_f32_16x16x32_bf16 v[84:87], a[172:175], v[28:31], v[84:87]
 ds_read_b64_tr_b16 v[18:19], v10 offset:16640
 buffer_store_dwordx4 v[60:63], v14, s[84:87], s5 offen offset:2304 sc1
 s_mul_i32 s4, s97, 10
 v_mfma_f32_16x16x32_bf16 v[84:87], a[168:171], v[24:27], v[84:87]
 s_add_i32 s4, s4, -222
 s_lshr_b32 s8, s4, 5
 v_mfma_f32_16x16x32_bf16 v[88:91], a[176:179], v[24:27], v[88:91]
 ds_read_b64_tr_b16 v[20:21], v10 offset:18432
 s_and_b32 s4, s4, 31
 v_mfma_f32_16x16x32_bf16 v[88:91], a[180:183], v[28:31], v[88:91]
 s_lshl_b32 s4, s4, 18
 s_cmp_eq_u32 s8, 0
 v_mfma_f32_16x16x32_bf16 v[92:95], a[188:191], v[28:31], v[92:95]
 ds_read_b64_tr_b16 v[22:23], v10 offset:18688
 s_cselect_b32 s7, 0x3e3504f3, s100
 v_mfma_f32_16x16x32_bf16 v[92:95], a[184:187], v[24:27], v[92:95]
 s_waitcnt lgkmcnt(8)
 s_cselect_b32 s8, 0, 0x800000
 s_add_u32 s4, s4, s8
 v_mfma_f32_16x16x32_bf16 v[96:99], a[160:163], v[32:35], v[96:99]
 ds_read_b64_tr_b16 v[24:25], v11 offset:16384
 v_accvgpr_read_b32 v48, a32
 v_accvgpr_read_b32 v49, a33
 v_mfma_f32_16x16x32_bf16 v[96:99], a[164:167], v[36:39], v[96:99]
 v_accvgpr_read_b32 v50, a34
 v_mfma_f32_16x16x32_bf16 v[100:103], a[172:175], v[36:39], v[100:103]
 ds_read_b64_tr_b16 v[26:27], v11 offset:16640
 v_accvgpr_read_b32 v51, a35
 v_accvgpr_read_b32 v52, a36
 v_mfma_f32_16x16x32_bf16 v[100:103], a[168:171], v[32:35], v[100:103]
 v_accvgpr_read_b32 v53, a37
 v_accvgpr_read_b32 v54, a38
 v_mfma_f32_16x16x32_bf16 v[104:107], a[176:179], v[32:35], v[104:107]
 ds_read_b64_tr_b16 v[28:29], v11 offset:18432
 v_accvgpr_read_b32 v55, a39
 v_mfma_f32_16x16x32_bf16 v[104:107], a[180:183], v[36:39], v[104:107]
 v_mul_f32 v48, s7, v48
 v_mul_f32 v49, s7, v49
 v_mfma_f32_16x16x32_bf16 v[108:111], a[188:191], v[36:39], v[108:111]
 ds_read_b64_tr_b16 v[30:31], v11 offset:18688
 v_mul_f32 v50, s7, v50
 v_mfma_f32_16x16x32_bf16 v[108:111], a[184:187], v[32:35], v[108:111]
 s_waitcnt lgkmcnt(8)
 v_mul_f32 v51, s7, v51
 v_mul_f32 v52, s7, v52
 v_mfma_f32_16x16x32_bf16 v[112:115], a[160:163], v[40:43], v[112:115]
 ds_read_b64_tr_b16 v[32:33], v10 offset:20480
 v_mul_f32 v53, s7, v53
 v_mul_f32 v54, s7, v54
 v_mfma_f32_16x16x32_bf16 v[112:115], a[164:167], v[44:47], v[112:115]
 v_mul_f32 v55, s7, v55
 v_mfma_f32_16x16x32_bf16 v[116:119], a[172:175], v[44:47], v[116:119]
 ds_read_b64_tr_b16 v[34:35], v10 offset:20736
 v_cvt_pk_bf16_f32 v56, v48, v49
 v_cvt_pk_bf16_f32 v57, v50, v51
 v_mfma_f32_16x16x32_bf16 v[116:119], a[168:171], v[40:43], v[116:119]
 v_cvt_pk_bf16_f32 v58, v52, v53
 v_cvt_pk_bf16_f32 v59, v54, v55
 v_mfma_f32_16x16x32_bf16 v[120:123], a[176:179], v[40:43], v[120:123]
 ds_read_b64_tr_b16 v[36:37], v10 offset:22528
 s_add_u32 s5, s4, 0
 v_mfma_f32_16x16x32_bf16 v[120:123], a[180:183], v[44:47], v[120:123]
 buffer_store_dwordx4 v[56:59], v14, s[84:87], s5 offen offset:2048 sc1
 v_accvgpr_read_b32 v48, a40
 v_mfma_f32_16x16x32_bf16 v[124:127], a[188:191], v[44:47], v[124:127]
 ds_read_b64_tr_b16 v[38:39], v10 offset:22784
 v_accvgpr_read_b32 v49, a41
 v_mfma_f32_16x16x32_bf16 v[124:127], a[184:187], v[40:43], v[124:127]
 s_waitcnt lgkmcnt(8)
 v_accvgpr_read_b32 v50, a42
 v_accvgpr_read_b32 v51, a43
 v_mfma_f32_16x16x32_bf16 v[64:67], a[192:195], v[16:19], v[64:67]
 ds_read_b64_tr_b16 v[40:41], v11 offset:20480
 v_accvgpr_read_b32 v52, a44
 v_accvgpr_read_b32 v53, a45
 v_mfma_f32_16x16x32_bf16 v[64:67], a[196:199], v[20:23], v[64:67]
 v_accvgpr_read_b32 v54, a46
 v_mfma_f32_16x16x32_bf16 v[68:71], a[204:207], v[20:23], v[68:71]
 ds_read_b64_tr_b16 v[42:43], v11 offset:20736
 v_accvgpr_read_b32 v55, a47
 v_mul_f32 v48, s7, v48
 v_mfma_f32_16x16x32_bf16 v[68:71], a[200:203], v[16:19], v[68:71]
 v_mul_f32 v49, s7, v49
 v_mul_f32 v50, s7, v50
 v_mfma_f32_16x16x32_bf16 v[72:75], a[208:211], v[16:19], v[72:75]
 ds_read_b64_tr_b16 v[44:45], v11 offset:22528
 v_mul_f32 v51, s7, v51
 v_mfma_f32_16x16x32_bf16 v[72:75], a[212:215], v[20:23], v[72:75]
 v_mul_f32 v52, s7, v52
 v_mul_f32 v53, s7, v53
 v_mfma_f32_16x16x32_bf16 v[76:79], a[220:223], v[20:23], v[76:79]
 ds_read_b64_tr_b16 v[46:47], v11 offset:22784
 v_mul_f32 v54, s7, v54
 v_mfma_f32_16x16x32_bf16 v[76:79], a[216:219], v[16:19], v[76:79]
 s_waitcnt lgkmcnt(8)
 v_mul_f32 v55, s7, v55
 v_cvt_pk_bf16_f32 v60, v48, v49
 v_mfma_f32_16x16x32_bf16 v[80:83], a[192:195], v[24:27], v[80:83]
 ds_read_b64_tr_b16 v[16:17], v4 offset:16384
 v_cvt_pk_bf16_f32 v61, v50, v51
 v_cvt_pk_bf16_f32 v62, v52, v53
 v_mfma_f32_16x16x32_bf16 v[80:83], a[196:199], v[28:31], v[80:83]
 v_cvt_pk_bf16_f32 v63, v54, v55
 v_mfma_f32_16x16x32_bf16 v[84:87], a[204:207], v[28:31], v[84:87]
 ds_read_b64_tr_b16 v[18:19], v4 offset:16640
 s_add_u32 s5, s4, 4096
 buffer_store_dwordx4 v[60:63], v14, s[84:87], s5 offen offset:2048 sc1
 v_mfma_f32_16x16x32_bf16 v[84:87], a[200:203], v[24:27], v[84:87]
 v_accvgpr_read_b32 v48, a48
 v_accvgpr_read_b32 v49, a49
 v_mfma_f32_16x16x32_bf16 v[88:91], a[208:211], v[24:27], v[88:91]
 ds_read_b64_tr_b16 v[20:21], v4 offset:18432
 v_accvgpr_read_b32 v50, a50
 v_mfma_f32_16x16x32_bf16 v[88:91], a[212:215], v[28:31], v[88:91]
 v_accvgpr_read_b32 v51, a51
 v_accvgpr_read_b32 v52, a52
 v_mfma_f32_16x16x32_bf16 v[92:95], a[220:223], v[28:31], v[92:95]
 ds_read_b64_tr_b16 v[22:23], v4 offset:18688
 v_accvgpr_read_b32 v53, a53
 v_mfma_f32_16x16x32_bf16 v[92:95], a[216:219], v[24:27], v[92:95]
 s_waitcnt lgkmcnt(8)
 v_accvgpr_read_b32 v54, a54
 v_accvgpr_read_b32 v55, a55
 v_mfma_f32_16x16x32_bf16 v[96:99], a[192:195], v[32:35], v[96:99]
 ds_read_b64_tr_b16 v[24:25], v5 offset:16384
 v_mul_f32 v48, s7, v48
 v_mul_f32 v49, s7, v49
 v_mfma_f32_16x16x32_bf16 v[96:99], a[196:199], v[36:39], v[96:99]
 v_mul_f32 v50, s7, v50
 v_mfma_f32_16x16x32_bf16 v[100:103], a[204:207], v[36:39], v[100:103]
 ds_read_b64_tr_b16 v[26:27], v5 offset:16640
 v_mul_f32 v51, s7, v51
 v_mul_f32 v52, s7, v52
 v_mfma_f32_16x16x32_bf16 v[100:103], a[200:203], v[32:35], v[100:103]
 v_mul_f32 v53, s7, v53
 v_mul_f32 v54, s7, v54
 v_mfma_f32_16x16x32_bf16 v[104:107], a[208:211], v[32:35], v[104:107]
 ds_read_b64_tr_b16 v[28:29], v5 offset:18432
 v_mul_f32 v55, s7, v55
 v_mfma_f32_16x16x32_bf16 v[104:107], a[212:215], v[36:39], v[104:107]
 v_cvt_pk_bf16_f32 v56, v48, v49
 v_cvt_pk_bf16_f32 v57, v50, v51
 v_mfma_f32_16x16x32_bf16 v[108:111], a[220:223], v[36:39], v[108:111]
 ds_read_b64_tr_b16 v[30:31], v5 offset:18688
 v_cvt_pk_bf16_f32 v58, v52, v53
 v_mfma_f32_16x16x32_bf16 v[108:111], a[216:219], v[32:35], v[108:111]
 s_waitcnt lgkmcnt(8)
 v_cvt_pk_bf16_f32 v59, v54, v55
 s_add_u32 s5, s4, 0
 v_mfma_f32_16x16x32_bf16 v[112:115], a[192:195], v[40:43], v[112:115]
 ds_read_b64_tr_b16 v[32:33], v4 offset:20480
 buffer_store_dwordx4 v[56:59], v14, s[84:87], s5 offen offset:2304 sc1
 v_accvgpr_read_b32 v48, a56
 v_mfma_f32_16x16x32_bf16 v[112:115], a[196:199], v[44:47], v[112:115]
 v_accvgpr_read_b32 v49, a57
 v_mfma_f32_16x16x32_bf16 v[116:119], a[204:207], v[44:47], v[116:119]
 ds_read_b64_tr_b16 v[34:35], v4 offset:20736
 v_accvgpr_read_b32 v50, a58
 v_accvgpr_read_b32 v51, a59
 v_mfma_f32_16x16x32_bf16 v[116:119], a[200:203], v[40:43], v[116:119]
 v_accvgpr_read_b32 v52, a60
 v_accvgpr_read_b32 v53, a61
 v_mfma_f32_16x16x32_bf16 v[120:123], a[208:211], v[40:43], v[120:123]
 ds_read_b64_tr_b16 v[36:37], v4 offset:22528
 v_accvgpr_read_b32 v54, a62
 v_mfma_f32_16x16x32_bf16 v[120:123], a[212:215], v[44:47], v[120:123]
 v_accvgpr_read_b32 v55, a63
 v_mul_f32 v48, s7, v48
 v_mfma_f32_16x16x32_bf16 v[124:127], a[220:223], v[44:47], v[124:127]
 ds_read_b64_tr_b16 v[38:39], v4 offset:22784
 v_mul_f32 v49, s7, v49
 v_mfma_f32_16x16x32_bf16 v[124:127], a[216:219], v[40:43], v[124:127]
 s_waitcnt lgkmcnt(8)
 v_mul_f32 v50, s7, v50
 v_mul_f32 v51, s7, v51
 v_mfma_f32_16x16x32_bf16 v[64:67], a[224:227], v[16:19], v[64:67]
 ds_read_b64_tr_b16 v[40:41], v5 offset:20480
 v_mul_f32 v52, s7, v52
 v_mul_f32 v53, s7, v53
 v_mfma_f32_16x16x32_bf16 v[64:67], a[228:231], v[20:23], v[64:67]
 v_mul_f32 v54, s7, v54
 v_mfma_f32_16x16x32_bf16 v[68:71], a[236:239], v[20:23], v[68:71]
 ds_read_b64_tr_b16 v[42:43], v5 offset:20736
 v_mul_f32 v55, s7, v55
 v_cvt_pk_bf16_f32 v60, v48, v49
 v_mfma_f32_16x16x32_bf16 v[68:71], a[232:235], v[16:19], v[68:71]
 v_cvt_pk_bf16_f32 v61, v50, v51
 v_cvt_pk_bf16_f32 v62, v52, v53
 v_mfma_f32_16x16x32_bf16 v[72:75], a[240:243], v[16:19], v[72:75]
 ds_read_b64_tr_b16 v[44:45], v5 offset:22528
 v_cvt_pk_bf16_f32 v63, v54, v55
 v_mfma_f32_16x16x32_bf16 v[72:75], a[244:247], v[20:23], v[72:75]
 s_add_u32 s5, s4, 4096
 buffer_store_dwordx4 v[60:63], v14, s[84:87], s5 offen offset:2304 sc1
 v_mfma_f32_16x16x32_bf16 v[76:79], a[252:255], v[20:23], v[76:79]
 ds_read_b64_tr_b16 v[46:47], v5 offset:22784
 s_mul_i32 s4, s97, 10
 v_mfma_f32_16x16x32_bf16 v[76:79], a[248:251], v[16:19], v[76:79]
 s_waitcnt lgkmcnt(8)
 s_add_i32 s4, s4, -223
 s_lshr_b32 s8, s4, 5
 v_mfma_f32_16x16x32_bf16 v[80:83], a[224:227], v[24:27], v[80:83]
 ds_read_b64_tr_b16 v[16:17], v6 offset:24576
 s_and_b32 s4, s4, 31
 s_lshl_b32 s4, s4, 18
 v_mfma_f32_16x16x32_bf16 v[80:83], a[228:231], v[28:31], v[80:83]
 s_cmp_eq_u32 s8, 0
 v_mfma_f32_16x16x32_bf16 v[84:87], a[236:239], v[28:31], v[84:87]
 ds_read_b64_tr_b16 v[18:19], v6 offset:24832
 s_cselect_b32 s7, 0x3e3504f3, s100
 s_cselect_b32 s8, 0, 0x800000
 v_mfma_f32_16x16x32_bf16 v[84:87], a[232:235], v[24:27], v[84:87]
 s_add_u32 s4, s4, s8
 v_accvgpr_read_b32 v48, a64
 v_mfma_f32_16x16x32_bf16 v[88:91], a[240:243], v[24:27], v[88:91]
 ds_read_b64_tr_b16 v[20:21], v6 offset:26624
 v_accvgpr_read_b32 v49, a65
 v_mfma_f32_16x16x32_bf16 v[88:91], a[244:247], v[28:31], v[88:91]
 v_accvgpr_read_b32 v50, a66
 v_accvgpr_read_b32 v51, a67
 v_mfma_f32_16x16x32_bf16 v[92:95], a[252:255], v[28:31], v[92:95]
 ds_read_b64_tr_b16 v[22:23], v6 offset:26880
 v_accvgpr_read_b32 v52, a68
 v_mfma_f32_16x16x32_bf16 v[92:95], a[248:251], v[24:27], v[92:95]
 s_waitcnt lgkmcnt(8)
 v_accvgpr_read_b32 v53, a69
 v_accvgpr_read_b32 v54, a70
 v_mfma_f32_16x16x32_bf16 v[96:99], a[224:227], v[32:35], v[96:99]
 ds_read_b64_tr_b16 v[24:25], v7 offset:24576
 v_accvgpr_read_b32 v55, a71
 v_mul_f32 v48, s7, v48
 v_mfma_f32_16x16x32_bf16 v[96:99], a[228:231], v[36:39], v[96:99]
 v_mul_f32 v49, s7, v49
 v_mfma_f32_16x16x32_bf16 v[100:103], a[236:239], v[36:39], v[100:103]
 ds_read_b64_tr_b16 v[26:27], v7 offset:24832
 v_mul_f32 v50, s7, v50
 v_mul_f32 v51, s7, v51
 v_mfma_f32_16x16x32_bf16 v[100:103], a[232:235], v[32:35], v[100:103]
 v_mul_f32 v52, s7, v52
 v_mfma_f32_16x16x32_bf16 v[104:107], a[240:243], v[32:35], v[104:107]
 ds_read_b64_tr_b16 v[28:29], v7 offset:26624
 v_mul_f32 v53, s7, v53
 v_mul_f32 v54, s7, v54
 v_mfma_f32_16x16x32_bf16 v[104:107], a[244:247], v[36:39], v[104:107]
 v_mul_f32 v55, s7, v55
 v_cvt_pk_bf16_f32 v56, v48, v49
 v_mfma_f32_16x16x32_bf16 v[108:111], a[252:255], v[36:39], v[108:111]
 ds_read_b64_tr_b16 v[30:31], v7 offset:26880
 v_cvt_pk_bf16_f32 v57, v50, v51
 v_mfma_f32_16x16x32_bf16 v[108:111], a[248:251], v[32:35], v[108:111]
 s_waitcnt lgkmcnt(8)
 v_cvt_pk_bf16_f32 v58, v52, v53
 v_cvt_pk_bf16_f32 v59, v54, v55
 v_mfma_f32_16x16x32_bf16 v[112:115], a[224:227], v[40:43], v[112:115]
 ds_read_b64_tr_b16 v[32:33], v6 offset:28672
 s_add_u32 s5, s4, 0
 buffer_store_dwordx4 v[56:59], v14, s[84:87], s5 offen offset:2048 sc1
 v_mfma_f32_16x16x32_bf16 v[112:115], a[228:231], v[44:47], v[112:115]
 v_accvgpr_read_b32 v48, a72
 v_mfma_f32_16x16x32_bf16 v[116:119], a[236:239], v[44:47], v[116:119]
 ds_read_b64_tr_b16 v[34:35], v6 offset:28928
 v_accvgpr_read_b32 v49, a73
 v_accvgpr_read_b32 v50, a74
 v_mfma_f32_16x16x32_bf16 v[116:119], a[232:235], v[40:43], v[116:119]
 v_accvgpr_read_b32 v51, a75
 v_mfma_f32_16x16x32_bf16 v[120:123], a[240:243], v[40:43], v[120:123]
 ds_read_b64_tr_b16 v[36:37], v6 offset:30720
 v_accvgpr_read_b32 v52, a76
 v_accvgpr_read_b32 v53, a77
 v_mfma_f32_16x16x32_bf16 v[120:123], a[244:247], v[44:47], v[120:123]
 v_accvgpr_read_b32 v54, a78
 v_accvgpr_read_b32 v55, a79
 v_mfma_f32_16x16x32_bf16 v[124:127], a[252:255], v[44:47], v[124:127]
 ds_read_b64_tr_b16 v[38:39], v6 offset:30976
 v_mul_f32 v48, s7, v48
 v_mfma_f32_16x16x32_bf16 v[124:127], a[248:251], v[40:43], v[124:127]
 s_waitcnt lgkmcnt(8)
 v_mul_f32 v49, s7, v49
 v_mul_f32 v50, s7, v50
 v_mfma_f32_16x16x32_bf16 v[128:131], a[128:131], v[16:19], v[128:131]
 ds_read_b64_tr_b16 v[40:41], v7 offset:28672
 v_mul_f32 v51, s7, v51
 v_mul_f32 v52, s7, v52
 v_mfma_f32_16x16x32_bf16 v[128:131], a[132:135], v[20:23], v[128:131]
 v_mul_f32 v53, s7, v53
 v_mfma_f32_16x16x32_bf16 v[132:135], a[140:143], v[20:23], v[132:135]
 ds_read_b64_tr_b16 v[42:43], v7 offset:28928
 v_mul_f32 v54, s7, v54
 v_mul_f32 v55, s7, v55
 v_mfma_f32_16x16x32_bf16 v[132:135], a[136:139], v[16:19], v[132:135]
 v_cvt_pk_bf16_f32 v60, v48, v49
 v_mfma_f32_16x16x32_bf16 v[136:139], a[144:147], v[16:19], v[136:139]
 ds_read_b64_tr_b16 v[44:45], v7 offset:30720
 v_cvt_pk_bf16_f32 v61, v50, v51
 v_cvt_pk_bf16_f32 v62, v52, v53
 v_mfma_f32_16x16x32_bf16 v[136:139], a[148:151], v[20:23], v[136:139]
 v_cvt_pk_bf16_f32 v63, v54, v55
 s_add_u32 s5, s4, 4096
 v_mfma_f32_16x16x32_bf16 v[140:143], a[156:159], v[20:23], v[140:143]
 ds_read_b64_tr_b16 v[46:47], v7 offset:30976
 buffer_store_dwordx4 v[60:63], v14, s[84:87], s5 offen offset:2048 sc1
 v_mfma_f32_16x16x32_bf16 v[140:143], a[152:155], v[16:19], v[140:143]
 s_waitcnt lgkmcnt(8)
 v_accvgpr_read_b32 v48, a80
 v_accvgpr_read_b32 v49, a81
 v_mfma_f32_16x16x32_bf16 v[144:147], a[128:131], v[24:27], v[144:147]
 ds_read_b64_tr_b16 v[16:17], v8 offset:24576
 v_accvgpr_read_b32 v50, a82
 v_accvgpr_read_b32 v51, a83
 v_mfma_f32_16x16x32_bf16 v[144:147], a[132:135], v[28:31], v[144:147]
 v_accvgpr_read_b32 v52, a84
 v_mfma_f32_16x16x32_bf16 v[148:151], a[140:143], v[28:31], v[148:151]
 ds_read_b64_tr_b16 v[18:19], v8 offset:24832
 v_accvgpr_read_b32 v53, a85
 v_accvgpr_read_b32 v54, a86
 v_mfma_f32_16x16x32_bf16 v[148:151], a[136:139], v[24:27], v[148:151]
 v_accvgpr_read_b32 v55, a87
 v_mfma_f32_16x16x32_bf16 v[152:155], a[144:147], v[24:27], v[152:155]
 ds_read_b64_tr_b16 v[20:21], v8 offset:26624
 v_mul_f32 v48, s7, v48
 v_mul_f32 v49, s7, v49
 v_mfma_f32_16x16x32_bf16 v[152:155], a[148:151], v[28:31], v[152:155]
 v_mul_f32 v50, s7, v50
 v_mul_f32 v51, s7, v51
 v_mfma_f32_16x16x32_bf16 v[156:159], a[156:159], v[28:31], v[156:159]
 ds_read_b64_tr_b16 v[22:23], v8 offset:26880
 v_mul_f32 v52, s7, v52
 v_mfma_f32_16x16x32_bf16 v[156:159], a[152:155], v[24:27], v[156:159]
 s_waitcnt lgkmcnt(8)
 v_mul_f32 v53, s7, v53
 v_mul_f32 v54, s7, v54
 v_mfma_f32_16x16x32_bf16 v[160:163], a[128:131], v[32:35], v[160:163]
 ds_read_b64_tr_b16 v[24:25], v9 offset:24576
 v_mul_f32 v55, s7, v55
 v_cvt_pk_bf16_f32 v56, v48, v49
 v_mfma_f32_16x16x32_bf16 v[160:163], a[132:135], v[36:39], v[160:163]
 v_cvt_pk_bf16_f32 v57, v50, v51
 v_mfma_f32_16x16x32_bf16 v[164:167], a[140:143], v[36:39], v[164:167]
 ds_read_b64_tr_b16 v[26:27], v9 offset:24832
 v_cvt_pk_bf16_f32 v58, v52, v53
 v_cvt_pk_bf16_f32 v59, v54, v55
 v_mfma_f32_16x16x32_bf16 v[164:167], a[136:139], v[32:35], v[164:167]
 s_add_u32 s5, s4, 0
 v_mfma_f32_16x16x32_bf16 v[168:171], a[144:147], v[32:35], v[168:171]
 ds_read_b64_tr_b16 v[28:29], v9 offset:26624
 buffer_store_dwordx4 v[56:59], v14, s[84:87], s5 offen offset:2304 sc1
 v_accvgpr_read_b32 v48, a88
 v_mfma_f32_16x16x32_bf16 v[168:171], a[148:151], v[36:39], v[168:171]
 v_accvgpr_read_b32 v49, a89
 v_accvgpr_read_b32 v50, a90
 v_mfma_f32_16x16x32_bf16 v[172:175], a[156:159], v[36:39], v[172:175]
 ds_read_b64_tr_b16 v[30:31], v9 offset:26880
 v_accvgpr_read_b32 v51, a91
 v_mfma_f32_16x16x32_bf16 v[172:175], a[152:155], v[32:35], v[172:175]
 s_waitcnt lgkmcnt(8)
 v_accvgpr_read_b32 v52, a92
 v_accvgpr_read_b32 v53, a93
 v_mfma_f32_16x16x32_bf16 v[176:179], a[128:131], v[40:43], v[176:179]
 ds_read_b64_tr_b16 v[32:33], v8 offset:28672
 v_accvgpr_read_b32 v54, a94
 v_accvgpr_read_b32 v55, a95
 v_mfma_f32_16x16x32_bf16 v[176:179], a[132:135], v[44:47], v[176:179]
 v_mul_f32 v48, s7, v48
 v_mfma_f32_16x16x32_bf16 v[180:183], a[140:143], v[44:47], v[180:183]
 ds_read_b64_tr_b16 v[34:35], v8 offset:28928
 v_mul_f32 v49, s7, v49
 v_mul_f32 v50, s7, v50
 v_mfma_f32_16x16x32_bf16 v[180:183], a[136:139], v[40:43], v[180:183]
 v_mul_f32 v51, s7, v51
 v_mfma_f32_16x16x32_bf16 v[184:187], a[144:147], v[40:43], v[184:187]
 ds_read_b64_tr_b16 v[36:37], v8 offset:30720
 v_mul_f32 v52, s7, v52
 v_mul_f32 v53, s7, v53
 v_mfma_f32_16x16x32_bf16 v[184:187], a[148:151], v[44:47], v[184:187]
 v_mul_f32 v54, s7, v54
 v_mul_f32 v55, s7, v55
 v_mfma_f32_16x16x32_bf16 v[188:191], a[156:159], v[44:47], v[188:191]
 ds_read_b64_tr_b16 v[38:39], v8 offset:30976
 v_cvt_pk_bf16_f32 v60, v48, v49
 v_mfma_f32_16x16x32_bf16 v[188:191], a[152:155], v[40:43], v[188:191]
 s_waitcnt lgkmcnt(8)
 v_cvt_pk_bf16_f32 v61, v50, v51
 v_cvt_pk_bf16_f32 v62, v52, v53
 v_mfma_f32_16x16x32_bf16 v[128:131], a[160:163], v[16:19], v[128:131]
 ds_read_b64_tr_b16 v[40:41], v9 offset:28672
 v_cvt_pk_bf16_f32 v63, v54, v55
 s_add_u32 s5, s4, 4096
 v_mfma_f32_16x16x32_bf16 v[128:131], a[164:167], v[20:23], v[128:131]
 buffer_store_dwordx4 v[60:63], v14, s[84:87], s5 offen offset:2304 sc1
 v_mfma_f32_16x16x32_bf16 v[132:135], a[172:175], v[20:23], v[132:135]
 ds_read_b64_tr_b16 v[42:43], v9 offset:28928
 s_mul_i32 s4, s97, 10
 s_add_i32 s4, s4, -221
 v_mfma_f32_16x16x32_bf16 v[132:135], a[168:171], v[16:19], v[132:135]
 s_lshr_b32 s8, s4, 5
 v_mfma_f32_16x16x32_bf16 v[136:139], a[176:179], v[16:19], v[136:139]
 ds_read_b64_tr_b16 v[44:45], v9 offset:30720
 s_and_b32 s4, s4, 31
 s_lshl_b32 s4, s4, 18
 v_mfma_f32_16x16x32_bf16 v[136:139], a[180:183], v[20:23], v[136:139]
 s_cmp_eq_u32 s8, 0
 s_cselect_b32 s7, 0x3e3504f3, s100
 v_mfma_f32_16x16x32_bf16 v[140:143], a[188:191], v[20:23], v[140:143]
 ds_read_b64_tr_b16 v[46:47], v9 offset:30976
 s_cselect_b32 s8, 0, 0x800000
 v_mfma_f32_16x16x32_bf16 v[140:143], a[184:187], v[16:19], v[140:143]
 s_waitcnt lgkmcnt(8)
 s_add_u32 s4, s4, s8
 v_accvgpr_read_b32 v48, a96
 v_mfma_f32_16x16x32_bf16 v[144:147], a[160:163], v[24:27], v[144:147]
 ds_read_b64_tr_b16 v[16:17], v10 offset:24576
 v_accvgpr_read_b32 v49, a97
 v_accvgpr_read_b32 v50, a98
 v_mfma_f32_16x16x32_bf16 v[144:147], a[164:167], v[28:31], v[144:147]
 v_accvgpr_read_b32 v51, a99
 v_mfma_f32_16x16x32_bf16 v[148:151], a[172:175], v[28:31], v[148:151]
 ds_read_b64_tr_b16 v[18:19], v10 offset:24832
 v_accvgpr_read_b32 v52, a100
 v_accvgpr_read_b32 v53, a101
 v_mfma_f32_16x16x32_bf16 v[148:151], a[168:171], v[24:27], v[148:151]
 v_accvgpr_read_b32 v54, a102
 v_mfma_f32_16x16x32_bf16 v[152:155], a[176:179], v[24:27], v[152:155]
 ds_read_b64_tr_b16 v[20:21], v10 offset:26624
 v_accvgpr_read_b32 v55, a103
 v_mul_f32 v48, s7, v48
 v_mfma_f32_16x16x32_bf16 v[152:155], a[180:183], v[28:31], v[152:155]
 v_mul_f32 v49, s7, v49
 v_mul_f32 v50, s7, v50
 v_mfma_f32_16x16x32_bf16 v[156:159], a[188:191], v[28:31], v[156:159]
 ds_read_b64_tr_b16 v[22:23], v10 offset:26880
 v_mul_f32 v51, s7, v51
 v_mfma_f32_16x16x32_bf16 v[156:159], a[184:187], v[24:27], v[156:159]
 s_waitcnt lgkmcnt(8)
 v_mul_f32 v52, s7, v52
 v_mul_f32 v53, s7, v53
 v_mfma_f32_16x16x32_bf16 v[160:163], a[160:163], v[32:35], v[160:163]
 ds_read_b64_tr_b16 v[24:25], v11 offset:24576
 v_mul_f32 v54, s7, v54
 v_mul_f32 v55, s7, v55
 v_mfma_f32_16x16x32_bf16 v[160:163], a[164:167], v[36:39], v[160:163]
 v_cvt_pk_bf16_f32 v56, v48, v49
 v_mfma_f32_16x16x32_bf16 v[164:167], a[172:175], v[36:39], v[164:167]
 ds_read_b64_tr_b16 v[26:27], v11 offset:24832
 v_cvt_pk_bf16_f32 v57, v50, v51
 v_cvt_pk_bf16_f32 v58, v52, v53
 v_mfma_f32_16x16x32_bf16 v[164:167], a[168:171], v[32:35], v[164:167]
 v_cvt_pk_bf16_f32 v59, v54, v55
 v_mfma_f32_16x16x32_bf16 v[168:171], a[176:179], v[32:35], v[168:171]
 ds_read_b64_tr_b16 v[28:29], v11 offset:26624
 s_add_u32 s5, s4, 0
 buffer_store_dwordx4 v[56:59], v14, s[84:87], s5 offen offset:2048 sc1
 v_mfma_f32_16x16x32_bf16 v[168:171], a[180:183], v[36:39], v[168:171]
 v_accvgpr_read_b32 v48, a104
 v_accvgpr_read_b32 v49, a105
 v_mfma_f32_16x16x32_bf16 v[172:175], a[188:191], v[36:39], v[172:175]
 ds_read_b64_tr_b16 v[30:31], v11 offset:26880
 v_accvgpr_read_b32 v50, a106
 v_mfma_f32_16x16x32_bf16 v[172:175], a[184:187], v[32:35], v[172:175]
 s_waitcnt lgkmcnt(8)
 v_accvgpr_read_b32 v51, a107
 v_accvgpr_read_b32 v52, a108
 v_mfma_f32_16x16x32_bf16 v[176:179], a[160:163], v[40:43], v[176:179]
 ds_read_b64_tr_b16 v[32:33], v10 offset:28672
 v_accvgpr_read_b32 v53, a109
 v_accvgpr_read_b32 v54, a110
 v_mfma_f32_16x16x32_bf16 v[176:179], a[164:167], v[44:47], v[176:179]
 v_accvgpr_read_b32 v55, a111
 v_mfma_f32_16x16x32_bf16 v[180:183], a[172:175], v[44:47], v[180:183]
 ds_read_b64_tr_b16 v[34:35], v10 offset:28928
 v_mul_f32 v48, s7, v48
 v_mul_f32 v49, s7, v49
 v_mfma_f32_16x16x32_bf16 v[180:183], a[168:171], v[40:43], v[180:183]
 v_mul_f32 v50, s7, v50
 v_mfma_f32_16x16x32_bf16 v[184:187], a[176:179], v[40:43], v[184:187]
 ds_read_b64_tr_b16 v[36:37], v10 offset:30720
 v_mul_f32 v51, s7, v51
 v_mul_f32 v52, s7, v52
 v_mfma_f32_16x16x32_bf16 v[184:187], a[180:183], v[44:47], v[184:187]
 v_mul_f32 v53, s7, v53
 v_mul_f32 v54, s7, v54
 v_mfma_f32_16x16x32_bf16 v[188:191], a[188:191], v[44:47], v[188:191]
 ds_read_b64_tr_b16 v[38:39], v10 offset:30976
 v_mul_f32 v55, s7, v55
 v_mfma_f32_16x16x32_bf16 v[188:191], a[184:187], v[40:43], v[188:191]
 s_waitcnt lgkmcnt(8)
 v_cvt_pk_bf16_f32 v60, v48, v49
 v_cvt_pk_bf16_f32 v61, v50, v51
 v_mfma_f32_16x16x32_bf16 v[128:131], a[192:195], v[16:19], v[128:131]
 ds_read_b64_tr_b16 v[40:41], v11 offset:28672
 v_cvt_pk_bf16_f32 v62, v52, v53
 v_cvt_pk_bf16_f32 v63, v54, v55
 v_mfma_f32_16x16x32_bf16 v[128:131], a[196:199], v[20:23], v[128:131]
 s_add_u32 s5, s4, 4096
 v_mfma_f32_16x16x32_bf16 v[132:135], a[204:207], v[20:23], v[132:135]
 ds_read_b64_tr_b16 v[42:43], v11 offset:28928
 buffer_store_dwordx4 v[60:63], v14, s[84:87], s5 offen offset:2048 sc1
 v_accvgpr_read_b32 v48, a112
 v_mfma_f32_16x16x32_bf16 v[132:135], a[200:203], v[16:19], v[132:135]
 v_accvgpr_read_b32 v49, a113
 v_mfma_f32_16x16x32_bf16 v[136:139], a[208:211], v[16:19], v[136:139]
 ds_read_b64_tr_b16 v[44:45], v11 offset:30720
 v_accvgpr_read_b32 v50, a114
 v_accvgpr_read_b32 v51, a115
 v_mfma_f32_16x16x32_bf16 v[136:139], a[212:215], v[20:23], v[136:139]
 v_accvgpr_read_b32 v52, a116
 v_accvgpr_read_b32 v53, a117
 v_mfma_f32_16x16x32_bf16 v[140:143], a[220:223], v[20:23], v[140:143]
 ds_read_b64_tr_b16 v[46:47], v11 offset:30976
 v_accvgpr_read_b32 v54, a118
 v_mfma_f32_16x16x32_bf16 v[140:143], a[216:219], v[16:19], v[140:143]
 s_waitcnt lgkmcnt(8)
 v_accvgpr_read_b32 v55, a119
 v_mul_f32 v48, s7, v48
 v_mfma_f32_16x16x32_bf16 v[144:147], a[192:195], v[24:27], v[144:147]
 ds_read_b64_tr_b16 v[16:17], v4 offset:24576
 v_mul_f32 v49, s7, v49
 v_mul_f32 v50, s7, v50
 v_mfma_f32_16x16x32_bf16 v[144:147], a[196:199], v[28:31], v[144:147]
 v_mul_f32 v51, s7, v51
 v_mfma_f32_16x16x32_bf16 v[148:151], a[204:207], v[28:31], v[148:151]
 ds_read_b64_tr_b16 v[18:19], v4 offset:24832
 v_mul_f32 v52, s7, v52
 v_mul_f32 v53, s7, v53
 v_mfma_f32_16x16x32_bf16 v[148:151], a[200:203], v[24:27], v[148:151]
 v_mul_f32 v54, s7, v54
 v_mfma_f32_16x16x32_bf16 v[152:155], a[208:211], v[24:27], v[152:155]
 ds_read_b64_tr_b16 v[20:21], v4 offset:26624
 v_mul_f32 v55, s7, v55
 v_cvt_pk_bf16_f32 v56, v48, v49
 v_mfma_f32_16x16x32_bf16 v[152:155], a[212:215], v[28:31], v[152:155]
 v_cvt_pk_bf16_f32 v57, v50, v51
 v_cvt_pk_bf16_f32 v58, v52, v53
 v_mfma_f32_16x16x32_bf16 v[156:159], a[220:223], v[28:31], v[156:159]
 ds_read_b64_tr_b16 v[22:23], v4 offset:26880
 v_cvt_pk_bf16_f32 v59, v54, v55
 v_mfma_f32_16x16x32_bf16 v[156:159], a[216:219], v[24:27], v[156:159]
 s_waitcnt lgkmcnt(8)
 s_add_u32 s5, s4, 0
 buffer_store_dwordx4 v[56:59], v14, s[84:87], s5 offen offset:2304 sc1
 v_mfma_f32_16x16x32_bf16 v[160:163], a[192:195], v[32:35], v[160:163]
 ds_read_b64_tr_b16 v[24:25], v5 offset:24576
 v_accvgpr_read_b32 v48, a120
 v_accvgpr_read_b32 v49, a121
 v_mfma_f32_16x16x32_bf16 v[160:163], a[196:199], v[36:39], v[160:163]
 v_accvgpr_read_b32 v50, a122
 v_mfma_f32_16x16x32_bf16 v[164:167], a[204:207], v[36:39], v[164:167]
 ds_read_b64_tr_b16 v[26:27], v5 offset:24832
 v_accvgpr_read_b32 v51, a123
 v_accvgpr_read_b32 v52, a124
 v_mfma_f32_16x16x32_bf16 v[164:167], a[200:203], v[32:35], v[164:167]
 v_accvgpr_read_b32 v53, a125
 v_mfma_f32_16x16x32_bf16 v[168:171], a[208:211], v[32:35], v[168:171]
 ds_read_b64_tr_b16 v[28:29], v5 offset:26624
 v_accvgpr_read_b32 v54, a126
 v_accvgpr_read_b32 v55, a127
 v_mfma_f32_16x16x32_bf16 v[168:171], a[212:215], v[36:39], v[168:171]
 v_mul_f32 v48, s7, v48
 v_mul_f32 v49, s7, v49
 v_mfma_f32_16x16x32_bf16 v[172:175], a[220:223], v[36:39], v[172:175]
 ds_read_b64_tr_b16 v[30:31], v5 offset:26880
 v_mul_f32 v50, s7, v50
 v_mfma_f32_16x16x32_bf16 v[172:175], a[216:219], v[32:35], v[172:175]
 s_waitcnt lgkmcnt(8)
 v_mul_f32 v51, s7, v51
 v_mul_f32 v52, s7, v52
 v_mfma_f32_16x16x32_bf16 v[176:179], a[192:195], v[40:43], v[176:179]
 ds_read_b64_tr_b16 v[32:33], v4 offset:28672
 v_mul_f32 v53, s7, v53
 v_mul_f32 v54, s7, v54
 v_mfma_f32_16x16x32_bf16 v[176:179], a[196:199], v[44:47], v[176:179]
 v_mul_f32 v55, s7, v55
 v_mfma_f32_16x16x32_bf16 v[180:183], a[204:207], v[44:47], v[180:183]
 ds_read_b64_tr_b16 v[34:35], v4 offset:28928
 v_cvt_pk_bf16_f32 v60, v48, v49
 v_cvt_pk_bf16_f32 v61, v50, v51
 v_mfma_f32_16x16x32_bf16 v[180:183], a[200:203], v[40:43], v[180:183]
 v_cvt_pk_bf16_f32 v62, v52, v53
 v_mfma_f32_16x16x32_bf16 v[184:187], a[208:211], v[40:43], v[184:187]
 ds_read_b64_tr_b16 v[36:37], v4 offset:30720
 v_cvt_pk_bf16_f32 v63, v54, v55
 s_add_u32 s5, s4, 4096
 v_mfma_f32_16x16x32_bf16 v[184:187], a[212:215], v[44:47], v[184:187]
 buffer_store_dwordx4 v[60:63], v14, s[84:87], s5 offen offset:2304 sc1
 s_mul_i32 s4, s97, 10
 v_mfma_f32_16x16x32_bf16 v[188:191], a[220:223], v[44:47], v[188:191]
 ds_read_b64_tr_b16 v[38:39], v4 offset:30976
 s_add_i32 s4, s4, -220
 v_mfma_f32_16x16x32_bf16 v[188:191], a[216:219], v[40:43], v[188:191]
 s_waitcnt lgkmcnt(8)
 s_lshr_b32 s8, s4, 5
 s_and_b32 s4, s4, 31
 v_mfma_f32_16x16x32_bf16 v[128:131], a[224:227], v[16:19], v[128:131]
 ds_read_b64_tr_b16 v[40:41], v5 offset:28672
 s_lshl_b32 s4, s4, 18
 s_cmp_eq_u32 s8, 0
 v_mfma_f32_16x16x32_bf16 v[128:131], a[228:231], v[20:23], v[128:131]
 s_cselect_b32 s7, 0x3e3504f3, s100
 v_mfma_f32_16x16x32_bf16 v[132:135], a[236:239], v[20:23], v[132:135]
 ds_read_b64_tr_b16 v[42:43], v5 offset:28928
 s_cselect_b32 s8, 0, 0x800000
 s_add_u32 s4, s4, s8
 v_mfma_f32_16x16x32_bf16 v[132:135], a[232:235], v[16:19], v[132:135]
 v_mul_f32 v64, s7, v64
 v_mfma_f32_16x16x32_bf16 v[136:139], a[240:243], v[16:19], v[136:139]
 ds_read_b64_tr_b16 v[44:45], v5 offset:30720
 v_mul_f32 v65, s7, v65
 v_mul_f32 v66, s7, v66
 v_mfma_f32_16x16x32_bf16 v[136:139], a[244:247], v[20:23], v[136:139]
 v_mul_f32 v67, s7, v67
 v_mul_f32 v68, s7, v68
 v_mfma_f32_16x16x32_bf16 v[140:143], a[252:255], v[20:23], v[140:143]
 ds_read_b64_tr_b16 v[46:47], v5 offset:30976
 v_mul_f32 v69, s7, v69
 v_mfma_f32_16x16x32_bf16 v[140:143], a[248:251], v[16:19], v[140:143]
 s_waitcnt lgkmcnt(8)
 v_mul_f32 v70, s7, v70
 v_mul_f32 v71, s7, v71
 v_mfma_f32_16x16x32_bf16 v[144:147], a[224:227], v[24:27], v[144:147]
 ds_read_b64_tr_b16 v[16:17], v6 offset:32768
 v_cvt_pk_bf16_f32 v56, v64, v65
 v_cvt_pk_bf16_f32 v57, v66, v67
 v_mfma_f32_16x16x32_bf16 v[144:147], a[228:231], v[28:31], v[144:147]
 v_cvt_pk_bf16_f32 v58, v68, v69
 v_mfma_f32_16x16x32_bf16 v[148:151], a[236:239], v[28:31], v[148:151]
 ds_read_b64_tr_b16 v[18:19], v6 offset:33024
 v_cvt_pk_bf16_f32 v59, v70, v71
 s_add_u32 s5, s4, 0
 v_mfma_f32_16x16x32_bf16 v[148:151], a[232:235], v[24:27], v[148:151]
 buffer_store_dwordx4 v[56:59], v14, s[84:87], s5 offen offset:2048 sc1
 v_mfma_f32_16x16x32_bf16 v[152:155], a[240:243], v[24:27], v[152:155]
 ds_read_b64_tr_b16 v[20:21], v6 offset:34816
 v_mul_f32 v72, s7, v72
 v_mul_f32 v73, s7, v73
 v_mfma_f32_16x16x32_bf16 v[152:155], a[244:247], v[28:31], v[152:155]
 v_mul_f32 v74, s7, v74
 v_mul_f32 v75, s7, v75
 v_mfma_f32_16x16x32_bf16 v[156:159], a[252:255], v[28:31], v[156:159]
 ds_read_b64_tr_b16 v[22:23], v6 offset:35072
 v_mul_f32 v76, s7, v76
 v_mfma_f32_16x16x32_bf16 v[156:159], a[248:251], v[24:27], v[156:159]
 s_waitcnt lgkmcnt(8)
 v_mul_f32 v77, s7, v77
 v_mul_f32 v78, s7, v78
 v_mfma_f32_16x16x32_bf16 v[160:163], a[224:227], v[32:35], v[160:163]
 ds_read_b64_tr_b16 v[24:25], v7 offset:32768
 v_mul_f32 v79, s7, v79
 v_cvt_pk_bf16_f32 v60, v72, v73
 v_mfma_f32_16x16x32_bf16 v[160:163], a[228:231], v[36:39], v[160:163]
 v_cvt_pk_bf16_f32 v61, v74, v75
 v_mfma_f32_16x16x32_bf16 v[164:167], a[236:239], v[36:39], v[164:167]
 ds_read_b64_tr_b16 v[26:27], v7 offset:33024
 v_cvt_pk_bf16_f32 v62, v76, v77
 v_cvt_pk_bf16_f32 v63, v78, v79
 v_mfma_f32_16x16x32_bf16 v[164:167], a[232:235], v[32:35], v[164:167]
 s_add_u32 s5, s4, 4096
 v_mfma_f32_16x16x32_bf16 v[168:171], a[240:243], v[32:35], v[168:171]
 ds_read_b64_tr_b16 v[28:29], v7 offset:34816
 buffer_store_dwordx4 v[60:63], v14, s[84:87], s5 offen offset:2048 sc1
 v_mul_f32 v80, s7, v80
 v_mfma_f32_16x16x32_bf16 v[168:171], a[244:247], v[36:39], v[168:171]
 v_mul_f32 v81, s7, v81
 v_mul_f32 v82, s7, v82
 v_mfma_f32_16x16x32_bf16 v[172:175], a[252:255], v[36:39], v[172:175]
 ds_read_b64_tr_b16 v[30:31], v7 offset:35072
 v_mul_f32 v83, s7, v83
 v_mfma_f32_16x16x32_bf16 v[172:175], a[248:251], v[32:35], v[172:175]
 s_waitcnt lgkmcnt(8)
 v_mul_f32 v84, s7, v84
 v_mul_f32 v85, s7, v85
 v_mfma_f32_16x16x32_bf16 v[176:179], a[224:227], v[40:43], v[176:179]
 ds_read_b64_tr_b16 v[32:33], v6 offset:36864
 v_mul_f32 v86, s7, v86
 v_mfma_f32_16x16x32_bf16 v[176:179], a[228:231], v[44:47], v[176:179]
 v_mul_f32 v87, s7, v87
 v_cvt_pk_bf16_f32 v56, v80, v81
 v_mfma_f32_16x16x32_bf16 v[180:183], a[236:239], v[44:47], v[180:183]
 ds_read_b64_tr_b16 v[34:35], v6 offset:37120
 v_cvt_pk_bf16_f32 v57, v82, v83
 v_cvt_pk_bf16_f32 v58, v84, v85
 v_mfma_f32_16x16x32_bf16 v[180:183], a[232:235], v[40:43], v[180:183]
 v_cvt_pk_bf16_f32 v59, v86, v87
 v_mfma_f32_16x16x32_bf16 v[184:187], a[240:243], v[40:43], v[184:187]
 ds_read_b64_tr_b16 v[36:37], v6 offset:38912
 s_add_u32 s5, s4, 0
 buffer_store_dwordx4 v[56:59], v14, s[84:87], s5 offen offset:2304 sc1
 v_mfma_f32_16x16x32_bf16 v[184:187], a[244:247], v[44:47], v[184:187]
 v_mul_f32 v88, s7, v88
 v_mul_f32 v89, s7, v89
 v_mfma_f32_16x16x32_bf16 v[188:191], a[252:255], v[44:47], v[188:191]
 ds_read_b64_tr_b16 v[38:39], v6 offset:39168
 v_mul_f32 v90, s7, v90
 v_mfma_f32_16x16x32_bf16 v[188:191], a[248:251], v[40:43], v[188:191]
 s_waitcnt lgkmcnt(8)
 v_mul_f32 v91, s7, v91
 v_mul_f32 v92, s7, v92
 v_mfma_f32_16x16x32_bf16 v[192:195], a[128:131], v[16:19], v[192:195]
 ds_read_b64_tr_b16 v[40:41], v7 offset:36864
 v_mul_f32 v93, s7, v93
 v_mfma_f32_16x16x32_bf16 v[192:195], a[132:135], v[20:23], v[192:195]
 v_mul_f32 v94, s7, v94
 v_mul_f32 v95, s7, v95
 v_mfma_f32_16x16x32_bf16 v[196:199], a[140:143], v[20:23], v[196:199]
 ds_read_b64_tr_b16 v[42:43], v7 offset:37120
 v_cvt_pk_bf16_f32 v60, v88, v89
 v_cvt_pk_bf16_f32 v61, v90, v91
 v_mfma_f32_16x16x32_bf16 v[196:199], a[136:139], v[16:19], v[196:199]
 v_cvt_pk_bf16_f32 v62, v92, v93
 v_mfma_f32_16x16x32_bf16 v[200:203], a[144:147], v[16:19], v[200:203]
 ds_read_b64_tr_b16 v[44:45], v7 offset:38912
 v_cvt_pk_bf16_f32 v63, v94, v95
 s_add_u32 s5, s4, 4096
 v_mfma_f32_16x16x32_bf16 v[200:203], a[148:151], v[20:23], v[200:203]
 buffer_store_dwordx4 v[60:63], v14, s[84:87], s5 offen offset:2304 sc1
 s_mul_i32 s4, s97, 10
 v_mfma_f32_16x16x32_bf16 v[204:207], a[156:159], v[20:23], v[204:207]
 ds_read_b64_tr_b16 v[46:47], v7 offset:39168
 s_add_i32 s4, s4, -218
 v_mfma_f32_16x16x32_bf16 v[204:207], a[152:155], v[16:19], v[204:207]
 s_waitcnt lgkmcnt(8)
 s_lshr_b32 s8, s4, 5
 s_and_b32 s4, s4, 31
 v_mfma_f32_16x16x32_bf16 v[208:211], a[128:131], v[24:27], v[208:211]
 ds_read_b64_tr_b16 v[16:17], v8 offset:32768
 s_lshl_b32 s4, s4, 18
 v_mfma_f32_16x16x32_bf16 v[208:211], a[132:135], v[28:31], v[208:211]
 s_cmp_eq_u32 s8, 0
 s_cselect_b32 s7, 0x3e3504f3, s100
 v_mfma_f32_16x16x32_bf16 v[212:215], a[140:143], v[28:31], v[212:215]
 ds_read_b64_tr_b16 v[18:19], v8 offset:33024
 s_cselect_b32 s8, 0, 0x800000
 s_add_u32 s4, s4, s8
 v_mfma_f32_16x16x32_bf16 v[212:215], a[136:139], v[24:27], v[212:215]
 v_mul_f32 v96, s7, v96
 v_mfma_f32_16x16x32_bf16 v[216:219], a[144:147], v[24:27], v[216:219]
 ds_read_b64_tr_b16 v[20:21], v8 offset:34816
 v_mul_f32 v97, s7, v97
 v_mul_f32 v98, s7, v98
 v_mfma_f32_16x16x32_bf16 v[216:219], a[148:151], v[28:31], v[216:219]
 v_mul_f32 v99, s7, v99
 v_mul_f32 v100, s7, v100
 v_mfma_f32_16x16x32_bf16 v[220:223], a[156:159], v[28:31], v[220:223]
 ds_read_b64_tr_b16 v[22:23], v8 offset:35072
 v_mul_f32 v101, s7, v101
 v_mfma_f32_16x16x32_bf16 v[220:223], a[152:155], v[24:27], v[220:223]
 s_waitcnt lgkmcnt(8)
 v_mul_f32 v102, s7, v102
 v_mul_f32 v103, s7, v103
 v_mfma_f32_16x16x32_bf16 v[224:227], a[128:131], v[32:35], v[224:227]
 ds_read_b64_tr_b16 v[24:25], v9 offset:32768
 v_cvt_pk_bf16_f32 v56, v96, v97
 v_mfma_f32_16x16x32_bf16 v[224:227], a[132:135], v[36:39], v[224:227]
 v_cvt_pk_bf16_f32 v57, v98, v99
 v_cvt_pk_bf16_f32 v58, v100, v101
 v_mfma_f32_16x16x32_bf16 v[228:231], a[140:143], v[36:39], v[228:231]
 ds_read_b64_tr_b16 v[26:27], v9 offset:33024
 v_cvt_pk_bf16_f32 v59, v102, v103
 s_add_u32 s5, s4, 0
 v_mfma_f32_16x16x32_bf16 v[228:231], a[136:139], v[32:35], v[228:231]
 buffer_store_dwordx4 v[56:59], v14, s[84:87], s5 offen offset:2048 sc1
 v_mfma_f32_16x16x32_bf16 v[232:235], a[144:147], v[32:35], v[232:235]
 ds_read_b64_tr_b16 v[28:29], v9 offset:34816
 v_mul_f32 v104, s7, v104
 v_mul_f32 v105, s7, v105
 v_mfma_f32_16x16x32_bf16 v[232:235], a[148:151], v[36:39], v[232:235]
 v_mul_f32 v106, s7, v106
 v_mul_f32 v107, s7, v107
 v_mfma_f32_16x16x32_bf16 v[236:239], a[156:159], v[36:39], v[236:239]
 ds_read_b64_tr_b16 v[30:31], v9 offset:35072
 v_mul_f32 v108, s7, v108
 v_mfma_f32_16x16x32_bf16 v[236:239], a[152:155], v[32:35], v[236:239]
 s_waitcnt lgkmcnt(8)
 v_mul_f32 v109, s7, v109
 v_mul_f32 v110, s7, v110
 v_mfma_f32_16x16x32_bf16 v[240:243], a[128:131], v[40:43], v[240:243]
 ds_read_b64_tr_b16 v[32:33], v8 offset:36864
 v_mul_f32 v111, s7, v111
 v_mfma_f32_16x16x32_bf16 v[240:243], a[132:135], v[44:47], v[240:243]
 v_cvt_pk_bf16_f32 v60, v104, v105
 v_cvt_pk_bf16_f32 v61, v106, v107
 v_mfma_f32_16x16x32_bf16 v[244:247], a[140:143], v[44:47], v[244:247]
 ds_read_b64_tr_b16 v[34:35], v8 offset:37120
 v_cvt_pk_bf16_f32 v62, v108, v109
 v_cvt_pk_bf16_f32 v63, v110, v111
 v_mfma_f32_16x16x32_bf16 v[244:247], a[136:139], v[40:43], v[244:247]
 s_add_u32 s5, s4, 4096
 v_mfma_f32_16x16x32_bf16 v[248:251], a[144:147], v[40:43], v[248:251]
 ds_read_b64_tr_b16 v[36:37], v8 offset:38912
 buffer_store_dwordx4 v[60:63], v14, s[84:87], s5 offen offset:2048 sc1
 v_mul_f32 v112, s7, v112
 v_mfma_f32_16x16x32_bf16 v[248:251], a[148:151], v[44:47], v[248:251]
 v_mul_f32 v113, s7, v113
 v_mul_f32 v114, s7, v114
 v_mfma_f32_16x16x32_bf16 v[252:255], a[156:159], v[44:47], v[252:255]
 ds_read_b64_tr_b16 v[38:39], v8 offset:39168
 v_mul_f32 v115, s7, v115
 v_mfma_f32_16x16x32_bf16 v[252:255], a[152:155], v[40:43], v[252:255]
 s_waitcnt lgkmcnt(8)
 v_mul_f32 v116, s7, v116
 v_mul_f32 v117, s7, v117
 v_mfma_f32_16x16x32_bf16 v[192:195], a[160:163], v[16:19], v[192:195]
 ds_read_b64_tr_b16 v[40:41], v9 offset:36864
 v_mul_f32 v118, s7, v118
 v_mfma_f32_16x16x32_bf16 v[192:195], a[164:167], v[20:23], v[192:195]
 v_mul_f32 v119, s7, v119
 v_cvt_pk_bf16_f32 v56, v112, v113
 v_mfma_f32_16x16x32_bf16 v[196:199], a[172:175], v[20:23], v[196:199]
 ds_read_b64_tr_b16 v[42:43], v9 offset:37120
 v_cvt_pk_bf16_f32 v57, v114, v115
 v_cvt_pk_bf16_f32 v58, v116, v117
 v_mfma_f32_16x16x32_bf16 v[196:199], a[168:171], v[16:19], v[196:199]
 v_cvt_pk_bf16_f32 v59, v118, v119
 v_mfma_f32_16x16x32_bf16 v[200:203], a[176:179], v[16:19], v[200:203]
 ds_read_b64_tr_b16 v[44:45], v9 offset:38912
 s_add_u32 s5, s4, 0
 buffer_store_dwordx4 v[56:59], v14, s[84:87], s5 offen offset:2304 sc1
 v_mfma_f32_16x16x32_bf16 v[200:203], a[180:183], v[20:23], v[200:203]
 v_mul_f32 v120, s7, v120
 v_mul_f32 v121, s7, v121
 v_mfma_f32_16x16x32_bf16 v[204:207], a[188:191], v[20:23], v[204:207]
 ds_read_b64_tr_b16 v[46:47], v9 offset:39168
 v_mul_f32 v122, s7, v122
 v_mfma_f32_16x16x32_bf16 v[204:207], a[184:187], v[16:19], v[204:207]
 s_waitcnt lgkmcnt(8)
 v_mul_f32 v123, s7, v123
 v_mul_f32 v124, s7, v124
 v_mfma_f32_16x16x32_bf16 v[208:211], a[160:163], v[24:27], v[208:211]
 ds_read_b64_tr_b16 v[16:17], v10 offset:32768
 v_mul_f32 v125, s7, v125
 v_mfma_f32_16x16x32_bf16 v[208:211], a[164:167], v[28:31], v[208:211]
 v_mul_f32 v126, s7, v126
 v_mul_f32 v127, s7, v127
 v_mfma_f32_16x16x32_bf16 v[212:215], a[172:175], v[28:31], v[212:215]
 ds_read_b64_tr_b16 v[18:19], v10 offset:33024
 v_cvt_pk_bf16_f32 v60, v120, v121
 v_cvt_pk_bf16_f32 v61, v122, v123
 v_mfma_f32_16x16x32_bf16 v[212:215], a[168:171], v[24:27], v[212:215]
 v_cvt_pk_bf16_f32 v62, v124, v125
 v_mfma_f32_16x16x32_bf16 v[216:219], a[176:179], v[24:27], v[216:219]
 ds_read_b64_tr_b16 v[20:21], v10 offset:34816
 v_cvt_pk_bf16_f32 v63, v126, v127
 s_add_u32 s5, s4, 4096
 v_mfma_f32_16x16x32_bf16 v[216:219], a[180:183], v[28:31], v[216:219]
 buffer_store_dwordx4 v[60:63], v14, s[84:87], s5 offen offset:2304 sc1
 s_mul_i32 s4, s97, 10
 v_mfma_f32_16x16x32_bf16 v[220:223], a[188:191], v[28:31], v[220:223]
 ds_read_b64_tr_b16 v[22:23], v10 offset:35072
 s_add_i32 s4, s4, -219
 v_mfma_f32_16x16x32_bf16 v[220:223], a[184:187], v[24:27], v[220:223]
 s_waitcnt lgkmcnt(8)
 s_lshr_b32 s8, s4, 5
 s_and_b32 s4, s4, 31
 v_mfma_f32_16x16x32_bf16 v[224:227], a[160:163], v[32:35], v[224:227]
 ds_read_b64_tr_b16 v[24:25], v11 offset:32768
 s_lshl_b32 s4, s4, 18
 v_mfma_f32_16x16x32_bf16 v[224:227], a[164:167], v[36:39], v[224:227]
 s_cmp_eq_u32 s8, 0
 s_cselect_b32 s7, 0x3e3504f3, s100
 v_mfma_f32_16x16x32_bf16 v[228:231], a[172:175], v[36:39], v[228:231]
 ds_read_b64_tr_b16 v[26:27], v11 offset:33024
 s_cselect_b32 s8, 0, 0x800000
 s_add_u32 s4, s4, s8
 v_mfma_f32_16x16x32_bf16 v[228:231], a[168:171], v[32:35], v[228:231]
 v_mul_f32 v128, s7, v128
 v_mfma_f32_16x16x32_bf16 v[232:235], a[176:179], v[32:35], v[232:235]
 ds_read_b64_tr_b16 v[28:29], v11 offset:34816
 v_mul_f32 v129, s7, v129
 v_mul_f32 v130, s7, v130
 v_mfma_f32_16x16x32_bf16 v[232:235], a[180:183], v[36:39], v[232:235]
 v_mul_f32 v131, s7, v131
 v_mul_f32 v132, s7, v132
 v_mfma_f32_16x16x32_bf16 v[236:239], a[188:191], v[36:39], v[236:239]
 ds_read_b64_tr_b16 v[30:31], v11 offset:35072
 v_mul_f32 v133, s7, v133
 v_mfma_f32_16x16x32_bf16 v[236:239], a[184:187], v[32:35], v[236:239]
 s_waitcnt lgkmcnt(8)
 v_mul_f32 v134, s7, v134
 v_mul_f32 v135, s7, v135
 v_mfma_f32_16x16x32_bf16 v[240:243], a[160:163], v[40:43], v[240:243]
 ds_read_b64_tr_b16 v[32:33], v10 offset:36864
 v_cvt_pk_bf16_f32 v56, v128, v129
 v_mfma_f32_16x16x32_bf16 v[240:243], a[164:167], v[44:47], v[240:243]
 v_cvt_pk_bf16_f32 v57, v130, v131
 v_cvt_pk_bf16_f32 v58, v132, v133
 v_mfma_f32_16x16x32_bf16 v[244:247], a[172:175], v[44:47], v[244:247]
 ds_read_b64_tr_b16 v[34:35], v10 offset:37120
 v_cvt_pk_bf16_f32 v59, v134, v135
 s_add_u32 s5, s4, 0
 v_mfma_f32_16x16x32_bf16 v[244:247], a[168:171], v[40:43], v[244:247]
 buffer_store_dwordx4 v[56:59], v14, s[84:87], s5 offen offset:2048 sc1
 v_mfma_f32_16x16x32_bf16 v[248:251], a[176:179], v[40:43], v[248:251]
 ds_read_b64_tr_b16 v[36:37], v10 offset:38912
 v_mul_f32 v136, s7, v136
 v_mul_f32 v137, s7, v137
 v_mfma_f32_16x16x32_bf16 v[248:251], a[180:183], v[44:47], v[248:251]
 v_mul_f32 v138, s7, v138
 v_mul_f32 v139, s7, v139
 v_mfma_f32_16x16x32_bf16 v[252:255], a[188:191], v[44:47], v[252:255]
 ds_read_b64_tr_b16 v[38:39], v10 offset:39168
 v_mul_f32 v140, s7, v140
 v_mfma_f32_16x16x32_bf16 v[252:255], a[184:187], v[40:43], v[252:255]
 s_waitcnt lgkmcnt(8)
 v_mul_f32 v141, s7, v141
 v_mul_f32 v142, s7, v142
 v_mfma_f32_16x16x32_bf16 v[192:195], a[192:195], v[16:19], v[192:195]
 ds_read_b64_tr_b16 v[40:41], v11 offset:36864
 v_mul_f32 v143, s7, v143
 v_mfma_f32_16x16x32_bf16 v[192:195], a[196:199], v[20:23], v[192:195]
 v_cvt_pk_bf16_f32 v60, v136, v137
 v_cvt_pk_bf16_f32 v61, v138, v139
 v_mfma_f32_16x16x32_bf16 v[196:199], a[204:207], v[20:23], v[196:199]
 ds_read_b64_tr_b16 v[42:43], v11 offset:37120
 v_cvt_pk_bf16_f32 v62, v140, v141
 v_cvt_pk_bf16_f32 v63, v142, v143
 v_mfma_f32_16x16x32_bf16 v[196:199], a[200:203], v[16:19], v[196:199]
 s_add_u32 s5, s4, 4096
 v_mfma_f32_16x16x32_bf16 v[200:203], a[208:211], v[16:19], v[200:203]
 ds_read_b64_tr_b16 v[44:45], v11 offset:38912
 buffer_store_dwordx4 v[60:63], v14, s[84:87], s5 offen offset:2048 sc1
 v_mul_f32 v144, s7, v144
 v_mfma_f32_16x16x32_bf16 v[200:203], a[212:215], v[20:23], v[200:203]
 v_mul_f32 v145, s7, v145
 v_mul_f32 v146, s7, v146
 v_mfma_f32_16x16x32_bf16 v[204:207], a[220:223], v[20:23], v[204:207]
 ds_read_b64_tr_b16 v[46:47], v11 offset:39168
 v_mul_f32 v147, s7, v147
 v_mfma_f32_16x16x32_bf16 v[204:207], a[216:219], v[16:19], v[204:207]
 s_waitcnt lgkmcnt(8)
 v_mul_f32 v148, s7, v148
 v_mul_f32 v149, s7, v149
 v_mfma_f32_16x16x32_bf16 v[208:211], a[192:195], v[24:27], v[208:211]
 ds_read_b64_tr_b16 v[16:17], v4 offset:32768
 v_mul_f32 v150, s7, v150
 v_mfma_f32_16x16x32_bf16 v[208:211], a[196:199], v[28:31], v[208:211]
 v_mul_f32 v151, s7, v151
 v_cvt_pk_bf16_f32 v56, v144, v145
 v_mfma_f32_16x16x32_bf16 v[212:215], a[204:207], v[28:31], v[212:215]
 ds_read_b64_tr_b16 v[18:19], v4 offset:33024
 v_cvt_pk_bf16_f32 v57, v146, v147
 v_cvt_pk_bf16_f32 v58, v148, v149
 v_mfma_f32_16x16x32_bf16 v[212:215], a[200:203], v[24:27], v[212:215]
 v_cvt_pk_bf16_f32 v59, v150, v151
 v_mfma_f32_16x16x32_bf16 v[216:219], a[208:211], v[24:27], v[216:219]
 ds_read_b64_tr_b16 v[20:21], v4 offset:34816
 s_add_u32 s5, s4, 0
 buffer_store_dwordx4 v[56:59], v14, s[84:87], s5 offen offset:2304 sc1
 v_mfma_f32_16x16x32_bf16 v[216:219], a[212:215], v[28:31], v[216:219]
 v_mul_f32 v152, s7, v152
 v_mul_f32 v153, s7, v153
 v_mfma_f32_16x16x32_bf16 v[220:223], a[220:223], v[28:31], v[220:223]
 ds_read_b64_tr_b16 v[22:23], v4 offset:35072
 v_mul_f32 v154, s7, v154
 v_mfma_f32_16x16x32_bf16 v[220:223], a[216:219], v[24:27], v[220:223]
 s_waitcnt lgkmcnt(8)
 v_mul_f32 v155, s7, v155
 v_mul_f32 v156, s7, v156
 v_mfma_f32_16x16x32_bf16 v[224:227], a[192:195], v[32:35], v[224:227]
 ds_read_b64_tr_b16 v[24:25], v5 offset:32768
 v_mul_f32 v157, s7, v157
 v_mfma_f32_16x16x32_bf16 v[224:227], a[196:199], v[36:39], v[224:227]
 v_mul_f32 v158, s7, v158
 v_mul_f32 v159, s7, v159
 v_mfma_f32_16x16x32_bf16 v[228:231], a[204:207], v[36:39], v[228:231]
 ds_read_b64_tr_b16 v[26:27], v5 offset:33024
 v_cvt_pk_bf16_f32 v60, v152, v153
 v_cvt_pk_bf16_f32 v61, v154, v155
 v_mfma_f32_16x16x32_bf16 v[228:231], a[200:203], v[32:35], v[228:231]
 v_cvt_pk_bf16_f32 v62, v156, v157
 v_mfma_f32_16x16x32_bf16 v[232:235], a[208:211], v[32:35], v[232:235]
 ds_read_b64_tr_b16 v[28:29], v5 offset:34816
 v_cvt_pk_bf16_f32 v63, v158, v159
 s_add_u32 s5, s4, 4096
 v_mfma_f32_16x16x32_bf16 v[232:235], a[212:215], v[36:39], v[232:235]
 buffer_store_dwordx4 v[60:63], v14, s[84:87], s5 offen offset:2304 sc1
 s_mul_i32 s4, s97, 10
 v_mfma_f32_16x16x32_bf16 v[236:239], a[220:223], v[36:39], v[236:239]
 ds_read_b64_tr_b16 v[30:31], v5 offset:35072
 s_add_i32 s4, s4, -217
 v_mfma_f32_16x16x32_bf16 v[236:239], a[216:219], v[32:35], v[236:239]
 s_waitcnt lgkmcnt(8)
 s_lshr_b32 s8, s4, 5
 s_and_b32 s4, s4, 31
 v_mfma_f32_16x16x32_bf16 v[240:243], a[192:195], v[40:43], v[240:243]
 ds_read_b64_tr_b16 v[32:33], v4 offset:36864
 s_lshl_b32 s4, s4, 18
 v_mfma_f32_16x16x32_bf16 v[240:243], a[196:199], v[44:47], v[240:243]
 s_cmp_eq_u32 s8, 0
 s_cselect_b32 s7, 0x3e3504f3, s100
 v_mfma_f32_16x16x32_bf16 v[244:247], a[204:207], v[44:47], v[244:247]
 ds_read_b64_tr_b16 v[34:35], v4 offset:37120
 s_cselect_b32 s8, 0, 0x800000
 s_add_u32 s4, s4, s8
 v_mfma_f32_16x16x32_bf16 v[244:247], a[200:203], v[40:43], v[244:247]
 v_mul_f32 v160, s7, v160
 v_mfma_f32_16x16x32_bf16 v[248:251], a[208:211], v[40:43], v[248:251]
 ds_read_b64_tr_b16 v[36:37], v4 offset:38912
 v_mul_f32 v161, s7, v161
 v_mul_f32 v162, s7, v162
 v_mfma_f32_16x16x32_bf16 v[248:251], a[212:215], v[44:47], v[248:251]
 v_mul_f32 v163, s7, v163
 v_mul_f32 v164, s7, v164
 v_mfma_f32_16x16x32_bf16 v[252:255], a[220:223], v[44:47], v[252:255]
 ds_read_b64_tr_b16 v[38:39], v4 offset:39168
 v_mul_f32 v165, s7, v165
 v_mfma_f32_16x16x32_bf16 v[252:255], a[216:219], v[40:43], v[252:255]
 s_waitcnt lgkmcnt(8)
 v_mul_f32 v166, s7, v166
 v_mul_f32 v167, s7, v167
 v_mfma_f32_16x16x32_bf16 v[192:195], a[224:227], v[16:19], v[192:195]
 ds_read_b64_tr_b16 v[40:41], v5 offset:36864
 v_cvt_pk_bf16_f32 v56, v160, v161
 v_mfma_f32_16x16x32_bf16 v[192:195], a[228:231], v[20:23], v[192:195]
 v_cvt_pk_bf16_f32 v57, v162, v163
 v_cvt_pk_bf16_f32 v58, v164, v165
 v_mfma_f32_16x16x32_bf16 v[196:199], a[236:239], v[20:23], v[196:199]
 ds_read_b64_tr_b16 v[42:43], v5 offset:37120
 v_cvt_pk_bf16_f32 v59, v166, v167
 s_add_u32 s5, s4, 0
 v_mfma_f32_16x16x32_bf16 v[196:199], a[232:235], v[16:19], v[196:199]
 buffer_store_dwordx4 v[56:59], v14, s[84:87], s5 offen offset:2048 sc1
 v_mfma_f32_16x16x32_bf16 v[200:203], a[240:243], v[16:19], v[200:203]
 ds_read_b64_tr_b16 v[44:45], v5 offset:38912
 v_mul_f32 v168, s7, v168
 v_mul_f32 v169, s7, v169
 v_mfma_f32_16x16x32_bf16 v[200:203], a[244:247], v[20:23], v[200:203]
 v_mul_f32 v170, s7, v170
 v_mul_f32 v171, s7, v171
 v_mfma_f32_16x16x32_bf16 v[204:207], a[252:255], v[20:23], v[204:207]
 ds_read_b64_tr_b16 v[46:47], v5 offset:39168
 v_mul_f32 v172, s7, v172
 v_mfma_f32_16x16x32_bf16 v[204:207], a[248:251], v[16:19], v[204:207]
 s_waitcnt lgkmcnt(8)
 v_mul_f32 v173, s7, v173
 v_mul_f32 v174, s7, v174
 v_mfma_f32_16x16x32_bf16 v[208:211], a[224:227], v[24:27], v[208:211]
 v_mul_f32 v175, s7, v175
 v_mfma_f32_16x16x32_bf16 v[208:211], a[228:231], v[28:31], v[208:211]
 v_cvt_pk_bf16_f32 v60, v168, v169
 v_cvt_pk_bf16_f32 v61, v170, v171
 v_mfma_f32_16x16x32_bf16 v[212:215], a[236:239], v[28:31], v[212:215]
 v_cvt_pk_bf16_f32 v62, v172, v173
 v_cvt_pk_bf16_f32 v63, v174, v175
 v_mfma_f32_16x16x32_bf16 v[212:215], a[232:235], v[24:27], v[212:215]
 s_add_u32 s5, s4, 4096
 v_mfma_f32_16x16x32_bf16 v[216:219], a[240:243], v[24:27], v[216:219]
 buffer_store_dwordx4 v[60:63], v14, s[84:87], s5 offen offset:2048 sc1
 v_mul_f32 v176, s7, v176
 v_mfma_f32_16x16x32_bf16 v[216:219], a[244:247], v[28:31], v[216:219]
 v_mul_f32 v177, s7, v177
 v_mul_f32 v178, s7, v178
 v_mfma_f32_16x16x32_bf16 v[220:223], a[252:255], v[28:31], v[220:223]
 v_mul_f32 v179, s7, v179
 v_mfma_f32_16x16x32_bf16 v[220:223], a[248:251], v[24:27], v[220:223]
 s_waitcnt lgkmcnt(4)
 v_mul_f32 v180, s7, v180
 v_mul_f32 v181, s7, v181
 v_mfma_f32_16x16x32_bf16 v[224:227], a[224:227], v[32:35], v[224:227]
 v_mul_f32 v182, s7, v182
 v_mfma_f32_16x16x32_bf16 v[224:227], a[228:231], v[36:39], v[224:227]
 v_mul_f32 v183, s7, v183
 v_cvt_pk_bf16_f32 v56, v176, v177
 v_mfma_f32_16x16x32_bf16 v[228:231], a[236:239], v[36:39], v[228:231]
 v_cvt_pk_bf16_f32 v57, v178, v179
 v_cvt_pk_bf16_f32 v58, v180, v181
 v_mfma_f32_16x16x32_bf16 v[228:231], a[232:235], v[32:35], v[228:231]
 v_cvt_pk_bf16_f32 v59, v182, v183
 v_mfma_f32_16x16x32_bf16 v[232:235], a[240:243], v[32:35], v[232:235]
 s_add_u32 s5, s4, 0
 buffer_store_dwordx4 v[56:59], v14, s[84:87], s5 offen offset:2304 sc1
 v_mfma_f32_16x16x32_bf16 v[232:235], a[244:247], v[36:39], v[232:235]
 v_mul_f32 v184, s7, v184
 v_mul_f32 v185, s7, v185
 v_mfma_f32_16x16x32_bf16 v[236:239], a[252:255], v[36:39], v[236:239]
 v_mul_f32 v186, s7, v186
 v_mfma_f32_16x16x32_bf16 v[236:239], a[248:251], v[32:35], v[236:239]
 s_waitcnt lgkmcnt(0)
 v_mul_f32 v187, s7, v187
 v_mul_f32 v188, s7, v188
 v_mfma_f32_16x16x32_bf16 v[240:243], a[224:227], v[40:43], v[240:243]
 v_mul_f32 v189, s7, v189
 v_mfma_f32_16x16x32_bf16 v[240:243], a[228:231], v[44:47], v[240:243]
 v_mul_f32 v190, s7, v190
 v_mul_f32 v191, s7, v191
 v_mfma_f32_16x16x32_bf16 v[244:247], a[236:239], v[44:47], v[244:247]
 v_cvt_pk_bf16_f32 v60, v184, v185
 v_cvt_pk_bf16_f32 v61, v186, v187
 v_mfma_f32_16x16x32_bf16 v[244:247], a[232:235], v[40:43], v[244:247]
 v_cvt_pk_bf16_f32 v62, v188, v189
 v_mfma_f32_16x16x32_bf16 v[248:251], a[240:243], v[40:43], v[248:251]
 v_cvt_pk_bf16_f32 v63, v190, v191
 s_add_u32 s5, s4, 4096
 v_mfma_f32_16x16x32_bf16 v[248:251], a[244:247], v[44:47], v[248:251]
 buffer_store_dwordx4 v[60:63], v14, s[84:87], s5 offen offset:2304 sc1
 v_mfma_f32_16x16x32_bf16 v[252:255], a[252:255], v[44:47], v[252:255]
 v_mfma_f32_16x16x32_bf16 v[252:255], a[248:251], v[40:43], v[252:255]
 s_nop 7
 s_mul_i32 s4, s97, 10
 s_add_i32 s4, s4, -216
 s_lshr_b32 s8, s4, 5
 s_and_b32 s4, s4, 31
 s_lshl_b32 s4, s4, 18
 s_cmp_eq_u32 s8, 0
 s_cselect_b32 s7, 0x3e3504f3, s100
 s_cselect_b32 s8, 0, 0x800000
 s_add_u32 s4, s4, s8
 v_mul_f32 v192, s7, v192
 v_mul_f32 v193, s7, v193
 v_mul_f32 v194, s7, v194
 v_mul_f32 v195, s7, v195
 v_mul_f32 v196, s7, v196
 v_mul_f32 v197, s7, v197
 v_mul_f32 v198, s7, v198
 v_mul_f32 v199, s7, v199
 v_cvt_pk_bf16_f32 v56, v192, v193
 v_cvt_pk_bf16_f32 v57, v194, v195
 v_cvt_pk_bf16_f32 v58, v196, v197
 v_cvt_pk_bf16_f32 v59, v198, v199
 s_add_u32 s5, s4, 0
 buffer_store_dwordx4 v[56:59], v14, s[84:87], s5 offen offset:2048 sc1
 v_mul_f32 v200, s7, v200
 v_mul_f32 v201, s7, v201
 v_mul_f32 v202, s7, v202
 v_mul_f32 v203, s7, v203
 v_mul_f32 v204, s7, v204
 v_mul_f32 v205, s7, v205
 v_mul_f32 v206, s7, v206
 v_mul_f32 v207, s7, v207
 v_cvt_pk_bf16_f32 v60, v200, v201
 v_cvt_pk_bf16_f32 v61, v202, v203
 v_cvt_pk_bf16_f32 v62, v204, v205
 v_cvt_pk_bf16_f32 v63, v206, v207
 s_add_u32 s5, s4, 4096
 buffer_store_dwordx4 v[60:63], v14, s[84:87], s5 offen offset:2048 sc1
 v_mul_f32 v208, s7, v208
 v_mul_f32 v209, s7, v209
 v_mul_f32 v210, s7, v210
 v_mul_f32 v211, s7, v211
 v_mul_f32 v212, s7, v212
 v_mul_f32 v213, s7, v213
 v_mul_f32 v214, s7, v214
 v_mul_f32 v215, s7, v215
 v_cvt_pk_bf16_f32 v56, v208, v209
 v_cvt_pk_bf16_f32 v57, v210, v211
 v_cvt_pk_bf16_f32 v58, v212, v213
 v_cvt_pk_bf16_f32 v59, v214, v215
 s_add_u32 s5, s4, 0
 buffer_store_dwordx4 v[56:59], v14, s[84:87], s5 offen offset:2304 sc1
 v_mul_f32 v216, s7, v216
 v_mul_f32 v217, s7, v217
 v_mul_f32 v218, s7, v218
 v_mul_f32 v219, s7, v219
 v_mul_f32 v220, s7, v220
 v_mul_f32 v221, s7, v221
 v_mul_f32 v222, s7, v222
 v_mul_f32 v223, s7, v223
 v_cvt_pk_bf16_f32 v60, v216, v217
 v_cvt_pk_bf16_f32 v61, v218, v219
 v_cvt_pk_bf16_f32 v62, v220, v221
 v_cvt_pk_bf16_f32 v63, v222, v223
 s_add_u32 s5, s4, 4096
 buffer_store_dwordx4 v[60:63], v14, s[84:87], s5 offen offset:2304 sc1
 s_mul_i32 s4, s97, 10
 s_add_i32 s4, s4, -215
 s_lshr_b32 s8, s4, 5
 s_and_b32 s4, s4, 31
 s_lshl_b32 s4, s4, 18
 s_cmp_eq_u32 s8, 0
 s_cselect_b32 s7, 0x3e3504f3, s100
 s_cselect_b32 s8, 0, 0x800000
 s_add_u32 s4, s4, s8
 v_mul_f32 v224, s7, v224
 v_mul_f32 v225, s7, v225
 v_mul_f32 v226, s7, v226
 v_mul_f32 v227, s7, v227
 v_mul_f32 v228, s7, v228
 v_mul_f32 v229, s7, v229
 v_mul_f32 v230, s7, v230
 v_mul_f32 v231, s7, v231
 v_cvt_pk_bf16_f32 v56, v224, v225
 v_cvt_pk_bf16_f32 v57, v226, v227
 v_cvt_pk_bf16_f32 v58, v228, v229
 v_cvt_pk_bf16_f32 v59, v230, v231
 s_add_u32 s5, s4, 0
 buffer_store_dwordx4 v[56:59], v14, s[84:87], s5 offen offset:2048 sc1
 v_mul_f32 v232, s7, v232
 v_mul_f32 v233, s7, v233
 v_mul_f32 v234, s7, v234
 v_mul_f32 v235, s7, v235
 v_mul_f32 v236, s7, v236
 v_mul_f32 v237, s7, v237
 v_mul_f32 v238, s7, v238
 v_mul_f32 v239, s7, v239
 v_cvt_pk_bf16_f32 v60, v232, v233
 v_cvt_pk_bf16_f32 v61, v234, v235
 v_cvt_pk_bf16_f32 v62, v236, v237
 v_cvt_pk_bf16_f32 v63, v238, v239
 s_add_u32 s5, s4, 4096
 buffer_store_dwordx4 v[60:63], v14, s[84:87], s5 offen offset:2048 sc1
 v_mul_f32 v240, s7, v240
 v_mul_f32 v241, s7, v241
 v_mul_f32 v242, s7, v242
 v_mul_f32 v243, s7, v243
 v_mul_f32 v244, s7, v244
 v_mul_f32 v245, s7, v245
 v_mul_f32 v246, s7, v246
 v_mul_f32 v247, s7, v247
 v_cvt_pk_bf16_f32 v56, v240, v241
 v_cvt_pk_bf16_f32 v57, v242, v243
 v_cvt_pk_bf16_f32 v58, v244, v245
 v_cvt_pk_bf16_f32 v59, v246, v247
 s_add_u32 s5, s4, 0
 buffer_store_dwordx4 v[56:59], v14, s[84:87], s5 offen offset:2304 sc1
 v_mul_f32 v248, s7, v248
 v_mul_f32 v249, s7, v249
 v_mul_f32 v250, s7, v250
 v_mul_f32 v251, s7, v251
 v_mul_f32 v252, s7, v252
 v_mul_f32 v253, s7, v253
 v_mul_f32 v254, s7, v254
 v_mul_f32 v255, s7, v255
 v_cvt_pk_bf16_f32 v60, v248, v249
 v_cvt_pk_bf16_f32 v61, v250, v251
 v_cvt_pk_bf16_f32 v62, v252, v253
 v_cvt_pk_bf16_f32 v63, v254, v255
 s_add_u32 s5, s4, 4096
 buffer_store_dwordx4 v[60:63], v14, s[84:87], s5 offen offset:2304 sc1
 s_endpgm
L_g1_C_fin:
L_g1_end:
    s_endpgm

.globl attfin_kernel
.p2align 8
.type attfin_kernel,@function
attfin_kernel:
 s_cmp_ge_u32 s2, 512
 s_cbranch_scc1 L_b_end
 s_load_dwordx2 s[4:5], s[0:1], 72
 s_load_dwordx4 s[68:71], s[0:1], 48
 s_load_dwordx2 s[56:57], s[0:1], 16
 s_load_dwordx2 s[58:59], s[0:1], 0
 v_lshrrev_b32 v7, 6, v0
 v_and_b32 v1, 63, v0
 v_readfirstlane_b32 s48, v7
L_b_here:
 s_lshr_b32 s12, s2, 3
 s_mul_i32 s12, s12, 384
 v_min_u32 v188, 2, v1
 v_lshlrev_b32 v188, 7, v188
 v_add_u32 v188, s12, v188
 v_min_u32 v188, L_b_end - L_b_here - 4, v188
 s_getpc_b64 s[8:9]
 s_add_u32 s8, s8, L_b_here - .
 s_addc_u32 s9, s9, -1
 v_mov_b32 v189, s9
 v_add_co_u32 v188, vcc, s8, v188
 s_nop 1
 v_addc_co_u32 v189, vcc, 0, v189, vcc
 global_load_dword v190, v[188:189], off
 s_cmp_ge_u32 s2, 256
 s_cbranch_scc1 L_b_gemm
 s_nop 1
 s_setprio 3
 v_lshlrev_b32 v2, 4, v1
 s_and_b32 s6, s2, 7
 s_bfe_u32 s7, s2, 0x20003
 s_lshl_b32 s6, s6, 2
 s_add_u32 s6, s6, s7
 s_lshr_b32 s7, s2, 5
 v_lshl_add_u32 v4, v7, 10, v2
 s_lshl_b32 s8, s6, 18
 s_add_u32 s12, s8, 12582912
 s_mov_b32 s44, 0
 s_lshl_b32 s9, s7, 3
 s_lshl_b32 s10, s48, 1
 s_add_u32 s9, s9, s10
 s_lshl_b32 s10, s9, 12
 s_add_u32 s10, s10, s8
 s_add_u32 s45, s10, 4194304
 s_lshl_b32 s47, s48, 10
 s_mov_b32 s46, 0
 s_waitcnt lgkmcnt(0)
 s_mov_b32 s40, s4
 s_mov_b32 s41, s5
 s_mov_b32 s42, 0x10000000
 s_mov_b32 s43, 0x20000
 s_add_u32 s96, s4, s12
 s_addc_u32 s97, s5, 0
 s_mov_b32 s98, 0x40000
 s_mov_b32 s99, 0x20000
 s_add_u32 m0, s47, 0
 s_nop 0
 buffer_load_dwordx4 v4, s[96:99], s44 offen lds
 s_add_u32 s44, s44, 4096
 s_add_u32 m0, s47, 4096
 s_nop 0
 buffer_load_dwordx4 v4, s[96:99], s44 offen lds
 s_add_u32 s44, s44, 4096
 s_add_u32 m0, s47, 8192
 s_nop 0
 buffer_load_dwordx4 v4, s[96:99], s44 offen lds
 s_add_u32 s44, s44, 4096
 s_add_u32 m0, s47, 12288
 s_nop 0
 buffer_load_dwordx4 v4, s[96:99], s44 offen lds
 s_add_u32 s44, s44, 4096
 s_add_u32 s47, s47, 16384
 s_and_b32 s47, s47, 65535
 s_add_u32 s11, s45, 4096
 buffer_load_dwordx4 v[16:19], v2, s[40:43], s45 offen offset:0
 buffer_load_dwordx4 v[20:23], v2, s[40:43], s45 offen offset:1024
 buffer_load_dwordx4 v[24:27], v2, s[40:43], s11 offen offset:0
 buffer_load_dwordx4 v[28:31], v2, s[40:43], s11 offen offset:1024
 s_add_u32 m0, s47, 0
 s_nop 0
 buffer_load_dwordx4 v4, s[96:99], s44 offen lds
 s_add_u32 s44, s44, 4096
 s_add_u32 m0, s47, 4096
 s_nop 0
 buffer_load_dwordx4 v4, s[96:99], s44 offen lds
 s_add_u32 s44, s44, 4096
 s_add_u32 m0, s47, 8192
 s_nop 0
 buffer_load_dwordx4 v4, s[96:99], s44 offen lds
 s_add_u32 s44, s44, 4096
 s_add_u32 m0, s47, 12288
 s_nop 0
 buffer_load_dwordx4 v4, s[96:99], s44 offen lds
 s_add_u32 s44, s44, 4096
 s_add_u32 s47, s47, 16384
 s_and_b32 s47, s47, 65535
 v_bfe_u32 v8, v1, 3, 1
 v_lshlrev_b32 v8, 15, v8
 v_lshrrev_b32 v9, 5, v1
 v_lshl_add_u32 v8, v9, 8, v8
 v_and_b32 v9, 7, v1
 v_lshl_add_u32 v8, v9, 4, v8
 v_bfe_u32 v9, v1, 4, 1
 v_lshl_add_u32 v8, v9, 7, v8
 s_lshl_b32 s10, s9, 16
 s_lshl_b32 s11, s6, 10
 s_add_u32 s10, s10, s11
 s_add_u32 s10, s10, 37748736
 v_add_u32 v5, s10, v8
 v_and_b32 v8, 3, v1
 v_bfe_u32 v9, v1, 2, 1
 v_bfe_u32 v10, v1, 4, 1
 v_xor_b32 v9, v9, v10
 v_or_b32 v8, v8, v9
 v_cmp_eq_u32 vcc, 0, v8
 v_mov_b32 v9, 0x3f803f80
 v_mov_b32 v3, v2
 v_mov_b32 v6, v2
 v_cndmask_b32 v152, 0, v9, vcc
 v_mov_b32 v153, v152
 v_mov_b32 v154, v152
 v_mov_b32 v155, v152
 v_mov_b32 v112, 0
 v_mov_b32 v113, 0
 v_mov_b32 v114, 0
 v_mov_b32 v115, 0
 v_mov_b32 v116, 0
 v_mov_b32 v117, 0
 v_mov_b32 v118, 0
 v_mov_b32 v119, 0
 v_mov_b32 v120, 0
 v_mov_b32 v121, 0
 v_mov_b32 v122, 0
 v_mov_b32 v123, 0
 v_mov_b32 v124, 0
 v_mov_b32 v125, 0
 v_mov_b32 v126, 0
 v_mov_b32 v127, 0
 v_mov_b32 v128, 0
 v_mov_b32 v129, 0
 v_mov_b32 v130, 0
 v_mov_b32 v131, 0
 v_mov_b32 v132, 0
 v_mov_b32 v133, 0
 v_mov_b32 v134, 0
 v_mov_b32 v135, 0
 v_mov_b32 v136, 0
 v_mov_b32 v137, 0
 v_mov_b32 v138, 0
 v_mov_b32 v139, 0
 v_mov_b32 v140, 0
 v_mov_b32 v141, 0
 v_mov_b32 v142, 0
 v_mov_b32 v143, 0
 v_mov_b32 v144, 0
 v_mov_b32 v145, 0
 v_mov_b32 v146, 0
 v_mov_b32 v147, 0
 v_mov_b32 v148, 0
 v_mov_b32 v149, 0
 v_mov_b32 v150, 0
 v_mov_b32 v151, 0
 v_mov_b32 v96, 0
 v_mov_b32 v97, 0
 v_mov_b32 v98, 0
 v_mov_b32 v99, 0
 v_mov_b32 v100, 0
 v_mov_b32 v101, 0
 v_mov_b32 v102, 0
 v_mov_b32 v103, 0
 v_mov_b32 v104, 0
 v_mov_b32 v105, 0
 v_mov_b32 v106, 0
 v_mov_b32 v107, 0
 v_mov_b32 v108, 0
 v_mov_b32 v109, 0
 v_mov_b32 v110, 0
 v_mov_b32 v111, 0
 v_mov_b32 v172, 0
 v_mov_b32 v173, 0
 v_mov_b32 v174, 0
 v_mov_b32 v175, 0
 v_mov_b32 v176, 0
 v_mov_b32 v177, 0
 v_mov_b32 v178, 0
 v_mov_b32 v179, 0
 v_mov_b32 v180, 0
 v_mov_b32 v181, 0
 v_mov_b32 v182, 0
 v_mov_b32 v183, 0
 v_mov_b32 v184, 0
 v_mov_b32 v185, 0
 v_mov_b32 v186, 0
 v_mov_b32 v187, 0
 s_mov_b32 s60, s56
 s_mov_b32 s61, s57
 s_mov_b32 s62, 0x200000
 s_mov_b32 s63, 0x20000
 s_lshr_b32 s64, s2, 3
 s_lshl_b32 s64, s64, 2
 s_add_u32 s64, s64, s48
 s_lshl_b32 s64, s64, 14
 s_and_b32 s65, s2, 1
 s_lshl_b32 s65, s65, 10
 s_add_u32 s64, s64, s65
 v_lshrrev_b32 v13, 3, v1
 v_lshlrev_b32 v13, 11, v13
 v_and_b32 v14, 7, v1
 v_lshl_add_u32 v13, v14, 7, v13
 s_waitcnt vmcnt(4)
 s_barrier
 ds_read_b128 v[156:159], v3 offset:0
 ds_read_b128 v[160:163], v3 offset:1024
 ds_read_b128 v[164:167], v3 offset:4096
 ds_read_b128 v[168:171], v3 offset:5120
 s_waitcnt lgkmcnt(2)
 v_mfma_f32_32x32x16_bf16 v[64:79], v[156:159], v[16:19], 0
 v_mfma_f32_32x32x16_bf16 v[64:79], v[160:163], v[20:23], v[64:79]
 v_mfma_f32_32x32x16_bf16 v[80:95], v[156:159], v[24:27], 0
 v_mfma_f32_32x32x16_bf16 v[80:95], v[160:163], v[28:31], v[80:95]
 s_nop 15
 v_max3_f32 v8, v64, v65, v66
 v_max3_f32 v8, v67, v68, v8
 v_max3_f32 v8, v69, v70, v8
 v_max3_f32 v8, v71, v72, v8
 v_max3_f32 v8, v73, v74, v8
 v_max3_f32 v8, v75, v76, v8
 v_max3_f32 v8, v77, v78, v8
 v_max_f32 v8, v79, v8
 v_max3_f32 v9, v80, v81, v82
 v_max3_f32 v9, v83, v84, v9
 v_max3_f32 v9, v85, v86, v9
 v_max3_f32 v9, v87, v88, v9
 v_max3_f32 v9, v89, v90, v9
 v_max3_f32 v9, v91, v92, v9
 v_max3_f32 v9, v93, v94, v9
 v_max_f32 v9, v95, v9
 v_mov_b32 v10, v8
 s_nop 1
 v_permlane32_swap_b32 v10, v8
 s_nop 1
 v_max_f32 v10, v10, v8
 v_sub_f32 v32, 0, v10
 v_sub_f32 v33, 0, v10
 v_sub_f32 v34, 0, v10
 v_sub_f32 v35, 0, v10
 v_sub_f32 v36, 0, v10
 v_sub_f32 v37, 0, v10
 v_sub_f32 v38, 0, v10
 v_sub_f32 v39, 0, v10
 v_sub_f32 v40, 0, v10
 v_sub_f32 v41, 0, v10
 v_sub_f32 v42, 0, v10
 v_sub_f32 v43, 0, v10
 v_sub_f32 v44, 0, v10
 v_sub_f32 v45, 0, v10
 v_sub_f32 v46, 0, v10
 v_sub_f32 v47, 0, v10
 v_mov_b32 v10, v9
 s_nop 1
 v_permlane32_swap_b32 v10, v9
 s_nop 1
 v_max_f32 v10, v10, v9
 v_sub_f32 v48, 0, v10
 v_sub_f32 v49, 0, v10
 v_sub_f32 v50, 0, v10
 v_sub_f32 v51, 0, v10
 v_sub_f32 v52, 0, v10
 v_sub_f32 v53, 0, v10
 v_sub_f32 v54, 0, v10
 v_sub_f32 v55, 0, v10
 v_sub_f32 v56, 0, v10
 v_sub_f32 v57, 0, v10
 v_sub_f32 v58, 0, v10
 v_sub_f32 v59, 0, v10
 v_sub_f32 v60, 0, v10
 v_sub_f32 v61, 0, v10
 v_sub_f32 v62, 0, v10
 v_sub_f32 v63, 0, v10
 s_movk_i32 s49, 14
 s_nop 1
 v_mfma_f32_32x32x16_bf16 v[64:79], v[156:159], v[16:19], v[32:47]
 v_mfma_f32_32x32x16_bf16 v[64:79], v[160:163], v[20:23], v[64:79]
 s_add_u32 m0, s47, 0
 s_nop 0
 buffer_load_dwordx4 v4, s[96:99], s44 offen lds
 s_add_u32 s44, s44, 4096
 s_add_u32 m0, s47, 4096
 s_nop 0
 buffer_load_dwordx4 v4, s[96:99], s44 offen lds
 s_add_u32 s44, s44, 4096
 s_add_u32 m0, s47, 8192
 s_nop 0
 buffer_load_dwordx4 v4, s[96:99], s44 offen lds
 s_add_u32 s44, s44, 4096
 s_add_u32 m0, s47, 12288
 s_nop 0
 buffer_load_dwordx4 v4, s[96:99], s44 offen lds
 s_add_u32 s44, s44, 4096
 s_add_u32 s47, s47, 16384
 s_and_b32 s47, s47, 65535
 s_nop 7
 s_nop 3
 s_setprio 0
.p2align 6
L_a_loop:
 v_mfma_f32_32x32x16_bf16 v[80:95], v[156:159], v[24:27], v[48:63]
 ds_read_b128 v[172:175], v6 offset:2048
 v_exp_f32 v64, v64
 v_exp_f32 v65, v65
 v_exp_f32 v66, v66
 v_cvt_pk_bf16_f32 v96, v64, v65
 v_exp_f32 v67, v67
 v_mfma_f32_32x32x16_bf16 v[80:95], v[160:163], v[28:31], v[80:95]
 ds_read_b128 v[176:179], v6 offset:3072
 v_exp_f32 v68, v68
 v_cvt_pk_bf16_f32 v97, v66, v67
 v_exp_f32 v69, v69
 v_exp_f32 v70, v70
 v_cvt_pk_bf16_f32 v98, v68, v69
 v_mfma_f32_32x32x16_bf16 v[128:143], v[180:183], v[104:107], v[128:143]
 v_exp_f32 v71, v71
 v_exp_f32 v72, v72
 v_cvt_pk_bf16_f32 v99, v70, v71
 v_exp_f32 v73, v73
 v_mfma_f32_16x16x32_bf16 v[148:151], v[152:155], v[104:107], v[148:151]
 v_exp_f32 v74, v74
 v_cvt_pk_bf16_f32 v100, v72, v73
 v_mfma_f32_32x32x16_bf16 v[128:143], v[184:187], v[108:111], v[128:143]
 v_exp_f32 v75, v75
 v_exp_f32 v76, v76
 v_cvt_pk_bf16_f32 v101, v74, v75
 v_exp_f32 v77, v77
 v_exp_f32 v78, v78
 v_exp_f32 v79, v79
 v_mfma_f32_16x16x32_bf16 v[148:151], v[152:155], v[108:111], v[148:151]
 s_waitcnt lgkmcnt(2)
 v_cvt_pk_bf16_f32 v102, v76, v77
 v_cvt_pk_bf16_f32 v103, v78, v79
 v_mfma_f32_32x32x16_bf16 v[64:79], v[164:167], v[16:19], v[32:47]
 ds_read_b128 v[156:159], v3 offset:8192
 v_exp_f32 v80, v80
 v_exp_f32 v81, v81
 v_exp_f32 v82, v82
 v_cvt_pk_bf16_f32 v104, v80, v81
 v_exp_f32 v83, v83
 v_mfma_f32_32x32x16_bf16 v[64:79], v[168:171], v[20:23], v[64:79]
 ds_read_b128 v[160:163], v3 offset:9216
 s_waitcnt lgkmcnt(2)
 v_exp_f32 v84, v84
 v_cvt_pk_bf16_f32 v105, v82, v83
 v_exp_f32 v85, v85
 v_exp_f32 v86, v86
 v_cvt_pk_bf16_f32 v106, v84, v85
 v_mfma_f32_32x32x16_bf16 v[112:127], v[172:175], v[96:99], v[112:127]
 s_sub_u32 s49, s49, 1
 v_exp_f32 v87, v87
 v_exp_f32 v88, v88
 v_cvt_pk_bf16_f32 v107, v86, v87
 v_exp_f32 v89, v89
 v_mfma_f32_16x16x32_bf16 v[144:147], v[152:155], v[96:99], v[144:147]
 v_exp_f32 v90, v90
 v_cvt_pk_bf16_f32 v108, v88, v89
 v_mfma_f32_32x32x16_bf16 v[112:127], v[176:179], v[100:103], v[112:127]
 v_exp_f32 v91, v91
 v_exp_f32 v92, v92
 v_cvt_pk_bf16_f32 v109, v90, v91
 v_exp_f32 v93, v93
 v_exp_f32 v94, v94
 v_exp_f32 v95, v95
 v_mfma_f32_16x16x32_bf16 v[144:147], v[152:155], v[100:103], v[144:147]
 v_cvt_pk_bf16_f32 v110, v92, v93
 v_cvt_pk_bf16_f32 v111, v94, v95
 v_mfma_f32_32x32x16_bf16 v[80:95], v[164:167], v[24:27], v[48:63]
 ds_read_b128 v[180:183], v6 offset:6144
 v_exp_f32 v64, v64
 v_exp_f32 v65, v65
 v_exp_f32 v66, v66
 v_cvt_pk_bf16_f32 v96, v64, v65
 v_exp_f32 v67, v67
 v_mfma_f32_32x32x16_bf16 v[80:95], v[168:171], v[28:31], v[80:95]
 ds_read_b128 v[184:187], v6 offset:7168
 v_exp_f32 v68, v68
 v_cvt_pk_bf16_f32 v97, v66, v67
 v_exp_f32 v69, v69
 v_exp_f32 v70, v70
 v_cvt_pk_bf16_f32 v98, v68, v69
 v_mfma_f32_32x32x16_bf16 v[128:143], v[172:175], v[104:107], v[128:143]
 v_exp_f32 v71, v71
 v_exp_f32 v72, v72
 v_cvt_pk_bf16_f32 v99, v70, v71
 v_exp_f32 v73, v73
 v_mfma_f32_16x16x32_bf16 v[148:151], v[152:155], v[104:107], v[148:151]
 v_exp_f32 v74, v74
 v_cvt_pk_bf16_f32 v100, v72, v73
 v_mfma_f32_32x32x16_bf16 v[128:143], v[176:179], v[108:111], v[128:143]
 v_exp_f32 v75, v75
 v_exp_f32 v76, v76
 v_cvt_pk_bf16_f32 v101, v74, v75
 v_exp_f32 v77, v77
 v_exp_f32 v78, v78
 v_exp_f32 v79, v79
 v_mfma_f32_16x16x32_bf16 v[148:151], v[152:155], v[108:111], v[148:151]
 s_waitcnt lgkmcnt(2)
 v_cvt_pk_bf16_f32 v102, v76, v77
 v_cvt_pk_bf16_f32 v103, v78, v79
 v_mfma_f32_32x32x16_bf16 v[64:79], v[156:159], v[16:19], v[32:47]
 ds_read_b128 v[164:167], v3 offset:12288
 v_exp_f32 v80, v80
 v_exp_f32 v81, v81
 v_exp_f32 v82, v82
 v_cvt_pk_bf16_f32 v104, v80, v81
 v_exp_f32 v83, v83
 v_mfma_f32_32x32x16_bf16 v[64:79], v[160:163], v[20:23], v[64:79]
 ds_read_b128 v[168:171], v3 offset:13312
 s_waitcnt lgkmcnt(2)
 v_exp_f32 v84, v84
 v_cvt_pk_bf16_f32 v105, v82, v83
 v_exp_f32 v85, v85
 v_exp_f32 v86, v86
 v_cvt_pk_bf16_f32 v106, v84, v85
 v_mfma_f32_32x32x16_bf16 v[112:127], v[180:183], v[96:99], v[112:127]
 v_exp_f32 v87, v87
 v_exp_f32 v88, v88
 v_cvt_pk_bf16_f32 v107, v86, v87
 v_exp_f32 v89, v89
 v_mfma_f32_16x16x32_bf16 v[144:147], v[152:155], v[96:99], v[144:147]
 v_exp_f32 v90, v90
 v_cvt_pk_bf16_f32 v108, v88, v89
 v_mfma_f32_32x32x16_bf16 v[112:127], v[184:187], v[100:103], v[112:127]
 v_exp_f32 v91, v91
 v_exp_f32 v92, v92
 v_cvt_pk_bf16_f32 v109, v90, v91
 v_exp_f32 v93, v93
 v_exp_f32 v94, v94
 v_exp_f32 v95, v95
 v_mfma_f32_16x16x32_bf16 v[144:147], v[152:155], v[100:103], v[144:147]
 v_cvt_pk_bf16_f32 v110, v92, v93
 v_cvt_pk_bf16_f32 v111, v94, v95
 v_mfma_f32_32x32x16_bf16 v[80:95], v[156:159], v[24:27], v[48:63]
 ds_read_b128 v[172:175], v6 offset:10240
 v_exp_f32 v64, v64
 v_exp_f32 v65, v65
 v_exp_f32 v66, v66
 v_cvt_pk_bf16_f32 v96, v64, v65
 v_exp_f32 v67, v67
 v_mfma_f32_32x32x16_bf16 v[80:95], v[160:163], v[28:31], v[80:95]
 ds_read_b128 v[176:179], v6 offset:11264
 v_exp_f32 v68, v68
 v_cvt_pk_bf16_f32 v97, v66, v67
 v_exp_f32 v69, v69
 v_exp_f32 v70, v70
 v_cvt_pk_bf16_f32 v98, v68, v69
 v_mfma_f32_32x32x16_bf16 v[128:143], v[180:183], v[104:107], v[128:143]
 s_add_u32 s46, s46, 16384
 v_exp_f32 v71, v71
 v_exp_f32 v72, v72
 v_cvt_pk_bf16_f32 v99, v70, v71
 v_exp_f32 v73, v73
 v_mfma_f32_16x16x32_bf16 v[148:151], v[152:155], v[104:107], v[148:151]
 s_and_b32 s46, s46, 65535
 v_exp_f32 v74, v74
 v_cvt_pk_bf16_f32 v100, v72, v73
 v_mfma_f32_32x32x16_bf16 v[128:143], v[184:187], v[108:111], v[128:143]
 v_exp_f32 v75, v75
 v_exp_f32 v76, v76
 v_cvt_pk_bf16_f32 v101, v74, v75
 v_exp_f32 v77, v77
 v_exp_f32 v78, v78
 v_exp_f32 v79, v79
 v_mfma_f32_16x16x32_bf16 v[148:151], v[152:155], v[108:111], v[148:151]
 s_waitcnt lgkmcnt(2)
 s_waitcnt vmcnt(4)
 s_barrier
 v_add_u32 v3, s46, v2
 v_cvt_pk_bf16_f32 v102, v76, v77
 v_cvt_pk_bf16_f32 v103, v78, v79
 v_mfma_f32_32x32x16_bf16 v[64:79], v[164:167], v[16:19], v[32:47]
 ds_read_b128 v[156:159], v3 offset:0
 v_exp_f32 v80, v80
 v_exp_f32 v81, v81
 v_exp_f32 v82, v82
 v_cvt_pk_bf16_f32 v104, v80, v81
 v_exp_f32 v83, v83
 v_mfma_f32_32x32x16_bf16 v[64:79], v[168:171], v[20:23], v[64:79]
 ds_read_b128 v[160:163], v3 offset:1024
 s_waitcnt lgkmcnt(2)
 v_exp_f32 v84, v84
 v_cvt_pk_bf16_f32 v105, v82, v83
 v_exp_f32 v85, v85
 v_exp_f32 v86, v86
 v_cvt_pk_bf16_f32 v106, v84, v85
 v_mfma_f32_32x32x16_bf16 v[112:127], v[172:175], v[96:99], v[112:127]
 s_add_u32 m0, s47, 0
 v_exp_f32 v87, v87
 v_exp_f32 v88, v88
 v_cvt_pk_bf16_f32 v107, v86, v87
 v_exp_f32 v89, v89
 v_mfma_f32_16x16x32_bf16 v[144:147], v[152:155], v[96:99], v[144:147]
 buffer_load_dwordx4 v4, s[96:99], s44 offen lds
 s_add_u32 s44, s44, 4096
 v_exp_f32 v90, v90
 v_cvt_pk_bf16_f32 v108, v88, v89
 v_mfma_f32_32x32x16_bf16 v[112:127], v[176:179], v[100:103], v[112:127]
 s_add_u32 m0, s47, 4096
 v_exp_f32 v91, v91
 v_exp_f32 v92, v92
 v_cvt_pk_bf16_f32 v109, v90, v91
 v_exp_f32 v93, v93
 v_exp_f32 v94, v94
 v_exp_f32 v95, v95
 v_mfma_f32_16x16x32_bf16 v[144:147], v[152:155], v[100:103], v[144:147]
 buffer_load_dwordx4 v4, s[96:99], s44 offen lds
 s_add_u32 s44, s44, 4096
 v_cvt_pk_bf16_f32 v110, v92, v93
 v_cvt_pk_bf16_f32 v111, v94, v95
 v_mfma_f32_32x32x16_bf16 v[80:95], v[164:167], v[24:27], v[48:63]
 ds_read_b128 v[180:183], v6 offset:14336
 v_exp_f32 v64, v64
 v_exp_f32 v65, v65
 v_exp_f32 v66, v66
 v_cvt_pk_bf16_f32 v96, v64, v65
 v_exp_f32 v67, v67
 v_mfma_f32_32x32x16_bf16 v[80:95], v[168:171], v[28:31], v[80:95]
 ds_read_b128 v[184:187], v6 offset:15360
 v_exp_f32 v68, v68
 v_cvt_pk_bf16_f32 v97, v66, v67
 v_exp_f32 v69, v69
 v_exp_f32 v70, v70
 v_cvt_pk_bf16_f32 v98, v68, v69
 v_mfma_f32_32x32x16_bf16 v[128:143], v[172:175], v[104:107], v[128:143]
 s_add_u32 m0, s47, 8192
 v_exp_f32 v71, v71
 v_exp_f32 v72, v72
 v_cvt_pk_bf16_f32 v99, v70, v71
 v_exp_f32 v73, v73
 v_mfma_f32_16x16x32_bf16 v[148:151], v[152:155], v[104:107], v[148:151]
 buffer_load_dwordx4 v4, s[96:99], s44 offen lds
 s_add_u32 s44, s44, 4096
 v_exp_f32 v74, v74
 v_cvt_pk_bf16_f32 v100, v72, v73
 v_mfma_f32_32x32x16_bf16 v[128:143], v[176:179], v[108:111], v[128:143]
 s_add_u32 m0, s47, 12288
 v_exp_f32 v75, v75
 v_exp_f32 v76, v76
 v_cvt_pk_bf16_f32 v101, v74, v75
 v_exp_f32 v77, v77
 v_exp_f32 v78, v78
 v_exp_f32 v79, v79
 v_mfma_f32_16x16x32_bf16 v[148:151], v[152:155], v[108:111], v[148:151]
 s_waitcnt lgkmcnt(2)
 buffer_load_dwordx4 v4, s[96:99], s44 offen lds
 s_add_u32 s44, s44, 4096
 v_cvt_pk_bf16_f32 v102, v76, v77
 v_cvt_pk_bf16_f32 v103, v78, v79
 v_mfma_f32_32x32x16_bf16 v[64:79], v[156:159], v[16:19], v[32:47]
 ds_read_b128 v[164:167], v3 offset:4096
 v_exp_f32 v80, v80
 v_exp_f32 v81, v81
 v_exp_f32 v82, v82
 v_cvt_pk_bf16_f32 v104, v80, v81
 v_exp_f32 v83, v83
 v_mfma_f32_32x32x16_bf16 v[64:79], v[160:163], v[20:23], v[64:79]
 ds_read_b128 v[168:171], v3 offset:5120
 s_waitcnt lgkmcnt(2)
 v_exp_f32 v84, v84
 v_cvt_pk_bf16_f32 v105, v82, v83
 v_exp_f32 v85, v85
 v_exp_f32 v86, v86
 v_cvt_pk_bf16_f32 v106, v84, v85
 v_mfma_f32_32x32x16_bf16 v[112:127], v[180:183], v[96:99], v[112:127]
 s_add_u32 s47, s47, 16384
 v_exp_f32 v87, v87
 v_exp_f32 v88, v88
 v_cvt_pk_bf16_f32 v107, v86, v87
 v_exp_f32 v89, v89
 v_mfma_f32_16x16x32_bf16 v[144:147], v[152:155], v[96:99], v[144:147]
 s_and_b32 s47, s47, 65535
 v_exp_f32 v90, v90
 v_cvt_pk_bf16_f32 v108, v88, v89
 v_mfma_f32_32x32x16_bf16 v[112:127], v[184:187], v[100:103], v[112:127]
 v_exp_f32 v91, v91
 v_exp_f32 v92, v92
 v_cvt_pk_bf16_f32 v109, v90, v91
 v_exp_f32 v93, v93
 v_exp_f32 v94, v94
 v_exp_f32 v95, v95
 v_mfma_f32_16x16x32_bf16 v[144:147], v[152:155], v[100:103], v[144:147]
 v_add_u32 v6, s46, v2
 v_cvt_pk_bf16_f32 v110, v92, v93
 v_cvt_pk_bf16_f32 v111, v94, v95
 s_cmp_lg_u32 s49, 0
 s_cbranch_scc1 L_a_loop
 v_mfma_f32_32x32x16_bf16 v[80:95], v[156:159], v[24:27], v[48:63]
 ds_read_b128 v[172:175], v6 offset:2048
 v_exp_f32 v64, v64
 v_exp_f32 v65, v65
 v_exp_f32 v66, v66
 v_cvt_pk_bf16_f32 v96, v64, v65
 v_exp_f32 v67, v67
 v_mfma_f32_32x32x16_bf16 v[80:95], v[160:163], v[28:31], v[80:95]
 ds_read_b128 v[176:179], v6 offset:3072
 v_exp_f32 v68, v68
 v_cvt_pk_bf16_f32 v97, v66, v67
 v_exp_f32 v69, v69
 v_exp_f32 v70, v70
 v_cvt_pk_bf16_f32 v98, v68, v69
 v_mfma_f32_32x32x16_bf16 v[128:143], v[180:183], v[104:107], v[128:143]
 buffer_load_dword v14, v13, s[60:63], s64 offen
 v_exp_f32 v71, v71
 v_exp_f32 v72, v72
 v_cvt_pk_bf16_f32 v99, v70, v71
 v_exp_f32 v73, v73
 v_mfma_f32_16x16x32_bf16 v[148:151], v[152:155], v[104:107], v[148:151]
 v_exp_f32 v74, v74
 v_cvt_pk_bf16_f32 v100, v72, v73
 v_mfma_f32_32x32x16_bf16 v[128:143], v[184:187], v[108:111], v[128:143]
 v_exp_f32 v75, v75
 v_exp_f32 v76, v76
 v_cvt_pk_bf16_f32 v101, v74, v75
 v_exp_f32 v77, v77
 v_exp_f32 v78, v78
 v_exp_f32 v79, v79
 v_mfma_f32_16x16x32_bf16 v[148:151], v[152:155], v[108:111], v[148:151]
 s_waitcnt lgkmcnt(2)
 v_cvt_pk_bf16_f32 v102, v76, v77
 v_cvt_pk_bf16_f32 v103, v78, v79
 v_mfma_f32_32x32x16_bf16 v[64:79], v[164:167], v[16:19], v[32:47]
 ds_read_b128 v[156:159], v3 offset:8192
 v_exp_f32 v80, v80
 v_exp_f32 v81, v81
 v_exp_f32 v82, v82
 v_cvt_pk_bf16_f32 v104, v80, v81
 v_exp_f32 v83, v83
 v_mfma_f32_32x32x16_bf16 v[64:79], v[168:171], v[20:23], v[64:79]
 ds_read_b128 v[160:163], v3 offset:9216
 s_waitcnt lgkmcnt(2)
 v_exp_f32 v84, v84
 v_cvt_pk_bf16_f32 v105, v82, v83
 v_exp_f32 v85, v85
 v_exp_f32 v86, v86
 v_cvt_pk_bf16_f32 v106, v84, v85
 v_mfma_f32_32x32x16_bf16 v[112:127], v[172:175], v[96:99], v[112:127]
 v_exp_f32 v87, v87
 v_exp_f32 v88, v88
 v_cvt_pk_bf16_f32 v107, v86, v87
 v_exp_f32 v89, v89
 v_mfma_f32_16x16x32_bf16 v[144:147], v[152:155], v[96:99], v[144:147]
 v_exp_f32 v90, v90
 v_cvt_pk_bf16_f32 v108, v88, v89
 v_mfma_f32_32x32x16_bf16 v[112:127], v[176:179], v[100:103], v[112:127]
 v_exp_f32 v91, v91
 v_exp_f32 v92, v92
 v_cvt_pk_bf16_f32 v109, v90, v91
 v_exp_f32 v93, v93
 v_exp_f32 v94, v94
 v_exp_f32 v95, v95
 v_mfma_f32_16x16x32_bf16 v[144:147], v[152:155], v[100:103], v[144:147]
 v_cvt_pk_bf16_f32 v110, v92, v93
 v_cvt_pk_bf16_f32 v111, v94, v95
 v_mfma_f32_32x32x16_bf16 v[80:95], v[164:167], v[24:27], v[48:63]
 ds_read_b128 v[180:183], v6 offset:6144
 v_exp_f32 v64, v64
 v_exp_f32 v65, v65
 v_exp_f32 v66, v66
 v_cvt_pk_bf16_f32 v96, v64, v65
 v_exp_f32 v67, v67
 v_mfma_f32_32x32x16_bf16 v[80:95], v[168:171], v[28:31], v[80:95]
 ds_read_b128 v[184:187], v6 offset:7168
 v_exp_f32 v68, v68
 v_cvt_pk_bf16_f32 v97, v66, v67
 v_exp_f32 v69, v69
 v_exp_f32 v70, v70
 v_cvt_pk_bf16_f32 v98, v68, v69
 v_mfma_f32_32x32x16_bf16 v[128:143], v[172:175], v[104:107], v[128:143]
 v_exp_f32 v71, v71
 v_exp_f32 v72, v72
 v_cvt_pk_bf16_f32 v99, v70, v71
 v_exp_f32 v73, v73
 v_mfma_f32_16x16x32_bf16 v[148:151], v[152:155], v[104:107], v[148:151]
 v_exp_f32 v74, v74
 v_cvt_pk_bf16_f32 v100, v72, v73
 v_mfma_f32_32x32x16_bf16 v[128:143], v[176:179], v[108:111], v[128:143]
 v_exp_f32 v75, v75
 v_exp_f32 v76, v76
 v_cvt_pk_bf16_f32 v101, v74, v75
 v_exp_f32 v77, v77
 v_exp_f32 v78, v78
 v_exp_f32 v79, v79
 v_mfma_f32_16x16x32_bf16 v[148:151], v[152:155], v[108:111], v[148:151]
 s_waitcnt lgkmcnt(2)
 v_cvt_pk_bf16_f32 v102, v76, v77
 v_cvt_pk_bf16_f32 v103, v78, v79
 v_mfma_f32_32x32x16_bf16 v[64:79], v[156:159], v[16:19], v[32:47]
 ds_read_b128 v[164:167], v3 offset:12288
 v_exp_f32 v80, v80
 v_exp_f32 v81, v81
 v_exp_f32 v82, v82
 v_cvt_pk_bf16_f32 v104, v80, v81
 v_exp_f32 v83, v83
 v_mfma_f32_32x32x16_bf16 v[64:79], v[160:163], v[20:23], v[64:79]
 ds_read_b128 v[168:171], v3 offset:13312
 s_waitcnt lgkmcnt(2)
 v_exp_f32 v84, v84
 v_cvt_pk_bf16_f32 v105, v82, v83
 v_exp_f32 v85, v85
 v_exp_f32 v86, v86
 v_cvt_pk_bf16_f32 v106, v84, v85
 v_mfma_f32_32x32x16_bf16 v[112:127], v[180:183], v[96:99], v[112:127]
 v_exp_f32 v87, v87
 v_exp_f32 v88, v88
 v_cvt_pk_bf16_f32 v107, v86, v87
 v_exp_f32 v89, v89
 v_mfma_f32_16x16x32_bf16 v[144:147], v[152:155], v[96:99], v[144:147]
 v_exp_f32 v90, v90
 v_cvt_pk_bf16_f32 v108, v88, v89
 v_mfma_f32_32x32x16_bf16 v[112:127], v[184:187], v[100:103], v[112:127]
 v_exp_f32 v91, v91
 v_exp_f32 v92, v92
 v_cvt_pk_bf16_f32 v109, v90, v91
 v_exp_f32 v93, v93
 v_exp_f32 v94, v94
 v_exp_f32 v95, v95
 v_mfma_f32_16x16x32_bf16 v[144:147], v[152:155], v[100:103], v[144:147]
 v_cvt_pk_bf16_f32 v110, v92, v93
 v_cvt_pk_bf16_f32 v111, v94, v95
 v_mfma_f32_32x32x16_bf16 v[80:95], v[156:159], v[24:27], v[48:63]
 ds_read_b128 v[172:175], v6 offset:10240
 v_exp_f32 v64, v64
 v_exp_f32 v65, v65
 v_exp_f32 v66, v66
 v_cvt_pk_bf16_f32 v96, v64, v65
 v_exp_f32 v67, v67
 v_mfma_f32_32x32x16_bf16 v[80:95], v[160:163], v[28:31], v[80:95]
 ds_read_b128 v[176:179], v6 offset:11264
 v_exp_f32 v68, v68
 v_cvt_pk_bf16_f32 v97, v66, v67
 v_exp_f32 v69, v69
 v_exp_f32 v70, v70
 v_cvt_pk_bf16_f32 v98, v68, v69
 v_mfma_f32_32x32x16_bf16 v[128:143], v[180:183], v[104:107], v[128:143]
 s_add_u32 s46, s46, 16384
 v_exp_f32 v71, v71
 v_exp_f32 v72, v72
 v_cvt_pk_bf16_f32 v99, v70, v71
 v_exp_f32 v73, v73
 v_mfma_f32_16x16x32_bf16 v[148:151], v[152:155], v[104:107], v[148:151]
 s_and_b32 s46, s46, 65535
 v_exp_f32 v74, v74
 v_cvt_pk_bf16_f32 v100, v72, v73
 v_mfma_f32_32x32x16_bf16 v[128:143], v[184:187], v[108:111], v[128:143]
 v_exp_f32 v75, v75
 v_exp_f32 v76, v76
 v_cvt_pk_bf16_f32 v101, v74, v75
 v_exp_f32 v77, v77
 v_exp_f32 v78, v78
 v_exp_f32 v79, v79
 v_mfma_f32_16x16x32_bf16 v[148:151], v[152:155], v[108:111], v[148:151]
 s_waitcnt lgkmcnt(2)
 s_waitcnt vmcnt(1)
 s_barrier
 v_add_u32 v3, s46, v2
 v_cvt_pk_bf16_f32 v102, v76, v77
 v_cvt_pk_bf16_f32 v103, v78, v79
 v_mfma_f32_32x32x16_bf16 v[64:79], v[164:167], v[16:19], v[32:47]
 ds_read_b128 v[156:159], v3 offset:0
 v_exp_f32 v80, v80
 v_exp_f32 v81, v81
 v_exp_f32 v82, v82
 v_cvt_pk_bf16_f32 v104, v80, v81
 v_exp_f32 v83, v83
 v_mfma_f32_32x32x16_bf16 v[64:79], v[168:171], v[20:23], v[64:79]
 ds_read_b128 v[160:163], v3 offset:1024
 s_waitcnt lgkmcnt(2)
 v_exp_f32 v84, v84
 v_cvt_pk_bf16_f32 v105, v82, v83
 v_exp_f32 v85, v85
 v_exp_f32 v86, v86
 v_cvt_pk_bf16_f32 v106, v84, v85
 v_mfma_f32_32x32x16_bf16 v[112:127], v[172:175], v[96:99], v[112:127]
 v_exp_f32 v87, v87
 v_exp_f32 v88, v88
 v_cvt_pk_bf16_f32 v107, v86, v87
 v_exp_f32 v89, v89
 v_mfma_f32_16x16x32_bf16 v[144:147], v[152:155], v[96:99], v[144:147]
 v_exp_f32 v90, v90
 v_cvt_pk_bf16_f32 v108, v88, v89
 v_mfma_f32_32x32x16_bf16 v[112:127], v[176:179], v[100:103], v[112:127]
 v_exp_f32 v91, v91
 v_exp_f32 v92, v92
 v_cvt_pk_bf16_f32 v109, v90, v91
 v_exp_f32 v93, v93
 v_exp_f32 v94, v94
 v_exp_f32 v95, v95
 v_mfma_f32_16x16x32_bf16 v[144:147], v[152:155], v[100:103], v[144:147]
 v_cvt_pk_bf16_f32 v110, v92, v93
 v_cvt_pk_bf16_f32 v111, v94, v95
 v_mfma_f32_32x32x16_bf16 v[80:95], v[164:167], v[24:27], v[48:63]
 ds_read_b128 v[180:183], v6 offset:14336
 v_exp_f32 v64, v64
 v_exp_f32 v65, v65
 v_exp_f32 v66, v66
 v_cvt_pk_bf16_f32 v96, v64, v65
 v_exp_f32 v67, v67
 v_mfma_f32_32x32x16_bf16 v[80:95], v[168:171], v[28:31], v[80:95]
 ds_read_b128 v[184:187], v6 offset:15360
 v_exp_f32 v68, v68
 v_cvt_pk_bf16_f32 v97, v66, v67
 v_exp_f32 v69, v69
 v_exp_f32 v70, v70
 v_cvt_pk_bf16_f32 v98, v68, v69
 v_mfma_f32_32x32x16_bf16 v[128:143], v[172:175], v[104:107], v[128:143]
 v_exp_f32 v71, v71
 v_exp_f32 v72, v72
 v_cvt_pk_bf16_f32 v99, v70, v71
 v_exp_f32 v73, v73
 v_mfma_f32_16x16x32_bf16 v[148:151], v[152:155], v[104:107], v[148:151]
 v_exp_f32 v74, v74
 v_cvt_pk_bf16_f32 v100, v72, v73
 v_mfma_f32_32x32x16_bf16 v[128:143], v[176:179], v[108:111], v[128:143]
 v_exp_f32 v75, v75
 v_exp_f32 v76, v76
 v_cvt_pk_bf16_f32 v101, v74, v75
 v_exp_f32 v77, v77
 v_exp_f32 v78, v78
 v_exp_f32 v79, v79
 v_mfma_f32_16x16x32_bf16 v[148:151], v[152:155], v[108:111], v[148:151]
 s_waitcnt lgkmcnt(2)
 v_cvt_pk_bf16_f32 v102, v76, v77
 v_cvt_pk_bf16_f32 v103, v78, v79
 v_mfma_f32_32x32x16_bf16 v[64:79], v[156:159], v[16:19], v[32:47]
 ds_read_b128 v[164:167], v3 offset:4096
 v_exp_f32 v80, v80
 v_exp_f32 v81, v81
 v_exp_f32 v82, v82
 v_cvt_pk_bf16_f32 v104, v80, v81
 v_exp_f32 v83, v83
 v_mfma_f32_32x32x16_bf16 v[64:79], v[160:163], v[20:23], v[64:79]
 ds_read_b128 v[168:171], v3 offset:5120
 s_waitcnt lgkmcnt(2)
 v_exp_f32 v84, v84
 v_cvt_pk_bf16_f32 v105, v82, v83
 v_exp_f32 v85, v85
 v_exp_f32 v86, v86
 v_cvt_pk_bf16_f32 v106, v84, v85
 v_mfma_f32_32x32x16_bf16 v[112:127], v[180:183], v[96:99], v[112:127]
 v_exp_f32 v87, v87
 v_exp_f32 v88, v88
 v_cvt_pk_bf16_f32 v107, v86, v87
 v_exp_f32 v89, v89
 v_mfma_f32_16x16x32_bf16 v[144:147], v[152:155], v[96:99], v[144:147]
 v_exp_f32 v90, v90
 v_cvt_pk_bf16_f32 v108, v88, v89
 v_mfma_f32_32x32x16_bf16 v[112:127], v[184:187], v[100:103], v[112:127]
 v_exp_f32 v91, v91
 v_exp_f32 v92, v92
 v_cvt_pk_bf16_f32 v109, v90, v91
 v_exp_f32 v93, v93
 v_exp_f32 v94, v94
 v_exp_f32 v95, v95
 v_mfma_f32_16x16x32_bf16 v[144:147], v[152:155], v[100:103], v[144:147]
 v_add_u32 v6, s46, v2
 v_cvt_pk_bf16_f32 v110, v92, v93
 v_cvt_pk_bf16_f32 v111, v94, v95
 v_mfma_f32_32x32x16_bf16 v[80:95], v[156:159], v[24:27], v[48:63]
 ds_read_b128 v[172:175], v6 offset:2048
 v_exp_f32 v64, v64
 v_exp_f32 v65, v65
 v_exp_f32 v66, v66
 v_cvt_pk_bf16_f32 v96, v64, v65
 v_exp_f32 v67, v67
 v_mfma_f32_32x32x16_bf16 v[80:95], v[160:163], v[28:31], v[80:95]
 ds_read_b128 v[176:179], v6 offset:3072
 v_exp_f32 v68, v68
 v_cvt_pk_bf16_f32 v97, v66, v67
 v_exp_f32 v69, v69
 v_exp_f32 v70, v70
 v_cvt_pk_bf16_f32 v98, v68, v69
 v_mfma_f32_32x32x16_bf16 v[128:143], v[180:183], v[104:107], v[128:143]
 v_exp_f32 v71, v71
 v_exp_f32 v72, v72
 v_cvt_pk_bf16_f32 v99, v70, v71
 v_exp_f32 v73, v73
 v_mfma_f32_16x16x32_bf16 v[148:151], v[152:155], v[104:107], v[148:151]
 v_exp_f32 v74, v74
 v_cvt_pk_bf16_f32 v100, v72, v73
 v_mfma_f32_32x32x16_bf16 v[128:143], v[184:187], v[108:111], v[128:143]
 v_exp_f32 v75, v75
 v_exp_f32 v76, v76
 v_cvt_pk_bf16_f32 v101, v74, v75
 v_exp_f32 v77, v77
 v_exp_f32 v78, v78
 v_exp_f32 v79, v79
 v_mfma_f32_16x16x32_bf16 v[148:151], v[152:155], v[108:111], v[148:151]
 s_waitcnt lgkmcnt(2)
 v_cvt_pk_bf16_f32 v102, v76, v77
 v_cvt_pk_bf16_f32 v103, v78, v79
 v_mfma_f32_32x32x16_bf16 v[64:79], v[164:167], v[16:19], v[32:47]
 ds_read_b128 v[156:159], v3 offset:8192
 v_exp_f32 v80, v80
 v_exp_f32 v81, v81
 v_exp_f32 v82, v82
 v_cvt_pk_bf16_f32 v104, v80, v81
 v_exp_f32 v83, v83
 v_mfma_f32_32x32x16_bf16 v[64:79], v[168:171], v[20:23], v[64:79]
 ds_read_b128 v[160:163], v3 offset:9216
 s_waitcnt lgkmcnt(2)
 v_exp_f32 v84, v84
 v_cvt_pk_bf16_f32 v105, v82, v83
 v_exp_f32 v85, v85
 v_exp_f32 v86, v86
 v_cvt_pk_bf16_f32 v106, v84, v85
 v_mfma_f32_32x32x16_bf16 v[112:127], v[172:175], v[96:99], v[112:127]
 v_exp_f32 v87, v87
 v_exp_f32 v88, v88
 v_cvt_pk_bf16_f32 v107, v86, v87
 v_exp_f32 v89, v89
 v_mfma_f32_16x16x32_bf16 v[144:147], v[152:155], v[96:99], v[144:147]
 v_exp_f32 v90, v90
 v_cvt_pk_bf16_f32 v108, v88, v89
 v_mfma_f32_32x32x16_bf16 v[112:127], v[176:179], v[100:103], v[112:127]
 v_exp_f32 v91, v91
 v_exp_f32 v92, v92
 v_cvt_pk_bf16_f32 v109, v90, v91
 v_exp_f32 v93, v93
 v_exp_f32 v94, v94
 v_exp_f32 v95, v95
 v_mfma_f32_16x16x32_bf16 v[144:147], v[152:155], v[100:103], v[144:147]
 v_cvt_pk_bf16_f32 v110, v92, v93
 v_cvt_pk_bf16_f32 v111, v94, v95
 v_mfma_f32_32x32x16_bf16 v[80:95], v[164:167], v[24:27], v[48:63]
 ds_read_b128 v[180:183], v6 offset:6144
 v_exp_f32 v64, v64
 v_exp_f32 v65, v65
 v_exp_f32 v66, v66
 v_cvt_pk_bf16_f32 v96, v64, v65
 v_exp_f32 v67, v67
 v_mfma_f32_32x32x16_bf16 v[80:95], v[168:171], v[28:31], v[80:95]
 ds_read_b128 v[184:187], v6 offset:7168
 v_exp_f32 v68, v68
 v_cvt_pk_bf16_f32 v97, v66, v67
 v_exp_f32 v69, v69
 v_exp_f32 v70, v70
 v_cvt_pk_bf16_f32 v98, v68, v69
 v_mfma_f32_32x32x16_bf16 v[128:143], v[172:175], v[104:107], v[128:143]
 v_exp_f32 v71, v71
 v_exp_f32 v72, v72
 v_cvt_pk_bf16_f32 v99, v70, v71
 v_exp_f32 v73, v73
 v_mfma_f32_16x16x32_bf16 v[148:151], v[152:155], v[104:107], v[148:151]
 v_exp_f32 v74, v74
 v_cvt_pk_bf16_f32 v100, v72, v73
 v_mfma_f32_32x32x16_bf16 v[128:143], v[176:179], v[108:111], v[128:143]
 v_exp_f32 v75, v75
 v_exp_f32 v76, v76
 v_cvt_pk_bf16_f32 v101, v74, v75
 v_exp_f32 v77, v77
 v_exp_f32 v78, v78
 v_exp_f32 v79, v79
 v_mfma_f32_16x16x32_bf16 v[148:151], v[152:155], v[108:111], v[148:151]
 s_waitcnt lgkmcnt(2)
 v_cvt_pk_bf16_f32 v102, v76, v77
 v_cvt_pk_bf16_f32 v103, v78, v79
 v_mfma_f32_32x32x16_bf16 v[64:79], v[156:159], v[16:19], v[32:47]
 ds_read_b128 v[164:167], v3 offset:12288
 v_exp_f32 v80, v80
 v_exp_f32 v81, v81
 v_exp_f32 v82, v82
 v_cvt_pk_bf16_f32 v104, v80, v81
 v_exp_f32 v83, v83
 v_mfma_f32_32x32x16_bf16 v[64:79], v[160:163], v[20:23], v[64:79]
 ds_read_b128 v[168:171], v3 offset:13312
 s_waitcnt lgkmcnt(2)
 v_exp_f32 v84, v84
 v_cvt_pk_bf16_f32 v105, v82, v83
 v_exp_f32 v85, v85
 v_exp_f32 v86, v86
 v_cvt_pk_bf16_f32 v106, v84, v85
 v_mfma_f32_32x32x16_bf16 v[112:127], v[180:183], v[96:99], v[112:127]
 v_exp_f32 v87, v87
 v_exp_f32 v88, v88
 v_cvt_pk_bf16_f32 v107, v86, v87
 v_exp_f32 v89, v89
 v_mfma_f32_16x16x32_bf16 v[144:147], v[152:155], v[96:99], v[144:147]
 v_exp_f32 v90, v90
 v_cvt_pk_bf16_f32 v108, v88, v89
 v_mfma_f32_32x32x16_bf16 v[112:127], v[184:187], v[100:103], v[112:127]
 v_exp_f32 v91, v91
 v_exp_f32 v92, v92
 v_cvt_pk_bf16_f32 v109, v90, v91
 v_exp_f32 v93, v93
 v_exp_f32 v94, v94
 v_exp_f32 v95, v95
 v_mfma_f32_16x16x32_bf16 v[144:147], v[152:155], v[100:103], v[144:147]
 v_cvt_pk_bf16_f32 v110, v92, v93
 v_cvt_pk_bf16_f32 v111, v94, v95
 v_mfma_f32_32x32x16_bf16 v[80:95], v[156:159], v[24:27], v[48:63]
 ds_read_b128 v[172:175], v6 offset:10240
 v_exp_f32 v64, v64
 v_exp_f32 v65, v65
 v_exp_f32 v66, v66
 v_cvt_pk_bf16_f32 v96, v64, v65
 v_exp_f32 v67, v67
 v_mfma_f32_32x32x16_bf16 v[80:95], v[160:163], v[28:31], v[80:95]
 ds_read_b128 v[176:179], v6 offset:11264
 v_exp_f32 v68, v68
 v_cvt_pk_bf16_f32 v97, v66, v67
 v_exp_f32 v69, v69
 v_exp_f32 v70, v70
 v_cvt_pk_bf16_f32 v98, v68, v69
 v_mfma_f32_32x32x16_bf16 v[128:143], v[180:183], v[104:107], v[128:143]
 v_exp_f32 v71, v71
 v_exp_f32 v72, v72
 v_cvt_pk_bf16_f32 v99, v70, v71
 v_exp_f32 v73, v73
 v_mfma_f32_16x16x32_bf16 v[148:151], v[152:155], v[104:107], v[148:151]
 v_exp_f32 v74, v74
 v_cvt_pk_bf16_f32 v100, v72, v73
 v_mfma_f32_32x32x16_bf16 v[128:143], v[184:187], v[108:111], v[128:143]
 v_exp_f32 v75, v75
 v_exp_f32 v76, v76
 v_cvt_pk_bf16_f32 v101, v74, v75
 v_exp_f32 v77, v77
 v_exp_f32 v78, v78
 v_exp_f32 v79, v79
 v_mfma_f32_16x16x32_bf16 v[148:151], v[152:155], v[108:111], v[148:151]
 s_waitcnt lgkmcnt(2)
 v_cvt_pk_bf16_f32 v102, v76, v77
 v_cvt_pk_bf16_f32 v103, v78, v79
 v_mfma_f32_32x32x16_bf16 v[64:79], v[164:167], v[16:19], v[32:47]
 v_exp_f32 v80, v80
 v_exp_f32 v81, v81
 v_exp_f32 v82, v82
 v_cvt_pk_bf16_f32 v104, v80, v81
 v_exp_f32 v83, v83
 v_mfma_f32_32x32x16_bf16 v[64:79], v[168:171], v[20:23], v[64:79]
 s_waitcnt lgkmcnt(0)
 v_exp_f32 v84, v84
 v_cvt_pk_bf16_f32 v105, v82, v83
 v_exp_f32 v85, v85
 v_exp_f32 v86, v86
 v_cvt_pk_bf16_f32 v106, v84, v85
 v_mfma_f32_32x32x16_bf16 v[112:127], v[172:175], v[96:99], v[112:127]
 v_exp_f32 v87, v87
 v_exp_f32 v88, v88
 v_cvt_pk_bf16_f32 v107, v86, v87
 v_exp_f32 v89, v89
 v_mfma_f32_16x16x32_bf16 v[144:147], v[152:155], v[96:99], v[144:147]
 v_exp_f32 v90, v90
 v_cvt_pk_bf16_f32 v108, v88, v89
 v_mfma_f32_32x32x16_bf16 v[112:127], v[176:179], v[100:103], v[112:127]
 v_exp_f32 v91, v91
 v_exp_f32 v92, v92
 v_cvt_pk_bf16_f32 v109, v90, v91
 v_exp_f32 v93, v93
 v_exp_f32 v94, v94
 v_exp_f32 v95, v95
 v_mfma_f32_16x16x32_bf16 v[144:147], v[152:155], v[100:103], v[144:147]
 v_cvt_pk_bf16_f32 v110, v92, v93
 v_cvt_pk_bf16_f32 v111, v94, v95
 v_mfma_f32_32x32x16_bf16 v[80:95], v[164:167], v[24:27], v[48:63]
 ds_read_b128 v[180:183], v6 offset:14336
 v_exp_f32 v64, v64
 v_exp_f32 v65, v65
 v_exp_f32 v66, v66
 v_cvt_pk_bf16_f32 v96, v64, v65
 v_exp_f32 v67, v67
 v_mfma_f32_32x32x16_bf16 v[80:95], v[168:171], v[28:31], v[80:95]
 ds_read_b128 v[184:187], v6 offset:15360
 v_exp_f32 v68, v68
 v_cvt_pk_bf16_f32 v97, v66, v67
 v_exp_f32 v69, v69
 v_exp_f32 v70, v70
 v_cvt_pk_bf16_f32 v98, v68, v69
 v_mfma_f32_32x32x16_bf16 v[128:143], v[172:175], v[104:107], v[128:143]
 v_exp_f32 v71, v71
 v_exp_f32 v72, v72
 v_cvt_pk_bf16_f32 v99, v70, v71
 v_exp_f32 v73, v73
 v_mfma_f32_16x16x32_bf16 v[148:151], v[152:155], v[104:107], v[148:151]
 v_exp_f32 v74, v74
 v_cvt_pk_bf16_f32 v100, v72, v73
 v_mfma_f32_32x32x16_bf16 v[128:143], v[176:179], v[108:111], v[128:143]
 v_exp_f32 v75, v75
 v_exp_f32 v76, v76
 v_cvt_pk_bf16_f32 v101, v74, v75
 v_exp_f32 v77, v77
 v_exp_f32 v78, v78
 v_exp_f32 v79, v79
 v_mfma_f32_16x16x32_bf16 v[148:151], v[152:155], v[108:111], v[148:151]
 v_cvt_pk_bf16_f32 v102, v76, v77
 v_cvt_pk_bf16_f32 v103, v78, v79
 v_mfma_f32_32x32x16_bf16 v[64:79], v[156:159], v[16:19], v[32:47]
 v_exp_f32 v80, v80
 v_exp_f32 v81, v81
 v_exp_f32 v82, v82
 v_cvt_pk_bf16_f32 v104, v80, v81
 v_exp_f32 v83, v83
 v_mfma_f32_32x32x16_bf16 v[64:79], v[160:163], v[20:23], v[64:79]
 s_waitcnt lgkmcnt(0)
 v_exp_f32 v84, v84
 v_cvt_pk_bf16_f32 v105, v82, v83
 v_exp_f32 v85, v85
 v_exp_f32 v86, v86
 v_cvt_pk_bf16_f32 v106, v84, v85
 v_mfma_f32_32x32x16_bf16 v[112:127], v[180:183], v[96:99], v[112:127]
 v_exp_f32 v87, v87
 v_exp_f32 v88, v88
 v_cvt_pk_bf16_f32 v107, v86, v87
 v_exp_f32 v89, v89
 v_mfma_f32_16x16x32_bf16 v[144:147], v[152:155], v[96:99], v[144:147]
 v_exp_f32 v90, v90
 v_cvt_pk_bf16_f32 v108, v88, v89
 v_mfma_f32_32x32x16_bf16 v[112:127], v[184:187], v[100:103], v[112:127]
 v_exp_f32 v91, v91
 v_exp_f32 v92, v92
 v_cvt_pk_bf16_f32 v109, v90, v91
 v_exp_f32 v93, v93
 v_exp_f32 v94, v94
 v_exp_f32 v95, v95
 v_mfma_f32_16x16x32_bf16 v[144:147], v[152:155], v[100:103], v[144:147]
 v_cvt_pk_bf16_f32 v110, v92, v93
 v_cvt_pk_bf16_f32 v111, v94, v95
 s_setprio 3
 v_mfma_f32_32x32x16_bf16 v[128:143], v[180:183], v[104:107], v[128:143]
 v_mfma_f32_16x16x32_bf16 v[148:151], v[152:155], v[104:107], v[148:151]
 v_mfma_f32_32x32x16_bf16 v[128:143], v[184:187], v[108:111], v[128:143]
 v_mfma_f32_16x16x32_bf16 v[148:151], v[152:155], v[108:111], v[148:151]
 s_nop 15
 v_add_f32 v8, v112, v113
 v_add_f32 v9, v128, v129
 v_add_f32 v8, v8, v114
 v_add_f32 v9, v9, v130
 v_add_f32 v8, v8, v115
 v_add_f32 v9, v9, v131
 v_add_f32 v8, v8, v116
 v_add_f32 v9, v9, v132
 v_add_f32 v8, v8, v117
 v_add_f32 v9, v9, v133
 v_add_f32 v8, v8, v118
 v_add_f32 v9, v9, v134
 v_add_f32 v8, v8, v119
 v_add_f32 v9, v9, v135
 v_add_f32 v8, v8, v120
 v_add_f32 v9, v9, v136
 v_add_f32 v8, v8, v121
 v_add_f32 v9, v9, v137
 v_add_f32 v8, v8, v122
 v_add_f32 v9, v9, v138
 v_add_f32 v8, v8, v123
 v_add_f32 v9, v9, v139
 v_add_f32 v8, v8, v124
 v_add_f32 v9, v9, v140
 v_add_f32 v8, v8, v125
 v_add_f32 v9, v9, v141
 v_add_f32 v8, v8, v126
 v_add_f32 v9, v9, v142
 v_add_f32 v8, v8, v127
 v_add_f32 v9, v9, v143
 v_add_f32 v8, v8, v9
 v_mov_b32 v10, 0x207
 v_max_f32 v9, v144, v148
 v_add_f32 v11, v144, v148
 v_add_f32 v8, v8, v11
 s_mov_b32 s52, 0x53800000
 v_cmp_class_f32 s[12:13], v8, v10
 v_cmp_le_f32 vcc, s52, v9
 s_nop 3
 s_or_b64 vcc, vcc, s[12:13]
 s_cbranch_scc1 L_a_slow
L_a_done:
 v_rcp_f32 v8, v144
 v_rcp_f32 v9, v148
 s_nop 0
 v_mul_f32 v112, v8, v112
 v_mul_f32 v113, v8, v113
 v_mul_f32 v114, v8, v114
 v_mul_f32 v115, v8, v115
 v_mul_f32 v116, v8, v116
 v_mul_f32 v117, v8, v117
 v_mul_f32 v118, v8, v118
 v_mul_f32 v119, v8, v119
 v_mul_f32 v120, v8, v120
 v_mul_f32 v121, v8, v121
 v_mul_f32 v122, v8, v122
 v_mul_f32 v123, v8, v123
 v_mul_f32 v124, v8, v124
 v_mul_f32 v125, v8, v125
 v_mul_f32 v126, v8, v126
 v_mul_f32 v127, v8, v127
 v_cvt_pk_bf16_f32 v96, v112, v113
 v_cvt_pk_bf16_f32 v97, v114, v115
 v_cvt_pk_bf16_f32 v98, v116, v117
 v_cvt_pk_bf16_f32 v99, v118, v119
 v_cvt_pk_bf16_f32 v100, v120, v121
 v_cvt_pk_bf16_f32 v101, v122, v123
 v_cvt_pk_bf16_f32 v102, v124, v125
 v_cvt_pk_bf16_f32 v103, v126, v127
 s_mov_b32 s52, 0
 buffer_store_dwordx4 v[96:99], v5, s[40:43], s52 offen offset:0 sc1
 buffer_store_dwordx4 v[100:103], v5, s[40:43], s52 offen offset:512 sc1
 v_mul_f32 v128, v9, v128
 v_mul_f32 v129, v9, v129
 v_mul_f32 v130, v9, v130
 v_mul_f32 v131, v9, v131
 v_mul_f32 v132, v9, v132
 v_mul_f32 v133, v9, v133
 v_mul_f32 v134, v9, v134
 v_mul_f32 v135, v9, v135
 v_mul_f32 v136, v9, v136
 v_mul_f32 v137, v9, v137
 v_mul_f32 v138, v9, v138
 v_mul_f32 v139, v9, v139
 v_mul_f32 v140, v9, v140
 v_mul_f32 v141, v9, v141
 v_mul_f32 v142, v9, v142
 v_mul_f32 v143, v9, v143
 v_cvt_pk_bf16_f32 v104, v128, v129
 v_cvt_pk_bf16_f32 v105, v130, v131
 v_cvt_pk_bf16_f32 v106, v132, v133
 v_cvt_pk_bf16_f32 v107, v134, v135
 v_cvt_pk_bf16_f32 v108, v136, v137
 v_cvt_pk_bf16_f32 v109, v138, v139
 v_cvt_pk_bf16_f32 v110, v140, v141
 v_cvt_pk_bf16_f32 v111, v142, v143
 s_mov_b32 s52, 65536
 buffer_store_dwordx4 v[104:107], v5, s[40:43], s52 offen offset:0 sc1
 buffer_store_dwordx4 v[108:111], v5, s[40:43], s52 offen offset:512 sc1
 s_lshl_b32 s14, s7, 5
 s_add_u32 s14, s14, s6
 s_lshl_b32 s14, s14, 7
 s_add_u32 s14, s14, 41943040
 v_mov_b32 v8, 1
 v_mov_b32 v9, 0
 s_waitcnt vmcnt(0)
 s_barrier
 s_cmp_lg_u32 s48, 0
 s_cbranch_scc1 L_a_nosig
 s_mov_b64 exec, 1
 buffer_store_dword v8, v9, s[40:43], s14 offen sc1
 s_mov_b64 exec, -1
L_a_nosig:
 s_endpgm
L_a_slow:
 s_mov_b32 s52, 0
 s_movk_i32 s49, 64
 v_mov_b32 v8, 0xff800000
 v_mov_b32 v9, 0xff800000
L_a_s1:
 buffer_load_dwordx4 v[156:159], v2, s[96:99], s52 offen offset:0
 buffer_load_dwordx4 v[160:163], v2, s[96:99], s52 offen offset:1024
 s_waitcnt vmcnt(0)
 v_mfma_f32_32x32x16_bf16 v[64:79], v[156:159], v[16:19], 0
 v_mfma_f32_32x32x16_bf16 v[64:79], v[160:163], v[20:23], v[64:79]
 v_mfma_f32_32x32x16_bf16 v[80:95], v[156:159], v[24:27], 0
 v_mfma_f32_32x32x16_bf16 v[80:95], v[160:163], v[28:31], v[80:95]
 s_nop 15
 v_max3_f32 v8, v64, v65, v8
 v_max3_f32 v8, v66, v67, v8
 v_max3_f32 v8, v68, v69, v8
 v_max3_f32 v8, v70, v71, v8
 v_max3_f32 v8, v72, v73, v8
 v_max3_f32 v8, v74, v75, v8
 v_max3_f32 v8, v76, v77, v8
 v_max3_f32 v8, v78, v79, v8
 v_max3_f32 v9, v80, v81, v9
 v_max3_f32 v9, v82, v83, v9
 v_max3_f32 v9, v84, v85, v9
 v_max3_f32 v9, v86, v87, v9
 v_max3_f32 v9, v88, v89, v9
 v_max3_f32 v9, v90, v91, v9
 v_max3_f32 v9, v92, v93, v9
 v_max3_f32 v9, v94, v95, v9
 s_add_u32 s52, s52, 4096
 s_sub_u32 s49, s49, 1
 s_cmp_lg_u32 s49, 0
 s_cbranch_scc1 L_a_s1
 v_mov_b32 v10, v8
 s_nop 1
 v_permlane32_swap_b32 v10, v8
 s_nop 1
 v_max_f32 v10, v10, v8
 v_sub_f32 v32, 0, v10
 v_sub_f32 v33, 0, v10
 v_sub_f32 v34, 0, v10
 v_sub_f32 v35, 0, v10
 v_sub_f32 v36, 0, v10
 v_sub_f32 v37, 0, v10
 v_sub_f32 v38, 0, v10
 v_sub_f32 v39, 0, v10
 v_sub_f32 v40, 0, v10
 v_sub_f32 v41, 0, v10
 v_sub_f32 v42, 0, v10
 v_sub_f32 v43, 0, v10
 v_sub_f32 v44, 0, v10
 v_sub_f32 v45, 0, v10
 v_sub_f32 v46, 0, v10
 v_sub_f32 v47, 0, v10
 v_mov_b32 v10, v9
 s_nop 1
 v_permlane32_swap_b32 v10, v9
 s_nop 1
 v_max_f32 v10, v10, v9
 v_sub_f32 v48, 0, v10
 v_sub_f32 v49, 0, v10
 v_sub_f32 v50, 0, v10
 v_sub_f32 v51, 0, v10
 v_sub_f32 v52, 0, v10
 v_sub_f32 v53, 0, v10
 v_sub_f32 v54, 0, v10
 v_sub_f32 v55, 0, v10
 v_sub_f32 v56, 0, v10
 v_sub_f32 v57, 0, v10
 v_sub_f32 v58, 0, v10
 v_sub_f32 v59, 0, v10
 v_sub_f32 v60, 0, v10
 v_sub_f32 v61, 0, v10
 v_sub_f32 v62, 0, v10
 v_sub_f32 v63, 0, v10
 v_mov_b32 v112, 0
 v_mov_b32 v113, 0
 v_mov_b32 v114, 0
 v_mov_b32 v115, 0
 v_mov_b32 v116, 0
 v_mov_b32 v117, 0
 v_mov_b32 v118, 0
 v_mov_b32 v119, 0
 v_mov_b32 v120, 0
 v_mov_b32 v121, 0
 v_mov_b32 v122, 0
 v_mov_b32 v123, 0
 v_mov_b32 v124, 0
 v_mov_b32 v125, 0
 v_mov_b32 v126, 0
 v_mov_b32 v127, 0
 v_mov_b32 v128, 0
 v_mov_b32 v129, 0
 v_mov_b32 v130, 0
 v_mov_b32 v131, 0
 v_mov_b32 v132, 0
 v_mov_b32 v133, 0
 v_mov_b32 v134, 0
 v_mov_b32 v135, 0
 v_mov_b32 v136, 0
 v_mov_b32 v137, 0
 v_mov_b32 v138, 0
 v_mov_b32 v139, 0
 v_mov_b32 v140, 0
 v_mov_b32 v141, 0
 v_mov_b32 v142, 0
 v_mov_b32 v143, 0
 v_mov_b32 v144, 0
 v_mov_b32 v145, 0
 v_mov_b32 v146, 0
 v_mov_b32 v147, 0
 v_mov_b32 v148, 0
 v_mov_b32 v149, 0
 v_mov_b32 v150, 0
 v_mov_b32 v151, 0
 s_mov_b32 s52, 0
 s_movk_i32 s49, 64
L_a_s2:
 buffer_load_dwordx4 v[156:159], v2, s[96:99], s52 offen offset:0
 buffer_load_dwordx4 v[160:163], v2, s[96:99], s52 offen offset:1024
 buffer_load_dwordx4 v[172:175], v2, s[96:99], s52 offen offset:2048
 buffer_load_dwordx4 v[176:179], v2, s[96:99], s52 offen offset:3072
 s_waitcnt vmcnt(0)
 v_mfma_f32_32x32x16_bf16 v[64:79], v[156:159], v[16:19], v[32:47]
 v_mfma_f32_32x32x16_bf16 v[64:79], v[160:163], v[20:23], v[64:79]
 v_mfma_f32_32x32x16_bf16 v[80:95], v[156:159], v[24:27], v[48:63]
 v_mfma_f32_32x32x16_bf16 v[80:95], v[160:163], v[28:31], v[80:95]
 s_nop 15
 v_exp_f32 v64, v64
 v_exp_f32 v65, v65
 v_exp_f32 v66, v66
 v_exp_f32 v67, v67
 v_exp_f32 v68, v68
 v_exp_f32 v69, v69
 v_exp_f32 v70, v70
 v_exp_f32 v71, v71
 v_exp_f32 v72, v72
 v_exp_f32 v73, v73
 v_exp_f32 v74, v74
 v_exp_f32 v75, v75
 v_exp_f32 v76, v76
 v_exp_f32 v77, v77
 v_exp_f32 v78, v78
 v_exp_f32 v79, v79
 s_nop 0
 v_cvt_pk_bf16_f32 v96, v64, v65
 v_cvt_pk_bf16_f32 v97, v66, v67
 v_cvt_pk_bf16_f32 v98, v68, v69
 v_cvt_pk_bf16_f32 v99, v70, v71
 v_cvt_pk_bf16_f32 v100, v72, v73
 v_cvt_pk_bf16_f32 v101, v74, v75
 v_cvt_pk_bf16_f32 v102, v76, v77
 v_cvt_pk_bf16_f32 v103, v78, v79
 v_exp_f32 v80, v80
 v_exp_f32 v81, v81
 v_exp_f32 v82, v82
 v_exp_f32 v83, v83
 v_exp_f32 v84, v84
 v_exp_f32 v85, v85
 v_exp_f32 v86, v86
 v_exp_f32 v87, v87
 v_exp_f32 v88, v88
 v_exp_f32 v89, v89
 v_exp_f32 v90, v90
 v_exp_f32 v91, v91
 v_exp_f32 v92, v92
 v_exp_f32 v93, v93
 v_exp_f32 v94, v94
 v_exp_f32 v95, v95
 s_nop 0
 v_cvt_pk_bf16_f32 v104, v80, v81
 v_cvt_pk_bf16_f32 v105, v82, v83
 v_cvt_pk_bf16_f32 v106, v84, v85
 v_cvt_pk_bf16_f32 v107, v86, v87
 v_cvt_pk_bf16_f32 v108, v88, v89
 v_cvt_pk_bf16_f32 v109, v90, v91
 v_cvt_pk_bf16_f32 v110, v92, v93
 v_cvt_pk_bf16_f32 v111, v94, v95
 s_nop 1
 v_mfma_f32_32x32x16_bf16 v[112:127], v[172:175], v[96:99], v[112:127]
 v_mfma_f32_16x16x32_bf16 v[144:147], v[152:155], v[96:99], v[144:147]
 v_mfma_f32_32x32x16_bf16 v[112:127], v[176:179], v[100:103], v[112:127]
 v_mfma_f32_16x16x32_bf16 v[144:147], v[152:155], v[100:103], v[144:147]
 v_mfma_f32_32x32x16_bf16 v[128:143], v[172:175], v[104:107], v[128:143]
 v_mfma_f32_16x16x32_bf16 v[148:151], v[152:155], v[104:107], v[148:151]
 v_mfma_f32_32x32x16_bf16 v[128:143], v[176:179], v[108:111], v[128:143]
 v_mfma_f32_16x16x32_bf16 v[148:151], v[152:155], v[108:111], v[148:151]
 s_add_u32 s52, s52, 4096
 s_sub_u32 s49, s49, 1
 s_cmp_lg_u32 s49, 0
 s_cbranch_scc1 L_a_s2
 s_nop 15
 s_branch L_a_done
L_b_gemm:
 s_sub_u32 s90, s2, 256
 s_setprio 2
 s_and_b32 s3, s90, 6
 s_lshl_b32 s3, s3, 1
 s_bfe_u32 s14, s90, 0x20003
 s_add_u32 s3, s3, s14
 s_lshr_b32 s89, s3, 1
 s_lshl_b32 s89, s89, 12
 s_add_u32 s89, s89, 41943040
 s_and_b32 s14, s90, 1
 s_lshl_b32 s14, s14, 3
 s_lshr_b32 s15, s90, 5
 s_add_u32 s14, s14, s15
 s_lshl_b32 s14, s14, 7
 s_lshl_b32 s3, s3, 3
 s_lshl_b32 s15, s48, 1
 s_add_u32 s3, s3, s15
 v_lshrrev_b32 v16, 2, v1
 v_lshlrev_b32 v16, 11, v16
 v_bfe_u32 v17, v1, 4, 1
 v_lshlrev_b32 v17, 1, v17
 v_and_b32 v18, 3, v1
 v_xor_b32 v17, v17, v18
 v_lshl_add_u32 v178, v17, 4, v16
 v_add_u32 v179, 32768, v178
 s_lshl_b32 s87, s48, 16
 s_add_u32 s87, s87, s14
 s_mov_b32 s76, s87
 v_lshlrev_b32 v12, 4, v1
 v_add_u32 v13, 114688, v12
 s_mul_i32 s77, s3, 114688
 s_add_u32 s77, s77, 20971520
 s_mov_b32 s91, s77
 s_bfe_u32 s15, s90, 0x20003
 s_lshl_b32 s15, s15, 1
 s_lshr_b32 s7, s90, 5
 s_add_u32 s78, s15, s7
 s_cmp_ge_u32 s78, 2
 s_cselect_b32 s7, 2, 0
 s_sub_u32 s81, s78, s7
 s_cmp_ge_u32 s81, 2
 s_cselect_b32 s7, 2, 0
 s_sub_u32 s81, s81, s7
 s_cmp_ge_u32 s81, 2
 s_cselect_b32 s7, 2, 0
 s_sub_u32 s81, s81, s7
 s_and_b32 s81, s78, 1
 s_and_b32 s78, s78, 7
 s_mov_b32 s88, s81
 s_sub_u32 s81, 1, s81
 s_mov_b32 s82, 1
 s_lshl_b32 s80, s48, 11
 s_mov_b32 s79, 0
 s_waitcnt lgkmcnt(0)
 s_mov_b32 s40, s4
 s_mov_b32 s41, s5
 s_mov_b32 s42, 0x10000000
 s_mov_b32 s43, 0x20000
 s_mov_b32 s60, s68
 s_mov_b32 s61, s69
 s_mov_b32 s62, 0x700000
 s_mov_b32 s63, 0x20000
 s_lshl_b32 s7, s88, 18
 s_add_u32 s76, s87, s7
 s_add_u32 m0, s80, 0
 s_nop 0
 buffer_load_dwordx4 v178, s[60:63], s76 offen offset:0 lds
 s_add_u32 m0, s80, 8128
 s_nop 0
 buffer_load_dwordx4 v178, s[60:63], s76 offen offset:64 lds
 s_add_u32 m0, s80, 1024
 s_nop 0
 buffer_load_dwordx4 v179, s[60:63], s76 offen offset:0 lds
 s_add_u32 m0, s80, 9152
 s_nop 0
 buffer_load_dwordx4 v179, s[60:63], s76 offen offset:64 lds
 s_add_u32 s80, s80, 16384
 s_and_b32 s80, s80, 65535
 s_lshl_b32 s6, s88, 12
 s_add_u32 s96, s91, s6
 buffer_load_dwordx4 v[32:35], v12, s[40:43], s96 offen offset:0
 buffer_load_dwordx4 v[48:51], v13, s[40:43], s96 offen offset:0
 buffer_load_dwordx4 v[36:39], v12, s[40:43], s96 offen offset:1024
 buffer_load_dwordx4 v[52:55], v13, s[40:43], s96 offen offset:1024
 buffer_load_dwordx4 v[40:43], v12, s[40:43], s96 offen offset:2048
 buffer_load_dwordx4 v[56:59], v13, s[40:43], s96 offen offset:2048
 buffer_load_dwordx4 v[44:47], v12, s[40:43], s96 offen offset:3072
 buffer_load_dwordx4 v[60:63], v13, s[40:43], s96 offen offset:3072
 s_add_u32 s88, s88, 1
 s_sub_u32 s81, s81, 1
 s_cselect_b32 s7, 2, 0
 s_sub_u32 s88, s88, s7
 s_add_u32 s81, s81, s7
 s_sub_u32 s82, s82, 1
 s_cselect_b32 s7, 2, 0
 s_add_u32 s88, s88, s7
 s_add_u32 s82, s82, s7
 s_lshl_b32 s7, s88, 18
 s_add_u32 s76, s87, s7
 s_add_u32 m0, s80, 0
 s_nop 0
 buffer_load_dwordx4 v178, s[60:63], s76 offen offset:0 lds
 s_add_u32 m0, s80, 8128
 s_nop 0
 buffer_load_dwordx4 v178, s[60:63], s76 offen offset:64 lds
 s_add_u32 m0, s80, 1024
 s_nop 0
 buffer_load_dwordx4 v179, s[60:63], s76 offen offset:0 lds
 s_add_u32 m0, s80, 9152
 s_nop 0
 buffer_load_dwordx4 v179, s[60:63], s76 offen offset:64 lds
 s_add_u32 s80, s80, 16384
 s_and_b32 s80, s80, 65535
 s_lshl_b32 s6, s88, 12
 s_add_u32 s97, s91, s6
 buffer_load_dwordx4 v[64:67], v12, s[40:43], s97 offen offset:0
 buffer_load_dwordx4 v[80:83], v13, s[40:43], s97 offen offset:0
 buffer_load_dwordx4 v[68:71], v12, s[40:43], s97 offen offset:1024
 buffer_load_dwordx4 v[84:87], v13, s[40:43], s97 offen offset:1024
 buffer_load_dwordx4 v[72:75], v12, s[40:43], s97 offen offset:2048
 buffer_load_dwordx4 v[88:91], v13, s[40:43], s97 offen offset:2048
 buffer_load_dwordx4 v[76:79], v12, s[40:43], s97 offen offset:3072
 buffer_load_dwordx4 v[92:95], v13, s[40:43], s97 offen offset:3072
 s_add_u32 s88, s88, 1
 s_sub_u32 s81, s81, 1
 s_cselect_b32 s7, 2, 0
 s_sub_u32 s88, s88, s7
 s_add_u32 s81, s81, s7
 s_sub_u32 s82, s82, 1
 s_cselect_b32 s7, 2, 0
 s_add_u32 s88, s88, s7
 s_add_u32 s82, s82, s7
 s_lshl_b32 s7, s88, 18
 s_add_u32 s76, s87, s7
 s_add_u32 m0, s80, 0
 s_nop 0
 buffer_load_dwordx4 v178, s[60:63], s76 offen offset:0 lds
 s_add_u32 m0, s80, 8128
 s_nop 0
 buffer_load_dwordx4 v178, s[60:63], s76 offen offset:64 lds
 s_add_u32 m0, s80, 1024
 s_nop 0
 buffer_load_dwordx4 v179, s[60:63], s76 offen offset:0 lds
 s_add_u32 m0, s80, 9152
 s_nop 0
 buffer_load_dwordx4 v179, s[60:63], s76 offen offset:64 lds
 s_add_u32 s80, s80, 16384
 s_and_b32 s80, s80, 65535
 s_lshl_b32 s6, s88, 12
 s_add_u32 s98, s91, s6
 s_add_u32 s88, s88, 1
 s_sub_u32 s81, s81, 1
 s_cselect_b32 s7, 2, 0
 s_sub_u32 s88, s88, s7
 s_add_u32 s81, s81, s7
 s_sub_u32 s82, s82, 1
 s_cselect_b32 s7, 2, 0
 s_add_u32 s88, s88, s7
 s_add_u32 s82, s82, s7
 s_lshl_b32 s7, s88, 18
 s_add_u32 s76, s87, s7
 s_mov_b32 s64, s56
 s_mov_b32 s65, s57
 s_mov_b32 s66, 0x200000
 s_mov_b32 s67, 0x20000
 s_mov_b32 s72, s70
 s_mov_b32 s73, s71
 s_mov_b32 s74, 0x400000
 s_mov_b32 s75, 0x20000
 s_mov_b32 s68, s58
 s_mov_b32 s69, s59
 s_mov_b32 s70, 0x400000
 s_mov_b32 s71, 0x20000
 v_lshrrev_b32 v19, 4, v1
 v_bfe_u32 v20, v1, 2, 2
 v_and_b32 v21, 1, v19
 v_lshlrev_b32 v22, 3, v18
 v_lshl_add_u32 v22, v21, 5, v22
 v_lshl_add_u32 v22, v20, 6, v22
 v_lshl_add_u32 v4, v19, 8, v22
 v_xor_b32 v5, 32, v4
 v_lshl_add_u32 v22, v21, 8, v22
 v_lshrrev_b32 v23, 1, v19
 v_lshl_add_u32 v8, v23, 10, v22
 v_xor_b32 v9, 32, v8
 v_lshlrev_b32 v14, 4, v1
 v_add_u32 v15, 32768, v14
 s_lshl_b32 s86, s3, 15
 v_and_b32 v22, 15, v1
 v_lshlrev_b32 v22, 11, v22
 s_add_u32 s15, s86, s14
 v_add_u32 v22, s15, v22
 v_lshl_add_u32 v3, v19, 3, v22
 v_lshl_add_u32 v22, v21, 5, v22
 v_lshl_add_u32 v6, v23, 4, v22
 s_add_u32 s86, s86, 37748736
 v_mov_b32 v10, v4
 v_mov_b32 v11, v5
 v_and_b32 v177, 31, v1
 v_lshlrev_b32 v177, 7, v177
 s_mov_b32 s8, 0
 buffer_load_dwordx2 v[160:161], v3, s[68:71], s8 offen offset:0
 buffer_load_dwordx2 v[162:163], v3, s[68:71], s8 offen offset:32
 buffer_load_dwordx2 v[164:165], v3, s[68:71], s8 offen offset:64
 buffer_load_dwordx2 v[166:167], v3, s[68:71], s8 offen offset:96
 s_mov_b32 s8, 32768
 buffer_load_dwordx2 v[168:169], v3, s[68:71], s8 offen offset:0
 buffer_load_dwordx2 v[170:171], v3, s[68:71], s8 offen offset:32
 buffer_load_dwordx2 v[172:173], v3, s[68:71], s8 offen offset:64
 buffer_load_dwordx2 v[174:175], v3, s[68:71], s8 offen offset:96
 v_accvgpr_write_b32 a0, 0
 v_accvgpr_write_b32 a1, 0
 v_accvgpr_write_b32 a2, 0
 v_accvgpr_write_b32 a3, 0
 v_accvgpr_write_b32 a4, 0
 v_accvgpr_write_b32 a5, 0
 v_accvgpr_write_b32 a6, 0
 v_accvgpr_write_b32 a7, 0
 v_accvgpr_write_b32 a8, 0
 v_accvgpr_write_b32 a9, 0
 v_accvgpr_write_b32 a10, 0
 v_accvgpr_write_b32 a11, 0
 v_accvgpr_write_b32 a12, 0
 v_accvgpr_write_b32 a13, 0
 v_accvgpr_write_b32 a14, 0
 v_accvgpr_write_b32 a15, 0
 v_accvgpr_write_b32 a16, 0
 v_accvgpr_write_b32 a17, 0
 v_accvgpr_write_b32 a18, 0
 v_accvgpr_write_b32 a19, 0
 v_accvgpr_write_b32 a20, 0
 v_accvgpr_write_b32 a21, 0
 v_accvgpr_write_b32 a22, 0
 v_accvgpr_write_b32 a23, 0
 v_accvgpr_write_b32 a24, 0
 v_accvgpr_write_b32 a25, 0
 v_accvgpr_write_b32 a26, 0
 v_accvgpr_write_b32 a27, 0
 v_accvgpr_write_b32 a28, 0
 v_accvgpr_write_b32 a29, 0
 v_accvgpr_write_b32 a30, 0
 v_accvgpr_write_b32 a31, 0
 v_accvgpr_write_b32 a32, 0
 v_accvgpr_write_b32 a33, 0
 v_accvgpr_write_b32 a34, 0
 v_accvgpr_write_b32 a35, 0
 v_accvgpr_write_b32 a36, 0
 v_accvgpr_write_b32 a37, 0
 v_accvgpr_write_b32 a38, 0
 v_accvgpr_write_b32 a39, 0
 v_accvgpr_write_b32 a40, 0
 v_accvgpr_write_b32 a41, 0
 v_accvgpr_write_b32 a42, 0
 v_accvgpr_write_b32 a43, 0
 v_accvgpr_write_b32 a44, 0
 v_accvgpr_write_b32 a45, 0
 v_accvgpr_write_b32 a46, 0
 v_accvgpr_write_b32 a47, 0
 v_accvgpr_write_b32 a48, 0
 v_accvgpr_write_b32 a49, 0
 v_accvgpr_write_b32 a50, 0
 v_accvgpr_write_b32 a51, 0
 v_accvgpr_write_b32 a52, 0
 v_accvgpr_write_b32 a53, 0
 v_accvgpr_write_b32 a54, 0
 v_accvgpr_write_b32 a55, 0
 v_accvgpr_write_b32 a56, 0
 v_accvgpr_write_b32 a57, 0
 v_accvgpr_write_b32 a58, 0
 v_accvgpr_write_b32 a59, 0
 v_accvgpr_write_b32 a60, 0
 v_accvgpr_write_b32 a61, 0
 v_accvgpr_write_b32 a62, 0
 v_accvgpr_write_b32 a63, 0
 s_movk_i32 s83, 8
 s_setprio 0
 s_waitcnt vmcnt(32)
 s_barrier
 ds_read_b64_tr_b16 v[128:129], v10 offset:0
 ds_read_b64_tr_b16 v[130:131], v10 offset:1024
 ds_read_b64_tr_b16 v[132:133], v10 offset:2048
 ds_read_b64_tr_b16 v[134:135], v10 offset:3072
 ds_read_b64_tr_b16 v[136:137], v11 offset:0
 ds_read_b64_tr_b16 v[138:139], v11 offset:1024
 ds_read_b64_tr_b16 v[140:141], v11 offset:2048
 ds_read_b64_tr_b16 v[142:143], v11 offset:3072
 ds_read_b64_tr_b16 v[144:145], v10 offset:8192
 ds_read_b64_tr_b16 v[146:147], v10 offset:9216
 ds_read_b64_tr_b16 v[148:149], v10 offset:10240
 ds_read_b64_tr_b16 v[150:151], v10 offset:11264
.p2align 6
L_g_loop:
 s_waitcnt vmcnt(16) lgkmcnt(8)
 s_setprio 1
 v_mfma_f32_16x16x32_bf16 a[0:3], v[128:131], v[32:35], a[0:3]
 s_add_u32 m0, s80, 0
 ds_read_b64_tr_b16 v[152:153], v11 offset:8192
 v_mfma_f32_16x16x32_bf16 a[0:3], v[132:135], v[36:39], a[0:3]
 ds_read_b64_tr_b16 v[154:155], v11 offset:9216
 s_waitcnt vmcnt(6)
 buffer_load_dwordx4 v178, s[60:63], s76 offen offset:0 lds
 v_mfma_f32_16x16x32_bf16 a[4:7], v[132:135], v[52:55], a[4:7]
 s_add_u32 m0, s80, 8128
 ds_read_b64_tr_b16 v[156:157], v11 offset:10240
 buffer_load_dwordx4 v178, s[60:63], s76 offen offset:64 lds
 v_mfma_f32_16x16x32_bf16 a[4:7], v[128:131], v[48:51], a[4:7]
 s_waitcnt lgkmcnt(7)
 ds_read_b64_tr_b16 v[158:159], v11 offset:11264
 s_setprio 0
 v_mfma_f32_16x16x32_bf16 a[8:11], v[136:139], v[32:35], a[8:11]
 s_add_u32 m0, s80, 1024
 ds_read_b64_tr_b16 v[128:129], v10 offset:4096
 v_mfma_f32_16x16x32_bf16 a[8:11], v[140:143], v[36:39], a[8:11]
 ds_read_b64_tr_b16 v[130:131], v10 offset:5120
 s_waitcnt vmcnt(6)
 buffer_load_dwordx4 v179, s[60:63], s76 offen offset:0 lds
 v_mfma_f32_16x16x32_bf16 a[12:15], v[140:143], v[52:55], a[12:15]
 s_add_u32 m0, s80, 9152
 ds_read_b64_tr_b16 v[132:133], v10 offset:6144
 buffer_load_dwordx4 v179, s[60:63], s76 offen offset:64 lds
 v_mfma_f32_16x16x32_bf16 a[12:15], v[136:139], v[48:51], a[12:15]
 s_waitcnt lgkmcnt(7)
 ds_read_b64_tr_b16 v[134:135], v10 offset:7168
 v_mfma_f32_16x16x32_bf16 a[16:19], v[144:147], v[32:35], a[16:19]
 s_add_u32 s80, s80, 16384
 ds_read_b64_tr_b16 v[136:137], v11 offset:4096
 v_mfma_f32_16x16x32_bf16 a[16:19], v[148:151], v[36:39], a[16:19]
 s_and_b32 s80, s80, 65535
 ds_read_b64_tr_b16 v[138:139], v11 offset:5120
 s_waitcnt vmcnt(6)
 buffer_load_dwordx4 v[96:99], v12, s[40:43], s98 offen offset:0
 v_mfma_f32_16x16x32_bf16 a[20:23], v[148:151], v[52:55], a[20:23]
 s_add_u32 s79, s79, 16384
 ds_read_b64_tr_b16 v[140:141], v11 offset:6144
 v_mfma_f32_16x16x32_bf16 a[20:23], v[144:147], v[48:51], a[20:23]
 s_waitcnt lgkmcnt(7)
 ds_read_b64_tr_b16 v[142:143], v11 offset:7168
 v_mfma_f32_16x16x32_bf16 a[24:27], v[152:155], v[32:35], a[24:27]
 s_and_b32 s79, s79, 65535
 ds_read_b64_tr_b16 v[144:145], v10 offset:12288
 s_waitcnt vmcnt(6)
 buffer_load_dwordx4 v[112:115], v13, s[40:43], s98 offen offset:0
 v_mfma_f32_16x16x32_bf16 a[24:27], v[156:159], v[36:39], a[24:27]
 s_lshl_b32 s6, s88, 12
 ds_read_b64_tr_b16 v[146:147], v10 offset:13312
 v_mfma_f32_16x16x32_bf16 a[28:31], v[156:159], v[52:55], a[28:31]
 s_add_u32 s96, s91, s6
 ds_read_b64_tr_b16 v[148:149], v10 offset:14336
 v_mfma_f32_16x16x32_bf16 a[28:31], v[152:155], v[48:51], a[28:31]
 s_waitcnt vmcnt(18) lgkmcnt(7)
 ds_read_b64_tr_b16 v[150:151], v10 offset:15360
 s_setprio 1
 v_mfma_f32_16x16x32_bf16 a[0:3], v[128:131], v[40:43], a[0:3]
 s_add_u32 s88, s88, 1
 ds_read_b64_tr_b16 v[152:153], v11 offset:12288
 s_waitcnt vmcnt(6)
 buffer_load_dwordx4 v[100:103], v12, s[40:43], s98 offen offset:1024
 v_mfma_f32_16x16x32_bf16 a[0:3], v[132:135], v[44:47], a[0:3]
 s_sub_u32 s81, s81, 1
 ds_read_b64_tr_b16 v[154:155], v11 offset:13312
 v_mfma_f32_16x16x32_bf16 a[4:7], v[132:135], v[60:63], a[4:7]
 s_cselect_b32 s7, 2, 0
 ds_read_b64_tr_b16 v[156:157], v11 offset:14336
 v_mfma_f32_16x16x32_bf16 a[4:7], v[128:131], v[56:59], a[4:7]
 s_waitcnt lgkmcnt(7)
 ds_read_b64_tr_b16 v[158:159], v11 offset:15360
 s_setprio 0
 v_mfma_f32_16x16x32_bf16 a[8:11], v[136:139], v[40:43], a[8:11]
 s_sub_u32 s88, s88, s7
 s_waitcnt vmcnt(6)
 buffer_load_dwordx4 v[116:119], v13, s[40:43], s98 offen offset:1024
 v_mfma_f32_16x16x32_bf16 a[8:11], v[140:143], v[44:47], a[8:11]
 s_add_u32 s81, s81, s7
 s_waitcnt vmcnt(6)
 buffer_load_dwordx4 v[104:107], v12, s[40:43], s98 offen offset:2048
 v_mfma_f32_16x16x32_bf16 a[12:15], v[140:143], v[60:63], a[12:15]
 s_sub_u32 s82, s82, 1
 s_waitcnt vmcnt(6)
 buffer_load_dwordx4 v[120:123], v13, s[40:43], s98 offen offset:2048
 v_mfma_f32_16x16x32_bf16 a[12:15], v[136:139], v[56:59], a[12:15]
 s_waitcnt vmcnt(30) lgkmcnt(0)
 s_barrier
 v_add_u32 v10, s79, v4
 v_add_u32 v11, s79, v5
 v_mfma_f32_16x16x32_bf16 a[16:19], v[144:147], v[40:43], a[16:19]
 s_cselect_b32 s7, 2, 0
 ds_read_b64_tr_b16 v[128:129], v10 offset:0
 ds_read_b64_tr_b16 v[130:131], v10 offset:1024
 v_mfma_f32_16x16x32_bf16 a[16:19], v[148:151], v[44:47], a[16:19]
 s_add_u32 s88, s88, s7
 ds_read_b64_tr_b16 v[132:133], v10 offset:2048
 ds_read_b64_tr_b16 v[134:135], v10 offset:3072
 v_mfma_f32_16x16x32_bf16 a[20:23], v[148:151], v[60:63], a[20:23]
 s_add_u32 s82, s82, s7
 ds_read_b64_tr_b16 v[136:137], v11 offset:0
 ds_read_b64_tr_b16 v[138:139], v11 offset:1024
 v_mfma_f32_16x16x32_bf16 a[20:23], v[144:147], v[56:59], a[20:23]
 s_waitcnt lgkmcnt(6)
 ds_read_b64_tr_b16 v[140:141], v11 offset:2048
 ds_read_b64_tr_b16 v[142:143], v11 offset:3072
 v_mfma_f32_16x16x32_bf16 a[24:27], v[152:155], v[40:43], a[24:27]
 s_lshl_b32 s7, s88, 18
 ds_read_b64_tr_b16 v[144:145], v10 offset:8192
 v_mfma_f32_16x16x32_bf16 a[24:27], v[156:159], v[44:47], a[24:27]
 s_add_u32 s76, s87, s7
 ds_read_b64_tr_b16 v[146:147], v10 offset:9216
 s_waitcnt vmcnt(6)
 buffer_load_dwordx4 v[108:111], v12, s[40:43], s98 offen offset:3072
 v_mfma_f32_16x16x32_bf16 a[28:31], v[156:159], v[60:63], a[28:31]
 ds_read_b64_tr_b16 v[148:149], v10 offset:10240
 s_waitcnt vmcnt(6)
 buffer_load_dwordx4 v[124:127], v13, s[40:43], s98 offen offset:3072
 v_mfma_f32_16x16x32_bf16 a[28:31], v[152:155], v[56:59], a[28:31]
 ds_read_b64_tr_b16 v[150:151], v10 offset:11264
 s_waitcnt vmcnt(16) lgkmcnt(8)
 v_mfma_f32_16x16x32_bf16 a[0:3], v[128:131], v[64:67], a[0:3]
 s_add_u32 m0, s80, 0
 ds_read_b64_tr_b16 v[152:153], v11 offset:8192
 v_mfma_f32_16x16x32_bf16 a[0:3], v[132:135], v[68:71], a[0:3]
 ds_read_b64_tr_b16 v[154:155], v11 offset:9216
 s_waitcnt vmcnt(6)
 buffer_load_dwordx4 v178, s[60:63], s76 offen offset:0 lds
 v_mfma_f32_16x16x32_bf16 a[4:7], v[132:135], v[84:87], a[4:7]
 s_add_u32 m0, s80, 8128
 ds_read_b64_tr_b16 v[156:157], v11 offset:10240
 buffer_load_dwordx4 v178, s[60:63], s76 offen offset:64 lds
 v_mfma_f32_16x16x32_bf16 a[4:7], v[128:131], v[80:83], a[4:7]
 s_waitcnt lgkmcnt(7)
 ds_read_b64_tr_b16 v[158:159], v11 offset:11264
 s_setprio 1
 v_mfma_f32_16x16x32_bf16 a[8:11], v[136:139], v[64:67], a[8:11]
 s_add_u32 m0, s80, 1024
 ds_read_b64_tr_b16 v[128:129], v10 offset:4096
 v_mfma_f32_16x16x32_bf16 a[8:11], v[140:143], v[68:71], a[8:11]
 ds_read_b64_tr_b16 v[130:131], v10 offset:5120
 s_waitcnt vmcnt(6)
 buffer_load_dwordx4 v179, s[60:63], s76 offen offset:0 lds
 v_mfma_f32_16x16x32_bf16 a[12:15], v[140:143], v[84:87], a[12:15]
 s_add_u32 m0, s80, 9152
 ds_read_b64_tr_b16 v[132:133], v10 offset:6144
 buffer_load_dwordx4 v179, s[60:63], s76 offen offset:64 lds
 v_mfma_f32_16x16x32_bf16 a[12:15], v[136:139], v[80:83], a[12:15]
 s_waitcnt lgkmcnt(7)
 ds_read_b64_tr_b16 v[134:135], v10 offset:7168
 s_setprio 0
 v_mfma_f32_16x16x32_bf16 a[16:19], v[144:147], v[64:67], a[16:19]
 s_add_u32 s80, s80, 16384
 ds_read_b64_tr_b16 v[136:137], v11 offset:4096
 v_mfma_f32_16x16x32_bf16 a[16:19], v[148:151], v[68:71], a[16:19]
 s_and_b32 s80, s80, 65535
 ds_read_b64_tr_b16 v[138:139], v11 offset:5120
 s_waitcnt vmcnt(6)
 buffer_load_dwordx4 v[32:35], v12, s[40:43], s96 offen offset:0
 v_mfma_f32_16x16x32_bf16 a[20:23], v[148:151], v[84:87], a[20:23]
 s_add_u32 s79, s79, 16384
 ds_read_b64_tr_b16 v[140:141], v11 offset:6144
 v_mfma_f32_16x16x32_bf16 a[20:23], v[144:147], v[80:83], a[20:23]
 s_waitcnt lgkmcnt(7)
 ds_read_b64_tr_b16 v[142:143], v11 offset:7168
 v_mfma_f32_16x16x32_bf16 a[24:27], v[152:155], v[64:67], a[24:27]
 s_and_b32 s79, s79, 65535
 ds_read_b64_tr_b16 v[144:145], v10 offset:12288
 s_waitcnt vmcnt(6)
 buffer_load_dwordx4 v[48:51], v13, s[40:43], s96 offen offset:0
 v_mfma_f32_16x16x32_bf16 a[24:27], v[156:159], v[68:71], a[24:27]
 s_lshl_b32 s6, s88, 12
 ds_read_b64_tr_b16 v[146:147], v10 offset:13312
 v_mfma_f32_16x16x32_bf16 a[28:31], v[156:159], v[84:87], a[28:31]
 s_add_u32 s97, s91, s6
 ds_read_b64_tr_b16 v[148:149], v10 offset:14336
 v_mfma_f32_16x16x32_bf16 a[28:31], v[152:155], v[80:83], a[28:31]
 s_waitcnt vmcnt(18) lgkmcnt(7)
 ds_read_b64_tr_b16 v[150:151], v10 offset:15360
 v_mfma_f32_16x16x32_bf16 a[0:3], v[128:131], v[72:75], a[0:3]
 s_add_u32 s88, s88, 1
 ds_read_b64_tr_b16 v[152:153], v11 offset:12288
 s_waitcnt vmcnt(6)
 buffer_load_dwordx4 v[36:39], v12, s[40:43], s96 offen offset:1024
 v_mfma_f32_16x16x32_bf16 a[0:3], v[132:135], v[76:79], a[0:3]
 s_sub_u32 s81, s81, 1
 ds_read_b64_tr_b16 v[154:155], v11 offset:13312
 v_mfma_f32_16x16x32_bf16 a[4:7], v[132:135], v[92:95], a[4:7]
 s_cselect_b32 s7, 2, 0
 ds_read_b64_tr_b16 v[156:157], v11 offset:14336
 v_mfma_f32_16x16x32_bf16 a[4:7], v[128:131], v[88:91], a[4:7]
 s_waitcnt lgkmcnt(7)
 ds_read_b64_tr_b16 v[158:159], v11 offset:15360
 v_mfma_f32_16x16x32_bf16 a[8:11], v[136:139], v[72:75], a[8:11]
 s_sub_u32 s88, s88, s7
 s_waitcnt vmcnt(6)
 buffer_load_dwordx4 v[52:55], v13, s[40:43], s96 offen offset:1024
 v_mfma_f32_16x16x32_bf16 a[8:11], v[140:143], v[76:79], a[8:11]
 s_add_u32 s81, s81, s7
 s_waitcnt vmcnt(6)
 buffer_load_dwordx4 v[40:43], v12, s[40:43], s96 offen offset:2048
 v_mfma_f32_16x16x32_bf16 a[12:15], v[140:143], v[92:95], a[12:15]
 s_sub_u32 s82, s82, 1
 s_waitcnt vmcnt(6)
 buffer_load_dwordx4 v[56:59], v13, s[40:43], s96 offen offset:2048
 v_mfma_f32_16x16x32_bf16 a[12:15], v[136:139], v[88:91], a[12:15]
 s_waitcnt vmcnt(30) lgkmcnt(0)
 s_barrier
 v_add_u32 v10, s79, v4
 v_add_u32 v11, s79, v5
 s_setprio 1
 v_mfma_f32_16x16x32_bf16 a[16:19], v[144:147], v[72:75], a[16:19]
 s_cselect_b32 s7, 2, 0
 ds_read_b64_tr_b16 v[128:129], v10 offset:0
 ds_read_b64_tr_b16 v[130:131], v10 offset:1024
 v_mfma_f32_16x16x32_bf16 a[16:19], v[148:151], v[76:79], a[16:19]
 s_add_u32 s88, s88, s7
 ds_read_b64_tr_b16 v[132:133], v10 offset:2048
 ds_read_b64_tr_b16 v[134:135], v10 offset:3072
 v_mfma_f32_16x16x32_bf16 a[20:23], v[148:151], v[92:95], a[20:23]
 s_add_u32 s82, s82, s7
 ds_read_b64_tr_b16 v[136:137], v11 offset:0
 ds_read_b64_tr_b16 v[138:139], v11 offset:1024
 v_mfma_f32_16x16x32_bf16 a[20:23], v[144:147], v[88:91], a[20:23]
 s_waitcnt lgkmcnt(6)
 ds_read_b64_tr_b16 v[140:141], v11 offset:2048
 ds_read_b64_tr_b16 v[142:143], v11 offset:3072
 s_setprio 0
 v_mfma_f32_16x16x32_bf16 a[24:27], v[152:155], v[72:75], a[24:27]
 s_lshl_b32 s7, s88, 18
 ds_read_b64_tr_b16 v[144:145], v10 offset:8192
 v_mfma_f32_16x16x32_bf16 a[24:27], v[156:159], v[76:79], a[24:27]
 s_add_u32 s76, s87, s7
 ds_read_b64_tr_b16 v[146:147], v10 offset:9216
 s_waitcnt vmcnt(6)
 buffer_load_dwordx4 v[44:47], v12, s[40:43], s96 offen offset:3072
 v_mfma_f32_16x16x32_bf16 a[28:31], v[156:159], v[92:95], a[28:31]
 ds_read_b64_tr_b16 v[148:149], v10 offset:10240
 s_waitcnt vmcnt(6)
 buffer_load_dwordx4 v[60:63], v13, s[40:43], s96 offen offset:3072
 v_mfma_f32_16x16x32_bf16 a[28:31], v[152:155], v[88:91], a[28:31]
 ds_read_b64_tr_b16 v[150:151], v10 offset:11264
 s_waitcnt vmcnt(16) lgkmcnt(8)
 v_mfma_f32_16x16x32_bf16 a[0:3], v[128:131], v[96:99], a[0:3]
 s_add_u32 m0, s80, 0
 ds_read_b64_tr_b16 v[152:153], v11 offset:8192
 v_mfma_f32_16x16x32_bf16 a[0:3], v[132:135], v[100:103], a[0:3]
 ds_read_b64_tr_b16 v[154:155], v11 offset:9216
 s_waitcnt vmcnt(6)
 buffer_load_dwordx4 v178, s[60:63], s76 offen offset:0 lds
 v_mfma_f32_16x16x32_bf16 a[4:7], v[132:135], v[116:119], a[4:7]
 s_add_u32 m0, s80, 8128
 ds_read_b64_tr_b16 v[156:157], v11 offset:10240
 buffer_load_dwordx4 v178, s[60:63], s76 offen offset:64 lds
 v_mfma_f32_16x16x32_bf16 a[4:7], v[128:131], v[112:115], a[4:7]
 s_waitcnt lgkmcnt(7)
 ds_read_b64_tr_b16 v[158:159], v11 offset:11264
 v_mfma_f32_16x16x32_bf16 a[8:11], v[136:139], v[96:99], a[8:11]
 s_add_u32 m0, s80, 1024
 ds_read_b64_tr_b16 v[128:129], v10 offset:4096
 v_mfma_f32_16x16x32_bf16 a[8:11], v[140:143], v[100:103], a[8:11]
 ds_read_b64_tr_b16 v[130:131], v10 offset:5120
 s_waitcnt vmcnt(6)
 buffer_load_dwordx4 v179, s[60:63], s76 offen offset:0 lds
 v_mfma_f32_16x16x32_bf16 a[12:15], v[140:143], v[116:119], a[12:15]
 s_add_u32 m0, s80, 9152
 ds_read_b64_tr_b16 v[132:133], v10 offset:6144
 buffer_load_dwordx4 v179, s[60:63], s76 offen offset:64 lds
 v_mfma_f32_16x16x32_bf16 a[12:15], v[136:139], v[112:115], a[12:15]
 s_waitcnt lgkmcnt(7)
 ds_read_b64_tr_b16 v[134:135], v10 offset:7168
 v_mfma_f32_16x16x32_bf16 a[16:19], v[144:147], v[96:99], a[16:19]
 s_add_u32 s80, s80, 16384
 ds_read_b64_tr_b16 v[136:137], v11 offset:4096
 v_mfma_f32_16x16x32_bf16 a[16:19], v[148:151], v[100:103], a[16:19]
 s_and_b32 s80, s80, 65535
 ds_read_b64_tr_b16 v[138:139], v11 offset:5120
 s_waitcnt vmcnt(6)
 buffer_load_dwordx4 v[64:67], v12, s[40:43], s97 offen offset:0
 v_mfma_f32_16x16x32_bf16 a[20:23], v[148:151], v[116:119], a[20:23]
 s_add_u32 s79, s79, 16384
 ds_read_b64_tr_b16 v[140:141], v11 offset:6144
 v_mfma_f32_16x16x32_bf16 a[20:23], v[144:147], v[112:115], a[20:23]
 s_waitcnt lgkmcnt(7)
 ds_read_b64_tr_b16 v[142:143], v11 offset:7168
 s_setprio 1
 v_mfma_f32_16x16x32_bf16 a[24:27], v[152:155], v[96:99], a[24:27]
 s_and_b32 s79, s79, 65535
 ds_read_b64_tr_b16 v[144:145], v10 offset:12288
 s_waitcnt vmcnt(6)
 buffer_load_dwordx4 v[80:83], v13, s[40:43], s97 offen offset:0
 v_mfma_f32_16x16x32_bf16 a[24:27], v[156:159], v[100:103], a[24:27]
 s_lshl_b32 s6, s88, 12
 ds_read_b64_tr_b16 v[146:147], v10 offset:13312
 v_mfma_f32_16x16x32_bf16 a[28:31], v[156:159], v[116:119], a[28:31]
 s_add_u32 s98, s91, s6
 ds_read_b64_tr_b16 v[148:149], v10 offset:14336
 v_mfma_f32_16x16x32_bf16 a[28:31], v[152:155], v[112:115], a[28:31]
 s_waitcnt vmcnt(18) lgkmcnt(7)
 ds_read_b64_tr_b16 v[150:151], v10 offset:15360
 s_setprio 0
 v_mfma_f32_16x16x32_bf16 a[0:3], v[128:131], v[104:107], a[0:3]
 s_add_u32 s88, s88, 1
 ds_read_b64_tr_b16 v[152:153], v11 offset:12288
 s_waitcnt vmcnt(6)
 buffer_load_dwordx4 v[68:71], v12, s[40:43], s97 offen offset:1024
 v_mfma_f32_16x16x32_bf16 a[0:3], v[132:135], v[108:111], a[0:3]
 s_sub_u32 s81, s81, 1
 ds_read_b64_tr_b16 v[154:155], v11 offset:13312
 v_mfma_f32_16x16x32_bf16 a[4:7], v[132:135], v[124:127], a[4:7]
 s_cselect_b32 s7, 2, 0
 ds_read_b64_tr_b16 v[156:157], v11 offset:14336
 v_mfma_f32_16x16x32_bf16 a[4:7], v[128:131], v[120:123], a[4:7]
 s_waitcnt lgkmcnt(7)
 ds_read_b64_tr_b16 v[158:159], v11 offset:15360
 v_mfma_f32_16x16x32_bf16 a[8:11], v[136:139], v[104:107], a[8:11]
 s_sub_u32 s88, s88, s7
 s_waitcnt vmcnt(6)
 buffer_load_dwordx4 v[84:87], v13, s[40:43], s97 offen offset:1024
 v_mfma_f32_16x16x32_bf16 a[8:11], v[140:143], v[108:111], a[8:11]
 s_add_u32 s81, s81, s7
 s_waitcnt vmcnt(6)
 buffer_load_dwordx4 v[72:75], v12, s[40:43], s97 offen offset:2048
 v_mfma_f32_16x16x32_bf16 a[12:15], v[140:143], v[124:127], a[12:15]
 s_sub_u32 s82, s82, 1
 s_waitcnt vmcnt(6)
 buffer_load_dwordx4 v[88:91], v13, s[40:43], s97 offen offset:2048
 v_mfma_f32_16x16x32_bf16 a[12:15], v[136:139], v[120:123], a[12:15]
 s_waitcnt vmcnt(30) lgkmcnt(0)
 s_barrier
 v_add_u32 v10, s79, v4
 v_add_u32 v11, s79, v5
 v_mfma_f32_16x16x32_bf16 a[16:19], v[144:147], v[104:107], a[16:19]
 s_cselect_b32 s7, 2, 0
 ds_read_b64_tr_b16 v[128:129], v10 offset:0
 ds_read_b64_tr_b16 v[130:131], v10 offset:1024
 v_mfma_f32_16x16x32_bf16 a[16:19], v[148:151], v[108:111], a[16:19]
 s_add_u32 s88, s88, s7
 ds_read_b64_tr_b16 v[132:133], v10 offset:2048
 ds_read_b64_tr_b16 v[134:135], v10 offset:3072
 v_mfma_f32_16x16x32_bf16 a[20:23], v[148:151], v[124:127], a[20:23]
 s_add_u32 s82, s82, s7
 ds_read_b64_tr_b16 v[136:137], v11 offset:0
 ds_read_b64_tr_b16 v[138:139], v11 offset:1024
 v_mfma_f32_16x16x32_bf16 a[20:23], v[144:147], v[120:123], a[20:23]
 s_waitcnt lgkmcnt(6)
 ds_read_b64_tr_b16 v[140:141], v11 offset:2048
 ds_read_b64_tr_b16 v[142:143], v11 offset:3072
 v_mfma_f32_16x16x32_bf16 a[24:27], v[152:155], v[104:107], a[24:27]
 s_lshl_b32 s7, s88, 18
 ds_read_b64_tr_b16 v[144:145], v10 offset:8192
 v_mfma_f32_16x16x32_bf16 a[24:27], v[156:159], v[108:111], a[24:27]
 s_add_u32 s76, s87, s7
 ds_read_b64_tr_b16 v[146:147], v10 offset:9216
 s_waitcnt vmcnt(6)
 buffer_load_dwordx4 v[76:79], v12, s[40:43], s97 offen offset:3072
 v_mfma_f32_16x16x32_bf16 a[28:31], v[156:159], v[124:127], a[28:31]
 ds_read_b64_tr_b16 v[148:149], v10 offset:10240
 s_waitcnt vmcnt(6)
 buffer_load_dwordx4 v[92:95], v13, s[40:43], s97 offen offset:3072
 v_mfma_f32_16x16x32_bf16 a[28:31], v[152:155], v[120:123], a[28:31]
 ds_read_b64_tr_b16 v[150:151], v10 offset:11264
 s_sub_u32 s83, s83, 1
 s_cmp_eq_u32 s83, 0
 s_cbranch_scc0 L_g_loop
L_g_tail:
 s_waitcnt vmcnt(16) lgkmcnt(8)
 v_mfma_f32_16x16x32_bf16 a[0:3], v[128:131], v[32:35], a[0:3]
 s_add_u32 m0, s80, 0
 ds_read_b64_tr_b16 v[152:153], v11 offset:8192
 v_mfma_f32_16x16x32_bf16 a[0:3], v[132:135], v[36:39], a[0:3]
 ds_read_b64_tr_b16 v[154:155], v11 offset:9216
 buffer_load_dwordx4 v178, s[60:63], s76 offen offset:0 lds
 v_mfma_f32_16x16x32_bf16 a[4:7], v[132:135], v[52:55], a[4:7]
 s_add_u32 m0, s80, 8128
 ds_read_b64_tr_b16 v[156:157], v11 offset:10240
 buffer_load_dwordx4 v178, s[60:63], s76 offen offset:64 lds
 v_mfma_f32_16x16x32_bf16 a[4:7], v[128:131], v[48:51], a[4:7]
 s_waitcnt lgkmcnt(7)
 ds_read_b64_tr_b16 v[158:159], v11 offset:11264
 v_mfma_f32_16x16x32_bf16 a[8:11], v[136:139], v[32:35], a[8:11]
 s_add_u32 m0, s80, 1024
 ds_read_b64_tr_b16 v[128:129], v10 offset:4096
 v_mfma_f32_16x16x32_bf16 a[8:11], v[140:143], v[36:39], a[8:11]
 ds_read_b64_tr_b16 v[130:131], v10 offset:5120
 buffer_load_dwordx4 v179, s[60:63], s76 offen offset:0 lds
 v_mfma_f32_16x16x32_bf16 a[12:15], v[140:143], v[52:55], a[12:15]
 s_add_u32 m0, s80, 9152
 ds_read_b64_tr_b16 v[132:133], v10 offset:6144
 buffer_load_dwordx4 v179, s[60:63], s76 offen offset:64 lds
 v_mfma_f32_16x16x32_bf16 a[12:15], v[136:139], v[48:51], a[12:15]
 s_waitcnt lgkmcnt(7)
 ds_read_b64_tr_b16 v[134:135], v10 offset:7168
 v_mfma_f32_16x16x32_bf16 a[16:19], v[144:147], v[32:35], a[16:19]
 s_add_u32 s80, s80, 16384
 ds_read_b64_tr_b16 v[136:137], v11 offset:4096
 v_mfma_f32_16x16x32_bf16 a[16:19], v[148:151], v[36:39], a[16:19]
 s_and_b32 s80, s80, 65535
 ds_read_b64_tr_b16 v[138:139], v11 offset:5120
 buffer_load_dwordx4 v[96:99], v12, s[40:43], s98 offen offset:0
 v_mfma_f32_16x16x32_bf16 a[20:23], v[148:151], v[52:55], a[20:23]
 s_add_u32 s79, s79, 16384
 ds_read_b64_tr_b16 v[140:141], v11 offset:6144
 v_mfma_f32_16x16x32_bf16 a[20:23], v[144:147], v[48:51], a[20:23]
 s_waitcnt lgkmcnt(7)
 ds_read_b64_tr_b16 v[142:143], v11 offset:7168
 v_mfma_f32_16x16x32_bf16 a[24:27], v[152:155], v[32:35], a[24:27]
 s_and_b32 s79, s79, 65535
 ds_read_b64_tr_b16 v[144:145], v10 offset:12288
 buffer_load_dwordx4 v[112:115], v13, s[40:43], s98 offen offset:0
 v_mfma_f32_16x16x32_bf16 a[24:27], v[156:159], v[36:39], a[24:27]
 s_lshl_b32 s6, s88, 12
 ds_read_b64_tr_b16 v[146:147], v10 offset:13312
 v_mfma_f32_16x16x32_bf16 a[28:31], v[156:159], v[52:55], a[28:31]
 s_add_u32 s96, s91, s6
 ds_read_b64_tr_b16 v[148:149], v10 offset:14336
 v_mfma_f32_16x16x32_bf16 a[28:31], v[152:155], v[48:51], a[28:31]
 s_waitcnt vmcnt(18) lgkmcnt(7)
 ds_read_b64_tr_b16 v[150:151], v10 offset:15360
 v_mfma_f32_16x16x32_bf16 a[0:3], v[128:131], v[40:43], a[0:3]
 s_mov_b32 s88, s78
 ds_read_b64_tr_b16 v[152:153], v11 offset:12288
 buffer_load_dwordx4 v[100:103], v12, s[40:43], s98 offen offset:1024
 v_mfma_f32_16x16x32_bf16 a[0:3], v[132:135], v[44:47], a[0:3]
 s_mov_b32 s91, s86
 ds_read_b64_tr_b16 v[154:155], v11 offset:13312
 v_mfma_f32_16x16x32_bf16 a[4:7], v[132:135], v[60:63], a[4:7]
 s_lshl_b32 s7, s88, 18
 ds_read_b64_tr_b16 v[156:157], v11 offset:14336
 v_mfma_f32_16x16x32_bf16 a[4:7], v[128:131], v[56:59], a[4:7]
 s_waitcnt lgkmcnt(7)
 ds_read_b64_tr_b16 v[158:159], v11 offset:15360
 v_mfma_f32_16x16x32_bf16 a[8:11], v[136:139], v[40:43], a[8:11]
 s_add_u32 s76, s87, s7
 buffer_load_dwordx4 v[116:119], v13, s[40:43], s98 offen offset:1024
 v_mfma_f32_16x16x32_bf16 a[8:11], v[140:143], v[44:47], a[8:11]
 buffer_load_dwordx4 v[104:107], v12, s[40:43], s98 offen offset:2048
 v_mfma_f32_16x16x32_bf16 a[12:15], v[140:143], v[60:63], a[12:15]
 buffer_load_dwordx4 v[120:123], v13, s[40:43], s98 offen offset:2048
 v_mfma_f32_16x16x32_bf16 a[12:15], v[136:139], v[56:59], a[12:15]
 s_waitcnt vmcnt(30) lgkmcnt(0)
 s_barrier
 v_add_u32 v10, s79, v4
 v_add_u32 v11, s79, v5
 v_mfma_f32_16x16x32_bf16 a[16:19], v[144:147], v[40:43], a[16:19]
 ds_read_b64_tr_b16 v[128:129], v10 offset:0
 ds_read_b64_tr_b16 v[130:131], v10 offset:1024
 v_mfma_f32_16x16x32_bf16 a[16:19], v[148:151], v[44:47], a[16:19]
 ds_read_b64_tr_b16 v[132:133], v10 offset:2048
 ds_read_b64_tr_b16 v[134:135], v10 offset:3072
 v_mfma_f32_16x16x32_bf16 a[20:23], v[148:151], v[60:63], a[20:23]
 ds_read_b64_tr_b16 v[136:137], v11 offset:0
 ds_read_b64_tr_b16 v[138:139], v11 offset:1024
 v_mfma_f32_16x16x32_bf16 a[20:23], v[144:147], v[56:59], a[20:23]
 s_waitcnt lgkmcnt(6)
 ds_read_b64_tr_b16 v[140:141], v11 offset:2048
 ds_read_b64_tr_b16 v[142:143], v11 offset:3072
 v_mfma_f32_16x16x32_bf16 a[24:27], v[152:155], v[40:43], a[24:27]
 ds_read_b64_tr_b16 v[144:145], v10 offset:8192
 v_mfma_f32_16x16x32_bf16 a[24:27], v[156:159], v[44:47], a[24:27]
 ds_read_b64_tr_b16 v[146:147], v10 offset:9216
 buffer_load_dwordx4 v[108:111], v12, s[40:43], s98 offen offset:3072
 v_mfma_f32_16x16x32_bf16 a[28:31], v[156:159], v[60:63], a[28:31]
 ds_read_b64_tr_b16 v[148:149], v10 offset:10240
 buffer_load_dwordx4 v[124:127], v13, s[40:43], s98 offen offset:3072
 v_mfma_f32_16x16x32_bf16 a[28:31], v[152:155], v[56:59], a[28:31]
 ds_read_b64_tr_b16 v[150:151], v10 offset:11264
 s_waitcnt vmcnt(16) lgkmcnt(8)
 s_mov_b32 s4, 0xbfb8aa3b
 s_mov_b32 s5, 0xffff0000
 v_mfma_f32_16x16x32_bf16 a[0:3], v[128:131], v[64:67], a[0:3]
 s_add_u32 m0, s80, 0
 ds_read_b64_tr_b16 v[152:153], v11 offset:8192
 v_mfma_f32_16x16x32_bf16 a[0:3], v[132:135], v[68:71], a[0:3]
 ds_read_b64_tr_b16 v[154:155], v11 offset:9216
 buffer_load_dwordx4 v178, s[64:67], s76 offen offset:0 lds
 v_mfma_f32_16x16x32_bf16 a[4:7], v[132:135], v[84:87], a[4:7]
 s_add_u32 m0, s80, 8128
 ds_read_b64_tr_b16 v[156:157], v11 offset:10240
 buffer_load_dwordx4 v178, s[64:67], s76 offen offset:64 lds
 v_mfma_f32_16x16x32_bf16 a[4:7], v[128:131], v[80:83], a[4:7]
 s_waitcnt lgkmcnt(7)
 ds_read_b64_tr_b16 v[158:159], v11 offset:11264
 v_mfma_f32_16x16x32_bf16 a[8:11], v[136:139], v[64:67], a[8:11]
 s_add_u32 m0, s80, 1024
 ds_read_b64_tr_b16 v[128:129], v10 offset:4096
 v_mfma_f32_16x16x32_bf16 a[8:11], v[140:143], v[68:71], a[8:11]
 ds_read_b64_tr_b16 v[130:131], v10 offset:5120
 buffer_load_dwordx4 v179, s[64:67], s76 offen offset:0 lds
 v_mfma_f32_16x16x32_bf16 a[12:15], v[140:143], v[84:87], a[12:15]
 s_add_u32 m0, s80, 9152
 ds_read_b64_tr_b16 v[132:133], v10 offset:6144
 buffer_load_dwordx4 v179, s[64:67], s76 offen offset:64 lds
 v_mfma_f32_16x16x32_bf16 a[12:15], v[136:139], v[80:83], a[12:15]
 s_waitcnt lgkmcnt(7)
 ds_read_b64_tr_b16 v[134:135], v10 offset:7168
 v_mfma_f32_16x16x32_bf16 a[16:19], v[144:147], v[64:67], a[16:19]
 s_add_u32 s80, s80, 16384
 ds_read_b64_tr_b16 v[136:137], v11 offset:4096
 s_cmp_lg_u32 s48, 0
 s_cbranch_scc1 L_g_np
 buffer_load_dword v176, v177, s[40:43], s89 offen sc1
L_g_np:
 v_mfma_f32_16x16x32_bf16 a[16:19], v[148:151], v[68:71], a[16:19]
 s_and_b32 s80, s80, 65535
 ds_read_b64_tr_b16 v[138:139], v11 offset:5120
 buffer_load_dwordx4 v[32:35], v12, s[40:43], s96 offen offset:0
 v_mfma_f32_16x16x32_bf16 a[20:23], v[148:151], v[84:87], a[20:23]
 s_add_u32 s79, s79, 16384
 ds_read_b64_tr_b16 v[140:141], v11 offset:6144
 v_mfma_f32_16x16x32_bf16 a[20:23], v[144:147], v[80:83], a[20:23]
 s_waitcnt lgkmcnt(7)
 ds_read_b64_tr_b16 v[142:143], v11 offset:7168
 v_mfma_f32_16x16x32_bf16 a[24:27], v[152:155], v[64:67], a[24:27]
 s_and_b32 s79, s79, 65535
 ds_read_b64_tr_b16 v[144:145], v10 offset:12288
 buffer_load_dwordx4 v[48:51], v13, s[40:43], s96 offen offset:0
 v_mfma_f32_16x16x32_bf16 a[24:27], v[156:159], v[68:71], a[24:27]
 s_lshl_b32 s6, s88, 12
 ds_read_b64_tr_b16 v[146:147], v10 offset:13312
 v_mfma_f32_16x16x32_bf16 a[28:31], v[156:159], v[84:87], a[28:31]
 s_add_u32 s97, s91, s6
 ds_read_b64_tr_b16 v[148:149], v10 offset:14336
 v_mfma_f32_16x16x32_bf16 a[28:31], v[152:155], v[80:83], a[28:31]
 s_waitcnt vmcnt(18) lgkmcnt(7)
 ds_read_b64_tr_b16 v[150:151], v10 offset:15360
 v_mfma_f32_16x16x32_bf16 a[0:3], v[128:131], v[72:75], a[0:3]
 s_add_u32 s88, s88, 1
 ds_read_b64_tr_b16 v[152:153], v11 offset:12288
 buffer_load_dwordx4 v[36:39], v12, s[40:43], s96 offen offset:1024
 v_mfma_f32_16x16x32_bf16 a[0:3], v[132:135], v[76:79], a[0:3]
 s_and_b32 s88, s88, 7
 ds_read_b64_tr_b16 v[154:155], v11 offset:13312
 v_mfma_f32_16x16x32_bf16 a[4:7], v[132:135], v[92:95], a[4:7]
 s_lshl_b32 s7, s88, 18
 ds_read_b64_tr_b16 v[156:157], v11 offset:14336
 v_mfma_f32_16x16x32_bf16 a[4:7], v[128:131], v[88:91], a[4:7]
 s_waitcnt lgkmcnt(7)
 ds_read_b64_tr_b16 v[158:159], v11 offset:15360
 v_mfma_f32_16x16x32_bf16 a[8:11], v[136:139], v[72:75], a[8:11]
 s_add_u32 s76, s87, s7
 buffer_load_dwordx4 v[52:55], v13, s[40:43], s96 offen offset:1024
 v_mfma_f32_16x16x32_bf16 a[8:11], v[140:143], v[76:79], a[8:11]
 buffer_load_dwordx4 v[40:43], v12, s[40:43], s96 offen offset:2048
 v_mfma_f32_16x16x32_bf16 a[12:15], v[140:143], v[92:95], a[12:15]
 buffer_load_dwordx4 v[56:59], v13, s[40:43], s96 offen offset:2048
 v_mfma_f32_16x16x32_bf16 a[12:15], v[136:139], v[88:91], a[12:15]
 s_waitcnt vmcnt(30) lgkmcnt(0)
 s_cmp_lg_u32 s48, 0
 s_cbranch_scc1 L_g_rdy
 s_waitcnt vmcnt(6)
L_g_chk:
 v_cmp_ne_u32 vcc, 1, v176
 s_nop 3
 s_cmp_eq_u64 vcc, 0
 s_cbranch_scc1 L_g_rdy
 s_sleep 2
 buffer_load_dword v176, v177, s[40:43], s89 offen sc1
 s_waitcnt vmcnt(0)
 s_branch L_g_chk
L_g_rdy:
 s_barrier
 v_add_u32 v10, s79, v4
 v_add_u32 v11, s79, v5
 v_mfma_f32_16x16x32_bf16 a[16:19], v[144:147], v[72:75], a[16:19]
 ds_read_b64_tr_b16 v[128:129], v10 offset:0
 ds_read_b64_tr_b16 v[130:131], v10 offset:1024
 v_mfma_f32_16x16x32_bf16 a[16:19], v[148:151], v[76:79], a[16:19]
 ds_read_b64_tr_b16 v[132:133], v10 offset:2048
 ds_read_b64_tr_b16 v[134:135], v10 offset:3072
 v_mfma_f32_16x16x32_bf16 a[20:23], v[148:151], v[92:95], a[20:23]
 ds_read_b64_tr_b16 v[136:137], v11 offset:0
 ds_read_b64_tr_b16 v[138:139], v11 offset:1024
 v_mfma_f32_16x16x32_bf16 a[20:23], v[144:147], v[88:91], a[20:23]
 s_waitcnt lgkmcnt(6)
 ds_read_b64_tr_b16 v[140:141], v11 offset:2048
 ds_read_b64_tr_b16 v[142:143], v11 offset:3072
 v_mfma_f32_16x16x32_bf16 a[24:27], v[152:155], v[72:75], a[24:27]
 ds_read_b64_tr_b16 v[144:145], v10 offset:8192
 v_mfma_f32_16x16x32_bf16 a[24:27], v[156:159], v[76:79], a[24:27]
 ds_read_b64_tr_b16 v[146:147], v10 offset:9216
 buffer_load_dwordx4 v[44:47], v12, s[40:43], s96 offen offset:3072
 v_mfma_f32_16x16x32_bf16 a[28:31], v[156:159], v[92:95], a[28:31]
 ds_read_b64_tr_b16 v[148:149], v10 offset:10240
 buffer_load_dwordx4 v[60:63], v13, s[40:43], s96 offen offset:3072
 v_mfma_f32_16x16x32_bf16 a[28:31], v[152:155], v[88:91], a[28:31]
 ds_read_b64_tr_b16 v[150:151], v10 offset:11264
 s_waitcnt vmcnt(16) lgkmcnt(8)
 v_mfma_f32_16x16x32_bf16 a[0:3], v[128:131], v[96:99], a[0:3]
 s_add_u32 m0, s80, 0
 ds_read_b64_tr_b16 v[152:153], v11 offset:8192
 v_mfma_f32_16x16x32_bf16 a[0:3], v[132:135], v[100:103], a[0:3]
 ds_read_b64_tr_b16 v[154:155], v11 offset:9216
 buffer_load_dwordx4 v178, s[64:67], s76 offen offset:0 lds
 v_mfma_f32_16x16x32_bf16 a[4:7], v[132:135], v[116:119], a[4:7]
 s_add_u32 m0, s80, 8128
 ds_read_b64_tr_b16 v[156:157], v11 offset:10240
 buffer_load_dwordx4 v178, s[64:67], s76 offen offset:64 lds
 v_mfma_f32_16x16x32_bf16 a[4:7], v[128:131], v[112:115], a[4:7]
 s_waitcnt lgkmcnt(7)
 ds_read_b64_tr_b16 v[158:159], v11 offset:11264
 v_mfma_f32_16x16x32_bf16 a[8:11], v[136:139], v[96:99], a[8:11]
 s_add_u32 m0, s80, 1024
 ds_read_b64_tr_b16 v[128:129], v10 offset:4096
 v_mfma_f32_16x16x32_bf16 a[8:11], v[140:143], v[100:103], a[8:11]
 ds_read_b64_tr_b16 v[130:131], v10 offset:5120
 buffer_load_dwordx4 v179, s[64:67], s76 offen offset:0 lds
 v_mfma_f32_16x16x32_bf16 a[12:15], v[140:143], v[116:119], a[12:15]
 s_add_u32 m0, s80, 9152
 ds_read_b64_tr_b16 v[132:133], v10 offset:6144
 buffer_load_dwordx4 v179, s[64:67], s76 offen offset:64 lds
 v_mfma_f32_16x16x32_bf16 a[12:15], v[136:139], v[112:115], a[12:15]
 s_waitcnt lgkmcnt(7)
 ds_read_b64_tr_b16 v[134:135], v10 offset:7168
 v_mfma_f32_16x16x32_bf16 a[16:19], v[144:147], v[96:99], a[16:19]
 s_add_u32 s80, s80, 16384
 ds_read_b64_tr_b16 v[136:137], v11 offset:4096
 v_mfma_f32_16x16x32_bf16 a[16:19], v[148:151], v[100:103], a[16:19]
 s_and_b32 s80, s80, 65535
 ds_read_b64_tr_b16 v[138:139], v11 offset:5120
 buffer_load_dwordx4 v[64:67], v14, s[40:43], s97 offen offset:0 sc1
 v_mfma_f32_16x16x32_bf16 a[20:23], v[148:151], v[116:119], a[20:23]
 s_add_u32 s79, s79, 16384
 ds_read_b64_tr_b16 v[140:141], v11 offset:6144
 v_mfma_f32_16x16x32_bf16 a[20:23], v[144:147], v[112:115], a[20:23]
 s_waitcnt lgkmcnt(7)
 ds_read_b64_tr_b16 v[142:143], v11 offset:7168
 v_mfma_f32_16x16x32_bf16 a[24:27], v[152:155], v[96:99], a[24:27]
 s_and_b32 s79, s79, 65535
 ds_read_b64_tr_b16 v[144:145], v10 offset:12288
 buffer_load_dwordx4 v[80:83], v15, s[40:43], s97 offen offset:0 sc1
 v_mfma_f32_16x16x32_bf16 a[24:27], v[156:159], v[100:103], a[24:27]
 s_lshl_b32 s6, s88, 12
 ds_read_b64_tr_b16 v[146:147], v10 offset:13312
 v_mfma_f32_16x16x32_bf16 a[28:31], v[156:159], v[116:119], a[28:31]
 s_add_u32 s98, s91, s6
 ds_read_b64_tr_b16 v[148:149], v10 offset:14336
 v_mfma_f32_16x16x32_bf16 a[28:31], v[152:155], v[112:115], a[28:31]
 s_waitcnt vmcnt(18) lgkmcnt(7)
 ds_read_b64_tr_b16 v[150:151], v10 offset:15360
 v_mfma_f32_16x16x32_bf16 a[0:3], v[128:131], v[104:107], a[0:3]
 s_add_u32 s88, s88, 1
 ds_read_b64_tr_b16 v[152:153], v11 offset:12288
 buffer_load_dwordx4 v[68:71], v14, s[40:43], s97 offen offset:1024 sc1
 v_mfma_f32_16x16x32_bf16 a[0:3], v[132:135], v[108:111], a[0:3]
 s_and_b32 s88, s88, 7
 ds_read_b64_tr_b16 v[154:155], v11 offset:13312
 v_mfma_f32_16x16x32_bf16 a[4:7], v[132:135], v[124:127], a[4:7]
 s_lshl_b32 s7, s88, 18
 ds_read_b64_tr_b16 v[156:157], v11 offset:14336
 v_mfma_f32_16x16x32_bf16 a[4:7], v[128:131], v[120:123], a[4:7]
 s_waitcnt lgkmcnt(7)
 ds_read_b64_tr_b16 v[158:159], v11 offset:15360
 v_mfma_f32_16x16x32_bf16 a[8:11], v[136:139], v[104:107], a[8:11]
 s_add_u32 s76, s87, s7
 buffer_load_dwordx4 v[84:87], v15, s[40:43], s97 offen offset:1024 sc1
 v_mfma_f32_16x16x32_bf16 a[8:11], v[140:143], v[108:111], a[8:11]
 buffer_load_dwordx4 v[72:75], v14, s[40:43], s97 offen offset:2048 sc1
 v_mfma_f32_16x16x32_bf16 a[12:15], v[140:143], v[124:127], a[12:15]
 buffer_load_dwordx4 v[88:91], v15, s[40:43], s97 offen offset:2048 sc1
 v_mfma_f32_16x16x32_bf16 a[12:15], v[136:139], v[120:123], a[12:15]
 s_waitcnt vmcnt(30) lgkmcnt(0)
 s_barrier
 v_add_u32 v10, s79, v4
 v_add_u32 v11, s79, v5
 v_mfma_f32_16x16x32_bf16 a[16:19], v[144:147], v[104:107], a[16:19]
 ds_read_b64_tr_b16 v[128:129], v10 offset:0
 ds_read_b64_tr_b16 v[130:131], v10 offset:1024
 v_mfma_f32_16x16x32_bf16 a[16:19], v[148:151], v[108:111], a[16:19]
 ds_read_b64_tr_b16 v[132:133], v10 offset:2048
 ds_read_b64_tr_b16 v[134:135], v10 offset:3072
 v_mfma_f32_16x16x32_bf16 a[20:23], v[148:151], v[124:127], a[20:23]
 ds_read_b64_tr_b16 v[136:137], v11 offset:0
 ds_read_b64_tr_b16 v[138:139], v11 offset:1024
 v_mfma_f32_16x16x32_bf16 a[20:23], v[144:147], v[120:123], a[20:23]
 s_waitcnt lgkmcnt(6)
 ds_read_b64_tr_b16 v[140:141], v11 offset:2048
 ds_read_b64_tr_b16 v[142:143], v11 offset:3072
 v_mfma_f32_16x16x32_bf16 a[24:27], v[152:155], v[104:107], a[24:27]
 ds_read_b64_tr_b16 v[144:145], v10 offset:8192
 v_mfma_f32_16x16x32_bf16 a[24:27], v[156:159], v[108:111], a[24:27]
 ds_read_b64_tr_b16 v[146:147], v10 offset:9216
 buffer_load_dwordx4 v[76:79], v14, s[40:43], s97 offen offset:3072 sc1
 v_mfma_f32_16x16x32_bf16 a[28:31], v[156:159], v[124:127], a[28:31]
 ds_read_b64_tr_b16 v[148:149], v10 offset:10240
 buffer_load_dwordx4 v[92:95], v15, s[40:43], s97 offen offset:3072 sc1
 v_mfma_f32_16x16x32_bf16 a[28:31], v[152:155], v[120:123], a[28:31]
 ds_read_b64_tr_b16 v[150:151], v10 offset:11264
 s_waitcnt vmcnt(16) lgkmcnt(8)
 v_mfma_f32_16x16x32_bf16 a[0:3], v[128:131], v[32:35], a[0:3]
 s_add_u32 m0, s80, 0
 ds_read_b64_tr_b16 v[152:153], v11 offset:8192
 v_mfma_f32_16x16x32_bf16 a[0:3], v[132:135], v[36:39], a[0:3]
 ds_read_b64_tr_b16 v[154:155], v11 offset:9216
 buffer_load_dwordx4 v178, s[64:67], s76 offen offset:0 lds
 v_mfma_f32_16x16x32_bf16 a[4:7], v[132:135], v[52:55], a[4:7]
 s_add_u32 m0, s80, 8128
 ds_read_b64_tr_b16 v[156:157], v11 offset:10240
 buffer_load_dwordx4 v178, s[64:67], s76 offen offset:64 lds
 v_mfma_f32_16x16x32_bf16 a[4:7], v[128:131], v[48:51], a[4:7]
 s_waitcnt lgkmcnt(7)
 ds_read_b64_tr_b16 v[158:159], v11 offset:11264
 v_mfma_f32_16x16x32_bf16 a[8:11], v[136:139], v[32:35], a[8:11]
 s_add_u32 m0, s80, 1024
 ds_read_b64_tr_b16 v[128:129], v10 offset:4096
 v_mfma_f32_16x16x32_bf16 a[8:11], v[140:143], v[36:39], a[8:11]
 ds_read_b64_tr_b16 v[130:131], v10 offset:5120
 buffer_load_dwordx4 v179, s[64:67], s76 offen offset:0 lds
 v_mfma_f32_16x16x32_bf16 a[12:15], v[140:143], v[52:55], a[12:15]
 s_add_u32 m0, s80, 9152
 ds_read_b64_tr_b16 v[132:133], v10 offset:6144
 buffer_load_dwordx4 v179, s[64:67], s76 offen offset:64 lds
 v_mfma_f32_16x16x32_bf16 a[12:15], v[136:139], v[48:51], a[12:15]
 s_waitcnt lgkmcnt(7)
 ds_read_b64_tr_b16 v[134:135], v10 offset:7168
 v_mfma_f32_16x16x32_bf16 a[16:19], v[144:147], v[32:35], a[16:19]
 s_add_u32 s80, s80, 16384
 ds_read_b64_tr_b16 v[136:137], v11 offset:4096
 v_mfma_f32_16x16x32_bf16 a[16:19], v[148:151], v[36:39], a[16:19]
 s_and_b32 s80, s80, 65535
 ds_read_b64_tr_b16 v[138:139], v11 offset:5120
 buffer_load_dwordx4 v[96:99], v14, s[40:43], s98 offen offset:0 sc1
 v_mfma_f32_16x16x32_bf16 a[20:23], v[148:151], v[52:55], a[20:23]
 s_add_u32 s79, s79, 16384
 ds_read_b64_tr_b16 v[140:141], v11 offset:6144
 v_mfma_f32_16x16x32_bf16 a[20:23], v[144:147], v[48:51], a[20:23]
 s_waitcnt lgkmcnt(7)
 ds_read_b64_tr_b16 v[142:143], v11 offset:7168
 v_mfma_f32_16x16x32_bf16 a[24:27], v[152:155], v[32:35], a[24:27]
 s_and_b32 s79, s79, 65535
 ds_read_b64_tr_b16 v[144:145], v10 offset:12288
 buffer_load_dwordx4 v[112:115], v15, s[40:43], s98 offen offset:0 sc1
 v_mfma_f32_16x16x32_bf16 a[24:27], v[156:159], v[36:39], a[24:27]
 s_lshl_b32 s6, s88, 12
 ds_read_b64_tr_b16 v[146:147], v10 offset:13312
 v_mfma_f32_16x16x32_bf16 a[28:31], v[156:159], v[52:55], a[28:31]
 s_add_u32 s96, s91, s6
 ds_read_b64_tr_b16 v[148:149], v10 offset:14336
 v_mfma_f32_16x16x32_bf16 a[28:31], v[152:155], v[48:51], a[28:31]
 s_waitcnt vmcnt(18) lgkmcnt(7)
 ds_read_b64_tr_b16 v[150:151], v10 offset:15360
 v_mfma_f32_16x16x32_bf16 a[0:3], v[128:131], v[40:43], a[0:3]
 s_add_u32 s88, s88, 1
 ds_read_b64_tr_b16 v[152:153], v11 offset:12288
 buffer_load_dwordx4 v[100:103], v14, s[40:43], s98 offen offset:1024 sc1
 v_mfma_f32_16x16x32_bf16 a[0:3], v[132:135], v[44:47], a[0:3]
 s_and_b32 s88, s88, 7
 ds_read_b64_tr_b16 v[154:155], v11 offset:13312
 v_mfma_f32_16x16x32_bf16 a[4:7], v[132:135], v[60:63], a[4:7]
 s_lshl_b32 s7, s88, 18
 ds_read_b64_tr_b16 v[156:157], v11 offset:14336
 v_mfma_f32_16x16x32_bf16 a[4:7], v[128:131], v[56:59], a[4:7]
 s_waitcnt lgkmcnt(7)
 ds_read_b64_tr_b16 v[158:159], v11 offset:15360
 v_mfma_f32_16x16x32_bf16 a[8:11], v[136:139], v[40:43], a[8:11]
 s_add_u32 s76, s87, s7
 buffer_load_dwordx4 v[116:119], v15, s[40:43], s98 offen offset:1024 sc1
 v_mfma_f32_16x16x32_bf16 a[8:11], v[140:143], v[44:47], a[8:11]
 buffer_load_dwordx4 v[104:107], v14, s[40:43], s98 offen offset:2048 sc1
 v_mfma_f32_16x16x32_bf16 a[12:15], v[140:143], v[60:63], a[12:15]
 buffer_load_dwordx4 v[120:123], v15, s[40:43], s98 offen offset:2048 sc1
 v_mfma_f32_16x16x32_bf16 a[12:15], v[136:139], v[56:59], a[12:15]
 s_waitcnt vmcnt(30) lgkmcnt(0)
 s_barrier
 v_add_u32 v10, s79, v8
 v_add_u32 v11, s79, v9
 v_mfma_f32_16x16x32_bf16 a[16:19], v[144:147], v[40:43], a[16:19]
 ds_read_b64_tr_b16 v[128:129], v10 offset:0
 ds_read_b64_tr_b16 v[130:131], v10 offset:512
 v_mfma_f32_16x16x32_bf16 a[16:19], v[148:151], v[44:47], a[16:19]
 ds_read_b64_tr_b16 v[132:133], v10 offset:2048
 ds_read_b64_tr_b16 v[134:135], v10 offset:2560
 v_mfma_f32_16x16x32_bf16 a[20:23], v[148:151], v[60:63], a[20:23]
 ds_read_b64_tr_b16 v[136:137], v11 offset:0
 ds_read_b64_tr_b16 v[138:139], v11 offset:512
 v_mfma_f32_16x16x32_bf16 a[20:23], v[144:147], v[56:59], a[20:23]
 s_waitcnt lgkmcnt(6)
 ds_read_b64_tr_b16 v[140:141], v11 offset:2048
 ds_read_b64_tr_b16 v[142:143], v11 offset:2560
 v_mfma_f32_16x16x32_bf16 a[24:27], v[152:155], v[40:43], a[24:27]
 ds_read_b64_tr_b16 v[144:145], v10 offset:8192
 v_mfma_f32_16x16x32_bf16 a[24:27], v[156:159], v[44:47], a[24:27]
 ds_read_b64_tr_b16 v[146:147], v10 offset:8704
 buffer_load_dwordx4 v[108:111], v14, s[40:43], s98 offen offset:3072 sc1
 v_mfma_f32_16x16x32_bf16 a[28:31], v[156:159], v[60:63], a[28:31]
 ds_read_b64_tr_b16 v[148:149], v10 offset:10240
 buffer_load_dwordx4 v[124:127], v15, s[40:43], s98 offen offset:3072 sc1
 v_mfma_f32_16x16x32_bf16 a[28:31], v[152:155], v[56:59], a[28:31]
 ds_read_b64_tr_b16 v[150:151], v10 offset:10752
 s_nop 7
 v_accvgpr_read_b32 v16, a0
 v_accvgpr_read_b32 v17, a1
 v_accvgpr_read_b32 v18, a2
 v_accvgpr_read_b32 v19, a3
 v_accvgpr_read_b32 v20, a4
 v_accvgpr_read_b32 v21, a5
 v_accvgpr_read_b32 v22, a6
 v_accvgpr_read_b32 v23, a7
 v_mul_f32 v24, s4, v16
 v_mul_f32 v25, s4, v17
 v_mul_f32 v26, s4, v18
 v_mul_f32 v27, s4, v19
 v_mul_f32 v28, s4, v20
 v_mul_f32 v29, s4, v21
 v_mul_f32 v30, s4, v22
 v_mul_f32 v31, s4, v23
 v_exp_f32 v24, v24
 v_exp_f32 v25, v25
 v_exp_f32 v26, v26
 v_exp_f32 v27, v27
 v_exp_f32 v28, v28
 v_exp_f32 v29, v29
 v_exp_f32 v30, v30
 v_exp_f32 v31, v31
 v_add_f32 v24, 1.0, v24
 v_add_f32 v25, 1.0, v25
 v_add_f32 v26, 1.0, v26
 v_add_f32 v27, 1.0, v27
 v_add_f32 v28, 1.0, v28
 v_add_f32 v29, 1.0, v29
 v_add_f32 v30, 1.0, v30
 v_add_f32 v31, 1.0, v31
 v_rcp_f32 v24, v24
 v_rcp_f32 v25, v25
 v_rcp_f32 v26, v26
 v_rcp_f32 v27, v27
 v_rcp_f32 v28, v28
 v_rcp_f32 v29, v29
 v_rcp_f32 v30, v30
 v_rcp_f32 v31, v31
 v_mul_f32 v24, v16, v24
 v_mul_f32 v25, v17, v25
 v_mul_f32 v26, v18, v26
 v_mul_f32 v27, v19, v27
 v_mul_f32 v28, v20, v28
 v_mul_f32 v29, v21, v29
 v_mul_f32 v30, v22, v30
 v_mul_f32 v31, v23, v31
 v_accvgpr_write_b32 a0, v24
 v_accvgpr_write_b32 a1, v25
 v_accvgpr_write_b32 a2, v26
 v_accvgpr_write_b32 a3, v27
 v_accvgpr_write_b32 a4, v28
 v_accvgpr_write_b32 a5, v29
 v_accvgpr_write_b32 a6, v30
 v_accvgpr_write_b32 a7, v31
 v_accvgpr_read_b32 v16, a8
 v_accvgpr_read_b32 v17, a9
 v_accvgpr_read_b32 v18, a10
 v_accvgpr_read_b32 v19, a11
 v_accvgpr_read_b32 v20, a12
 v_accvgpr_read_b32 v21, a13
 v_accvgpr_read_b32 v22, a14
 v_accvgpr_read_b32 v23, a15
 v_mul_f32 v24, s4, v16
 v_mul_f32 v25, s4, v17
 v_mul_f32 v26, s4, v18
 v_mul_f32 v27, s4, v19
 v_mul_f32 v28, s4, v20
 v_mul_f32 v29, s4, v21
 v_mul_f32 v30, s4, v22
 v_mul_f32 v31, s4, v23
 v_exp_f32 v24, v24
 v_exp_f32 v25, v25
 v_exp_f32 v26, v26
 v_exp_f32 v27, v27
 v_exp_f32 v28, v28
 v_exp_f32 v29, v29
 v_exp_f32 v30, v30
 v_exp_f32 v31, v31
 v_add_f32 v24, 1.0, v24
 v_add_f32 v25, 1.0, v25
 v_add_f32 v26, 1.0, v26
 v_add_f32 v27, 1.0, v27
 v_add_f32 v28, 1.0, v28
 v_add_f32 v29, 1.0, v29
 v_add_f32 v30, 1.0, v30
 v_add_f32 v31, 1.0, v31
 v_rcp_f32 v24, v24
 v_rcp_f32 v25, v25
 v_rcp_f32 v26, v26
 v_rcp_f32 v27, v27
 v_rcp_f32 v28, v28
 v_rcp_f32 v29, v29
 v_rcp_f32 v30, v30
 v_rcp_f32 v31, v31
 v_mul_f32 v24, v16, v24
 v_mul_f32 v25, v17, v25
 v_mul_f32 v26, v18, v26
 v_mul_f32 v27, v19, v27
 v_mul_f32 v28, v20, v28
 v_mul_f32 v29, v21, v29
 v_mul_f32 v30, v22, v30
 v_mul_f32 v31, v23, v31
 v_accvgpr_write_b32 a8, v24
 v_accvgpr_write_b32 a9, v25
 v_accvgpr_write_b32 a10, v26
 v_accvgpr_write_b32 a11, v27
 v_accvgpr_write_b32 a12, v28
 v_accvgpr_write_b32 a13, v29
 v_accvgpr_write_b32 a14, v30
 v_accvgpr_write_b32 a15, v31
 v_accvgpr_read_b32 v16, a16
 v_accvgpr_read_b32 v17, a17
 v_accvgpr_read_b32 v18, a18
 v_accvgpr_read_b32 v19, a19
 v_accvgpr_read_b32 v20, a20
 v_accvgpr_read_b32 v21, a21
 v_accvgpr_read_b32 v22, a22
 v_accvgpr_read_b32 v23, a23
 v_mul_f32 v24, s4, v16
 v_mul_f32 v25, s4, v17
 v_mul_f32 v26, s4, v18
 v_mul_f32 v27, s4, v19
 v_mul_f32 v28, s4, v20
 v_mul_f32 v29, s4, v21
 v_mul_f32 v30, s4, v22
 v_mul_f32 v31, s4, v23
 v_exp_f32 v24, v24
 v_exp_f32 v25, v25
 v_exp_f32 v26, v26
 v_exp_f32 v27, v27
 v_exp_f32 v28, v28
 v_exp_f32 v29, v29
 v_exp_f32 v30, v30
 v_exp_f32 v31, v31
 v_add_f32 v24, 1.0, v24
 v_add_f32 v25, 1.0, v25
 v_add_f32 v26, 1.0, v26
 v_add_f32 v27, 1.0, v27
 v_add_f32 v28, 1.0, v28
 v_add_f32 v29, 1.0, v29
 v_add_f32 v30, 1.0, v30
 v_add_f32 v31, 1.0, v31
 v_rcp_f32 v24, v24
 v_rcp_f32 v25, v25
 v_rcp_f32 v26, v26
 v_rcp_f32 v27, v27
 v_rcp_f32 v28, v28
 v_rcp_f32 v29, v29
 v_rcp_f32 v30, v30
 v_rcp_f32 v31, v31
 v_mul_f32 v24, v16, v24
 v_mul_f32 v25, v17, v25
 v_mul_f32 v26, v18, v26
 v_mul_f32 v27, v19, v27
 v_mul_f32 v28, v20, v28
 v_mul_f32 v29, v21, v29
 v_mul_f32 v30, v22, v30
 v_mul_f32 v31, v23, v31
 v_accvgpr_write_b32 a16, v24
 v_accvgpr_write_b32 a17, v25
 v_accvgpr_write_b32 a18, v26
 v_accvgpr_write_b32 a19, v27
 v_accvgpr_write_b32 a20, v28
 v_accvgpr_write_b32 a21, v29
 v_accvgpr_write_b32 a22, v30
 v_accvgpr_write_b32 a23, v31
 v_accvgpr_read_b32 v16, a24
 v_accvgpr_read_b32 v17, a25
 v_accvgpr_read_b32 v18, a26
 v_accvgpr_read_b32 v19, a27
 v_accvgpr_read_b32 v20, a28
 v_accvgpr_read_b32 v21, a29
 v_accvgpr_read_b32 v22, a30
 v_accvgpr_read_b32 v23, a31
 v_mul_f32 v24, s4, v16
 v_mul_f32 v25, s4, v17
 v_mul_f32 v26, s4, v18
 v_mul_f32 v27, s4, v19
 v_mul_f32 v28, s4, v20
 v_mul_f32 v29, s4, v21
 v_mul_f32 v30, s4, v22
 v_mul_f32 v31, s4, v23
 v_exp_f32 v24, v24
 v_exp_f32 v25, v25
 v_exp_f32 v26, v26
 v_exp_f32 v27, v27
 v_exp_f32 v28, v28
 v_exp_f32 v29, v29
 v_exp_f32 v30, v30
 v_exp_f32 v31, v31
 v_add_f32 v24, 1.0, v24
 v_add_f32 v25, 1.0, v25
 v_add_f32 v26, 1.0, v26
 v_add_f32 v27, 1.0, v27
 v_add_f32 v28, 1.0, v28
 v_add_f32 v29, 1.0, v29
 v_add_f32 v30, 1.0, v30
 v_add_f32 v31, 1.0, v31
 v_rcp_f32 v24, v24
 v_rcp_f32 v25, v25
 v_rcp_f32 v26, v26
 v_rcp_f32 v27, v27
 v_rcp_f32 v28, v28
 v_rcp_f32 v29, v29
 v_rcp_f32 v30, v30
 v_rcp_f32 v31, v31
 v_mul_f32 v24, v16, v24
 v_mul_f32 v25, v17, v25
 v_mul_f32 v26, v18, v26
 v_mul_f32 v27, v19, v27
 v_mul_f32 v28, v20, v28
 v_mul_f32 v29, v21, v29
 v_mul_f32 v30, v22, v30
 v_mul_f32 v31, v23, v31
 v_accvgpr_write_b32 a24, v24
 v_accvgpr_write_b32 a25, v25
 v_accvgpr_write_b32 a26, v26
 v_accvgpr_write_b32 a27, v27
 v_accvgpr_write_b32 a28, v28
 v_accvgpr_write_b32 a29, v29
 v_accvgpr_write_b32 a30, v30
 v_accvgpr_write_b32 a31, v31
 s_waitcnt vmcnt(16) lgkmcnt(8)
 v_mfma_f32_16x16x32_bf16 a[32:35], v[128:131], v[64:67], a[32:35]
 s_add_u32 m0, s80, 0
 ds_read_b64_tr_b16 v[152:153], v11 offset:8192
 v_mfma_f32_16x16x32_bf16 a[32:35], v[132:135], v[68:71], a[32:35]
 ds_read_b64_tr_b16 v[154:155], v11 offset:8704
 buffer_load_dwordx4 v178, s[64:67], s76 offen offset:0 lds
 v_mfma_f32_16x16x32_bf16 a[36:39], v[132:135], v[84:87], a[36:39]
 s_add_u32 m0, s80, 8128
 ds_read_b64_tr_b16 v[156:157], v11 offset:10240
 buffer_load_dwordx4 v178, s[64:67], s76 offen offset:64 lds
 v_mfma_f32_16x16x32_bf16 a[36:39], v[128:131], v[80:83], a[36:39]
 s_waitcnt lgkmcnt(7)
 ds_read_b64_tr_b16 v[158:159], v11 offset:10752
 v_mfma_f32_16x16x32_bf16 a[40:43], v[136:139], v[64:67], a[40:43]
 s_add_u32 m0, s80, 1024
 ds_read_b64_tr_b16 v[128:129], v10 offset:4096
 v_mfma_f32_16x16x32_bf16 a[40:43], v[140:143], v[68:71], a[40:43]
 ds_read_b64_tr_b16 v[130:131], v10 offset:4608
 buffer_load_dwordx4 v179, s[64:67], s76 offen offset:0 lds
 v_mfma_f32_16x16x32_bf16 a[44:47], v[140:143], v[84:87], a[44:47]
 s_add_u32 m0, s80, 9152
 ds_read_b64_tr_b16 v[132:133], v10 offset:6144
 buffer_load_dwordx4 v179, s[64:67], s76 offen offset:64 lds
 v_mfma_f32_16x16x32_bf16 a[44:47], v[136:139], v[80:83], a[44:47]
 s_waitcnt lgkmcnt(7)
 ds_read_b64_tr_b16 v[134:135], v10 offset:6656
 v_mfma_f32_16x16x32_bf16 a[48:51], v[144:147], v[64:67], a[48:51]
 s_add_u32 s80, s80, 16384
 ds_read_b64_tr_b16 v[136:137], v11 offset:4096
 v_mfma_f32_16x16x32_bf16 a[48:51], v[148:151], v[68:71], a[48:51]
 s_and_b32 s80, s80, 65535
 ds_read_b64_tr_b16 v[138:139], v11 offset:4608
 buffer_load_dwordx4 v[32:35], v14, s[40:43], s96 offen offset:0 sc1
 v_mfma_f32_16x16x32_bf16 a[52:55], v[148:151], v[84:87], a[52:55]
 s_add_u32 s79, s79, 16384
 ds_read_b64_tr_b16 v[140:141], v11 offset:6144
 v_mfma_f32_16x16x32_bf16 a[52:55], v[144:147], v[80:83], a[52:55]
 s_waitcnt lgkmcnt(7)
 ds_read_b64_tr_b16 v[142:143], v11 offset:6656
 v_mfma_f32_16x16x32_bf16 a[56:59], v[152:155], v[64:67], a[56:59]
 s_and_b32 s79, s79, 65535
 ds_read_b64_tr_b16 v[144:145], v10 offset:12288
 buffer_load_dwordx4 v[48:51], v15, s[40:43], s96 offen offset:0 sc1
 v_mfma_f32_16x16x32_bf16 a[56:59], v[156:159], v[68:71], a[56:59]
 s_lshl_b32 s6, s88, 12
 ds_read_b64_tr_b16 v[146:147], v10 offset:12800
 v_mfma_f32_16x16x32_bf16 a[60:63], v[156:159], v[84:87], a[60:63]
 s_add_u32 s97, s91, s6
 ds_read_b64_tr_b16 v[148:149], v10 offset:14336
 v_mfma_f32_16x16x32_bf16 a[60:63], v[152:155], v[80:83], a[60:63]
 s_waitcnt vmcnt(18) lgkmcnt(7)
 ds_read_b64_tr_b16 v[150:151], v10 offset:14848
 v_mfma_f32_16x16x32_bf16 a[32:35], v[128:131], v[72:75], a[32:35]
 s_add_u32 s88, s88, 1
 ds_read_b64_tr_b16 v[152:153], v11 offset:12288
 buffer_load_dwordx4 v[36:39], v14, s[40:43], s96 offen offset:1024 sc1
 v_mfma_f32_16x16x32_bf16 a[32:35], v[132:135], v[76:79], a[32:35]
 s_and_b32 s88, s88, 7
 ds_read_b64_tr_b16 v[154:155], v11 offset:12800
 v_mfma_f32_16x16x32_bf16 a[36:39], v[132:135], v[92:95], a[36:39]
 s_lshl_b32 s7, s88, 18
 ds_read_b64_tr_b16 v[156:157], v11 offset:14336
 v_mfma_f32_16x16x32_bf16 a[36:39], v[128:131], v[88:91], a[36:39]
 s_waitcnt lgkmcnt(7)
 ds_read_b64_tr_b16 v[158:159], v11 offset:14848
 v_mfma_f32_16x16x32_bf16 a[40:43], v[136:139], v[72:75], a[40:43]
 s_add_u32 s76, s87, s7
 buffer_load_dwordx4 v[52:55], v15, s[40:43], s96 offen offset:1024 sc1
 v_mfma_f32_16x16x32_bf16 a[40:43], v[140:143], v[76:79], a[40:43]
 buffer_load_dwordx4 v[40:43], v14, s[40:43], s96 offen offset:2048 sc1
 v_mfma_f32_16x16x32_bf16 a[44:47], v[140:143], v[92:95], a[44:47]
 buffer_load_dwordx4 v[56:59], v15, s[40:43], s96 offen offset:2048 sc1
 v_mfma_f32_16x16x32_bf16 a[44:47], v[136:139], v[88:91], a[44:47]
 s_waitcnt vmcnt(30) lgkmcnt(0)
 s_barrier
 v_add_u32 v10, s79, v8
 v_add_u32 v11, s79, v9
 v_mfma_f32_16x16x32_bf16 a[48:51], v[144:147], v[72:75], a[48:51]
 ds_read_b64_tr_b16 v[128:129], v10 offset:0
 ds_read_b64_tr_b16 v[130:131], v10 offset:512
 v_mfma_f32_16x16x32_bf16 a[48:51], v[148:151], v[76:79], a[48:51]
 ds_read_b64_tr_b16 v[132:133], v10 offset:2048
 ds_read_b64_tr_b16 v[134:135], v10 offset:2560
 v_mfma_f32_16x16x32_bf16 a[52:55], v[148:151], v[92:95], a[52:55]
 ds_read_b64_tr_b16 v[136:137], v11 offset:0
 ds_read_b64_tr_b16 v[138:139], v11 offset:512
 v_mfma_f32_16x16x32_bf16 a[52:55], v[144:147], v[88:91], a[52:55]
 s_waitcnt lgkmcnt(6)
 ds_read_b64_tr_b16 v[140:141], v11 offset:2048
 ds_read_b64_tr_b16 v[142:143], v11 offset:2560
 v_mfma_f32_16x16x32_bf16 a[56:59], v[152:155], v[72:75], a[56:59]
 ds_read_b64_tr_b16 v[144:145], v10 offset:8192
 v_mfma_f32_16x16x32_bf16 a[56:59], v[156:159], v[76:79], a[56:59]
 ds_read_b64_tr_b16 v[146:147], v10 offset:8704
 buffer_load_dwordx4 v[44:47], v14, s[40:43], s96 offen offset:3072 sc1
 v_mfma_f32_16x16x32_bf16 a[60:63], v[156:159], v[92:95], a[60:63]
 ds_read_b64_tr_b16 v[148:149], v10 offset:10240
 buffer_load_dwordx4 v[60:63], v15, s[40:43], s96 offen offset:3072 sc1
 v_mfma_f32_16x16x32_bf16 a[60:63], v[152:155], v[88:91], a[60:63]
 ds_read_b64_tr_b16 v[150:151], v10 offset:10752
 s_waitcnt vmcnt(16) lgkmcnt(8)
 v_mfma_f32_16x16x32_bf16 a[32:35], v[128:131], v[96:99], a[32:35]
 s_add_u32 m0, s80, 0
 ds_read_b64_tr_b16 v[152:153], v11 offset:8192
 v_mfma_f32_16x16x32_bf16 a[32:35], v[132:135], v[100:103], a[32:35]
 ds_read_b64_tr_b16 v[154:155], v11 offset:8704
 buffer_load_dwordx4 v178, s[64:67], s76 offen offset:0 lds
 v_mfma_f32_16x16x32_bf16 a[36:39], v[132:135], v[116:119], a[36:39]
 s_add_u32 m0, s80, 8128
 ds_read_b64_tr_b16 v[156:157], v11 offset:10240
 buffer_load_dwordx4 v178, s[64:67], s76 offen offset:64 lds
 v_mfma_f32_16x16x32_bf16 a[36:39], v[128:131], v[112:115], a[36:39]
 s_waitcnt lgkmcnt(7)
 ds_read_b64_tr_b16 v[158:159], v11 offset:10752
 v_mfma_f32_16x16x32_bf16 a[40:43], v[136:139], v[96:99], a[40:43]
 s_add_u32 m0, s80, 1024
 ds_read_b64_tr_b16 v[128:129], v10 offset:4096
 v_mfma_f32_16x16x32_bf16 a[40:43], v[140:143], v[100:103], a[40:43]
 ds_read_b64_tr_b16 v[130:131], v10 offset:4608
 buffer_load_dwordx4 v179, s[64:67], s76 offen offset:0 lds
 v_mfma_f32_16x16x32_bf16 a[44:47], v[140:143], v[116:119], a[44:47]
 s_add_u32 m0, s80, 9152
 ds_read_b64_tr_b16 v[132:133], v10 offset:6144
 buffer_load_dwordx4 v179, s[64:67], s76 offen offset:64 lds
 v_mfma_f32_16x16x32_bf16 a[44:47], v[136:139], v[112:115], a[44:47]
 s_waitcnt lgkmcnt(7)
 ds_read_b64_tr_b16 v[134:135], v10 offset:6656
 v_mfma_f32_16x16x32_bf16 a[48:51], v[144:147], v[96:99], a[48:51]
 s_add_u32 s80, s80, 16384
 ds_read_b64_tr_b16 v[136:137], v11 offset:4096
 v_mfma_f32_16x16x32_bf16 a[48:51], v[148:151], v[100:103], a[48:51]
 s_and_b32 s80, s80, 65535
 ds_read_b64_tr_b16 v[138:139], v11 offset:4608
 buffer_load_dwordx4 v[64:67], v14, s[40:43], s97 offen offset:0 sc1
 v_mfma_f32_16x16x32_bf16 a[52:55], v[148:151], v[116:119], a[52:55]
 s_add_u32 s79, s79, 16384
 ds_read_b64_tr_b16 v[140:141], v11 offset:6144
 v_mfma_f32_16x16x32_bf16 a[52:55], v[144:147], v[112:115], a[52:55]
 s_waitcnt lgkmcnt(7)
 ds_read_b64_tr_b16 v[142:143], v11 offset:6656
 v_mfma_f32_16x16x32_bf16 a[56:59], v[152:155], v[96:99], a[56:59]
 s_and_b32 s79, s79, 65535
 ds_read_b64_tr_b16 v[144:145], v10 offset:12288
 buffer_load_dwordx4 v[80:83], v15, s[40:43], s97 offen offset:0 sc1
 v_mfma_f32_16x16x32_bf16 a[56:59], v[156:159], v[100:103], a[56:59]
 s_lshl_b32 s6, s88, 12
 ds_read_b64_tr_b16 v[146:147], v10 offset:12800
 v_mfma_f32_16x16x32_bf16 a[60:63], v[156:159], v[116:119], a[60:63]
 s_add_u32 s98, s91, s6
 ds_read_b64_tr_b16 v[148:149], v10 offset:14336
 v_mfma_f32_16x16x32_bf16 a[60:63], v[152:155], v[112:115], a[60:63]
 s_waitcnt vmcnt(18) lgkmcnt(7)
 ds_read_b64_tr_b16 v[150:151], v10 offset:14848
 v_mfma_f32_16x16x32_bf16 a[32:35], v[128:131], v[104:107], a[32:35]
 s_add_u32 s88, s88, 1
 ds_read_b64_tr_b16 v[152:153], v11 offset:12288
 buffer_load_dwordx4 v[68:71], v14, s[40:43], s97 offen offset:1024 sc1
 v_mfma_f32_16x16x32_bf16 a[32:35], v[132:135], v[108:111], a[32:35]
 s_and_b32 s88, s88, 7
 ds_read_b64_tr_b16 v[154:155], v11 offset:12800
 v_mfma_f32_16x16x32_bf16 a[36:39], v[132:135], v[124:127], a[36:39]
 s_lshl_b32 s7, s88, 18
 ds_read_b64_tr_b16 v[156:157], v11 offset:14336
 v_mfma_f32_16x16x32_bf16 a[36:39], v[128:131], v[120:123], a[36:39]
 s_waitcnt lgkmcnt(7)
 ds_read_b64_tr_b16 v[158:159], v11 offset:14848
 v_mfma_f32_16x16x32_bf16 a[40:43], v[136:139], v[104:107], a[40:43]
 s_add_u32 s76, s87, s7
 buffer_load_dwordx4 v[84:87], v15, s[40:43], s97 offen offset:1024 sc1
 v_mfma_f32_16x16x32_bf16 a[40:43], v[140:143], v[108:111], a[40:43]
 buffer_load_dwordx4 v[72:75], v14, s[40:43], s97 offen offset:2048 sc1
 v_mfma_f32_16x16x32_bf16 a[44:47], v[140:143], v[124:127], a[44:47]
 buffer_load_dwordx4 v[88:91], v15, s[40:43], s97 offen offset:2048 sc1
 v_mfma_f32_16x16x32_bf16 a[44:47], v[136:139], v[120:123], a[44:47]
 s_waitcnt vmcnt(30) lgkmcnt(0)
 s_barrier
 v_add_u32 v10, s79, v8
 v_add_u32 v11, s79, v9
 v_mfma_f32_16x16x32_bf16 a[48:51], v[144:147], v[104:107], a[48:51]
 ds_read_b64_tr_b16 v[128:129], v10 offset:0
 ds_read_b64_tr_b16 v[130:131], v10 offset:512
 v_mfma_f32_16x16x32_bf16 a[48:51], v[148:151], v[108:111], a[48:51]
 ds_read_b64_tr_b16 v[132:133], v10 offset:2048
 ds_read_b64_tr_b16 v[134:135], v10 offset:2560
 v_mfma_f32_16x16x32_bf16 a[52:55], v[148:151], v[124:127], a[52:55]
 ds_read_b64_tr_b16 v[136:137], v11 offset:0
 ds_read_b64_tr_b16 v[138:139], v11 offset:512
 v_mfma_f32_16x16x32_bf16 a[52:55], v[144:147], v[120:123], a[52:55]
 s_waitcnt lgkmcnt(6)
 ds_read_b64_tr_b16 v[140:141], v11 offset:2048
 ds_read_b64_tr_b16 v[142:143], v11 offset:2560
 v_mfma_f32_16x16x32_bf16 a[56:59], v[152:155], v[104:107], a[56:59]
 ds_read_b64_tr_b16 v[144:145], v10 offset:8192
 v_mfma_f32_16x16x32_bf16 a[56:59], v[156:159], v[108:111], a[56:59]
 ds_read_b64_tr_b16 v[146:147], v10 offset:8704
 buffer_load_dwordx4 v[76:79], v14, s[40:43], s97 offen offset:3072 sc1
 v_mfma_f32_16x16x32_bf16 a[60:63], v[156:159], v[124:127], a[60:63]
 ds_read_b64_tr_b16 v[148:149], v10 offset:10240
 buffer_load_dwordx4 v[92:95], v15, s[40:43], s97 offen offset:3072 sc1
 v_mfma_f32_16x16x32_bf16 a[60:63], v[152:155], v[120:123], a[60:63]
 ds_read_b64_tr_b16 v[150:151], v10 offset:10752
 s_waitcnt vmcnt(16) lgkmcnt(8)
 v_mfma_f32_16x16x32_bf16 a[32:35], v[128:131], v[32:35], a[32:35]
 s_add_u32 m0, s80, 0
 ds_read_b64_tr_b16 v[152:153], v11 offset:8192
 v_mfma_f32_16x16x32_bf16 a[32:35], v[132:135], v[36:39], a[32:35]
 ds_read_b64_tr_b16 v[154:155], v11 offset:8704
 buffer_load_dwordx4 v178, s[64:67], s76 offen offset:0 lds
 v_mfma_f32_16x16x32_bf16 a[36:39], v[132:135], v[52:55], a[36:39]
 s_add_u32 m0, s80, 8128
 ds_read_b64_tr_b16 v[156:157], v11 offset:10240
 buffer_load_dwordx4 v178, s[64:67], s76 offen offset:64 lds
 v_mfma_f32_16x16x32_bf16 a[36:39], v[128:131], v[48:51], a[36:39]
 s_waitcnt lgkmcnt(7)
 ds_read_b64_tr_b16 v[158:159], v11 offset:10752
 v_mfma_f32_16x16x32_bf16 a[40:43], v[136:139], v[32:35], a[40:43]
 s_add_u32 m0, s80, 1024
 ds_read_b64_tr_b16 v[128:129], v10 offset:4096
 v_mfma_f32_16x16x32_bf16 a[40:43], v[140:143], v[36:39], a[40:43]
 ds_read_b64_tr_b16 v[130:131], v10 offset:4608
 buffer_load_dwordx4 v179, s[64:67], s76 offen offset:0 lds
 v_mfma_f32_16x16x32_bf16 a[44:47], v[140:143], v[52:55], a[44:47]
 s_add_u32 m0, s80, 9152
 ds_read_b64_tr_b16 v[132:133], v10 offset:6144
 buffer_load_dwordx4 v179, s[64:67], s76 offen offset:64 lds
 v_mfma_f32_16x16x32_bf16 a[44:47], v[136:139], v[48:51], a[44:47]
 s_waitcnt lgkmcnt(7)
 ds_read_b64_tr_b16 v[134:135], v10 offset:6656
 v_mfma_f32_16x16x32_bf16 a[48:51], v[144:147], v[32:35], a[48:51]
 s_add_u32 s80, s80, 16384
 ds_read_b64_tr_b16 v[136:137], v11 offset:4096
 v_mfma_f32_16x16x32_bf16 a[48:51], v[148:151], v[36:39], a[48:51]
 s_and_b32 s80, s80, 65535
 ds_read_b64_tr_b16 v[138:139], v11 offset:4608
 buffer_load_dwordx4 v[96:99], v14, s[40:43], s98 offen offset:0 sc1
 v_mfma_f32_16x16x32_bf16 a[52:55], v[148:151], v[52:55], a[52:55]
 s_add_u32 s79, s79, 16384
 ds_read_b64_tr_b16 v[140:141], v11 offset:6144
 v_mfma_f32_16x16x32_bf16 a[52:55], v[144:147], v[48:51], a[52:55]
 s_waitcnt lgkmcnt(7)
 ds_read_b64_tr_b16 v[142:143], v11 offset:6656
 v_mfma_f32_16x16x32_bf16 a[56:59], v[152:155], v[32:35], a[56:59]
 s_and_b32 s79, s79, 65535
 ds_read_b64_tr_b16 v[144:145], v10 offset:12288
 buffer_load_dwordx4 v[112:115], v15, s[40:43], s98 offen offset:0 sc1
 v_mfma_f32_16x16x32_bf16 a[56:59], v[156:159], v[36:39], a[56:59]
 s_lshl_b32 s6, s88, 12
 ds_read_b64_tr_b16 v[146:147], v10 offset:12800
 v_mfma_f32_16x16x32_bf16 a[60:63], v[156:159], v[52:55], a[60:63]
 s_add_u32 s96, s91, s6
 ds_read_b64_tr_b16 v[148:149], v10 offset:14336
 v_mfma_f32_16x16x32_bf16 a[60:63], v[152:155], v[48:51], a[60:63]
 s_waitcnt vmcnt(18) lgkmcnt(7)
 ds_read_b64_tr_b16 v[150:151], v10 offset:14848
 v_mfma_f32_16x16x32_bf16 a[32:35], v[128:131], v[40:43], a[32:35]
 s_add_u32 s88, s88, 1
 ds_read_b64_tr_b16 v[152:153], v11 offset:12288
 buffer_load_dwordx4 v[100:103], v14, s[40:43], s98 offen offset:1024 sc1
 v_mfma_f32_16x16x32_bf16 a[32:35], v[132:135], v[44:47], a[32:35]
 s_and_b32 s88, s88, 7
 ds_read_b64_tr_b16 v[154:155], v11 offset:12800
 v_mfma_f32_16x16x32_bf16 a[36:39], v[132:135], v[60:63], a[36:39]
 s_lshl_b32 s7, s88, 18
 ds_read_b64_tr_b16 v[156:157], v11 offset:14336
 v_mfma_f32_16x16x32_bf16 a[36:39], v[128:131], v[56:59], a[36:39]
 s_waitcnt lgkmcnt(7)
 ds_read_b64_tr_b16 v[158:159], v11 offset:14848
 v_mfma_f32_16x16x32_bf16 a[40:43], v[136:139], v[40:43], a[40:43]
 s_add_u32 s76, s87, s7
 buffer_load_dwordx4 v[116:119], v15, s[40:43], s98 offen offset:1024 sc1
 v_mfma_f32_16x16x32_bf16 a[40:43], v[140:143], v[44:47], a[40:43]
 buffer_load_dwordx4 v[104:107], v14, s[40:43], s98 offen offset:2048 sc1
 v_mfma_f32_16x16x32_bf16 a[44:47], v[140:143], v[60:63], a[44:47]
 buffer_load_dwordx4 v[120:123], v15, s[40:43], s98 offen offset:2048 sc1
 v_mfma_f32_16x16x32_bf16 a[44:47], v[136:139], v[56:59], a[44:47]
 s_waitcnt vmcnt(30) lgkmcnt(0)
 s_barrier
 v_add_u32 v10, s79, v8
 v_add_u32 v11, s79, v9
 v_mfma_f32_16x16x32_bf16 a[48:51], v[144:147], v[40:43], a[48:51]
 ds_read_b64_tr_b16 v[128:129], v10 offset:0
 ds_read_b64_tr_b16 v[130:131], v10 offset:512
 v_mfma_f32_16x16x32_bf16 a[48:51], v[148:151], v[44:47], a[48:51]
 ds_read_b64_tr_b16 v[132:133], v10 offset:2048
 ds_read_b64_tr_b16 v[134:135], v10 offset:2560
 v_mfma_f32_16x16x32_bf16 a[52:55], v[148:151], v[60:63], a[52:55]
 ds_read_b64_tr_b16 v[136:137], v11 offset:0
 ds_read_b64_tr_b16 v[138:139], v11 offset:512
 v_mfma_f32_16x16x32_bf16 a[52:55], v[144:147], v[56:59], a[52:55]
 s_waitcnt lgkmcnt(6)
 ds_read_b64_tr_b16 v[140:141], v11 offset:2048
 ds_read_b64_tr_b16 v[142:143], v11 offset:2560
 v_mfma_f32_16x16x32_bf16 a[56:59], v[152:155], v[40:43], a[56:59]
 ds_read_b64_tr_b16 v[144:145], v10 offset:8192
 v_mfma_f32_16x16x32_bf16 a[56:59], v[156:159], v[44:47], a[56:59]
 ds_read_b64_tr_b16 v[146:147], v10 offset:8704
 buffer_load_dwordx4 v[108:111], v14, s[40:43], s98 offen offset:3072 sc1
 v_mfma_f32_16x16x32_bf16 a[60:63], v[156:159], v[60:63], a[60:63]
 ds_read_b64_tr_b16 v[148:149], v10 offset:10240
 buffer_load_dwordx4 v[124:127], v15, s[40:43], s98 offen offset:3072 sc1
 v_mfma_f32_16x16x32_bf16 a[60:63], v[152:155], v[56:59], a[60:63]
 ds_read_b64_tr_b16 v[150:151], v10 offset:10752
 s_waitcnt vmcnt(16) lgkmcnt(8)
 v_mfma_f32_16x16x32_bf16 a[32:35], v[128:131], v[64:67], a[32:35]
 s_add_u32 m0, s80, 0
 ds_read_b64_tr_b16 v[152:153], v11 offset:8192
 v_mfma_f32_16x16x32_bf16 a[32:35], v[132:135], v[68:71], a[32:35]
 ds_read_b64_tr_b16 v[154:155], v11 offset:8704
 buffer_load_dwordx4 v178, s[64:67], s76 offen offset:0 lds
 v_mfma_f32_16x16x32_bf16 a[36:39], v[132:135], v[84:87], a[36:39]
 s_add_u32 m0, s80, 8128
 ds_read_b64_tr_b16 v[156:157], v11 offset:10240
 buffer_load_dwordx4 v178, s[64:67], s76 offen offset:64 lds
 v_mfma_f32_16x16x32_bf16 a[36:39], v[128:131], v[80:83], a[36:39]
 s_waitcnt lgkmcnt(7)
 ds_read_b64_tr_b16 v[158:159], v11 offset:10752
 v_mfma_f32_16x16x32_bf16 a[40:43], v[136:139], v[64:67], a[40:43]
 s_add_u32 m0, s80, 1024
 ds_read_b64_tr_b16 v[128:129], v10 offset:4096
 v_mfma_f32_16x16x32_bf16 a[40:43], v[140:143], v[68:71], a[40:43]
 ds_read_b64_tr_b16 v[130:131], v10 offset:4608
 buffer_load_dwordx4 v179, s[64:67], s76 offen offset:0 lds
 v_mfma_f32_16x16x32_bf16 a[44:47], v[140:143], v[84:87], a[44:47]
 s_add_u32 m0, s80, 9152
 ds_read_b64_tr_b16 v[132:133], v10 offset:6144
 buffer_load_dwordx4 v179, s[64:67], s76 offen offset:64 lds
 v_mfma_f32_16x16x32_bf16 a[44:47], v[136:139], v[80:83], a[44:47]
 s_waitcnt lgkmcnt(7)
 ds_read_b64_tr_b16 v[134:135], v10 offset:6656
 v_mfma_f32_16x16x32_bf16 a[48:51], v[144:147], v[64:67], a[48:51]
 s_add_u32 s80, s80, 16384
 ds_read_b64_tr_b16 v[136:137], v11 offset:4096
 v_mfma_f32_16x16x32_bf16 a[48:51], v[148:151], v[68:71], a[48:51]
 s_and_b32 s80, s80, 65535
 ds_read_b64_tr_b16 v[138:139], v11 offset:4608
 buffer_load_dwordx4 v[32:35], v14, s[40:43], s96 offen offset:0 sc1
 v_mfma_f32_16x16x32_bf16 a[52:55], v[148:151], v[84:87], a[52:55]
 s_add_u32 s79, s79, 16384
 ds_read_b64_tr_b16 v[140:141], v11 offset:6144
 v_mfma_f32_16x16x32_bf16 a[52:55], v[144:147], v[80:83], a[52:55]
 s_waitcnt lgkmcnt(7)
 ds_read_b64_tr_b16 v[142:143], v11 offset:6656
 v_mfma_f32_16x16x32_bf16 a[56:59], v[152:155], v[64:67], a[56:59]
 s_and_b32 s79, s79, 65535
 ds_read_b64_tr_b16 v[144:145], v10 offset:12288
 buffer_load_dwordx4 v[48:51], v15, s[40:43], s96 offen offset:0 sc1
 v_mfma_f32_16x16x32_bf16 a[56:59], v[156:159], v[68:71], a[56:59]
 s_lshl_b32 s6, s88, 12
 ds_read_b64_tr_b16 v[146:147], v10 offset:12800
 v_mfma_f32_16x16x32_bf16 a[60:63], v[156:159], v[84:87], a[60:63]
 s_add_u32 s97, s91, s6
 ds_read_b64_tr_b16 v[148:149], v10 offset:14336
 v_mfma_f32_16x16x32_bf16 a[60:63], v[152:155], v[80:83], a[60:63]
 s_waitcnt vmcnt(18) lgkmcnt(7)
 ds_read_b64_tr_b16 v[150:151], v10 offset:14848
 v_mfma_f32_16x16x32_bf16 a[32:35], v[128:131], v[72:75], a[32:35]
 s_add_u32 s88, s88, 1
 ds_read_b64_tr_b16 v[152:153], v11 offset:12288
 buffer_load_dwordx4 v[36:39], v14, s[40:43], s96 offen offset:1024 sc1
 v_mfma_f32_16x16x32_bf16 a[32:35], v[132:135], v[76:79], a[32:35]
 s_and_b32 s88, s88, 7
 ds_read_b64_tr_b16 v[154:155], v11 offset:12800
 v_mfma_f32_16x16x32_bf16 a[36:39], v[132:135], v[92:95], a[36:39]
 s_lshl_b32 s7, s88, 18
 ds_read_b64_tr_b16 v[156:157], v11 offset:14336
 v_mfma_f32_16x16x32_bf16 a[36:39], v[128:131], v[88:91], a[36:39]
 s_waitcnt lgkmcnt(7)
 ds_read_b64_tr_b16 v[158:159], v11 offset:14848
 v_mfma_f32_16x16x32_bf16 a[40:43], v[136:139], v[72:75], a[40:43]
 s_add_u32 s76, s87, s7
 buffer_load_dwordx4 v[52:55], v15, s[40:43], s96 offen offset:1024 sc1
 v_mfma_f32_16x16x32_bf16 a[40:43], v[140:143], v[76:79], a[40:43]
 buffer_load_dwordx4 v[40:43], v14, s[40:43], s96 offen offset:2048 sc1
 v_mfma_f32_16x16x32_bf16 a[44:47], v[140:143], v[92:95], a[44:47]
 buffer_load_dwordx4 v[56:59], v15, s[40:43], s96 offen offset:2048 sc1
 v_mfma_f32_16x16x32_bf16 a[44:47], v[136:139], v[88:91], a[44:47]
 s_waitcnt vmcnt(30) lgkmcnt(0)
 s_barrier
 v_add_u32 v10, s79, v8
 v_add_u32 v11, s79, v9
 v_mfma_f32_16x16x32_bf16 a[48:51], v[144:147], v[72:75], a[48:51]
 ds_read_b64_tr_b16 v[128:129], v10 offset:0
 ds_read_b64_tr_b16 v[130:131], v10 offset:512
 v_mfma_f32_16x16x32_bf16 a[48:51], v[148:151], v[76:79], a[48:51]
 ds_read_b64_tr_b16 v[132:133], v10 offset:2048
 ds_read_b64_tr_b16 v[134:135], v10 offset:2560
 v_mfma_f32_16x16x32_bf16 a[52:55], v[148:151], v[92:95], a[52:55]
 ds_read_b64_tr_b16 v[136:137], v11 offset:0
 ds_read_b64_tr_b16 v[138:139], v11 offset:512
 v_mfma_f32_16x16x32_bf16 a[52:55], v[144:147], v[88:91], a[52:55]
 s_waitcnt lgkmcnt(6)
 ds_read_b64_tr_b16 v[140:141], v11 offset:2048
 ds_read_b64_tr_b16 v[142:143], v11 offset:2560
 v_mfma_f32_16x16x32_bf16 a[56:59], v[152:155], v[72:75], a[56:59]
 ds_read_b64_tr_b16 v[144:145], v10 offset:8192
 v_mfma_f32_16x16x32_bf16 a[56:59], v[156:159], v[76:79], a[56:59]
 ds_read_b64_tr_b16 v[146:147], v10 offset:8704
 buffer_load_dwordx4 v[44:47], v14, s[40:43], s96 offen offset:3072 sc1
 v_mfma_f32_16x16x32_bf16 a[60:63], v[156:159], v[92:95], a[60:63]
 ds_read_b64_tr_b16 v[148:149], v10 offset:10240
 buffer_load_dwordx4 v[60:63], v15, s[40:43], s96 offen offset:3072 sc1
 v_mfma_f32_16x16x32_bf16 a[60:63], v[152:155], v[88:91], a[60:63]
 ds_read_b64_tr_b16 v[150:151], v10 offset:10752
 s_waitcnt vmcnt(16) lgkmcnt(8)
 v_mfma_f32_16x16x32_bf16 a[32:35], v[128:131], v[96:99], a[32:35]
 s_add_u32 m0, s80, 0
 ds_read_b64_tr_b16 v[152:153], v11 offset:8192
 v_mfma_f32_16x16x32_bf16 a[32:35], v[132:135], v[100:103], a[32:35]
 ds_read_b64_tr_b16 v[154:155], v11 offset:8704
 buffer_load_dwordx4 v178, s[64:67], s76 offen offset:0 lds
 v_mfma_f32_16x16x32_bf16 a[36:39], v[132:135], v[116:119], a[36:39]
 s_add_u32 m0, s80, 8128
 ds_read_b64_tr_b16 v[156:157], v11 offset:10240
 buffer_load_dwordx4 v178, s[64:67], s76 offen offset:64 lds
 v_mfma_f32_16x16x32_bf16 a[36:39], v[128:131], v[112:115], a[36:39]
 s_waitcnt lgkmcnt(7)
 ds_read_b64_tr_b16 v[158:159], v11 offset:10752
 v_mfma_f32_16x16x32_bf16 a[40:43], v[136:139], v[96:99], a[40:43]
 s_add_u32 m0, s80, 1024
 ds_read_b64_tr_b16 v[128:129], v10 offset:4096
 v_mfma_f32_16x16x32_bf16 a[40:43], v[140:143], v[100:103], a[40:43]
 ds_read_b64_tr_b16 v[130:131], v10 offset:4608
 buffer_load_dwordx4 v179, s[64:67], s76 offen offset:0 lds
 v_mfma_f32_16x16x32_bf16 a[44:47], v[140:143], v[116:119], a[44:47]
 s_add_u32 m0, s80, 9152
 ds_read_b64_tr_b16 v[132:133], v10 offset:6144
 buffer_load_dwordx4 v179, s[64:67], s76 offen offset:64 lds
 v_mfma_f32_16x16x32_bf16 a[44:47], v[136:139], v[112:115], a[44:47]
 s_waitcnt lgkmcnt(7)
 ds_read_b64_tr_b16 v[134:135], v10 offset:6656
 v_mfma_f32_16x16x32_bf16 a[48:51], v[144:147], v[96:99], a[48:51]
 s_add_u32 s80, s80, 16384
 ds_read_b64_tr_b16 v[136:137], v11 offset:4096
 v_mfma_f32_16x16x32_bf16 a[48:51], v[148:151], v[100:103], a[48:51]
 s_and_b32 s80, s80, 65535
 ds_read_b64_tr_b16 v[138:139], v11 offset:4608
 buffer_load_dwordx4 v[64:67], v14, s[40:43], s97 offen offset:0 sc1
 v_mfma_f32_16x16x32_bf16 a[52:55], v[148:151], v[116:119], a[52:55]
 s_add_u32 s79, s79, 16384
 ds_read_b64_tr_b16 v[140:141], v11 offset:6144
 v_mfma_f32_16x16x32_bf16 a[52:55], v[144:147], v[112:115], a[52:55]
 s_waitcnt lgkmcnt(7)
 ds_read_b64_tr_b16 v[142:143], v11 offset:6656
 v_mfma_f32_16x16x32_bf16 a[56:59], v[152:155], v[96:99], a[56:59]
 s_and_b32 s79, s79, 65535
 ds_read_b64_tr_b16 v[144:145], v10 offset:12288
 buffer_load_dwordx4 v[80:83], v15, s[40:43], s97 offen offset:0 sc1
 v_mfma_f32_16x16x32_bf16 a[56:59], v[156:159], v[100:103], a[56:59]
 s_lshl_b32 s6, s88, 12
 ds_read_b64_tr_b16 v[146:147], v10 offset:12800
 v_mfma_f32_16x16x32_bf16 a[60:63], v[156:159], v[116:119], a[60:63]
 s_add_u32 s98, s91, s6
 ds_read_b64_tr_b16 v[148:149], v10 offset:14336
 v_mfma_f32_16x16x32_bf16 a[60:63], v[152:155], v[112:115], a[60:63]
 s_waitcnt vmcnt(18) lgkmcnt(7)
 ds_read_b64_tr_b16 v[150:151], v10 offset:14848
 v_mfma_f32_16x16x32_bf16 a[32:35], v[128:131], v[104:107], a[32:35]
 s_add_u32 s88, s88, 1
 ds_read_b64_tr_b16 v[152:153], v11 offset:12288
 buffer_load_dwordx4 v[68:71], v14, s[40:43], s97 offen offset:1024 sc1
 v_mfma_f32_16x16x32_bf16 a[32:35], v[132:135], v[108:111], a[32:35]
 s_and_b32 s88, s88, 7
 ds_read_b64_tr_b16 v[154:155], v11 offset:12800
 v_mfma_f32_16x16x32_bf16 a[36:39], v[132:135], v[124:127], a[36:39]
 s_lshl_b32 s7, s88, 18
 ds_read_b64_tr_b16 v[156:157], v11 offset:14336
 v_mfma_f32_16x16x32_bf16 a[36:39], v[128:131], v[120:123], a[36:39]
 s_waitcnt lgkmcnt(7)
 ds_read_b64_tr_b16 v[158:159], v11 offset:14848
 v_mfma_f32_16x16x32_bf16 a[40:43], v[136:139], v[104:107], a[40:43]
 s_add_u32 s76, s87, s7
 buffer_load_dwordx4 v[84:87], v15, s[40:43], s97 offen offset:1024 sc1
 v_mfma_f32_16x16x32_bf16 a[40:43], v[140:143], v[108:111], a[40:43]
 buffer_load_dwordx4 v[72:75], v14, s[40:43], s97 offen offset:2048 sc1
 v_mfma_f32_16x16x32_bf16 a[44:47], v[140:143], v[124:127], a[44:47]
 buffer_load_dwordx4 v[88:91], v15, s[40:43], s97 offen offset:2048 sc1
 v_mfma_f32_16x16x32_bf16 a[44:47], v[136:139], v[120:123], a[44:47]
 s_waitcnt vmcnt(30) lgkmcnt(0)
 s_barrier
 v_add_u32 v10, s79, v8
 v_add_u32 v11, s79, v9
 v_mfma_f32_16x16x32_bf16 a[48:51], v[144:147], v[104:107], a[48:51]
 ds_read_b64_tr_b16 v[128:129], v10 offset:0
 ds_read_b64_tr_b16 v[130:131], v10 offset:512
 v_mfma_f32_16x16x32_bf16 a[48:51], v[148:151], v[108:111], a[48:51]
 ds_read_b64_tr_b16 v[132:133], v10 offset:2048
 ds_read_b64_tr_b16 v[134:135], v10 offset:2560
 v_mfma_f32_16x16x32_bf16 a[52:55], v[148:151], v[124:127], a[52:55]
 ds_read_b64_tr_b16 v[136:137], v11 offset:0
 ds_read_b64_tr_b16 v[138:139], v11 offset:512
 v_mfma_f32_16x16x32_bf16 a[52:55], v[144:147], v[120:123], a[52:55]
 s_waitcnt lgkmcnt(6)
 ds_read_b64_tr_b16 v[140:141], v11 offset:2048
 ds_read_b64_tr_b16 v[142:143], v11 offset:2560
 v_mfma_f32_16x16x32_bf16 a[56:59], v[152:155], v[104:107], a[56:59]
 ds_read_b64_tr_b16 v[144:145], v10 offset:8192
 v_mfma_f32_16x16x32_bf16 a[56:59], v[156:159], v[108:111], a[56:59]
 ds_read_b64_tr_b16 v[146:147], v10 offset:8704
 buffer_load_dwordx4 v[76:79], v14, s[40:43], s97 offen offset:3072 sc1
 v_mfma_f32_16x16x32_bf16 a[60:63], v[156:159], v[124:127], a[60:63]
 ds_read_b64_tr_b16 v[148:149], v10 offset:10240
 buffer_load_dwordx4 v[92:95], v15, s[40:43], s97 offen offset:3072 sc1
 v_mfma_f32_16x16x32_bf16 a[60:63], v[152:155], v[120:123], a[60:63]
 ds_read_b64_tr_b16 v[150:151], v10 offset:10752
 s_waitcnt vmcnt(16) lgkmcnt(8)
 v_mfma_f32_16x16x32_bf16 a[32:35], v[128:131], v[32:35], a[32:35]
 ds_read_b64_tr_b16 v[152:153], v11 offset:8192
 v_mfma_f32_16x16x32_bf16 a[32:35], v[132:135], v[36:39], a[32:35]
 ds_read_b64_tr_b16 v[154:155], v11 offset:8704
 v_mfma_f32_16x16x32_bf16 a[36:39], v[132:135], v[52:55], a[36:39]
 ds_read_b64_tr_b16 v[156:157], v11 offset:10240
 v_mfma_f32_16x16x32_bf16 a[36:39], v[128:131], v[48:51], a[36:39]
 s_waitcnt lgkmcnt(7)
 ds_read_b64_tr_b16 v[158:159], v11 offset:10752
 v_mfma_f32_16x16x32_bf16 a[40:43], v[136:139], v[32:35], a[40:43]
 ds_read_b64_tr_b16 v[128:129], v10 offset:4096
 v_mfma_f32_16x16x32_bf16 a[40:43], v[140:143], v[36:39], a[40:43]
 ds_read_b64_tr_b16 v[130:131], v10 offset:4608
 v_mfma_f32_16x16x32_bf16 a[44:47], v[140:143], v[52:55], a[44:47]
 ds_read_b64_tr_b16 v[132:133], v10 offset:6144
 v_mfma_f32_16x16x32_bf16 a[44:47], v[136:139], v[48:51], a[44:47]
 s_waitcnt lgkmcnt(7)
 ds_read_b64_tr_b16 v[134:135], v10 offset:6656
 v_mfma_f32_16x16x32_bf16 a[48:51], v[144:147], v[32:35], a[48:51]
 s_add_u32 s79, s79, 16384
 ds_read_b64_tr_b16 v[136:137], v11 offset:4096
 v_mfma_f32_16x16x32_bf16 a[48:51], v[148:151], v[36:39], a[48:51]
 s_and_b32 s79, s79, 65535
 ds_read_b64_tr_b16 v[138:139], v11 offset:4608
 buffer_load_dwordx4 v[96:99], v14, s[40:43], s98 offen offset:0 sc1
 v_mfma_f32_16x16x32_bf16 a[52:55], v[148:151], v[52:55], a[52:55]
 ds_read_b64_tr_b16 v[140:141], v11 offset:6144
 v_mfma_f32_16x16x32_bf16 a[52:55], v[144:147], v[48:51], a[52:55]
 s_waitcnt lgkmcnt(7)
 ds_read_b64_tr_b16 v[142:143], v11 offset:6656
 v_mfma_f32_16x16x32_bf16 a[56:59], v[152:155], v[32:35], a[56:59]
 ds_read_b64_tr_b16 v[144:145], v10 offset:12288
 buffer_load_dwordx4 v[112:115], v15, s[40:43], s98 offen offset:0 sc1
 v_mfma_f32_16x16x32_bf16 a[56:59], v[156:159], v[36:39], a[56:59]
 ds_read_b64_tr_b16 v[146:147], v10 offset:12800
 v_mfma_f32_16x16x32_bf16 a[60:63], v[156:159], v[52:55], a[60:63]
 ds_read_b64_tr_b16 v[148:149], v10 offset:14336
 v_mfma_f32_16x16x32_bf16 a[60:63], v[152:155], v[48:51], a[60:63]
 s_waitcnt vmcnt(14) lgkmcnt(7)
 ds_read_b64_tr_b16 v[150:151], v10 offset:14848
 v_mfma_f32_16x16x32_bf16 a[32:35], v[128:131], v[40:43], a[32:35]
 ds_read_b64_tr_b16 v[152:153], v11 offset:12288
 buffer_load_dwordx4 v[100:103], v14, s[40:43], s98 offen offset:1024 sc1
 v_mfma_f32_16x16x32_bf16 a[32:35], v[132:135], v[44:47], a[32:35]
 ds_read_b64_tr_b16 v[154:155], v11 offset:12800
 v_mfma_f32_16x16x32_bf16 a[36:39], v[132:135], v[60:63], a[36:39]
 ds_read_b64_tr_b16 v[156:157], v11 offset:14336
 v_mfma_f32_16x16x32_bf16 a[36:39], v[128:131], v[56:59], a[36:39]
 s_waitcnt lgkmcnt(7)
 ds_read_b64_tr_b16 v[158:159], v11 offset:14848
 v_mfma_f32_16x16x32_bf16 a[40:43], v[136:139], v[40:43], a[40:43]
 buffer_load_dwordx4 v[116:119], v15, s[40:43], s98 offen offset:1024 sc1
 v_mfma_f32_16x16x32_bf16 a[40:43], v[140:143], v[44:47], a[40:43]
 buffer_load_dwordx4 v[104:107], v14, s[40:43], s98 offen offset:2048 sc1
 v_mfma_f32_16x16x32_bf16 a[44:47], v[140:143], v[60:63], a[44:47]
 buffer_load_dwordx4 v[120:123], v15, s[40:43], s98 offen offset:2048 sc1
 v_mfma_f32_16x16x32_bf16 a[44:47], v[136:139], v[56:59], a[44:47]
 s_waitcnt vmcnt(26) lgkmcnt(0)
 s_barrier
 v_add_u32 v10, s79, v8
 v_add_u32 v11, s79, v9
 v_mfma_f32_16x16x32_bf16 a[48:51], v[144:147], v[40:43], a[48:51]
 ds_read_b64_tr_b16 v[128:129], v10 offset:0
 ds_read_b64_tr_b16 v[130:131], v10 offset:512
 v_mfma_f32_16x16x32_bf16 a[48:51], v[148:151], v[44:47], a[48:51]
 ds_read_b64_tr_b16 v[132:133], v10 offset:2048
 ds_read_b64_tr_b16 v[134:135], v10 offset:2560
 v_mfma_f32_16x16x32_bf16 a[52:55], v[148:151], v[60:63], a[52:55]
 ds_read_b64_tr_b16 v[136:137], v11 offset:0
 ds_read_b64_tr_b16 v[138:139], v11 offset:512
 v_mfma_f32_16x16x32_bf16 a[52:55], v[144:147], v[56:59], a[52:55]
 s_waitcnt lgkmcnt(6)
 ds_read_b64_tr_b16 v[140:141], v11 offset:2048
 ds_read_b64_tr_b16 v[142:143], v11 offset:2560
 v_mfma_f32_16x16x32_bf16 a[56:59], v[152:155], v[40:43], a[56:59]
 ds_read_b64_tr_b16 v[144:145], v10 offset:8192
 v_mfma_f32_16x16x32_bf16 a[56:59], v[156:159], v[44:47], a[56:59]
 ds_read_b64_tr_b16 v[146:147], v10 offset:8704
 buffer_load_dwordx4 v[108:111], v14, s[40:43], s98 offen offset:3072 sc1
 v_mfma_f32_16x16x32_bf16 a[60:63], v[156:159], v[60:63], a[60:63]
 ds_read_b64_tr_b16 v[148:149], v10 offset:10240
 buffer_load_dwordx4 v[124:127], v15, s[40:43], s98 offen offset:3072 sc1
 v_mfma_f32_16x16x32_bf16 a[60:63], v[152:155], v[56:59], a[60:63]
 ds_read_b64_tr_b16 v[150:151], v10 offset:10752
 s_waitcnt vmcnt(12) lgkmcnt(8)
 v_mfma_f32_16x16x32_bf16 a[32:35], v[128:131], v[64:67], a[32:35]
 ds_read_b64_tr_b16 v[152:153], v11 offset:8192
 v_mfma_f32_16x16x32_bf16 a[32:35], v[132:135], v[68:71], a[32:35]
 ds_read_b64_tr_b16 v[154:155], v11 offset:8704
 v_mfma_f32_16x16x32_bf16 a[36:39], v[132:135], v[84:87], a[36:39]
 ds_read_b64_tr_b16 v[156:157], v11 offset:10240
 v_mfma_f32_16x16x32_bf16 a[36:39], v[128:131], v[80:83], a[36:39]
 s_waitcnt lgkmcnt(7)
 ds_read_b64_tr_b16 v[158:159], v11 offset:10752
 v_mfma_f32_16x16x32_bf16 a[40:43], v[136:139], v[64:67], a[40:43]
 ds_read_b64_tr_b16 v[128:129], v10 offset:4096
 v_mfma_f32_16x16x32_bf16 a[40:43], v[140:143], v[68:71], a[40:43]
 ds_read_b64_tr_b16 v[130:131], v10 offset:4608
 v_mfma_f32_16x16x32_bf16 a[44:47], v[140:143], v[84:87], a[44:47]
 ds_read_b64_tr_b16 v[132:133], v10 offset:6144
 v_mfma_f32_16x16x32_bf16 a[44:47], v[136:139], v[80:83], a[44:47]
 s_waitcnt lgkmcnt(7)
 ds_read_b64_tr_b16 v[134:135], v10 offset:6656
 v_mfma_f32_16x16x32_bf16 a[48:51], v[144:147], v[64:67], a[48:51]
 s_add_u32 s79, s79, 16384
 ds_read_b64_tr_b16 v[136:137], v11 offset:4096
 v_mfma_f32_16x16x32_bf16 a[48:51], v[148:151], v[68:71], a[48:51]
 s_and_b32 s79, s79, 65535
 ds_read_b64_tr_b16 v[138:139], v11 offset:4608
 v_mfma_f32_16x16x32_bf16 a[52:55], v[148:151], v[84:87], a[52:55]
 ds_read_b64_tr_b16 v[140:141], v11 offset:6144
 v_mfma_f32_16x16x32_bf16 a[52:55], v[144:147], v[80:83], a[52:55]
 s_waitcnt lgkmcnt(7)
 ds_read_b64_tr_b16 v[142:143], v11 offset:6656
 v_mfma_f32_16x16x32_bf16 a[56:59], v[152:155], v[64:67], a[56:59]
 ds_read_b64_tr_b16 v[144:145], v10 offset:12288
 v_mfma_f32_16x16x32_bf16 a[56:59], v[156:159], v[68:71], a[56:59]
 ds_read_b64_tr_b16 v[146:147], v10 offset:12800
 v_mfma_f32_16x16x32_bf16 a[60:63], v[156:159], v[84:87], a[60:63]
 ds_read_b64_tr_b16 v[148:149], v10 offset:14336
 v_mfma_f32_16x16x32_bf16 a[60:63], v[152:155], v[80:83], a[60:63]
 s_waitcnt vmcnt(8) lgkmcnt(7)
 ds_read_b64_tr_b16 v[150:151], v10 offset:14848
 v_mfma_f32_16x16x32_bf16 a[32:35], v[128:131], v[72:75], a[32:35]
 ds_read_b64_tr_b16 v[152:153], v11 offset:12288
 v_mfma_f32_16x16x32_bf16 a[32:35], v[132:135], v[76:79], a[32:35]
 ds_read_b64_tr_b16 v[154:155], v11 offset:12800
 v_mfma_f32_16x16x32_bf16 a[36:39], v[132:135], v[92:95], a[36:39]
 ds_read_b64_tr_b16 v[156:157], v11 offset:14336
 v_mfma_f32_16x16x32_bf16 a[36:39], v[128:131], v[88:91], a[36:39]
 s_waitcnt lgkmcnt(7)
 ds_read_b64_tr_b16 v[158:159], v11 offset:14848
 v_mfma_f32_16x16x32_bf16 a[40:43], v[136:139], v[72:75], a[40:43]
 v_mfma_f32_16x16x32_bf16 a[40:43], v[140:143], v[76:79], a[40:43]
 v_mfma_f32_16x16x32_bf16 a[44:47], v[140:143], v[92:95], a[44:47]
 v_mfma_f32_16x16x32_bf16 a[44:47], v[136:139], v[88:91], a[44:47]
 s_waitcnt vmcnt(16) lgkmcnt(0)
 s_barrier
 v_add_u32 v10, s79, v8
 v_add_u32 v11, s79, v9
 v_mfma_f32_16x16x32_bf16 a[48:51], v[144:147], v[72:75], a[48:51]
 ds_read_b64_tr_b16 v[128:129], v10 offset:0
 ds_read_b64_tr_b16 v[130:131], v10 offset:512
 v_mfma_f32_16x16x32_bf16 a[48:51], v[148:151], v[76:79], a[48:51]
 ds_read_b64_tr_b16 v[132:133], v10 offset:2048
 ds_read_b64_tr_b16 v[134:135], v10 offset:2560
 v_mfma_f32_16x16x32_bf16 a[52:55], v[148:151], v[92:95], a[52:55]
 ds_read_b64_tr_b16 v[136:137], v11 offset:0
 ds_read_b64_tr_b16 v[138:139], v11 offset:512
 v_mfma_f32_16x16x32_bf16 a[52:55], v[144:147], v[88:91], a[52:55]
 s_waitcnt lgkmcnt(6)
 ds_read_b64_tr_b16 v[140:141], v11 offset:2048
 ds_read_b64_tr_b16 v[142:143], v11 offset:2560
 v_mfma_f32_16x16x32_bf16 a[56:59], v[152:155], v[72:75], a[56:59]
 ds_read_b64_tr_b16 v[144:145], v10 offset:8192
 v_mfma_f32_16x16x32_bf16 a[56:59], v[156:159], v[76:79], a[56:59]
 ds_read_b64_tr_b16 v[146:147], v10 offset:8704
 v_mfma_f32_16x16x32_bf16 a[60:63], v[156:159], v[92:95], a[60:63]
 ds_read_b64_tr_b16 v[148:149], v10 offset:10240
 v_mfma_f32_16x16x32_bf16 a[60:63], v[152:155], v[88:91], a[60:63]
 ds_read_b64_tr_b16 v[150:151], v10 offset:10752
 s_waitcnt vmcnt(4) lgkmcnt(8)
 v_mfma_f32_16x16x32_bf16 a[32:35], v[128:131], v[96:99], a[32:35]
 ds_read_b64_tr_b16 v[152:153], v11 offset:8192
 v_mfma_f32_16x16x32_bf16 a[32:35], v[132:135], v[100:103], a[32:35]
 ds_read_b64_tr_b16 v[154:155], v11 offset:8704
 v_mfma_f32_16x16x32_bf16 a[36:39], v[132:135], v[116:119], a[36:39]
 ds_read_b64_tr_b16 v[156:157], v11 offset:10240
 v_mfma_f32_16x16x32_bf16 a[36:39], v[128:131], v[112:115], a[36:39]
 s_waitcnt lgkmcnt(7)
 ds_read_b64_tr_b16 v[158:159], v11 offset:10752
 v_mfma_f32_16x16x32_bf16 a[40:43], v[136:139], v[96:99], a[40:43]
 ds_read_b64_tr_b16 v[128:129], v10 offset:4096
 v_mfma_f32_16x16x32_bf16 a[40:43], v[140:143], v[100:103], a[40:43]
 ds_read_b64_tr_b16 v[130:131], v10 offset:4608
 v_mfma_f32_16x16x32_bf16 a[44:47], v[140:143], v[116:119], a[44:47]
 ds_read_b64_tr_b16 v[132:133], v10 offset:6144
 v_mfma_f32_16x16x32_bf16 a[44:47], v[136:139], v[112:115], a[44:47]
 s_waitcnt lgkmcnt(7)
 ds_read_b64_tr_b16 v[134:135], v10 offset:6656
 v_mfma_f32_16x16x32_bf16 a[48:51], v[144:147], v[96:99], a[48:51]
 ds_read_b64_tr_b16 v[136:137], v11 offset:4096
 v_mfma_f32_16x16x32_bf16 a[48:51], v[148:151], v[100:103], a[48:51]
 ds_read_b64_tr_b16 v[138:139], v11 offset:4608
 v_mfma_f32_16x16x32_bf16 a[52:55], v[148:151], v[116:119], a[52:55]
 ds_read_b64_tr_b16 v[140:141], v11 offset:6144
 v_mfma_f32_16x16x32_bf16 a[52:55], v[144:147], v[112:115], a[52:55]
 s_waitcnt lgkmcnt(7)
 ds_read_b64_tr_b16 v[142:143], v11 offset:6656
 v_mfma_f32_16x16x32_bf16 a[56:59], v[152:155], v[96:99], a[56:59]
 ds_read_b64_tr_b16 v[144:145], v10 offset:12288
 v_mfma_f32_16x16x32_bf16 a[56:59], v[156:159], v[100:103], a[56:59]
 ds_read_b64_tr_b16 v[146:147], v10 offset:12800
 v_mfma_f32_16x16x32_bf16 a[60:63], v[156:159], v[116:119], a[60:63]
 ds_read_b64_tr_b16 v[148:149], v10 offset:14336
 v_mfma_f32_16x16x32_bf16 a[60:63], v[152:155], v[112:115], a[60:63]
 s_waitcnt vmcnt(0) lgkmcnt(7)
 ds_read_b64_tr_b16 v[150:151], v10 offset:14848
 v_mfma_f32_16x16x32_bf16 a[32:35], v[128:131], v[104:107], a[32:35]
 ds_read_b64_tr_b16 v[152:153], v11 offset:12288
 v_mfma_f32_16x16x32_bf16 a[32:35], v[132:135], v[108:111], a[32:35]
 ds_read_b64_tr_b16 v[154:155], v11 offset:12800
 v_mfma_f32_16x16x32_bf16 a[36:39], v[132:135], v[124:127], a[36:39]
 ds_read_b64_tr_b16 v[156:157], v11 offset:14336
 v_mfma_f32_16x16x32_bf16 a[36:39], v[128:131], v[120:123], a[36:39]
 s_waitcnt lgkmcnt(7)
 ds_read_b64_tr_b16 v[158:159], v11 offset:14848
 v_mfma_f32_16x16x32_bf16 a[40:43], v[136:139], v[104:107], a[40:43]
 v_mfma_f32_16x16x32_bf16 a[40:43], v[140:143], v[108:111], a[40:43]
 v_mfma_f32_16x16x32_bf16 a[44:47], v[140:143], v[124:127], a[44:47]
 v_mfma_f32_16x16x32_bf16 a[44:47], v[136:139], v[120:123], a[44:47]
 s_waitcnt lgkmcnt(4)
 v_mfma_f32_16x16x32_bf16 a[48:51], v[144:147], v[104:107], a[48:51]
 v_mfma_f32_16x16x32_bf16 a[48:51], v[148:151], v[108:111], a[48:51]
 v_mfma_f32_16x16x32_bf16 a[52:55], v[148:151], v[124:127], a[52:55]
 v_mfma_f32_16x16x32_bf16 a[52:55], v[144:147], v[120:123], a[52:55]
 s_waitcnt lgkmcnt(0)
 v_mfma_f32_16x16x32_bf16 a[56:59], v[152:155], v[104:107], a[56:59]
 v_mfma_f32_16x16x32_bf16 a[56:59], v[156:159], v[108:111], a[56:59]
 v_mfma_f32_16x16x32_bf16 a[60:63], v[156:159], v[124:127], a[60:63]
 v_mfma_f32_16x16x32_bf16 a[60:63], v[152:155], v[120:123], a[60:63]
 s_nop 7
 s_waitcnt vmcnt(63)
 v_accvgpr_read_b32 v32, a0
 v_accvgpr_read_b32 v33, a1
 v_accvgpr_read_b32 v34, a2
 v_accvgpr_read_b32 v35, a3
 v_accvgpr_read_b32 v36, a8
 v_accvgpr_read_b32 v37, a9
 v_accvgpr_read_b32 v38, a10
 v_accvgpr_read_b32 v39, a11
 v_accvgpr_read_b32 v40, a32
 v_accvgpr_read_b32 v41, a33
 v_accvgpr_read_b32 v42, a34
 v_accvgpr_read_b32 v43, a35
 v_accvgpr_read_b32 v44, a40
 v_accvgpr_read_b32 v45, a41
 v_accvgpr_read_b32 v46, a42
 v_accvgpr_read_b32 v47, a43
 v_lshlrev_b32 v48, 16, v160
 v_and_b32 v49, s5, v160
 v_lshlrev_b32 v50, 16, v161
 v_and_b32 v51, s5, v161
 v_lshlrev_b32 v52, 16, v162
 v_and_b32 v53, s5, v162
 v_lshlrev_b32 v54, 16, v163
 v_and_b32 v55, s5, v163
 v_fmac_f32 v48, v40, v32
 v_fmac_f32 v49, v41, v33
 v_fmac_f32 v50, v42, v34
 v_fmac_f32 v51, v43, v35
 v_fmac_f32 v52, v44, v36
 v_fmac_f32 v53, v45, v37
 v_fmac_f32 v54, v46, v38
 v_fmac_f32 v55, v47, v39
 v_cvt_pk_bf16_f32 v56, v48, v49
 v_cvt_pk_bf16_f32 v57, v50, v51
 v_cvt_pk_bf16_f32 v58, v52, v53
 v_cvt_pk_bf16_f32 v59, v54, v55
 s_mov_b32 s84, 0
 s_nop 0
 v_permlane16_swap_b32 v56, v58
 v_permlane16_swap_b32 v57, v59
 v_accvgpr_read_b32 v60, a16
 v_accvgpr_read_b32 v61, a17
 v_accvgpr_read_b32 v62, a18
 v_accvgpr_read_b32 v63, a19
 v_accvgpr_read_b32 v64, a24
 v_accvgpr_read_b32 v65, a25
 v_accvgpr_read_b32 v66, a26
 v_accvgpr_read_b32 v67, a27
 v_accvgpr_read_b32 v68, a48
 v_accvgpr_read_b32 v69, a49
 v_accvgpr_read_b32 v70, a50
 v_accvgpr_read_b32 v71, a51
 v_accvgpr_read_b32 v72, a56
 v_accvgpr_read_b32 v73, a57
 v_accvgpr_read_b32 v74, a58
 v_accvgpr_read_b32 v75, a59
 v_lshlrev_b32 v76, 16, v164
 v_and_b32 v77, s5, v164
 v_lshlrev_b32 v78, 16, v165
 v_and_b32 v79, s5, v165
 v_lshlrev_b32 v80, 16, v166
 v_and_b32 v81, s5, v166
 v_lshlrev_b32 v82, 16, v167
 v_and_b32 v83, s5, v167
 v_fmac_f32 v76, v68, v60
 v_fmac_f32 v77, v69, v61
 v_fmac_f32 v78, v70, v62
 v_fmac_f32 v79, v71, v63
 v_fmac_f32 v80, v72, v64
 v_fmac_f32 v81, v73, v65
 v_fmac_f32 v82, v74, v66
 v_fmac_f32 v83, v75, v67
 v_cvt_pk_bf16_f32 v84, v76, v77
 v_cvt_pk_bf16_f32 v85, v78, v79
 v_cvt_pk_bf16_f32 v86, v80, v81
 v_cvt_pk_bf16_f32 v87, v82, v83
 s_mov_b32 s84, 0
 s_nop 0
 v_permlane16_swap_b32 v84, v86
 v_permlane16_swap_b32 v85, v87
 buffer_store_dwordx4 v[56:59], v6, s[72:75], s84 offen offset:0 sc1
 buffer_store_dwordx4 v[84:87], v6, s[72:75], s84 offen offset:64 sc1
 s_nop 0
 v_accvgpr_read_b32 v32, a4
 v_accvgpr_read_b32 v33, a5
 v_accvgpr_read_b32 v34, a6
 v_accvgpr_read_b32 v35, a7
 v_accvgpr_read_b32 v36, a12
 v_accvgpr_read_b32 v37, a13
 v_accvgpr_read_b32 v38, a14
 v_accvgpr_read_b32 v39, a15
 v_accvgpr_read_b32 v40, a36
 v_accvgpr_read_b32 v41, a37
 v_accvgpr_read_b32 v42, a38
 v_accvgpr_read_b32 v43, a39
 v_accvgpr_read_b32 v44, a44
 v_accvgpr_read_b32 v45, a45
 v_accvgpr_read_b32 v46, a46
 v_accvgpr_read_b32 v47, a47
 v_lshlrev_b32 v48, 16, v168
 v_and_b32 v49, s5, v168
 v_lshlrev_b32 v50, 16, v169
 v_and_b32 v51, s5, v169
 v_lshlrev_b32 v52, 16, v170
 v_and_b32 v53, s5, v170
 v_lshlrev_b32 v54, 16, v171
 v_and_b32 v55, s5, v171
 v_fmac_f32 v48, v40, v32
 v_fmac_f32 v49, v41, v33
 v_fmac_f32 v50, v42, v34
 v_fmac_f32 v51, v43, v35
 v_fmac_f32 v52, v44, v36
 v_fmac_f32 v53, v45, v37
 v_fmac_f32 v54, v46, v38
 v_fmac_f32 v55, v47, v39
 v_cvt_pk_bf16_f32 v56, v48, v49
 v_cvt_pk_bf16_f32 v57, v50, v51
 v_cvt_pk_bf16_f32 v58, v52, v53
 v_cvt_pk_bf16_f32 v59, v54, v55
 s_mov_b32 s84, 32768
 s_nop 0
 v_permlane16_swap_b32 v56, v58
 v_permlane16_swap_b32 v57, v59
 v_accvgpr_read_b32 v60, a20
 v_accvgpr_read_b32 v61, a21
 v_accvgpr_read_b32 v62, a22
 v_accvgpr_read_b32 v63, a23
 v_accvgpr_read_b32 v64, a28
 v_accvgpr_read_b32 v65, a29
 v_accvgpr_read_b32 v66, a30
 v_accvgpr_read_b32 v67, a31
 v_accvgpr_read_b32 v68, a52
 v_accvgpr_read_b32 v69, a53
 v_accvgpr_read_b32 v70, a54
 v_accvgpr_read_b32 v71, a55
 v_accvgpr_read_b32 v72, a60
 v_accvgpr_read_b32 v73, a61
 v_accvgpr_read_b32 v74, a62
 v_accvgpr_read_b32 v75, a63
 v_lshlrev_b32 v76, 16, v172
 v_and_b32 v77, s5, v172
 v_lshlrev_b32 v78, 16, v173
 v_and_b32 v79, s5, v173
 v_lshlrev_b32 v80, 16, v174
 v_and_b32 v81, s5, v174
 v_lshlrev_b32 v82, 16, v175
 v_and_b32 v83, s5, v175
 v_fmac_f32 v76, v68, v60
 v_fmac_f32 v77, v69, v61
 v_fmac_f32 v78, v70, v62
 v_fmac_f32 v79, v71, v63
 v_fmac_f32 v80, v72, v64
 v_fmac_f32 v81, v73, v65
 v_fmac_f32 v82, v74, v66
 v_fmac_f32 v83, v75, v67
 v_cvt_pk_bf16_f32 v84, v76, v77
 v_cvt_pk_bf16_f32 v85, v78, v79
 v_cvt_pk_bf16_f32 v86, v80, v81
 v_cvt_pk_bf16_f32 v87, v82, v83
 s_mov_b32 s84, 32768
 s_nop 0
 v_permlane16_swap_b32 v84, v86
 v_permlane16_swap_b32 v85, v87
 buffer_store_dwordx4 v[56:59], v6, s[72:75], s84 offen offset:0 sc1
 buffer_store_dwordx4 v[84:87], v6, s[72:75], s84 offen offset:64 sc1
 s_nop 0
 s_endpgm
L_b_end:
    s_endpgm
.section .rodata,"a"
.p2align 6
.amdhsa_kernel gemm1_kernel
  .amdhsa_next_free_vgpr 512
  .amdhsa_next_free_sgpr 102
  .amdhsa_accum_offset 256
  .amdhsa_group_segment_fixed_size 0
  .amdhsa_kernarg_size 80
  .amdhsa_user_sgpr_count 2
  .amdhsa_user_sgpr_kernarg_segment_ptr 1
  .amdhsa_system_sgpr_workgroup_id_x 1
  .amdhsa_float_denorm_mode_32 3
.end_amdhsa_kernel
.p2align 6
.amdhsa_kernel attfin_kernel
  .amdhsa_next_free_vgpr 256
  .amdhsa_next_free_sgpr 102
  .amdhsa_accum_offset 192
  .amdhsa_group_segment_fixed_size 0
  .amdhsa_kernarg_size 80
  .amdhsa_user_sgpr_count 2
  .amdhsa_user_sgpr_kernarg_segment_ptr 1
  .amdhsa_system_sgpr_workgroup_id_x 1
  .amdhsa_float_denorm_mode_32 3
.end_amdhsa_kernel
```
